```python
import torch

def _softmax(x, axis=-1):
    return torch.softmax(x, dim=axis)

def _gelu(x):
    return torch.nn.functional.gelu(x, approximate='tanh')

def _silu(x):
    return torch.nn.functional.silu(x)

def _sigmoid(x):
    return torch.sigmoid(x)

def _layernorm(x, axis=-1, eps=1e-05):
    m = x.mean(dim=axis, keepdim=True)
    v = x.var(dim=axis, keepdim=True, unbiased=False)
    return (x - m) / torch.sqrt(v + eps)

def _scatter_add(tgt, idx, src, axis=0):
    return tgt.clone().index_add_(axis, idx, src)

def _segment_sum(src, seg, n):
    out = torch.zeros((n,) + src.shape[1:], dtype=src.dtype)
    return out.index_add_(0, seg, src)

def _pad(x, pw):
    flat = tuple((v for pair in reversed(pw) for v in pair))
    return torch.nn.functional.pad(x, flat)
kernel_name = 'adaLN_cond__memory_aug_recurrent_mem_tr__dense_activation_relu__prompt'

def setup_inputs():

    _w = lambda a: (lambda t: t.to(torch.bfloat16) if t.is_floating_point() else t)(torch.as_tensor(a))

    def _A_setup():
        B, S, Dm = (1, 2048, 1024)
        H, Dh = (32, 128)
        M, seg = (8, 32)
        seg = min(seg, S)
        S = S // seg * seg
        return {'x': _w((lambda *s: torch.randn(*s, dtype=torch.bfloat16) * 0.05)(B, S, Dm)), 'mem0': _w((lambda *s: torch.randn(*s, dtype=torch.bfloat16) * 0.4)(B, M, Dm)), 'Wq': _w((lambda *s: torch.randn(*s, dtype=torch.bfloat16) * 3.2)(Dm, H, Dh) * Dm ** (-0.5)), 'Wk': _w((lambda *s: torch.randn(*s, dtype=torch.bfloat16) * 3.2)(Dm, H, Dh) * Dm ** (-0.5)), 'Wv': _w((lambda *s: torch.randn(*s, dtype=torch.bfloat16) * 0.4)(Dm, H, Dh) * Dm ** (-0.5)), 'Wo': _w((lambda *s: torch.randn(*s, dtype=torch.bfloat16) * 0.4)(H, Dh, Dm) * (H * Dh) ** (-0.5)), 'seg_len': seg}
    _A_in = _A_setup()

    def _B_setup():
        B, S, D, Dff = (1, 2048, 1024, 3584)
        return {'x': _w((lambda *s: torch.randn(*s, dtype=torch.bfloat16) * 0.05)(B, S, D)), 'w1': _w((lambda *s: torch.randn(*s, dtype=torch.bfloat16) * 0.05)(D, Dff)), 'w2': _w((lambda *s: torch.randn(*s, dtype=torch.bfloat16) * 0.05)(Dff, D))}
    _B_in = _B_setup()
    return {'A_x': _A_in['x'], 'A_mem0': _A_in['mem0'], 'A_Wq': _A_in['Wq'], 'A_Wk': _A_in['Wk'], 'A_Wv': _A_in['Wv'], 'A_Wo': _A_in['Wo'], 'A_seg_len': _A_in['seg_len'], 'B_x': _B_in['x'], 'B_w1': _B_in['w1'], 'B_w2': _B_in['w2'], 'c': _w((lambda *s: torch.randn(*s, dtype=torch.bfloat16) * 0.1)(1, 1024) * 8.0), 'w_mod': _w((lambda *s: torch.randn(*s, dtype=torch.bfloat16) * 0.1)(1024, 6 * 1024) * 1024 ** (-0.5) * 8.0)}

def reference(A_x, A_mem0, A_Wq, A_Wk, A_Wv, A_Wo, A_seg_len, B_x, B_w1, B_w2, c, w_mod):

    def _A_ref(x, mem0, Wq, Wk, Wv, Wo, seg_len):
        B, S, Dm = x.shape
        H, Dh = (Wq.shape[1], Wq.shape[2])
        M = mem0.shape[1]
        scale = Dh ** (-0.5)
        n_seg = S // seg_len
        L = M + seg_len
        idx = torch.arange(L)
        mask = (idx[:, None] < M) | (idx[:, None] >= idx[None, :])
        mem = mem0
        outs = []
        for s in range(n_seg):
            xs = x[:, s * seg_len:(s + 1) * seg_len, :].clone()
            h = torch.concatenate([mem, xs], axis=1)
            q = torch.einsum('btd,dhe->bhte', h, Wq)
            k = torch.einsum('btd,dhe->bhte', h, Wk)
            v = torch.einsum('btd,dhe->bhte', h, Wv)
            scores = torch.einsum('bhqe,bhke->bhqk', q, k) * scale
            scores = torch.where(mask[None, None], scores, -1000000000.0)
            p = _softmax(scores, axis=-1)
            o = torch.einsum('bhqk,bhke->bhqe', p, v)
            o = torch.einsum('bhte,hed->btd', o, Wo)
            mem = o[:, :M, :].clone()
            outs.append(o[:, M:, :])
        return torch.concatenate(outs, axis=1)

    def _B_ref(x, w1, w2):
        h = torch.einsum('bsd,df->bsf', x, w1)
        zero = torch.zeros_like(h)
        h = torch.maximum(h, zero)
        return torch.einsum('bsf,fd->bsd', h, w2)
    x = A_x
    mod = (_silu(c) @ w_mod).reshape(c.shape[0], 6, 1, -1)
    sa, ca, ga, sb, cb, gb = (mod[:, 0].clone(), mod[:, 1].clone(), mod[:, 2].clone(), mod[:, 3].clone(), mod[:, 4].clone(), mod[:, 5].clone())
    h = _layernorm(x, axis=-1) * (1 + ca) + sa
    x = x + ga * _A_ref(h, A_mem0, A_Wq, A_Wk, A_Wv, A_Wo, A_seg_len)
    h = _layernorm(x, axis=-1) * (1 + cb) + sb
    x = x + gb * _B_ref(h, B_w1, B_w2)
    return x
```

```asm
; @launch kernel=mod_kernel grid=(256,1,1) block=(1024,1,1) lds=2048
; @launch kernel=main_kernel grid=(256,1,1) block=(256,1,1) lds=159744
.amdgcn_target "amdgcn-amd-amdhsa--gfx950"
.text
.globl mod_kernel
.p2align 8
.type mod_kernel,@function
mod_kernel:
s_cmp_ge_u32 s2, 256
s_cbranch_scc1 .Lend_1
s_load_dwordx2 s[4:5], s[0:1], 112
s_load_dwordx2 s[6:7], s[0:1], 80
s_load_dwordx2 s[8:9], s[0:1], 88
s_cmp_ge_u32 s2, 192
s_cbranch_scc1 .Lfill_2
v_lshrrev_b32 v2, 2, v0
v_lshlrev_b32 v3, 1, v2
v_mul_u32_u24 v4, 12288, v2
v_and_b32 v5, 3, v0
v_lshlrev_b32 v5, 4, v5
v_add_u32 v4, v4, v5
s_lshl_b32 s10, s2, 6
s_waitcnt lgkmcnt(0)
s_mov_b32 s12, s6
s_mov_b32 s13, s7
s_mov_b32 s14, 0x800
s_mov_b32 s15, 0x00020000
s_mov_b32 s16, s8
s_mov_b32 s17, s9
s_mov_b32 s18, 0xc00000
s_mov_b32 s19, 0x00020000
s_add_u32 s20, s4, 0xc00000
s_addc_u32 s21, s5, 0
s_mov_b32 s22, 0x6000
s_mov_b32 s23, 0x00020000
buffer_load_ushort v8, v3, s[12:15], 0 offen offset:0
buffer_load_ushort v9, v3, s[12:15], 0 offen offset:512
buffer_load_ushort v10, v3, s[12:15], 0 offen offset:1024
buffer_load_ushort v11, v3, s[12:15], 0 offen offset:1536
buffer_load_dwordx4 v[12:15], v4, s[16:19], s10 offen
s_add_u32 s10, s10, 3145728
buffer_load_dwordx4 v[16:19], v4, s[16:19], s10 offen
s_add_u32 s10, s10, 3145728
buffer_load_dwordx4 v[20:23], v4, s[16:19], s10 offen
s_add_u32 s10, s10, 3145728
buffer_load_dwordx4 v[24:27], v4, s[16:19], s10 offen
v_mov_b32 v32, 0
v_mov_b32 v33, 0
v_mov_b32 v34, 0
v_mov_b32 v35, 0
v_mov_b32 v36, 0
v_mov_b32 v37, 0
v_mov_b32 v38, 0
v_mov_b32 v39, 0
s_waitcnt vmcnt(4)
v_lshlrev_b32 v8, 16, v8
v_mul_f32 v6, 0xbfb8aa3b, v8
v_exp_f32 v6, v6
s_nop 0
v_add_f32 v6, 1.0, v6
v_rcp_f32 v6, v6
s_nop 0
v_mul_f32 v8, v8, v6
v_cvt_pk_bf16_f32 v8, v8, v8
v_lshlrev_b32 v8, 16, v8
v_lshlrev_b32 v9, 16, v9
v_mul_f32 v6, 0xbfb8aa3b, v9
v_exp_f32 v6, v6
s_nop 0
v_add_f32 v6, 1.0, v6
v_rcp_f32 v6, v6
s_nop 0
v_mul_f32 v9, v9, v6
v_cvt_pk_bf16_f32 v9, v9, v9
v_lshlrev_b32 v9, 16, v9
v_lshlrev_b32 v10, 16, v10
v_mul_f32 v6, 0xbfb8aa3b, v10
v_exp_f32 v6, v6
s_nop 0
v_add_f32 v6, 1.0, v6
v_rcp_f32 v6, v6
s_nop 0
v_mul_f32 v10, v10, v6
v_cvt_pk_bf16_f32 v10, v10, v10
v_lshlrev_b32 v10, 16, v10
v_lshlrev_b32 v11, 16, v11
v_mul_f32 v6, 0xbfb8aa3b, v11
v_exp_f32 v6, v6
s_nop 0
v_add_f32 v6, 1.0, v6
v_rcp_f32 v6, v6
s_nop 0
v_mul_f32 v11, v11, v6
v_cvt_pk_bf16_f32 v11, v11, v11
v_lshlrev_b32 v11, 16, v11
s_waitcnt vmcnt(3)
v_lshlrev_b32 v6, 16, v12
v_and_b32 v7, 0xffff0000, v12
v_fmac_f32 v32, v6, v8
v_fmac_f32 v33, v7, v8
v_lshlrev_b32 v6, 16, v13
v_and_b32 v7, 0xffff0000, v13
v_fmac_f32 v34, v6, v8
v_fmac_f32 v35, v7, v8
v_lshlrev_b32 v6, 16, v14
v_and_b32 v7, 0xffff0000, v14
v_fmac_f32 v36, v6, v8
v_fmac_f32 v37, v7, v8
v_lshlrev_b32 v6, 16, v15
v_and_b32 v7, 0xffff0000, v15
v_fmac_f32 v38, v6, v8
v_fmac_f32 v39, v7, v8
s_waitcnt vmcnt(2)
v_lshlrev_b32 v6, 16, v16
v_and_b32 v7, 0xffff0000, v16
v_fmac_f32 v32, v6, v9
v_fmac_f32 v33, v7, v9
v_lshlrev_b32 v6, 16, v17
v_and_b32 v7, 0xffff0000, v17
v_fmac_f32 v34, v6, v9
v_fmac_f32 v35, v7, v9
v_lshlrev_b32 v6, 16, v18
v_and_b32 v7, 0xffff0000, v18
v_fmac_f32 v36, v6, v9
v_fmac_f32 v37, v7, v9
v_lshlrev_b32 v6, 16, v19
v_and_b32 v7, 0xffff0000, v19
v_fmac_f32 v38, v6, v9
v_fmac_f32 v39, v7, v9
s_waitcnt vmcnt(1)
v_lshlrev_b32 v6, 16, v20
v_and_b32 v7, 0xffff0000, v20
v_fmac_f32 v32, v6, v10
v_fmac_f32 v33, v7, v10
v_lshlrev_b32 v6, 16, v21
v_and_b32 v7, 0xffff0000, v21
v_fmac_f32 v34, v6, v10
v_fmac_f32 v35, v7, v10
v_lshlrev_b32 v6, 16, v22
v_and_b32 v7, 0xffff0000, v22
v_fmac_f32 v36, v6, v10
v_fmac_f32 v37, v7, v10
v_lshlrev_b32 v6, 16, v23
v_and_b32 v7, 0xffff0000, v23
v_fmac_f32 v38, v6, v10
v_fmac_f32 v39, v7, v10
s_waitcnt vmcnt(0)
v_lshlrev_b32 v6, 16, v24
v_and_b32 v7, 0xffff0000, v24
v_fmac_f32 v32, v6, v11
v_fmac_f32 v33, v7, v11
v_lshlrev_b32 v6, 16, v25
v_and_b32 v7, 0xffff0000, v25
v_fmac_f32 v34, v6, v11
v_fmac_f32 v35, v7, v11
v_lshlrev_b32 v6, 16, v26
v_and_b32 v7, 0xffff0000, v26
v_fmac_f32 v36, v6, v11
v_fmac_f32 v37, v7, v11
v_lshlrev_b32 v6, 16, v27
v_and_b32 v7, 0xffff0000, v27
v_fmac_f32 v38, v6, v11
v_fmac_f32 v39, v7, v11
v_add_f32_dpp v32, v32, v32 row_ror:4 row_mask:0xf bank_mask:0xf
v_add_f32_dpp v33, v33, v33 row_ror:4 row_mask:0xf bank_mask:0xf
v_add_f32_dpp v34, v34, v34 row_ror:4 row_mask:0xf bank_mask:0xf
v_add_f32_dpp v35, v35, v35 row_ror:4 row_mask:0xf bank_mask:0xf
v_add_f32_dpp v36, v36, v36 row_ror:4 row_mask:0xf bank_mask:0xf
v_add_f32_dpp v37, v37, v37 row_ror:4 row_mask:0xf bank_mask:0xf
v_add_f32_dpp v38, v38, v38 row_ror:4 row_mask:0xf bank_mask:0xf
v_add_f32_dpp v39, v39, v39 row_ror:4 row_mask:0xf bank_mask:0xf
v_add_f32_dpp v32, v32, v32 row_ror:8 row_mask:0xf bank_mask:0xf
v_add_f32_dpp v33, v33, v33 row_ror:8 row_mask:0xf bank_mask:0xf
v_add_f32_dpp v34, v34, v34 row_ror:8 row_mask:0xf bank_mask:0xf
v_add_f32_dpp v35, v35, v35 row_ror:8 row_mask:0xf bank_mask:0xf
v_add_f32_dpp v36, v36, v36 row_ror:8 row_mask:0xf bank_mask:0xf
v_add_f32_dpp v37, v37, v37 row_ror:8 row_mask:0xf bank_mask:0xf
v_add_f32_dpp v38, v38, v38 row_ror:8 row_mask:0xf bank_mask:0xf
v_add_f32_dpp v39, v39, v39 row_ror:8 row_mask:0xf bank_mask:0xf
v_mov_b32 v40, v32
v_mov_b32 v41, v33
v_mov_b32 v42, v34
v_mov_b32 v43, v35
v_mov_b32 v44, v36
v_mov_b32 v45, v37
v_mov_b32 v46, v38
v_mov_b32 v47, v39
v_permlane16_swap_b32 v32, v40
v_permlane16_swap_b32 v33, v41
v_permlane16_swap_b32 v34, v42
v_permlane16_swap_b32 v35, v43
v_permlane16_swap_b32 v36, v44
v_permlane16_swap_b32 v37, v45
v_permlane16_swap_b32 v38, v46
v_permlane16_swap_b32 v39, v47
v_add_f32 v32, v32, v40
v_add_f32 v33, v33, v41
v_add_f32 v34, v34, v42
v_add_f32 v35, v35, v43
v_add_f32 v36, v36, v44
v_add_f32 v37, v37, v45
v_add_f32 v38, v38, v46
v_add_f32 v39, v39, v47
v_mov_b32 v40, v32
v_mov_b32 v41, v33
v_mov_b32 v42, v34
v_mov_b32 v43, v35
v_mov_b32 v44, v36
v_mov_b32 v45, v37
v_mov_b32 v46, v38
v_mov_b32 v47, v39
v_permlane32_swap_b32 v32, v40
v_permlane32_swap_b32 v33, v41
v_permlane32_swap_b32 v34, v42
v_permlane32_swap_b32 v35, v43
v_permlane32_swap_b32 v36, v44
v_permlane32_swap_b32 v37, v45
v_permlane32_swap_b32 v38, v46
v_permlane32_swap_b32 v39, v47
v_add_f32 v32, v32, v40
v_add_f32 v33, v33, v41
v_add_f32 v34, v34, v42
v_add_f32 v35, v35, v43
v_add_f32 v36, v36, v44
v_add_f32 v37, v37, v45
v_add_f32 v38, v38, v46
v_add_f32 v39, v39, v47
v_lshrrev_b32 v2, 6, v0
v_lshlrev_b32 v2, 7, v2
v_and_b32 v3, 63, v0
v_lshlrev_b32 v5, 5, v3
v_add_u32 v2, v2, v5
s_mov_b64 exec, 0xf
ds_write_b128 v2, v[32:35]
ds_write_b128 v2, v[36:39] offset:16
s_mov_b64 exec, -1
s_waitcnt lgkmcnt(0)
s_barrier
v_cmp_gt_u32 vcc, 32, v0
s_and_saveexec_b64 s[24:25], vcc
s_cbranch_execz .Lend_1
v_lshlrev_b32 v2, 2, v0
ds_read_b32 v8, v2 offset:0
ds_read_b32 v9, v2 offset:128
ds_read_b32 v10, v2 offset:256
ds_read_b32 v11, v2 offset:384
ds_read_b32 v12, v2 offset:512
ds_read_b32 v13, v2 offset:640
ds_read_b32 v14, v2 offset:768
ds_read_b32 v15, v2 offset:896
ds_read_b32 v16, v2 offset:1024
ds_read_b32 v17, v2 offset:1152
ds_read_b32 v18, v2 offset:1280
ds_read_b32 v19, v2 offset:1408
ds_read_b32 v20, v2 offset:1536
ds_read_b32 v21, v2 offset:1664
ds_read_b32 v22, v2 offset:1792
ds_read_b32 v23, v2 offset:1920
s_waitcnt lgkmcnt(0)
v_add_f32 v8, v8, v9
v_add_f32 v8, v8, v10
v_add_f32 v8, v8, v11
v_add_f32 v8, v8, v12
v_add_f32 v8, v8, v13
v_add_f32 v8, v8, v14
v_add_f32 v8, v8, v15
v_add_f32 v8, v8, v16
v_add_f32 v8, v8, v17
v_add_f32 v8, v8, v18
v_add_f32 v8, v8, v19
v_add_f32 v8, v8, v20
v_add_f32 v8, v8, v21
v_add_f32 v8, v8, v22
v_add_f32 v8, v8, v23
v_cvt_pk_bf16_f32 v8, v8, v8
v_lshlrev_b32 v8, 16, v8
s_lshr_b32 s10, s2, 5
v_add_f32 v9, 1.0, v8
v_cvt_pk_bf16_f32 v9, v9, v9
v_lshlrev_b32 v9, 16, v9
s_cmp_eq_u32 s10, 1
s_cselect_b32 s11, 1, 0
s_cmp_eq_u32 s10, 4
s_cselect_b32 s11, 1, s11
s_cmp_eq_u32 s11, 1
s_cselect_b64 vcc, -1, 0
v_cndmask_b32 v8, v8, v9, vcc
v_and_b32 v2, 16, v0
v_lshlrev_b32 v2, 2, v2
v_and_b32 v3, 4, v0
v_lshlrev_b32 v3, 3, v3
v_add_u32 v2, v2, v3
v_and_b32 v3, 8, v0
v_lshlrev_b32 v3, 1, v3
v_add_u32 v2, v2, v3
v_and_b32 v3, 3, v0
v_lshlrev_b32 v3, 2, v3
v_add_u32 v2, v2, v3
s_lshl_b32 s10, s2, 7
buffer_store_dword v8, v2, s[20:23], s10 offen
s_waitcnt vmcnt(0)
s_endpgm
.Lfill_2:
s_waitcnt lgkmcnt(0)
s_add_u32 s20, s4, 0xd00000
s_addc_u32 s21, s5, 0
s_mov_b32 s22, 0x200000
s_mov_b32 s23, 0x00020000
s_sub_u32 s10, s2, 192
s_mul_i32 s10, s10, 32768
v_lshlrev_b32 v2, 4, v0
v_mov_b32 v4, -1
v_mov_b32 v5, -1
v_mov_b32 v6, -1
v_mov_b32 v7, -1
buffer_store_dwordx4 v[4:7], v2, s[20:23], s10 offen
s_add_u32 s10, s10, 16384
buffer_store_dwordx4 v[4:7], v2, s[20:23], s10 offen
s_add_u32 s10, s10, 16384
s_add_u32 s20, s4, 0x8000000
s_addc_u32 s21, s5, 0
s_mov_b32 s22, 0x100000
s_mov_b32 s23, 0x00020000
s_sub_u32 s10, s2, 192
s_lshl_b32 s10, s10, 14
buffer_store_dwordx4 v[4:7], v2, s[20:23], s10 offen
s_sub_u32 s10, s2, 192
s_lshr_b32 s11, s10, 5
s_lshl_b32 s12, s11, 5
s_add_u32 s12, s12, 40
s_load_dwordx2 s[6:7], s[0:1], s12
s_mov_b32 s14, 7340032
s_cmp_eq_u32 s11, 0
s_cselect_b32 s14, 8388608, s14
s_mov_b32 s15, 0x00020000
s_add_u32 s16, s4, 0x6c00000
s_addc_u32 s17, s5, 0
s_mov_b32 s18, 0x200000
s_mov_b32 s19, 0x00020000
s_and_b32 s24, s10, 15
s_bfe_u32 s25, s10, 0x10004
s_lshl_b32 s26, s24, 19
s_lshl_b32 s27, s25, 10
s_add_u32 s26, s26, s27
s_add_u32 s26, s26, 384
s_lshl_b32 s27, s10, 15
v_lshrrev_b32 v9, 3, v0
v_lshlrev_b32 v9, 11, v9
v_and_b32 v10, 7, v0
v_lshl_add_u32 v9, v10, 4, v9
s_waitcnt lgkmcnt(0)
s_mov_b32 s12, s6
s_mov_b32 s13, s7
v_add_u32 v9, s26, v9
v_add_u32 v10, 262144, v9
buffer_load_dwordx4 v[12:15], v9, s[12:15], 0 offen
buffer_load_dwordx4 v[16:19], v10, s[12:15], 0 offen
s_waitcnt vmcnt(1)
buffer_store_dwordx4 v[12:15], v2, s[16:19], s27 offen
s_add_u32 s27, s27, 16384
s_waitcnt vmcnt(1)
buffer_store_dwordx4 v[16:19], v2, s[16:19], s27 offen
s_add_u32 s24, s4, 0xf00000
s_addc_u32 s25, s5, 0
s_mov_b32 s26, 0x10000
s_mov_b32 s27, 0x00020000
s_sub_u32 s10, s2, 192
s_lshl_b32 s10, s10, 10
v_mov_b32 v8, 0
v_cmp_gt_u32 vcc, 0x100, v0
v_lshlrev_b32 v3, 2, v0
s_and_saveexec_b64 s[28:29], vcc
buffer_store_dword v8, v3, s[24:27], s10 offen
s_add_u32 s24, s4, 0x8104000
s_addc_u32 s25, s5, 0
s_mov_b32 s26, 0x10000
s_mov_b32 s27, 0x00020000
buffer_store_dword v8, v3, s[24:27], s10 offen
s_waitcnt vmcnt(0)
.Lend_1:
s_endpgm
.section .rodata,"a"
.p2align 6
.amdhsa_kernel mod_kernel
.amdhsa_next_free_vgpr 48
.amdhsa_next_free_sgpr 102
.amdhsa_accum_offset 48
.amdhsa_group_segment_fixed_size 0
.amdhsa_kernarg_size 120
.amdhsa_user_sgpr_count 2
.amdhsa_user_sgpr_kernarg_segment_ptr 1
.amdhsa_system_sgpr_workgroup_id_x 1
.end_amdhsa_kernel
.text
.globl main_kernel
.p2align 8
.type main_kernel,@function
main_kernel:
s_cmp_ge_u32 s2, 256
s_cbranch_scc1 .Lend_3
v_lshrrev_b32 v1, 6, v0
s_nop 0
v_readfirstlane_b32 s3, v1
v_and_b32 v0, 63, v0
s_load_dwordx2 s[4:5], s[0:1], 112
s_load_dwordx2 s[6:7], s[0:1], 0
s_waitcnt lgkmcnt(0)
s_add_u32 s16, s4, 0xf00000
s_addc_u32 s17, s5, 0
s_mov_b32 s18, 0x10000
s_mov_b32 s19, 0x00020000
s_getreg_b32 s20, hwreg(HW_REG_XCC_ID, 0, 4)
s_and_b32 s20, s20, 7
v_mov_b32 v170, 0
s_cmp_lg_u32 s3, 0
s_cbranch_scc1 .Lr0_6
s_lshl_b32 s30, s20, 7
v_mov_b32 v172, 1
s_mov_b64 exec, 1
buffer_atomic_add v172, v170, s[16:19], s30 offen sc0
s_mov_b64 exec, -1
.Lr0_6:
s_lshr_b32 s58, s2, 5
s_lshl_b32 s58, s58, 7
s_mov_b32 s40, s6
s_mov_b32 s41, s7
s_mov_b32 s42, 0x400000
s_mov_b32 s43, 0x00020000
v_and_b32 v2, 7, v0
v_bfe_u32 v3, v0, 3, 2
v_lshrrev_b32 v5, 5, v0
v_lshlrev_b32 v4, 11, v2
v_lshl_add_u32 v4, v3, 5, v4
v_lshl_add_u32 v4, v5, 4, v4
s_lshl_b32 s56, s2, 14
s_lshl_b32 s57, s3, 9
s_add_u32 s56, s56, s57
buffer_load_dwordx4 v[32:35], v4, s[40:43], s56 offen offset:0
buffer_load_dwordx4 v[36:39], v4, s[40:43], s56 offen offset:128
buffer_load_dwordx4 v[40:43], v4, s[40:43], s56 offen offset:256
buffer_load_dwordx4 v[44:47], v4, s[40:43], s56 offen offset:384
s_add_u32 s44, s4, 0xc00000
s_addc_u32 s45, s5, 0
s_mov_b32 s46, 0x2000
s_mov_b32 s47, 0x00020000
v_lshlrev_b32 v6, 6, v3
v_lshl_add_u32 v6, v5, 5, v6
s_lshl_b32 s56, s3, 10
s_add_u32 s57, s56, 4096
buffer_load_dwordx4 v[64:67], v6, s[44:47], s56 offen offset:0
buffer_load_dwordx4 v[96:99], v6, s[44:47], s57 offen offset:0
buffer_load_dwordx4 v[68:71], v6, s[44:47], s56 offen offset:16
buffer_load_dwordx4 v[100:103], v6, s[44:47], s57 offen offset:16
buffer_load_dwordx4 v[72:75], v6, s[44:47], s56 offen offset:256
buffer_load_dwordx4 v[104:107], v6, s[44:47], s57 offen offset:256
buffer_load_dwordx4 v[76:79], v6, s[44:47], s56 offen offset:272
buffer_load_dwordx4 v[108:111], v6, s[44:47], s57 offen offset:272
buffer_load_dwordx4 v[80:83], v6, s[44:47], s56 offen offset:512
buffer_load_dwordx4 v[112:115], v6, s[44:47], s57 offen offset:512
buffer_load_dwordx4 v[84:87], v6, s[44:47], s56 offen offset:528
buffer_load_dwordx4 v[116:119], v6, s[44:47], s57 offen offset:528
buffer_load_dwordx4 v[88:91], v6, s[44:47], s56 offen offset:768
buffer_load_dwordx4 v[120:123], v6, s[44:47], s57 offen offset:768
buffer_load_dwordx4 v[92:95], v6, s[44:47], s56 offen offset:784
buffer_load_dwordx4 v[124:127], v6, s[44:47], s57 offen offset:784
s_add_u32 s48, s4, 0x0
s_addc_u32 s49, s5, 0
s_mov_b32 s50, 0x400000
s_mov_b32 s51, 0x00020000
s_add_u32 s52, s4, 0x400000
s_addc_u32 s53, s5, 0
s_mov_b32 s54, 0x400000
s_mov_b32 s55, 0x00020000
v_lshlrev_b32 v4, 4, v2
v_lshl_add_u32 v4, v5, 9, v4
v_lshl_add_u32 v4, v3, 10, v4
s_lshr_b32 s56, s2, 2
s_lshl_b32 s56, s56, 16
s_and_b32 s57, s2, 3
s_lshl_b32 s57, s57, 7
s_add_u32 s56, s56, s57
s_lshl_b32 s57, s3, 14
s_add_u32 s56, s56, s57
s_cmp_lg_u32 s3, 0
s_cbranch_scc1 .Lrs_7
s_mov_b64 exec, 1
s_waitcnt vmcnt(20)
v_readfirstlane_b32 s21, v172
ds_write_b32 v170, v172 offset:18432
s_cmp_lg_u32 s21, 31
s_cbranch_scc1 .Lnf_8
v_mov_b32 v172, 1
buffer_atomic_add v172, v170, s[16:19], 0 offen offset:1024 sc0 sc1
s_waitcnt vmcnt(0)
v_readfirstlane_b32 s30, v172
s_cmp_lg_u32 s30, 7
s_cbranch_scc1 .Lnf_8
v_mov_b32 v172, 1
v_mov_b32 v173, 0
buffer_atomic_cmpswap v[172:173], v170, s[16:19], 0 offen offset:1152 sc1
s_waitcnt vmcnt(0)
.Lnf_8:
s_mov_b64 exec, -1
.Lrs_7:
v_mov_b32 v6, 0x3f803f80
v_mov_b32 v8, 0
v_mov_b32 v9, 0
v_mov_b32 v10, 0
v_mov_b32 v11, 0
s_waitcnt vmcnt(19)
v_dot2c_f32_bf16 v8, v32, v6
v_dot2c_f32_bf16 v9, v32, v32
v_dot2c_f32_bf16 v10, v33, v6
v_dot2c_f32_bf16 v11, v33, v33
v_dot2c_f32_bf16 v8, v34, v6
v_dot2c_f32_bf16 v9, v34, v34
v_dot2c_f32_bf16 v10, v35, v6
v_dot2c_f32_bf16 v11, v35, v35
s_waitcnt vmcnt(18)
v_dot2c_f32_bf16 v8, v36, v6
v_dot2c_f32_bf16 v9, v36, v36
v_dot2c_f32_bf16 v10, v37, v6
v_dot2c_f32_bf16 v11, v37, v37
v_dot2c_f32_bf16 v8, v38, v6
v_dot2c_f32_bf16 v9, v38, v38
v_dot2c_f32_bf16 v10, v39, v6
v_dot2c_f32_bf16 v11, v39, v39
s_waitcnt vmcnt(17)
v_dot2c_f32_bf16 v8, v40, v6
v_dot2c_f32_bf16 v9, v40, v40
v_dot2c_f32_bf16 v10, v41, v6
v_dot2c_f32_bf16 v11, v41, v41
v_dot2c_f32_bf16 v8, v42, v6
v_dot2c_f32_bf16 v9, v42, v42
v_dot2c_f32_bf16 v10, v43, v6
v_dot2c_f32_bf16 v11, v43, v43
s_waitcnt vmcnt(16)
v_dot2c_f32_bf16 v8, v44, v6
v_dot2c_f32_bf16 v9, v44, v44
v_dot2c_f32_bf16 v10, v45, v6
v_dot2c_f32_bf16 v11, v45, v45
v_dot2c_f32_bf16 v8, v46, v6
v_dot2c_f32_bf16 v9, v46, v46
v_dot2c_f32_bf16 v10, v47, v6
v_dot2c_f32_bf16 v11, v47, v47
s_nop 1
v_add_f32 v8, v8, v10
v_add_f32 v9, v9, v11
s_nop 0
v_add_f32_dpp v8, v8, v8 row_ror:8 row_mask:0xf bank_mask:0xf
v_add_f32_dpp v9, v9, v9 row_ror:8 row_mask:0xf bank_mask:0xf
v_mov_b32 v10, v8
v_mov_b32 v11, v9
s_nop 0
v_permlane16_swap_b32 v8, v10
v_permlane16_swap_b32 v9, v11
v_add_f32 v8, v8, v10
v_add_f32 v9, v9, v11
v_mov_b32 v10, v8
v_mov_b32 v11, v9
s_nop 0
v_permlane32_swap_b32 v8, v10
v_permlane32_swap_b32 v9, v11
v_add_f32 v8, v8, v10
v_add_f32 v9, v9, v11
v_lshlrev_b32 v7, 3, v2
s_lshl_b32 s57, s3, 6
v_add_u32 v12, s57, v7
ds_write_b64 v12, v[8:9]
v_permlane32_swap_b32 v32, v34
v_permlane32_swap_b32 v33, v35
v_permlane32_swap_b32 v36, v38
v_permlane32_swap_b32 v37, v39
v_permlane32_swap_b32 v40, v42
v_permlane32_swap_b32 v41, v43
v_permlane32_swap_b32 v44, v46
v_permlane32_swap_b32 v45, v47
s_add_u32 s57, s56, 0
buffer_store_dwordx4 v[32:35], v4, s[52:55], s57 offen sc1
s_add_u32 s57, s56, 4096
buffer_store_dwordx4 v[36:39], v4, s[52:55], s57 offen sc1
s_add_u32 s57, s56, 8192
buffer_store_dwordx4 v[40:43], v4, s[52:55], s57 offen sc1
s_add_u32 s57, s56, 12288
buffer_store_dwordx4 v[44:47], v4, s[52:55], s57 offen sc1
s_waitcnt lgkmcnt(0)
s_barrier
ds_read_b64 v[8:9], v7 offset:0
ds_read_b64 v[10:11], v7 offset:64
ds_read_b64 v[12:13], v7 offset:128
ds_read_b64 v[14:15], v7 offset:192
s_waitcnt lgkmcnt(0)
v_add_f32 v8, v8, v10
v_add_f32 v9, v9, v11
v_add_f32 v12, v12, v14
v_add_f32 v13, v13, v15
v_add_f32 v8, v8, v12
v_add_f32 v9, v9, v13
v_mul_f32 v8, 0x3a800000, v8
v_mul_f32 v9, 0x3a800000, v9
v_fma_f32 v9, -v8, v8, v9
v_max_f32 v9, 0, v9
v_cvt_pk_bf16_f32 v10, v8, v9
v_lshlrev_b32 v8, 16, v10
v_and_b32 v9, 0xffff0000, v10
v_add_f32 v9, 0x3727c5ac, v9
v_cvt_pk_bf16_f32 v9, v9, v9
v_lshlrev_b32 v9, 16, v9
v_sqrt_f32 v9, v9
s_nop 0
v_cvt_pk_bf16_f32 v9, v9, v9
v_lshlrev_b32 v9, 16, v9
v_rcp_f32 v9, v9
s_waitcnt vmcnt(4)
v_lshlrev_b32 v12, 16, v32
v_and_b32 v13, 0xffff0000, v32
v_lshlrev_b32 v14, 16, v33
v_and_b32 v15, 0xffff0000, v33
v_lshlrev_b32 v16, 16, v34
v_and_b32 v17, 0xffff0000, v34
v_lshlrev_b32 v18, 16, v35
v_and_b32 v19, 0xffff0000, v35
v_sub_f32 v12, v12, v8
v_sub_f32 v13, v13, v8
v_sub_f32 v14, v14, v8
v_sub_f32 v15, v15, v8
v_sub_f32 v16, v16, v8
v_sub_f32 v17, v17, v8
v_sub_f32 v18, v18, v8
v_sub_f32 v19, v19, v8
v_cvt_pk_bf16_f32 v20, v12, v13
v_cvt_pk_bf16_f32 v21, v14, v15
v_cvt_pk_bf16_f32 v22, v16, v17
v_cvt_pk_bf16_f32 v23, v18, v19
v_lshlrev_b32 v12, 16, v20
v_and_b32 v13, 0xffff0000, v20
v_lshlrev_b32 v14, 16, v21
v_and_b32 v15, 0xffff0000, v21
v_lshlrev_b32 v16, 16, v22
v_and_b32 v17, 0xffff0000, v22
v_lshlrev_b32 v18, 16, v23
v_and_b32 v19, 0xffff0000, v23
v_mul_f32 v12, v12, v9
v_mul_f32 v13, v13, v9
v_mul_f32 v14, v14, v9
v_mul_f32 v15, v15, v9
v_mul_f32 v16, v16, v9
v_mul_f32 v17, v17, v9
v_mul_f32 v18, v18, v9
v_mul_f32 v19, v19, v9
v_cvt_pk_bf16_f32 v20, v12, v13
v_cvt_pk_bf16_f32 v21, v14, v15
v_cvt_pk_bf16_f32 v22, v16, v17
v_cvt_pk_bf16_f32 v23, v18, v19
v_lshlrev_b32 v12, 16, v20
v_and_b32 v13, 0xffff0000, v20
v_lshlrev_b32 v14, 16, v21
v_and_b32 v15, 0xffff0000, v21
v_lshlrev_b32 v16, 16, v22
v_and_b32 v17, 0xffff0000, v22
v_lshlrev_b32 v18, 16, v23
v_and_b32 v19, 0xffff0000, v23
v_mul_f32 v12, v12, v96
v_mul_f32 v13, v13, v97
v_mul_f32 v14, v14, v98
v_mul_f32 v15, v15, v99
v_mul_f32 v16, v16, v100
v_mul_f32 v17, v17, v101
v_mul_f32 v18, v18, v102
v_mul_f32 v19, v19, v103
v_cvt_pk_bf16_f32 v20, v12, v13
v_cvt_pk_bf16_f32 v21, v14, v15
v_cvt_pk_bf16_f32 v22, v16, v17
v_cvt_pk_bf16_f32 v23, v18, v19
v_lshlrev_b32 v12, 16, v20
v_and_b32 v13, 0xffff0000, v20
v_lshlrev_b32 v14, 16, v21
v_and_b32 v15, 0xffff0000, v21
v_lshlrev_b32 v16, 16, v22
v_and_b32 v17, 0xffff0000, v22
v_lshlrev_b32 v18, 16, v23
v_and_b32 v19, 0xffff0000, v23
v_add_f32 v12, v12, v64
v_add_f32 v13, v13, v65
v_add_f32 v14, v14, v66
v_add_f32 v15, v15, v67
v_add_f32 v16, v16, v68
v_add_f32 v17, v17, v69
v_add_f32 v18, v18, v70
v_add_f32 v19, v19, v71
v_cvt_pk_bf16_f32 v32, v12, v13
v_cvt_pk_bf16_f32 v33, v14, v15
v_cvt_pk_bf16_f32 v34, v16, v17
v_cvt_pk_bf16_f32 v35, v18, v19
s_add_u32 s57, s56, 0
buffer_store_dwordx4 v[32:35], v4, s[48:51], s57 offen sc1
v_lshlrev_b32 v12, 16, v36
v_and_b32 v13, 0xffff0000, v36
v_lshlrev_b32 v14, 16, v37
v_and_b32 v15, 0xffff0000, v37
v_lshlrev_b32 v16, 16, v38
v_and_b32 v17, 0xffff0000, v38
v_lshlrev_b32 v18, 16, v39
v_and_b32 v19, 0xffff0000, v39
v_sub_f32 v12, v12, v8
v_sub_f32 v13, v13, v8
v_sub_f32 v14, v14, v8
v_sub_f32 v15, v15, v8
v_sub_f32 v16, v16, v8
v_sub_f32 v17, v17, v8
v_sub_f32 v18, v18, v8
v_sub_f32 v19, v19, v8
v_cvt_pk_bf16_f32 v20, v12, v13
v_cvt_pk_bf16_f32 v21, v14, v15
v_cvt_pk_bf16_f32 v22, v16, v17
v_cvt_pk_bf16_f32 v23, v18, v19
v_lshlrev_b32 v12, 16, v20
v_and_b32 v13, 0xffff0000, v20
v_lshlrev_b32 v14, 16, v21
v_and_b32 v15, 0xffff0000, v21
v_lshlrev_b32 v16, 16, v22
v_and_b32 v17, 0xffff0000, v22
v_lshlrev_b32 v18, 16, v23
v_and_b32 v19, 0xffff0000, v23
v_mul_f32 v12, v12, v9
v_mul_f32 v13, v13, v9
v_mul_f32 v14, v14, v9
v_mul_f32 v15, v15, v9
v_mul_f32 v16, v16, v9
v_mul_f32 v17, v17, v9
v_mul_f32 v18, v18, v9
v_mul_f32 v19, v19, v9
v_cvt_pk_bf16_f32 v20, v12, v13
v_cvt_pk_bf16_f32 v21, v14, v15
v_cvt_pk_bf16_f32 v22, v16, v17
v_cvt_pk_bf16_f32 v23, v18, v19
v_lshlrev_b32 v12, 16, v20
v_and_b32 v13, 0xffff0000, v20
v_lshlrev_b32 v14, 16, v21
v_and_b32 v15, 0xffff0000, v21
v_lshlrev_b32 v16, 16, v22
v_and_b32 v17, 0xffff0000, v22
v_lshlrev_b32 v18, 16, v23
v_and_b32 v19, 0xffff0000, v23
v_mul_f32 v12, v12, v104
v_mul_f32 v13, v13, v105
v_mul_f32 v14, v14, v106
v_mul_f32 v15, v15, v107
v_mul_f32 v16, v16, v108
v_mul_f32 v17, v17, v109
v_mul_f32 v18, v18, v110
v_mul_f32 v19, v19, v111
v_cvt_pk_bf16_f32 v20, v12, v13
v_cvt_pk_bf16_f32 v21, v14, v15
v_cvt_pk_bf16_f32 v22, v16, v17
v_cvt_pk_bf16_f32 v23, v18, v19
v_lshlrev_b32 v12, 16, v20
v_and_b32 v13, 0xffff0000, v20
v_lshlrev_b32 v14, 16, v21
v_and_b32 v15, 0xffff0000, v21
v_lshlrev_b32 v16, 16, v22
v_and_b32 v17, 0xffff0000, v22
v_lshlrev_b32 v18, 16, v23
v_and_b32 v19, 0xffff0000, v23
v_add_f32 v12, v12, v72
v_add_f32 v13, v13, v73
v_add_f32 v14, v14, v74
v_add_f32 v15, v15, v75
v_add_f32 v16, v16, v76
v_add_f32 v17, v17, v77
v_add_f32 v18, v18, v78
v_add_f32 v19, v19, v79
v_cvt_pk_bf16_f32 v36, v12, v13
v_cvt_pk_bf16_f32 v37, v14, v15
v_cvt_pk_bf16_f32 v38, v16, v17
v_cvt_pk_bf16_f32 v39, v18, v19
s_add_u32 s57, s56, 4096
buffer_store_dwordx4 v[36:39], v4, s[48:51], s57 offen sc1
v_lshlrev_b32 v12, 16, v40
v_and_b32 v13, 0xffff0000, v40
v_lshlrev_b32 v14, 16, v41
v_and_b32 v15, 0xffff0000, v41
v_lshlrev_b32 v16, 16, v42
v_and_b32 v17, 0xffff0000, v42
v_lshlrev_b32 v18, 16, v43
v_and_b32 v19, 0xffff0000, v43
v_sub_f32 v12, v12, v8
v_sub_f32 v13, v13, v8
v_sub_f32 v14, v14, v8
v_sub_f32 v15, v15, v8
v_sub_f32 v16, v16, v8
v_sub_f32 v17, v17, v8
v_sub_f32 v18, v18, v8
v_sub_f32 v19, v19, v8
v_cvt_pk_bf16_f32 v20, v12, v13
v_cvt_pk_bf16_f32 v21, v14, v15
v_cvt_pk_bf16_f32 v22, v16, v17
v_cvt_pk_bf16_f32 v23, v18, v19
v_lshlrev_b32 v12, 16, v20
v_and_b32 v13, 0xffff0000, v20
v_lshlrev_b32 v14, 16, v21
v_and_b32 v15, 0xffff0000, v21
v_lshlrev_b32 v16, 16, v22
v_and_b32 v17, 0xffff0000, v22
v_lshlrev_b32 v18, 16, v23
v_and_b32 v19, 0xffff0000, v23
v_mul_f32 v12, v12, v9
v_mul_f32 v13, v13, v9
v_mul_f32 v14, v14, v9
v_mul_f32 v15, v15, v9
v_mul_f32 v16, v16, v9
v_mul_f32 v17, v17, v9
v_mul_f32 v18, v18, v9
v_mul_f32 v19, v19, v9
v_cvt_pk_bf16_f32 v20, v12, v13
v_cvt_pk_bf16_f32 v21, v14, v15
v_cvt_pk_bf16_f32 v22, v16, v17
v_cvt_pk_bf16_f32 v23, v18, v19
v_lshlrev_b32 v12, 16, v20
v_and_b32 v13, 0xffff0000, v20
v_lshlrev_b32 v14, 16, v21
v_and_b32 v15, 0xffff0000, v21
v_lshlrev_b32 v16, 16, v22
v_and_b32 v17, 0xffff0000, v22
v_lshlrev_b32 v18, 16, v23
v_and_b32 v19, 0xffff0000, v23
v_mul_f32 v12, v12, v112
v_mul_f32 v13, v13, v113
v_mul_f32 v14, v14, v114
v_mul_f32 v15, v15, v115
v_mul_f32 v16, v16, v116
v_mul_f32 v17, v17, v117
v_mul_f32 v18, v18, v118
v_mul_f32 v19, v19, v119
v_cvt_pk_bf16_f32 v20, v12, v13
v_cvt_pk_bf16_f32 v21, v14, v15
v_cvt_pk_bf16_f32 v22, v16, v17
v_cvt_pk_bf16_f32 v23, v18, v19
v_lshlrev_b32 v12, 16, v20
v_and_b32 v13, 0xffff0000, v20
v_lshlrev_b32 v14, 16, v21
v_and_b32 v15, 0xffff0000, v21
v_lshlrev_b32 v16, 16, v22
v_and_b32 v17, 0xffff0000, v22
v_lshlrev_b32 v18, 16, v23
v_and_b32 v19, 0xffff0000, v23
v_add_f32 v12, v12, v80
v_add_f32 v13, v13, v81
v_add_f32 v14, v14, v82
v_add_f32 v15, v15, v83
v_add_f32 v16, v16, v84
v_add_f32 v17, v17, v85
v_add_f32 v18, v18, v86
v_add_f32 v19, v19, v87
v_cvt_pk_bf16_f32 v40, v12, v13
v_cvt_pk_bf16_f32 v41, v14, v15
v_cvt_pk_bf16_f32 v42, v16, v17
v_cvt_pk_bf16_f32 v43, v18, v19
s_add_u32 s57, s56, 8192
buffer_store_dwordx4 v[40:43], v4, s[48:51], s57 offen sc1
v_lshlrev_b32 v12, 16, v44
v_and_b32 v13, 0xffff0000, v44
v_lshlrev_b32 v14, 16, v45
v_and_b32 v15, 0xffff0000, v45
v_lshlrev_b32 v16, 16, v46
v_and_b32 v17, 0xffff0000, v46
v_lshlrev_b32 v18, 16, v47
v_and_b32 v19, 0xffff0000, v47
v_sub_f32 v12, v12, v8
v_sub_f32 v13, v13, v8
v_sub_f32 v14, v14, v8
v_sub_f32 v15, v15, v8
v_sub_f32 v16, v16, v8
v_sub_f32 v17, v17, v8
v_sub_f32 v18, v18, v8
v_sub_f32 v19, v19, v8
v_cvt_pk_bf16_f32 v20, v12, v13
v_cvt_pk_bf16_f32 v21, v14, v15
v_cvt_pk_bf16_f32 v22, v16, v17
v_cvt_pk_bf16_f32 v23, v18, v19
v_lshlrev_b32 v12, 16, v20
v_and_b32 v13, 0xffff0000, v20
v_lshlrev_b32 v14, 16, v21
v_and_b32 v15, 0xffff0000, v21
v_lshlrev_b32 v16, 16, v22
v_and_b32 v17, 0xffff0000, v22
v_lshlrev_b32 v18, 16, v23
v_and_b32 v19, 0xffff0000, v23
v_mul_f32 v12, v12, v9
v_mul_f32 v13, v13, v9
v_mul_f32 v14, v14, v9
v_mul_f32 v15, v15, v9
v_mul_f32 v16, v16, v9
v_mul_f32 v17, v17, v9
v_mul_f32 v18, v18, v9
v_mul_f32 v19, v19, v9
v_cvt_pk_bf16_f32 v20, v12, v13
v_cvt_pk_bf16_f32 v21, v14, v15
v_cvt_pk_bf16_f32 v22, v16, v17
v_cvt_pk_bf16_f32 v23, v18, v19
v_lshlrev_b32 v12, 16, v20
v_and_b32 v13, 0xffff0000, v20
v_lshlrev_b32 v14, 16, v21
v_and_b32 v15, 0xffff0000, v21
v_lshlrev_b32 v16, 16, v22
v_and_b32 v17, 0xffff0000, v22
v_lshlrev_b32 v18, 16, v23
v_and_b32 v19, 0xffff0000, v23
v_mul_f32 v12, v12, v120
v_mul_f32 v13, v13, v121
v_mul_f32 v14, v14, v122
v_mul_f32 v15, v15, v123
v_mul_f32 v16, v16, v124
v_mul_f32 v17, v17, v125
v_mul_f32 v18, v18, v126
v_mul_f32 v19, v19, v127
v_cvt_pk_bf16_f32 v20, v12, v13
v_cvt_pk_bf16_f32 v21, v14, v15
v_cvt_pk_bf16_f32 v22, v16, v17
v_cvt_pk_bf16_f32 v23, v18, v19
v_lshlrev_b32 v12, 16, v20
v_and_b32 v13, 0xffff0000, v20
v_lshlrev_b32 v14, 16, v21
v_and_b32 v15, 0xffff0000, v21
v_lshlrev_b32 v16, 16, v22
v_and_b32 v17, 0xffff0000, v22
v_lshlrev_b32 v18, 16, v23
v_and_b32 v19, 0xffff0000, v23
v_add_f32 v12, v12, v88
v_add_f32 v13, v13, v89
v_add_f32 v14, v14, v90
v_add_f32 v15, v15, v91
v_add_f32 v16, v16, v92
v_add_f32 v17, v17, v93
v_add_f32 v18, v18, v94
v_add_f32 v19, v19, v95
v_cvt_pk_bf16_f32 v44, v12, v13
v_cvt_pk_bf16_f32 v45, v14, v15
v_cvt_pk_bf16_f32 v46, v16, v17
v_cvt_pk_bf16_f32 v47, v18, v19
s_add_u32 s57, s56, 12288
buffer_store_dwordx4 v[44:47], v4, s[48:51], s57 offen sc1
v_mov_b32 v2, 0
ds_read_b32 v4, v2 offset:18432
s_mov_b32 s32, 0
s_add_u32 s58, s58, 28672
s_waitcnt lgkmcnt(0)
v_readfirstlane_b32 s21, v4
s_cmp_ge_u32 s21, 32
s_cbranch_scc1 .Lnc_11
s_cmp_lt_u32 s20, 4
s_cbranch_scc1 .Lload_4
.Lnc_11:
buffer_load_dword v4, v170, s[16:19], 0 offen offset:1152 sc1
s_waitcnt vmcnt(0)
ds_write_b32 v170, v4 offset:18448
s_waitcnt lgkmcnt(0)
s_waitcnt vmcnt(0)
s_barrier
s_cmp_lg_u32 s3, 0
s_cbranch_scc1 .Lsg_12
v_mov_b32 v172, 1
s_mov_b64 exec, 1
buffer_atomic_add v172, v170, s[16:19], s58 offen sc1
s_mov_b64 exec, -1
.Lsg_12:
s_mov_b32 s58, 0
ds_read_b32 v4, v170 offset:18448
s_waitcnt lgkmcnt(0)
v_readfirstlane_b32 s30, v4
s_cmp_lg_u32 s30, 1
s_cbranch_scc1 .Lwm_5
s_mov_b32 s32, 1
s_cmp_ge_u32 s21, 32
s_cbranch_scc1 .Lend_3
s_barrier
s_branch .Lworker_10
.Lload_4:
s_lshl_b32 s22, s20, 5
s_add_u32 s22, s22, s21
s_load_dwordx4 s[60:63], s[0:1], 16
s_load_dwordx4 s[64:67], s[0:1], 32
v_lshrrev_b32 v4, 2, v0
v_and_b32 v5, 3, v0
v_lshlrev_b32 v5, 4, v5
v_lshl_add_u32 v6, v4, 13, v5
v_lshl_add_u32 v7, v4, 11, v5
v_bfe_u32 v8, v0, 3, 1
v_lshlrev_b32 v8, 5, v8
v_bfe_u32 v9, v0, 2, 1
v_add_u32 v8, v8, v9
v_bfe_u32 v9, v0, 5, 1
v_bfe_u32 v10, v0, 4, 1
v_lshl_add_u32 v11, v9, 3, v8
v_lshl_add_u32 v11, v10, 2, v11
v_lshl_add_u32 v12, v10, 4, v8
v_lshl_add_u32 v12, v9, 2, v12
s_lshl_b32 s31, s3, 15
s_add_u32 s31, s31, 28672
v_and_b32 v9, 3, v0
v_lshlrev_b32 v9, 3, v9
v_add_u32 v9, s31, v9
v_lshl_add_u32 v11, v11, 6, v9
v_lshl_add_u32 v12, v12, 6, v9
s_waitcnt lgkmcnt(0)
s_cmp_eq_u32 s58, 0
s_cbranch_scc1 .Lh1_13
s_add_u32 s40, s4, 0xf00000
s_addc_u32 s41, s5, 0
s_mov_b32 s42, 0x10000
s_mov_b32 s43, 0x00020000
s_waitcnt vmcnt(0)
s_barrier
s_cmp_lg_u32 s3, 0
s_cbranch_scc1 .Lsg_14
v_mov_b32 v172, 1
s_mov_b64 exec, 1
buffer_atomic_add v172, v170, s[40:43], s58 offen sc1
s_mov_b64 exec, -1
.Lsg_14:
s_mov_b32 s58, 0
.Lh1_13:
s_mov_b32 s16, s60
s_mov_b32 s17, s61
s_mov_b32 s18, 0x800000
s_mov_b32 s19, 0x00020000
s_lshl_b32 s34, s22, 6
s_add_u32 m0, s31, 0
s_lshl_b32 s30, s3, 2
s_add_u32 s30, s30, 0
s_add_u32 s30, s30, s21
s_and_b32 s30, s30, 15
s_lshl_b32 s30, s30, 19
s_add_u32 s30, s30, s34
buffer_load_dwordx4 v6, s[16:19], s30 offen lds
s_add_u32 m0, m0, 1024
s_add_u32 s30, s30, 131072
buffer_load_dwordx4 v6, s[16:19], s30 offen lds
s_add_u32 m0, m0, 1024
s_add_u32 s30, s30, 131072
buffer_load_dwordx4 v6, s[16:19], s30 offen lds
s_add_u32 m0, m0, 1024
s_add_u32 s30, s30, 131072
buffer_load_dwordx4 v6, s[16:19], s30 offen lds
s_add_u32 m0, m0, 1024
s_add_u32 s30, s30, 131072
s_lshl_b32 s30, s3, 2
s_add_u32 s30, s30, 1
s_add_u32 s30, s30, s21
s_and_b32 s30, s30, 15
s_lshl_b32 s30, s30, 19
s_add_u32 s30, s30, s34
buffer_load_dwordx4 v6, s[16:19], s30 offen lds
s_add_u32 m0, m0, 1024
s_add_u32 s30, s30, 131072
buffer_load_dwordx4 v6, s[16:19], s30 offen lds
s_add_u32 m0, m0, 1024
s_add_u32 s30, s30, 131072
buffer_load_dwordx4 v6, s[16:19], s30 offen lds
s_add_u32 m0, m0, 1024
s_add_u32 s30, s30, 131072
buffer_load_dwordx4 v6, s[16:19], s30 offen lds
s_add_u32 m0, m0, 1024
s_add_u32 s30, s30, 131072
s_lshl_b32 s30, s3, 2
s_add_u32 s30, s30, 2
s_add_u32 s30, s30, s21
s_and_b32 s30, s30, 15
s_lshl_b32 s30, s30, 19
s_add_u32 s30, s30, s34
buffer_load_dwordx4 v6, s[16:19], s30 offen lds
s_add_u32 m0, m0, 1024
s_add_u32 s30, s30, 131072
buffer_load_dwordx4 v6, s[16:19], s30 offen lds
s_add_u32 m0, m0, 1024
s_add_u32 s30, s30, 131072
buffer_load_dwordx4 v6, s[16:19], s30 offen lds
s_add_u32 m0, m0, 1024
s_add_u32 s30, s30, 131072
buffer_load_dwordx4 v6, s[16:19], s30 offen lds
s_add_u32 m0, m0, 1024
s_add_u32 s30, s30, 131072
s_lshl_b32 s30, s3, 2
s_add_u32 s30, s30, 3
s_add_u32 s30, s30, s21
s_and_b32 s30, s30, 15
s_lshl_b32 s30, s30, 19
s_add_u32 s30, s30, s34
buffer_load_dwordx4 v6, s[16:19], s30 offen lds
s_add_u32 m0, m0, 1024
s_add_u32 s30, s30, 131072
buffer_load_dwordx4 v6, s[16:19], s30 offen lds
s_add_u32 m0, m0, 1024
s_add_u32 s30, s30, 131072
buffer_load_dwordx4 v6, s[16:19], s30 offen lds
s_add_u32 m0, m0, 1024
s_add_u32 s30, s30, 131072
buffer_load_dwordx4 v6, s[16:19], s30 offen lds
s_mov_b32 s16, s62
s_mov_b32 s17, s63
s_mov_b32 s18, 0x800000
s_mov_b32 s19, 0x00020000
s_lshl_b32 s34, s22, 6
s_add_u32 m0, s31, 16384
s_lshl_b32 s30, s3, 2
s_add_u32 s30, s30, 0
s_add_u32 s30, s30, s21
s_and_b32 s30, s30, 15
s_lshl_b32 s30, s30, 19
s_add_u32 s30, s30, s34
buffer_load_dwordx4 v6, s[16:19], s30 offen lds
s_add_u32 m0, m0, 1024
s_add_u32 s30, s30, 131072
buffer_load_dwordx4 v6, s[16:19], s30 offen lds
s_add_u32 m0, m0, 1024
s_add_u32 s30, s30, 131072
buffer_load_dwordx4 v6, s[16:19], s30 offen lds
s_add_u32 m0, m0, 1024
s_add_u32 s30, s30, 131072
buffer_load_dwordx4 v6, s[16:19], s30 offen lds
s_add_u32 m0, m0, 1024
s_add_u32 s30, s30, 131072
s_lshl_b32 s30, s3, 2
s_add_u32 s30, s30, 1
s_add_u32 s30, s30, s21
s_and_b32 s30, s30, 15
s_lshl_b32 s30, s30, 19
s_add_u32 s30, s30, s34
buffer_load_dwordx4 v6, s[16:19], s30 offen lds
s_add_u32 m0, m0, 1024
s_add_u32 s30, s30, 131072
buffer_load_dwordx4 v6, s[16:19], s30 offen lds
s_add_u32 m0, m0, 1024
s_add_u32 s30, s30, 131072
buffer_load_dwordx4 v6, s[16:19], s30 offen lds
s_add_u32 m0, m0, 1024
s_add_u32 s30, s30, 131072
buffer_load_dwordx4 v6, s[16:19], s30 offen lds
s_add_u32 m0, m0, 1024
s_add_u32 s30, s30, 131072
s_lshl_b32 s30, s3, 2
s_add_u32 s30, s30, 2
s_add_u32 s30, s30, s21
s_and_b32 s30, s30, 15
s_lshl_b32 s30, s30, 19
s_add_u32 s30, s30, s34
buffer_load_dwordx4 v6, s[16:19], s30 offen lds
s_add_u32 m0, m0, 1024
s_add_u32 s30, s30, 131072
buffer_load_dwordx4 v6, s[16:19], s30 offen lds
s_add_u32 m0, m0, 1024
s_add_u32 s30, s30, 131072
buffer_load_dwordx4 v6, s[16:19], s30 offen lds
s_add_u32 m0, m0, 1024
s_add_u32 s30, s30, 131072
buffer_load_dwordx4 v6, s[16:19], s30 offen lds
s_add_u32 m0, m0, 1024
s_add_u32 s30, s30, 131072
s_lshl_b32 s30, s3, 2
s_add_u32 s30, s30, 3
s_add_u32 s30, s30, s21
s_and_b32 s30, s30, 15
s_lshl_b32 s30, s30, 19
s_add_u32 s30, s30, s34
buffer_load_dwordx4 v6, s[16:19], s30 offen lds
s_add_u32 m0, m0, 1024
s_add_u32 s30, s30, 131072
buffer_load_dwordx4 v6, s[16:19], s30 offen lds
s_add_u32 m0, m0, 1024
s_add_u32 s30, s30, 131072
buffer_load_dwordx4 v6, s[16:19], s30 offen lds
s_add_u32 m0, m0, 1024
s_add_u32 s30, s30, 131072
buffer_load_dwordx4 v6, s[16:19], s30 offen lds
s_waitcnt vmcnt(16)
ds_read_b64_tr_b16 a[0:1], v11 offset:0
ds_read_b64_tr_b16 a[2:3], v11 offset:128
ds_read_b64_tr_b16 a[4:5], v11 offset:1024
ds_read_b64_tr_b16 a[6:7], v11 offset:1152
ds_read_b64_tr_b16 a[8:9], v11 offset:4096
ds_read_b64_tr_b16 a[10:11], v11 offset:4224
ds_read_b64_tr_b16 a[12:13], v11 offset:5120
ds_read_b64_tr_b16 a[14:15], v11 offset:5248
ds_read_b64_tr_b16 a[16:17], v11 offset:8192
ds_read_b64_tr_b16 a[18:19], v11 offset:8320
ds_read_b64_tr_b16 a[20:21], v11 offset:9216
ds_read_b64_tr_b16 a[22:23], v11 offset:9344
ds_read_b64_tr_b16 a[24:25], v11 offset:12288
ds_read_b64_tr_b16 a[26:27], v11 offset:12416
ds_read_b64_tr_b16 a[28:29], v11 offset:13312
ds_read_b64_tr_b16 a[30:31], v11 offset:13440
ds_read_b64_tr_b16 a[32:33], v11 offset:32
ds_read_b64_tr_b16 a[34:35], v11 offset:160
ds_read_b64_tr_b16 a[36:37], v11 offset:1056
ds_read_b64_tr_b16 a[38:39], v11 offset:1184
ds_read_b64_tr_b16 a[40:41], v11 offset:4128
ds_read_b64_tr_b16 a[42:43], v11 offset:4256
ds_read_b64_tr_b16 a[44:45], v11 offset:5152
ds_read_b64_tr_b16 a[46:47], v11 offset:5280
ds_read_b64_tr_b16 a[48:49], v11 offset:8224
ds_read_b64_tr_b16 a[50:51], v11 offset:8352
ds_read_b64_tr_b16 a[52:53], v11 offset:9248
ds_read_b64_tr_b16 a[54:55], v11 offset:9376
ds_read_b64_tr_b16 a[56:57], v11 offset:12320
ds_read_b64_tr_b16 a[58:59], v11 offset:12448
ds_read_b64_tr_b16 a[60:61], v11 offset:13344
ds_read_b64_tr_b16 a[62:63], v11 offset:13472
s_waitcnt lgkmcnt(0)
s_mov_b32 s16, s64
s_mov_b32 s17, s65
s_mov_b32 s18, 0x800000
s_mov_b32 s19, 0x00020000
s_lshl_b32 s34, s22, 6
s_add_u32 m0, s31, 0
s_lshl_b32 s30, s3, 2
s_add_u32 s30, s30, 0
s_add_u32 s30, s30, s21
s_and_b32 s30, s30, 15
s_lshl_b32 s30, s30, 19
s_add_u32 s30, s30, s34
buffer_load_dwordx4 v6, s[16:19], s30 offen lds
s_add_u32 m0, m0, 1024
s_add_u32 s30, s30, 131072
buffer_load_dwordx4 v6, s[16:19], s30 offen lds
s_add_u32 m0, m0, 1024
s_add_u32 s30, s30, 131072
buffer_load_dwordx4 v6, s[16:19], s30 offen lds
s_add_u32 m0, m0, 1024
s_add_u32 s30, s30, 131072
buffer_load_dwordx4 v6, s[16:19], s30 offen lds
s_add_u32 m0, m0, 1024
s_add_u32 s30, s30, 131072
s_lshl_b32 s30, s3, 2
s_add_u32 s30, s30, 1
s_add_u32 s30, s30, s21
s_and_b32 s30, s30, 15
s_lshl_b32 s30, s30, 19
s_add_u32 s30, s30, s34
buffer_load_dwordx4 v6, s[16:19], s30 offen lds
s_add_u32 m0, m0, 1024
s_add_u32 s30, s30, 131072
buffer_load_dwordx4 v6, s[16:19], s30 offen lds
s_add_u32 m0, m0, 1024
s_add_u32 s30, s30, 131072
buffer_load_dwordx4 v6, s[16:19], s30 offen lds
s_add_u32 m0, m0, 1024
s_add_u32 s30, s30, 131072
buffer_load_dwordx4 v6, s[16:19], s30 offen lds
s_add_u32 m0, m0, 1024
s_add_u32 s30, s30, 131072
s_lshl_b32 s30, s3, 2
s_add_u32 s30, s30, 2
s_add_u32 s30, s30, s21
s_and_b32 s30, s30, 15
s_lshl_b32 s30, s30, 19
s_add_u32 s30, s30, s34
buffer_load_dwordx4 v6, s[16:19], s30 offen lds
s_add_u32 m0, m0, 1024
s_add_u32 s30, s30, 131072
buffer_load_dwordx4 v6, s[16:19], s30 offen lds
s_add_u32 m0, m0, 1024
s_add_u32 s30, s30, 131072
buffer_load_dwordx4 v6, s[16:19], s30 offen lds
s_add_u32 m0, m0, 1024
s_add_u32 s30, s30, 131072
buffer_load_dwordx4 v6, s[16:19], s30 offen lds
s_add_u32 m0, m0, 1024
s_add_u32 s30, s30, 131072
s_lshl_b32 s30, s3, 2
s_add_u32 s30, s30, 3
s_add_u32 s30, s30, s21
s_and_b32 s30, s30, 15
s_lshl_b32 s30, s30, 19
s_add_u32 s30, s30, s34
buffer_load_dwordx4 v6, s[16:19], s30 offen lds
s_add_u32 m0, m0, 1024
s_add_u32 s30, s30, 131072
buffer_load_dwordx4 v6, s[16:19], s30 offen lds
s_add_u32 m0, m0, 1024
s_add_u32 s30, s30, 131072
buffer_load_dwordx4 v6, s[16:19], s30 offen lds
s_add_u32 m0, m0, 1024
s_add_u32 s30, s30, 131072
buffer_load_dwordx4 v6, s[16:19], s30 offen lds
s_waitcnt vmcnt(16)
ds_read_b64_tr_b16 a[64:65], v11 offset:16384
ds_read_b64_tr_b16 a[66:67], v11 offset:16512
ds_read_b64_tr_b16 a[68:69], v11 offset:17408
ds_read_b64_tr_b16 a[70:71], v11 offset:17536
ds_read_b64_tr_b16 a[72:73], v11 offset:20480
ds_read_b64_tr_b16 a[74:75], v11 offset:20608
ds_read_b64_tr_b16 a[76:77], v11 offset:21504
ds_read_b64_tr_b16 a[78:79], v11 offset:21632
ds_read_b64_tr_b16 a[80:81], v11 offset:24576
ds_read_b64_tr_b16 a[82:83], v11 offset:24704
ds_read_b64_tr_b16 a[84:85], v11 offset:25600
ds_read_b64_tr_b16 a[86:87], v11 offset:25728
ds_read_b64_tr_b16 a[88:89], v11 offset:28672
ds_read_b64_tr_b16 a[90:91], v11 offset:28800
ds_read_b64_tr_b16 a[92:93], v11 offset:29696
ds_read_b64_tr_b16 a[94:95], v11 offset:29824
ds_read_b64_tr_b16 a[96:97], v11 offset:16416
ds_read_b64_tr_b16 a[98:99], v11 offset:16544
ds_read_b64_tr_b16 a[100:101], v11 offset:17440
ds_read_b64_tr_b16 a[102:103], v11 offset:17568
ds_read_b64_tr_b16 a[104:105], v11 offset:20512
ds_read_b64_tr_b16 a[106:107], v11 offset:20640
ds_read_b64_tr_b16 a[108:109], v11 offset:21536
ds_read_b64_tr_b16 a[110:111], v11 offset:21664
ds_read_b64_tr_b16 a[112:113], v11 offset:24608
ds_read_b64_tr_b16 a[114:115], v11 offset:24736
ds_read_b64_tr_b16 a[116:117], v11 offset:25632
ds_read_b64_tr_b16 a[118:119], v11 offset:25760
ds_read_b64_tr_b16 a[120:121], v11 offset:28704
ds_read_b64_tr_b16 a[122:123], v11 offset:28832
ds_read_b64_tr_b16 a[124:125], v11 offset:29728
ds_read_b64_tr_b16 a[126:127], v11 offset:29856
s_waitcnt lgkmcnt(0)
s_mov_b32 s16, s66
s_mov_b32 s17, s67
s_mov_b32 s18, 0x800000
s_mov_b32 s19, 0x00020000
s_lshl_b32 s34, s20, 21
s_lshl_b32 s33, s21, 6
s_add_u32 s34, s34, s33
s_add_u32 m0, s31, 16384
s_lshl_b32 s30, s3, 2
s_add_u32 s30, s30, 0
s_add_u32 s30, s30, s21
s_and_b32 s30, s30, 15
s_lshl_b32 s30, s30, 17
s_add_u32 s30, s30, s34
buffer_load_dwordx4 v7, s[16:19], s30 offen lds
s_add_u32 m0, m0, 1024
s_add_u32 s30, s30, 32768
buffer_load_dwordx4 v7, s[16:19], s30 offen lds
s_add_u32 m0, m0, 1024
s_add_u32 s30, s30, 32768
buffer_load_dwordx4 v7, s[16:19], s30 offen lds
s_add_u32 m0, m0, 1024
s_add_u32 s30, s30, 32768
buffer_load_dwordx4 v7, s[16:19], s30 offen lds
s_add_u32 m0, m0, 1024
s_add_u32 s30, s30, 32768
s_lshl_b32 s30, s3, 2
s_add_u32 s30, s30, 1
s_add_u32 s30, s30, s21
s_and_b32 s30, s30, 15
s_lshl_b32 s30, s30, 17
s_add_u32 s30, s30, s34
buffer_load_dwordx4 v7, s[16:19], s30 offen lds
s_add_u32 m0, m0, 1024
s_add_u32 s30, s30, 32768
buffer_load_dwordx4 v7, s[16:19], s30 offen lds
s_add_u32 m0, m0, 1024
s_add_u32 s30, s30, 32768
buffer_load_dwordx4 v7, s[16:19], s30 offen lds
s_add_u32 m0, m0, 1024
s_add_u32 s30, s30, 32768
buffer_load_dwordx4 v7, s[16:19], s30 offen lds
s_add_u32 m0, m0, 1024
s_add_u32 s30, s30, 32768
s_lshl_b32 s30, s3, 2
s_add_u32 s30, s30, 2
s_add_u32 s30, s30, s21
s_and_b32 s30, s30, 15
s_lshl_b32 s30, s30, 17
s_add_u32 s30, s30, s34
buffer_load_dwordx4 v7, s[16:19], s30 offen lds
s_add_u32 m0, m0, 1024
s_add_u32 s30, s30, 32768
buffer_load_dwordx4 v7, s[16:19], s30 offen lds
s_add_u32 m0, m0, 1024
s_add_u32 s30, s30, 32768
buffer_load_dwordx4 v7, s[16:19], s30 offen lds
s_add_u32 m0, m0, 1024
s_add_u32 s30, s30, 32768
buffer_load_dwordx4 v7, s[16:19], s30 offen lds
s_add_u32 m0, m0, 1024
s_add_u32 s30, s30, 32768
s_lshl_b32 s30, s3, 2
s_add_u32 s30, s30, 3
s_add_u32 s30, s30, s21
s_and_b32 s30, s30, 15
s_lshl_b32 s30, s30, 17
s_add_u32 s30, s30, s34
buffer_load_dwordx4 v7, s[16:19], s30 offen lds
s_add_u32 m0, m0, 1024
s_add_u32 s30, s30, 32768
buffer_load_dwordx4 v7, s[16:19], s30 offen lds
s_add_u32 m0, m0, 1024
s_add_u32 s30, s30, 32768
buffer_load_dwordx4 v7, s[16:19], s30 offen lds
s_add_u32 m0, m0, 1024
s_add_u32 s30, s30, 32768
buffer_load_dwordx4 v7, s[16:19], s30 offen lds
s_waitcnt vmcnt(16)
ds_read_b64_tr_b16 a[128:129], v11 offset:0
ds_read_b64_tr_b16 a[130:131], v11 offset:128
ds_read_b64_tr_b16 a[132:133], v11 offset:1024
ds_read_b64_tr_b16 a[134:135], v11 offset:1152
ds_read_b64_tr_b16 a[136:137], v11 offset:4096
ds_read_b64_tr_b16 a[138:139], v11 offset:4224
ds_read_b64_tr_b16 a[140:141], v11 offset:5120
ds_read_b64_tr_b16 a[142:143], v11 offset:5248
ds_read_b64_tr_b16 a[144:145], v11 offset:8192
ds_read_b64_tr_b16 a[146:147], v11 offset:8320
ds_read_b64_tr_b16 a[148:149], v11 offset:9216
ds_read_b64_tr_b16 a[150:151], v11 offset:9344
ds_read_b64_tr_b16 a[152:153], v11 offset:12288
ds_read_b64_tr_b16 a[154:155], v11 offset:12416
ds_read_b64_tr_b16 a[156:157], v11 offset:13312
ds_read_b64_tr_b16 a[158:159], v11 offset:13440
ds_read_b64_tr_b16 a[160:161], v11 offset:32
ds_read_b64_tr_b16 a[162:163], v11 offset:160
ds_read_b64_tr_b16 a[164:165], v11 offset:1056
ds_read_b64_tr_b16 a[166:167], v11 offset:1184
ds_read_b64_tr_b16 a[168:169], v11 offset:4128
ds_read_b64_tr_b16 a[170:171], v11 offset:4256
ds_read_b64_tr_b16 a[172:173], v11 offset:5152
ds_read_b64_tr_b16 a[174:175], v11 offset:5280
ds_read_b64_tr_b16 a[176:177], v11 offset:8224
ds_read_b64_tr_b16 a[178:179], v11 offset:8352
ds_read_b64_tr_b16 a[180:181], v11 offset:9248
ds_read_b64_tr_b16 a[182:183], v11 offset:9376
ds_read_b64_tr_b16 a[184:185], v11 offset:12320
ds_read_b64_tr_b16 a[186:187], v11 offset:12448
ds_read_b64_tr_b16 a[188:189], v11 offset:13344
ds_read_b64_tr_b16 a[190:191], v11 offset:13472
s_waitcnt lgkmcnt(0)
s_waitcnt vmcnt(0)
ds_read_b64_tr_b16 a[192:193], v12 offset:16384
ds_read_b64_tr_b16 a[194:195], v12 offset:16512
ds_read_b64_tr_b16 a[196:197], v12 offset:16896
ds_read_b64_tr_b16 a[198:199], v12 offset:17024
ds_read_b64_tr_b16 a[200:201], v12 offset:20480
ds_read_b64_tr_b16 a[202:203], v12 offset:20608
ds_read_b64_tr_b16 a[204:205], v12 offset:20992
ds_read_b64_tr_b16 a[206:207], v12 offset:21120
ds_read_b64_tr_b16 a[208:209], v12 offset:24576
ds_read_b64_tr_b16 a[210:211], v12 offset:24704
ds_read_b64_tr_b16 a[212:213], v12 offset:25088
ds_read_b64_tr_b16 a[214:215], v12 offset:25216
ds_read_b64_tr_b16 a[216:217], v12 offset:28672
ds_read_b64_tr_b16 a[218:219], v12 offset:28800
ds_read_b64_tr_b16 a[220:221], v12 offset:29184
ds_read_b64_tr_b16 a[222:223], v12 offset:29312
ds_read_b64_tr_b16 a[224:225], v12 offset:16416
ds_read_b64_tr_b16 a[226:227], v12 offset:16544
ds_read_b64_tr_b16 a[228:229], v12 offset:16928
ds_read_b64_tr_b16 a[230:231], v12 offset:17056
ds_read_b64_tr_b16 a[232:233], v12 offset:20512
ds_read_b64_tr_b16 a[234:235], v12 offset:20640
ds_read_b64_tr_b16 a[236:237], v12 offset:21024
ds_read_b64_tr_b16 a[238:239], v12 offset:21152
ds_read_b64_tr_b16 a[240:241], v12 offset:24608
ds_read_b64_tr_b16 a[242:243], v12 offset:24736
ds_read_b64_tr_b16 a[244:245], v12 offset:25120
ds_read_b64_tr_b16 a[246:247], v12 offset:25248
ds_read_b64_tr_b16 a[248:249], v12 offset:28704
ds_read_b64_tr_b16 a[250:251], v12 offset:28832
ds_read_b64_tr_b16 a[252:253], v12 offset:29216
ds_read_b64_tr_b16 a[254:255], v12 offset:29344
s_waitcnt lgkmcnt(0)
.Lwm_5:
s_cmp_lg_u32 s32, 0
s_cbranch_scc1 .Lgo_15
s_add_u32 s16, s4, 0xf00000
s_addc_u32 s17, s5, 0
s_mov_b32 s18, 0x10000
s_mov_b32 s19, 0x00020000
s_barrier
s_cmp_lg_u32 s3, 0
s_cbranch_scc1 .Lms_16
s_mov_b32 s30, 4000
v_mov_b32 v2, 0
s_mov_b64 exec, 1
.Lmp_17:
buffer_load_dword v4, v2, s[16:19], 0 offen offset:1152 sc1
s_waitcnt vmcnt(0)
v_readfirstlane_b32 s31, v4
s_cmp_lg_u32 s31, 0
s_cbranch_scc1 .Lmg_18
s_sub_u32 s30, s30, 1
s_cmp_lg_u32 s30, 0
s_cbranch_scc1 .Lmp_17
v_mov_b32 v4, 2
v_mov_b32 v5, 0
buffer_atomic_cmpswap v[4:5], v2, s[16:19], 0 offen offset:1152 sc0 sc1
s_waitcnt vmcnt(0)
v_readfirstlane_b32 s31, v4
s_cmp_eq_u32 s31, 0
s_cselect_b32 s31, 2, s31
.Lmg_18:
v_mov_b32 v4, s31
v_mov_b32 v5, 1
s_cmp_eq_u32 s31, 1
s_cbranch_scc1 .Lmf_19
buffer_atomic_add v5, v2, s[16:19], 0 offen offset:1280 sc0 sc1
s_waitcnt vmcnt(0)
.Lmf_19:
ds_write_b64 v2, v[4:5] offset:18440
s_mov_b64 exec, -1
.Lms_16:
s_waitcnt lgkmcnt(0)
s_barrier
v_mov_b32 v2, 0
ds_read_b64 v[4:5], v2 offset:18440
s_waitcnt lgkmcnt(0)
v_readfirstlane_b32 s32, v4
v_readfirstlane_b32 s30, v5
s_cmp_eq_u32 s32, 2
s_cbranch_scc0 .Lnat_20
s_cmp_ge_u32 s30, 256
s_cbranch_scc1 .Lend_3
s_lshr_b32 s20, s30, 5
s_and_b32 s21, s30, 31
s_cmp_ge_u32 s30, 128
s_cbranch_scc1 .Lworker_10
s_branch .Lload_4
.Lnat_20:
s_cmp_ge_u32 s21, 32
s_cbranch_scc1 .Lend_3
s_cmp_ge_u32 s20, 4
s_cbranch_scc1 .Lworker_10
.Lgo_15:
s_add_u32 s8, s4, 0xd00000
s_addc_u32 s9, s5, 0
s_mov_b32 s10, 0x210000
s_mov_b32 s11, 0x00020000
s_add_u32 s12, s4, 0x2000000
s_addc_u32 s13, s5, 0
s_mov_b32 s14, 0x6200000
s_mov_b32 s15, 0x00020000
v_and_b32 v6, 8, v0
v_mov_b32 v2, 0x4444
v_mov_b32 v7, 0xeeee
v_cmp_ne_u32 vcc, 0, v6
s_nop 1
v_cndmask_b32 v2, v2, v7, vcc
v_lshlrev_b32 v6, 4, v0
s_lshl_b32 s31, s3, 2
s_add_u32 s31, s31, 0
s_add_u32 s31, s31, s21
s_and_b32 s31, s31, 15
s_lshl_b32 s30, s20, 14
s_lshl_b32 s31, s31, 10
s_add_u32 s30, s30, s31
v_add_u32 v240, s30, v6
v_add_u32 v244, 65536, v240
s_lshl_b32 s31, s3, 2
s_add_u32 s31, s31, 1
s_add_u32 s31, s31, s21
s_and_b32 s31, s31, 15
s_lshl_b32 s30, s20, 14
s_lshl_b32 s31, s31, 10
s_add_u32 s30, s30, s31
v_add_u32 v241, s30, v6
v_add_u32 v245, 65536, v241
s_lshl_b32 s31, s3, 2
s_add_u32 s31, s31, 2
s_add_u32 s31, s31, s21
s_and_b32 s31, s31, 15
s_lshl_b32 s30, s20, 14
s_lshl_b32 s31, s31, 10
s_add_u32 s30, s30, s31
v_add_u32 v242, s30, v6
v_add_u32 v246, 65536, v242
s_lshl_b32 s31, s3, 2
s_add_u32 s31, s31, 3
s_add_u32 s31, s31, s21
s_and_b32 s31, s31, 15
s_lshl_b32 s30, s20, 14
s_lshl_b32 s31, s31, 10
s_add_u32 s30, s30, s31
v_add_u32 v243, s30, v6
v_add_u32 v247, 65536, v243
v_bfe_u32 v6, v0, 4, 1
v_mul_u32_u24 v6, 576, v6
v_bfe_u32 v7, v0, 5, 1
v_lshl_add_u32 v6, v7, 6, v6
v_and_b32 v7, 15, v0
v_lshl_add_u32 v5, v7, 2, v6
s_mul_i32 s30, s3, 1152
v_add_u32 v5, s30, v5
s_mov_b32 s23, 0
s_mov_b32 s24, 0
s_mov_b32 s25, 524288
s_mov_b32 s26, 1048576
s_mov_b32 s27, 400000
s_lshl_b32 s28, s22, 11
s_lshl_b32 s29, s22, 9
s_add_u32 s29, s29, 67108864
s_cmp_eq_u32 s32, 2
s_cbranch_scc1 .Lsafe_22
s_cmp_eq_u32 s3, 1
s_cbranch_scc1 .Lwv_25
s_cmp_eq_u32 s3, 2
s_cbranch_scc1 .Lwv_26
s_cmp_eq_u32 s3, 3
s_cbranch_scc1 .Lwv_27
v_and_b32 v160, 15, v0
v_lshrrev_b32 v161, 4, v0
v_bfe_u32 v162, v0, 5, 1
v_bfe_u32 v163, v0, 4, 1
v_and_b32 v164, 7, v0
v_mul_u32_u24 v152, 144, v164
v_bfe_u32 v164, v0, 3, 1
v_mul_u32_u24 v164, 4608, v164
v_add_u32 v152, v152, v164
v_lshl_add_u32 v152, v162, 6, v152
v_lshl_add_u32 v152, v163, 4, v152
v_and_b32 v164, 7, v0
v_and_b32 v165, 8, v0
v_lshl_add_u32 v153, v165, 1, v164
v_lshl_add_u32 v153, v163, 5, v153
v_lshlrev_b32 v153, 4, v153
v_lshl_add_u32 v153, v162, 10, v153
v_lshl_add_u32 v154, v163, 5, v160
v_lshlrev_b32 v154, 4, v154
v_lshl_add_u32 v154, v162, 10, v154
s_mul_i32 s30, s22, 1280
s_add_u32 s30, s30, 131072
s_and_b32 s31, s22, 0x7c
s_mul_i32 s31, s31, 1280
s_add_u32 s31, s31, 131072
v_lshlrev_b32 v166, 4, v164
v_lshl_add_u32 v167, v161, 7, v166
v_add_u32 v155, s30, v167
v_add_u32 v156, 768, v155
v_mov_b32 v168, 1073741824
v_cmp_ne_u32 vcc, 0, v165
s_nop 1
v_cndmask_b32 v155, v155, v168, vcc
v_cndmask_b32 v156, v156, v168, vcc
v_cmp_eq_u32 vcc, 0, v162
s_nop 1
v_cndmask_b32 v156, v156, v168, vcc
v_lshl_add_u32 v157, v165, 6, v167
v_add_u32 v157, s31, v157
v_lshl_add_u32 v158, v162, 7, v166
v_lshl_add_u32 v158, v163, 3, v158
v_lshrrev_b32 v169, 1, v165
v_add_u32 v158, v158, v169
v_add_u32 v158, s31, v158
v_add_u32 v158, 1024, v158
v_mul_u32_u24 v224, 288, v161
v_lshl_add_u32 v224, v160, 2, v224
v_add_u32 v224, 9216, v224
v_add_u32 v225, 1152, v224
v_add_u32 v226, 2304, v224
v_add_u32 v227, 3456, v224
s_lshr_b32 s30, s21, 1
s_lshl_b32 s30, s30, 10
s_and_b32 s31, s21, 1
s_lshl_b32 s31, s31, 7
s_add_u32 s30, s30, s31
s_lshl_b32 s31, s20, 14
s_add_u32 s30, s30, s31
s_add_u32 s30, s30, 65536
v_lshl_add_u32 v159, v161, 8, v166
v_add_u32 v159, s30, v159
v_cmp_ne_u32 vcc, 0, v165
s_nop 1
v_cndmask_b32 v159, v159, v168, vcc
v_mov_b32 v129, 0
v_mov_b32 v130, 0
v_mov_b32 v131, 0
v_mov_b32 v133, 0
v_mov_b32 v134, 0
v_mov_b32 v135, 0
v_mov_b32 v141, 0
v_mov_b32 v142, 0
v_mov_b32 v143, 0
s_mov_b32 s34, 0x3fb8aa3b
s_mov_b32 s35, 0x3db504f3
s_barrier
.Lw0_28:
buffer_load_dwordx4 v[8:11], v240, s[8:11], s24 offen sc1
buffer_load_dwordx4 v[12:15], v241, s[8:11], s24 offen sc1
buffer_load_dwordx4 v[16:19], v242, s[8:11], s24 offen sc1
buffer_load_dwordx4 v[20:23], v243, s[8:11], s24 offen sc1
v_mov_b32 v24, 0
v_mov_b32 v25, 0
v_mov_b32 v26, 0
v_mov_b32 v27, 0
v_mov_b32 v28, 0
v_mov_b32 v29, 0
v_mov_b32 v30, 0
v_mov_b32 v31, 0
v_mov_b32 v32, 0
v_mov_b32 v33, 0
v_mov_b32 v34, 0
v_mov_b32 v35, 0
v_mov_b32 v36, 0
v_mov_b32 v37, 0
v_mov_b32 v38, 0
v_mov_b32 v39, 0
v_mov_b32 v40, 0
v_mov_b32 v41, 0
v_mov_b32 v42, 0
v_mov_b32 v43, 0
v_mov_b32 v44, 0
v_mov_b32 v45, 0
v_mov_b32 v46, 0
v_mov_b32 v47, 0
ds_read_b128 v[64:67], v153 offset:20480
ds_read_b128 v[72:75], v154 offset:22528
ds_read_b128 v[68:71], v153 offset:20608
ds_read_b128 v[76:79], v154 offset:22784
.Lga_29:
s_waitcnt vmcnt(3)
v_max3_u32 v6, v8, v9, v10
v_max_u32 v6, v6, v11
v_cmp_eq_u32 vcc, -1, v6
s_cbranch_vccnz .Lgr_31
.Lgo_30:
v_smfmac_f32_16x16x64_bf16 v[24:27], v[8:11], a[0:7], v2
v_smfmac_f32_16x16x64_bf16 v[28:31], v[8:11], a[32:39], v2
v_smfmac_f32_16x16x64_bf16 v[32:35], v[8:11], a[64:71], v2
v_smfmac_f32_16x16x64_bf16 v[36:39], v[8:11], a[96:103], v2
.Lga_32:
s_waitcnt vmcnt(2)
v_max3_u32 v6, v12, v13, v14
v_max_u32 v6, v6, v15
v_cmp_eq_u32 vcc, -1, v6
s_cbranch_vccnz .Lgr_34
.Lgo_33:
v_smfmac_f32_16x16x64_bf16 v[24:27], v[12:15], a[8:15], v2
v_smfmac_f32_16x16x64_bf16 v[28:31], v[12:15], a[40:47], v2
v_smfmac_f32_16x16x64_bf16 v[32:35], v[12:15], a[72:79], v2
v_smfmac_f32_16x16x64_bf16 v[36:39], v[12:15], a[104:111], v2
.Lga_35:
s_waitcnt vmcnt(1)
v_max3_u32 v6, v16, v17, v18
v_max_u32 v6, v6, v19
v_cmp_eq_u32 vcc, -1, v6
s_cbranch_vccnz .Lgr_37
.Lgo_36:
v_smfmac_f32_16x16x64_bf16 v[24:27], v[16:19], a[16:23], v2
v_smfmac_f32_16x16x64_bf16 v[28:31], v[16:19], a[48:55], v2
v_smfmac_f32_16x16x64_bf16 v[32:35], v[16:19], a[80:87], v2
v_smfmac_f32_16x16x64_bf16 v[36:39], v[16:19], a[112:119], v2
.Lga_38:
s_waitcnt vmcnt(0)
v_max3_u32 v6, v20, v21, v22
v_max_u32 v6, v6, v23
v_cmp_eq_u32 vcc, -1, v6
s_cbranch_vccnz .Lgr_40
.Lgo_39:
v_smfmac_f32_16x16x64_bf16 v[24:27], v[20:23], a[24:31], v2
v_smfmac_f32_16x16x64_bf16 v[28:31], v[20:23], a[56:63], v2
v_smfmac_f32_16x16x64_bf16 v[32:35], v[20:23], a[88:95], v2
v_smfmac_f32_16x16x64_bf16 v[36:39], v[20:23], a[120:127], v2
s_nop 5
v_permlane32_swap_b32 v24, v28
v_permlane32_swap_b32 v25, v29
v_permlane32_swap_b32 v26, v30
v_permlane32_swap_b32 v27, v31
v_add_f32 v24, v24, v28
v_add_f32 v25, v25, v29
v_add_f32 v26, v26, v30
v_add_f32 v27, v27, v31
ds_write_b32 v5, v24 offset:0
ds_write_b32 v5, v25 offset:144
ds_write_b32 v5, v26 offset:288
ds_write_b32 v5, v27 offset:432
v_permlane32_swap_b32 v32, v36
v_permlane32_swap_b32 v33, v37
v_permlane32_swap_b32 v34, v38
v_permlane32_swap_b32 v35, v39
v_add_f32 v32, v32, v36
v_add_f32 v33, v33, v37
v_add_f32 v34, v34, v38
v_add_f32 v35, v35, v39
ds_write_b32 v5, v32 offset:4608
ds_write_b32 v5, v33 offset:4752
ds_write_b32 v5, v34 offset:4896
ds_write_b32 v5, v35 offset:5040
s_waitcnt lgkmcnt(0)
s_barrier
ds_read_b128 v[176:179], v152 offset:0
ds_read_b128 v[180:183], v152 offset:32
ds_read_b128 v[184:187], v152 offset:1152
ds_read_b128 v[188:191], v152 offset:1184
ds_read_b128 v[192:195], v152 offset:2304
ds_read_b128 v[196:199], v152 offset:2336
ds_read_b128 v[200:203], v152 offset:3456
ds_read_b128 v[204:207], v152 offset:3488
s_waitcnt lgkmcnt(4)
v_pk_add_f32 v[176:177], v[176:177], v[184:185]
v_pk_add_f32 v[178:179], v[178:179], v[186:187]
v_pk_add_f32 v[180:181], v[180:181], v[188:189]
v_pk_add_f32 v[182:183], v[182:183], v[190:191]
s_waitcnt lgkmcnt(0)
v_pk_add_f32 v[192:193], v[192:193], v[200:201]
v_pk_add_f32 v[194:195], v[194:195], v[202:203]
v_pk_add_f32 v[196:197], v[196:197], v[204:205]
v_pk_add_f32 v[198:199], v[198:199], v[206:207]
v_pk_add_f32 v[176:177], v[176:177], v[192:193]
v_pk_add_f32 v[178:179], v[178:179], v[194:195]
v_pk_add_f32 v[180:181], v[180:181], v[196:197]
v_pk_add_f32 v[182:183], v[182:183], v[198:199]
v_cvt_pk_bf16_f32 v88, v176, v177
v_cvt_pk_bf16_f32 v89, v178, v179
v_cvt_pk_bf16_f32 v90, v180, v181
v_cvt_pk_bf16_f32 v91, v182, v183
s_nop 1
v_mfma_f32_16x16x32_bf16 v[92:95], v[64:67], v[88:91], 0
v_mfma_f32_16x16x32_bf16 v[96:99], v[68:71], v[88:91], 0
v_mfma_f32_16x16x32_bf16 v[100:103], v[88:91], v[88:91], 0
s_cmp_eq_u32 s23, 63
s_cbranch_scc1 .Llast_41
s_nop 3
buffer_store_dwordx4 v[92:95], v155, s[8:11], s24 offen
buffer_store_dwordx4 v[96:99], v155, s[8:11], s24 offen offset:512
buffer_store_dwordx4 v[100:103], v156, s[8:11], s24 offen
v_smfmac_f32_16x16x64_bf16 v[40:43], v[8:11], a[128:135], v2
v_smfmac_f32_16x16x64_bf16 v[44:47], v[8:11], a[160:167], v2
v_smfmac_f32_16x16x64_bf16 v[40:43], v[12:15], a[136:143], v2
v_smfmac_f32_16x16x64_bf16 v[44:47], v[12:15], a[168:175], v2
v_smfmac_f32_16x16x64_bf16 v[40:43], v[16:19], a[144:151], v2
v_smfmac_f32_16x16x64_bf16 v[44:47], v[16:19], a[176:183], v2
v_smfmac_f32_16x16x64_bf16 v[40:43], v[20:23], a[152:159], v2
v_smfmac_f32_16x16x64_bf16 v[44:47], v[20:23], a[184:191], v2
s_nop 7
v_permlane32_swap_b32 v40, v44
v_permlane32_swap_b32 v41, v45
v_permlane32_swap_b32 v42, v46
v_permlane32_swap_b32 v43, v47
v_add_f32 v40, v40, v44
v_add_f32 v41, v41, v45
v_add_f32 v42, v42, v46
v_add_f32 v43, v43, v47
ds_write_b32 v5, v40 offset:9216
ds_write_b32 v5, v41 offset:9360
ds_write_b32 v5, v42 offset:9504
ds_write_b32 v5, v43 offset:9648
s_waitcnt vmcnt(0)
buffer_load_dwordx4 v[104:107], v157, s[8:11], s24 offen offset:0 sc1
buffer_load_dword v120, v158, s[8:11], s24 offen offset:0 sc1
buffer_load_dwordx4 v[108:111], v157, s[8:11], s24 offen offset:1280 sc1
buffer_load_dword v121, v158, s[8:11], s24 offen offset:1280 sc1
buffer_load_dwordx4 v[112:115], v157, s[8:11], s24 offen offset:2560 sc1
buffer_load_dword v122, v158, s[8:11], s24 offen offset:2560 sc1
buffer_load_dwordx4 v[116:119], v157, s[8:11], s24 offen offset:3840 sc1
buffer_load_dword v123, v158, s[8:11], s24 offen offset:3840 sc1
s_waitcnt lgkmcnt(0)
s_barrier
ds_read2_b32 v[208:209], v224 offset1:36
ds_read2_b32 v[210:211], v224 offset0:16 offset1:52
ds_read2_b32 v[212:213], v225 offset1:36
ds_read2_b32 v[214:215], v225 offset0:16 offset1:52
ds_read2_b32 v[216:217], v226 offset1:36
ds_read2_b32 v[218:219], v226 offset0:16 offset1:52
ds_read2_b32 v[220:221], v227 offset1:36
ds_read2_b32 v[222:223], v227 offset0:16 offset1:52
v_xor_b32 v153, 4096, v153
v_xor_b32 v154, 4096, v154
s_waitcnt lgkmcnt(0)
v_pk_add_f32 v[208:209], v[208:209], v[212:213]
v_pk_add_f32 v[210:211], v[210:211], v[214:215]
v_pk_add_f32 v[216:217], v[216:217], v[220:221]
v_pk_add_f32 v[218:219], v[218:219], v[222:223]
v_pk_add_f32 v[208:209], v[208:209], v[216:217]
v_pk_add_f32 v[210:211], v[210:211], v[218:219]
v_cvt_pk_bf16_f32 v128, v208, v209
v_cvt_pk_bf16_f32 v132, v210, v211
s_branch .Lsc_44
.Ls_42:
buffer_load_dwordx4 v[104:107], v157, s[8:11], s24 offen offset:0 sc1
buffer_load_dword v120, v158, s[8:11], s24 offen offset:0 sc1
buffer_load_dwordx4 v[108:111], v157, s[8:11], s24 offen offset:1280 sc1
buffer_load_dword v121, v158, s[8:11], s24 offen offset:1280 sc1
buffer_load_dwordx4 v[112:115], v157, s[8:11], s24 offen offset:2560 sc1
buffer_load_dword v122, v158, s[8:11], s24 offen offset:2560 sc1
buffer_load_dwordx4 v[116:119], v157, s[8:11], s24 offen offset:3840 sc1
buffer_load_dword v123, v158, s[8:11], s24 offen offset:3840 sc1
.Lsc_44:
s_waitcnt vmcnt(4)
v_pk_add_f32 v[104:105], v[104:105], v[108:109]
v_pk_add_f32 v[106:107], v[106:107], v[110:111]
v_add_f32 v120, v120, v121
s_waitcnt vmcnt(0)
v_pk_add_f32 v[112:113], v[112:113], v[116:117]
v_pk_add_f32 v[114:115], v[114:115], v[118:119]
v_add_f32 v122, v122, v123
v_pk_add_f32 v[104:105], v[104:105], v[112:113]
v_pk_add_f32 v[106:107], v[106:107], v[114:115]
v_add_f32 v108, v120, v122
v_cmp_u_f32 s[60:61], v104, v105
v_cmp_u_f32 s[62:63], v106, v107
v_cmp_u_f32 vcc, v108, v108
v_cvt_pk_bf16_f32 v112, v104, v105
v_cvt_pk_bf16_f32 v113, v106, v107
v_cvt_pk_bf16_f32 v114, v108, v108
s_or_b64 s[60:61], s[60:61], s[62:63]
s_or_b64 vcc, vcc, s[60:61]
s_cbranch_vccz .Lso_43
s_cmp_eq_u32 s27, 0
s_cbranch_scc1 .Lso_43
s_sub_u32 s27, s27, 1
s_branch .Ls_42
.Lso_43:
v_lshlrev_b32 v104, 16, v112
v_and_b32 v105, 0xffff0000, v112
v_lshlrev_b32 v106, 16, v113
v_and_b32 v107, 0xffff0000, v113
v_lshlrev_b32 v108, 16, v114
v_mul_f32 v104, s35, v104
v_mul_f32 v105, s35, v105
v_mul_f32 v106, s35, v106
v_mul_f32 v107, s35, v107
v_mul_f32 v108, s35, v108
v_cvt_pk_bf16_f32 v112, v104, v105
v_cvt_pk_bf16_f32 v113, v106, v107
v_cvt_pk_bf16_f32 v114, v108, v108
v_lshlrev_b32 v104, 16, v112
v_and_b32 v105, 0xffff0000, v112
v_lshlrev_b32 v106, 16, v113
v_and_b32 v107, 0xffff0000, v113
v_lshlrev_b32 v108, 16, v114
v_max3_f32 v112, v104, v105, v106
v_max3_f32 v112, v112, v107, v108
s_nop 1
v_max_f32_dpp v112, v112, v112 row_ror:8 row_mask:0xf bank_mask:0xf
v_mov_b32 v113, v112
s_nop 1
v_permlane16_swap_b32 v112, v113
v_max_f32 v112, v112, v113
v_mov_b32 v113, v112
s_nop 1
v_permlane32_swap_b32 v112, v113
v_max_f32 v112, v112, v113
v_mul_f32 v112, 0xbfb8aa3b, v112
v_fma_f32 v104, v104, s34, v112
v_fma_f32 v105, v105, s34, v112
v_fma_f32 v106, v106, s34, v112
v_fma_f32 v107, v107, s34, v112
v_fma_f32 v108, v108, s34, v112
v_exp_f32 v104, v104
v_exp_f32 v105, v105
v_exp_f32 v106, v106
v_exp_f32 v107, v107
v_exp_f32 v108, v108
v_cvt_pk_bf16_f32 v136, v104, v105
v_cvt_pk_bf16_f32 v137, v106, v107
v_mov_b32_dpp v113, v108 row_ror:8 row_mask:0xf bank_mask:0xf
v_mov_b32_dpp v138, v136 row_ror:8 row_mask:0xf bank_mask:0xf
v_mov_b32_dpp v139, v137 row_ror:8 row_mask:0xf bank_mask:0xf
v_cvt_pk_bf16_f32 v140, v108, v113
v_add_f32 v104, v104, v105
v_add_f32 v106, v106, v107
v_mfma_f32_16x16x32_bf16 v[144:147], v[72:75], v[136:139], 0
v_add_f32 v104, v104, v106
v_add_f32 v112, v104, v108
v_mfma_f32_16x16x32_bf16 v[148:151], v[76:79], v[136:139], 0
s_nop 0
v_add_f32_dpp v112, v112, v112 row_ror:8 row_mask:0xf bank_mask:0xf
v_mfma_f32_16x16x32_bf16 v[144:147], v[128:131], v[140:143], v[144:147]
v_mov_b32 v113, v112
s_nop 1
v_permlane16_swap_b32 v112, v113
v_add_f32 v112, v112, v113
v_mfma_f32_16x16x32_bf16 v[148:151], v[132:135], v[140:143], v[148:151]
v_mov_b32 v113, v112
s_nop 1
v_permlane32_swap_b32 v112, v113
v_add_f32 v112, v112, v113
v_rcp_f32 v112, v112
s_nop 0
v_mul_f32 v144, v144, v112
v_mul_f32 v145, v145, v112
v_mul_f32 v146, v146, v112
v_mul_f32 v147, v147, v112
v_mul_f32 v148, v148, v112
v_mul_f32 v149, v149, v112
v_mul_f32 v150, v150, v112
v_mul_f32 v151, v151, v112
v_cvt_pk_bf16_f32 v104, v144, v145
v_cvt_pk_bf16_f32 v105, v146, v147
v_cvt_pk_bf16_f32 v106, v148, v149
v_cvt_pk_bf16_f32 v107, v150, v151
buffer_store_dwordx4 v[104:107], v159, s[8:11], s24 offen
s_waitcnt vmcnt(0)
s_barrier
buffer_load_dwordx4 v[8:11], v244, s[8:11], s24 offen sc1
buffer_load_dwordx4 v[12:15], v245, s[8:11], s24 offen sc1
buffer_load_dwordx4 v[16:19], v246, s[8:11], s24 offen sc1
buffer_load_dwordx4 v[20:23], v247, s[8:11], s24 offen sc1
v_mov_b32 v24, 0
v_mov_b32 v25, 0
v_mov_b32 v26, 0
v_mov_b32 v27, 0
v_mov_b32 v28, 0
v_mov_b32 v29, 0
v_mov_b32 v30, 0
v_mov_b32 v31, 0
.Lga_45:
s_waitcnt vmcnt(3)
v_max3_u32 v6, v8, v9, v10
v_max_u32 v6, v6, v11
v_cmp_eq_u32 vcc, -1, v6
s_cbranch_vccnz .Lgr_47
.Lgo_46:
v_smfmac_f32_16x16x64_bf16 v[24:27], v[8:11], a[192:199], v2
v_smfmac_f32_16x16x64_bf16 v[28:31], v[8:11], a[224:231], v2
.Lga_48:
s_waitcnt vmcnt(2)
v_max3_u32 v6, v12, v13, v14
v_max_u32 v6, v6, v15
v_cmp_eq_u32 vcc, -1, v6
s_cbranch_vccnz .Lgr_50
.Lgo_49:
v_smfmac_f32_16x16x64_bf16 v[24:27], v[12:15], a[200:207], v2
v_smfmac_f32_16x16x64_bf16 v[28:31], v[12:15], a[232:239], v2
.Lga_51:
s_waitcnt vmcnt(1)
v_max3_u32 v6, v16, v17, v18
v_max_u32 v6, v6, v19
v_cmp_eq_u32 vcc, -1, v6
s_cbranch_vccnz .Lgr_53
.Lgo_52:
v_smfmac_f32_16x16x64_bf16 v[24:27], v[16:19], a[208:215], v2
v_smfmac_f32_16x16x64_bf16 v[28:31], v[16:19], a[240:247], v2
.Lga_54:
s_waitcnt vmcnt(0)
v_max3_u32 v6, v20, v21, v22
v_max_u32 v6, v6, v23
v_cmp_eq_u32 vcc, -1, v6
s_cbranch_vccnz .Lgr_56
.Lgo_55:
v_smfmac_f32_16x16x64_bf16 v[24:27], v[20:23], a[216:223], v2
v_smfmac_f32_16x16x64_bf16 v[28:31], v[20:23], a[248:255], v2
s_nop 7
v_permlane32_swap_b32 v24, v28
v_permlane32_swap_b32 v25, v29
v_permlane32_swap_b32 v26, v30
v_permlane32_swap_b32 v27, v31
v_add_f32 v24, v24, v28
v_add_f32 v25, v25, v29
v_add_f32 v26, v26, v30
v_add_f32 v27, v27, v31
ds_write_b32 v5, v24 offset:13824
ds_write_b32 v5, v25 offset:13968
ds_write_b32 v5, v26 offset:14112
ds_write_b32 v5, v27 offset:14256
s_waitcnt lgkmcnt(0)
s_barrier
s_barrier
s_barrier
s_add_u32 s23, s23, 1
s_mov_b32 s24, s25
s_mov_b32 s25, s26
s_add_u32 s26, s26, 524288
s_and_b32 s26, s26, 2097151
s_branch .Lw0_28
.Lgr_31:
s_cmp_eq_u32 s27, 0
s_cbranch_scc1 .Lgo_30
s_sub_u32 s27, s27, 1
buffer_load_dwordx4 v[8:11], v240, s[8:11], s24 offen sc1
buffer_load_dwordx4 v[12:15], v241, s[8:11], s24 offen sc1
buffer_load_dwordx4 v[16:19], v242, s[8:11], s24 offen sc1
buffer_load_dwordx4 v[20:23], v243, s[8:11], s24 offen sc1
s_branch .Lga_29
.Lgr_34:
s_cmp_eq_u32 s27, 0
s_cbranch_scc1 .Lgo_33
s_sub_u32 s27, s27, 1
buffer_load_dwordx4 v[12:15], v241, s[8:11], s24 offen sc1
buffer_load_dwordx4 v[16:19], v242, s[8:11], s24 offen sc1
buffer_load_dwordx4 v[20:23], v243, s[8:11], s24 offen sc1
s_branch .Lga_32
.Lgr_37:
s_cmp_eq_u32 s27, 0
s_cbranch_scc1 .Lgo_36
s_sub_u32 s27, s27, 1
buffer_load_dwordx4 v[16:19], v242, s[8:11], s24 offen sc1
buffer_load_dwordx4 v[20:23], v243, s[8:11], s24 offen sc1
s_branch .Lga_35
.Lgr_40:
s_cmp_eq_u32 s27, 0
s_cbranch_scc1 .Lgo_39
s_sub_u32 s27, s27, 1
buffer_load_dwordx4 v[20:23], v243, s[8:11], s24 offen sc1
s_branch .Lga_38
.Llast_41:
v_smfmac_f32_16x16x64_bf16 v[40:43], v[8:11], a[128:135], v2
v_smfmac_f32_16x16x64_bf16 v[44:47], v[8:11], a[160:167], v2
v_smfmac_f32_16x16x64_bf16 v[40:43], v[12:15], a[136:143], v2
v_smfmac_f32_16x16x64_bf16 v[44:47], v[12:15], a[168:175], v2
v_smfmac_f32_16x16x64_bf16 v[40:43], v[16:19], a[144:151], v2
v_smfmac_f32_16x16x64_bf16 v[44:47], v[16:19], a[176:183], v2
v_smfmac_f32_16x16x64_bf16 v[40:43], v[20:23], a[152:159], v2
v_smfmac_f32_16x16x64_bf16 v[44:47], v[20:23], a[184:191], v2
s_nop 7
v_permlane32_swap_b32 v40, v44
v_permlane32_swap_b32 v41, v45
v_permlane32_swap_b32 v42, v46
v_permlane32_swap_b32 v43, v47
v_add_f32 v40, v40, v44
v_add_f32 v41, v41, v45
v_add_f32 v42, v42, v46
v_add_f32 v43, v43, v47
ds_write_b32 v5, v40 offset:9216
ds_write_b32 v5, v41 offset:9360
ds_write_b32 v5, v42 offset:9504
ds_write_b32 v5, v43 offset:9648
s_branch .Ldone_23
.Lgr_47:
s_cmp_eq_u32 s27, 0
s_cbranch_scc1 .Lgo_46
s_sub_u32 s27, s27, 1
buffer_load_dwordx4 v[8:11], v244, s[8:11], s24 offen sc1
buffer_load_dwordx4 v[12:15], v245, s[8:11], s24 offen sc1
buffer_load_dwordx4 v[16:19], v246, s[8:11], s24 offen sc1
buffer_load_dwordx4 v[20:23], v247, s[8:11], s24 offen sc1
s_branch .Lga_45
.Lgr_50:
s_cmp_eq_u32 s27, 0
s_cbranch_scc1 .Lgo_49
s_sub_u32 s27, s27, 1
buffer_load_dwordx4 v[12:15], v245, s[8:11], s24 offen sc1
buffer_load_dwordx4 v[16:19], v246, s[8:11], s24 offen sc1
buffer_load_dwordx4 v[20:23], v247, s[8:11], s24 offen sc1
s_branch .Lga_48
.Lgr_53:
s_cmp_eq_u32 s27, 0
s_cbranch_scc1 .Lgo_52
s_sub_u32 s27, s27, 1
buffer_load_dwordx4 v[16:19], v246, s[8:11], s24 offen sc1
buffer_load_dwordx4 v[20:23], v247, s[8:11], s24 offen sc1
s_branch .Lga_51
.Lgr_56:
s_cmp_eq_u32 s27, 0
s_cbranch_scc1 .Lgo_55
s_sub_u32 s27, s27, 1
buffer_load_dwordx4 v[20:23], v247, s[8:11], s24 offen sc1
s_branch .Lga_54
.Lwv_25:
v_and_b32 v160, 15, v0
v_lshrrev_b32 v161, 4, v0
v_bfe_u32 v162, v0, 5, 1
v_bfe_u32 v163, v0, 4, 1
v_bfe_u32 v164, v0, 1, 3
v_and_b32 v165, 1, v0
v_and_b32 v166, 7, v0
v_mul_u32_u24 v152, 144, v166
v_lshl_add_u32 v152, v162, 6, v152
v_lshl_add_u32 v152, v163, 4, v152
v_lshlrev_b32 v153, 4, v166
v_lshl_add_u32 v153, v161, 7, v153
v_mov_b32 v167, 1073741824
v_cmp_lt_u32 vcc, 7, v160
s_nop 1
v_cndmask_b32 v153, v153, v167, vcc
v_mul_u32_u24 v154, 576, v162
v_and_b32 v166, 31, v0
v_lshl_add_u32 v154, v166, 2, v154
v_add_u32 v154, 9216, v154
v_add_u32 v224, 0, v154
v_add_u32 v225, 1152, v154
v_add_u32 v226, 2304, v154
v_add_u32 v227, 3456, v154
v_mul_u32_u24 v155, 144, v164
v_lshl_add_u32 v155, v161, 5, v155
v_lshl_add_u32 v155, v165, 4, v155
s_lshl_b32 s30, s21, 2
s_add_u32 s30, s30, s20
s_lshl_b32 s30, s30, 10
s_add_u32 s30, s30, 393216
v_lshlrev_b32 v236, 4, v0
v_add_u32 v236, s30, v236
v_lshlrev_b32 v168, 3, v0
s_lshr_b32 s30, s21, 1
s_lshl_b32 s30, s30, 10
s_and_b32 s31, s21, 1
s_lshl_b32 s31, s31, 7
s_add_u32 s30, s30, s31
s_lshl_b32 s31, s20, 14
s_add_u32 s30, s30, s31
v_lshlrev_b32 v237, 3, v160
v_lshl_add_u32 v237, v161, 8, v237
v_add_u32 v237, s30, v237
v_add_u32 v238, 65536, v237
s_mul_i32 s30, s22, 1280
s_add_u32 s30, s30, 131072
v_lshlrev_b32 v239, 4, v0
v_add_u32 v239, s30, v239
v_lshlrev_b32 v154, 2, v0
v_add_u32 v154, s30, v154
v_mov_b32 v232, -1
v_mov_b32 v233, -1
v_mov_b32 v234, -1
v_mov_b32 v235, -1
v_mov_b32 v72, 0
s_mov_b32 s30, 2098560
.Lpp_57:
buffer_load_dword v73, v72, s[8:11], s30 offen sc1
s_waitcnt vmcnt(0)
v_cmp_eq_u32 vcc, 0, v73
s_cbranch_vccz .Lpk_58
s_cmp_eq_u32 s27, 0
s_cbranch_scc1 .Lpk_58
s_sub_u32 s27, s27, 1
s_branch .Lpp_57
.Lpk_58:
v_readfirstlane_b32 s30, v73
s_cmp_eq_u32 s30, 2
s_cselect_b32 s30, 8192, 0
s_lshr_b32 s31, s21, 1
s_lshl_b32 s31, s31, 14
s_add_u32 s30, s30, s31
s_and_b32 s31, s21, 1
s_lshl_b32 s31, s31, 12
s_add_u32 s30, s30, s31
s_lshl_b32 s31, s20, 10
s_add_u32 s30, s30, s31
s_add_u32 s30, s30, 100663296
v_lshlrev_b32 v236, 4, v0
v_add_u32 v236, s30, v236
s_barrier
.Lw1_59:
buffer_load_dwordx4 v[8:11], v240, s[8:11], s24 offen sc1
buffer_load_dwordx4 v[12:15], v241, s[8:11], s24 offen sc1
buffer_load_dwordx4 v[16:19], v242, s[8:11], s24 offen sc1
buffer_load_dwordx4 v[20:23], v243, s[8:11], s24 offen sc1
v_mov_b32 v24, 0
v_mov_b32 v25, 0
v_mov_b32 v26, 0
v_mov_b32 v27, 0
v_mov_b32 v28, 0
v_mov_b32 v29, 0
v_mov_b32 v30, 0
v_mov_b32 v31, 0
v_mov_b32 v32, 0
v_mov_b32 v33, 0
v_mov_b32 v34, 0
v_mov_b32 v35, 0
v_mov_b32 v36, 0
v_mov_b32 v37, 0
v_mov_b32 v38, 0
v_mov_b32 v39, 0
v_mov_b32 v40, 0
v_mov_b32 v41, 0
v_mov_b32 v42, 0
v_mov_b32 v43, 0
v_mov_b32 v44, 0
v_mov_b32 v45, 0
v_mov_b32 v46, 0
v_mov_b32 v47, 0
.Lga_60:
s_waitcnt vmcnt(3)
v_max3_u32 v6, v8, v9, v10
v_max_u32 v6, v6, v11
v_cmp_eq_u32 vcc, -1, v6
s_cbranch_vccnz .Lgr_62
.Lgo_61:
v_smfmac_f32_16x16x64_bf16 v[24:27], v[8:11], a[0:7], v2
v_smfmac_f32_16x16x64_bf16 v[28:31], v[8:11], a[32:39], v2
v_smfmac_f32_16x16x64_bf16 v[32:35], v[8:11], a[64:71], v2
v_smfmac_f32_16x16x64_bf16 v[36:39], v[8:11], a[96:103], v2
.Lga_63:
s_waitcnt vmcnt(2)
v_max3_u32 v6, v12, v13, v14
v_max_u32 v6, v6, v15
v_cmp_eq_u32 vcc, -1, v6
s_cbranch_vccnz .Lgr_65
.Lgo_64:
v_smfmac_f32_16x16x64_bf16 v[24:27], v[12:15], a[8:15], v2
v_smfmac_f32_16x16x64_bf16 v[28:31], v[12:15], a[40:47], v2
v_smfmac_f32_16x16x64_bf16 v[32:35], v[12:15], a[72:79], v2
v_smfmac_f32_16x16x64_bf16 v[36:39], v[12:15], a[104:111], v2
.Lga_66:
s_waitcnt vmcnt(1)
v_max3_u32 v6, v16, v17, v18
v_max_u32 v6, v6, v19
v_cmp_eq_u32 vcc, -1, v6
s_cbranch_vccnz .Lgr_68
.Lgo_67:
v_smfmac_f32_16x16x64_bf16 v[24:27], v[16:19], a[16:23], v2
v_smfmac_f32_16x16x64_bf16 v[28:31], v[16:19], a[48:55], v2
v_smfmac_f32_16x16x64_bf16 v[32:35], v[16:19], a[80:87], v2
v_smfmac_f32_16x16x64_bf16 v[36:39], v[16:19], a[112:119], v2
.Lga_69:
s_waitcnt vmcnt(0)
v_max3_u32 v6, v20, v21, v22
v_max_u32 v6, v6, v23
v_cmp_eq_u32 vcc, -1, v6
s_cbranch_vccnz .Lgr_71
.Lgo_70:
v_smfmac_f32_16x16x64_bf16 v[24:27], v[20:23], a[24:31], v2
v_smfmac_f32_16x16x64_bf16 v[28:31], v[20:23], a[56:63], v2
v_smfmac_f32_16x16x64_bf16 v[32:35], v[20:23], a[88:95], v2
v_smfmac_f32_16x16x64_bf16 v[36:39], v[20:23], a[120:127], v2
s_nop 5
v_permlane32_swap_b32 v24, v28
v_permlane32_swap_b32 v25, v29
v_permlane32_swap_b32 v26, v30
v_permlane32_swap_b32 v27, v31
v_add_f32 v24, v24, v28
v_add_f32 v25, v25, v29
v_add_f32 v26, v26, v30
v_add_f32 v27, v27, v31
ds_write_b32 v5, v24 offset:0
ds_write_b32 v5, v25 offset:144
ds_write_b32 v5, v26 offset:288
ds_write_b32 v5, v27 offset:432
v_permlane32_swap_b32 v32, v36
v_permlane32_swap_b32 v33, v37
v_permlane32_swap_b32 v34, v38
v_permlane32_swap_b32 v35, v39
v_add_f32 v32, v32, v36
v_add_f32 v33, v33, v37
v_add_f32 v34, v34, v38
v_add_f32 v35, v35, v39
ds_write_b32 v5, v32 offset:4608
ds_write_b32 v5, v33 offset:4752
ds_write_b32 v5, v34 offset:4896
ds_write_b32 v5, v35 offset:5040
s_waitcnt lgkmcnt(0)
s_barrier
v_smfmac_f32_16x16x64_bf16 v[40:43], v[8:11], a[128:135], v2
v_smfmac_f32_16x16x64_bf16 v[44:47], v[8:11], a[160:167], v2
v_smfmac_f32_16x16x64_bf16 v[40:43], v[12:15], a[136:143], v2
v_smfmac_f32_16x16x64_bf16 v[44:47], v[12:15], a[168:175], v2
v_smfmac_f32_16x16x64_bf16 v[40:43], v[16:19], a[144:151], v2
v_smfmac_f32_16x16x64_bf16 v[44:47], v[16:19], a[176:183], v2
v_smfmac_f32_16x16x64_bf16 v[40:43], v[20:23], a[152:159], v2
v_smfmac_f32_16x16x64_bf16 v[44:47], v[20:23], a[184:191], v2
s_nop 7
v_permlane32_swap_b32 v40, v44
v_permlane32_swap_b32 v41, v45
v_permlane32_swap_b32 v42, v46
v_permlane32_swap_b32 v43, v47
v_add_f32 v40, v40, v44
v_add_f32 v41, v41, v45
v_add_f32 v42, v42, v46
v_add_f32 v43, v43, v47
ds_write_b32 v5, v40 offset:9216
ds_write_b32 v5, v41 offset:9360
ds_write_b32 v5, v42 offset:9504
ds_write_b32 v5, v43 offset:9648
s_waitcnt lgkmcnt(0)
s_barrier
ds_read_b128 v[64:67], v152 offset:4608
ds_read_b128 v[68:71], v152 offset:4640
ds_read2_b32 v[72:73], v224 offset1:36
ds_read2_b32 v[74:75], v224 offset0:72 offset1:108
ds_read_b128 v[76:79], v152 offset:5760
ds_read_b128 v[80:83], v152 offset:5792
ds_read2_b32 v[84:85], v225 offset1:36
ds_read2_b32 v[86:87], v225 offset0:72 offset1:108
ds_read_b128 v[88:91], v152 offset:6912
ds_read_b128 v[92:95], v152 offset:6944
ds_read2_b32 v[96:97], v226 offset1:36
ds_read2_b32 v[98:99], v226 offset0:72 offset1:108
ds_read_b128 v[100:103], v152 offset:8064
ds_read_b128 v[104:107], v152 offset:8096
ds_read2_b32 v[108:109], v227 offset1:36
ds_read2_b32 v[110:111], v227 offset0:72 offset1:108
s_waitcnt lgkmcnt(0)
v_pk_add_f32 v[64:65], v[64:65], v[76:77]
v_pk_add_f32 v[66:67], v[66:67], v[78:79]
v_pk_add_f32 v[68:69], v[68:69], v[80:81]
v_pk_add_f32 v[70:71], v[70:71], v[82:83]
v_pk_add_f32 v[72:73], v[72:73], v[84:85]
v_pk_add_f32 v[74:75], v[74:75], v[86:87]
v_pk_add_f32 v[88:89], v[88:89], v[100:101]
v_pk_add_f32 v[90:91], v[90:91], v[102:103]
v_pk_add_f32 v[92:93], v[92:93], v[104:105]
v_pk_add_f32 v[94:95], v[94:95], v[106:107]
v_pk_add_f32 v[96:97], v[96:97], v[108:109]
v_pk_add_f32 v[98:99], v[98:99], v[110:111]
v_pk_add_f32 v[64:65], v[64:65], v[88:89]
v_pk_add_f32 v[66:67], v[66:67], v[90:91]
v_pk_add_f32 v[68:69], v[68:69], v[92:93]
v_pk_add_f32 v[70:71], v[70:71], v[94:95]
v_pk_add_f32 v[72:73], v[72:73], v[96:97]
v_pk_add_f32 v[74:75], v[74:75], v[98:99]
v_cvt_pk_bf16_f32 v76, v64, v65
v_cvt_pk_bf16_f32 v77, v66, v67
v_cvt_pk_bf16_f32 v78, v68, v69
v_cvt_pk_bf16_f32 v79, v70, v71
v_cvt_pk_bf16_f32 v80, v72, v73
v_cvt_pk_bf16_f32 v81, v74, v75
s_cmp_eq_u32 s23, 63
s_cbranch_scc1 .Llast_72
s_barrier
buffer_load_dwordx4 v[8:11], v244, s[8:11], s24 offen sc1
buffer_load_dwordx4 v[12:15], v245, s[8:11], s24 offen sc1
buffer_load_dwordx4 v[16:19], v246, s[8:11], s24 offen sc1
buffer_load_dwordx4 v[20:23], v247, s[8:11], s24 offen sc1
v_mov_b32 v24, 0
v_mov_b32 v25, 0
v_mov_b32 v26, 0
v_mov_b32 v27, 0
v_mov_b32 v28, 0
v_mov_b32 v29, 0
v_mov_b32 v30, 0
v_mov_b32 v31, 0
.Lga_73:
s_waitcnt vmcnt(3)
v_max3_u32 v6, v8, v9, v10
v_max_u32 v6, v6, v11
v_cmp_eq_u32 vcc, -1, v6
s_cbranch_vccnz .Lgr_75
.Lgo_74:
v_smfmac_f32_16x16x64_bf16 v[24:27], v[8:11], a[192:199], v2
v_smfmac_f32_16x16x64_bf16 v[28:31], v[8:11], a[224:231], v2
.Lga_76:
s_waitcnt vmcnt(2)
v_max3_u32 v6, v12, v13, v14
v_max_u32 v6, v6, v15
v_cmp_eq_u32 vcc, -1, v6
s_cbranch_vccnz .Lgr_78
.Lgo_77:
v_smfmac_f32_16x16x64_bf16 v[24:27], v[12:15], a[200:207], v2
v_smfmac_f32_16x16x64_bf16 v[28:31], v[12:15], a[232:239], v2
.Lga_79:
s_waitcnt vmcnt(1)
v_max3_u32 v6, v16, v17, v18
v_max_u32 v6, v6, v19
v_cmp_eq_u32 vcc, -1, v6
s_cbranch_vccnz .Lgr_81
.Lgo_80:
v_smfmac_f32_16x16x64_bf16 v[24:27], v[16:19], a[208:215], v2
v_smfmac_f32_16x16x64_bf16 v[28:31], v[16:19], a[240:247], v2
.Lga_82:
s_waitcnt vmcnt(0)
v_max3_u32 v6, v20, v21, v22
v_max_u32 v6, v6, v23
v_cmp_eq_u32 vcc, -1, v6
s_cbranch_vccnz .Lgr_84
.Lgo_83:
v_smfmac_f32_16x16x64_bf16 v[24:27], v[20:23], a[216:223], v2
v_smfmac_f32_16x16x64_bf16 v[28:31], v[20:23], a[248:255], v2
s_nop 7
v_permlane32_swap_b32 v24, v28
v_permlane32_swap_b32 v25, v29
v_permlane32_swap_b32 v26, v30
v_permlane32_swap_b32 v27, v31
v_add_f32 v24, v24, v28
v_add_f32 v25, v25, v29
v_add_f32 v26, v26, v30
v_add_f32 v27, v27, v31
ds_write_b32 v5, v24 offset:13824
ds_write_b32 v5, v25 offset:13968
ds_write_b32 v5, v26 offset:14112
ds_write_b32 v5, v27 offset:14256
s_waitcnt lgkmcnt(0)
s_barrier
s_barrier
s_lshr_b32 s35, s26, 1
buffer_store_dwordx4 v[232:235], v236, s[12:15], s35 offen sc1
s_add_u32 s30, s29, 4194304
buffer_store_dwordx4 v[76:79], v153, s[12:15], s29 offen sc1
buffer_store_dwordx2 v[80:81], v168, s[12:15], s30 offen sc1
s_add_u32 s29, s29, 65536
buffer_store_dwordx2 v[232:233], v237, s[8:11], s26 offen
buffer_store_dwordx2 v[232:233], v238, s[8:11], s26 offen
buffer_store_dwordx4 v[232:235], v239, s[8:11], s26 offen
buffer_store_dword v232, v154, s[8:11], s26 offen offset:1024
s_waitcnt vmcnt(0)
s_and_b32 s30, s23, 7
s_cmp_eq_u32 s30, 7
s_cbranch_scc1 .Lsig_85
.Lsb_86:
s_barrier
s_add_u32 s23, s23, 1
s_mov_b32 s24, s25
s_mov_b32 s25, s26
s_add_u32 s26, s26, 524288
s_and_b32 s26, s26, 2097151
s_branch .Lw1_59
.Lgr_62:
s_cmp_eq_u32 s27, 0
s_cbranch_scc1 .Lgo_61
s_sub_u32 s27, s27, 1
buffer_load_dwordx4 v[8:11], v240, s[8:11], s24 offen sc1
buffer_load_dwordx4 v[12:15], v241, s[8:11], s24 offen sc1
buffer_load_dwordx4 v[16:19], v242, s[8:11], s24 offen sc1
buffer_load_dwordx4 v[20:23], v243, s[8:11], s24 offen sc1
s_branch .Lga_60
.Lgr_65:
s_cmp_eq_u32 s27, 0
s_cbranch_scc1 .Lgo_64
s_sub_u32 s27, s27, 1
buffer_load_dwordx4 v[12:15], v241, s[8:11], s24 offen sc1
buffer_load_dwordx4 v[16:19], v242, s[8:11], s24 offen sc1
buffer_load_dwordx4 v[20:23], v243, s[8:11], s24 offen sc1
s_branch .Lga_63
.Lgr_68:
s_cmp_eq_u32 s27, 0
s_cbranch_scc1 .Lgo_67
s_sub_u32 s27, s27, 1
buffer_load_dwordx4 v[16:19], v242, s[8:11], s24 offen sc1
buffer_load_dwordx4 v[20:23], v243, s[8:11], s24 offen sc1
s_branch .Lga_66
.Lgr_71:
s_cmp_eq_u32 s27, 0
s_cbranch_scc1 .Lgo_70
s_sub_u32 s27, s27, 1
buffer_load_dwordx4 v[20:23], v243, s[8:11], s24 offen sc1
s_branch .Lga_69
.Llast_72:
s_add_u32 s30, s29, 4194304
buffer_store_dwordx4 v[76:79], v153, s[12:15], s29 offen sc1
buffer_store_dwordx2 v[80:81], v168, s[12:15], s30 offen sc1
s_add_u32 s29, s29, 65536
s_waitcnt vmcnt(0)
s_lshr_b32 s30, s23, 3
s_lshl_b32 s30, s30, 2
s_add_u32 s30, s30, s20
s_lshl_b32 s30, s30, 7
s_add_u32 s30, s30, 2103296
v_mov_b32 v64, 1
v_mov_b32 v65, 0
s_mov_b64 exec, 1
buffer_atomic_add v64, v65, s[8:11], s30 offen sc1
s_mov_b64 exec, -1
s_branch .Ldone_232
.Lgr_75:
s_cmp_eq_u32 s27, 0
s_cbranch_scc1 .Lgo_74
s_sub_u32 s27, s27, 1
buffer_load_dwordx4 v[8:11], v244, s[8:11], s24 offen sc1
buffer_load_dwordx4 v[12:15], v245, s[8:11], s24 offen sc1
buffer_load_dwordx4 v[16:19], v246, s[8:11], s24 offen sc1
buffer_load_dwordx4 v[20:23], v247, s[8:11], s24 offen sc1
s_branch .Lga_73
.Lgr_78:
s_cmp_eq_u32 s27, 0
s_cbranch_scc1 .Lgo_77
s_sub_u32 s27, s27, 1
buffer_load_dwordx4 v[12:15], v245, s[8:11], s24 offen sc1
buffer_load_dwordx4 v[16:19], v246, s[8:11], s24 offen sc1
buffer_load_dwordx4 v[20:23], v247, s[8:11], s24 offen sc1
s_branch .Lga_76
.Lgr_81:
s_cmp_eq_u32 s27, 0
s_cbranch_scc1 .Lgo_80
s_sub_u32 s27, s27, 1
buffer_load_dwordx4 v[16:19], v246, s[8:11], s24 offen sc1
buffer_load_dwordx4 v[20:23], v247, s[8:11], s24 offen sc1
s_branch .Lga_79
.Lgr_84:
s_cmp_eq_u32 s27, 0
s_cbranch_scc1 .Lgo_83
s_sub_u32 s27, s27, 1
buffer_load_dwordx4 v[20:23], v247, s[8:11], s24 offen sc1
s_branch .Lga_82
.Lsig_85:
s_waitcnt vmcnt(0)
s_lshr_b32 s30, s23, 3
s_lshl_b32 s30, s30, 2
s_add_u32 s30, s30, s20
s_lshl_b32 s30, s30, 7
s_add_u32 s30, s30, 2103296
v_mov_b32 v64, 1
v_mov_b32 v65, 0
s_mov_b64 exec, 1
buffer_atomic_add v64, v65, s[8:11], s30 offen sc1
s_mov_b64 exec, -1
s_branch .Lsb_86
.Lwv_26:
v_and_b32 v160, 15, v0
v_lshrrev_b32 v161, 4, v0
v_bfe_u32 v162, v0, 5, 1
v_bfe_u32 v163, v0, 4, 1
v_bfe_u32 v164, v0, 1, 3
v_and_b32 v165, 1, v0
s_lshr_b32 s30, s21, 1
s_lshl_b32 s30, s30, 10
s_and_b32 s31, s21, 1
s_lshl_b32 s31, s31, 7
s_add_u32 s30, s30, s31
s_lshl_b32 s31, s20, 14
s_add_u32 s30, s30, s31
v_lshlrev_b32 v152, 3, v160
v_lshl_add_u32 v152, v161, 8, v152
v_add_u32 v152, s30, v152
v_add_u32 v156, 65536, v152
s_lshl_b32 s30, s21, 12
s_add_u32 s30, s30, 393216
v_lshlrev_b32 v153, 4, v0
v_add_u32 v153, s30, v153
s_lshl_b32 s30, s20, 10
v_add_u32 v155, s30, v153
s_mul_i32 s30, s22, 1280
s_add_u32 s30, s30, 131072
v_lshlrev_b32 v154, 4, v0
v_add_u32 v154, s30, v154
v_lshlrev_b32 v166, 2, v0
v_add_u32 v166, s30, v166
v_mul_u32_u24 v168, 144, v164
v_lshl_add_u32 v168, v161, 5, v168
v_lshl_add_u32 v168, v165, 4, v168
v_mov_b32 v96, -1
v_mov_b32 v97, -1
v_mov_b32 v98, -1
v_mov_b32 v99, -1
s_load_dwordx2 s[60:61], s[0:1], 8
s_waitcnt lgkmcnt(0)
s_mov_b32 s16, s60
s_mov_b32 s17, s61
s_mov_b32 s18, 0x4000
s_mov_b32 s19, 0x00020000
v_lshlrev_b32 v167, 11, v164
v_lshl_add_u32 v167, v161, 4, v167
v_lshl_add_u32 v167, v165, 3, v167
s_lshl_b32 s30, s21, 6
buffer_load_dwordx2 v[64:65], v167, s[16:19], s30 offen
s_waitcnt vmcnt(0)
buffer_store_dwordx2 v[64:65], v152, s[8:11], 0 offen
v_mov_b32 v72, 0
s_cmp_lg_u32 s22, 0
s_cbranch_scc1 .Lnopr_87
s_mov_b32 s36, -1
s_mov_b32 s37, -1
s_mov_b64 exec, 1
s_mov_b32 s30, 101711872
s_memtime s[60:61]
s_waitcnt lgkmcnt(0)
buffer_store_dword v72, v72, s[12:15], s30 offen sc1
s_waitcnt vmcnt(0)
s_memtime s[62:63]
s_waitcnt lgkmcnt(0)
s_sub_u32 s60, s62, s60
s_min_u32 s36, s36, s60
s_mov_b32 s30, 101720064
s_memtime s[60:61]
s_waitcnt lgkmcnt(0)
buffer_store_dword v72, v72, s[12:15], s30 offen sc1
s_waitcnt vmcnt(0)
s_memtime s[62:63]
s_waitcnt lgkmcnt(0)
s_sub_u32 s60, s62, s60
s_min_u32 s37, s37, s60
s_mov_b32 s30, 101712896
s_memtime s[60:61]
s_waitcnt lgkmcnt(0)
buffer_store_dword v72, v72, s[12:15], s30 offen sc1
s_waitcnt vmcnt(0)
s_memtime s[62:63]
s_waitcnt lgkmcnt(0)
s_sub_u32 s60, s62, s60
s_min_u32 s36, s36, s60
s_mov_b32 s30, 101721088
s_memtime s[60:61]
s_waitcnt lgkmcnt(0)
buffer_store_dword v72, v72, s[12:15], s30 offen sc1
s_waitcnt vmcnt(0)
s_memtime s[62:63]
s_waitcnt lgkmcnt(0)
s_sub_u32 s60, s62, s60
s_min_u32 s37, s37, s60
s_mov_b32 s30, 101711872
s_memtime s[60:61]
s_waitcnt lgkmcnt(0)
buffer_store_dword v72, v72, s[12:15], s30 offen sc1
s_waitcnt vmcnt(0)
s_memtime s[62:63]
s_waitcnt lgkmcnt(0)
s_sub_u32 s60, s62, s60
s_min_u32 s36, s36, s60
s_mov_b32 s30, 101720064
s_memtime s[60:61]
s_waitcnt lgkmcnt(0)
buffer_store_dword v72, v72, s[12:15], s30 offen sc1
s_waitcnt vmcnt(0)
s_memtime s[62:63]
s_waitcnt lgkmcnt(0)
s_sub_u32 s60, s62, s60
s_min_u32 s37, s37, s60
s_mov_b32 s30, 101712896
s_memtime s[60:61]
s_waitcnt lgkmcnt(0)
buffer_store_dword v72, v72, s[12:15], s30 offen sc1
s_waitcnt vmcnt(0)
s_memtime s[62:63]
s_waitcnt lgkmcnt(0)
s_sub_u32 s60, s62, s60
s_min_u32 s36, s36, s60
s_mov_b32 s30, 101721088
s_memtime s[60:61]
s_waitcnt lgkmcnt(0)
buffer_store_dword v72, v72, s[12:15], s30 offen sc1
s_waitcnt vmcnt(0)
s_memtime s[62:63]
s_waitcnt lgkmcnt(0)
s_sub_u32 s60, s62, s60
s_min_u32 s37, s37, s60
s_mov_b32 s30, 101711872
s_memtime s[60:61]
s_waitcnt lgkmcnt(0)
buffer_store_dword v72, v72, s[12:15], s30 offen sc1
s_waitcnt vmcnt(0)
s_memtime s[62:63]
s_waitcnt lgkmcnt(0)
s_sub_u32 s60, s62, s60
s_min_u32 s36, s36, s60
s_mov_b32 s30, 101720064
s_memtime s[60:61]
s_waitcnt lgkmcnt(0)
buffer_store_dword v72, v72, s[12:15], s30 offen sc1
s_waitcnt vmcnt(0)
s_memtime s[62:63]
s_waitcnt lgkmcnt(0)
s_sub_u32 s60, s62, s60
s_min_u32 s37, s37, s60
s_mov_b32 s30, 101712896
s_memtime s[60:61]
s_waitcnt lgkmcnt(0)
buffer_store_dword v72, v72, s[12:15], s30 offen sc1
s_waitcnt vmcnt(0)
s_memtime s[62:63]
s_waitcnt lgkmcnt(0)
s_sub_u32 s60, s62, s60
s_min_u32 s36, s36, s60
s_mov_b32 s30, 101721088
s_memtime s[60:61]
s_waitcnt lgkmcnt(0)
buffer_store_dword v72, v72, s[12:15], s30 offen sc1
s_waitcnt vmcnt(0)
s_memtime s[62:63]
s_waitcnt lgkmcnt(0)
s_sub_u32 s60, s62, s60
s_min_u32 s37, s37, s60
s_cmp_lt_u32 s37, s36
s_cselect_b32 s36, 2, 1
v_mov_b32 v73, s36
s_mov_b32 s30, 2098560
buffer_store_dword v73, v72, s[8:11], s30 offen sc1
s_mov_b64 exec, -1
.Lnopr_87:
v_mov_b32 v72, 0
s_mov_b32 s30, 2098560
.Lpp_88:
buffer_load_dword v73, v72, s[8:11], s30 offen sc1
s_waitcnt vmcnt(0)
v_cmp_eq_u32 vcc, 0, v73
s_cbranch_vccz .Lpk_89
s_cmp_eq_u32 s27, 0
s_cbranch_scc1 .Lpk_89
s_sub_u32 s27, s27, 1
s_branch .Lpp_88
.Lpk_89:
v_readfirstlane_b32 s30, v73
s_cmp_eq_u32 s30, 2
s_cselect_b32 s30, 8192, 0
s_lshr_b32 s31, s21, 1
s_lshl_b32 s31, s31, 14
s_add_u32 s30, s30, s31
s_and_b32 s31, s21, 1
s_lshl_b32 s31, s31, 12
s_add_u32 s30, s30, s31
s_lshl_b32 s31, s20, 10
s_add_u32 s30, s30, s31
s_add_u32 s30, s30, 100663296
v_lshlrev_b32 v155, 4, v0
v_add_u32 v155, s30, v155
v_xor_b32 v225, 1024, v155
v_xor_b32 v226, 2048, v155
v_xor_b32 v227, 3072, v155
s_barrier
.Lw2_90:
buffer_load_dwordx4 v[8:11], v240, s[8:11], s24 offen sc1
buffer_load_dwordx4 v[12:15], v241, s[8:11], s24 offen sc1
buffer_load_dwordx4 v[16:19], v242, s[8:11], s24 offen sc1
buffer_load_dwordx4 v[20:23], v243, s[8:11], s24 offen sc1
v_mov_b32 v24, 0
v_mov_b32 v25, 0
v_mov_b32 v26, 0
v_mov_b32 v27, 0
v_mov_b32 v28, 0
v_mov_b32 v29, 0
v_mov_b32 v30, 0
v_mov_b32 v31, 0
v_mov_b32 v32, 0
v_mov_b32 v33, 0
v_mov_b32 v34, 0
v_mov_b32 v35, 0
v_mov_b32 v36, 0
v_mov_b32 v37, 0
v_mov_b32 v38, 0
v_mov_b32 v39, 0
v_mov_b32 v40, 0
v_mov_b32 v41, 0
v_mov_b32 v42, 0
v_mov_b32 v43, 0
v_mov_b32 v44, 0
v_mov_b32 v45, 0
v_mov_b32 v46, 0
v_mov_b32 v47, 0
.Lga_91:
s_waitcnt vmcnt(3)
v_max3_u32 v6, v8, v9, v10
v_max_u32 v6, v6, v11
v_cmp_eq_u32 vcc, -1, v6
s_cbranch_vccnz .Lgr_93
.Lgo_92:
v_smfmac_f32_16x16x64_bf16 v[24:27], v[8:11], a[0:7], v2
v_smfmac_f32_16x16x64_bf16 v[28:31], v[8:11], a[32:39], v2
v_smfmac_f32_16x16x64_bf16 v[32:35], v[8:11], a[64:71], v2
v_smfmac_f32_16x16x64_bf16 v[36:39], v[8:11], a[96:103], v2
.Lga_94:
s_waitcnt vmcnt(2)
v_max3_u32 v6, v12, v13, v14
v_max_u32 v6, v6, v15
v_cmp_eq_u32 vcc, -1, v6
s_cbranch_vccnz .Lgr_96
.Lgo_95:
v_smfmac_f32_16x16x64_bf16 v[24:27], v[12:15], a[8:15], v2
v_smfmac_f32_16x16x64_bf16 v[28:31], v[12:15], a[40:47], v2
v_smfmac_f32_16x16x64_bf16 v[32:35], v[12:15], a[72:79], v2
v_smfmac_f32_16x16x64_bf16 v[36:39], v[12:15], a[104:111], v2
.Lga_97:
s_waitcnt vmcnt(1)
v_max3_u32 v6, v16, v17, v18
v_max_u32 v6, v6, v19
v_cmp_eq_u32 vcc, -1, v6
s_cbranch_vccnz .Lgr_99
.Lgo_98:
v_smfmac_f32_16x16x64_bf16 v[24:27], v[16:19], a[16:23], v2
v_smfmac_f32_16x16x64_bf16 v[28:31], v[16:19], a[48:55], v2
v_smfmac_f32_16x16x64_bf16 v[32:35], v[16:19], a[80:87], v2
v_smfmac_f32_16x16x64_bf16 v[36:39], v[16:19], a[112:119], v2
.Lga_100:
s_waitcnt vmcnt(0)
v_max3_u32 v6, v20, v21, v22
v_max_u32 v6, v6, v23
v_cmp_eq_u32 vcc, -1, v6
s_cbranch_vccnz .Lgr_102
.Lgo_101:
v_smfmac_f32_16x16x64_bf16 v[24:27], v[20:23], a[24:31], v2
v_smfmac_f32_16x16x64_bf16 v[28:31], v[20:23], a[56:63], v2
v_smfmac_f32_16x16x64_bf16 v[32:35], v[20:23], a[88:95], v2
v_smfmac_f32_16x16x64_bf16 v[36:39], v[20:23], a[120:127], v2
s_nop 5
v_permlane32_swap_b32 v24, v28
v_permlane32_swap_b32 v25, v29
v_permlane32_swap_b32 v26, v30
v_permlane32_swap_b32 v27, v31
v_add_f32 v24, v24, v28
v_add_f32 v25, v25, v29
v_add_f32 v26, v26, v30
v_add_f32 v27, v27, v31
ds_write_b32 v5, v24 offset:0
ds_write_b32 v5, v25 offset:144
ds_write_b32 v5, v26 offset:288
ds_write_b32 v5, v27 offset:432
v_permlane32_swap_b32 v32, v36
v_permlane32_swap_b32 v33, v37
v_permlane32_swap_b32 v34, v38
v_permlane32_swap_b32 v35, v39
v_add_f32 v32, v32, v36
v_add_f32 v33, v33, v37
v_add_f32 v34, v34, v38
v_add_f32 v35, v35, v39
ds_write_b32 v5, v32 offset:4608
ds_write_b32 v5, v33 offset:4752
ds_write_b32 v5, v34 offset:4896
ds_write_b32 v5, v35 offset:5040
s_waitcnt lgkmcnt(0)
s_barrier
v_smfmac_f32_16x16x64_bf16 v[40:43], v[8:11], a[128:135], v2
v_smfmac_f32_16x16x64_bf16 v[44:47], v[8:11], a[160:167], v2
v_smfmac_f32_16x16x64_bf16 v[40:43], v[12:15], a[136:143], v2
v_smfmac_f32_16x16x64_bf16 v[44:47], v[12:15], a[168:175], v2
v_smfmac_f32_16x16x64_bf16 v[40:43], v[16:19], a[144:151], v2
v_smfmac_f32_16x16x64_bf16 v[44:47], v[16:19], a[176:183], v2
v_smfmac_f32_16x16x64_bf16 v[40:43], v[20:23], a[152:159], v2
v_smfmac_f32_16x16x64_bf16 v[44:47], v[20:23], a[184:191], v2
s_nop 7
v_permlane32_swap_b32 v40, v44
v_permlane32_swap_b32 v41, v45
v_permlane32_swap_b32 v42, v46
v_permlane32_swap_b32 v43, v47
v_add_f32 v40, v40, v44
v_add_f32 v41, v41, v45
v_add_f32 v42, v42, v46
v_add_f32 v43, v43, v47
ds_write_b32 v5, v40 offset:9216
ds_write_b32 v5, v41 offset:9360
ds_write_b32 v5, v42 offset:9504
ds_write_b32 v5, v43 offset:9648
s_cmp_eq_u32 s23, 63
s_cbranch_scc1 .Ldone_23
s_waitcnt lgkmcnt(0)
s_barrier
s_barrier
buffer_load_dwordx4 v[8:11], v244, s[8:11], s24 offen sc1
buffer_load_dwordx4 v[12:15], v245, s[8:11], s24 offen sc1
buffer_load_dwordx4 v[16:19], v246, s[8:11], s24 offen sc1
buffer_load_dwordx4 v[20:23], v247, s[8:11], s24 offen sc1
v_mov_b32 v24, 0
v_mov_b32 v25, 0
v_mov_b32 v26, 0
v_mov_b32 v27, 0
v_mov_b32 v28, 0
v_mov_b32 v29, 0
v_mov_b32 v30, 0
v_mov_b32 v31, 0
.Lga_103:
s_waitcnt vmcnt(3)
v_max3_u32 v6, v8, v9, v10
v_max_u32 v6, v6, v11
v_cmp_eq_u32 vcc, -1, v6
s_cbranch_vccnz .Lgr_105
.Lgo_104:
v_smfmac_f32_16x16x64_bf16 v[24:27], v[8:11], a[192:199], v2
v_smfmac_f32_16x16x64_bf16 v[28:31], v[8:11], a[224:231], v2
.Lga_106:
s_waitcnt vmcnt(2)
v_max3_u32 v6, v12, v13, v14
v_max_u32 v6, v6, v15
v_cmp_eq_u32 vcc, -1, v6
s_cbranch_vccnz .Lgr_108
.Lgo_107:
v_smfmac_f32_16x16x64_bf16 v[24:27], v[12:15], a[200:207], v2
v_smfmac_f32_16x16x64_bf16 v[28:31], v[12:15], a[232:239], v2
.Lga_109:
s_waitcnt vmcnt(1)
v_max3_u32 v6, v16, v17, v18
v_max_u32 v6, v6, v19
v_cmp_eq_u32 vcc, -1, v6
s_cbranch_vccnz .Lgr_111
.Lgo_110:
v_smfmac_f32_16x16x64_bf16 v[24:27], v[16:19], a[208:215], v2
v_smfmac_f32_16x16x64_bf16 v[28:31], v[16:19], a[240:247], v2
.Lga_112:
s_waitcnt vmcnt(0)
v_max3_u32 v6, v20, v21, v22
v_max_u32 v6, v6, v23
v_cmp_eq_u32 vcc, -1, v6
s_cbranch_vccnz .Lgr_114
.Lgo_113:
v_smfmac_f32_16x16x64_bf16 v[24:27], v[20:23], a[216:223], v2
v_smfmac_f32_16x16x64_bf16 v[28:31], v[20:23], a[248:255], v2
s_nop 7
v_permlane32_swap_b32 v24, v28
v_permlane32_swap_b32 v25, v29
v_permlane32_swap_b32 v26, v30
v_permlane32_swap_b32 v27, v31
v_add_f32 v24, v24, v28
v_add_f32 v25, v25, v29
v_add_f32 v26, v26, v30
v_add_f32 v27, v27, v31
ds_write_b32 v5, v24 offset:13824
ds_write_b32 v5, v25 offset:13968
ds_write_b32 v5, v26 offset:14112
ds_write_b32 v5, v27 offset:14256
s_waitcnt lgkmcnt(0)
s_barrier
ds_read_b128 v[64:67], v168 offset:13824
ds_read_b128 v[68:71], v168 offset:14976
ds_read_b128 v[72:75], v168 offset:16128
ds_read_b128 v[76:79], v168 offset:17280
s_lshr_b32 s35, s24, 1
s_waitcnt lgkmcnt(2)
v_pk_add_f32 v[64:65], v[64:65], v[68:69]
v_pk_add_f32 v[66:67], v[66:67], v[70:71]
s_waitcnt lgkmcnt(0)
v_pk_add_f32 v[72:73], v[72:73], v[76:77]
v_pk_add_f32 v[74:75], v[74:75], v[78:79]
v_pk_add_f32 v[64:65], v[64:65], v[72:73]
v_pk_add_f32 v[66:67], v[66:67], v[74:75]
buffer_store_dwordx4 v[64:67], v155, s[12:15], s35 offen sc1
s_barrier
s_waitcnt vmcnt(0)
.Lp_115:
buffer_load_dwordx4 v[68:71], v225, s[12:15], s35 offen sc1
buffer_load_dwordx4 v[72:75], v226, s[12:15], s35 offen sc1
buffer_load_dwordx4 v[76:79], v227, s[12:15], s35 offen sc1
s_waitcnt vmcnt(2)
v_pk_add_f32 v[68:69], v[64:65], v[68:69]
v_pk_add_f32 v[70:71], v[66:67], v[70:71]
s_waitcnt vmcnt(0)
v_pk_add_f32 v[72:73], v[72:73], v[76:77]
v_pk_add_f32 v[74:75], v[74:75], v[78:79]
v_pk_add_f32 v[72:73], v[68:69], v[72:73]
v_pk_add_f32 v[74:75], v[70:71], v[74:75]
v_cmp_u_f32 s[60:61], v72, v73
v_cmp_u_f32 vcc, v74, v75
v_cvt_pk_bf16_f32 v68, v72, v73
v_cvt_pk_bf16_f32 v69, v74, v75
s_or_b64 vcc, vcc, s[60:61]
s_cbranch_vccz .Lpo_116
s_cmp_eq_u32 s27, 0
s_cbranch_scc1 .Lpo_116
s_sub_u32 s27, s27, 1
s_branch .Lp_115
.Lpo_116:
buffer_store_dwordx2 v[68:69], v152, s[8:11], s25 offen
s_waitcnt vmcnt(0)
s_barrier
s_add_u32 s23, s23, 1
s_mov_b32 s24, s25
s_mov_b32 s25, s26
s_add_u32 s26, s26, 524288
s_and_b32 s26, s26, 2097151
s_branch .Lw2_90
.Lgr_93:
s_cmp_eq_u32 s27, 0
s_cbranch_scc1 .Lgo_92
s_sub_u32 s27, s27, 1
buffer_load_dwordx4 v[8:11], v240, s[8:11], s24 offen sc1
buffer_load_dwordx4 v[12:15], v241, s[8:11], s24 offen sc1
buffer_load_dwordx4 v[16:19], v242, s[8:11], s24 offen sc1
buffer_load_dwordx4 v[20:23], v243, s[8:11], s24 offen sc1
s_branch .Lga_91
.Lgr_96:
s_cmp_eq_u32 s27, 0
s_cbranch_scc1 .Lgo_95
s_sub_u32 s27, s27, 1
buffer_load_dwordx4 v[12:15], v241, s[8:11], s24 offen sc1
buffer_load_dwordx4 v[16:19], v242, s[8:11], s24 offen sc1
buffer_load_dwordx4 v[20:23], v243, s[8:11], s24 offen sc1
s_branch .Lga_94
.Lgr_99:
s_cmp_eq_u32 s27, 0
s_cbranch_scc1 .Lgo_98
s_sub_u32 s27, s27, 1
buffer_load_dwordx4 v[16:19], v242, s[8:11], s24 offen sc1
buffer_load_dwordx4 v[20:23], v243, s[8:11], s24 offen sc1
s_branch .Lga_97
.Lgr_102:
s_cmp_eq_u32 s27, 0
s_cbranch_scc1 .Lgo_101
s_sub_u32 s27, s27, 1
buffer_load_dwordx4 v[20:23], v243, s[8:11], s24 offen sc1
s_branch .Lga_100
.Lgr_105:
s_cmp_eq_u32 s27, 0
s_cbranch_scc1 .Lgo_104
s_sub_u32 s27, s27, 1
buffer_load_dwordx4 v[8:11], v244, s[8:11], s24 offen sc1
buffer_load_dwordx4 v[12:15], v245, s[8:11], s24 offen sc1
buffer_load_dwordx4 v[16:19], v246, s[8:11], s24 offen sc1
buffer_load_dwordx4 v[20:23], v247, s[8:11], s24 offen sc1
s_branch .Lga_103
.Lgr_108:
s_cmp_eq_u32 s27, 0
s_cbranch_scc1 .Lgo_107
s_sub_u32 s27, s27, 1
buffer_load_dwordx4 v[12:15], v245, s[8:11], s24 offen sc1
buffer_load_dwordx4 v[16:19], v246, s[8:11], s24 offen sc1
buffer_load_dwordx4 v[20:23], v247, s[8:11], s24 offen sc1
s_branch .Lga_106
.Lgr_111:
s_cmp_eq_u32 s27, 0
s_cbranch_scc1 .Lgo_110
s_sub_u32 s27, s27, 1
buffer_load_dwordx4 v[16:19], v246, s[8:11], s24 offen sc1
buffer_load_dwordx4 v[20:23], v247, s[8:11], s24 offen sc1
s_branch .Lga_109
.Lgr_114:
s_cmp_eq_u32 s27, 0
s_cbranch_scc1 .Lgo_113
s_sub_u32 s27, s27, 1
buffer_load_dwordx4 v[20:23], v247, s[8:11], s24 offen sc1
s_branch .Lga_112
.Lwv_27:
v_and_b32 v160, 15, v0
v_lshrrev_b32 v161, 4, v0
v_bfe_u32 v162, v0, 5, 1
v_bfe_u32 v163, v0, 4, 1
v_bfe_u32 v164, v0, 1, 3
v_and_b32 v165, 1, v0
v_lshlrev_b32 v152, 4, v0
v_mov_b32 v64, 0
v_mov_b32 v65, 0
v_mov_b32 v66, 0
v_mov_b32 v67, 0
s_add_u32 s60, s12, s28
s_addc_u32 s61, s13, 0
s_add_u32 s60, s60, 524288
s_addc_u32 s61, s61, 0
s_add_u32 s62, s60, 16777216
s_addc_u32 s63, s61, 0
s_mov_b32 s31, 0
s_lshl_b32 s31, s31, 2
s_add_u32 s31, s31, s20
s_lshl_b32 s31, s31, 7
s_add_u32 s31, s31, 2099200
v_mov_b32 v69, 0
.Lkw_117:
buffer_load_dword v68, v69, s[8:11], s31 offen sc1
s_waitcnt vmcnt(0)
v_readfirstlane_b32 s30, v68
s_cmp_ge_u32 s30, 32
s_cbranch_scc1 .Lko_118
s_cmp_eq_u32 s27, 0
s_cbranch_scc1 .Lko_118
s_sub_u32 s27, s27, 1
s_branch .Lkw_117
.Lko_118:
s_mov_b32 s33, 20480
s_mov_b32 m0, s33
s_add_u32 s30, s28, 16777216
buffer_load_dwordx4 v152, s[12:15], s28 offen sc1 lds
buffer_load_dwordx4 v152, s[12:15], s28 offen offset:1024 sc1 lds
s_add_u32 m0, s33, 2048
s_xor_b32 s33, s33, 12288
buffer_load_dwordx4 v152, s[12:15], s30 offen sc1 lds
buffer_load_dwordx4 v152, s[12:15], s30 offen offset:1024 sc1 lds
s_add_u32 s28, s28, 262144
s_mov_b32 m0, s33
s_add_u32 s30, s28, 16777216
buffer_load_dwordx4 v152, s[12:15], s28 offen sc1 lds
buffer_load_dwordx4 v152, s[12:15], s28 offen offset:1024 sc1 lds
s_add_u32 m0, s33, 2048
s_xor_b32 s33, s33, 12288
buffer_load_dwordx4 v152, s[12:15], s30 offen sc1 lds
buffer_load_dwordx4 v152, s[12:15], s30 offen offset:1024 sc1 lds
s_add_u32 s28, s28, 262144
s_waitcnt vmcnt(0)
s_barrier
.Lw3_119:
buffer_load_dwordx4 v[8:11], v240, s[8:11], s24 offen sc1
buffer_load_dwordx4 v[12:15], v241, s[8:11], s24 offen sc1
buffer_load_dwordx4 v[16:19], v242, s[8:11], s24 offen sc1
buffer_load_dwordx4 v[20:23], v243, s[8:11], s24 offen sc1
v_mov_b32 v24, 0
v_mov_b32 v25, 0
v_mov_b32 v26, 0
v_mov_b32 v27, 0
v_mov_b32 v28, 0
v_mov_b32 v29, 0
v_mov_b32 v30, 0
v_mov_b32 v31, 0
v_mov_b32 v32, 0
v_mov_b32 v33, 0
v_mov_b32 v34, 0
v_mov_b32 v35, 0
v_mov_b32 v36, 0
v_mov_b32 v37, 0
v_mov_b32 v38, 0
v_mov_b32 v39, 0
v_mov_b32 v40, 0
v_mov_b32 v41, 0
v_mov_b32 v42, 0
v_mov_b32 v43, 0
v_mov_b32 v44, 0
v_mov_b32 v45, 0
v_mov_b32 v46, 0
v_mov_b32 v47, 0
.Lga_120:
s_waitcnt vmcnt(3)
v_max3_u32 v6, v8, v9, v10
v_max_u32 v6, v6, v11
v_cmp_eq_u32 vcc, -1, v6
s_cbranch_vccnz .Lgr_122
.Lgo_121:
v_smfmac_f32_16x16x64_bf16 v[24:27], v[8:11], a[0:7], v2
v_smfmac_f32_16x16x64_bf16 v[28:31], v[8:11], a[32:39], v2
v_smfmac_f32_16x16x64_bf16 v[32:35], v[8:11], a[64:71], v2
v_smfmac_f32_16x16x64_bf16 v[36:39], v[8:11], a[96:103], v2
.Lga_123:
s_waitcnt vmcnt(2)
v_max3_u32 v6, v12, v13, v14
v_max_u32 v6, v6, v15
v_cmp_eq_u32 vcc, -1, v6
s_cbranch_vccnz .Lgr_125
.Lgo_124:
v_smfmac_f32_16x16x64_bf16 v[24:27], v[12:15], a[8:15], v2
v_smfmac_f32_16x16x64_bf16 v[28:31], v[12:15], a[40:47], v2
v_smfmac_f32_16x16x64_bf16 v[32:35], v[12:15], a[72:79], v2
v_smfmac_f32_16x16x64_bf16 v[36:39], v[12:15], a[104:111], v2
.Lga_126:
s_waitcnt vmcnt(1)
v_max3_u32 v6, v16, v17, v18
v_max_u32 v6, v6, v19
v_cmp_eq_u32 vcc, -1, v6
s_cbranch_vccnz .Lgr_128
.Lgo_127:
v_smfmac_f32_16x16x64_bf16 v[24:27], v[16:19], a[16:23], v2
v_smfmac_f32_16x16x64_bf16 v[28:31], v[16:19], a[48:55], v2
v_smfmac_f32_16x16x64_bf16 v[32:35], v[16:19], a[80:87], v2
v_smfmac_f32_16x16x64_bf16 v[36:39], v[16:19], a[112:119], v2
.Lga_129:
s_waitcnt vmcnt(0)
v_max3_u32 v6, v20, v21, v22
v_max_u32 v6, v6, v23
v_cmp_eq_u32 vcc, -1, v6
s_cbranch_vccnz .Lgr_131
.Lgo_130:
v_smfmac_f32_16x16x64_bf16 v[24:27], v[20:23], a[24:31], v2
v_smfmac_f32_16x16x64_bf16 v[28:31], v[20:23], a[56:63], v2
v_smfmac_f32_16x16x64_bf16 v[32:35], v[20:23], a[88:95], v2
v_smfmac_f32_16x16x64_bf16 v[36:39], v[20:23], a[120:127], v2
s_nop 5
v_permlane32_swap_b32 v24, v28
v_permlane32_swap_b32 v25, v29
v_permlane32_swap_b32 v26, v30
v_permlane32_swap_b32 v27, v31
v_add_f32 v24, v24, v28
v_add_f32 v25, v25, v29
v_add_f32 v26, v26, v30
v_add_f32 v27, v27, v31
ds_write_b32 v5, v24 offset:0
ds_write_b32 v5, v25 offset:144
ds_write_b32 v5, v26 offset:288
ds_write_b32 v5, v27 offset:432
v_permlane32_swap_b32 v32, v36
v_permlane32_swap_b32 v33, v37
v_permlane32_swap_b32 v34, v38
v_permlane32_swap_b32 v35, v39
v_add_f32 v32, v32, v36
v_add_f32 v33, v33, v37
v_add_f32 v34, v34, v38
v_add_f32 v35, v35, v39
ds_write_b32 v5, v32 offset:4608
ds_write_b32 v5, v33 offset:4752
ds_write_b32 v5, v34 offset:4896
ds_write_b32 v5, v35 offset:5040
s_waitcnt lgkmcnt(0)
s_barrier
v_smfmac_f32_16x16x64_bf16 v[40:43], v[8:11], a[128:135], v2
v_smfmac_f32_16x16x64_bf16 v[44:47], v[8:11], a[160:167], v2
v_smfmac_f32_16x16x64_bf16 v[40:43], v[12:15], a[136:143], v2
v_smfmac_f32_16x16x64_bf16 v[44:47], v[12:15], a[168:175], v2
v_smfmac_f32_16x16x64_bf16 v[40:43], v[16:19], a[144:151], v2
v_smfmac_f32_16x16x64_bf16 v[44:47], v[16:19], a[176:183], v2
v_smfmac_f32_16x16x64_bf16 v[40:43], v[20:23], a[152:159], v2
v_smfmac_f32_16x16x64_bf16 v[44:47], v[20:23], a[184:191], v2
s_nop 7
v_permlane32_swap_b32 v40, v44
v_permlane32_swap_b32 v41, v45
v_permlane32_swap_b32 v42, v46
v_permlane32_swap_b32 v43, v47
v_add_f32 v40, v40, v44
v_add_f32 v41, v41, v45
v_add_f32 v42, v42, v46
v_add_f32 v43, v43, v47
ds_write_b32 v5, v40 offset:9216
ds_write_b32 v5, v41 offset:9360
ds_write_b32 v5, v42 offset:9504
ds_write_b32 v5, v43 offset:9648
s_cmp_eq_u32 s23, 63
s_cbranch_scc1 .Ldone_23
s_waitcnt lgkmcnt(0)
s_barrier
s_barrier
buffer_load_dwordx4 v[8:11], v244, s[8:11], s24 offen sc1
buffer_load_dwordx4 v[12:15], v245, s[8:11], s24 offen sc1
buffer_load_dwordx4 v[16:19], v246, s[8:11], s24 offen sc1
buffer_load_dwordx4 v[20:23], v247, s[8:11], s24 offen sc1
v_mov_b32 v24, 0
v_mov_b32 v25, 0
v_mov_b32 v26, 0
v_mov_b32 v27, 0
v_mov_b32 v28, 0
v_mov_b32 v29, 0
v_mov_b32 v30, 0
v_mov_b32 v31, 0
.Lga_132:
s_waitcnt vmcnt(3)
v_max3_u32 v6, v8, v9, v10
v_max_u32 v6, v6, v11
v_cmp_eq_u32 vcc, -1, v6
s_cbranch_vccnz .Lgr_134
.Lgo_133:
v_smfmac_f32_16x16x64_bf16 v[24:27], v[8:11], a[192:199], v2
v_smfmac_f32_16x16x64_bf16 v[28:31], v[8:11], a[224:231], v2
.Lga_135:
s_waitcnt vmcnt(2)
v_max3_u32 v6, v12, v13, v14
v_max_u32 v6, v6, v15
v_cmp_eq_u32 vcc, -1, v6
s_cbranch_vccnz .Lgr_137
.Lgo_136:
v_smfmac_f32_16x16x64_bf16 v[24:27], v[12:15], a[200:207], v2
v_smfmac_f32_16x16x64_bf16 v[28:31], v[12:15], a[232:239], v2
.Lga_138:
s_waitcnt vmcnt(1)
v_max3_u32 v6, v16, v17, v18
v_max_u32 v6, v6, v19
v_cmp_eq_u32 vcc, -1, v6
s_cbranch_vccnz .Lgr_140
.Lgo_139:
v_smfmac_f32_16x16x64_bf16 v[24:27], v[16:19], a[208:215], v2
v_smfmac_f32_16x16x64_bf16 v[28:31], v[16:19], a[240:247], v2
.Lga_141:
s_waitcnt vmcnt(0)
v_max3_u32 v6, v20, v21, v22
v_max_u32 v6, v6, v23
v_cmp_eq_u32 vcc, -1, v6
s_cbranch_vccnz .Lgr_143
.Lgo_142:
v_smfmac_f32_16x16x64_bf16 v[24:27], v[20:23], a[216:223], v2
v_smfmac_f32_16x16x64_bf16 v[28:31], v[20:23], a[248:255], v2
s_nop 7
v_permlane32_swap_b32 v24, v28
v_permlane32_swap_b32 v25, v29
v_permlane32_swap_b32 v26, v30
v_permlane32_swap_b32 v27, v31
v_add_f32 v24, v24, v28
v_add_f32 v25, v25, v29
v_add_f32 v26, v26, v30
v_add_f32 v27, v27, v31
ds_write_b32 v5, v24 offset:13824
ds_write_b32 v5, v25 offset:13968
ds_write_b32 v5, v26 offset:14112
ds_write_b32 v5, v27 offset:14256
s_waitcnt lgkmcnt(0)
s_barrier
s_barrier
s_and_b32 s30, s23, 7
s_cmp_eq_u32 s30, 6
s_cbranch_scc1 .Lkvw_144
.Lkvb_145:
s_mov_b32 m0, s33
s_add_u32 s30, s28, 16777216
buffer_load_dwordx4 v152, s[12:15], s28 offen sc1 lds
buffer_load_dwordx4 v152, s[12:15], s28 offen offset:1024 sc1 lds
s_add_u32 m0, s33, 2048
s_xor_b32 s33, s33, 12288
buffer_load_dwordx4 v152, s[12:15], s30 offen sc1 lds
buffer_load_dwordx4 v152, s[12:15], s30 offen offset:1024 sc1 lds
s_add_u32 s28, s28, 262144
s_barrier
s_add_u32 s23, s23, 1
s_mov_b32 s24, s25
s_mov_b32 s25, s26
s_add_u32 s26, s26, 524288
s_and_b32 s26, s26, 2097151
s_branch .Lw3_119
.Lgr_122:
s_cmp_eq_u32 s27, 0
s_cbranch_scc1 .Lgo_121
s_sub_u32 s27, s27, 1
buffer_load_dwordx4 v[8:11], v240, s[8:11], s24 offen sc1
buffer_load_dwordx4 v[12:15], v241, s[8:11], s24 offen sc1
buffer_load_dwordx4 v[16:19], v242, s[8:11], s24 offen sc1
buffer_load_dwordx4 v[20:23], v243, s[8:11], s24 offen sc1
s_branch .Lga_120
.Lgr_125:
s_cmp_eq_u32 s27, 0
s_cbranch_scc1 .Lgo_124
s_sub_u32 s27, s27, 1
buffer_load_dwordx4 v[12:15], v241, s[8:11], s24 offen sc1
buffer_load_dwordx4 v[16:19], v242, s[8:11], s24 offen sc1
buffer_load_dwordx4 v[20:23], v243, s[8:11], s24 offen sc1
s_branch .Lga_123
.Lgr_128:
s_cmp_eq_u32 s27, 0
s_cbranch_scc1 .Lgo_127
s_sub_u32 s27, s27, 1
buffer_load_dwordx4 v[16:19], v242, s[8:11], s24 offen sc1
buffer_load_dwordx4 v[20:23], v243, s[8:11], s24 offen sc1
s_branch .Lga_126
.Lgr_131:
s_cmp_eq_u32 s27, 0
s_cbranch_scc1 .Lgo_130
s_sub_u32 s27, s27, 1
buffer_load_dwordx4 v[20:23], v243, s[8:11], s24 offen sc1
s_branch .Lga_129
.Lgr_134:
s_cmp_eq_u32 s27, 0
s_cbranch_scc1 .Lgo_133
s_sub_u32 s27, s27, 1
buffer_load_dwordx4 v[8:11], v244, s[8:11], s24 offen sc1
buffer_load_dwordx4 v[12:15], v245, s[8:11], s24 offen sc1
buffer_load_dwordx4 v[16:19], v246, s[8:11], s24 offen sc1
buffer_load_dwordx4 v[20:23], v247, s[8:11], s24 offen sc1
s_branch .Lga_132
.Lgr_137:
s_cmp_eq_u32 s27, 0
s_cbranch_scc1 .Lgo_136
s_sub_u32 s27, s27, 1
buffer_load_dwordx4 v[12:15], v245, s[8:11], s24 offen sc1
buffer_load_dwordx4 v[16:19], v246, s[8:11], s24 offen sc1
buffer_load_dwordx4 v[20:23], v247, s[8:11], s24 offen sc1
s_branch .Lga_135
.Lgr_140:
s_cmp_eq_u32 s27, 0
s_cbranch_scc1 .Lgo_139
s_sub_u32 s27, s27, 1
buffer_load_dwordx4 v[16:19], v246, s[8:11], s24 offen sc1
buffer_load_dwordx4 v[20:23], v247, s[8:11], s24 offen sc1
s_branch .Lga_138
.Lgr_143:
s_cmp_eq_u32 s27, 0
s_cbranch_scc1 .Lgo_142
s_sub_u32 s27, s27, 1
buffer_load_dwordx4 v[20:23], v247, s[8:11], s24 offen sc1
s_branch .Lga_141
.Lkvw_144:
s_cmp_eq_u32 s23, 62
s_cbranch_scc1 .Lkvb_145
s_add_u32 s31, s23, 2
s_lshr_b32 s31, s31, 3
s_cmp_lt_u32 s31, 3
s_cselect_b32 s60, 16, 8
s_lshl_b32 s31, s31, 2
s_add_u32 s31, s31, s20
s_lshl_b32 s31, s31, 7
s_add_u32 s31, s31, 2099200
v_mov_b32 v69, 0
.Lkw_146:
buffer_load_dword v68, v69, s[8:11], s31 offen sc1
s_waitcnt vmcnt(0)
v_readfirstlane_b32 s30, v68
s_cmp_ge_u32 s30, s60
s_cbranch_scc1 .Lko_147
s_cmp_eq_u32 s27, 0
s_cbranch_scc1 .Lko_147
s_sub_u32 s27, s27, 1
s_branch .Lkw_146
.Lko_147:
s_branch .Lkvb_145
.Ldone_23:
s_waitcnt lgkmcnt(0)
s_barrier
.Ldone_232:
s_branch .Lfin_21
.Lsafe_22:
s_cmp_eq_u32 s3, 1
s_cbranch_scc1 .Lwv_150
s_cmp_eq_u32 s3, 2
s_cbranch_scc1 .Lwv_151
s_cmp_eq_u32 s3, 3
s_cbranch_scc1 .Lwv_152
v_and_b32 v160, 15, v0
v_lshrrev_b32 v161, 4, v0
v_bfe_u32 v162, v0, 5, 1
v_bfe_u32 v163, v0, 4, 1
v_and_b32 v164, 7, v0
v_mul_u32_u24 v152, 144, v164
v_bfe_u32 v164, v0, 3, 1
v_mul_u32_u24 v164, 4608, v164
v_add_u32 v152, v152, v164
v_lshl_add_u32 v152, v162, 6, v152
v_lshl_add_u32 v152, v163, 4, v152
v_and_b32 v164, 7, v0
v_and_b32 v165, 8, v0
v_lshl_add_u32 v153, v165, 1, v164
v_lshl_add_u32 v153, v163, 5, v153
v_lshlrev_b32 v153, 4, v153
v_lshl_add_u32 v153, v162, 10, v153
v_lshl_add_u32 v154, v163, 5, v160
v_lshlrev_b32 v154, 4, v154
v_lshl_add_u32 v154, v162, 10, v154
s_mul_i32 s30, s22, 1280
s_add_u32 s30, s30, 131072
s_and_b32 s31, s22, 0x7c
s_mul_i32 s31, s31, 1280
s_add_u32 s31, s31, 131072
v_lshlrev_b32 v166, 4, v164
v_lshl_add_u32 v167, v161, 7, v166
v_add_u32 v155, s30, v167
v_add_u32 v156, 768, v155
v_mov_b32 v168, 1073741824
v_cmp_ne_u32 vcc, 0, v165
s_nop 1
v_cndmask_b32 v155, v155, v168, vcc
v_cndmask_b32 v156, v156, v168, vcc
v_cmp_eq_u32 vcc, 0, v162
s_nop 1
v_cndmask_b32 v156, v156, v168, vcc
v_lshl_add_u32 v157, v165, 6, v167
v_add_u32 v157, s31, v157
v_lshl_add_u32 v158, v162, 7, v166
v_lshl_add_u32 v158, v163, 3, v158
v_lshrrev_b32 v169, 1, v165
v_add_u32 v158, v158, v169
v_add_u32 v158, s31, v158
v_add_u32 v158, 1024, v158
v_mul_u32_u24 v224, 288, v161
v_lshl_add_u32 v224, v160, 2, v224
v_add_u32 v224, 9216, v224
v_add_u32 v225, 1152, v224
v_add_u32 v226, 2304, v224
v_add_u32 v227, 3456, v224
s_lshr_b32 s30, s21, 1
s_lshl_b32 s30, s30, 10
s_and_b32 s31, s21, 1
s_lshl_b32 s31, s31, 7
s_add_u32 s30, s30, s31
s_lshl_b32 s31, s20, 14
s_add_u32 s30, s30, s31
s_add_u32 s30, s30, 65536
v_lshl_add_u32 v159, v161, 8, v166
v_add_u32 v159, s30, v159
v_cmp_ne_u32 vcc, 0, v165
s_nop 1
v_cndmask_b32 v159, v159, v168, vcc
v_mov_b32 v129, 0
v_mov_b32 v130, 0
v_mov_b32 v131, 0
v_mov_b32 v133, 0
v_mov_b32 v134, 0
v_mov_b32 v135, 0
v_mov_b32 v141, 0
v_mov_b32 v142, 0
v_mov_b32 v143, 0
s_mov_b32 s34, 0x3fb8aa3b
s_mov_b32 s35, 0x3db504f3
s_barrier
.Lw0_153:
buffer_load_dwordx4 v[8:11], v240, s[8:11], s24 offen sc1
buffer_load_dwordx4 v[12:15], v241, s[8:11], s24 offen sc1
buffer_load_dwordx4 v[16:19], v242, s[8:11], s24 offen sc1
buffer_load_dwordx4 v[20:23], v243, s[8:11], s24 offen sc1
v_mov_b32 v24, 0
v_mov_b32 v25, 0
v_mov_b32 v26, 0
v_mov_b32 v27, 0
v_mov_b32 v28, 0
v_mov_b32 v29, 0
v_mov_b32 v30, 0
v_mov_b32 v31, 0
v_mov_b32 v32, 0
v_mov_b32 v33, 0
v_mov_b32 v34, 0
v_mov_b32 v35, 0
v_mov_b32 v36, 0
v_mov_b32 v37, 0
v_mov_b32 v38, 0
v_mov_b32 v39, 0
v_mov_b32 v40, 0
v_mov_b32 v41, 0
v_mov_b32 v42, 0
v_mov_b32 v43, 0
v_mov_b32 v44, 0
v_mov_b32 v45, 0
v_mov_b32 v46, 0
v_mov_b32 v47, 0
ds_read_b128 v[64:67], v153 offset:20480
ds_read_b128 v[72:75], v154 offset:22528
ds_read_b128 v[68:71], v153 offset:20608
ds_read_b128 v[76:79], v154 offset:22784
.Lga_154:
s_waitcnt vmcnt(3)
v_max3_u32 v6, v8, v9, v10
v_max_u32 v6, v6, v11
v_cmp_eq_u32 vcc, -1, v6
s_cbranch_vccnz .Lgr_156
.Lgo_155:
v_smfmac_f32_16x16x64_bf16 v[24:27], v[8:11], a[0:7], v2
v_smfmac_f32_16x16x64_bf16 v[28:31], v[8:11], a[32:39], v2
v_smfmac_f32_16x16x64_bf16 v[32:35], v[8:11], a[64:71], v2
v_smfmac_f32_16x16x64_bf16 v[36:39], v[8:11], a[96:103], v2
.Lga_157:
s_waitcnt vmcnt(2)
v_max3_u32 v6, v12, v13, v14
v_max_u32 v6, v6, v15
v_cmp_eq_u32 vcc, -1, v6
s_cbranch_vccnz .Lgr_159
.Lgo_158:
v_smfmac_f32_16x16x64_bf16 v[24:27], v[12:15], a[8:15], v2
v_smfmac_f32_16x16x64_bf16 v[28:31], v[12:15], a[40:47], v2
v_smfmac_f32_16x16x64_bf16 v[32:35], v[12:15], a[72:79], v2
v_smfmac_f32_16x16x64_bf16 v[36:39], v[12:15], a[104:111], v2
.Lga_160:
s_waitcnt vmcnt(1)
v_max3_u32 v6, v16, v17, v18
v_max_u32 v6, v6, v19
v_cmp_eq_u32 vcc, -1, v6
s_cbranch_vccnz .Lgr_162
.Lgo_161:
v_smfmac_f32_16x16x64_bf16 v[24:27], v[16:19], a[16:23], v2
v_smfmac_f32_16x16x64_bf16 v[28:31], v[16:19], a[48:55], v2
v_smfmac_f32_16x16x64_bf16 v[32:35], v[16:19], a[80:87], v2
v_smfmac_f32_16x16x64_bf16 v[36:39], v[16:19], a[112:119], v2
.Lga_163:
s_waitcnt vmcnt(0)
v_max3_u32 v6, v20, v21, v22
v_max_u32 v6, v6, v23
v_cmp_eq_u32 vcc, -1, v6
s_cbranch_vccnz .Lgr_165
.Lgo_164:
v_smfmac_f32_16x16x64_bf16 v[24:27], v[20:23], a[24:31], v2
v_smfmac_f32_16x16x64_bf16 v[28:31], v[20:23], a[56:63], v2
v_smfmac_f32_16x16x64_bf16 v[32:35], v[20:23], a[88:95], v2
v_smfmac_f32_16x16x64_bf16 v[36:39], v[20:23], a[120:127], v2
s_nop 5
v_permlane32_swap_b32 v24, v28
v_permlane32_swap_b32 v25, v29
v_permlane32_swap_b32 v26, v30
v_permlane32_swap_b32 v27, v31
v_add_f32 v24, v24, v28
v_add_f32 v25, v25, v29
v_add_f32 v26, v26, v30
v_add_f32 v27, v27, v31
ds_write_b32 v5, v24 offset:0
ds_write_b32 v5, v25 offset:144
ds_write_b32 v5, v26 offset:288
ds_write_b32 v5, v27 offset:432
v_permlane32_swap_b32 v32, v36
v_permlane32_swap_b32 v33, v37
v_permlane32_swap_b32 v34, v38
v_permlane32_swap_b32 v35, v39
v_add_f32 v32, v32, v36
v_add_f32 v33, v33, v37
v_add_f32 v34, v34, v38
v_add_f32 v35, v35, v39
ds_write_b32 v5, v32 offset:4608
ds_write_b32 v5, v33 offset:4752
ds_write_b32 v5, v34 offset:4896
ds_write_b32 v5, v35 offset:5040
s_waitcnt lgkmcnt(0)
s_barrier
ds_read_b128 v[176:179], v152 offset:0
ds_read_b128 v[180:183], v152 offset:32
ds_read_b128 v[184:187], v152 offset:1152
ds_read_b128 v[188:191], v152 offset:1184
ds_read_b128 v[192:195], v152 offset:2304
ds_read_b128 v[196:199], v152 offset:2336
ds_read_b128 v[200:203], v152 offset:3456
ds_read_b128 v[204:207], v152 offset:3488
s_waitcnt lgkmcnt(4)
v_pk_add_f32 v[176:177], v[176:177], v[184:185]
v_pk_add_f32 v[178:179], v[178:179], v[186:187]
v_pk_add_f32 v[180:181], v[180:181], v[188:189]
v_pk_add_f32 v[182:183], v[182:183], v[190:191]
s_waitcnt lgkmcnt(0)
v_pk_add_f32 v[192:193], v[192:193], v[200:201]
v_pk_add_f32 v[194:195], v[194:195], v[202:203]
v_pk_add_f32 v[196:197], v[196:197], v[204:205]
v_pk_add_f32 v[198:199], v[198:199], v[206:207]
v_pk_add_f32 v[176:177], v[176:177], v[192:193]
v_pk_add_f32 v[178:179], v[178:179], v[194:195]
v_pk_add_f32 v[180:181], v[180:181], v[196:197]
v_pk_add_f32 v[182:183], v[182:183], v[198:199]
v_cvt_pk_bf16_f32 v88, v176, v177
v_cvt_pk_bf16_f32 v89, v178, v179
v_cvt_pk_bf16_f32 v90, v180, v181
v_cvt_pk_bf16_f32 v91, v182, v183
s_nop 1
v_mfma_f32_16x16x32_bf16 v[92:95], v[64:67], v[88:91], 0
v_mfma_f32_16x16x32_bf16 v[96:99], v[68:71], v[88:91], 0
v_mfma_f32_16x16x32_bf16 v[100:103], v[88:91], v[88:91], 0
s_cmp_eq_u32 s23, 63
s_cbranch_scc1 .Llast_166
s_nop 3
buffer_store_dwordx4 v[92:95], v155, s[8:11], s24 offen sc1
buffer_store_dwordx4 v[96:99], v155, s[8:11], s24 offen offset:512 sc1
buffer_store_dwordx4 v[100:103], v156, s[8:11], s24 offen sc1
v_smfmac_f32_16x16x64_bf16 v[40:43], v[8:11], a[128:135], v2
v_smfmac_f32_16x16x64_bf16 v[44:47], v[8:11], a[160:167], v2
v_smfmac_f32_16x16x64_bf16 v[40:43], v[12:15], a[136:143], v2
v_smfmac_f32_16x16x64_bf16 v[44:47], v[12:15], a[168:175], v2
v_smfmac_f32_16x16x64_bf16 v[40:43], v[16:19], a[144:151], v2
v_smfmac_f32_16x16x64_bf16 v[44:47], v[16:19], a[176:183], v2
v_smfmac_f32_16x16x64_bf16 v[40:43], v[20:23], a[152:159], v2
v_smfmac_f32_16x16x64_bf16 v[44:47], v[20:23], a[184:191], v2
s_nop 7
v_permlane32_swap_b32 v40, v44
v_permlane32_swap_b32 v41, v45
v_permlane32_swap_b32 v42, v46
v_permlane32_swap_b32 v43, v47
v_add_f32 v40, v40, v44
v_add_f32 v41, v41, v45
v_add_f32 v42, v42, v46
v_add_f32 v43, v43, v47
ds_write_b32 v5, v40 offset:9216
ds_write_b32 v5, v41 offset:9360
ds_write_b32 v5, v42 offset:9504
ds_write_b32 v5, v43 offset:9648
s_waitcnt vmcnt(0)
buffer_load_dwordx4 v[104:107], v157, s[8:11], s24 offen offset:0 sc1
buffer_load_dword v120, v158, s[8:11], s24 offen offset:0 sc1
buffer_load_dwordx4 v[108:111], v157, s[8:11], s24 offen offset:1280 sc1
buffer_load_dword v121, v158, s[8:11], s24 offen offset:1280 sc1
buffer_load_dwordx4 v[112:115], v157, s[8:11], s24 offen offset:2560 sc1
buffer_load_dword v122, v158, s[8:11], s24 offen offset:2560 sc1
buffer_load_dwordx4 v[116:119], v157, s[8:11], s24 offen offset:3840 sc1
buffer_load_dword v123, v158, s[8:11], s24 offen offset:3840 sc1
s_waitcnt lgkmcnt(0)
s_barrier
ds_read2_b32 v[208:209], v224 offset1:36
ds_read2_b32 v[210:211], v224 offset0:16 offset1:52
ds_read2_b32 v[212:213], v225 offset1:36
ds_read2_b32 v[214:215], v225 offset0:16 offset1:52
ds_read2_b32 v[216:217], v226 offset1:36
ds_read2_b32 v[218:219], v226 offset0:16 offset1:52
ds_read2_b32 v[220:221], v227 offset1:36
ds_read2_b32 v[222:223], v227 offset0:16 offset1:52
v_xor_b32 v153, 4096, v153
v_xor_b32 v154, 4096, v154
s_waitcnt lgkmcnt(0)
v_pk_add_f32 v[208:209], v[208:209], v[212:213]
v_pk_add_f32 v[210:211], v[210:211], v[214:215]
v_pk_add_f32 v[216:217], v[216:217], v[220:221]
v_pk_add_f32 v[218:219], v[218:219], v[222:223]
v_pk_add_f32 v[208:209], v[208:209], v[216:217]
v_pk_add_f32 v[210:211], v[210:211], v[218:219]
v_cvt_pk_bf16_f32 v128, v208, v209
v_cvt_pk_bf16_f32 v132, v210, v211
s_branch .Lsc_169
.Ls_167:
buffer_load_dwordx4 v[104:107], v157, s[8:11], s24 offen offset:0 sc1
buffer_load_dword v120, v158, s[8:11], s24 offen offset:0 sc1
buffer_load_dwordx4 v[108:111], v157, s[8:11], s24 offen offset:1280 sc1
buffer_load_dword v121, v158, s[8:11], s24 offen offset:1280 sc1
buffer_load_dwordx4 v[112:115], v157, s[8:11], s24 offen offset:2560 sc1
buffer_load_dword v122, v158, s[8:11], s24 offen offset:2560 sc1
buffer_load_dwordx4 v[116:119], v157, s[8:11], s24 offen offset:3840 sc1
buffer_load_dword v123, v158, s[8:11], s24 offen offset:3840 sc1
.Lsc_169:
s_waitcnt vmcnt(4)
v_pk_add_f32 v[104:105], v[104:105], v[108:109]
v_pk_add_f32 v[106:107], v[106:107], v[110:111]
v_add_f32 v120, v120, v121
s_waitcnt vmcnt(0)
v_pk_add_f32 v[112:113], v[112:113], v[116:117]
v_pk_add_f32 v[114:115], v[114:115], v[118:119]
v_add_f32 v122, v122, v123
v_pk_add_f32 v[104:105], v[104:105], v[112:113]
v_pk_add_f32 v[106:107], v[106:107], v[114:115]
v_add_f32 v108, v120, v122
v_cmp_u_f32 s[60:61], v104, v105
v_cmp_u_f32 s[62:63], v106, v107
v_cmp_u_f32 vcc, v108, v108
v_cvt_pk_bf16_f32 v112, v104, v105
v_cvt_pk_bf16_f32 v113, v106, v107
v_cvt_pk_bf16_f32 v114, v108, v108
s_or_b64 s[60:61], s[60:61], s[62:63]
s_or_b64 vcc, vcc, s[60:61]
s_cbranch_vccz .Lso_168
s_cmp_eq_u32 s27, 0
s_cbranch_scc1 .Lso_168
s_sub_u32 s27, s27, 1
s_branch .Ls_167
.Lso_168:
v_lshlrev_b32 v104, 16, v112
v_and_b32 v105, 0xffff0000, v112
v_lshlrev_b32 v106, 16, v113
v_and_b32 v107, 0xffff0000, v113
v_lshlrev_b32 v108, 16, v114
v_mul_f32 v104, s35, v104
v_mul_f32 v105, s35, v105
v_mul_f32 v106, s35, v106
v_mul_f32 v107, s35, v107
v_mul_f32 v108, s35, v108
v_cvt_pk_bf16_f32 v112, v104, v105
v_cvt_pk_bf16_f32 v113, v106, v107
v_cvt_pk_bf16_f32 v114, v108, v108
v_lshlrev_b32 v104, 16, v112
v_and_b32 v105, 0xffff0000, v112
v_lshlrev_b32 v106, 16, v113
v_and_b32 v107, 0xffff0000, v113
v_lshlrev_b32 v108, 16, v114
v_max3_f32 v112, v104, v105, v106
v_max3_f32 v112, v112, v107, v108
s_nop 1
v_max_f32_dpp v112, v112, v112 row_ror:8 row_mask:0xf bank_mask:0xf
v_mov_b32 v113, v112
s_nop 1
v_permlane16_swap_b32 v112, v113
v_max_f32 v112, v112, v113
v_mov_b32 v113, v112
s_nop 1
v_permlane32_swap_b32 v112, v113
v_max_f32 v112, v112, v113
v_mul_f32 v112, 0xbfb8aa3b, v112
v_fma_f32 v104, v104, s34, v112
v_fma_f32 v105, v105, s34, v112
v_fma_f32 v106, v106, s34, v112
v_fma_f32 v107, v107, s34, v112
v_fma_f32 v108, v108, s34, v112
v_exp_f32 v104, v104
v_exp_f32 v105, v105
v_exp_f32 v106, v106
v_exp_f32 v107, v107
v_exp_f32 v108, v108
v_cvt_pk_bf16_f32 v136, v104, v105
v_cvt_pk_bf16_f32 v137, v106, v107
v_mov_b32_dpp v113, v108 row_ror:8 row_mask:0xf bank_mask:0xf
v_mov_b32_dpp v138, v136 row_ror:8 row_mask:0xf bank_mask:0xf
v_mov_b32_dpp v139, v137 row_ror:8 row_mask:0xf bank_mask:0xf
v_cvt_pk_bf16_f32 v140, v108, v113
v_add_f32 v104, v104, v105
v_add_f32 v106, v106, v107
v_mfma_f32_16x16x32_bf16 v[144:147], v[72:75], v[136:139], 0
v_add_f32 v104, v104, v106
v_add_f32 v112, v104, v108
v_mfma_f32_16x16x32_bf16 v[148:151], v[76:79], v[136:139], 0
s_nop 0
v_add_f32_dpp v112, v112, v112 row_ror:8 row_mask:0xf bank_mask:0xf
v_mfma_f32_16x16x32_bf16 v[144:147], v[128:131], v[140:143], v[144:147]
v_mov_b32 v113, v112
s_nop 1
v_permlane16_swap_b32 v112, v113
v_add_f32 v112, v112, v113
v_mfma_f32_16x16x32_bf16 v[148:151], v[132:135], v[140:143], v[148:151]
v_mov_b32 v113, v112
s_nop 1
v_permlane32_swap_b32 v112, v113
v_add_f32 v112, v112, v113
v_rcp_f32 v112, v112
s_nop 0
v_mul_f32 v144, v144, v112
v_mul_f32 v145, v145, v112
v_mul_f32 v146, v146, v112
v_mul_f32 v147, v147, v112
v_mul_f32 v148, v148, v112
v_mul_f32 v149, v149, v112
v_mul_f32 v150, v150, v112
v_mul_f32 v151, v151, v112
v_cvt_pk_bf16_f32 v104, v144, v145
v_cvt_pk_bf16_f32 v105, v146, v147
v_cvt_pk_bf16_f32 v106, v148, v149
v_cvt_pk_bf16_f32 v107, v150, v151
buffer_store_dwordx4 v[104:107], v159, s[8:11], s24 offen sc1
s_waitcnt vmcnt(0)
s_barrier
buffer_load_dwordx4 v[8:11], v244, s[8:11], s24 offen sc1
buffer_load_dwordx4 v[12:15], v245, s[8:11], s24 offen sc1
buffer_load_dwordx4 v[16:19], v246, s[8:11], s24 offen sc1
buffer_load_dwordx4 v[20:23], v247, s[8:11], s24 offen sc1
v_mov_b32 v24, 0
v_mov_b32 v25, 0
v_mov_b32 v26, 0
v_mov_b32 v27, 0
v_mov_b32 v28, 0
v_mov_b32 v29, 0
v_mov_b32 v30, 0
v_mov_b32 v31, 0
.Lga_170:
s_waitcnt vmcnt(3)
v_max3_u32 v6, v8, v9, v10
v_max_u32 v6, v6, v11
v_cmp_eq_u32 vcc, -1, v6
s_cbranch_vccnz .Lgr_172
.Lgo_171:
v_smfmac_f32_16x16x64_bf16 v[24:27], v[8:11], a[192:199], v2
v_smfmac_f32_16x16x64_bf16 v[28:31], v[8:11], a[224:231], v2
.Lga_173:
s_waitcnt vmcnt(2)
v_max3_u32 v6, v12, v13, v14
v_max_u32 v6, v6, v15
v_cmp_eq_u32 vcc, -1, v6
s_cbranch_vccnz .Lgr_175
.Lgo_174:
v_smfmac_f32_16x16x64_bf16 v[24:27], v[12:15], a[200:207], v2
v_smfmac_f32_16x16x64_bf16 v[28:31], v[12:15], a[232:239], v2
.Lga_176:
s_waitcnt vmcnt(1)
v_max3_u32 v6, v16, v17, v18
v_max_u32 v6, v6, v19
v_cmp_eq_u32 vcc, -1, v6
s_cbranch_vccnz .Lgr_178
.Lgo_177:
v_smfmac_f32_16x16x64_bf16 v[24:27], v[16:19], a[208:215], v2
v_smfmac_f32_16x16x64_bf16 v[28:31], v[16:19], a[240:247], v2
.Lga_179:
s_waitcnt vmcnt(0)
v_max3_u32 v6, v20, v21, v22
v_max_u32 v6, v6, v23
v_cmp_eq_u32 vcc, -1, v6
s_cbranch_vccnz .Lgr_181
.Lgo_180:
v_smfmac_f32_16x16x64_bf16 v[24:27], v[20:23], a[216:223], v2
v_smfmac_f32_16x16x64_bf16 v[28:31], v[20:23], a[248:255], v2
s_nop 7
v_permlane32_swap_b32 v24, v28
v_permlane32_swap_b32 v25, v29
v_permlane32_swap_b32 v26, v30
v_permlane32_swap_b32 v27, v31
v_add_f32 v24, v24, v28
v_add_f32 v25, v25, v29
v_add_f32 v26, v26, v30
v_add_f32 v27, v27, v31
ds_write_b32 v5, v24 offset:13824
ds_write_b32 v5, v25 offset:13968
ds_write_b32 v5, v26 offset:14112
ds_write_b32 v5, v27 offset:14256
s_waitcnt lgkmcnt(0)
s_barrier
s_barrier
s_barrier
s_add_u32 s23, s23, 1
s_mov_b32 s24, s25
s_mov_b32 s25, s26
s_add_u32 s26, s26, 524288
s_and_b32 s26, s26, 2097151
s_branch .Lw0_153
.Lgr_156:
s_cmp_eq_u32 s27, 0
s_cbranch_scc1 .Lgo_155
s_sub_u32 s27, s27, 1
buffer_load_dwordx4 v[8:11], v240, s[8:11], s24 offen sc1
buffer_load_dwordx4 v[12:15], v241, s[8:11], s24 offen sc1
buffer_load_dwordx4 v[16:19], v242, s[8:11], s24 offen sc1
buffer_load_dwordx4 v[20:23], v243, s[8:11], s24 offen sc1
s_branch .Lga_154
.Lgr_159:
s_cmp_eq_u32 s27, 0
s_cbranch_scc1 .Lgo_158
s_sub_u32 s27, s27, 1
buffer_load_dwordx4 v[12:15], v241, s[8:11], s24 offen sc1
buffer_load_dwordx4 v[16:19], v242, s[8:11], s24 offen sc1
buffer_load_dwordx4 v[20:23], v243, s[8:11], s24 offen sc1
s_branch .Lga_157
.Lgr_162:
s_cmp_eq_u32 s27, 0
s_cbranch_scc1 .Lgo_161
s_sub_u32 s27, s27, 1
buffer_load_dwordx4 v[16:19], v242, s[8:11], s24 offen sc1
buffer_load_dwordx4 v[20:23], v243, s[8:11], s24 offen sc1
s_branch .Lga_160
.Lgr_165:
s_cmp_eq_u32 s27, 0
s_cbranch_scc1 .Lgo_164
s_sub_u32 s27, s27, 1
buffer_load_dwordx4 v[20:23], v243, s[8:11], s24 offen sc1
s_branch .Lga_163
.Llast_166:
v_smfmac_f32_16x16x64_bf16 v[40:43], v[8:11], a[128:135], v2
v_smfmac_f32_16x16x64_bf16 v[44:47], v[8:11], a[160:167], v2
v_smfmac_f32_16x16x64_bf16 v[40:43], v[12:15], a[136:143], v2
v_smfmac_f32_16x16x64_bf16 v[44:47], v[12:15], a[168:175], v2
v_smfmac_f32_16x16x64_bf16 v[40:43], v[16:19], a[144:151], v2
v_smfmac_f32_16x16x64_bf16 v[44:47], v[16:19], a[176:183], v2
v_smfmac_f32_16x16x64_bf16 v[40:43], v[20:23], a[152:159], v2
v_smfmac_f32_16x16x64_bf16 v[44:47], v[20:23], a[184:191], v2
s_nop 7
v_permlane32_swap_b32 v40, v44
v_permlane32_swap_b32 v41, v45
v_permlane32_swap_b32 v42, v46
v_permlane32_swap_b32 v43, v47
v_add_f32 v40, v40, v44
v_add_f32 v41, v41, v45
v_add_f32 v42, v42, v46
v_add_f32 v43, v43, v47
ds_write_b32 v5, v40 offset:9216
ds_write_b32 v5, v41 offset:9360
ds_write_b32 v5, v42 offset:9504
ds_write_b32 v5, v43 offset:9648
s_branch .Ldone_148
.Lgr_172:
s_cmp_eq_u32 s27, 0
s_cbranch_scc1 .Lgo_171
s_sub_u32 s27, s27, 1
buffer_load_dwordx4 v[8:11], v244, s[8:11], s24 offen sc1
buffer_load_dwordx4 v[12:15], v245, s[8:11], s24 offen sc1
buffer_load_dwordx4 v[16:19], v246, s[8:11], s24 offen sc1
buffer_load_dwordx4 v[20:23], v247, s[8:11], s24 offen sc1
s_branch .Lga_170
.Lgr_175:
s_cmp_eq_u32 s27, 0
s_cbranch_scc1 .Lgo_174
s_sub_u32 s27, s27, 1
buffer_load_dwordx4 v[12:15], v245, s[8:11], s24 offen sc1
buffer_load_dwordx4 v[16:19], v246, s[8:11], s24 offen sc1
buffer_load_dwordx4 v[20:23], v247, s[8:11], s24 offen sc1
s_branch .Lga_173
.Lgr_178:
s_cmp_eq_u32 s27, 0
s_cbranch_scc1 .Lgo_177
s_sub_u32 s27, s27, 1
buffer_load_dwordx4 v[16:19], v246, s[8:11], s24 offen sc1
buffer_load_dwordx4 v[20:23], v247, s[8:11], s24 offen sc1
s_branch .Lga_176
.Lgr_181:
s_cmp_eq_u32 s27, 0
s_cbranch_scc1 .Lgo_180
s_sub_u32 s27, s27, 1
buffer_load_dwordx4 v[20:23], v247, s[8:11], s24 offen sc1
s_branch .Lga_179
.Lwv_150:
v_and_b32 v160, 15, v0
v_lshrrev_b32 v161, 4, v0
v_bfe_u32 v162, v0, 5, 1
v_bfe_u32 v163, v0, 4, 1
v_bfe_u32 v164, v0, 1, 3
v_and_b32 v165, 1, v0
v_and_b32 v166, 7, v0
v_mul_u32_u24 v152, 144, v166
v_lshl_add_u32 v152, v162, 6, v152
v_lshl_add_u32 v152, v163, 4, v152
v_lshlrev_b32 v153, 4, v166
v_lshl_add_u32 v153, v161, 7, v153
v_mov_b32 v167, 1073741824
v_cmp_lt_u32 vcc, 7, v160
s_nop 1
v_cndmask_b32 v153, v153, v167, vcc
v_mul_u32_u24 v154, 576, v162
v_and_b32 v166, 31, v0
v_lshl_add_u32 v154, v166, 2, v154
v_add_u32 v154, 9216, v154
v_add_u32 v224, 0, v154
v_add_u32 v225, 1152, v154
v_add_u32 v226, 2304, v154
v_add_u32 v227, 3456, v154
v_mul_u32_u24 v155, 144, v164
v_lshl_add_u32 v155, v161, 5, v155
v_lshl_add_u32 v155, v165, 4, v155
s_lshl_b32 s30, s21, 2
s_add_u32 s30, s30, s20
s_lshl_b32 s30, s30, 10
s_add_u32 s30, s30, 393216
v_lshlrev_b32 v236, 4, v0
v_add_u32 v236, s30, v236
v_lshlrev_b32 v168, 3, v0
s_lshr_b32 s30, s21, 1
s_lshl_b32 s30, s30, 10
s_and_b32 s31, s21, 1
s_lshl_b32 s31, s31, 7
s_add_u32 s30, s30, s31
s_lshl_b32 s31, s20, 14
s_add_u32 s30, s30, s31
v_lshlrev_b32 v237, 3, v160
v_lshl_add_u32 v237, v161, 8, v237
v_add_u32 v237, s30, v237
v_add_u32 v238, 65536, v237
s_mul_i32 s30, s22, 1280
s_add_u32 s30, s30, 131072
v_lshlrev_b32 v239, 4, v0
v_add_u32 v239, s30, v239
v_lshlrev_b32 v154, 2, v0
v_add_u32 v154, s30, v154
v_mov_b32 v232, -1
v_mov_b32 v233, -1
v_mov_b32 v234, -1
v_mov_b32 v235, -1
v_mov_b32 v72, 0
s_mov_b32 s30, 2098560
.Lpp_182:
buffer_load_dword v73, v72, s[8:11], s30 offen sc1
s_waitcnt vmcnt(0)
v_cmp_eq_u32 vcc, 0, v73
s_cbranch_vccz .Lpk_183
s_cmp_eq_u32 s27, 0
s_cbranch_scc1 .Lpk_183
s_sub_u32 s27, s27, 1
s_branch .Lpp_182
.Lpk_183:
v_readfirstlane_b32 s30, v73
s_cmp_eq_u32 s30, 2
s_cselect_b32 s30, 8192, 0
s_lshr_b32 s31, s21, 1
s_lshl_b32 s31, s31, 14
s_add_u32 s30, s30, s31
s_and_b32 s31, s21, 1
s_lshl_b32 s31, s31, 12
s_add_u32 s30, s30, s31
s_lshl_b32 s31, s20, 10
s_add_u32 s30, s30, s31
s_add_u32 s30, s30, 100663296
v_lshlrev_b32 v236, 4, v0
v_add_u32 v236, s30, v236
s_barrier
.Lw1_184:
buffer_load_dwordx4 v[8:11], v240, s[8:11], s24 offen sc1
buffer_load_dwordx4 v[12:15], v241, s[8:11], s24 offen sc1
buffer_load_dwordx4 v[16:19], v242, s[8:11], s24 offen sc1
buffer_load_dwordx4 v[20:23], v243, s[8:11], s24 offen sc1
v_mov_b32 v24, 0
v_mov_b32 v25, 0
v_mov_b32 v26, 0
v_mov_b32 v27, 0
v_mov_b32 v28, 0
v_mov_b32 v29, 0
v_mov_b32 v30, 0
v_mov_b32 v31, 0
v_mov_b32 v32, 0
v_mov_b32 v33, 0
v_mov_b32 v34, 0
v_mov_b32 v35, 0
v_mov_b32 v36, 0
v_mov_b32 v37, 0
v_mov_b32 v38, 0
v_mov_b32 v39, 0
v_mov_b32 v40, 0
v_mov_b32 v41, 0
v_mov_b32 v42, 0
v_mov_b32 v43, 0
v_mov_b32 v44, 0
v_mov_b32 v45, 0
v_mov_b32 v46, 0
v_mov_b32 v47, 0
.Lga_185:
s_waitcnt vmcnt(3)
v_max3_u32 v6, v8, v9, v10
v_max_u32 v6, v6, v11
v_cmp_eq_u32 vcc, -1, v6
s_cbranch_vccnz .Lgr_187
.Lgo_186:
v_smfmac_f32_16x16x64_bf16 v[24:27], v[8:11], a[0:7], v2
v_smfmac_f32_16x16x64_bf16 v[28:31], v[8:11], a[32:39], v2
v_smfmac_f32_16x16x64_bf16 v[32:35], v[8:11], a[64:71], v2
v_smfmac_f32_16x16x64_bf16 v[36:39], v[8:11], a[96:103], v2
.Lga_188:
s_waitcnt vmcnt(2)
v_max3_u32 v6, v12, v13, v14
v_max_u32 v6, v6, v15
v_cmp_eq_u32 vcc, -1, v6
s_cbranch_vccnz .Lgr_190
.Lgo_189:
v_smfmac_f32_16x16x64_bf16 v[24:27], v[12:15], a[8:15], v2
v_smfmac_f32_16x16x64_bf16 v[28:31], v[12:15], a[40:47], v2
v_smfmac_f32_16x16x64_bf16 v[32:35], v[12:15], a[72:79], v2
v_smfmac_f32_16x16x64_bf16 v[36:39], v[12:15], a[104:111], v2
.Lga_191:
s_waitcnt vmcnt(1)
v_max3_u32 v6, v16, v17, v18
v_max_u32 v6, v6, v19
v_cmp_eq_u32 vcc, -1, v6
s_cbranch_vccnz .Lgr_193
.Lgo_192:
v_smfmac_f32_16x16x64_bf16 v[24:27], v[16:19], a[16:23], v2
v_smfmac_f32_16x16x64_bf16 v[28:31], v[16:19], a[48:55], v2
v_smfmac_f32_16x16x64_bf16 v[32:35], v[16:19], a[80:87], v2
v_smfmac_f32_16x16x64_bf16 v[36:39], v[16:19], a[112:119], v2
.Lga_194:
s_waitcnt vmcnt(0)
v_max3_u32 v6, v20, v21, v22
v_max_u32 v6, v6, v23
v_cmp_eq_u32 vcc, -1, v6
s_cbranch_vccnz .Lgr_196
.Lgo_195:
v_smfmac_f32_16x16x64_bf16 v[24:27], v[20:23], a[24:31], v2
v_smfmac_f32_16x16x64_bf16 v[28:31], v[20:23], a[56:63], v2
v_smfmac_f32_16x16x64_bf16 v[32:35], v[20:23], a[88:95], v2
v_smfmac_f32_16x16x64_bf16 v[36:39], v[20:23], a[120:127], v2
s_nop 5
v_permlane32_swap_b32 v24, v28
v_permlane32_swap_b32 v25, v29
v_permlane32_swap_b32 v26, v30
v_permlane32_swap_b32 v27, v31
v_add_f32 v24, v24, v28
v_add_f32 v25, v25, v29
v_add_f32 v26, v26, v30
v_add_f32 v27, v27, v31
ds_write_b32 v5, v24 offset:0
ds_write_b32 v5, v25 offset:144
ds_write_b32 v5, v26 offset:288
ds_write_b32 v5, v27 offset:432
v_permlane32_swap_b32 v32, v36
v_permlane32_swap_b32 v33, v37
v_permlane32_swap_b32 v34, v38
v_permlane32_swap_b32 v35, v39
v_add_f32 v32, v32, v36
v_add_f32 v33, v33, v37
v_add_f32 v34, v34, v38
v_add_f32 v35, v35, v39
ds_write_b32 v5, v32 offset:4608
ds_write_b32 v5, v33 offset:4752
ds_write_b32 v5, v34 offset:4896
ds_write_b32 v5, v35 offset:5040
s_waitcnt lgkmcnt(0)
s_barrier
v_smfmac_f32_16x16x64_bf16 v[40:43], v[8:11], a[128:135], v2
v_smfmac_f32_16x16x64_bf16 v[44:47], v[8:11], a[160:167], v2
v_smfmac_f32_16x16x64_bf16 v[40:43], v[12:15], a[136:143], v2
v_smfmac_f32_16x16x64_bf16 v[44:47], v[12:15], a[168:175], v2
v_smfmac_f32_16x16x64_bf16 v[40:43], v[16:19], a[144:151], v2
v_smfmac_f32_16x16x64_bf16 v[44:47], v[16:19], a[176:183], v2
v_smfmac_f32_16x16x64_bf16 v[40:43], v[20:23], a[152:159], v2
v_smfmac_f32_16x16x64_bf16 v[44:47], v[20:23], a[184:191], v2
s_nop 7
v_permlane32_swap_b32 v40, v44
v_permlane32_swap_b32 v41, v45
v_permlane32_swap_b32 v42, v46
v_permlane32_swap_b32 v43, v47
v_add_f32 v40, v40, v44
v_add_f32 v41, v41, v45
v_add_f32 v42, v42, v46
v_add_f32 v43, v43, v47
ds_write_b32 v5, v40 offset:9216
ds_write_b32 v5, v41 offset:9360
ds_write_b32 v5, v42 offset:9504
ds_write_b32 v5, v43 offset:9648
s_waitcnt lgkmcnt(0)
s_barrier
ds_read_b128 v[64:67], v152 offset:4608
ds_read_b128 v[68:71], v152 offset:4640
ds_read2_b32 v[72:73], v224 offset1:36
ds_read2_b32 v[74:75], v224 offset0:72 offset1:108
ds_read_b128 v[76:79], v152 offset:5760
ds_read_b128 v[80:83], v152 offset:5792
ds_read2_b32 v[84:85], v225 offset1:36
ds_read2_b32 v[86:87], v225 offset0:72 offset1:108
ds_read_b128 v[88:91], v152 offset:6912
ds_read_b128 v[92:95], v152 offset:6944
ds_read2_b32 v[96:97], v226 offset1:36
ds_read2_b32 v[98:99], v226 offset0:72 offset1:108
ds_read_b128 v[100:103], v152 offset:8064
ds_read_b128 v[104:107], v152 offset:8096
ds_read2_b32 v[108:109], v227 offset1:36
ds_read2_b32 v[110:111], v227 offset0:72 offset1:108
s_waitcnt lgkmcnt(0)
v_pk_add_f32 v[64:65], v[64:65], v[76:77]
v_pk_add_f32 v[66:67], v[66:67], v[78:79]
v_pk_add_f32 v[68:69], v[68:69], v[80:81]
v_pk_add_f32 v[70:71], v[70:71], v[82:83]
v_pk_add_f32 v[72:73], v[72:73], v[84:85]
v_pk_add_f32 v[74:75], v[74:75], v[86:87]
v_pk_add_f32 v[88:89], v[88:89], v[100:101]
v_pk_add_f32 v[90:91], v[90:91], v[102:103]
v_pk_add_f32 v[92:93], v[92:93], v[104:105]
v_pk_add_f32 v[94:95], v[94:95], v[106:107]
v_pk_add_f32 v[96:97], v[96:97], v[108:109]
v_pk_add_f32 v[98:99], v[98:99], v[110:111]
v_pk_add_f32 v[64:65], v[64:65], v[88:89]
v_pk_add_f32 v[66:67], v[66:67], v[90:91]
v_pk_add_f32 v[68:69], v[68:69], v[92:93]
v_pk_add_f32 v[70:71], v[70:71], v[94:95]
v_pk_add_f32 v[72:73], v[72:73], v[96:97]
v_pk_add_f32 v[74:75], v[74:75], v[98:99]
v_cvt_pk_bf16_f32 v76, v64, v65
v_cvt_pk_bf16_f32 v77, v66, v67
v_cvt_pk_bf16_f32 v78, v68, v69
v_cvt_pk_bf16_f32 v79, v70, v71
v_cvt_pk_bf16_f32 v80, v72, v73
v_cvt_pk_bf16_f32 v81, v74, v75
s_cmp_eq_u32 s23, 63
s_cbranch_scc1 .Llast_197
s_barrier
buffer_load_dwordx4 v[8:11], v244, s[8:11], s24 offen sc1
buffer_load_dwordx4 v[12:15], v245, s[8:11], s24 offen sc1
buffer_load_dwordx4 v[16:19], v246, s[8:11], s24 offen sc1
buffer_load_dwordx4 v[20:23], v247, s[8:11], s24 offen sc1
v_mov_b32 v24, 0
v_mov_b32 v25, 0
v_mov_b32 v26, 0
v_mov_b32 v27, 0
v_mov_b32 v28, 0
v_mov_b32 v29, 0
v_mov_b32 v30, 0
v_mov_b32 v31, 0
.Lga_198:
s_waitcnt vmcnt(3)
v_max3_u32 v6, v8, v9, v10
v_max_u32 v6, v6, v11
v_cmp_eq_u32 vcc, -1, v6
s_cbranch_vccnz .Lgr_200
.Lgo_199:
v_smfmac_f32_16x16x64_bf16 v[24:27], v[8:11], a[192:199], v2
v_smfmac_f32_16x16x64_bf16 v[28:31], v[8:11], a[224:231], v2
.Lga_201:
s_waitcnt vmcnt(2)
v_max3_u32 v6, v12, v13, v14
v_max_u32 v6, v6, v15
v_cmp_eq_u32 vcc, -1, v6
s_cbranch_vccnz .Lgr_203
.Lgo_202:
v_smfmac_f32_16x16x64_bf16 v[24:27], v[12:15], a[200:207], v2
v_smfmac_f32_16x16x64_bf16 v[28:31], v[12:15], a[232:239], v2
.Lga_204:
s_waitcnt vmcnt(1)
v_max3_u32 v6, v16, v17, v18
v_max_u32 v6, v6, v19
v_cmp_eq_u32 vcc, -1, v6
s_cbranch_vccnz .Lgr_206
.Lgo_205:
v_smfmac_f32_16x16x64_bf16 v[24:27], v[16:19], a[208:215], v2
v_smfmac_f32_16x16x64_bf16 v[28:31], v[16:19], a[240:247], v2
.Lga_207:
s_waitcnt vmcnt(0)
v_max3_u32 v6, v20, v21, v22
v_max_u32 v6, v6, v23
v_cmp_eq_u32 vcc, -1, v6
s_cbranch_vccnz .Lgr_209
.Lgo_208:
v_smfmac_f32_16x16x64_bf16 v[24:27], v[20:23], a[216:223], v2
v_smfmac_f32_16x16x64_bf16 v[28:31], v[20:23], a[248:255], v2
s_nop 7
v_permlane32_swap_b32 v24, v28
v_permlane32_swap_b32 v25, v29
v_permlane32_swap_b32 v26, v30
v_permlane32_swap_b32 v27, v31
v_add_f32 v24, v24, v28
v_add_f32 v25, v25, v29
v_add_f32 v26, v26, v30
v_add_f32 v27, v27, v31
ds_write_b32 v5, v24 offset:13824
ds_write_b32 v5, v25 offset:13968
ds_write_b32 v5, v26 offset:14112
ds_write_b32 v5, v27 offset:14256
s_waitcnt lgkmcnt(0)
s_barrier
s_barrier
s_lshr_b32 s35, s26, 1
buffer_store_dwordx4 v[232:235], v236, s[12:15], s35 offen sc1
s_add_u32 s30, s29, 4194304
buffer_store_dwordx4 v[76:79], v153, s[12:15], s29 offen sc1
buffer_store_dwordx2 v[80:81], v168, s[12:15], s30 offen sc1
s_add_u32 s29, s29, 65536
buffer_store_dwordx2 v[232:233], v237, s[8:11], s26 offen sc1
buffer_store_dwordx2 v[232:233], v238, s[8:11], s26 offen sc1
buffer_store_dwordx4 v[232:235], v239, s[8:11], s26 offen sc1
buffer_store_dword v232, v154, s[8:11], s26 offen offset:1024 sc1
s_waitcnt vmcnt(0)
s_and_b32 s30, s23, 7
s_cmp_eq_u32 s30, 7
s_cbranch_scc1 .Lsig_210
.Lsb_211:
s_barrier
s_add_u32 s23, s23, 1
s_mov_b32 s24, s25
s_mov_b32 s25, s26
s_add_u32 s26, s26, 524288
s_and_b32 s26, s26, 2097151
s_branch .Lw1_184
.Lgr_187:
s_cmp_eq_u32 s27, 0
s_cbranch_scc1 .Lgo_186
s_sub_u32 s27, s27, 1
buffer_load_dwordx4 v[8:11], v240, s[8:11], s24 offen sc1
buffer_load_dwordx4 v[12:15], v241, s[8:11], s24 offen sc1
buffer_load_dwordx4 v[16:19], v242, s[8:11], s24 offen sc1
buffer_load_dwordx4 v[20:23], v243, s[8:11], s24 offen sc1
s_branch .Lga_185
.Lgr_190:
s_cmp_eq_u32 s27, 0
s_cbranch_scc1 .Lgo_189
s_sub_u32 s27, s27, 1
buffer_load_dwordx4 v[12:15], v241, s[8:11], s24 offen sc1
buffer_load_dwordx4 v[16:19], v242, s[8:11], s24 offen sc1
buffer_load_dwordx4 v[20:23], v243, s[8:11], s24 offen sc1
s_branch .Lga_188
.Lgr_193:
s_cmp_eq_u32 s27, 0
s_cbranch_scc1 .Lgo_192
s_sub_u32 s27, s27, 1
buffer_load_dwordx4 v[16:19], v242, s[8:11], s24 offen sc1
buffer_load_dwordx4 v[20:23], v243, s[8:11], s24 offen sc1
s_branch .Lga_191
.Lgr_196:
s_cmp_eq_u32 s27, 0
s_cbranch_scc1 .Lgo_195
s_sub_u32 s27, s27, 1
buffer_load_dwordx4 v[20:23], v243, s[8:11], s24 offen sc1
s_branch .Lga_194
.Llast_197:
s_add_u32 s30, s29, 4194304
buffer_store_dwordx4 v[76:79], v153, s[12:15], s29 offen sc1
buffer_store_dwordx2 v[80:81], v168, s[12:15], s30 offen sc1
s_add_u32 s29, s29, 65536
s_waitcnt vmcnt(0)
s_lshr_b32 s30, s23, 3
s_lshl_b32 s30, s30, 2
s_add_u32 s30, s30, s20
s_lshl_b32 s30, s30, 7
s_add_u32 s30, s30, 2103296
v_mov_b32 v64, 1
v_mov_b32 v65, 0
s_mov_b64 exec, 1
buffer_atomic_add v64, v65, s[8:11], s30 offen sc1
s_mov_b64 exec, -1
s_branch .Ldone_1482
.Lgr_200:
s_cmp_eq_u32 s27, 0
s_cbranch_scc1 .Lgo_199
s_sub_u32 s27, s27, 1
buffer_load_dwordx4 v[8:11], v244, s[8:11], s24 offen sc1
buffer_load_dwordx4 v[12:15], v245, s[8:11], s24 offen sc1
buffer_load_dwordx4 v[16:19], v246, s[8:11], s24 offen sc1
buffer_load_dwordx4 v[20:23], v247, s[8:11], s24 offen sc1
s_branch .Lga_198
.Lgr_203:
s_cmp_eq_u32 s27, 0
s_cbranch_scc1 .Lgo_202
s_sub_u32 s27, s27, 1
buffer_load_dwordx4 v[12:15], v245, s[8:11], s24 offen sc1
buffer_load_dwordx4 v[16:19], v246, s[8:11], s24 offen sc1
buffer_load_dwordx4 v[20:23], v247, s[8:11], s24 offen sc1
s_branch .Lga_201
.Lgr_206:
s_cmp_eq_u32 s27, 0
s_cbranch_scc1 .Lgo_205
s_sub_u32 s27, s27, 1
buffer_load_dwordx4 v[16:19], v246, s[8:11], s24 offen sc1
buffer_load_dwordx4 v[20:23], v247, s[8:11], s24 offen sc1
s_branch .Lga_204
.Lgr_209:
s_cmp_eq_u32 s27, 0
s_cbranch_scc1 .Lgo_208
s_sub_u32 s27, s27, 1
buffer_load_dwordx4 v[20:23], v247, s[8:11], s24 offen sc1
s_branch .Lga_207
.Lsig_210:
s_waitcnt vmcnt(0)
s_lshr_b32 s30, s23, 3
s_lshl_b32 s30, s30, 2
s_add_u32 s30, s30, s20
s_lshl_b32 s30, s30, 7
s_add_u32 s30, s30, 2103296
v_mov_b32 v64, 1
v_mov_b32 v65, 0
s_mov_b64 exec, 1
buffer_atomic_add v64, v65, s[8:11], s30 offen sc1
s_mov_b64 exec, -1
s_branch .Lsb_211
.Lwv_151:
v_and_b32 v160, 15, v0
v_lshrrev_b32 v161, 4, v0
v_bfe_u32 v162, v0, 5, 1
v_bfe_u32 v163, v0, 4, 1
v_bfe_u32 v164, v0, 1, 3
v_and_b32 v165, 1, v0
s_lshr_b32 s30, s21, 1
s_lshl_b32 s30, s30, 10
s_and_b32 s31, s21, 1
s_lshl_b32 s31, s31, 7
s_add_u32 s30, s30, s31
s_lshl_b32 s31, s20, 14
s_add_u32 s30, s30, s31
v_lshlrev_b32 v152, 3, v160
v_lshl_add_u32 v152, v161, 8, v152
v_add_u32 v152, s30, v152
v_add_u32 v156, 65536, v152
s_lshl_b32 s30, s21, 12
s_add_u32 s30, s30, 393216
v_lshlrev_b32 v153, 4, v0
v_add_u32 v153, s30, v153
s_lshl_b32 s30, s20, 10
v_add_u32 v155, s30, v153
s_mul_i32 s30, s22, 1280
s_add_u32 s30, s30, 131072
v_lshlrev_b32 v154, 4, v0
v_add_u32 v154, s30, v154
v_lshlrev_b32 v166, 2, v0
v_add_u32 v166, s30, v166
v_mul_u32_u24 v168, 144, v164
v_lshl_add_u32 v168, v161, 5, v168
v_lshl_add_u32 v168, v165, 4, v168
v_mov_b32 v96, -1
v_mov_b32 v97, -1
v_mov_b32 v98, -1
v_mov_b32 v99, -1
s_load_dwordx2 s[60:61], s[0:1], 8
s_waitcnt lgkmcnt(0)
s_mov_b32 s16, s60
s_mov_b32 s17, s61
s_mov_b32 s18, 0x4000
s_mov_b32 s19, 0x00020000
v_lshlrev_b32 v167, 11, v164
v_lshl_add_u32 v167, v161, 4, v167
v_lshl_add_u32 v167, v165, 3, v167
s_lshl_b32 s30, s21, 6
buffer_load_dwordx2 v[64:65], v167, s[16:19], s30 offen
s_waitcnt vmcnt(0)
buffer_store_dwordx2 v[64:65], v152, s[8:11], 0 offen sc1
v_mov_b32 v72, 0
s_cmp_lg_u32 s22, 0
s_cbranch_scc1 .Lnopr_212
s_mov_b32 s36, -1
s_mov_b32 s37, -1
s_mov_b64 exec, 1
s_mov_b32 s30, 101711872
s_memtime s[60:61]
s_waitcnt lgkmcnt(0)
buffer_store_dword v72, v72, s[12:15], s30 offen sc1
s_waitcnt vmcnt(0)
s_memtime s[62:63]
s_waitcnt lgkmcnt(0)
s_sub_u32 s60, s62, s60
s_min_u32 s36, s36, s60
s_mov_b32 s30, 101720064
s_memtime s[60:61]
s_waitcnt lgkmcnt(0)
buffer_store_dword v72, v72, s[12:15], s30 offen sc1
s_waitcnt vmcnt(0)
s_memtime s[62:63]
s_waitcnt lgkmcnt(0)
s_sub_u32 s60, s62, s60
s_min_u32 s37, s37, s60
s_mov_b32 s30, 101712896
s_memtime s[60:61]
s_waitcnt lgkmcnt(0)
buffer_store_dword v72, v72, s[12:15], s30 offen sc1
s_waitcnt vmcnt(0)
s_memtime s[62:63]
s_waitcnt lgkmcnt(0)
s_sub_u32 s60, s62, s60
s_min_u32 s36, s36, s60
s_mov_b32 s30, 101721088
s_memtime s[60:61]
s_waitcnt lgkmcnt(0)
buffer_store_dword v72, v72, s[12:15], s30 offen sc1
s_waitcnt vmcnt(0)
s_memtime s[62:63]
s_waitcnt lgkmcnt(0)
s_sub_u32 s60, s62, s60
s_min_u32 s37, s37, s60
s_mov_b32 s30, 101711872
s_memtime s[60:61]
s_waitcnt lgkmcnt(0)
buffer_store_dword v72, v72, s[12:15], s30 offen sc1
s_waitcnt vmcnt(0)
s_memtime s[62:63]
s_waitcnt lgkmcnt(0)
s_sub_u32 s60, s62, s60
s_min_u32 s36, s36, s60
s_mov_b32 s30, 101720064
s_memtime s[60:61]
s_waitcnt lgkmcnt(0)
buffer_store_dword v72, v72, s[12:15], s30 offen sc1
s_waitcnt vmcnt(0)
s_memtime s[62:63]
s_waitcnt lgkmcnt(0)
s_sub_u32 s60, s62, s60
s_min_u32 s37, s37, s60
s_mov_b32 s30, 101712896
s_memtime s[60:61]
s_waitcnt lgkmcnt(0)
buffer_store_dword v72, v72, s[12:15], s30 offen sc1
s_waitcnt vmcnt(0)
s_memtime s[62:63]
s_waitcnt lgkmcnt(0)
s_sub_u32 s60, s62, s60
s_min_u32 s36, s36, s60
s_mov_b32 s30, 101721088
s_memtime s[60:61]
s_waitcnt lgkmcnt(0)
buffer_store_dword v72, v72, s[12:15], s30 offen sc1
s_waitcnt vmcnt(0)
s_memtime s[62:63]
s_waitcnt lgkmcnt(0)
s_sub_u32 s60, s62, s60
s_min_u32 s37, s37, s60
s_mov_b32 s30, 101711872
s_memtime s[60:61]
s_waitcnt lgkmcnt(0)
buffer_store_dword v72, v72, s[12:15], s30 offen sc1
s_waitcnt vmcnt(0)
s_memtime s[62:63]
s_waitcnt lgkmcnt(0)
s_sub_u32 s60, s62, s60
s_min_u32 s36, s36, s60
s_mov_b32 s30, 101720064
s_memtime s[60:61]
s_waitcnt lgkmcnt(0)
buffer_store_dword v72, v72, s[12:15], s30 offen sc1
s_waitcnt vmcnt(0)
s_memtime s[62:63]
s_waitcnt lgkmcnt(0)
s_sub_u32 s60, s62, s60
s_min_u32 s37, s37, s60
s_mov_b32 s30, 101712896
s_memtime s[60:61]
s_waitcnt lgkmcnt(0)
buffer_store_dword v72, v72, s[12:15], s30 offen sc1
s_waitcnt vmcnt(0)
s_memtime s[62:63]
s_waitcnt lgkmcnt(0)
s_sub_u32 s60, s62, s60
s_min_u32 s36, s36, s60
s_mov_b32 s30, 101721088
s_memtime s[60:61]
s_waitcnt lgkmcnt(0)
buffer_store_dword v72, v72, s[12:15], s30 offen sc1
s_waitcnt vmcnt(0)
s_memtime s[62:63]
s_waitcnt lgkmcnt(0)
s_sub_u32 s60, s62, s60
s_min_u32 s37, s37, s60
s_cmp_lt_u32 s37, s36
s_cselect_b32 s36, 2, 1
v_mov_b32 v73, s36
s_mov_b32 s30, 2098560
buffer_store_dword v73, v72, s[8:11], s30 offen sc1
s_mov_b64 exec, -1
.Lnopr_212:
v_mov_b32 v72, 0
s_mov_b32 s30, 2098560
.Lpp_213:
buffer_load_dword v73, v72, s[8:11], s30 offen sc1
s_waitcnt vmcnt(0)
v_cmp_eq_u32 vcc, 0, v73
s_cbranch_vccz .Lpk_214
s_cmp_eq_u32 s27, 0
s_cbranch_scc1 .Lpk_214
s_sub_u32 s27, s27, 1
s_branch .Lpp_213
.Lpk_214:
v_readfirstlane_b32 s30, v73
s_cmp_eq_u32 s30, 2
s_cselect_b32 s30, 8192, 0
s_lshr_b32 s31, s21, 1
s_lshl_b32 s31, s31, 14
s_add_u32 s30, s30, s31
s_and_b32 s31, s21, 1
s_lshl_b32 s31, s31, 12
s_add_u32 s30, s30, s31
s_lshl_b32 s31, s20, 10
s_add_u32 s30, s30, s31
s_add_u32 s30, s30, 100663296
v_lshlrev_b32 v155, 4, v0
v_add_u32 v155, s30, v155
v_xor_b32 v225, 1024, v155
v_xor_b32 v226, 2048, v155
v_xor_b32 v227, 3072, v155
s_barrier
.Lw2_215:
buffer_load_dwordx4 v[8:11], v240, s[8:11], s24 offen sc1
buffer_load_dwordx4 v[12:15], v241, s[8:11], s24 offen sc1
buffer_load_dwordx4 v[16:19], v242, s[8:11], s24 offen sc1
buffer_load_dwordx4 v[20:23], v243, s[8:11], s24 offen sc1
v_mov_b32 v24, 0
v_mov_b32 v25, 0
v_mov_b32 v26, 0
v_mov_b32 v27, 0
v_mov_b32 v28, 0
v_mov_b32 v29, 0
v_mov_b32 v30, 0
v_mov_b32 v31, 0
v_mov_b32 v32, 0
v_mov_b32 v33, 0
v_mov_b32 v34, 0
v_mov_b32 v35, 0
v_mov_b32 v36, 0
v_mov_b32 v37, 0
v_mov_b32 v38, 0
v_mov_b32 v39, 0
v_mov_b32 v40, 0
v_mov_b32 v41, 0
v_mov_b32 v42, 0
v_mov_b32 v43, 0
v_mov_b32 v44, 0
v_mov_b32 v45, 0
v_mov_b32 v46, 0
v_mov_b32 v47, 0
.Lga_216:
s_waitcnt vmcnt(3)
v_max3_u32 v6, v8, v9, v10
v_max_u32 v6, v6, v11
v_cmp_eq_u32 vcc, -1, v6
s_cbranch_vccnz .Lgr_218
.Lgo_217:
v_smfmac_f32_16x16x64_bf16 v[24:27], v[8:11], a[0:7], v2
v_smfmac_f32_16x16x64_bf16 v[28:31], v[8:11], a[32:39], v2
v_smfmac_f32_16x16x64_bf16 v[32:35], v[8:11], a[64:71], v2
v_smfmac_f32_16x16x64_bf16 v[36:39], v[8:11], a[96:103], v2
.Lga_219:
s_waitcnt vmcnt(2)
v_max3_u32 v6, v12, v13, v14
v_max_u32 v6, v6, v15
v_cmp_eq_u32 vcc, -1, v6
s_cbranch_vccnz .Lgr_221
.Lgo_220:
v_smfmac_f32_16x16x64_bf16 v[24:27], v[12:15], a[8:15], v2
v_smfmac_f32_16x16x64_bf16 v[28:31], v[12:15], a[40:47], v2
v_smfmac_f32_16x16x64_bf16 v[32:35], v[12:15], a[72:79], v2
v_smfmac_f32_16x16x64_bf16 v[36:39], v[12:15], a[104:111], v2
.Lga_222:
s_waitcnt vmcnt(1)
v_max3_u32 v6, v16, v17, v18
v_max_u32 v6, v6, v19
v_cmp_eq_u32 vcc, -1, v6
s_cbranch_vccnz .Lgr_224
.Lgo_223:
v_smfmac_f32_16x16x64_bf16 v[24:27], v[16:19], a[16:23], v2
v_smfmac_f32_16x16x64_bf16 v[28:31], v[16:19], a[48:55], v2
v_smfmac_f32_16x16x64_bf16 v[32:35], v[16:19], a[80:87], v2
v_smfmac_f32_16x16x64_bf16 v[36:39], v[16:19], a[112:119], v2
.Lga_225:
s_waitcnt vmcnt(0)
v_max3_u32 v6, v20, v21, v22
v_max_u32 v6, v6, v23
v_cmp_eq_u32 vcc, -1, v6
s_cbranch_vccnz .Lgr_227
.Lgo_226:
v_smfmac_f32_16x16x64_bf16 v[24:27], v[20:23], a[24:31], v2
v_smfmac_f32_16x16x64_bf16 v[28:31], v[20:23], a[56:63], v2
v_smfmac_f32_16x16x64_bf16 v[32:35], v[20:23], a[88:95], v2
v_smfmac_f32_16x16x64_bf16 v[36:39], v[20:23], a[120:127], v2
s_nop 5
v_permlane32_swap_b32 v24, v28
v_permlane32_swap_b32 v25, v29
v_permlane32_swap_b32 v26, v30
v_permlane32_swap_b32 v27, v31
v_add_f32 v24, v24, v28
v_add_f32 v25, v25, v29
v_add_f32 v26, v26, v30
v_add_f32 v27, v27, v31
ds_write_b32 v5, v24 offset:0
ds_write_b32 v5, v25 offset:144
ds_write_b32 v5, v26 offset:288
ds_write_b32 v5, v27 offset:432
v_permlane32_swap_b32 v32, v36
v_permlane32_swap_b32 v33, v37
v_permlane32_swap_b32 v34, v38
v_permlane32_swap_b32 v35, v39
v_add_f32 v32, v32, v36
v_add_f32 v33, v33, v37
v_add_f32 v34, v34, v38
v_add_f32 v35, v35, v39
ds_write_b32 v5, v32 offset:4608
ds_write_b32 v5, v33 offset:4752
ds_write_b32 v5, v34 offset:4896
ds_write_b32 v5, v35 offset:5040
s_waitcnt lgkmcnt(0)
s_barrier
v_smfmac_f32_16x16x64_bf16 v[40:43], v[8:11], a[128:135], v2
v_smfmac_f32_16x16x64_bf16 v[44:47], v[8:11], a[160:167], v2
v_smfmac_f32_16x16x64_bf16 v[40:43], v[12:15], a[136:143], v2
v_smfmac_f32_16x16x64_bf16 v[44:47], v[12:15], a[168:175], v2
v_smfmac_f32_16x16x64_bf16 v[40:43], v[16:19], a[144:151], v2
v_smfmac_f32_16x16x64_bf16 v[44:47], v[16:19], a[176:183], v2
v_smfmac_f32_16x16x64_bf16 v[40:43], v[20:23], a[152:159], v2
v_smfmac_f32_16x16x64_bf16 v[44:47], v[20:23], a[184:191], v2
s_nop 7
v_permlane32_swap_b32 v40, v44
v_permlane32_swap_b32 v41, v45
v_permlane32_swap_b32 v42, v46
v_permlane32_swap_b32 v43, v47
v_add_f32 v40, v40, v44
v_add_f32 v41, v41, v45
v_add_f32 v42, v42, v46
v_add_f32 v43, v43, v47
ds_write_b32 v5, v40 offset:9216
ds_write_b32 v5, v41 offset:9360
ds_write_b32 v5, v42 offset:9504
ds_write_b32 v5, v43 offset:9648
s_cmp_eq_u32 s23, 63
s_cbranch_scc1 .Ldone_148
s_waitcnt lgkmcnt(0)
s_barrier
s_barrier
buffer_load_dwordx4 v[8:11], v244, s[8:11], s24 offen sc1
buffer_load_dwordx4 v[12:15], v245, s[8:11], s24 offen sc1
buffer_load_dwordx4 v[16:19], v246, s[8:11], s24 offen sc1
buffer_load_dwordx4 v[20:23], v247, s[8:11], s24 offen sc1
v_mov_b32 v24, 0
v_mov_b32 v25, 0
v_mov_b32 v26, 0
v_mov_b32 v27, 0
v_mov_b32 v28, 0
v_mov_b32 v29, 0
v_mov_b32 v30, 0
v_mov_b32 v31, 0
.Lga_228:
s_waitcnt vmcnt(3)
v_max3_u32 v6, v8, v9, v10
v_max_u32 v6, v6, v11
v_cmp_eq_u32 vcc, -1, v6
s_cbranch_vccnz .Lgr_230
.Lgo_229:
v_smfmac_f32_16x16x64_bf16 v[24:27], v[8:11], a[192:199], v2
v_smfmac_f32_16x16x64_bf16 v[28:31], v[8:11], a[224:231], v2
.Lga_231:
s_waitcnt vmcnt(2)
v_max3_u32 v6, v12, v13, v14
v_max_u32 v6, v6, v15
v_cmp_eq_u32 vcc, -1, v6
s_cbranch_vccnz .Lgr_233
.Lgo_232:
v_smfmac_f32_16x16x64_bf16 v[24:27], v[12:15], a[200:207], v2
v_smfmac_f32_16x16x64_bf16 v[28:31], v[12:15], a[232:239], v2
.Lga_234:
s_waitcnt vmcnt(1)
v_max3_u32 v6, v16, v17, v18
v_max_u32 v6, v6, v19
v_cmp_eq_u32 vcc, -1, v6
s_cbranch_vccnz .Lgr_236
.Lgo_235:
v_smfmac_f32_16x16x64_bf16 v[24:27], v[16:19], a[208:215], v2
v_smfmac_f32_16x16x64_bf16 v[28:31], v[16:19], a[240:247], v2
.Lga_237:
s_waitcnt vmcnt(0)
v_max3_u32 v6, v20, v21, v22
v_max_u32 v6, v6, v23
v_cmp_eq_u32 vcc, -1, v6
s_cbranch_vccnz .Lgr_239
.Lgo_238:
v_smfmac_f32_16x16x64_bf16 v[24:27], v[20:23], a[216:223], v2
v_smfmac_f32_16x16x64_bf16 v[28:31], v[20:23], a[248:255], v2
s_nop 7
v_permlane32_swap_b32 v24, v28
v_permlane32_swap_b32 v25, v29
v_permlane32_swap_b32 v26, v30
v_permlane32_swap_b32 v27, v31
v_add_f32 v24, v24, v28
v_add_f32 v25, v25, v29
v_add_f32 v26, v26, v30
v_add_f32 v27, v27, v31
ds_write_b32 v5, v24 offset:13824
ds_write_b32 v5, v25 offset:13968
ds_write_b32 v5, v26 offset:14112
ds_write_b32 v5, v27 offset:14256
s_waitcnt lgkmcnt(0)
s_barrier
ds_read_b128 v[64:67], v168 offset:13824
ds_read_b128 v[68:71], v168 offset:14976
ds_read_b128 v[72:75], v168 offset:16128
ds_read_b128 v[76:79], v168 offset:17280
s_lshr_b32 s35, s24, 1
s_waitcnt lgkmcnt(2)
v_pk_add_f32 v[64:65], v[64:65], v[68:69]
v_pk_add_f32 v[66:67], v[66:67], v[70:71]
s_waitcnt lgkmcnt(0)
v_pk_add_f32 v[72:73], v[72:73], v[76:77]
v_pk_add_f32 v[74:75], v[74:75], v[78:79]
v_pk_add_f32 v[64:65], v[64:65], v[72:73]
v_pk_add_f32 v[66:67], v[66:67], v[74:75]
buffer_store_dwordx4 v[64:67], v155, s[12:15], s35 offen sc1
s_barrier
s_waitcnt vmcnt(0)
.Lp_240:
buffer_load_dwordx4 v[68:71], v225, s[12:15], s35 offen sc1
buffer_load_dwordx4 v[72:75], v226, s[12:15], s35 offen sc1
buffer_load_dwordx4 v[76:79], v227, s[12:15], s35 offen sc1
s_waitcnt vmcnt(2)
v_pk_add_f32 v[68:69], v[64:65], v[68:69]
v_pk_add_f32 v[70:71], v[66:67], v[70:71]
s_waitcnt vmcnt(0)
v_pk_add_f32 v[72:73], v[72:73], v[76:77]
v_pk_add_f32 v[74:75], v[74:75], v[78:79]
v_pk_add_f32 v[72:73], v[68:69], v[72:73]
v_pk_add_f32 v[74:75], v[70:71], v[74:75]
v_cmp_u_f32 s[60:61], v72, v73
v_cmp_u_f32 vcc, v74, v75
v_cvt_pk_bf16_f32 v68, v72, v73
v_cvt_pk_bf16_f32 v69, v74, v75
s_or_b64 vcc, vcc, s[60:61]
s_cbranch_vccz .Lpo_241
s_cmp_eq_u32 s27, 0
s_cbranch_scc1 .Lpo_241
s_sub_u32 s27, s27, 1
s_branch .Lp_240
.Lpo_241:
buffer_store_dwordx2 v[68:69], v152, s[8:11], s25 offen sc1
s_waitcnt vmcnt(0)
s_barrier
s_add_u32 s23, s23, 1
s_mov_b32 s24, s25
s_mov_b32 s25, s26
s_add_u32 s26, s26, 524288
s_and_b32 s26, s26, 2097151
s_branch .Lw2_215
.Lgr_218:
s_cmp_eq_u32 s27, 0
s_cbranch_scc1 .Lgo_217
s_sub_u32 s27, s27, 1
buffer_load_dwordx4 v[8:11], v240, s[8:11], s24 offen sc1
buffer_load_dwordx4 v[12:15], v241, s[8:11], s24 offen sc1
buffer_load_dwordx4 v[16:19], v242, s[8:11], s24 offen sc1
buffer_load_dwordx4 v[20:23], v243, s[8:11], s24 offen sc1
s_branch .Lga_216
.Lgr_221:
s_cmp_eq_u32 s27, 0
s_cbranch_scc1 .Lgo_220
s_sub_u32 s27, s27, 1
buffer_load_dwordx4 v[12:15], v241, s[8:11], s24 offen sc1
buffer_load_dwordx4 v[16:19], v242, s[8:11], s24 offen sc1
buffer_load_dwordx4 v[20:23], v243, s[8:11], s24 offen sc1
s_branch .Lga_219
.Lgr_224:
s_cmp_eq_u32 s27, 0
s_cbranch_scc1 .Lgo_223
s_sub_u32 s27, s27, 1
buffer_load_dwordx4 v[16:19], v242, s[8:11], s24 offen sc1
buffer_load_dwordx4 v[20:23], v243, s[8:11], s24 offen sc1
s_branch .Lga_222
.Lgr_227:
s_cmp_eq_u32 s27, 0
s_cbranch_scc1 .Lgo_226
s_sub_u32 s27, s27, 1
buffer_load_dwordx4 v[20:23], v243, s[8:11], s24 offen sc1
s_branch .Lga_225
.Lgr_230:
s_cmp_eq_u32 s27, 0
s_cbranch_scc1 .Lgo_229
s_sub_u32 s27, s27, 1
buffer_load_dwordx4 v[8:11], v244, s[8:11], s24 offen sc1
buffer_load_dwordx4 v[12:15], v245, s[8:11], s24 offen sc1
buffer_load_dwordx4 v[16:19], v246, s[8:11], s24 offen sc1
buffer_load_dwordx4 v[20:23], v247, s[8:11], s24 offen sc1
s_branch .Lga_228
.Lgr_233:
s_cmp_eq_u32 s27, 0
s_cbranch_scc1 .Lgo_232
s_sub_u32 s27, s27, 1
buffer_load_dwordx4 v[12:15], v245, s[8:11], s24 offen sc1
buffer_load_dwordx4 v[16:19], v246, s[8:11], s24 offen sc1
buffer_load_dwordx4 v[20:23], v247, s[8:11], s24 offen sc1
s_branch .Lga_231
.Lgr_236:
s_cmp_eq_u32 s27, 0
s_cbranch_scc1 .Lgo_235
s_sub_u32 s27, s27, 1
buffer_load_dwordx4 v[16:19], v246, s[8:11], s24 offen sc1
buffer_load_dwordx4 v[20:23], v247, s[8:11], s24 offen sc1
s_branch .Lga_234
.Lgr_239:
s_cmp_eq_u32 s27, 0
s_cbranch_scc1 .Lgo_238
s_sub_u32 s27, s27, 1
buffer_load_dwordx4 v[20:23], v247, s[8:11], s24 offen sc1
s_branch .Lga_237
.Lwv_152:
v_and_b32 v160, 15, v0
v_lshrrev_b32 v161, 4, v0
v_bfe_u32 v162, v0, 5, 1
v_bfe_u32 v163, v0, 4, 1
v_bfe_u32 v164, v0, 1, 3
v_and_b32 v165, 1, v0
v_lshlrev_b32 v152, 4, v0
v_mov_b32 v64, 0
v_mov_b32 v65, 0
v_mov_b32 v66, 0
v_mov_b32 v67, 0
s_add_u32 s60, s12, s28
s_addc_u32 s61, s13, 0
s_add_u32 s60, s60, 524288
s_addc_u32 s61, s61, 0
s_add_u32 s62, s60, 16777216
s_addc_u32 s63, s61, 0
s_mov_b32 s31, 0
s_lshl_b32 s31, s31, 2
s_add_u32 s31, s31, s20
s_lshl_b32 s31, s31, 7
s_add_u32 s31, s31, 2099200
v_mov_b32 v69, 0
.Lkw_242:
buffer_load_dword v68, v69, s[8:11], s31 offen sc1
s_waitcnt vmcnt(0)
v_readfirstlane_b32 s30, v68
s_cmp_ge_u32 s30, 32
s_cbranch_scc1 .Lko_243
s_cmp_eq_u32 s27, 0
s_cbranch_scc1 .Lko_243
s_sub_u32 s27, s27, 1
s_branch .Lkw_242
.Lko_243:
s_mov_b32 s33, 20480
s_mov_b32 m0, s33
s_add_u32 s30, s28, 16777216
buffer_load_dwordx4 v152, s[12:15], s28 offen sc1 lds
buffer_load_dwordx4 v152, s[12:15], s28 offen offset:1024 sc1 lds
s_add_u32 m0, s33, 2048
s_xor_b32 s33, s33, 12288
buffer_load_dwordx4 v152, s[12:15], s30 offen sc1 lds
buffer_load_dwordx4 v152, s[12:15], s30 offen offset:1024 sc1 lds
s_add_u32 s28, s28, 262144
s_mov_b32 m0, s33
s_add_u32 s30, s28, 16777216
buffer_load_dwordx4 v152, s[12:15], s28 offen sc1 lds
buffer_load_dwordx4 v152, s[12:15], s28 offen offset:1024 sc1 lds
s_add_u32 m0, s33, 2048
s_xor_b32 s33, s33, 12288
buffer_load_dwordx4 v152, s[12:15], s30 offen sc1 lds
buffer_load_dwordx4 v152, s[12:15], s30 offen offset:1024 sc1 lds
s_add_u32 s28, s28, 262144
s_waitcnt vmcnt(0)
s_barrier
.Lw3_244:
buffer_load_dwordx4 v[8:11], v240, s[8:11], s24 offen sc1
buffer_load_dwordx4 v[12:15], v241, s[8:11], s24 offen sc1
buffer_load_dwordx4 v[16:19], v242, s[8:11], s24 offen sc1
buffer_load_dwordx4 v[20:23], v243, s[8:11], s24 offen sc1
v_mov_b32 v24, 0
v_mov_b32 v25, 0
v_mov_b32 v26, 0
v_mov_b32 v27, 0
v_mov_b32 v28, 0
v_mov_b32 v29, 0
v_mov_b32 v30, 0
v_mov_b32 v31, 0
v_mov_b32 v32, 0
v_mov_b32 v33, 0
v_mov_b32 v34, 0
v_mov_b32 v35, 0
v_mov_b32 v36, 0
v_mov_b32 v37, 0
v_mov_b32 v38, 0
v_mov_b32 v39, 0
v_mov_b32 v40, 0
v_mov_b32 v41, 0
v_mov_b32 v42, 0
v_mov_b32 v43, 0
v_mov_b32 v44, 0
v_mov_b32 v45, 0
v_mov_b32 v46, 0
v_mov_b32 v47, 0
.Lga_245:
s_waitcnt vmcnt(3)
v_max3_u32 v6, v8, v9, v10
v_max_u32 v6, v6, v11
v_cmp_eq_u32 vcc, -1, v6
s_cbranch_vccnz .Lgr_247
.Lgo_246:
v_smfmac_f32_16x16x64_bf16 v[24:27], v[8:11], a[0:7], v2
v_smfmac_f32_16x16x64_bf16 v[28:31], v[8:11], a[32:39], v2
v_smfmac_f32_16x16x64_bf16 v[32:35], v[8:11], a[64:71], v2
v_smfmac_f32_16x16x64_bf16 v[36:39], v[8:11], a[96:103], v2
.Lga_248:
s_waitcnt vmcnt(2)
v_max3_u32 v6, v12, v13, v14
v_max_u32 v6, v6, v15
v_cmp_eq_u32 vcc, -1, v6
s_cbranch_vccnz .Lgr_250
.Lgo_249:
v_smfmac_f32_16x16x64_bf16 v[24:27], v[12:15], a[8:15], v2
v_smfmac_f32_16x16x64_bf16 v[28:31], v[12:15], a[40:47], v2
v_smfmac_f32_16x16x64_bf16 v[32:35], v[12:15], a[72:79], v2
v_smfmac_f32_16x16x64_bf16 v[36:39], v[12:15], a[104:111], v2
.Lga_251:
s_waitcnt vmcnt(1)
v_max3_u32 v6, v16, v17, v18
v_max_u32 v6, v6, v19
v_cmp_eq_u32 vcc, -1, v6
s_cbranch_vccnz .Lgr_253
.Lgo_252:
v_smfmac_f32_16x16x64_bf16 v[24:27], v[16:19], a[16:23], v2
v_smfmac_f32_16x16x64_bf16 v[28:31], v[16:19], a[48:55], v2
v_smfmac_f32_16x16x64_bf16 v[32:35], v[16:19], a[80:87], v2
v_smfmac_f32_16x16x64_bf16 v[36:39], v[16:19], a[112:119], v2
.Lga_254:
s_waitcnt vmcnt(0)
v_max3_u32 v6, v20, v21, v22
v_max_u32 v6, v6, v23
v_cmp_eq_u32 vcc, -1, v6
s_cbranch_vccnz .Lgr_256
.Lgo_255:
v_smfmac_f32_16x16x64_bf16 v[24:27], v[20:23], a[24:31], v2
v_smfmac_f32_16x16x64_bf16 v[28:31], v[20:23], a[56:63], v2
v_smfmac_f32_16x16x64_bf16 v[32:35], v[20:23], a[88:95], v2
v_smfmac_f32_16x16x64_bf16 v[36:39], v[20:23], a[120:127], v2
s_nop 5
v_permlane32_swap_b32 v24, v28
v_permlane32_swap_b32 v25, v29
v_permlane32_swap_b32 v26, v30
v_permlane32_swap_b32 v27, v31
v_add_f32 v24, v24, v28
v_add_f32 v25, v25, v29
v_add_f32 v26, v26, v30
v_add_f32 v27, v27, v31
ds_write_b32 v5, v24 offset:0
ds_write_b32 v5, v25 offset:144
ds_write_b32 v5, v26 offset:288
ds_write_b32 v5, v27 offset:432
v_permlane32_swap_b32 v32, v36
v_permlane32_swap_b32 v33, v37
v_permlane32_swap_b32 v34, v38
v_permlane32_swap_b32 v35, v39
v_add_f32 v32, v32, v36
v_add_f32 v33, v33, v37
v_add_f32 v34, v34, v38
v_add_f32 v35, v35, v39
ds_write_b32 v5, v32 offset:4608
ds_write_b32 v5, v33 offset:4752
ds_write_b32 v5, v34 offset:4896
ds_write_b32 v5, v35 offset:5040
s_waitcnt lgkmcnt(0)
s_barrier
v_smfmac_f32_16x16x64_bf16 v[40:43], v[8:11], a[128:135], v2
v_smfmac_f32_16x16x64_bf16 v[44:47], v[8:11], a[160:167], v2
v_smfmac_f32_16x16x64_bf16 v[40:43], v[12:15], a[136:143], v2
v_smfmac_f32_16x16x64_bf16 v[44:47], v[12:15], a[168:175], v2
v_smfmac_f32_16x16x64_bf16 v[40:43], v[16:19], a[144:151], v2
v_smfmac_f32_16x16x64_bf16 v[44:47], v[16:19], a[176:183], v2
v_smfmac_f32_16x16x64_bf16 v[40:43], v[20:23], a[152:159], v2
v_smfmac_f32_16x16x64_bf16 v[44:47], v[20:23], a[184:191], v2
s_nop 7
v_permlane32_swap_b32 v40, v44
v_permlane32_swap_b32 v41, v45
v_permlane32_swap_b32 v42, v46
v_permlane32_swap_b32 v43, v47
v_add_f32 v40, v40, v44
v_add_f32 v41, v41, v45
v_add_f32 v42, v42, v46
v_add_f32 v43, v43, v47
ds_write_b32 v5, v40 offset:9216
ds_write_b32 v5, v41 offset:9360
ds_write_b32 v5, v42 offset:9504
ds_write_b32 v5, v43 offset:9648
s_cmp_eq_u32 s23, 63
s_cbranch_scc1 .Ldone_148
s_waitcnt lgkmcnt(0)
s_barrier
s_barrier
buffer_load_dwordx4 v[8:11], v244, s[8:11], s24 offen sc1
buffer_load_dwordx4 v[12:15], v245, s[8:11], s24 offen sc1
buffer_load_dwordx4 v[16:19], v246, s[8:11], s24 offen sc1
buffer_load_dwordx4 v[20:23], v247, s[8:11], s24 offen sc1
v_mov_b32 v24, 0
v_mov_b32 v25, 0
v_mov_b32 v26, 0
v_mov_b32 v27, 0
v_mov_b32 v28, 0
v_mov_b32 v29, 0
v_mov_b32 v30, 0
v_mov_b32 v31, 0
.Lga_257:
s_waitcnt vmcnt(3)
v_max3_u32 v6, v8, v9, v10
v_max_u32 v6, v6, v11
v_cmp_eq_u32 vcc, -1, v6
s_cbranch_vccnz .Lgr_259
.Lgo_258:
v_smfmac_f32_16x16x64_bf16 v[24:27], v[8:11], a[192:199], v2
v_smfmac_f32_16x16x64_bf16 v[28:31], v[8:11], a[224:231], v2
.Lga_260:
s_waitcnt vmcnt(2)
v_max3_u32 v6, v12, v13, v14
v_max_u32 v6, v6, v15
v_cmp_eq_u32 vcc, -1, v6
s_cbranch_vccnz .Lgr_262
.Lgo_261:
v_smfmac_f32_16x16x64_bf16 v[24:27], v[12:15], a[200:207], v2
v_smfmac_f32_16x16x64_bf16 v[28:31], v[12:15], a[232:239], v2
.Lga_263:
s_waitcnt vmcnt(1)
v_max3_u32 v6, v16, v17, v18
v_max_u32 v6, v6, v19
v_cmp_eq_u32 vcc, -1, v6
s_cbranch_vccnz .Lgr_265
.Lgo_264:
v_smfmac_f32_16x16x64_bf16 v[24:27], v[16:19], a[208:215], v2
v_smfmac_f32_16x16x64_bf16 v[28:31], v[16:19], a[240:247], v2
.Lga_266:
s_waitcnt vmcnt(0)
v_max3_u32 v6, v20, v21, v22
v_max_u32 v6, v6, v23
v_cmp_eq_u32 vcc, -1, v6
s_cbranch_vccnz .Lgr_268
.Lgo_267:
v_smfmac_f32_16x16x64_bf16 v[24:27], v[20:23], a[216:223], v2
v_smfmac_f32_16x16x64_bf16 v[28:31], v[20:23], a[248:255], v2
s_nop 7
v_permlane32_swap_b32 v24, v28
v_permlane32_swap_b32 v25, v29
v_permlane32_swap_b32 v26, v30
v_permlane32_swap_b32 v27, v31
v_add_f32 v24, v24, v28
v_add_f32 v25, v25, v29
v_add_f32 v26, v26, v30
v_add_f32 v27, v27, v31
ds_write_b32 v5, v24 offset:13824
ds_write_b32 v5, v25 offset:13968
ds_write_b32 v5, v26 offset:14112
ds_write_b32 v5, v27 offset:14256
s_waitcnt lgkmcnt(0)
s_barrier
s_barrier
s_and_b32 s30, s23, 7
s_cmp_eq_u32 s30, 6
s_cbranch_scc1 .Lkvw_269
.Lkvb_270:
s_mov_b32 m0, s33
s_add_u32 s30, s28, 16777216
buffer_load_dwordx4 v152, s[12:15], s28 offen sc1 lds
buffer_load_dwordx4 v152, s[12:15], s28 offen offset:1024 sc1 lds
s_add_u32 m0, s33, 2048
s_xor_b32 s33, s33, 12288
buffer_load_dwordx4 v152, s[12:15], s30 offen sc1 lds
buffer_load_dwordx4 v152, s[12:15], s30 offen offset:1024 sc1 lds
s_add_u32 s28, s28, 262144
s_barrier
s_add_u32 s23, s23, 1
s_mov_b32 s24, s25
s_mov_b32 s25, s26
s_add_u32 s26, s26, 524288
s_and_b32 s26, s26, 2097151
s_branch .Lw3_244
.Lgr_247:
s_cmp_eq_u32 s27, 0
s_cbranch_scc1 .Lgo_246
s_sub_u32 s27, s27, 1
buffer_load_dwordx4 v[8:11], v240, s[8:11], s24 offen sc1
buffer_load_dwordx4 v[12:15], v241, s[8:11], s24 offen sc1
buffer_load_dwordx4 v[16:19], v242, s[8:11], s24 offen sc1
buffer_load_dwordx4 v[20:23], v243, s[8:11], s24 offen sc1
s_branch .Lga_245
.Lgr_250:
s_cmp_eq_u32 s27, 0
s_cbranch_scc1 .Lgo_249
s_sub_u32 s27, s27, 1
buffer_load_dwordx4 v[12:15], v241, s[8:11], s24 offen sc1
buffer_load_dwordx4 v[16:19], v242, s[8:11], s24 offen sc1
buffer_load_dwordx4 v[20:23], v243, s[8:11], s24 offen sc1
s_branch .Lga_248
.Lgr_253:
s_cmp_eq_u32 s27, 0
s_cbranch_scc1 .Lgo_252
s_sub_u32 s27, s27, 1
buffer_load_dwordx4 v[16:19], v242, s[8:11], s24 offen sc1
buffer_load_dwordx4 v[20:23], v243, s[8:11], s24 offen sc1
s_branch .Lga_251
.Lgr_256:
s_cmp_eq_u32 s27, 0
s_cbranch_scc1 .Lgo_255
s_sub_u32 s27, s27, 1
buffer_load_dwordx4 v[20:23], v243, s[8:11], s24 offen sc1
s_branch .Lga_254
.Lgr_259:
s_cmp_eq_u32 s27, 0
s_cbranch_scc1 .Lgo_258
s_sub_u32 s27, s27, 1
buffer_load_dwordx4 v[8:11], v244, s[8:11], s24 offen sc1
buffer_load_dwordx4 v[12:15], v245, s[8:11], s24 offen sc1
buffer_load_dwordx4 v[16:19], v246, s[8:11], s24 offen sc1
buffer_load_dwordx4 v[20:23], v247, s[8:11], s24 offen sc1
s_branch .Lga_257
.Lgr_262:
s_cmp_eq_u32 s27, 0
s_cbranch_scc1 .Lgo_261
s_sub_u32 s27, s27, 1
buffer_load_dwordx4 v[12:15], v245, s[8:11], s24 offen sc1
buffer_load_dwordx4 v[16:19], v246, s[8:11], s24 offen sc1
buffer_load_dwordx4 v[20:23], v247, s[8:11], s24 offen sc1
s_branch .Lga_260
.Lgr_265:
s_cmp_eq_u32 s27, 0
s_cbranch_scc1 .Lgo_264
s_sub_u32 s27, s27, 1
buffer_load_dwordx4 v[16:19], v246, s[8:11], s24 offen sc1
buffer_load_dwordx4 v[20:23], v247, s[8:11], s24 offen sc1
s_branch .Lga_263
.Lgr_268:
s_cmp_eq_u32 s27, 0
s_cbranch_scc1 .Lgo_267
s_sub_u32 s27, s27, 1
buffer_load_dwordx4 v[20:23], v247, s[8:11], s24 offen sc1
s_branch .Lga_266
.Lkvw_269:
s_cmp_eq_u32 s23, 62
s_cbranch_scc1 .Lkvb_270
s_add_u32 s31, s23, 2
s_lshr_b32 s31, s31, 3
s_cmp_lt_u32 s31, 3
s_cselect_b32 s60, 16, 8
s_lshl_b32 s31, s31, 2
s_add_u32 s31, s31, s20
s_lshl_b32 s31, s31, 7
s_add_u32 s31, s31, 2099200
v_mov_b32 v69, 0
.Lkw_271:
buffer_load_dword v68, v69, s[8:11], s31 offen sc1
s_waitcnt vmcnt(0)
v_readfirstlane_b32 s30, v68
s_cmp_ge_u32 s30, s60
s_cbranch_scc1 .Lko_272
s_cmp_eq_u32 s27, 0
s_cbranch_scc1 .Lko_272
s_sub_u32 s27, s27, 1
s_branch .Lkw_271
.Lko_272:
s_branch .Lkvb_270
.Ldone_148:
s_waitcnt lgkmcnt(0)
s_barrier
.Ldone_1482:
s_branch .Lfin_21
.Lfin_21:
s_mov_b32 s76, s20
s_mov_b32 s77, s21
s_mov_b32 s80, 400000
s_mov_b32 s78, 7
s_add_u32 s88, s4, 0xf00000
s_addc_u32 s89, s5, 0
s_mov_b32 s90, 0x7214000
s_mov_b32 s91, 0x00020000
s_cmp_lg_u32 s3, 0
s_cbranch_scc1 .Lws_273
s_lshl_b32 s81, s76, 7
s_add_u32 s81, s81, 9728
v_mov_b32 v1, s81
v_mov_b32 v2, 32
s_mov_b32 s81, 11136
v_writelane_b32 v1, s81, 1
v_writelane_b32 v2, 32, 1
s_mov_b64 exec, 3
.Lwl_274:
buffer_load_dword v3, v1, s[88:91], 0 offen sc1
s_waitcnt vmcnt(0)
v_cmp_lt_u32 vcc, v3, v2
s_cbranch_vccz .Lwo_275
s_cmp_eq_u32 s80, 0
s_cbranch_scc1 .Lwo_275
s_sub_u32 s80, s80, 1
s_branch .Lwl_274
.Lwo_275:
s_mov_b64 exec, -1
.Lws_273:
s_barrier
s_cmp_ge_u32 s3, 2
s_cbranch_scc1 .Lna_276
s_lshr_b32 s84, s77, 2
s_add_u32 s84, s84, 56
s_and_b32 s85, s77, 3
s_lshl_b32 s85, s85, 1
s_add_u32 s85, s85, s3
s_lshl_b32 s81, s76, 3
s_add_u32 s85, s85, s81
s_add_u32 s12, s4, 0x1000000
s_addc_u32 s13, s5, 0
s_mov_b32 s14, 0x5800000
s_mov_b32 s15, 0x00020000
s_lshl_b32 s16, s84, 18
s_lshl_b32 s17, s85, 13
s_add_u32 s16, s16, s17
s_add_u32 s17, s16, 16777216
s_add_u32 s18, s16, 33554432
s_add_u32 s19, s16, 50331648
s_lshl_b32 s20, s84, 16
s_lshl_b32 s21, s85, 11
s_add_u32 s20, s20, s21
s_add_u32 s21, s20, 88080384
s_add_u32 s20, s20, 83886080
v_lshlrev_b32 v8, 4, v0
v_add_u32 v9, 4096, v8
v_lshlrev_b32 v5, 3, v0
v_lshrrev_b32 v6, 5, v0
v_lshlrev_b32 v4, 7, v6
v_and_b32 v7, 7, v0
v_lshlrev_b32 v7, 4, v7
v_add_u32 v4, v4, v7
buffer_load_dwordx4 v[12:15], v8, s[12:15], s16 offen offset:0 sc1
buffer_load_dwordx4 v[44:47], v8, s[12:15], s17 offen offset:0 sc1
buffer_load_dwordx4 v[16:19], v8, s[12:15], s16 offen offset:1024 sc1
buffer_load_dwordx4 v[48:51], v8, s[12:15], s17 offen offset:1024 sc1
buffer_load_dwordx4 v[20:23], v8, s[12:15], s16 offen offset:2048 sc1
buffer_load_dwordx4 v[52:55], v8, s[12:15], s17 offen offset:2048 sc1
buffer_load_dwordx4 v[24:27], v8, s[12:15], s16 offen offset:3072 sc1
buffer_load_dwordx4 v[56:59], v8, s[12:15], s17 offen offset:3072 sc1
buffer_load_dwordx4 v[28:31], v9, s[12:15], s16 offen offset:0 sc1
buffer_load_dwordx4 v[60:63], v9, s[12:15], s17 offen offset:0 sc1
buffer_load_dwordx4 v[32:35], v9, s[12:15], s16 offen offset:1024 sc1
buffer_load_dwordx4 v[64:67], v9, s[12:15], s17 offen offset:1024 sc1
buffer_load_dwordx4 v[36:39], v9, s[12:15], s16 offen offset:2048 sc1
buffer_load_dwordx4 v[68:71], v9, s[12:15], s17 offen offset:2048 sc1
buffer_load_dwordx4 v[40:43], v9, s[12:15], s16 offen offset:3072 sc1
buffer_load_dwordx4 v[72:75], v9, s[12:15], s17 offen offset:3072 sc1
buffer_load_dwordx4 v[108:111], v8, s[12:15], s18 offen offset:0 sc1
buffer_load_dwordx4 v[112:115], v8, s[12:15], s18 offen offset:1024 sc1
buffer_load_dwordx4 v[116:119], v8, s[12:15], s18 offen offset:2048 sc1
buffer_load_dwordx4 v[120:123], v8, s[12:15], s18 offen offset:3072 sc1
buffer_load_dwordx4 v[124:127], v9, s[12:15], s18 offen offset:0 sc1
buffer_load_dwordx4 v[128:131], v9, s[12:15], s18 offen offset:1024 sc1
buffer_load_dwordx4 v[132:135], v9, s[12:15], s18 offen offset:2048 sc1
buffer_load_dwordx4 v[136:139], v9, s[12:15], s18 offen offset:3072 sc1
s_mov_b32 exec_lo, 0xff
s_mov_b32 exec_hi, 0xff
buffer_load_dwordx4 v[76:79], v4, s[12:15], s20 offen offset:0 sc1
buffer_load_dwordx4 v[80:83], v4, s[12:15], s20 offen offset:256 sc1
buffer_load_dwordx4 v[84:87], v4, s[12:15], s20 offen offset:512 sc1
buffer_load_dwordx4 v[88:91], v4, s[12:15], s20 offen offset:768 sc1
buffer_load_dwordx4 v[92:95], v4, s[12:15], s20 offen offset:1024 sc1
buffer_load_dwordx4 v[96:99], v4, s[12:15], s20 offen offset:1280 sc1
buffer_load_dwordx4 v[100:103], v4, s[12:15], s20 offen offset:1536 sc1
buffer_load_dwordx4 v[104:107], v4, s[12:15], s20 offen offset:1792 sc1
s_mov_b64 exec, -1
buffer_load_dwordx2 v[140:141], v5, s[12:15], s21 offen offset:0 sc1
v_mov_b32 v142, 0
v_mov_b32 v143, 0
buffer_load_dwordx2 v[144:145], v5, s[12:15], s21 offen offset:512 sc1
v_mov_b32 v146, 0
v_mov_b32 v147, 0
buffer_load_dwordx2 v[148:149], v5, s[12:15], s21 offen offset:1024 sc1
v_mov_b32 v150, 0
v_mov_b32 v151, 0
buffer_load_dwordx2 v[152:153], v5, s[12:15], s21 offen offset:1536 sc1
v_mov_b32 v154, 0
v_mov_b32 v155, 0
v_and_b32 v7, 31, v0
v_lshlrev_b32 v6, 2, v6
v_sub_u32 v7, v7, v6
s_waitcnt vmcnt(34)
v_mfma_f32_32x32x16_bf16 v[156:171], v[44:47], v[12:15], 0
s_waitcnt vmcnt(32)
v_mfma_f32_32x32x16_bf16 v[156:171], v[48:51], v[16:19], v[156:171]
s_waitcnt vmcnt(30)
v_mfma_f32_32x32x16_bf16 v[156:171], v[52:55], v[20:23], v[156:171]
s_waitcnt vmcnt(28)
v_mfma_f32_32x32x16_bf16 v[156:171], v[56:59], v[24:27], v[156:171]
s_waitcnt vmcnt(26)
v_mfma_f32_32x32x16_bf16 v[156:171], v[60:63], v[28:31], v[156:171]
s_waitcnt vmcnt(24)
v_mfma_f32_32x32x16_bf16 v[156:171], v[64:67], v[32:35], v[156:171]
s_waitcnt vmcnt(22)
v_mfma_f32_32x32x16_bf16 v[156:171], v[68:71], v[36:39], v[156:171]
s_waitcnt vmcnt(20)
v_mfma_f32_32x32x16_bf16 v[156:171], v[72:75], v[40:43], v[156:171]
s_waitcnt vmcnt(4)
v_mfma_f32_32x32x16_bf16 v[172:187], v[76:79], v[12:15], 0
v_mfma_f32_32x32x16_bf16 v[172:187], v[80:83], v[16:19], v[172:187]
v_mfma_f32_32x32x16_bf16 v[172:187], v[84:87], v[20:23], v[172:187]
v_mfma_f32_32x32x16_bf16 v[172:187], v[88:91], v[24:27], v[172:187]
v_mfma_f32_32x32x16_bf16 v[172:187], v[92:95], v[28:31], v[172:187]
v_mfma_f32_32x32x16_bf16 v[172:187], v[96:99], v[32:35], v[172:187]
v_mfma_f32_32x32x16_bf16 v[172:187], v[100:103], v[36:39], v[172:187]
v_mfma_f32_32x32x16_bf16 v[172:187], v[104:107], v[40:43], v[172:187]
s_nop 2
v_cvt_pk_bf16_f32 v188, v156, v157
v_cvt_pk_bf16_f32 v189, v158, v159
v_cvt_pk_bf16_f32 v190, v160, v161
v_cvt_pk_bf16_f32 v191, v162, v163
v_cvt_pk_bf16_f32 v192, v164, v165
v_cvt_pk_bf16_f32 v193, v166, v167
v_cvt_pk_bf16_f32 v194, v168, v169
v_cvt_pk_bf16_f32 v195, v170, v171
s_nop 0
v_cvt_pk_bf16_f32 v196, v172, v173
v_cvt_pk_bf16_f32 v197, v174, v175
v_lshlrev_b32 v156, 16, v188
v_and_b32 v157, 0xffff0000, v188
v_lshlrev_b32 v158, 16, v189
v_and_b32 v159, 0xffff0000, v189
v_lshlrev_b32 v160, 16, v190
v_and_b32 v161, 0xffff0000, v190
v_lshlrev_b32 v162, 16, v191
v_and_b32 v163, 0xffff0000, v191
v_lshlrev_b32 v164, 16, v192
v_and_b32 v165, 0xffff0000, v192
v_lshlrev_b32 v166, 16, v193
v_and_b32 v167, 0xffff0000, v193
v_lshlrev_b32 v168, 16, v194
v_and_b32 v169, 0xffff0000, v194
v_lshlrev_b32 v170, 16, v195
v_and_b32 v171, 0xffff0000, v195
v_lshlrev_b32 v172, 16, v196
v_and_b32 v173, 0xffff0000, v196
v_lshlrev_b32 v174, 16, v197
v_and_b32 v175, 0xffff0000, v197
v_mul_f32 v156, 0x3db504f3, v156
v_mul_f32 v157, 0x3db504f3, v157
v_mul_f32 v158, 0x3db504f3, v158
v_mul_f32 v159, 0x3db504f3, v159
v_mul_f32 v160, 0x3db504f3, v160
v_mul_f32 v161, 0x3db504f3, v161
v_mul_f32 v162, 0x3db504f3, v162
v_mul_f32 v163, 0x3db504f3, v163
v_mul_f32 v164, 0x3db504f3, v164
v_mul_f32 v165, 0x3db504f3, v165
v_mul_f32 v166, 0x3db504f3, v166
v_mul_f32 v167, 0x3db504f3, v167
v_mul_f32 v168, 0x3db504f3, v168
v_mul_f32 v169, 0x3db504f3, v169
v_mul_f32 v170, 0x3db504f3, v170
v_mul_f32 v171, 0x3db504f3, v171
v_mul_f32 v172, 0x3db504f3, v172
v_mul_f32 v173, 0x3db504f3, v173
v_mul_f32 v174, 0x3db504f3, v174
v_mul_f32 v175, 0x3db504f3, v175
v_cvt_pk_bf16_f32 v188, v156, v157
v_cvt_pk_bf16_f32 v189, v158, v159
v_cvt_pk_bf16_f32 v190, v160, v161
v_cvt_pk_bf16_f32 v191, v162, v163
v_cvt_pk_bf16_f32 v192, v164, v165
v_cvt_pk_bf16_f32 v193, v166, v167
v_cvt_pk_bf16_f32 v194, v168, v169
v_cvt_pk_bf16_f32 v195, v170, v171
v_cvt_pk_bf16_f32 v196, v172, v173
v_cvt_pk_bf16_f32 v197, v174, v175
v_lshlrev_b32 v156, 16, v188
v_and_b32 v157, 0xffff0000, v188
v_lshlrev_b32 v158, 16, v189
v_and_b32 v159, 0xffff0000, v189
v_lshlrev_b32 v160, 16, v190
v_and_b32 v161, 0xffff0000, v190
v_lshlrev_b32 v162, 16, v191
v_and_b32 v163, 0xffff0000, v191
v_lshlrev_b32 v164, 16, v192
v_and_b32 v165, 0xffff0000, v192
v_lshlrev_b32 v166, 16, v193
v_and_b32 v167, 0xffff0000, v193
v_lshlrev_b32 v168, 16, v194
v_and_b32 v169, 0xffff0000, v194
v_lshlrev_b32 v170, 16, v195
v_and_b32 v171, 0xffff0000, v195
v_lshlrev_b32 v172, 16, v196
v_and_b32 v173, 0xffff0000, v196
v_lshlrev_b32 v174, 16, v197
v_and_b32 v175, 0xffff0000, v197
v_mov_b32 v6, 0xff800000
v_cmp_le_i32 s[24:25], 0, v7
v_cmp_le_i32 s[26:27], 1, v7
v_cmp_le_i32 s[28:29], 2, v7
v_cmp_le_i32 s[30:31], 3, v7
v_cndmask_b32 v156, v6, v156, s[24:25]
v_cndmask_b32 v157, v6, v157, s[26:27]
v_cndmask_b32 v158, v6, v158, s[28:29]
v_cndmask_b32 v159, v6, v159, s[30:31]
v_cmp_le_i32 s[24:25], 8, v7
v_cmp_le_i32 s[26:27], 9, v7
v_cmp_le_i32 s[28:29], 10, v7
v_cmp_le_i32 s[30:31], 11, v7
v_cndmask_b32 v160, v6, v160, s[24:25]
v_cndmask_b32 v161, v6, v161, s[26:27]
v_cndmask_b32 v162, v6, v162, s[28:29]
v_cndmask_b32 v163, v6, v163, s[30:31]
v_cmp_le_i32 s[24:25], 16, v7
v_cmp_le_i32 s[26:27], 17, v7
v_cmp_le_i32 s[28:29], 18, v7
v_cmp_le_i32 s[30:31], 19, v7
v_cndmask_b32 v164, v6, v164, s[24:25]
v_cndmask_b32 v165, v6, v165, s[26:27]
v_cndmask_b32 v166, v6, v166, s[28:29]
v_cndmask_b32 v167, v6, v167, s[30:31]
v_cmp_le_i32 s[24:25], 24, v7
v_cmp_le_i32 s[26:27], 25, v7
v_cmp_le_i32 s[28:29], 26, v7
v_cmp_le_i32 s[30:31], 27, v7
v_cndmask_b32 v168, v6, v168, s[24:25]
v_cndmask_b32 v169, v6, v169, s[26:27]
v_cndmask_b32 v170, v6, v170, s[28:29]
v_cndmask_b32 v171, v6, v171, s[30:31]
v_max3_f32 v188, v156, v157, v158
v_max3_f32 v189, v159, v160, v161
v_max3_f32 v188, v188, v162, v163
v_max3_f32 v189, v189, v164, v165
v_max3_f32 v188, v188, v166, v167
v_max3_f32 v189, v189, v168, v169
v_max3_f32 v188, v188, v170, v171
v_max3_f32 v189, v189, v172, v173
v_max3_f32 v188, v188, v174, v175
v_max_f32 v188, v188, v189
v_mov_b32 v189, v188
s_nop 1
v_permlane32_swap_b32 v188, v189
v_max_f32 v188, v188, v189
v_mul_f32 v188, 0xbfb8aa3b, v188
s_mov_b32 s22, 0x3fb8aa3b
v_fma_f32 v156, v156, s22, v188
v_fma_f32 v157, v157, s22, v188
v_fma_f32 v158, v158, s22, v188
v_fma_f32 v159, v159, s22, v188
v_fma_f32 v160, v160, s22, v188
v_fma_f32 v161, v161, s22, v188
v_fma_f32 v162, v162, s22, v188
v_fma_f32 v163, v163, s22, v188
v_fma_f32 v164, v164, s22, v188
v_fma_f32 v165, v165, s22, v188
v_fma_f32 v166, v166, s22, v188
v_fma_f32 v167, v167, s22, v188
v_fma_f32 v168, v168, s22, v188
v_fma_f32 v169, v169, s22, v188
v_fma_f32 v170, v170, s22, v188
v_fma_f32 v171, v171, s22, v188
v_fma_f32 v172, v172, s22, v188
v_fma_f32 v173, v173, s22, v188
v_fma_f32 v174, v174, s22, v188
v_fma_f32 v175, v175, s22, v188
v_exp_f32 v156, v156
v_exp_f32 v157, v157
v_exp_f32 v158, v158
v_exp_f32 v159, v159
v_exp_f32 v160, v160
v_exp_f32 v161, v161
v_exp_f32 v162, v162
v_exp_f32 v163, v163
v_exp_f32 v164, v164
v_exp_f32 v165, v165
v_exp_f32 v166, v166
v_exp_f32 v167, v167
v_exp_f32 v168, v168
v_exp_f32 v169, v169
v_exp_f32 v170, v170
v_exp_f32 v171, v171
v_exp_f32 v172, v172
v_exp_f32 v173, v173
v_exp_f32 v174, v174
v_exp_f32 v175, v175
v_add_f32 v188, v156, v157
v_add_f32 v189, v158, v159
v_add_f32 v188, v188, v160
v_add_f32 v189, v189, v161
v_add_f32 v188, v188, v162
v_add_f32 v189, v189, v163
v_add_f32 v188, v188, v164
v_add_f32 v189, v189, v165
v_add_f32 v188, v188, v166
v_add_f32 v189, v189, v167
v_add_f32 v188, v188, v168
v_add_f32 v189, v189, v169
v_add_f32 v188, v188, v170
v_add_f32 v189, v189, v171
v_add_f32 v188, v188, v172
v_add_f32 v189, v189, v173
v_add_f32 v188, v188, v174
v_add_f32 v189, v189, v175
v_add_f32 v188, v188, v189
v_mov_b32 v189, v188
s_nop 1
v_permlane32_swap_b32 v188, v189
v_add_f32 v188, v188, v189
v_rcp_f32 v188, v188
s_nop 0
v_mul_f32 v156, v156, v188
v_mul_f32 v157, v157, v188
v_mul_f32 v158, v158, v188
v_mul_f32 v159, v159, v188
v_mul_f32 v160, v160, v188
v_mul_f32 v161, v161, v188
v_mul_f32 v162, v162, v188
v_mul_f32 v163, v163, v188
v_mul_f32 v164, v164, v188
v_mul_f32 v165, v165, v188
v_mul_f32 v166, v166, v188
v_mul_f32 v167, v167, v188
v_mul_f32 v168, v168, v188
v_mul_f32 v169, v169, v188
v_mul_f32 v170, v170, v188
v_mul_f32 v171, v171, v188
v_mul_f32 v172, v172, v188
v_mul_f32 v173, v173, v188
v_mul_f32 v174, v174, v188
v_mul_f32 v175, v175, v188
v_cvt_pk_bf16_f32 v192, v156, v157
v_cvt_pk_bf16_f32 v193, v158, v159
v_cvt_pk_bf16_f32 v194, v160, v161
v_cvt_pk_bf16_f32 v195, v162, v163
v_cvt_pk_bf16_f32 v196, v164, v165
v_cvt_pk_bf16_f32 v197, v166, v167
v_cvt_pk_bf16_f32 v198, v168, v169
v_cvt_pk_bf16_f32 v199, v170, v171
v_cvt_pk_bf16_f32 v200, v172, v173
v_cvt_pk_bf16_f32 v201, v174, v175
v_mov_b32 v202, 0
v_mov_b32 v203, 0
s_waitcnt vmcnt(0)
v_mfma_f32_32x32x16_bf16 v[12:27], v[108:111], v[192:195], 0
v_mfma_f32_32x32x16_bf16 v[28:43], v[116:119], v[192:195], 0
v_mfma_f32_32x32x16_bf16 v[44:59], v[124:127], v[192:195], 0
v_mfma_f32_32x32x16_bf16 v[60:75], v[132:135], v[192:195], 0
v_mfma_f32_32x32x16_bf16 v[12:27], v[112:115], v[196:199], v[12:27]
v_mfma_f32_32x32x16_bf16 v[28:43], v[120:123], v[196:199], v[28:43]
v_mfma_f32_32x32x16_bf16 v[44:59], v[128:131], v[196:199], v[44:59]
v_mfma_f32_32x32x16_bf16 v[60:75], v[136:139], v[196:199], v[60:75]
v_mfma_f32_32x32x16_bf16 v[12:27], v[140:143], v[200:203], v[12:27]
v_mfma_f32_32x32x16_bf16 v[28:43], v[144:147], v[200:203], v[28:43]
v_mfma_f32_32x32x16_bf16 v[44:59], v[148:151], v[200:203], v[44:59]
v_mfma_f32_32x32x16_bf16 v[60:75], v[152:155], v[200:203], v[60:75]
s_nop 8
v_cvt_pk_bf16_f32 v76, v12, v13
v_cvt_pk_bf16_f32 v77, v14, v15
v_cvt_pk_bf16_f32 v78, v16, v17
v_cvt_pk_bf16_f32 v79, v18, v19
buffer_store_dwordx4 v[76:79], v8, s[12:15], s19 offen offset:0 sc1
v_cvt_pk_bf16_f32 v80, v20, v21
v_cvt_pk_bf16_f32 v81, v22, v23
v_cvt_pk_bf16_f32 v82, v24, v25
v_cvt_pk_bf16_f32 v83, v26, v27
buffer_store_dwordx4 v[80:83], v8, s[12:15], s19 offen offset:1024 sc1
v_cvt_pk_bf16_f32 v84, v28, v29
v_cvt_pk_bf16_f32 v85, v30, v31
v_cvt_pk_bf16_f32 v86, v32, v33
v_cvt_pk_bf16_f32 v87, v34, v35
buffer_store_dwordx4 v[84:87], v8, s[12:15], s19 offen offset:2048 sc1
v_cvt_pk_bf16_f32 v88, v36, v37
v_cvt_pk_bf16_f32 v89, v38, v39
v_cvt_pk_bf16_f32 v90, v40, v41
v_cvt_pk_bf16_f32 v91, v42, v43
buffer_store_dwordx4 v[88:91], v8, s[12:15], s19 offen offset:3072 sc1
v_cvt_pk_bf16_f32 v92, v44, v45
v_cvt_pk_bf16_f32 v93, v46, v47
v_cvt_pk_bf16_f32 v94, v48, v49
v_cvt_pk_bf16_f32 v95, v50, v51
buffer_store_dwordx4 v[92:95], v9, s[12:15], s19 offen offset:0 sc1
v_cvt_pk_bf16_f32 v96, v52, v53
v_cvt_pk_bf16_f32 v97, v54, v55
v_cvt_pk_bf16_f32 v98, v56, v57
v_cvt_pk_bf16_f32 v99, v58, v59
buffer_store_dwordx4 v[96:99], v9, s[12:15], s19 offen offset:1024 sc1
v_cvt_pk_bf16_f32 v100, v60, v61
v_cvt_pk_bf16_f32 v101, v62, v63
v_cvt_pk_bf16_f32 v102, v64, v65
v_cvt_pk_bf16_f32 v103, v66, v67
buffer_store_dwordx4 v[100:103], v9, s[12:15], s19 offen offset:2048 sc1
v_cvt_pk_bf16_f32 v104, v68, v69
v_cvt_pk_bf16_f32 v105, v70, v71
v_cvt_pk_bf16_f32 v106, v72, v73
v_cvt_pk_bf16_f32 v107, v74, v75
buffer_store_dwordx4 v[104:107], v9, s[12:15], s19 offen offset:3072 sc1
.Lna_276:
v_mov_b32 v1, 1408
buffer_load_dword v1, v1, s[88:91], 0 offen sc1
s_waitcnt vmcnt(0)
v_readfirstlane_b32 s70, v1
s_cmp_eq_u32 s70, 2
s_cselect_b32 s70, 8192, 0
s_add_u32 s86, s70, 119586816
s_bfe_u32 s82, s77, 0x10004
s_mul_i32 s82, s82, 512
s_add_u32 s86, s86, s82
s_bfe_u32 s82, s76, 0x20000
s_mul_i32 s82, s82, 128
s_add_u32 s86, s86, s82
s_waitcnt vmcnt(0)
s_barrier
s_cmp_lg_u32 s3, 0
s_cbranch_scc1 .Lsg_277
v_mov_b32 v1, 1
v_mul_u32_u24 v2, 0, v0
s_mov_b64 exec, 1
buffer_atomic_add v1, v2, s[88:91], s86 offen sc1
s_mov_b64 exec, -1
.Lsg_277:
s_and_b32 s84, s77, 1
s_add_u32 s84, s84, 14
s_lshr_b32 s85, s77, 1
s_add_u32 s86, s70, 119586816
s_bfe_u32 s82, s77, 0x10000
s_mul_i32 s82, s82, 512
s_add_u32 s86, s86, s82
s_bfe_u32 s82, s76, 0x20000
s_mul_i32 s82, s82, 128
s_add_u32 s86, s86, s82
s_load_dwordx2 s[6:7], s[0:1], 40
s_add_u32 s40, s4, 0x4000000
s_addc_u32 s41, s5, 0
s_mov_b32 s42, 0x1000000
s_mov_b32 s43, 0x00020000
s_and_b32 s18, s85, 7
s_mov_b32 s19, 2048
s_cmp_eq_u32 s18, 3
s_cselect_b32 s19, 128, s19
v_lshrrev_b32 v142, 2, v0
v_and_b32 v142, 3, v142
v_lshrrev_b32 v143, 5, v0
v_lshlrev_b32 v143, 2, v143
v_add_u32 v143, v143, v142
v_mul_u32_u24 v143, 128, v143
v_and_b32 v144, 3, v0
v_lshlrev_b32 v144, 3, v144
v_add_u32 v143, v143, v144
v_and_b32 v144, 16, v0
v_lshlrev_b32 v144, 1, v144
v_add_u32 v143, v143, v144
v_lshrrev_b32 v142, 1, v142
s_and_b32 s53, s3, 0
s_mul_i32 s53, s53, 2
s_add_u32 s57, s53, 0
v_xor_b32 v144, s57, v142
v_lshlrev_b32 v144, 6, v144
v_add_u32 v136, v143, v144
s_add_u32 s57, s53, 1
v_xor_b32 v144, s57, v142
v_lshlrev_b32 v144, 6, v144
v_add_u32 v137, v143, v144
s_lshr_b32 s53, s3, 0
s_mul_i32 s53, s53, 262144
v_lshlrev_b32 v140, 4, v0
v_add_u32 v140, s53, v140
v_lshrrev_b32 v142, 3, v0
s_mul_i32 s53, s3, 8
v_add_u32 v142, s53, v142
v_and_b32 v143, 3, v142
v_lshrrev_b32 v143, 1, v143
v_and_b32 v144, 7, v0
v_lshrrev_b32 v144, 2, v144
v_xor_b32 v143, v143, v144
v_lshlrev_b32 v143, 6, v143
v_and_b32 v144, 3, v0
v_lshlrev_b32 v144, 4, v144
v_add_u32 v143, v143, v144
s_mov_b32 s53, s19
v_mul_lo_u32 v142, v142, s53
v_add_u32 v141, v142, v143
s_mul_i32 s54, s53, 32
s_lshl_b32 s56, s3, 10
s_waitcnt lgkmcnt(0)
s_mul_i32 s48, s84, 1048576
s_mul_i32 s49, s85, 128
s_mov_b32 s50, 128
s_add_u32 s16, s4, 113246208
s_addc_u32 s17, s5, 0
s_lshr_b32 s18, s85, 3
s_lshl_b32 s18, s18, 19
s_cmp_eq_u32 s19, 128
s_cselect_b32 s6, s16, s6
s_cselect_b32 s7, s17, s7
s_cselect_b32 s49, s18, s49
s_mul_i32 s18, s76, 32
s_mov_b32 s50, 32
s_lshl_b32 s16, s18, 11
s_add_u32 s48, s48, s16
s_mul_i32 s16, s18, s19
s_lshl_b32 s16, s16, 5
s_add_u32 s49, s49, s16
s_mov_b32 s44, s6
s_mov_b32 s45, s7
s_mov_b32 s46, 0x800000
s_mov_b32 s47, 0x00020000
s_add_u32 m0, s56, 0
s_nop 0
buffer_load_dwordx4 v141, s[44:47], s49 offen lds
s_add_u32 s49, s49, s54
s_add_u32 m0, s56, 4096
s_nop 0
buffer_load_dwordx4 v141, s[44:47], s49 offen lds
s_add_u32 s49, s49, s54
s_add_u32 m0, s56, 8192
s_nop 0
buffer_load_dwordx4 v141, s[44:47], s49 offen lds
s_add_u32 s49, s49, s54
s_add_u32 m0, s56, 12288
s_nop 0
buffer_load_dwordx4 v141, s[44:47], s49 offen lds
s_add_u32 s49, s49, s54
s_add_u32 m0, s56, 16384
s_nop 0
buffer_load_dwordx4 v141, s[44:47], s49 offen lds
s_add_u32 s49, s49, s54
s_add_u32 m0, s56, 20480
s_nop 0
buffer_load_dwordx4 v141, s[44:47], s49 offen lds
s_add_u32 s49, s49, s54
s_add_u32 m0, s56, 24576
s_nop 0
buffer_load_dwordx4 v141, s[44:47], s49 offen lds
s_add_u32 s49, s49, s54
s_add_u32 m0, s56, 28672
s_nop 0
buffer_load_dwordx4 v141, s[44:47], s49 offen lds
s_add_u32 s49, s49, s54
s_add_u32 m0, s56, 32768
s_nop 0
buffer_load_dwordx4 v141, s[44:47], s49 offen lds
s_add_u32 s49, s49, s54
s_add_u32 m0, s56, 36864
s_nop 0
buffer_load_dwordx4 v141, s[44:47], s49 offen lds
s_add_u32 s49, s49, s54
s_add_u32 m0, s56, 40960
s_nop 0
buffer_load_dwordx4 v141, s[44:47], s49 offen lds
s_add_u32 s49, s49, s54
s_add_u32 m0, s56, 45056
s_nop 0
buffer_load_dwordx4 v141, s[44:47], s49 offen lds
s_add_u32 s49, s49, s54
s_add_u32 m0, s56, 49152
s_nop 0
buffer_load_dwordx4 v141, s[44:47], s49 offen lds
s_add_u32 s49, s49, s54
s_add_u32 m0, s56, 53248
s_nop 0
buffer_load_dwordx4 v141, s[44:47], s49 offen lds
s_add_u32 s49, s49, s54
s_add_u32 m0, s56, 57344
s_nop 0
buffer_load_dwordx4 v141, s[44:47], s49 offen lds
s_add_u32 s49, s49, s54
s_add_u32 m0, s56, 61440
s_nop 0
buffer_load_dwordx4 v141, s[44:47], s49 offen lds
s_add_u32 s49, s49, s54
s_add_u32 m0, s56, 65536
s_nop 0
buffer_load_dwordx4 v141, s[44:47], s49 offen lds
s_add_u32 s49, s49, s54
s_add_u32 m0, s56, 69632
s_nop 0
buffer_load_dwordx4 v141, s[44:47], s49 offen lds
s_add_u32 s49, s49, s54
s_add_u32 m0, s56, 73728
s_nop 0
buffer_load_dwordx4 v141, s[44:47], s49 offen lds
s_add_u32 s49, s49, s54
s_add_u32 m0, s56, 77824
s_nop 0
buffer_load_dwordx4 v141, s[44:47], s49 offen lds
s_add_u32 s49, s49, s54
s_add_u32 m0, s56, 81920
s_nop 0
buffer_load_dwordx4 v141, s[44:47], s49 offen lds
s_add_u32 s49, s49, s54
s_add_u32 m0, s56, 86016
s_nop 0
buffer_load_dwordx4 v141, s[44:47], s49 offen lds
s_add_u32 s49, s49, s54
s_add_u32 m0, s56, 90112
s_nop 0
buffer_load_dwordx4 v141, s[44:47], s49 offen lds
s_add_u32 s49, s49, s54
s_add_u32 m0, s56, 94208
s_nop 0
buffer_load_dwordx4 v141, s[44:47], s49 offen lds
s_add_u32 s49, s49, s54
s_add_u32 m0, s56, 98304
s_nop 0
buffer_load_dwordx4 v141, s[44:47], s49 offen lds
s_add_u32 s49, s49, s54
s_add_u32 m0, s56, 102400
s_nop 0
buffer_load_dwordx4 v141, s[44:47], s49 offen lds
s_add_u32 s49, s49, s54
s_add_u32 m0, s56, 106496
s_nop 0
buffer_load_dwordx4 v141, s[44:47], s49 offen lds
s_add_u32 s49, s49, s54
s_add_u32 m0, s56, 110592
s_nop 0
buffer_load_dwordx4 v141, s[44:47], s49 offen lds
s_add_u32 s49, s49, s54
s_add_u32 m0, s56, 114688
s_nop 0
buffer_load_dwordx4 v141, s[44:47], s49 offen lds
s_add_u32 s49, s49, s54
s_add_u32 m0, s56, 118784
s_nop 0
buffer_load_dwordx4 v141, s[44:47], s49 offen lds
s_add_u32 s49, s49, s54
s_add_u32 m0, s56, 122880
s_nop 0
buffer_load_dwordx4 v141, s[44:47], s49 offen lds
s_add_u32 s49, s49, s54
s_add_u32 m0, s56, 126976
s_nop 0
buffer_load_dwordx4 v141, s[44:47], s49 offen lds
s_add_u32 s49, s49, s54
s_lshr_b32 s16, s3, 0
s_mul_i32 s16, s16, 1
s_mul_i32 s18, s84, 4
s_add_u32 s16, s16, s18
s_and_b32 s17, s3, 0
s_mul_i32 s17, s17, 4
s_mul_i32 s18, s85, 4
s_add_u32 s17, s17, s18
v_lshlrev_b32 v4, 4, v0
s_add_u32 s36, s4, 0x7000000
s_addc_u32 s37, s5, 0
s_mov_b32 s38, 0x400000
s_mov_b32 s39, 0x00020000
s_and_b32 s16, s16, 7
s_lshl_b32 s12, s16, 17
s_lshl_b32 s18, s17, 11
s_add_u32 s12, s12, s18
s_lshl_b32 s18, s76, 20
s_add_u32 s12, s12, s18
v_bfe_u32 v4, v0, 2, 3
v_lshlrev_b32 v4, 7, v4
v_lshrrev_b32 v5, 5, v0
v_lshl_add_u32 v4, v5, 6, v4
v_and_b32 v5, 3, v0
v_lshl_add_u32 v4, v5, 4, v4
s_cmp_lg_u32 s3, 0
s_cbranch_scc1 .Lws_278
v_mul_u32_u24 v1, 0, v0
v_add_u32 v1, s86, v1
v_mov_b32 v2, 16
s_mov_b64 exec, 1
.Lwl_279:
buffer_load_dword v3, v1, s[88:91], 0 offen sc1
s_waitcnt vmcnt(0)
v_cmp_lt_u32 vcc, v3, v2
s_cbranch_vccz .Lwo_280
s_cmp_eq_u32 s80, 0
s_cbranch_scc1 .Lwo_280
s_sub_u32 s80, s80, 1
s_branch .Lwl_279
.Lwo_280:
s_mov_b64 exec, -1
.Lws_278:
s_barrier
buffer_load_dwordx4 v[8:11], v140, s[40:43], s48 offen offset:0 sc1
buffer_load_dwordx4 v[12:15], v140, s[40:43], s48 offen offset:1024 sc1
buffer_load_dwordx4 v[16:19], v140, s[40:43], s48 offen offset:2048 sc1
buffer_load_dwordx4 v[20:23], v140, s[40:43], s48 offen offset:3072 sc1
s_add_u32 s48, s48, 4096
buffer_load_dwordx4 v[24:27], v140, s[40:43], s48 offen offset:0 sc1
buffer_load_dwordx4 v[28:31], v140, s[40:43], s48 offen offset:1024 sc1
buffer_load_dwordx4 v[32:35], v140, s[40:43], s48 offen offset:2048 sc1
buffer_load_dwordx4 v[36:39], v140, s[40:43], s48 offen offset:3072 sc1
s_add_u32 s48, s48, 4096
buffer_load_dwordx4 v[40:43], v140, s[40:43], s48 offen offset:0 sc1
buffer_load_dwordx4 v[44:47], v140, s[40:43], s48 offen offset:1024 sc1
buffer_load_dwordx4 v[48:51], v140, s[40:43], s48 offen offset:2048 sc1
buffer_load_dwordx4 v[52:55], v140, s[40:43], s48 offen offset:3072 sc1
s_add_u32 s48, s48, 4096
buffer_load_dwordx4 v[56:59], v140, s[40:43], s48 offen offset:0 sc1
buffer_load_dwordx4 v[60:63], v140, s[40:43], s48 offen offset:1024 sc1
v_accvgpr_write_b32 a0, 0
v_accvgpr_write_b32 a1, 0
v_accvgpr_write_b32 a2, 0
v_accvgpr_write_b32 a3, 0
v_accvgpr_write_b32 a4, 0
v_accvgpr_write_b32 a5, 0
v_accvgpr_write_b32 a6, 0
v_accvgpr_write_b32 a7, 0
v_accvgpr_write_b32 a8, 0
v_accvgpr_write_b32 a9, 0
v_accvgpr_write_b32 a10, 0
v_accvgpr_write_b32 a11, 0
v_accvgpr_write_b32 a12, 0
v_accvgpr_write_b32 a13, 0
v_accvgpr_write_b32 a14, 0
v_accvgpr_write_b32 a15, 0
v_accvgpr_write_b32 a16, 0
v_accvgpr_write_b32 a17, 0
v_accvgpr_write_b32 a18, 0
v_accvgpr_write_b32 a19, 0
v_accvgpr_write_b32 a20, 0
v_accvgpr_write_b32 a21, 0
v_accvgpr_write_b32 a22, 0
v_accvgpr_write_b32 a23, 0
v_accvgpr_write_b32 a24, 0
v_accvgpr_write_b32 a25, 0
v_accvgpr_write_b32 a26, 0
v_accvgpr_write_b32 a27, 0
v_accvgpr_write_b32 a28, 0
v_accvgpr_write_b32 a29, 0
v_accvgpr_write_b32 a30, 0
v_accvgpr_write_b32 a31, 0
s_waitcnt vmcnt(10)
s_barrier
s_mov_b32 s51, 0
s_add_u32 s52, s56, 98304
v_mov_b32 v138, v136
v_mov_b32 v139, v137
ds_read_b64_tr_b16 v[72:73], v138 offset:0
ds_read_b64_tr_b16 v[74:75], v138 offset:1024
ds_read_b64_tr_b16 v[76:77], v139 offset:0
ds_read_b64_tr_b16 v[78:79], v139 offset:1024
ds_read_b64_tr_b16 v[80:81], v138 offset:2048
ds_read_b64_tr_b16 v[82:83], v138 offset:3072
ds_read_b64_tr_b16 v[84:85], v139 offset:2048
ds_read_b64_tr_b16 v[86:87], v139 offset:3072
ds_read_b64_tr_b16 v[88:89], v138 offset:4096
ds_read_b64_tr_b16 v[90:91], v138 offset:5120
ds_read_b64_tr_b16 v[92:93], v139 offset:4096
ds_read_b64_tr_b16 v[94:95], v139 offset:5120
ds_read_b64_tr_b16 v[96:97], v138 offset:6144
ds_read_b64_tr_b16 v[98:99], v138 offset:7168
ds_read_b64_tr_b16 v[100:101], v139 offset:6144
ds_read_b64_tr_b16 v[102:103], v139 offset:7168
.LgB_282:
s_waitcnt lgkmcnt(8)
v_mfma_f32_32x32x16_bf16 a[0:15], v[72:75], v[8:11], a[0:15]
s_waitcnt vmcnt(8)
s_barrier
ds_read_b64_tr_b16 v[104:105], v138 offset:8192
ds_read_b64_tr_b16 v[106:107], v138 offset:9216
v_mfma_f32_32x32x16_bf16 a[16:31], v[76:79], v[8:11], a[16:31]
ds_read_b64_tr_b16 v[108:109], v139 offset:8192
ds_read_b64_tr_b16 v[110:111], v139 offset:9216
buffer_load_dwordx4 v[64:67], v140, s[40:43], s48 offen offset:2048 sc1
v_mfma_f32_32x32x16_bf16 a[0:15], v[80:83], v[12:15], a[0:15]
ds_read_b64_tr_b16 v[112:113], v138 offset:10240
ds_read_b64_tr_b16 v[114:115], v138 offset:11264
buffer_load_dwordx4 v[68:71], v140, s[40:43], s48 offen offset:3072 sc1
s_add_u32 s48, s48, 4096
v_mfma_f32_32x32x16_bf16 a[16:31], v[84:87], v[12:15], a[16:31]
ds_read_b64_tr_b16 v[116:117], v139 offset:10240
ds_read_b64_tr_b16 v[118:119], v139 offset:11264
s_cmp_eq_u32 s50, 8
s_cselect_b32 s42, 0, s42
s_waitcnt lgkmcnt(8)
v_mfma_f32_32x32x16_bf16 a[0:15], v[88:91], v[16:19], a[0:15]
s_waitcnt vmcnt(8)
s_barrier
ds_read_b64_tr_b16 v[120:121], v138 offset:12288
ds_read_b64_tr_b16 v[122:123], v138 offset:13312
v_mfma_f32_32x32x16_bf16 a[16:31], v[92:95], v[16:19], a[16:31]
ds_read_b64_tr_b16 v[124:125], v139 offset:12288
ds_read_b64_tr_b16 v[126:127], v139 offset:13312
buffer_load_dwordx4 v[8:11], v140, s[40:43], s48 offen offset:0 sc1
v_mfma_f32_32x32x16_bf16 a[0:15], v[96:99], v[20:23], a[0:15]
ds_read_b64_tr_b16 v[128:129], v138 offset:14336
ds_read_b64_tr_b16 v[130:131], v138 offset:15360
buffer_load_dwordx4 v[12:15], v140, s[40:43], s48 offen offset:1024 sc1
v_mfma_f32_32x32x16_bf16 a[16:31], v[100:103], v[20:23], a[16:31]
ds_read_b64_tr_b16 v[132:133], v139 offset:14336
ds_read_b64_tr_b16 v[134:135], v139 offset:15360
s_waitcnt lgkmcnt(8)
v_mfma_f32_32x32x16_bf16 a[0:15], v[104:107], v[24:27], a[0:15]
s_waitcnt vmcnt(8)
s_barrier
ds_read_b64_tr_b16 v[72:73], v138 offset:16384
ds_read_b64_tr_b16 v[74:75], v138 offset:17408
v_mfma_f32_32x32x16_bf16 a[16:31], v[108:111], v[24:27], a[16:31]
ds_read_b64_tr_b16 v[76:77], v139 offset:16384
ds_read_b64_tr_b16 v[78:79], v139 offset:17408
buffer_load_dwordx4 v[16:19], v140, s[40:43], s48 offen offset:2048 sc1
v_mfma_f32_32x32x16_bf16 a[0:15], v[112:115], v[28:31], a[0:15]
ds_read_b64_tr_b16 v[80:81], v138 offset:18432
ds_read_b64_tr_b16 v[82:83], v138 offset:19456
buffer_load_dwordx4 v[20:23], v140, s[40:43], s48 offen offset:3072 sc1
s_add_u32 s48, s48, 4096
v_mfma_f32_32x32x16_bf16 a[16:31], v[116:119], v[28:31], a[16:31]
ds_read_b64_tr_b16 v[84:85], v139 offset:18432
ds_read_b64_tr_b16 v[86:87], v139 offset:19456
s_waitcnt lgkmcnt(8)
v_mfma_f32_32x32x16_bf16 a[0:15], v[120:123], v[32:35], a[0:15]
s_waitcnt vmcnt(8)
s_barrier
ds_read_b64_tr_b16 v[88:89], v138 offset:20480
ds_read_b64_tr_b16 v[90:91], v138 offset:21504
v_mfma_f32_32x32x16_bf16 a[16:31], v[124:127], v[32:35], a[16:31]
ds_read_b64_tr_b16 v[92:93], v139 offset:20480
ds_read_b64_tr_b16 v[94:95], v139 offset:21504
buffer_load_dwordx4 v[24:27], v140, s[40:43], s48 offen offset:0 sc1
v_mfma_f32_32x32x16_bf16 a[0:15], v[128:131], v[36:39], a[0:15]
ds_read_b64_tr_b16 v[96:97], v138 offset:22528
ds_read_b64_tr_b16 v[98:99], v138 offset:23552
buffer_load_dwordx4 v[28:31], v140, s[40:43], s48 offen offset:1024 sc1
v_mfma_f32_32x32x16_bf16 a[16:31], v[132:135], v[36:39], a[16:31]
ds_read_b64_tr_b16 v[100:101], v139 offset:22528
ds_read_b64_tr_b16 v[102:103], v139 offset:23552
s_waitcnt lgkmcnt(8)
v_mfma_f32_32x32x16_bf16 a[0:15], v[72:75], v[40:43], a[0:15]
s_waitcnt vmcnt(8)
s_barrier
ds_read_b64_tr_b16 v[104:105], v138 offset:24576
ds_read_b64_tr_b16 v[106:107], v138 offset:25600
v_mfma_f32_32x32x16_bf16 a[16:31], v[76:79], v[40:43], a[16:31]
ds_read_b64_tr_b16 v[108:109], v139 offset:24576
ds_read_b64_tr_b16 v[110:111], v139 offset:25600
buffer_load_dwordx4 v[32:35], v140, s[40:43], s48 offen offset:2048 sc1
v_mfma_f32_32x32x16_bf16 a[0:15], v[80:83], v[44:47], a[0:15]
ds_read_b64_tr_b16 v[112:113], v138 offset:26624
ds_read_b64_tr_b16 v[114:115], v138 offset:27648
buffer_load_dwordx4 v[36:39], v140, s[40:43], s48 offen offset:3072 sc1
s_add_u32 s48, s48, 4096
v_mfma_f32_32x32x16_bf16 a[16:31], v[84:87], v[44:47], a[16:31]
ds_read_b64_tr_b16 v[116:117], v139 offset:26624
ds_read_b64_tr_b16 v[118:119], v139 offset:27648
s_waitcnt lgkmcnt(8)
v_mfma_f32_32x32x16_bf16 a[0:15], v[88:91], v[48:51], a[0:15]
s_waitcnt vmcnt(8)
s_barrier
ds_read_b64_tr_b16 v[120:121], v138 offset:28672
ds_read_b64_tr_b16 v[122:123], v138 offset:29696
v_mfma_f32_32x32x16_bf16 a[16:31], v[92:95], v[48:51], a[16:31]
ds_read_b64_tr_b16 v[124:125], v139 offset:28672
ds_read_b64_tr_b16 v[126:127], v139 offset:29696
buffer_load_dwordx4 v[40:43], v140, s[40:43], s48 offen offset:0 sc1
v_mfma_f32_32x32x16_bf16 a[0:15], v[96:99], v[52:55], a[0:15]
ds_read_b64_tr_b16 v[128:129], v138 offset:30720
ds_read_b64_tr_b16 v[130:131], v138 offset:31744
buffer_load_dwordx4 v[44:47], v140, s[40:43], s48 offen offset:1024 sc1
v_mfma_f32_32x32x16_bf16 a[16:31], v[100:103], v[52:55], a[16:31]
ds_read_b64_tr_b16 v[132:133], v139 offset:30720
ds_read_b64_tr_b16 v[134:135], v139 offset:31744
s_waitcnt lgkmcnt(8)
v_mfma_f32_32x32x16_bf16 a[0:15], v[104:107], v[56:59], a[0:15]
s_waitcnt vmcnt(8)
s_barrier
s_add_u32 s58, s51, s56
s_add_u32 s51, s51, 32768
s_cmp_eq_u32 s51, 131072
s_cselect_b32 s51, 0, s51
v_add_u32 v138, s51, v136
v_add_u32 v139, s51, v137
ds_read_b64_tr_b16 v[72:73], v138 offset:0
ds_read_b64_tr_b16 v[74:75], v138 offset:1024
v_mfma_f32_32x32x16_bf16 a[16:31], v[108:111], v[56:59], a[16:31]
ds_read_b64_tr_b16 v[76:77], v139 offset:0
ds_read_b64_tr_b16 v[78:79], v139 offset:1024
buffer_load_dwordx4 v[48:51], v140, s[40:43], s48 offen offset:2048 sc1
v_mfma_f32_32x32x16_bf16 a[0:15], v[112:115], v[60:63], a[0:15]
ds_read_b64_tr_b16 v[80:81], v138 offset:2048
ds_read_b64_tr_b16 v[82:83], v138 offset:3072
buffer_load_dwordx4 v[52:55], v140, s[40:43], s48 offen offset:3072 sc1
s_add_u32 s48, s48, 4096
v_mfma_f32_32x32x16_bf16 a[16:31], v[116:119], v[60:63], a[16:31]
ds_read_b64_tr_b16 v[84:85], v139 offset:2048
ds_read_b64_tr_b16 v[86:87], v139 offset:3072
s_waitcnt lgkmcnt(8)
v_mfma_f32_32x32x16_bf16 a[0:15], v[120:123], v[64:67], a[0:15]
s_waitcnt vmcnt(8)
s_barrier
ds_read_b64_tr_b16 v[88:89], v138 offset:4096
ds_read_b64_tr_b16 v[90:91], v138 offset:5120
v_mfma_f32_32x32x16_bf16 a[16:31], v[124:127], v[64:67], a[16:31]
ds_read_b64_tr_b16 v[92:93], v139 offset:4096
ds_read_b64_tr_b16 v[94:95], v139 offset:5120
buffer_load_dwordx4 v[56:59], v140, s[40:43], s48 offen offset:0 sc1
v_mfma_f32_32x32x16_bf16 a[0:15], v[128:131], v[68:71], a[0:15]
ds_read_b64_tr_b16 v[96:97], v138 offset:6144
ds_read_b64_tr_b16 v[98:99], v138 offset:7168
buffer_load_dwordx4 v[60:63], v140, s[40:43], s48 offen offset:1024 sc1
v_mfma_f32_32x32x16_bf16 a[16:31], v[132:135], v[68:71], a[16:31]
ds_read_b64_tr_b16 v[100:101], v139 offset:6144
ds_read_b64_tr_b16 v[102:103], v139 offset:7168
s_sub_u32 s50, s50, 8
s_cmp_lg_u32 s50, 0
s_cbranch_scc1 .LgB_282
s_waitcnt vmcnt(0) lgkmcnt(0)
s_nop 15
s_add_u32 s57, s12, 0
buffer_store_dwordx4 a[0:3], v4, s[36:39], s57 offen offset:0 sc1
buffer_store_dwordx4 a[4:7], v4, s[36:39], s57 offen offset:1024 sc1
buffer_store_dwordx4 a[8:11], v4, s[36:39], s57 offen offset:2048 sc1
buffer_store_dwordx4 a[12:15], v4, s[36:39], s57 offen offset:3072 sc1
s_add_u32 s57, s12, 4096
buffer_store_dwordx4 a[16:19], v4, s[36:39], s57 offen offset:0 sc1
buffer_store_dwordx4 a[20:23], v4, s[36:39], s57 offen offset:1024 sc1
buffer_store_dwordx4 a[24:27], v4, s[36:39], s57 offen offset:2048 sc1
buffer_store_dwordx4 a[28:31], v4, s[36:39], s57 offen offset:3072 sc1
s_add_u32 s86, s70, 119587840
s_bfe_u32 s82, s77, 0x10000
s_mul_i32 s82, s82, 512
s_add_u32 s86, s86, s82
s_bfe_u32 s82, s76, 0x20000
s_mul_i32 s82, s82, 128
s_add_u32 s86, s86, s82
s_waitcnt vmcnt(0)
s_barrier
s_cmp_lg_u32 s3, 0
s_cbranch_scc1 .Lsg_283
v_mov_b32 v1, 1
v_mul_u32_u24 v2, 0, v0
s_mov_b64 exec, 1
buffer_atomic_add v1, v2, s[88:91], s86 offen sc1
s_mov_b64 exec, -1
.Lsg_283:
s_cmp_ge_u32 s77, 16
s_cbranch_scc1 .Lnl_284
s_lshl_b32 s84, s76, 1
s_lshr_b32 s81, s77, 3
s_add_u32 s84, s84, s81
s_add_u32 s84, s84, 56
s_and_b32 s85, s77, 7
s_add_u32 s12, s4, 0x400000
s_addc_u32 s13, s5, 0
s_mov_b32 s14, 0x400000
s_mov_b32 s15, 0x00020000
s_add_u32 s16, s4, 0xc00000
s_addc_u32 s17, s5, 0
s_mov_b32 s18, 0x6000
s_mov_b32 s19, 0x00020000
s_add_u32 s24, s4, 0x7000000
s_addc_u32 s25, s5, 0
s_mov_b32 s26, 0x400000
s_mov_b32 s27, 0x00020000
v_and_b32 v4, 3, v0
v_bfe_u32 v5, v0, 2, 1
v_lshrrev_b32 v6, 3, v0
s_lshl_b32 s28, s85, 2
v_add_u32 v4, s28, v4
s_mul_i32 s28, s3, 16
v_add_u32 v6, s28, v6
v_lshl_add_u32 v7, v5, 5, v4
v_lshlrev_b32 v7, 4, v7
v_lshl_add_u32 v8, v6, 10, v7
v_lshrrev_b32 v7, 2, v4
v_lshlrev_b32 v7, 7, v7
v_lshl_add_u32 v7, v5, 6, v7
v_and_b32 v9, 3, v4
v_lshl_add_u32 v7, v9, 4, v7
v_lshl_add_u32 v9, v6, 11, v7
v_lshlrev_b32 v10, 5, v5
v_lshl_add_u32 v10, v6, 6, v10
s_lshl_b32 s28, s84, 16
s_and_b32 s29, s84, 7
s_lshl_b32 s29, s29, 17
s_mov_b32 s30, 8192
buffer_load_dwordx4 v[208:211], v10, s[16:19], s30 offen offset:0
buffer_load_dwordx4 v[212:215], v10, s[16:19], s30 offen offset:16
buffer_load_dwordx4 v[216:219], v10, s[16:19], s30 offen offset:512
buffer_load_dwordx4 v[220:223], v10, s[16:19], s30 offen offset:528
s_add_u32 s20, s4, 0x800000
s_addc_u32 s21, s5, 0
s_mov_b32 s22, 0x400000
s_mov_b32 s23, 0x00020000
s_add_u32 s31, s28, 0
buffer_load_dwordx4 v[192:195], v8, s[12:15], s31 offen sc1
s_add_u32 s31, s28, 8192
buffer_load_dwordx4 v[196:199], v8, s[12:15], s31 offen sc1
s_add_u32 s86, s70, 119587840
s_bfe_u32 s82, s76, 0x10001
s_mul_i32 s82, s82, 512
s_add_u32 s86, s86, s82
s_cmp_lg_u32 s3, 0
s_cbranch_scc1 .Lws_285
v_mul_u32_u24 v1, 128, v0
v_add_u32 v1, s86, v1
v_mov_b32 v2, 16
s_mov_b64 exec, 15
.Lwl_286:
buffer_load_dword v3, v1, s[88:91], 0 offen sc1
s_waitcnt vmcnt(0)
v_cmp_lt_u32 vcc, v3, v2
s_cbranch_vccz .Lwo_287
s_cmp_eq_u32 s80, 0
s_cbranch_scc1 .Lwo_287
s_sub_u32 s80, s80, 1
s_branch .Lwl_286
.Lwo_287:
s_mov_b64 exec, -1
.Lws_285:
s_barrier
s_add_u32 s31, s29, 0
buffer_load_dwordx4 v[64:67], v9, s[24:27], s31 offen offset:0 sc1
buffer_load_dwordx4 v[68:71], v9, s[24:27], s31 offen offset:1024 sc1
s_add_u32 s31, s29, 1048576
buffer_load_dwordx4 v[72:75], v9, s[24:27], s31 offen offset:0 sc1
buffer_load_dwordx4 v[76:79], v9, s[24:27], s31 offen offset:1024 sc1
s_add_u32 s31, s29, 2097152
buffer_load_dwordx4 v[80:83], v9, s[24:27], s31 offen offset:0 sc1
buffer_load_dwordx4 v[84:87], v9, s[24:27], s31 offen offset:1024 sc1
s_add_u32 s31, s29, 3145728
buffer_load_dwordx4 v[88:91], v9, s[24:27], s31 offen offset:0 sc1
buffer_load_dwordx4 v[92:95], v9, s[24:27], s31 offen offset:1024 sc1
s_add_u32 s31, s29, 16384
buffer_load_dwordx4 v[96:99], v9, s[24:27], s31 offen offset:0 sc1
buffer_load_dwordx4 v[100:103], v9, s[24:27], s31 offen offset:1024 sc1
s_add_u32 s31, s29, 1064960
buffer_load_dwordx4 v[104:107], v9, s[24:27], s31 offen offset:0 sc1
buffer_load_dwordx4 v[108:111], v9, s[24:27], s31 offen offset:1024 sc1
s_add_u32 s31, s29, 2113536
buffer_load_dwordx4 v[112:115], v9, s[24:27], s31 offen offset:0 sc1
buffer_load_dwordx4 v[116:119], v9, s[24:27], s31 offen offset:1024 sc1
s_add_u32 s31, s29, 3162112
buffer_load_dwordx4 v[120:123], v9, s[24:27], s31 offen offset:0 sc1
buffer_load_dwordx4 v[124:127], v9, s[24:27], s31 offen offset:1024 sc1
v_mov_b32 v12, 0x3f803f80
v_mov_b32 v16, 0
v_mov_b32 v17, 0
v_mov_b32 v18, 0
v_mov_b32 v19, 0
s_waitcnt vmcnt(12)
v_pk_add_f32 v[64:65], v[64:65], v[72:73]
v_pk_add_f32 v[66:67], v[66:67], v[74:75]
v_pk_add_f32 v[68:69], v[68:69], v[76:77]
v_pk_add_f32 v[70:71], v[70:71], v[78:79]
s_waitcnt vmcnt(8)
v_pk_add_f32 v[80:81], v[80:81], v[88:89]
v_pk_add_f32 v[82:83], v[82:83], v[90:91]
v_pk_add_f32 v[84:85], v[84:85], v[92:93]
v_pk_add_f32 v[86:87], v[86:87], v[94:95]
v_pk_add_f32 v[64:65], v[64:65], v[80:81]
v_pk_add_f32 v[66:67], v[66:67], v[82:83]
v_pk_add_f32 v[68:69], v[68:69], v[84:85]
v_pk_add_f32 v[70:71], v[70:71], v[86:87]
v_cvt_pk_bf16_f32 v248, v64, v65
v_cvt_pk_bf16_f32 v249, v66, v67
v_cvt_pk_bf16_f32 v250, v68, v69
v_cvt_pk_bf16_f32 v251, v70, v71
v_lshlrev_b32 v240, 16, v248
v_and_b32 v241, 0xffff0000, v248
v_lshlrev_b32 v242, 16, v249
v_and_b32 v243, 0xffff0000, v249
v_lshlrev_b32 v244, 16, v250
v_and_b32 v245, 0xffff0000, v250
v_lshlrev_b32 v246, 16, v251
v_and_b32 v247, 0xffff0000, v251
v_mul_f32 v240, v240, v208
v_mul_f32 v241, v241, v209
v_mul_f32 v242, v242, v210
v_mul_f32 v243, v243, v211
v_mul_f32 v244, v244, v212
v_mul_f32 v245, v245, v213
v_mul_f32 v246, v246, v214
v_mul_f32 v247, v247, v215
v_cvt_pk_bf16_f32 v248, v240, v241
v_cvt_pk_bf16_f32 v249, v242, v243
v_cvt_pk_bf16_f32 v250, v244, v245
v_cvt_pk_bf16_f32 v251, v246, v247
v_lshlrev_b32 v240, 16, v248
v_and_b32 v241, 0xffff0000, v248
v_lshlrev_b32 v248, 16, v192
v_and_b32 v192, 0xffff0000, v192
v_lshlrev_b32 v242, 16, v249
v_and_b32 v243, 0xffff0000, v249
v_lshlrev_b32 v249, 16, v193
v_and_b32 v193, 0xffff0000, v193
v_lshlrev_b32 v244, 16, v250
v_and_b32 v245, 0xffff0000, v250
v_lshlrev_b32 v250, 16, v194
v_and_b32 v194, 0xffff0000, v194
v_lshlrev_b32 v246, 16, v251
v_and_b32 v247, 0xffff0000, v251
v_lshlrev_b32 v251, 16, v195
v_and_b32 v195, 0xffff0000, v195
v_add_f32 v240, v240, v248
v_add_f32 v241, v241, v192
v_add_f32 v242, v242, v249
v_add_f32 v243, v243, v193
v_add_f32 v244, v244, v250
v_add_f32 v245, v245, v194
v_add_f32 v246, v246, v251
v_add_f32 v247, v247, v195
v_cvt_pk_bf16_f32 v192, v240, v241
v_cvt_pk_bf16_f32 v193, v242, v243
v_cvt_pk_bf16_f32 v194, v244, v245
v_cvt_pk_bf16_f32 v195, v246, v247
s_add_u32 s31, s28, 0
buffer_store_dwordx4 v[192:195], v8, s[12:15], s31 offen sc1
v_dot2c_f32_bf16 v16, v192, v12
v_dot2c_f32_bf16 v17, v192, v192
v_dot2c_f32_bf16 v18, v193, v12
v_dot2c_f32_bf16 v19, v193, v193
v_dot2c_f32_bf16 v16, v194, v12
v_dot2c_f32_bf16 v17, v194, v194
v_dot2c_f32_bf16 v18, v195, v12
v_dot2c_f32_bf16 v19, v195, v195
s_waitcnt vmcnt(5)
v_pk_add_f32 v[96:97], v[96:97], v[104:105]
v_pk_add_f32 v[98:99], v[98:99], v[106:107]
v_pk_add_f32 v[100:101], v[100:101], v[108:109]
v_pk_add_f32 v[102:103], v[102:103], v[110:111]
s_waitcnt vmcnt(1)
v_pk_add_f32 v[112:113], v[112:113], v[120:121]
v_pk_add_f32 v[114:115], v[114:115], v[122:123]
v_pk_add_f32 v[116:117], v[116:117], v[124:125]
v_pk_add_f32 v[118:119], v[118:119], v[126:127]
v_pk_add_f32 v[96:97], v[96:97], v[112:113]
v_pk_add_f32 v[98:99], v[98:99], v[114:115]
v_pk_add_f32 v[100:101], v[100:101], v[116:117]
v_pk_add_f32 v[102:103], v[102:103], v[118:119]
v_cvt_pk_bf16_f32 v248, v96, v97
v_cvt_pk_bf16_f32 v249, v98, v99
v_cvt_pk_bf16_f32 v250, v100, v101
v_cvt_pk_bf16_f32 v251, v102, v103
v_lshlrev_b32 v240, 16, v248
v_and_b32 v241, 0xffff0000, v248
v_lshlrev_b32 v242, 16, v249
v_and_b32 v243, 0xffff0000, v249
v_lshlrev_b32 v244, 16, v250
v_and_b32 v245, 0xffff0000, v250
v_lshlrev_b32 v246, 16, v251
v_and_b32 v247, 0xffff0000, v251
v_mul_f32 v240, v240, v216
v_mul_f32 v241, v241, v217
v_mul_f32 v242, v242, v218
v_mul_f32 v243, v243, v219
v_mul_f32 v244, v244, v220
v_mul_f32 v245, v245, v221
v_mul_f32 v246, v246, v222
v_mul_f32 v247, v247, v223
v_cvt_pk_bf16_f32 v248, v240, v241
v_cvt_pk_bf16_f32 v249, v242, v243
v_cvt_pk_bf16_f32 v250, v244, v245
v_cvt_pk_bf16_f32 v251, v246, v247
v_lshlrev_b32 v240, 16, v248
v_and_b32 v241, 0xffff0000, v248
v_lshlrev_b32 v248, 16, v196
v_and_b32 v196, 0xffff0000, v196
v_lshlrev_b32 v242, 16, v249
v_and_b32 v243, 0xffff0000, v249
v_lshlrev_b32 v249, 16, v197
v_and_b32 v197, 0xffff0000, v197
v_lshlrev_b32 v244, 16, v250
v_and_b32 v245, 0xffff0000, v250
v_lshlrev_b32 v250, 16, v198
v_and_b32 v198, 0xffff0000, v198
v_lshlrev_b32 v246, 16, v251
v_and_b32 v247, 0xffff0000, v251
v_lshlrev_b32 v251, 16, v199
v_and_b32 v199, 0xffff0000, v199
v_add_f32 v240, v240, v248
v_add_f32 v241, v241, v196
v_add_f32 v242, v242, v249
v_add_f32 v243, v243, v197
v_add_f32 v244, v244, v250
v_add_f32 v245, v245, v198
v_add_f32 v246, v246, v251
v_add_f32 v247, v247, v199
v_cvt_pk_bf16_f32 v196, v240, v241
v_cvt_pk_bf16_f32 v197, v242, v243
v_cvt_pk_bf16_f32 v198, v244, v245
v_cvt_pk_bf16_f32 v199, v246, v247
s_add_u32 s31, s28, 8192
buffer_store_dwordx4 v[196:199], v8, s[12:15], s31 offen sc1
v_dot2c_f32_bf16 v16, v196, v12
v_dot2c_f32_bf16 v17, v196, v196
v_dot2c_f32_bf16 v18, v197, v12
v_dot2c_f32_bf16 v19, v197, v197
v_dot2c_f32_bf16 v16, v198, v12
v_dot2c_f32_bf16 v17, v198, v198
v_dot2c_f32_bf16 v18, v199, v12
v_dot2c_f32_bf16 v19, v199, v199
s_mov_b32 s30, 12288
s_mov_b32 s31, 16384
buffer_load_dwordx4 v[64:67], v10, s[16:19], s30 offen offset:0
buffer_load_dwordx4 v[96:99], v10, s[16:19], s31 offen offset:0
buffer_load_dwordx4 v[68:71], v10, s[16:19], s30 offen offset:16
buffer_load_dwordx4 v[100:103], v10, s[16:19], s31 offen offset:16
buffer_load_dwordx4 v[72:75], v10, s[16:19], s30 offen offset:512
buffer_load_dwordx4 v[104:107], v10, s[16:19], s31 offen offset:512
buffer_load_dwordx4 v[76:79], v10, s[16:19], s30 offen offset:528
buffer_load_dwordx4 v[108:111], v10, s[16:19], s31 offen offset:528
v_add_f32 v16, v16, v18
v_add_f32 v17, v17, v19
s_nop 0
v_add_f32_dpp v16, v16, v16 row_ror:4 row_mask:0xf bank_mask:0xf
v_add_f32_dpp v17, v17, v17 row_ror:4 row_mask:0xf bank_mask:0xf
s_nop 0
v_add_f32_dpp v16, v16, v16 row_ror:8 row_mask:0xf bank_mask:0xf
v_add_f32_dpp v17, v17, v17 row_ror:8 row_mask:0xf bank_mask:0xf
v_mov_b32 v18, v16
v_mov_b32 v19, v17
s_nop 0
v_permlane16_swap_b32 v16, v18
v_permlane16_swap_b32 v17, v19
v_add_f32 v16, v16, v18
v_add_f32 v17, v17, v19
v_mov_b32 v18, v16
v_mov_b32 v19, v17
s_nop 0
v_permlane32_swap_b32 v16, v18
v_permlane32_swap_b32 v17, v19
v_add_f32 v16, v16, v18
v_add_f32 v17, v17, v19
v_and_b32 v13, 3, v0
v_lshlrev_b32 v13, 3, v13
s_lshl_b32 s31, s3, 6
v_add_u32 v14, s31, v13
ds_write_b64 v14, v[16:17]
s_waitcnt lgkmcnt(0)
s_barrier
ds_read_b64 v[16:17], v13 offset:0
ds_read_b64 v[18:19], v13 offset:64
ds_read_b64 v[20:21], v13 offset:128
ds_read_b64 v[22:23], v13 offset:192
s_waitcnt lgkmcnt(0)
v_add_f32 v16, v16, v18
v_add_f32 v17, v17, v19
v_add_f32 v20, v20, v22
v_add_f32 v21, v21, v23
v_add_f32 v16, v16, v20
v_add_f32 v17, v17, v21
v_mul_f32 v16, 0x3a800000, v16
v_mul_f32 v17, 0x3a800000, v17
v_fma_f32 v17, -v16, v16, v17
v_max_f32 v17, 0, v17
v_cvt_pk_bf16_f32 v18, v16, v17
v_lshlrev_b32 v16, 16, v18
v_and_b32 v17, 0xffff0000, v18
v_add_f32 v17, 0x3727c5ac, v17
v_cvt_pk_bf16_f32 v17, v17, v17
v_lshlrev_b32 v17, 16, v17
v_sqrt_f32 v17, v17
s_nop 0
v_cvt_pk_bf16_f32 v17, v17, v17
v_lshlrev_b32 v17, 16, v17
v_rcp_f32 v17, v17
s_waitcnt vmcnt(0)
v_lshlrev_b32 v240, 16, v192
v_and_b32 v241, 0xffff0000, v192
v_lshlrev_b32 v242, 16, v193
v_and_b32 v243, 0xffff0000, v193
v_lshlrev_b32 v244, 16, v194
v_and_b32 v245, 0xffff0000, v194
v_lshlrev_b32 v246, 16, v195
v_and_b32 v247, 0xffff0000, v195
v_sub_f32 v240, v240, v16
v_sub_f32 v241, v241, v16
v_sub_f32 v242, v242, v16
v_sub_f32 v243, v243, v16
v_sub_f32 v244, v244, v16
v_sub_f32 v245, v245, v16
v_sub_f32 v246, v246, v16
v_sub_f32 v247, v247, v16
v_cvt_pk_bf16_f32 v248, v240, v241
v_cvt_pk_bf16_f32 v249, v242, v243
v_cvt_pk_bf16_f32 v250, v244, v245
v_cvt_pk_bf16_f32 v251, v246, v247
v_lshlrev_b32 v240, 16, v248
v_and_b32 v241, 0xffff0000, v248
v_lshlrev_b32 v242, 16, v249
v_and_b32 v243, 0xffff0000, v249
v_lshlrev_b32 v244, 16, v250
v_and_b32 v245, 0xffff0000, v250
v_lshlrev_b32 v246, 16, v251
v_and_b32 v247, 0xffff0000, v251
v_mul_f32 v240, v240, v17
v_mul_f32 v241, v241, v17
v_mul_f32 v242, v242, v17
v_mul_f32 v243, v243, v17
v_mul_f32 v244, v244, v17
v_mul_f32 v245, v245, v17
v_mul_f32 v246, v246, v17
v_mul_f32 v247, v247, v17
v_cvt_pk_bf16_f32 v248, v240, v241
v_cvt_pk_bf16_f32 v249, v242, v243
v_cvt_pk_bf16_f32 v250, v244, v245
v_cvt_pk_bf16_f32 v251, v246, v247
v_lshlrev_b32 v240, 16, v248
v_and_b32 v241, 0xffff0000, v248
v_lshlrev_b32 v242, 16, v249
v_and_b32 v243, 0xffff0000, v249
v_lshlrev_b32 v244, 16, v250
v_and_b32 v245, 0xffff0000, v250
v_lshlrev_b32 v246, 16, v251
v_and_b32 v247, 0xffff0000, v251
v_mul_f32 v240, v240, v96
v_mul_f32 v241, v241, v97
v_mul_f32 v242, v242, v98
v_mul_f32 v243, v243, v99
v_mul_f32 v244, v244, v100
v_mul_f32 v245, v245, v101
v_mul_f32 v246, v246, v102
v_mul_f32 v247, v247, v103
v_cvt_pk_bf16_f32 v248, v240, v241
v_cvt_pk_bf16_f32 v249, v242, v243
v_cvt_pk_bf16_f32 v250, v244, v245
v_cvt_pk_bf16_f32 v251, v246, v247
v_lshlrev_b32 v240, 16, v248
v_and_b32 v241, 0xffff0000, v248
v_lshlrev_b32 v242, 16, v249
v_and_b32 v243, 0xffff0000, v249
v_lshlrev_b32 v244, 16, v250
v_and_b32 v245, 0xffff0000, v250
v_lshlrev_b32 v246, 16, v251
v_and_b32 v247, 0xffff0000, v251
v_add_f32 v240, v240, v64
v_add_f32 v241, v241, v65
v_add_f32 v242, v242, v66
v_add_f32 v243, v243, v67
v_add_f32 v244, v244, v68
v_add_f32 v245, v245, v69
v_add_f32 v246, v246, v70
v_add_f32 v247, v247, v71
v_cvt_pk_bf16_f32 v192, v240, v241
v_cvt_pk_bf16_f32 v193, v242, v243
v_cvt_pk_bf16_f32 v194, v244, v245
v_cvt_pk_bf16_f32 v195, v246, v247
s_add_u32 s31, s28, 0
buffer_store_dwordx4 v[192:195], v8, s[20:23], s31 offen sc1
v_lshlrev_b32 v240, 16, v196
v_and_b32 v241, 0xffff0000, v196
v_lshlrev_b32 v242, 16, v197
v_and_b32 v243, 0xffff0000, v197
v_lshlrev_b32 v244, 16, v198
v_and_b32 v245, 0xffff0000, v198
v_lshlrev_b32 v246, 16, v199
v_and_b32 v247, 0xffff0000, v199
v_sub_f32 v240, v240, v16
v_sub_f32 v241, v241, v16
v_sub_f32 v242, v242, v16
v_sub_f32 v243, v243, v16
v_sub_f32 v244, v244, v16
v_sub_f32 v245, v245, v16
v_sub_f32 v246, v246, v16
v_sub_f32 v247, v247, v16
v_cvt_pk_bf16_f32 v248, v240, v241
v_cvt_pk_bf16_f32 v249, v242, v243
v_cvt_pk_bf16_f32 v250, v244, v245
v_cvt_pk_bf16_f32 v251, v246, v247
v_lshlrev_b32 v240, 16, v248
v_and_b32 v241, 0xffff0000, v248
v_lshlrev_b32 v242, 16, v249
v_and_b32 v243, 0xffff0000, v249
v_lshlrev_b32 v244, 16, v250
v_and_b32 v245, 0xffff0000, v250
v_lshlrev_b32 v246, 16, v251
v_and_b32 v247, 0xffff0000, v251
v_mul_f32 v240, v240, v17
v_mul_f32 v241, v241, v17
v_mul_f32 v242, v242, v17
v_mul_f32 v243, v243, v17
v_mul_f32 v244, v244, v17
v_mul_f32 v245, v245, v17
v_mul_f32 v246, v246, v17
v_mul_f32 v247, v247, v17
v_cvt_pk_bf16_f32 v248, v240, v241
v_cvt_pk_bf16_f32 v249, v242, v243
v_cvt_pk_bf16_f32 v250, v244, v245
v_cvt_pk_bf16_f32 v251, v246, v247
v_lshlrev_b32 v240, 16, v248
v_and_b32 v241, 0xffff0000, v248
v_lshlrev_b32 v242, 16, v249
v_and_b32 v243, 0xffff0000, v249
v_lshlrev_b32 v244, 16, v250
v_and_b32 v245, 0xffff0000, v250
v_lshlrev_b32 v246, 16, v251
v_and_b32 v247, 0xffff0000, v251
v_mul_f32 v240, v240, v104
v_mul_f32 v241, v241, v105
v_mul_f32 v242, v242, v106
v_mul_f32 v243, v243, v107
v_mul_f32 v244, v244, v108
v_mul_f32 v245, v245, v109
v_mul_f32 v246, v246, v110
v_mul_f32 v247, v247, v111
v_cvt_pk_bf16_f32 v248, v240, v241
v_cvt_pk_bf16_f32 v249, v242, v243
v_cvt_pk_bf16_f32 v250, v244, v245
v_cvt_pk_bf16_f32 v251, v246, v247
v_lshlrev_b32 v240, 16, v248
v_and_b32 v241, 0xffff0000, v248
v_lshlrev_b32 v242, 16, v249
v_and_b32 v243, 0xffff0000, v249
v_lshlrev_b32 v244, 16, v250
v_and_b32 v245, 0xffff0000, v250
v_lshlrev_b32 v246, 16, v251
v_and_b32 v247, 0xffff0000, v251
v_add_f32 v240, v240, v72
v_add_f32 v241, v241, v73
v_add_f32 v242, v242, v74
v_add_f32 v243, v243, v75
v_add_f32 v244, v244, v76
v_add_f32 v245, v245, v77
v_add_f32 v246, v246, v78
v_add_f32 v247, v247, v79
v_cvt_pk_bf16_f32 v196, v240, v241
v_cvt_pk_bf16_f32 v197, v242, v243
v_cvt_pk_bf16_f32 v198, v244, v245
v_cvt_pk_bf16_f32 v199, v246, v247
s_add_u32 s31, s28, 8192
buffer_store_dwordx4 v[196:199], v8, s[20:23], s31 offen sc1
s_add_u32 s86, s70, 119588864
s_bfe_u32 s82, s76, 0x10001
s_mul_i32 s82, s82, 512
s_add_u32 s86, s86, s82
s_waitcnt vmcnt(0)
s_barrier
s_cmp_lg_u32 s3, 0
s_cbranch_scc1 .Lsg_288
v_mov_b32 v1, 1
v_mul_u32_u24 v2, 128, v0
s_mov_b64 exec, 15
buffer_atomic_add v1, v2, s[88:91], s86 offen sc1
s_mov_b64 exec, -1
.Lsg_288:
.Lnl_284:
s_and_b32 s84, s77, 1
s_add_u32 s84, s84, 14
s_lshr_b32 s85, s77, 1
s_cmp_ge_u32 s76, 2
s_cselect_b32 s81, 12, 16
s_cmp_ge_u32 s85, s81
s_cbranch_scc1 .Lnf_289
s_lshl_b32 s81, s76, 4
s_cmp_eq_u32 s76, 3
s_cselect_b32 s81, 44, s81
s_add_u32 s85, s85, s81
s_add_u32 s86, s70, 119588864
s_bfe_u32 s82, s77, 0x10000
s_mul_i32 s82, s82, 512
s_add_u32 s86, s86, s82
s_bfe_u32 s82, s76, 0x20000
s_mul_i32 s82, s82, 128
s_add_u32 s86, s86, s82
s_load_dwordx2 s[6:7], s[0:1], 64
s_add_u32 s40, s4, 0x800000
s_addc_u32 s41, s5, 0
s_mov_b32 s42, 0x400000
s_mov_b32 s43, 0x00020000
v_lshrrev_b32 v142, 2, v0
v_and_b32 v142, 3, v142
v_lshrrev_b32 v143, 5, v0
v_lshlrev_b32 v143, 2, v143
v_add_u32 v143, v143, v142
v_mul_u32_u24 v143, 128, v143
v_and_b32 v144, 3, v0
v_lshlrev_b32 v144, 3, v144
v_add_u32 v143, v143, v144
v_and_b32 v144, 16, v0
v_lshlrev_b32 v144, 1, v144
v_add_u32 v143, v143, v144
v_lshrrev_b32 v142, 1, v142
s_and_b32 s53, s3, 0
s_mul_i32 s53, s53, 2
s_add_u32 s57, s53, 0
v_xor_b32 v144, s57, v142
v_lshlrev_b32 v144, 6, v144
v_add_u32 v136, v143, v144
s_add_u32 s57, s53, 1
v_xor_b32 v144, s57, v142
v_lshlrev_b32 v144, 6, v144
v_add_u32 v137, v143, v144
s_lshr_b32 s53, s3, 0
s_mul_i32 s53, s53, 65536
v_lshlrev_b32 v140, 4, v0
v_add_u32 v140, s53, v140
v_lshrrev_b32 v142, 3, v0
s_mul_i32 s53, s3, 8
v_add_u32 v142, s53, v142
v_and_b32 v143, 3, v142
v_lshrrev_b32 v143, 1, v143
v_and_b32 v144, 7, v0
v_lshrrev_b32 v144, 2, v144
v_xor_b32 v143, v143, v144
v_lshlrev_b32 v143, 6, v143
v_and_b32 v144, 3, v0
v_lshlrev_b32 v144, 4, v144
v_add_u32 v143, v143, v144
s_mov_b32 s53, 7168
v_mul_lo_u32 v142, v142, s53
v_add_u32 v141, v142, v143
s_mul_i32 s54, s53, 32
s_lshl_b32 s56, s3, 10
s_waitcnt lgkmcnt(0)
s_mul_i32 s48, s84, 262144
s_mul_i32 s49, s85, 128
s_mov_b32 s50, 32
s_mov_b32 s44, s6
s_mov_b32 s45, s7
s_mov_b32 s46, 0x700000
s_mov_b32 s47, 0x00020000
s_add_u32 m0, s56, 0
s_nop 0
buffer_load_dwordx4 v141, s[44:47], s49 offen lds
s_add_u32 s49, s49, s54
s_add_u32 m0, s56, 4096
s_nop 0
buffer_load_dwordx4 v141, s[44:47], s49 offen lds
s_add_u32 s49, s49, s54
s_add_u32 m0, s56, 8192
s_nop 0
buffer_load_dwordx4 v141, s[44:47], s49 offen lds
s_add_u32 s49, s49, s54
s_add_u32 m0, s56, 12288
s_nop 0
buffer_load_dwordx4 v141, s[44:47], s49 offen lds
s_add_u32 s49, s49, s54
s_add_u32 m0, s56, 16384
s_nop 0
buffer_load_dwordx4 v141, s[44:47], s49 offen lds
s_add_u32 s49, s49, s54
s_add_u32 m0, s56, 20480
s_nop 0
buffer_load_dwordx4 v141, s[44:47], s49 offen lds
s_add_u32 s49, s49, s54
s_add_u32 m0, s56, 24576
s_nop 0
buffer_load_dwordx4 v141, s[44:47], s49 offen lds
s_add_u32 s49, s49, s54
s_add_u32 m0, s56, 28672
s_nop 0
buffer_load_dwordx4 v141, s[44:47], s49 offen lds
s_add_u32 s49, s49, s54
s_add_u32 m0, s56, 32768
s_nop 0
buffer_load_dwordx4 v141, s[44:47], s49 offen lds
s_add_u32 s49, s49, s54
s_add_u32 m0, s56, 36864
s_nop 0
buffer_load_dwordx4 v141, s[44:47], s49 offen lds
s_add_u32 s49, s49, s54
s_add_u32 m0, s56, 40960
s_nop 0
buffer_load_dwordx4 v141, s[44:47], s49 offen lds
s_add_u32 s49, s49, s54
s_add_u32 m0, s56, 45056
s_nop 0
buffer_load_dwordx4 v141, s[44:47], s49 offen lds
s_add_u32 s49, s49, s54
s_add_u32 m0, s56, 49152
s_nop 0
buffer_load_dwordx4 v141, s[44:47], s49 offen lds
s_add_u32 s49, s49, s54
s_add_u32 m0, s56, 53248
s_nop 0
buffer_load_dwordx4 v141, s[44:47], s49 offen lds
s_add_u32 s49, s49, s54
s_add_u32 m0, s56, 57344
s_nop 0
buffer_load_dwordx4 v141, s[44:47], s49 offen lds
s_add_u32 s49, s49, s54
s_add_u32 m0, s56, 61440
s_nop 0
buffer_load_dwordx4 v141, s[44:47], s49 offen lds
s_add_u32 s49, s49, s54
s_add_u32 m0, s56, 65536
s_nop 0
buffer_load_dwordx4 v141, s[44:47], s49 offen lds
s_add_u32 s49, s49, s54
s_add_u32 m0, s56, 69632
s_nop 0
buffer_load_dwordx4 v141, s[44:47], s49 offen lds
s_add_u32 s49, s49, s54
s_add_u32 m0, s56, 73728
s_nop 0
buffer_load_dwordx4 v141, s[44:47], s49 offen lds
s_add_u32 s49, s49, s54
s_add_u32 m0, s56, 77824
s_nop 0
buffer_load_dwordx4 v141, s[44:47], s49 offen lds
s_add_u32 s49, s49, s54
s_add_u32 m0, s56, 81920
s_nop 0
buffer_load_dwordx4 v141, s[44:47], s49 offen lds
s_add_u32 s49, s49, s54
s_add_u32 m0, s56, 86016
s_nop 0
buffer_load_dwordx4 v141, s[44:47], s49 offen lds
s_add_u32 s49, s49, s54
s_add_u32 m0, s56, 90112
s_nop 0
buffer_load_dwordx4 v141, s[44:47], s49 offen lds
s_add_u32 s49, s49, s54
s_add_u32 m0, s56, 94208
s_nop 0
buffer_load_dwordx4 v141, s[44:47], s49 offen lds
s_add_u32 s49, s49, s54
s_add_u32 m0, s56, 98304
s_nop 0
buffer_load_dwordx4 v141, s[44:47], s49 offen lds
s_add_u32 s49, s49, s54
s_add_u32 m0, s56, 102400
s_nop 0
buffer_load_dwordx4 v141, s[44:47], s49 offen lds
s_add_u32 s49, s49, s54
s_add_u32 m0, s56, 106496
s_nop 0
buffer_load_dwordx4 v141, s[44:47], s49 offen lds
s_add_u32 s49, s49, s54
s_add_u32 m0, s56, 110592
s_nop 0
buffer_load_dwordx4 v141, s[44:47], s49 offen lds
s_add_u32 s49, s49, s54
s_add_u32 m0, s56, 114688
s_nop 0
buffer_load_dwordx4 v141, s[44:47], s49 offen lds
s_add_u32 s49, s49, s54
s_add_u32 m0, s56, 118784
s_nop 0
buffer_load_dwordx4 v141, s[44:47], s49 offen lds
s_add_u32 s49, s49, s54
s_add_u32 m0, s56, 122880
s_nop 0
buffer_load_dwordx4 v141, s[44:47], s49 offen lds
s_add_u32 s49, s49, s54
s_add_u32 m0, s56, 126976
s_nop 0
buffer_load_dwordx4 v141, s[44:47], s49 offen lds
s_add_u32 s49, s49, s54
s_lshr_b32 s16, s3, 0
s_mul_i32 s16, s16, 1
s_mul_i32 s18, s84, 4
s_add_u32 s16, s16, s18
s_and_b32 s17, s3, 0
s_mul_i32 s17, s17, 4
s_mul_i32 s18, s85, 4
s_add_u32 s17, s17, s18
v_lshlrev_b32 v4, 4, v0
s_add_u32 s36, s4, 0x5000000
s_addc_u32 s37, s5, 0
s_mov_b32 s38, 0xe00000
s_mov_b32 s39, 0x00020000
s_mul_i32 s12, s16, 229376
s_lshl_b32 s18, s17, 10
s_add_u32 s12, s12, s18
s_cmp_lg_u32 s3, 0
s_cbranch_scc1 .Lws_290
v_mul_u32_u24 v1, 0, v0
v_add_u32 v1, s86, v1
v_mov_b32 v2, 32
s_mov_b64 exec, 1
.Lwl_291:
buffer_load_dword v3, v1, s[88:91], 0 offen sc1
s_waitcnt vmcnt(0)
v_cmp_lt_u32 vcc, v3, v2
s_cbranch_vccz .Lwo_292
s_cmp_eq_u32 s80, 0
s_cbranch_scc1 .Lwo_292
s_sub_u32 s80, s80, 1
s_branch .Lwl_291
.Lwo_292:
s_mov_b64 exec, -1
.Lws_290:
s_barrier
buffer_load_dwordx4 v[8:11], v140, s[40:43], s48 offen offset:0 sc1
buffer_load_dwordx4 v[12:15], v140, s[40:43], s48 offen offset:1024 sc1
buffer_load_dwordx4 v[16:19], v140, s[40:43], s48 offen offset:2048 sc1
buffer_load_dwordx4 v[20:23], v140, s[40:43], s48 offen offset:3072 sc1
s_add_u32 s48, s48, 4096
buffer_load_dwordx4 v[24:27], v140, s[40:43], s48 offen offset:0 sc1
buffer_load_dwordx4 v[28:31], v140, s[40:43], s48 offen offset:1024 sc1
buffer_load_dwordx4 v[32:35], v140, s[40:43], s48 offen offset:2048 sc1
buffer_load_dwordx4 v[36:39], v140, s[40:43], s48 offen offset:3072 sc1
s_add_u32 s48, s48, 4096
buffer_load_dwordx4 v[40:43], v140, s[40:43], s48 offen offset:0 sc1
buffer_load_dwordx4 v[44:47], v140, s[40:43], s48 offen offset:1024 sc1
buffer_load_dwordx4 v[48:51], v140, s[40:43], s48 offen offset:2048 sc1
buffer_load_dwordx4 v[52:55], v140, s[40:43], s48 offen offset:3072 sc1
s_add_u32 s48, s48, 4096
buffer_load_dwordx4 v[56:59], v140, s[40:43], s48 offen offset:0 sc1
buffer_load_dwordx4 v[60:63], v140, s[40:43], s48 offen offset:1024 sc1
v_accvgpr_write_b32 a0, 0
v_accvgpr_write_b32 a1, 0
v_accvgpr_write_b32 a2, 0
v_accvgpr_write_b32 a3, 0
v_accvgpr_write_b32 a4, 0
v_accvgpr_write_b32 a5, 0
v_accvgpr_write_b32 a6, 0
v_accvgpr_write_b32 a7, 0
v_accvgpr_write_b32 a8, 0
v_accvgpr_write_b32 a9, 0
v_accvgpr_write_b32 a10, 0
v_accvgpr_write_b32 a11, 0
v_accvgpr_write_b32 a12, 0
v_accvgpr_write_b32 a13, 0
v_accvgpr_write_b32 a14, 0
v_accvgpr_write_b32 a15, 0
v_accvgpr_write_b32 a16, 0
v_accvgpr_write_b32 a17, 0
v_accvgpr_write_b32 a18, 0
v_accvgpr_write_b32 a19, 0
v_accvgpr_write_b32 a20, 0
v_accvgpr_write_b32 a21, 0
v_accvgpr_write_b32 a22, 0
v_accvgpr_write_b32 a23, 0
v_accvgpr_write_b32 a24, 0
v_accvgpr_write_b32 a25, 0
v_accvgpr_write_b32 a26, 0
v_accvgpr_write_b32 a27, 0
v_accvgpr_write_b32 a28, 0
v_accvgpr_write_b32 a29, 0
v_accvgpr_write_b32 a30, 0
v_accvgpr_write_b32 a31, 0
s_waitcnt vmcnt(10)
s_barrier
s_mov_b32 s51, 0
s_add_u32 s52, s56, 98304
v_mov_b32 v138, v136
v_mov_b32 v139, v137
ds_read_b64_tr_b16 v[72:73], v138 offset:0
ds_read_b64_tr_b16 v[74:75], v138 offset:1024
ds_read_b64_tr_b16 v[76:77], v139 offset:0
ds_read_b64_tr_b16 v[78:79], v139 offset:1024
ds_read_b64_tr_b16 v[80:81], v138 offset:2048
ds_read_b64_tr_b16 v[82:83], v138 offset:3072
ds_read_b64_tr_b16 v[84:85], v139 offset:2048
ds_read_b64_tr_b16 v[86:87], v139 offset:3072
ds_read_b64_tr_b16 v[88:89], v138 offset:4096
ds_read_b64_tr_b16 v[90:91], v138 offset:5120
ds_read_b64_tr_b16 v[92:93], v139 offset:4096
ds_read_b64_tr_b16 v[94:95], v139 offset:5120
ds_read_b64_tr_b16 v[96:97], v138 offset:6144
ds_read_b64_tr_b16 v[98:99], v138 offset:7168
ds_read_b64_tr_b16 v[100:101], v139 offset:6144
ds_read_b64_tr_b16 v[102:103], v139 offset:7168
.LgB_294:
s_waitcnt lgkmcnt(8)
v_mfma_f32_32x32x16_bf16 a[0:15], v[72:75], v[8:11], a[0:15]
s_waitcnt vmcnt(8)
s_barrier
ds_read_b64_tr_b16 v[104:105], v138 offset:8192
ds_read_b64_tr_b16 v[106:107], v138 offset:9216
v_mfma_f32_32x32x16_bf16 a[16:31], v[76:79], v[8:11], a[16:31]
ds_read_b64_tr_b16 v[108:109], v139 offset:8192
ds_read_b64_tr_b16 v[110:111], v139 offset:9216
buffer_load_dwordx4 v[64:67], v140, s[40:43], s48 offen offset:2048 sc1
v_mfma_f32_32x32x16_bf16 a[0:15], v[80:83], v[12:15], a[0:15]
ds_read_b64_tr_b16 v[112:113], v138 offset:10240
ds_read_b64_tr_b16 v[114:115], v138 offset:11264
buffer_load_dwordx4 v[68:71], v140, s[40:43], s48 offen offset:3072 sc1
s_add_u32 s48, s48, 4096
v_mfma_f32_32x32x16_bf16 a[16:31], v[84:87], v[12:15], a[16:31]
ds_read_b64_tr_b16 v[116:117], v139 offset:10240
ds_read_b64_tr_b16 v[118:119], v139 offset:11264
s_cmp_eq_u32 s50, 8
s_cselect_b32 s42, 0, s42
s_waitcnt lgkmcnt(8)
v_mfma_f32_32x32x16_bf16 a[0:15], v[88:91], v[16:19], a[0:15]
s_waitcnt vmcnt(8)
s_barrier
ds_read_b64_tr_b16 v[120:121], v138 offset:12288
ds_read_b64_tr_b16 v[122:123], v138 offset:13312
v_mfma_f32_32x32x16_bf16 a[16:31], v[92:95], v[16:19], a[16:31]
ds_read_b64_tr_b16 v[124:125], v139 offset:12288
ds_read_b64_tr_b16 v[126:127], v139 offset:13312
buffer_load_dwordx4 v[8:11], v140, s[40:43], s48 offen offset:0 sc1
v_mfma_f32_32x32x16_bf16 a[0:15], v[96:99], v[20:23], a[0:15]
ds_read_b64_tr_b16 v[128:129], v138 offset:14336
ds_read_b64_tr_b16 v[130:131], v138 offset:15360
buffer_load_dwordx4 v[12:15], v140, s[40:43], s48 offen offset:1024 sc1
v_mfma_f32_32x32x16_bf16 a[16:31], v[100:103], v[20:23], a[16:31]
ds_read_b64_tr_b16 v[132:133], v139 offset:14336
ds_read_b64_tr_b16 v[134:135], v139 offset:15360
s_waitcnt lgkmcnt(8)
v_mfma_f32_32x32x16_bf16 a[0:15], v[104:107], v[24:27], a[0:15]
s_waitcnt vmcnt(8)
s_barrier
ds_read_b64_tr_b16 v[72:73], v138 offset:16384
ds_read_b64_tr_b16 v[74:75], v138 offset:17408
v_mfma_f32_32x32x16_bf16 a[16:31], v[108:111], v[24:27], a[16:31]
ds_read_b64_tr_b16 v[76:77], v139 offset:16384
ds_read_b64_tr_b16 v[78:79], v139 offset:17408
buffer_load_dwordx4 v[16:19], v140, s[40:43], s48 offen offset:2048 sc1
v_mfma_f32_32x32x16_bf16 a[0:15], v[112:115], v[28:31], a[0:15]
ds_read_b64_tr_b16 v[80:81], v138 offset:18432
ds_read_b64_tr_b16 v[82:83], v138 offset:19456
buffer_load_dwordx4 v[20:23], v140, s[40:43], s48 offen offset:3072 sc1
s_add_u32 s48, s48, 4096
v_mfma_f32_32x32x16_bf16 a[16:31], v[116:119], v[28:31], a[16:31]
ds_read_b64_tr_b16 v[84:85], v139 offset:18432
ds_read_b64_tr_b16 v[86:87], v139 offset:19456
s_waitcnt lgkmcnt(8)
v_mfma_f32_32x32x16_bf16 a[0:15], v[120:123], v[32:35], a[0:15]
s_waitcnt vmcnt(8)
s_barrier
ds_read_b64_tr_b16 v[88:89], v138 offset:20480
ds_read_b64_tr_b16 v[90:91], v138 offset:21504
v_mfma_f32_32x32x16_bf16 a[16:31], v[124:127], v[32:35], a[16:31]
ds_read_b64_tr_b16 v[92:93], v139 offset:20480
ds_read_b64_tr_b16 v[94:95], v139 offset:21504
buffer_load_dwordx4 v[24:27], v140, s[40:43], s48 offen offset:0 sc1
v_mfma_f32_32x32x16_bf16 a[0:15], v[128:131], v[36:39], a[0:15]
ds_read_b64_tr_b16 v[96:97], v138 offset:22528
ds_read_b64_tr_b16 v[98:99], v138 offset:23552
buffer_load_dwordx4 v[28:31], v140, s[40:43], s48 offen offset:1024 sc1
v_mfma_f32_32x32x16_bf16 a[16:31], v[132:135], v[36:39], a[16:31]
ds_read_b64_tr_b16 v[100:101], v139 offset:22528
ds_read_b64_tr_b16 v[102:103], v139 offset:23552
s_waitcnt lgkmcnt(8)
v_mfma_f32_32x32x16_bf16 a[0:15], v[72:75], v[40:43], a[0:15]
s_waitcnt vmcnt(8)
s_barrier
ds_read_b64_tr_b16 v[104:105], v138 offset:24576
ds_read_b64_tr_b16 v[106:107], v138 offset:25600
v_mfma_f32_32x32x16_bf16 a[16:31], v[76:79], v[40:43], a[16:31]
ds_read_b64_tr_b16 v[108:109], v139 offset:24576
ds_read_b64_tr_b16 v[110:111], v139 offset:25600
buffer_load_dwordx4 v[32:35], v140, s[40:43], s48 offen offset:2048 sc1
v_mfma_f32_32x32x16_bf16 a[0:15], v[80:83], v[44:47], a[0:15]
ds_read_b64_tr_b16 v[112:113], v138 offset:26624
ds_read_b64_tr_b16 v[114:115], v138 offset:27648
buffer_load_dwordx4 v[36:39], v140, s[40:43], s48 offen offset:3072 sc1
s_add_u32 s48, s48, 4096
v_mfma_f32_32x32x16_bf16 a[16:31], v[84:87], v[44:47], a[16:31]
ds_read_b64_tr_b16 v[116:117], v139 offset:26624
ds_read_b64_tr_b16 v[118:119], v139 offset:27648
s_waitcnt lgkmcnt(8)
v_mfma_f32_32x32x16_bf16 a[0:15], v[88:91], v[48:51], a[0:15]
s_waitcnt vmcnt(8)
s_barrier
ds_read_b64_tr_b16 v[120:121], v138 offset:28672
ds_read_b64_tr_b16 v[122:123], v138 offset:29696
v_mfma_f32_32x32x16_bf16 a[16:31], v[92:95], v[48:51], a[16:31]
ds_read_b64_tr_b16 v[124:125], v139 offset:28672
ds_read_b64_tr_b16 v[126:127], v139 offset:29696
buffer_load_dwordx4 v[40:43], v140, s[40:43], s48 offen offset:0 sc1
v_mfma_f32_32x32x16_bf16 a[0:15], v[96:99], v[52:55], a[0:15]
ds_read_b64_tr_b16 v[128:129], v138 offset:30720
ds_read_b64_tr_b16 v[130:131], v138 offset:31744
buffer_load_dwordx4 v[44:47], v140, s[40:43], s48 offen offset:1024 sc1
v_mfma_f32_32x32x16_bf16 a[16:31], v[100:103], v[52:55], a[16:31]
ds_read_b64_tr_b16 v[132:133], v139 offset:30720
ds_read_b64_tr_b16 v[134:135], v139 offset:31744
s_waitcnt lgkmcnt(8)
v_mfma_f32_32x32x16_bf16 a[0:15], v[104:107], v[56:59], a[0:15]
s_waitcnt vmcnt(8)
s_barrier
s_add_u32 s58, s51, s56
s_add_u32 s51, s51, 32768
s_cmp_eq_u32 s51, 131072
s_cselect_b32 s51, 0, s51
v_add_u32 v138, s51, v136
v_add_u32 v139, s51, v137
ds_read_b64_tr_b16 v[72:73], v138 offset:0
ds_read_b64_tr_b16 v[74:75], v138 offset:1024
v_mfma_f32_32x32x16_bf16 a[16:31], v[108:111], v[56:59], a[16:31]
ds_read_b64_tr_b16 v[76:77], v139 offset:0
ds_read_b64_tr_b16 v[78:79], v139 offset:1024
buffer_load_dwordx4 v[48:51], v140, s[40:43], s48 offen offset:2048 sc1
v_mfma_f32_32x32x16_bf16 a[0:15], v[112:115], v[60:63], a[0:15]
ds_read_b64_tr_b16 v[80:81], v138 offset:2048
ds_read_b64_tr_b16 v[82:83], v138 offset:3072
buffer_load_dwordx4 v[52:55], v140, s[40:43], s48 offen offset:3072 sc1
s_add_u32 s48, s48, 4096
v_mfma_f32_32x32x16_bf16 a[16:31], v[116:119], v[60:63], a[16:31]
ds_read_b64_tr_b16 v[84:85], v139 offset:2048
ds_read_b64_tr_b16 v[86:87], v139 offset:3072
s_waitcnt lgkmcnt(8)
v_mfma_f32_32x32x16_bf16 a[0:15], v[120:123], v[64:67], a[0:15]
s_waitcnt vmcnt(8)
s_barrier
ds_read_b64_tr_b16 v[88:89], v138 offset:4096
ds_read_b64_tr_b16 v[90:91], v138 offset:5120
v_mfma_f32_32x32x16_bf16 a[16:31], v[124:127], v[64:67], a[16:31]
ds_read_b64_tr_b16 v[92:93], v139 offset:4096
ds_read_b64_tr_b16 v[94:95], v139 offset:5120
buffer_load_dwordx4 v[56:59], v140, s[40:43], s48 offen offset:0 sc1
v_mfma_f32_32x32x16_bf16 a[0:15], v[128:131], v[68:71], a[0:15]
ds_read_b64_tr_b16 v[96:97], v138 offset:6144
ds_read_b64_tr_b16 v[98:99], v138 offset:7168
buffer_load_dwordx4 v[60:63], v140, s[40:43], s48 offen offset:1024 sc1
v_mfma_f32_32x32x16_bf16 a[16:31], v[132:135], v[68:71], a[16:31]
ds_read_b64_tr_b16 v[100:101], v139 offset:6144
ds_read_b64_tr_b16 v[102:103], v139 offset:7168
s_sub_u32 s50, s50, 8
s_cmp_lg_u32 s50, 0
s_cbranch_scc1 .LgB_294
s_waitcnt vmcnt(0) lgkmcnt(0)
s_nop 15
s_add_u32 s57, s12, 0
v_accvgpr_read_b32 v8, a0
v_accvgpr_read_b32 v9, a1
v_accvgpr_read_b32 v10, a2
v_accvgpr_read_b32 v11, a3
v_accvgpr_read_b32 v12, a4
v_accvgpr_read_b32 v13, a5
v_accvgpr_read_b32 v14, a6
v_accvgpr_read_b32 v15, a7
v_max_f32 v8, 0, v8
v_max_f32 v9, 0, v9
v_max_f32 v10, 0, v10
v_max_f32 v11, 0, v11
v_max_f32 v12, 0, v12
v_max_f32 v13, 0, v13
v_max_f32 v14, 0, v14
v_max_f32 v15, 0, v15
v_cvt_pk_bf16_f32 v16, v8, v9
v_cvt_pk_bf16_f32 v17, v10, v11
v_cvt_pk_bf16_f32 v18, v12, v13
v_cvt_pk_bf16_f32 v19, v14, v15
buffer_store_dwordx4 v[16:19], v4, s[36:39], s57 offen offset:0 sc1
v_accvgpr_read_b32 v20, a8
v_accvgpr_read_b32 v21, a9
v_accvgpr_read_b32 v22, a10
v_accvgpr_read_b32 v23, a11
v_accvgpr_read_b32 v24, a12
v_accvgpr_read_b32 v25, a13
v_accvgpr_read_b32 v26, a14
v_accvgpr_read_b32 v27, a15
v_max_f32 v20, 0, v20
v_max_f32 v21, 0, v21
v_max_f32 v22, 0, v22
v_max_f32 v23, 0, v23
v_max_f32 v24, 0, v24
v_max_f32 v25, 0, v25
v_max_f32 v26, 0, v26
v_max_f32 v27, 0, v27
v_cvt_pk_bf16_f32 v28, v20, v21
v_cvt_pk_bf16_f32 v29, v22, v23
v_cvt_pk_bf16_f32 v30, v24, v25
v_cvt_pk_bf16_f32 v31, v26, v27
buffer_store_dwordx4 v[28:31], v4, s[36:39], s57 offen offset:1024 sc1
v_accvgpr_read_b32 v8, a16
v_accvgpr_read_b32 v9, a17
v_accvgpr_read_b32 v10, a18
v_accvgpr_read_b32 v11, a19
v_accvgpr_read_b32 v12, a20
v_accvgpr_read_b32 v13, a21
v_accvgpr_read_b32 v14, a22
v_accvgpr_read_b32 v15, a23
v_max_f32 v8, 0, v8
v_max_f32 v9, 0, v9
v_max_f32 v10, 0, v10
v_max_f32 v11, 0, v11
v_max_f32 v12, 0, v12
v_max_f32 v13, 0, v13
v_max_f32 v14, 0, v14
v_max_f32 v15, 0, v15
v_cvt_pk_bf16_f32 v16, v8, v9
v_cvt_pk_bf16_f32 v17, v10, v11
v_cvt_pk_bf16_f32 v18, v12, v13
v_cvt_pk_bf16_f32 v19, v14, v15
buffer_store_dwordx4 v[16:19], v4, s[36:39], s57 offen offset:2048 sc1
v_accvgpr_read_b32 v20, a24
v_accvgpr_read_b32 v21, a25
v_accvgpr_read_b32 v22, a26
v_accvgpr_read_b32 v23, a27
v_accvgpr_read_b32 v24, a28
v_accvgpr_read_b32 v25, a29
v_accvgpr_read_b32 v26, a30
v_accvgpr_read_b32 v27, a31
v_max_f32 v20, 0, v20
v_max_f32 v21, 0, v21
v_max_f32 v22, 0, v22
v_max_f32 v23, 0, v23
v_max_f32 v24, 0, v24
v_max_f32 v25, 0, v25
v_max_f32 v26, 0, v26
v_max_f32 v27, 0, v27
v_cvt_pk_bf16_f32 v28, v20, v21
v_cvt_pk_bf16_f32 v29, v22, v23
v_cvt_pk_bf16_f32 v30, v24, v25
v_cvt_pk_bf16_f32 v31, v26, v27
buffer_store_dwordx4 v[28:31], v4, s[36:39], s57 offen offset:3072 sc1
.Lnf_289:
s_add_u32 s86, s70, 119589888
s_bfe_u32 s82, s77, 0x10000
s_mul_i32 s82, s82, 512
s_add_u32 s86, s86, s82
s_bfe_u32 s82, s76, 0x20000
s_mul_i32 s82, s82, 128
s_add_u32 s86, s86, s82
s_waitcnt vmcnt(0)
s_barrier
s_cmp_lg_u32 s3, 0
s_cbranch_scc1 .Lsg_295
v_mov_b32 v1, 1
v_mul_u32_u24 v2, 0, v0
s_mov_b64 exec, 1
buffer_atomic_add v1, v2, s[88:91], s86 offen sc1
s_mov_b64 exec, -1
.Lsg_295:
s_and_b32 s84, s77, 1
s_add_u32 s84, s84, 14
s_lshr_b32 s85, s77, 1
s_load_dwordx2 s[6:7], s[0:1], 72
s_add_u32 s40, s4, 0x5000000
s_addc_u32 s41, s5, 0
s_mov_b32 s42, 0xe00000
s_mov_b32 s43, 0x00020000
s_and_b32 s18, s85, 7
s_mov_b32 s19, 2048
s_cmp_eq_u32 s18, 3
s_cselect_b32 s19, 128, s19
v_lshrrev_b32 v142, 2, v0
v_and_b32 v142, 3, v142
v_lshrrev_b32 v143, 5, v0
v_lshlrev_b32 v143, 2, v143
v_add_u32 v143, v143, v142
v_mul_u32_u24 v143, 128, v143
v_and_b32 v144, 3, v0
v_lshlrev_b32 v144, 3, v144
v_add_u32 v143, v143, v144
v_and_b32 v144, 16, v0
v_lshlrev_b32 v144, 1, v144
v_add_u32 v143, v143, v144
v_lshrrev_b32 v142, 1, v142
s_and_b32 s53, s3, 0
s_mul_i32 s53, s53, 2
s_add_u32 s57, s53, 0
v_xor_b32 v144, s57, v142
v_lshlrev_b32 v144, 6, v144
v_add_u32 v136, v143, v144
s_add_u32 s57, s53, 1
v_xor_b32 v144, s57, v142
v_lshlrev_b32 v144, 6, v144
v_add_u32 v137, v143, v144
s_lshr_b32 s53, s3, 0
s_mul_i32 s53, s53, 229376
v_lshlrev_b32 v140, 4, v0
v_add_u32 v140, s53, v140
v_lshrrev_b32 v142, 3, v0
s_mul_i32 s53, s3, 8
v_add_u32 v142, s53, v142
v_and_b32 v143, 3, v142
v_lshrrev_b32 v143, 1, v143
v_and_b32 v144, 7, v0
v_lshrrev_b32 v144, 2, v144
v_xor_b32 v143, v143, v144
v_lshlrev_b32 v143, 6, v143
v_and_b32 v144, 3, v0
v_lshlrev_b32 v144, 4, v144
v_add_u32 v143, v143, v144
s_mov_b32 s53, s19
v_mul_lo_u32 v142, v142, s53
v_add_u32 v141, v142, v143
s_mul_i32 s54, s53, 32
s_lshl_b32 s56, s3, 10
s_waitcnt lgkmcnt(0)
s_mul_i32 s48, s84, 917504
s_mul_i32 s49, s85, 128
s_mov_b32 s50, 112
s_add_u32 s16, s4, 114294784
s_addc_u32 s17, s5, 0
s_lshr_b32 s18, s85, 3
s_lshl_b32 s18, s18, 19
s_cmp_eq_u32 s19, 128
s_cselect_b32 s6, s16, s6
s_cselect_b32 s7, s17, s7
s_cselect_b32 s49, s18, s49
s_mul_i32 s18, s76, 32
s_mov_b32 s50, 32
s_cmp_ge_u32 s76, 2
s_cselect_b32 s50, 24, 32
s_cmp_eq_u32 s76, 3
s_cselect_b32 s18, 88, s18
s_lshl_b32 s16, s18, 11
s_add_u32 s48, s48, s16
s_mul_i32 s16, s18, s19
s_lshl_b32 s16, s16, 5
s_add_u32 s49, s49, s16
s_mov_b32 s44, s6
s_mov_b32 s45, s7
s_mov_b32 s46, 0x700000
s_mov_b32 s47, 0x00020000
s_add_u32 m0, s56, 0
s_nop 0
buffer_load_dwordx4 v141, s[44:47], s49 offen lds
s_add_u32 s49, s49, s54
s_add_u32 m0, s56, 4096
s_nop 0
buffer_load_dwordx4 v141, s[44:47], s49 offen lds
s_add_u32 s49, s49, s54
s_add_u32 m0, s56, 8192
s_nop 0
buffer_load_dwordx4 v141, s[44:47], s49 offen lds
s_add_u32 s49, s49, s54
s_add_u32 m0, s56, 12288
s_nop 0
buffer_load_dwordx4 v141, s[44:47], s49 offen lds
s_add_u32 s49, s49, s54
s_add_u32 m0, s56, 16384
s_nop 0
buffer_load_dwordx4 v141, s[44:47], s49 offen lds
s_add_u32 s49, s49, s54
s_add_u32 m0, s56, 20480
s_nop 0
buffer_load_dwordx4 v141, s[44:47], s49 offen lds
s_add_u32 s49, s49, s54
s_add_u32 m0, s56, 24576
s_nop 0
buffer_load_dwordx4 v141, s[44:47], s49 offen lds
s_add_u32 s49, s49, s54
s_add_u32 m0, s56, 28672
s_nop 0
buffer_load_dwordx4 v141, s[44:47], s49 offen lds
s_add_u32 s49, s49, s54
s_add_u32 m0, s56, 32768
s_nop 0
buffer_load_dwordx4 v141, s[44:47], s49 offen lds
s_add_u32 s49, s49, s54
s_add_u32 m0, s56, 36864
s_nop 0
buffer_load_dwordx4 v141, s[44:47], s49 offen lds
s_add_u32 s49, s49, s54
s_add_u32 m0, s56, 40960
s_nop 0
buffer_load_dwordx4 v141, s[44:47], s49 offen lds
s_add_u32 s49, s49, s54
s_add_u32 m0, s56, 45056
s_nop 0
buffer_load_dwordx4 v141, s[44:47], s49 offen lds
s_add_u32 s49, s49, s54
s_add_u32 m0, s56, 49152
s_nop 0
buffer_load_dwordx4 v141, s[44:47], s49 offen lds
s_add_u32 s49, s49, s54
s_add_u32 m0, s56, 53248
s_nop 0
buffer_load_dwordx4 v141, s[44:47], s49 offen lds
s_add_u32 s49, s49, s54
s_add_u32 m0, s56, 57344
s_nop 0
buffer_load_dwordx4 v141, s[44:47], s49 offen lds
s_add_u32 s49, s49, s54
s_add_u32 m0, s56, 61440
s_nop 0
buffer_load_dwordx4 v141, s[44:47], s49 offen lds
s_add_u32 s49, s49, s54
s_add_u32 m0, s56, 65536
s_nop 0
buffer_load_dwordx4 v141, s[44:47], s49 offen lds
s_add_u32 s49, s49, s54
s_add_u32 m0, s56, 69632
s_nop 0
buffer_load_dwordx4 v141, s[44:47], s49 offen lds
s_add_u32 s49, s49, s54
s_add_u32 m0, s56, 73728
s_nop 0
buffer_load_dwordx4 v141, s[44:47], s49 offen lds
s_add_u32 s49, s49, s54
s_add_u32 m0, s56, 77824
s_nop 0
buffer_load_dwordx4 v141, s[44:47], s49 offen lds
s_add_u32 s49, s49, s54
s_add_u32 m0, s56, 81920
s_nop 0
buffer_load_dwordx4 v141, s[44:47], s49 offen lds
s_add_u32 s49, s49, s54
s_add_u32 m0, s56, 86016
s_nop 0
buffer_load_dwordx4 v141, s[44:47], s49 offen lds
s_add_u32 s49, s49, s54
s_add_u32 m0, s56, 90112
s_nop 0
buffer_load_dwordx4 v141, s[44:47], s49 offen lds
s_add_u32 s49, s49, s54
s_add_u32 m0, s56, 94208
s_nop 0
buffer_load_dwordx4 v141, s[44:47], s49 offen lds
s_add_u32 s49, s49, s54
s_add_u32 m0, s56, 98304
s_nop 0
buffer_load_dwordx4 v141, s[44:47], s49 offen lds
s_add_u32 s49, s49, s54
s_add_u32 m0, s56, 102400
s_nop 0
buffer_load_dwordx4 v141, s[44:47], s49 offen lds
s_add_u32 s49, s49, s54
s_add_u32 m0, s56, 106496
s_nop 0
buffer_load_dwordx4 v141, s[44:47], s49 offen lds
s_add_u32 s49, s49, s54
s_add_u32 m0, s56, 110592
s_nop 0
buffer_load_dwordx4 v141, s[44:47], s49 offen lds
s_add_u32 s49, s49, s54
s_add_u32 m0, s56, 114688
s_nop 0
buffer_load_dwordx4 v141, s[44:47], s49 offen lds
s_add_u32 s49, s49, s54
s_add_u32 m0, s56, 118784
s_nop 0
buffer_load_dwordx4 v141, s[44:47], s49 offen lds
s_add_u32 s49, s49, s54
s_add_u32 m0, s56, 122880
s_nop 0
buffer_load_dwordx4 v141, s[44:47], s49 offen lds
s_add_u32 s49, s49, s54
s_add_u32 m0, s56, 126976
s_nop 0
buffer_load_dwordx4 v141, s[44:47], s49 offen lds
s_add_u32 s49, s49, s54
s_lshr_b32 s16, s3, 0
s_mul_i32 s16, s16, 1
s_mul_i32 s18, s84, 4
s_add_u32 s16, s16, s18
s_and_b32 s17, s3, 0
s_mul_i32 s17, s17, 4
s_mul_i32 s18, s85, 4
s_add_u32 s17, s17, s18
v_lshlrev_b32 v4, 4, v0
s_add_u32 s36, s4, 0x7000000
s_addc_u32 s37, s5, 0
s_mov_b32 s38, 0x400000
s_mov_b32 s39, 0x00020000
s_and_b32 s16, s16, 7
s_lshl_b32 s12, s16, 17
s_lshl_b32 s18, s17, 11
s_add_u32 s12, s12, s18
s_lshl_b32 s18, s76, 20
s_add_u32 s12, s12, s18
v_bfe_u32 v4, v0, 2, 3
v_lshlrev_b32 v4, 7, v4
v_lshrrev_b32 v5, 5, v0
v_lshl_add_u32 v4, v5, 6, v4
v_and_b32 v5, 3, v0
v_lshl_add_u32 v4, v5, 4, v4
s_cmp_lg_u32 s3, 0
s_cbranch_scc1 .Lws_296
v_mul_u32_u24 v1, 0, v0
v_add_u32 v1, s86, v1
v_mov_b32 v2, 16
s_mov_b64 exec, 1
.Lwl_297:
buffer_load_dword v3, v1, s[88:91], 0 offen sc1
s_waitcnt vmcnt(0)
v_cmp_lt_u32 vcc, v3, v2
s_cbranch_vccz .Lwo_298
s_cmp_eq_u32 s80, 0
s_cbranch_scc1 .Lwo_298
s_sub_u32 s80, s80, 1
s_branch .Lwl_297
.Lwo_298:
s_mov_b64 exec, -1
.Lws_296:
s_barrier
buffer_load_dwordx4 v[8:11], v140, s[40:43], s48 offen offset:0 sc1
buffer_load_dwordx4 v[12:15], v140, s[40:43], s48 offen offset:1024 sc1
buffer_load_dwordx4 v[16:19], v140, s[40:43], s48 offen offset:2048 sc1
buffer_load_dwordx4 v[20:23], v140, s[40:43], s48 offen offset:3072 sc1
s_add_u32 s48, s48, 4096
buffer_load_dwordx4 v[24:27], v140, s[40:43], s48 offen offset:0 sc1
buffer_load_dwordx4 v[28:31], v140, s[40:43], s48 offen offset:1024 sc1
buffer_load_dwordx4 v[32:35], v140, s[40:43], s48 offen offset:2048 sc1
buffer_load_dwordx4 v[36:39], v140, s[40:43], s48 offen offset:3072 sc1
s_add_u32 s48, s48, 4096
buffer_load_dwordx4 v[40:43], v140, s[40:43], s48 offen offset:0 sc1
buffer_load_dwordx4 v[44:47], v140, s[40:43], s48 offen offset:1024 sc1
buffer_load_dwordx4 v[48:51], v140, s[40:43], s48 offen offset:2048 sc1
buffer_load_dwordx4 v[52:55], v140, s[40:43], s48 offen offset:3072 sc1
s_add_u32 s48, s48, 4096
buffer_load_dwordx4 v[56:59], v140, s[40:43], s48 offen offset:0 sc1
buffer_load_dwordx4 v[60:63], v140, s[40:43], s48 offen offset:1024 sc1
v_accvgpr_write_b32 a0, 0
v_accvgpr_write_b32 a1, 0
v_accvgpr_write_b32 a2, 0
v_accvgpr_write_b32 a3, 0
v_accvgpr_write_b32 a4, 0
v_accvgpr_write_b32 a5, 0
v_accvgpr_write_b32 a6, 0
v_accvgpr_write_b32 a7, 0
v_accvgpr_write_b32 a8, 0
v_accvgpr_write_b32 a9, 0
v_accvgpr_write_b32 a10, 0
v_accvgpr_write_b32 a11, 0
v_accvgpr_write_b32 a12, 0
v_accvgpr_write_b32 a13, 0
v_accvgpr_write_b32 a14, 0
v_accvgpr_write_b32 a15, 0
v_accvgpr_write_b32 a16, 0
v_accvgpr_write_b32 a17, 0
v_accvgpr_write_b32 a18, 0
v_accvgpr_write_b32 a19, 0
v_accvgpr_write_b32 a20, 0
v_accvgpr_write_b32 a21, 0
v_accvgpr_write_b32 a22, 0
v_accvgpr_write_b32 a23, 0
v_accvgpr_write_b32 a24, 0
v_accvgpr_write_b32 a25, 0
v_accvgpr_write_b32 a26, 0
v_accvgpr_write_b32 a27, 0
v_accvgpr_write_b32 a28, 0
v_accvgpr_write_b32 a29, 0
v_accvgpr_write_b32 a30, 0
v_accvgpr_write_b32 a31, 0
s_waitcnt vmcnt(10)
s_barrier
s_mov_b32 s51, 0
s_add_u32 s52, s56, 98304
v_mov_b32 v138, v136
v_mov_b32 v139, v137
ds_read_b64_tr_b16 v[72:73], v138 offset:0
ds_read_b64_tr_b16 v[74:75], v138 offset:1024
ds_read_b64_tr_b16 v[76:77], v139 offset:0
ds_read_b64_tr_b16 v[78:79], v139 offset:1024
ds_read_b64_tr_b16 v[80:81], v138 offset:2048
ds_read_b64_tr_b16 v[82:83], v138 offset:3072
ds_read_b64_tr_b16 v[84:85], v139 offset:2048
ds_read_b64_tr_b16 v[86:87], v139 offset:3072
ds_read_b64_tr_b16 v[88:89], v138 offset:4096
ds_read_b64_tr_b16 v[90:91], v138 offset:5120
ds_read_b64_tr_b16 v[92:93], v139 offset:4096
ds_read_b64_tr_b16 v[94:95], v139 offset:5120
ds_read_b64_tr_b16 v[96:97], v138 offset:6144
ds_read_b64_tr_b16 v[98:99], v138 offset:7168
ds_read_b64_tr_b16 v[100:101], v139 offset:6144
ds_read_b64_tr_b16 v[102:103], v139 offset:7168
.LgB_300:
s_waitcnt lgkmcnt(8)
v_mfma_f32_32x32x16_bf16 a[0:15], v[72:75], v[8:11], a[0:15]
s_waitcnt vmcnt(8)
s_barrier
ds_read_b64_tr_b16 v[104:105], v138 offset:8192
ds_read_b64_tr_b16 v[106:107], v138 offset:9216
v_mfma_f32_32x32x16_bf16 a[16:31], v[76:79], v[8:11], a[16:31]
ds_read_b64_tr_b16 v[108:109], v139 offset:8192
ds_read_b64_tr_b16 v[110:111], v139 offset:9216
buffer_load_dwordx4 v[64:67], v140, s[40:43], s48 offen offset:2048 sc1
v_mfma_f32_32x32x16_bf16 a[0:15], v[80:83], v[12:15], a[0:15]
ds_read_b64_tr_b16 v[112:113], v138 offset:10240
ds_read_b64_tr_b16 v[114:115], v138 offset:11264
buffer_load_dwordx4 v[68:71], v140, s[40:43], s48 offen offset:3072 sc1
s_add_u32 s48, s48, 4096
v_mfma_f32_32x32x16_bf16 a[16:31], v[84:87], v[12:15], a[16:31]
ds_read_b64_tr_b16 v[116:117], v139 offset:10240
ds_read_b64_tr_b16 v[118:119], v139 offset:11264
s_cmp_eq_u32 s50, 8
s_cselect_b32 s42, 0, s42
s_waitcnt lgkmcnt(8)
v_mfma_f32_32x32x16_bf16 a[0:15], v[88:91], v[16:19], a[0:15]
s_waitcnt vmcnt(8)
s_barrier
ds_read_b64_tr_b16 v[120:121], v138 offset:12288
ds_read_b64_tr_b16 v[122:123], v138 offset:13312
v_mfma_f32_32x32x16_bf16 a[16:31], v[92:95], v[16:19], a[16:31]
ds_read_b64_tr_b16 v[124:125], v139 offset:12288
ds_read_b64_tr_b16 v[126:127], v139 offset:13312
buffer_load_dwordx4 v[8:11], v140, s[40:43], s48 offen offset:0 sc1
v_mfma_f32_32x32x16_bf16 a[0:15], v[96:99], v[20:23], a[0:15]
ds_read_b64_tr_b16 v[128:129], v138 offset:14336
ds_read_b64_tr_b16 v[130:131], v138 offset:15360
buffer_load_dwordx4 v[12:15], v140, s[40:43], s48 offen offset:1024 sc1
v_mfma_f32_32x32x16_bf16 a[16:31], v[100:103], v[20:23], a[16:31]
ds_read_b64_tr_b16 v[132:133], v139 offset:14336
ds_read_b64_tr_b16 v[134:135], v139 offset:15360
s_waitcnt lgkmcnt(8)
v_mfma_f32_32x32x16_bf16 a[0:15], v[104:107], v[24:27], a[0:15]
s_waitcnt vmcnt(8)
s_barrier
ds_read_b64_tr_b16 v[72:73], v138 offset:16384
ds_read_b64_tr_b16 v[74:75], v138 offset:17408
v_mfma_f32_32x32x16_bf16 a[16:31], v[108:111], v[24:27], a[16:31]
ds_read_b64_tr_b16 v[76:77], v139 offset:16384
ds_read_b64_tr_b16 v[78:79], v139 offset:17408
buffer_load_dwordx4 v[16:19], v140, s[40:43], s48 offen offset:2048 sc1
v_mfma_f32_32x32x16_bf16 a[0:15], v[112:115], v[28:31], a[0:15]
ds_read_b64_tr_b16 v[80:81], v138 offset:18432
ds_read_b64_tr_b16 v[82:83], v138 offset:19456
buffer_load_dwordx4 v[20:23], v140, s[40:43], s48 offen offset:3072 sc1
s_add_u32 s48, s48, 4096
v_mfma_f32_32x32x16_bf16 a[16:31], v[116:119], v[28:31], a[16:31]
ds_read_b64_tr_b16 v[84:85], v139 offset:18432
ds_read_b64_tr_b16 v[86:87], v139 offset:19456
s_waitcnt lgkmcnt(8)
v_mfma_f32_32x32x16_bf16 a[0:15], v[120:123], v[32:35], a[0:15]
s_waitcnt vmcnt(8)
s_barrier
ds_read_b64_tr_b16 v[88:89], v138 offset:20480
ds_read_b64_tr_b16 v[90:91], v138 offset:21504
v_mfma_f32_32x32x16_bf16 a[16:31], v[124:127], v[32:35], a[16:31]
ds_read_b64_tr_b16 v[92:93], v139 offset:20480
ds_read_b64_tr_b16 v[94:95], v139 offset:21504
buffer_load_dwordx4 v[24:27], v140, s[40:43], s48 offen offset:0 sc1
v_mfma_f32_32x32x16_bf16 a[0:15], v[128:131], v[36:39], a[0:15]
ds_read_b64_tr_b16 v[96:97], v138 offset:22528
ds_read_b64_tr_b16 v[98:99], v138 offset:23552
buffer_load_dwordx4 v[28:31], v140, s[40:43], s48 offen offset:1024 sc1
v_mfma_f32_32x32x16_bf16 a[16:31], v[132:135], v[36:39], a[16:31]
ds_read_b64_tr_b16 v[100:101], v139 offset:22528
ds_read_b64_tr_b16 v[102:103], v139 offset:23552
s_waitcnt lgkmcnt(8)
v_mfma_f32_32x32x16_bf16 a[0:15], v[72:75], v[40:43], a[0:15]
s_waitcnt vmcnt(8)
s_barrier
ds_read_b64_tr_b16 v[104:105], v138 offset:24576
ds_read_b64_tr_b16 v[106:107], v138 offset:25600
v_mfma_f32_32x32x16_bf16 a[16:31], v[76:79], v[40:43], a[16:31]
ds_read_b64_tr_b16 v[108:109], v139 offset:24576
ds_read_b64_tr_b16 v[110:111], v139 offset:25600
buffer_load_dwordx4 v[32:35], v140, s[40:43], s48 offen offset:2048 sc1
v_mfma_f32_32x32x16_bf16 a[0:15], v[80:83], v[44:47], a[0:15]
ds_read_b64_tr_b16 v[112:113], v138 offset:26624
ds_read_b64_tr_b16 v[114:115], v138 offset:27648
buffer_load_dwordx4 v[36:39], v140, s[40:43], s48 offen offset:3072 sc1
s_add_u32 s48, s48, 4096
v_mfma_f32_32x32x16_bf16 a[16:31], v[84:87], v[44:47], a[16:31]
ds_read_b64_tr_b16 v[116:117], v139 offset:26624
ds_read_b64_tr_b16 v[118:119], v139 offset:27648
s_waitcnt lgkmcnt(8)
v_mfma_f32_32x32x16_bf16 a[0:15], v[88:91], v[48:51], a[0:15]
s_waitcnt vmcnt(8)
s_barrier
ds_read_b64_tr_b16 v[120:121], v138 offset:28672
ds_read_b64_tr_b16 v[122:123], v138 offset:29696
v_mfma_f32_32x32x16_bf16 a[16:31], v[92:95], v[48:51], a[16:31]
ds_read_b64_tr_b16 v[124:125], v139 offset:28672
ds_read_b64_tr_b16 v[126:127], v139 offset:29696
buffer_load_dwordx4 v[40:43], v140, s[40:43], s48 offen offset:0 sc1
v_mfma_f32_32x32x16_bf16 a[0:15], v[96:99], v[52:55], a[0:15]
ds_read_b64_tr_b16 v[128:129], v138 offset:30720
ds_read_b64_tr_b16 v[130:131], v138 offset:31744
buffer_load_dwordx4 v[44:47], v140, s[40:43], s48 offen offset:1024 sc1
v_mfma_f32_32x32x16_bf16 a[16:31], v[100:103], v[52:55], a[16:31]
ds_read_b64_tr_b16 v[132:133], v139 offset:30720
ds_read_b64_tr_b16 v[134:135], v139 offset:31744
s_waitcnt lgkmcnt(8)
v_mfma_f32_32x32x16_bf16 a[0:15], v[104:107], v[56:59], a[0:15]
s_waitcnt vmcnt(8)
s_barrier
s_add_u32 s58, s51, s56
s_add_u32 s51, s51, 32768
s_cmp_eq_u32 s51, 131072
s_cselect_b32 s51, 0, s51
v_add_u32 v138, s51, v136
v_add_u32 v139, s51, v137
ds_read_b64_tr_b16 v[72:73], v138 offset:0
ds_read_b64_tr_b16 v[74:75], v138 offset:1024
v_mfma_f32_32x32x16_bf16 a[16:31], v[108:111], v[56:59], a[16:31]
ds_read_b64_tr_b16 v[76:77], v139 offset:0
ds_read_b64_tr_b16 v[78:79], v139 offset:1024
buffer_load_dwordx4 v[48:51], v140, s[40:43], s48 offen offset:2048 sc1
v_mfma_f32_32x32x16_bf16 a[0:15], v[112:115], v[60:63], a[0:15]
ds_read_b64_tr_b16 v[80:81], v138 offset:2048
ds_read_b64_tr_b16 v[82:83], v138 offset:3072
buffer_load_dwordx4 v[52:55], v140, s[40:43], s48 offen offset:3072 sc1
s_add_u32 s48, s48, 4096
v_mfma_f32_32x32x16_bf16 a[16:31], v[116:119], v[60:63], a[16:31]
ds_read_b64_tr_b16 v[84:85], v139 offset:2048
ds_read_b64_tr_b16 v[86:87], v139 offset:3072
s_waitcnt lgkmcnt(8)
v_mfma_f32_32x32x16_bf16 a[0:15], v[120:123], v[64:67], a[0:15]
s_waitcnt vmcnt(8)
s_barrier
ds_read_b64_tr_b16 v[88:89], v138 offset:4096
ds_read_b64_tr_b16 v[90:91], v138 offset:5120
v_mfma_f32_32x32x16_bf16 a[16:31], v[124:127], v[64:67], a[16:31]
ds_read_b64_tr_b16 v[92:93], v139 offset:4096
ds_read_b64_tr_b16 v[94:95], v139 offset:5120
buffer_load_dwordx4 v[56:59], v140, s[40:43], s48 offen offset:0 sc1
v_mfma_f32_32x32x16_bf16 a[0:15], v[128:131], v[68:71], a[0:15]
ds_read_b64_tr_b16 v[96:97], v138 offset:6144
ds_read_b64_tr_b16 v[98:99], v138 offset:7168
buffer_load_dwordx4 v[60:63], v140, s[40:43], s48 offen offset:1024 sc1
v_mfma_f32_32x32x16_bf16 a[16:31], v[132:135], v[68:71], a[16:31]
ds_read_b64_tr_b16 v[100:101], v139 offset:6144
ds_read_b64_tr_b16 v[102:103], v139 offset:7168
s_sub_u32 s50, s50, 8
s_cmp_lg_u32 s50, 0
s_cbranch_scc1 .LgB_300
s_waitcnt vmcnt(0) lgkmcnt(0)
s_nop 15
s_add_u32 s57, s12, 0
buffer_store_dwordx4 a[0:3], v4, s[36:39], s57 offen offset:0 sc1
buffer_store_dwordx4 a[4:7], v4, s[36:39], s57 offen offset:1024 sc1
buffer_store_dwordx4 a[8:11], v4, s[36:39], s57 offen offset:2048 sc1
buffer_store_dwordx4 a[12:15], v4, s[36:39], s57 offen offset:3072 sc1
s_add_u32 s57, s12, 4096
buffer_store_dwordx4 a[16:19], v4, s[36:39], s57 offen offset:0 sc1
buffer_store_dwordx4 a[20:23], v4, s[36:39], s57 offen offset:1024 sc1
buffer_store_dwordx4 a[24:27], v4, s[36:39], s57 offen offset:2048 sc1
buffer_store_dwordx4 a[28:31], v4, s[36:39], s57 offen offset:3072 sc1
s_add_u32 s86, s70, 119590912
s_bfe_u32 s82, s77, 0x10000
s_mul_i32 s82, s82, 512
s_add_u32 s86, s86, s82
s_bfe_u32 s82, s77, 0x20003
s_mul_i32 s82, s82, 128
s_add_u32 s86, s86, s82
s_waitcnt vmcnt(0)
s_barrier
s_cmp_lg_u32 s3, 0
s_cbranch_scc1 .Lsg_301
v_mov_b32 v1, 1
v_mul_u32_u24 v2, 0, v0
s_mov_b64 exec, 1
buffer_atomic_add v1, v2, s[88:91], s86 offen sc1
s_mov_b64 exec, -1
.Lsg_301:
s_and_b32 s84, s77, 1
s_lshl_b32 s84, s84, 2
s_add_u32 s84, s84, s76
s_add_u32 s84, s84, 56
s_bfe_u32 s85, s77, 0x20001
s_lshr_b32 s83, s77, 3
s_lshl_b32 s83, s83, 4
s_load_dwordx2 s[6:7], s[0:1], 96
s_add_u32 s12, s4, 0x400000
s_addc_u32 s13, s5, 0
s_mov_b32 s14, 0x400000
s_mov_b32 s15, 0x00020000
s_add_u32 s16, s4, 0xc00000
s_addc_u32 s17, s5, 0
s_mov_b32 s18, 0x6000
s_mov_b32 s19, 0x00020000
s_add_u32 s24, s4, 0x7000000
s_addc_u32 s25, s5, 0
s_mov_b32 s26, 0x400000
s_mov_b32 s27, 0x00020000
v_and_b32 v4, 7, v0
v_bfe_u32 v5, v0, 3, 1
v_lshrrev_b32 v6, 4, v0
s_lshl_b32 s28, s85, 3
v_add_u32 v4, s28, v4
s_mul_i32 s28, s3, 4
s_add_u32 s28, s28, s83
v_add_u32 v6, s28, v6
v_lshl_add_u32 v7, v5, 5, v4
v_lshlrev_b32 v7, 4, v7
v_lshl_add_u32 v8, v6, 10, v7
v_lshrrev_b32 v7, 2, v4
v_lshlrev_b32 v7, 7, v7
v_lshl_add_u32 v7, v5, 6, v7
v_and_b32 v9, 3, v4
v_lshl_add_u32 v7, v9, 4, v7
v_lshl_add_u32 v9, v6, 11, v7
v_lshlrev_b32 v10, 5, v5
v_lshl_add_u32 v10, v6, 6, v10
s_lshl_b32 s28, s84, 16
s_and_b32 s29, s84, 7
s_lshl_b32 s29, s29, 17
s_mov_b32 s30, 20480
buffer_load_dwordx4 v[208:211], v10, s[16:19], s30 offen offset:0
buffer_load_dwordx4 v[212:215], v10, s[16:19], s30 offen offset:16
s_waitcnt lgkmcnt(0)
s_mov_b32 s20, s6
s_mov_b32 s21, s7
s_mov_b32 s22, 0x400000
s_mov_b32 s23, 0x00020000
v_lshlrev_b32 v11, 11, v4
v_lshl_add_u32 v11, v6, 5, v11
v_lshl_add_u32 v11, v5, 3, v11
s_add_u32 s31, s28, 0
buffer_load_dwordx4 v[192:195], v8, s[12:15], s31 offen sc1
s_cmp_lg_u32 s3, 0
s_cbranch_scc1 .Lws_302
v_mul_u32_u24 v1, 0, v0
v_add_u32 v1, s86, v1
v_mov_b32 v2, 16
s_mov_b64 exec, 1
.Lwl_303:
buffer_load_dword v3, v1, s[88:91], 0 offen sc1
s_waitcnt vmcnt(0)
v_cmp_lt_u32 vcc, v3, v2
s_cbranch_vccz .Lwo_304
s_cmp_eq_u32 s80, 0
s_cbranch_scc1 .Lwo_304
s_sub_u32 s80, s80, 1
s_branch .Lwl_303
.Lwo_304:
s_mov_b64 exec, -1
.Lws_302:
s_barrier
s_add_u32 s31, s29, 0
buffer_load_dwordx4 v[64:67], v9, s[24:27], s31 offen offset:0 sc1
buffer_load_dwordx4 v[68:71], v9, s[24:27], s31 offen offset:1024 sc1
s_add_u32 s31, s29, 1048576
buffer_load_dwordx4 v[72:75], v9, s[24:27], s31 offen offset:0 sc1
buffer_load_dwordx4 v[76:79], v9, s[24:27], s31 offen offset:1024 sc1
s_add_u32 s31, s29, 2097152
buffer_load_dwordx4 v[80:83], v9, s[24:27], s31 offen offset:0 sc1
buffer_load_dwordx4 v[84:87], v9, s[24:27], s31 offen offset:1024 sc1
s_add_u32 s31, s29, 3145728
buffer_load_dwordx4 v[88:91], v9, s[24:27], s31 offen offset:0 sc1
buffer_load_dwordx4 v[92:95], v9, s[24:27], s31 offen offset:1024 sc1
v_mov_b32 v12, 0x3f803f80
v_mov_b32 v16, 0
v_mov_b32 v17, 0
v_mov_b32 v18, 0
v_mov_b32 v19, 0
s_waitcnt vmcnt(4)
v_pk_add_f32 v[64:65], v[64:65], v[72:73]
v_pk_add_f32 v[66:67], v[66:67], v[74:75]
v_pk_add_f32 v[68:69], v[68:69], v[76:77]
v_pk_add_f32 v[70:71], v[70:71], v[78:79]
s_waitcnt vmcnt(0)
v_pk_add_f32 v[80:81], v[80:81], v[88:89]
v_pk_add_f32 v[82:83], v[82:83], v[90:91]
v_pk_add_f32 v[84:85], v[84:85], v[92:93]
v_pk_add_f32 v[86:87], v[86:87], v[94:95]
v_pk_add_f32 v[64:65], v[64:65], v[80:81]
v_pk_add_f32 v[66:67], v[66:67], v[82:83]
v_pk_add_f32 v[68:69], v[68:69], v[84:85]
v_pk_add_f32 v[70:71], v[70:71], v[86:87]
v_cvt_pk_bf16_f32 v248, v64, v65
v_cvt_pk_bf16_f32 v249, v66, v67
v_cvt_pk_bf16_f32 v250, v68, v69
v_cvt_pk_bf16_f32 v251, v70, v71
v_lshlrev_b32 v240, 16, v248
v_and_b32 v241, 0xffff0000, v248
v_lshlrev_b32 v242, 16, v249
v_and_b32 v243, 0xffff0000, v249
v_lshlrev_b32 v244, 16, v250
v_and_b32 v245, 0xffff0000, v250
v_lshlrev_b32 v246, 16, v251
v_and_b32 v247, 0xffff0000, v251
v_mul_f32 v240, v240, v208
v_mul_f32 v241, v241, v209
v_mul_f32 v242, v242, v210
v_mul_f32 v243, v243, v211
v_mul_f32 v244, v244, v212
v_mul_f32 v245, v245, v213
v_mul_f32 v246, v246, v214
v_mul_f32 v247, v247, v215
v_cvt_pk_bf16_f32 v248, v240, v241
v_cvt_pk_bf16_f32 v249, v242, v243
v_cvt_pk_bf16_f32 v250, v244, v245
v_cvt_pk_bf16_f32 v251, v246, v247
v_lshlrev_b32 v240, 16, v248
v_and_b32 v241, 0xffff0000, v248
v_lshlrev_b32 v248, 16, v192
v_and_b32 v192, 0xffff0000, v192
v_lshlrev_b32 v242, 16, v249
v_and_b32 v243, 0xffff0000, v249
v_lshlrev_b32 v249, 16, v193
v_and_b32 v193, 0xffff0000, v193
v_lshlrev_b32 v244, 16, v250
v_and_b32 v245, 0xffff0000, v250
v_lshlrev_b32 v250, 16, v194
v_and_b32 v194, 0xffff0000, v194
v_lshlrev_b32 v246, 16, v251
v_and_b32 v247, 0xffff0000, v251
v_lshlrev_b32 v251, 16, v195
v_and_b32 v195, 0xffff0000, v195
v_add_f32 v240, v240, v248
v_add_f32 v241, v241, v192
v_add_f32 v242, v242, v249
v_add_f32 v243, v243, v193
v_add_f32 v244, v244, v250
v_add_f32 v245, v245, v194
v_add_f32 v246, v246, v251
v_add_f32 v247, v247, v195
v_cvt_pk_bf16_f32 v192, v240, v241
v_cvt_pk_bf16_f32 v193, v242, v243
v_cvt_pk_bf16_f32 v194, v244, v245
v_cvt_pk_bf16_f32 v195, v246, v247
buffer_store_dwordx2 v[192:193], v11, s[20:23], s28 offen offset:0
buffer_store_dwordx2 v[194:195], v11, s[20:23], s28 offen offset:16
.Lend_3:
s_waitcnt vmcnt(0)
s_endpgm
.Lworker_10:
s_sub_u32 s76, s20, 4
s_mov_b32 s77, s21
s_mov_b32 s80, 400000
s_mov_b32 s78, 0
s_add_u32 s88, s4, 0xf00000
s_addc_u32 s89, s5, 0
s_mov_b32 s90, 0x7214000
s_mov_b32 s91, 0x00020000
s_add_u32 s20, s4, 0xf00000
s_addc_u32 s21, s5, 0
s_mov_b32 s22, 0x0
s_mov_b32 s23, 0x00020000
s_mov_b32 s24, 0
s_mov_b32 s25, 0
v_mov_b32 v5, 0
s_lshr_b32 s83, s77, 4
s_add_u32 s83, s83, 1
s_mov_b32 s84, 0
s_and_b32 s85, s77, 15
s_lshl_b32 s81, s76, 4
s_add_u32 s85, s85, s81
s_lshl_b32 s13, s83, 3
s_add_u32 s13, s13, 16
s_load_dwordx2 s[6:7], s[0:1], s13
s_add_u32 s40, s4, 0x0
s_addc_u32 s41, s5, 0
s_mov_b32 s42, 0x400000
s_mov_b32 s43, 0x00020000
v_lshrrev_b32 v173, 2, v0
v_and_b32 v173, 3, v173
v_lshrrev_b32 v174, 5, v0
v_lshlrev_b32 v174, 2, v174
v_add_u32 v174, v174, v173
v_mul_u32_u24 v174, 128, v174
v_and_b32 v175, 3, v0
v_lshlrev_b32 v175, 3, v175
v_add_u32 v174, v174, v175
v_and_b32 v175, 16, v0
v_lshlrev_b32 v175, 1, v175
v_add_u32 v174, v174, v175
v_lshrrev_b32 v173, 1, v173
s_and_b32 s53, s3, 0
s_mul_i32 s53, s53, 2
s_add_u32 s57, s53, 0
v_xor_b32 v175, s57, v173
v_lshlrev_b32 v175, 6, v175
v_add_u32 v168, v174, v175
s_add_u32 s57, s53, 1
v_xor_b32 v175, s57, v173
v_lshlrev_b32 v175, 6, v175
v_add_u32 v169, v174, v175
s_lshr_b32 s53, s3, 0
s_mul_i32 s53, s53, 131072
v_lshlrev_b32 v170, 4, v0
v_add_u32 v170, s53, v170
v_add_u32 v171, 65536, v170
v_lshrrev_b32 v173, 3, v0
s_mul_i32 s53, s3, 8
v_add_u32 v173, s53, v173
v_and_b32 v174, 3, v173
v_lshrrev_b32 v174, 1, v174
v_and_b32 v175, 7, v0
v_lshrrev_b32 v175, 2, v175
v_xor_b32 v174, v174, v175
v_lshlrev_b32 v174, 6, v174
v_and_b32 v175, 3, v0
v_lshlrev_b32 v175, 4, v175
v_add_u32 v174, v174, v175
s_mov_b32 s53, 8192
v_mul_lo_u32 v173, v173, s53
v_add_u32 v172, v173, v174
s_mul_i32 s54, s53, 32
s_lshl_b32 s56, s3, 10
s_waitcnt lgkmcnt(0)
s_mov_b32 s44, s6
s_mov_b32 s45, s7
s_mov_b32 s46, 0x800000
s_mov_b32 s47, 0x00020000
s_mul_i32 s48, s84, 524288
s_mul_i32 s49, s85, 128
s_mov_b32 s50, 32
s_add_u32 m0, s56, 0
s_nop 0
buffer_load_dwordx4 v172, s[44:47], s49 offen lds
s_add_u32 s49, s49, s54
s_add_u32 m0, s56, 4096
s_nop 0
buffer_load_dwordx4 v172, s[44:47], s49 offen lds
s_add_u32 s49, s49, s54
s_add_u32 m0, s56, 8192
s_nop 0
buffer_load_dwordx4 v172, s[44:47], s49 offen lds
s_add_u32 s49, s49, s54
s_add_u32 m0, s56, 12288
s_nop 0
buffer_load_dwordx4 v172, s[44:47], s49 offen lds
s_add_u32 s49, s49, s54
s_add_u32 m0, s56, 16384
s_nop 0
buffer_load_dwordx4 v172, s[44:47], s49 offen lds
s_add_u32 s49, s49, s54
s_add_u32 m0, s56, 20480
s_nop 0
buffer_load_dwordx4 v172, s[44:47], s49 offen lds
s_add_u32 s49, s49, s54
s_add_u32 m0, s56, 24576
s_nop 0
buffer_load_dwordx4 v172, s[44:47], s49 offen lds
s_add_u32 s49, s49, s54
s_mov_b32 s86, 28672
s_cmp_lg_u32 s3, 0
s_cbranch_scc1 .Lws_305
v_mul_u32_u24 v1, 128, v0
v_add_u32 v1, s86, v1
v_mov_b32 v2, 32
s_mov_b64 exec, 1
.Lwl_306:
buffer_load_dword v3, v1, s[88:91], 0 offen sc1
s_waitcnt vmcnt(0)
v_cmp_lt_u32 vcc, v3, v2
s_cbranch_vccz .Lwo_307
s_cmp_eq_u32 s80, 0
s_cbranch_scc1 .Lwo_307
s_sub_u32 s80, s80, 1
s_branch .Lwl_306
.Lwo_307:
s_mov_b64 exec, -1
.Lws_305:
s_barrier
buffer_load_dwordx4 v[8:11], v170, s[40:43], s48 offen offset:0 sc1
buffer_load_dwordx4 v[12:15], v171, s[40:43], s48 offen offset:0 sc1
buffer_load_dwordx4 v[16:19], v170, s[40:43], s48 offen offset:1024 sc1
buffer_load_dwordx4 v[20:23], v171, s[40:43], s48 offen offset:1024 sc1
buffer_load_dwordx4 v[24:27], v170, s[40:43], s48 offen offset:2048 sc1
buffer_load_dwordx4 v[28:31], v171, s[40:43], s48 offen offset:2048 sc1
buffer_load_dwordx4 v[32:35], v170, s[40:43], s48 offen offset:3072 sc1
buffer_load_dwordx4 v[36:39], v171, s[40:43], s48 offen offset:3072 sc1
s_add_u32 s48, s48, 4096
buffer_load_dwordx4 v[40:43], v170, s[40:43], s48 offen offset:0 sc1
buffer_load_dwordx4 v[44:47], v171, s[40:43], s48 offen offset:0 sc1
buffer_load_dwordx4 v[48:51], v170, s[40:43], s48 offen offset:1024 sc1
buffer_load_dwordx4 v[52:55], v171, s[40:43], s48 offen offset:1024 sc1
buffer_load_dwordx4 v[56:59], v170, s[40:43], s48 offen offset:2048 sc1
buffer_load_dwordx4 v[60:63], v171, s[40:43], s48 offen offset:2048 sc1
buffer_load_dwordx4 v[64:67], v170, s[40:43], s48 offen offset:3072 sc1
buffer_load_dwordx4 v[68:71], v171, s[40:43], s48 offen offset:3072 sc1
s_add_u32 s48, s48, 4096
buffer_load_dwordx4 v[72:75], v170, s[40:43], s48 offen offset:0 sc1
buffer_load_dwordx4 v[76:79], v171, s[40:43], s48 offen offset:0 sc1
buffer_load_dwordx4 v[80:83], v170, s[40:43], s48 offen offset:1024 sc1
buffer_load_dwordx4 v[84:87], v171, s[40:43], s48 offen offset:1024 sc1
buffer_load_dwordx4 v[88:91], v170, s[40:43], s48 offen offset:2048 sc1
buffer_load_dwordx4 v[92:95], v171, s[40:43], s48 offen offset:2048 sc1
buffer_load_dwordx4 v[96:99], v170, s[40:43], s48 offen offset:3072 sc1
buffer_load_dwordx4 v[100:103], v171, s[40:43], s48 offen offset:3072 sc1
s_add_u32 s48, s48, 4096
buffer_load_dwordx4 v[104:107], v170, s[40:43], s48 offen offset:0 sc1
buffer_load_dwordx4 v[108:111], v171, s[40:43], s48 offen offset:0 sc1
buffer_load_dwordx4 v[112:115], v170, s[40:43], s48 offen offset:1024 sc1
buffer_load_dwordx4 v[116:119], v171, s[40:43], s48 offen offset:1024 sc1
s_lshl_b32 s12, s83, 24
s_add_u32 s12, s12, 16777216
s_add_u32 s36, s4, s12
s_addc_u32 s37, s5, 0
s_mov_b32 s38, 16777216
s_mov_b32 s39, 0x00020000
s_lshr_b32 s12, s3, 0
s_mul_i32 s12, s12, 2
s_lshl_b32 s13, s84, 3
s_add_u32 s12, s12, s13
s_lshl_b32 s12, s12, 18
s_and_b32 s13, s3, 0
s_mul_i32 s13, s13, 4
s_mul_i32 s14, s85, 4
s_add_u32 s13, s13, s14
s_lshl_b32 s13, s13, 10
s_add_u32 s12, s12, s13
v_lshlrev_b32 v2, 4, v0
s_cmp_eq_u32 s83, 2
s_cbranch_scc1 .Lvt_308
v_accvgpr_write_b32 a0, 0
v_accvgpr_write_b32 a1, 0
v_accvgpr_write_b32 a2, 0
v_accvgpr_write_b32 a3, 0
v_accvgpr_write_b32 a4, 0
v_accvgpr_write_b32 a5, 0
v_accvgpr_write_b32 a6, 0
v_accvgpr_write_b32 a7, 0
v_accvgpr_write_b32 a8, 0
v_accvgpr_write_b32 a9, 0
v_accvgpr_write_b32 a10, 0
v_accvgpr_write_b32 a11, 0
v_accvgpr_write_b32 a12, 0
v_accvgpr_write_b32 a13, 0
v_accvgpr_write_b32 a14, 0
v_accvgpr_write_b32 a15, 0
v_accvgpr_write_b32 a16, 0
v_accvgpr_write_b32 a17, 0
v_accvgpr_write_b32 a18, 0
v_accvgpr_write_b32 a19, 0
v_accvgpr_write_b32 a20, 0
v_accvgpr_write_b32 a21, 0
v_accvgpr_write_b32 a22, 0
v_accvgpr_write_b32 a23, 0
v_accvgpr_write_b32 a24, 0
v_accvgpr_write_b32 a25, 0
v_accvgpr_write_b32 a26, 0
v_accvgpr_write_b32 a27, 0
v_accvgpr_write_b32 a28, 0
v_accvgpr_write_b32 a29, 0
v_accvgpr_write_b32 a30, 0
v_accvgpr_write_b32 a31, 0
v_accvgpr_write_b32 a32, 0
v_accvgpr_write_b32 a33, 0
v_accvgpr_write_b32 a34, 0
v_accvgpr_write_b32 a35, 0
v_accvgpr_write_b32 a36, 0
v_accvgpr_write_b32 a37, 0
v_accvgpr_write_b32 a38, 0
v_accvgpr_write_b32 a39, 0
v_accvgpr_write_b32 a40, 0
v_accvgpr_write_b32 a41, 0
v_accvgpr_write_b32 a42, 0
v_accvgpr_write_b32 a43, 0
v_accvgpr_write_b32 a44, 0
v_accvgpr_write_b32 a45, 0
v_accvgpr_write_b32 a46, 0
v_accvgpr_write_b32 a47, 0
v_accvgpr_write_b32 a48, 0
v_accvgpr_write_b32 a49, 0
v_accvgpr_write_b32 a50, 0
v_accvgpr_write_b32 a51, 0
v_accvgpr_write_b32 a52, 0
v_accvgpr_write_b32 a53, 0
v_accvgpr_write_b32 a54, 0
v_accvgpr_write_b32 a55, 0
v_accvgpr_write_b32 a56, 0
v_accvgpr_write_b32 a57, 0
v_accvgpr_write_b32 a58, 0
v_accvgpr_write_b32 a59, 0
v_accvgpr_write_b32 a60, 0
v_accvgpr_write_b32 a61, 0
v_accvgpr_write_b32 a62, 0
v_accvgpr_write_b32 a63, 0
s_waitcnt vmcnt(24)
s_barrier
ds_read_b64_tr_b16 v[136:137], v168 offset:0
ds_read_b64_tr_b16 v[138:139], v168 offset:1024
ds_read_b64_tr_b16 v[140:141], v169 offset:0
ds_read_b64_tr_b16 v[142:143], v169 offset:1024
ds_read_b64_tr_b16 v[144:145], v168 offset:2048
ds_read_b64_tr_b16 v[146:147], v168 offset:3072
ds_read_b64_tr_b16 v[148:149], v169 offset:2048
ds_read_b64_tr_b16 v[150:151], v169 offset:3072
s_waitcnt lgkmcnt(4)
v_mfma_f32_32x32x16_bf16 a[0:15], v[136:139], v[8:11], a[0:15]
s_waitcnt vmcnt(20) lgkmcnt(0)
s_barrier
ds_read_b64_tr_b16 v[152:153], v168 offset:4096
ds_read_b64_tr_b16 v[154:155], v168 offset:5120
v_mfma_f32_32x32x16_bf16 a[32:47], v[136:139], v[12:15], a[32:47]
ds_read_b64_tr_b16 v[156:157], v169 offset:4096
ds_read_b64_tr_b16 v[158:159], v169 offset:5120
s_add_u32 m0, s56, 28672
s_nop 0
buffer_load_dwordx4 v172, s[44:47], s49 offen lds
s_add_u32 s49, s49, s54
v_mfma_f32_32x32x16_bf16 a[16:31], v[140:143], v[8:11], a[16:31]
ds_read_b64_tr_b16 v[160:161], v168 offset:6144
ds_read_b64_tr_b16 v[162:163], v168 offset:7168
buffer_load_dwordx4 v[120:123], v170, s[40:43], s48 offen offset:2048 sc1
v_mfma_f32_32x32x16_bf16 a[48:63], v[140:143], v[12:15], a[48:63]
ds_read_b64_tr_b16 v[164:165], v169 offset:6144
ds_read_b64_tr_b16 v[166:167], v169 offset:7168
buffer_load_dwordx4 v[124:127], v171, s[40:43], s48 offen offset:2048 sc1
v_mfma_f32_32x32x16_bf16 a[0:15], v[144:147], v[16:19], a[0:15]
buffer_load_dwordx4 v[128:131], v170, s[40:43], s48 offen offset:3072 sc1
v_mfma_f32_32x32x16_bf16 a[32:47], v[144:147], v[20:23], a[32:47]
buffer_load_dwordx4 v[132:135], v171, s[40:43], s48 offen offset:3072 sc1
s_add_u32 s48, s48, 4096
v_mfma_f32_32x32x16_bf16 a[16:31], v[148:151], v[16:19], a[16:31]
s_cmp_eq_u32 s50, 8
s_cselect_b32 s42, 0, s42
s_cselect_b32 s46, 0, s46
v_mfma_f32_32x32x16_bf16 a[48:63], v[148:151], v[20:23], a[48:63]
s_waitcnt lgkmcnt(4)
v_mfma_f32_32x32x16_bf16 a[0:15], v[152:155], v[24:27], a[0:15]
s_waitcnt vmcnt(21) lgkmcnt(0)
s_barrier
ds_read_b64_tr_b16 v[136:137], v168 offset:8192
ds_read_b64_tr_b16 v[138:139], v168 offset:9216
v_mfma_f32_32x32x16_bf16 a[32:47], v[152:155], v[28:31], a[32:47]
ds_read_b64_tr_b16 v[140:141], v169 offset:8192
ds_read_b64_tr_b16 v[142:143], v169 offset:9216
s_add_u32 m0, s56, 0
s_nop 0
buffer_load_dwordx4 v172, s[44:47], s49 offen lds
s_add_u32 s49, s49, s54
v_mfma_f32_32x32x16_bf16 a[16:31], v[156:159], v[24:27], a[16:31]
ds_read_b64_tr_b16 v[144:145], v168 offset:10240
ds_read_b64_tr_b16 v[146:147], v168 offset:11264
buffer_load_dwordx4 v[8:11], v170, s[40:43], s48 offen offset:0 sc1
v_mfma_f32_32x32x16_bf16 a[48:63], v[156:159], v[28:31], a[48:63]
ds_read_b64_tr_b16 v[148:149], v169 offset:10240
ds_read_b64_tr_b16 v[150:151], v169 offset:11264
buffer_load_dwordx4 v[12:15], v171, s[40:43], s48 offen offset:0 sc1
v_mfma_f32_32x32x16_bf16 a[0:15], v[160:163], v[32:35], a[0:15]
v_mfma_f32_32x32x16_bf16 a[32:47], v[160:163], v[36:39], a[32:47]
buffer_load_dwordx4 v[16:19], v170, s[40:43], s48 offen offset:1024 sc1
v_mfma_f32_32x32x16_bf16 a[16:31], v[164:167], v[32:35], a[16:31]
buffer_load_dwordx4 v[20:23], v171, s[40:43], s48 offen offset:1024 sc1
v_mfma_f32_32x32x16_bf16 a[48:63], v[164:167], v[36:39], a[48:63]
s_waitcnt lgkmcnt(4)
v_mfma_f32_32x32x16_bf16 a[0:15], v[136:139], v[40:43], a[0:15]
s_waitcnt vmcnt(22) lgkmcnt(0)
s_barrier
ds_read_b64_tr_b16 v[152:153], v168 offset:12288
ds_read_b64_tr_b16 v[154:155], v168 offset:13312
v_mfma_f32_32x32x16_bf16 a[32:47], v[136:139], v[44:47], a[32:47]
ds_read_b64_tr_b16 v[156:157], v169 offset:12288
ds_read_b64_tr_b16 v[158:159], v169 offset:13312
s_add_u32 m0, s56, 4096
s_nop 0
buffer_load_dwordx4 v172, s[44:47], s49 offen lds
s_add_u32 s49, s49, s54
v_mfma_f32_32x32x16_bf16 a[16:31], v[140:143], v[40:43], a[16:31]
ds_read_b64_tr_b16 v[160:161], v168 offset:14336
ds_read_b64_tr_b16 v[162:163], v168 offset:15360
buffer_load_dwordx4 v[24:27], v170, s[40:43], s48 offen offset:2048 sc1
v_mfma_f32_32x32x16_bf16 a[48:63], v[140:143], v[44:47], a[48:63]
ds_read_b64_tr_b16 v[164:165], v169 offset:14336
ds_read_b64_tr_b16 v[166:167], v169 offset:15360
buffer_load_dwordx4 v[28:31], v171, s[40:43], s48 offen offset:2048 sc1
v_mfma_f32_32x32x16_bf16 a[0:15], v[144:147], v[48:51], a[0:15]
v_mfma_f32_32x32x16_bf16 a[32:47], v[144:147], v[52:55], a[32:47]
buffer_load_dwordx4 v[32:35], v170, s[40:43], s48 offen offset:3072 sc1
v_mfma_f32_32x32x16_bf16 a[16:31], v[148:151], v[48:51], a[16:31]
buffer_load_dwordx4 v[36:39], v171, s[40:43], s48 offen offset:3072 sc1
s_add_u32 s48, s48, 4096
v_mfma_f32_32x32x16_bf16 a[48:63], v[148:151], v[52:55], a[48:63]
s_waitcnt lgkmcnt(4)
v_mfma_f32_32x32x16_bf16 a[0:15], v[152:155], v[56:59], a[0:15]
s_waitcnt vmcnt(23) lgkmcnt(0)
s_barrier
ds_read_b64_tr_b16 v[136:137], v168 offset:16384
ds_read_b64_tr_b16 v[138:139], v168 offset:17408
v_mfma_f32_32x32x16_bf16 a[32:47], v[152:155], v[60:63], a[32:47]
ds_read_b64_tr_b16 v[140:141], v169 offset:16384
ds_read_b64_tr_b16 v[142:143], v169 offset:17408
s_add_u32 m0, s56, 8192
s_nop 0
buffer_load_dwordx4 v172, s[44:47], s49 offen lds
s_add_u32 s49, s49, s54
v_mfma_f32_32x32x16_bf16 a[16:31], v[156:159], v[56:59], a[16:31]
ds_read_b64_tr_b16 v[144:145], v168 offset:18432
ds_read_b64_tr_b16 v[146:147], v168 offset:19456
buffer_load_dwordx4 v[40:43], v170, s[40:43], s48 offen offset:0 sc1
v_mfma_f32_32x32x16_bf16 a[48:63], v[156:159], v[60:63], a[48:63]
ds_read_b64_tr_b16 v[148:149], v169 offset:18432
ds_read_b64_tr_b16 v[150:151], v169 offset:19456
buffer_load_dwordx4 v[44:47], v171, s[40:43], s48 offen offset:0 sc1
v_mfma_f32_32x32x16_bf16 a[0:15], v[160:163], v[64:67], a[0:15]
v_mfma_f32_32x32x16_bf16 a[32:47], v[160:163], v[68:71], a[32:47]
buffer_load_dwordx4 v[48:51], v170, s[40:43], s48 offen offset:1024 sc1
v_mfma_f32_32x32x16_bf16 a[16:31], v[164:167], v[64:67], a[16:31]
buffer_load_dwordx4 v[52:55], v171, s[40:43], s48 offen offset:1024 sc1
v_mfma_f32_32x32x16_bf16 a[48:63], v[164:167], v[68:71], a[48:63]
s_waitcnt lgkmcnt(4)
v_mfma_f32_32x32x16_bf16 a[0:15], v[136:139], v[72:75], a[0:15]
s_waitcnt vmcnt(24) lgkmcnt(0)
s_barrier
ds_read_b64_tr_b16 v[152:153], v168 offset:20480
ds_read_b64_tr_b16 v[154:155], v168 offset:21504
v_mfma_f32_32x32x16_bf16 a[32:47], v[136:139], v[76:79], a[32:47]
ds_read_b64_tr_b16 v[156:157], v169 offset:20480
ds_read_b64_tr_b16 v[158:159], v169 offset:21504
s_add_u32 m0, s56, 12288
s_nop 0
buffer_load_dwordx4 v172, s[44:47], s49 offen lds
s_add_u32 s49, s49, s54
v_mfma_f32_32x32x16_bf16 a[16:31], v[140:143], v[72:75], a[16:31]
ds_read_b64_tr_b16 v[160:161], v168 offset:22528
ds_read_b64_tr_b16 v[162:163], v168 offset:23552
buffer_load_dwordx4 v[56:59], v170, s[40:43], s48 offen offset:2048 sc1
v_mfma_f32_32x32x16_bf16 a[48:63], v[140:143], v[76:79], a[48:63]
ds_read_b64_tr_b16 v[164:165], v169 offset:22528
ds_read_b64_tr_b16 v[166:167], v169 offset:23552
buffer_load_dwordx4 v[60:63], v171, s[40:43], s48 offen offset:2048 sc1
v_mfma_f32_32x32x16_bf16 a[0:15], v[144:147], v[80:83], a[0:15]
v_mfma_f32_32x32x16_bf16 a[32:47], v[144:147], v[84:87], a[32:47]
buffer_load_dwordx4 v[64:67], v170, s[40:43], s48 offen offset:3072 sc1
v_mfma_f32_32x32x16_bf16 a[16:31], v[148:151], v[80:83], a[16:31]
buffer_load_dwordx4 v[68:71], v171, s[40:43], s48 offen offset:3072 sc1
s_add_u32 s48, s48, 4096
v_mfma_f32_32x32x16_bf16 a[48:63], v[148:151], v[84:87], a[48:63]
s_waitcnt lgkmcnt(4)
v_mfma_f32_32x32x16_bf16 a[0:15], v[152:155], v[88:91], a[0:15]
s_waitcnt vmcnt(25) lgkmcnt(0)
s_barrier
ds_read_b64_tr_b16 v[136:137], v168 offset:24576
ds_read_b64_tr_b16 v[138:139], v168 offset:25600
v_mfma_f32_32x32x16_bf16 a[32:47], v[152:155], v[92:95], a[32:47]
ds_read_b64_tr_b16 v[140:141], v169 offset:24576
ds_read_b64_tr_b16 v[142:143], v169 offset:25600
s_add_u32 m0, s56, 16384
s_nop 0
buffer_load_dwordx4 v172, s[44:47], s49 offen lds
s_add_u32 s49, s49, s54
v_mfma_f32_32x32x16_bf16 a[16:31], v[156:159], v[88:91], a[16:31]
ds_read_b64_tr_b16 v[144:145], v168 offset:26624
ds_read_b64_tr_b16 v[146:147], v168 offset:27648
buffer_load_dwordx4 v[72:75], v170, s[40:43], s48 offen offset:0 sc1
v_mfma_f32_32x32x16_bf16 a[48:63], v[156:159], v[92:95], a[48:63]
ds_read_b64_tr_b16 v[148:149], v169 offset:26624
ds_read_b64_tr_b16 v[150:151], v169 offset:27648
buffer_load_dwordx4 v[76:79], v171, s[40:43], s48 offen offset:0 sc1
v_mfma_f32_32x32x16_bf16 a[0:15], v[160:163], v[96:99], a[0:15]
v_mfma_f32_32x32x16_bf16 a[32:47], v[160:163], v[100:103], a[32:47]
buffer_load_dwordx4 v[80:83], v170, s[40:43], s48 offen offset:1024 sc1
v_mfma_f32_32x32x16_bf16 a[16:31], v[164:167], v[96:99], a[16:31]
buffer_load_dwordx4 v[84:87], v171, s[40:43], s48 offen offset:1024 sc1
v_mfma_f32_32x32x16_bf16 a[48:63], v[164:167], v[100:103], a[48:63]
s_waitcnt lgkmcnt(4)
v_mfma_f32_32x32x16_bf16 a[0:15], v[136:139], v[104:107], a[0:15]
s_waitcnt vmcnt(25) lgkmcnt(0)
s_barrier
ds_read_b64_tr_b16 v[152:153], v168 offset:28672
ds_read_b64_tr_b16 v[154:155], v168 offset:29696
v_mfma_f32_32x32x16_bf16 a[32:47], v[136:139], v[108:111], a[32:47]
ds_read_b64_tr_b16 v[156:157], v169 offset:28672
ds_read_b64_tr_b16 v[158:159], v169 offset:29696
s_add_u32 m0, s56, 20480
s_nop 0
buffer_load_dwordx4 v172, s[44:47], s49 offen lds
s_add_u32 s49, s49, s54
v_mfma_f32_32x32x16_bf16 a[16:31], v[140:143], v[104:107], a[16:31]
ds_read_b64_tr_b16 v[160:161], v168 offset:30720
ds_read_b64_tr_b16 v[162:163], v168 offset:31744
buffer_load_dwordx4 v[88:91], v170, s[40:43], s48 offen offset:2048 sc1
v_mfma_f32_32x32x16_bf16 a[48:63], v[140:143], v[108:111], a[48:63]
ds_read_b64_tr_b16 v[164:165], v169 offset:30720
ds_read_b64_tr_b16 v[166:167], v169 offset:31744
buffer_load_dwordx4 v[92:95], v171, s[40:43], s48 offen offset:2048 sc1
v_mfma_f32_32x32x16_bf16 a[0:15], v[144:147], v[112:115], a[0:15]
v_mfma_f32_32x32x16_bf16 a[32:47], v[144:147], v[116:119], a[32:47]
buffer_load_dwordx4 v[96:99], v170, s[40:43], s48 offen offset:3072 sc1
v_mfma_f32_32x32x16_bf16 a[16:31], v[148:151], v[112:115], a[16:31]
buffer_load_dwordx4 v[100:103], v171, s[40:43], s48 offen offset:3072 sc1
s_add_u32 s48, s48, 4096
v_mfma_f32_32x32x16_bf16 a[48:63], v[148:151], v[116:119], a[48:63]
s_waitcnt lgkmcnt(4)
v_mfma_f32_32x32x16_bf16 a[0:15], v[152:155], v[120:123], a[0:15]
s_waitcnt vmcnt(25) lgkmcnt(0)
s_barrier
ds_read_b64_tr_b16 v[136:137], v168 offset:0
ds_read_b64_tr_b16 v[138:139], v168 offset:1024
v_mfma_f32_32x32x16_bf16 a[32:47], v[152:155], v[124:127], a[32:47]
ds_read_b64_tr_b16 v[140:141], v169 offset:0
ds_read_b64_tr_b16 v[142:143], v169 offset:1024
s_add_u32 m0, s56, 24576
s_nop 0
buffer_load_dwordx4 v172, s[44:47], s49 offen lds
s_add_u32 s49, s49, s54
v_mfma_f32_32x32x16_bf16 a[16:31], v[156:159], v[120:123], a[16:31]
ds_read_b64_tr_b16 v[144:145], v168 offset:2048
ds_read_b64_tr_b16 v[146:147], v168 offset:3072
buffer_load_dwordx4 v[104:107], v170, s[40:43], s48 offen offset:0 sc1
v_mfma_f32_32x32x16_bf16 a[48:63], v[156:159], v[124:127], a[48:63]
ds_read_b64_tr_b16 v[148:149], v169 offset:2048
ds_read_b64_tr_b16 v[150:151], v169 offset:3072
buffer_load_dwordx4 v[108:111], v171, s[40:43], s48 offen offset:0 sc1
v_mfma_f32_32x32x16_bf16 a[0:15], v[160:163], v[128:131], a[0:15]
v_mfma_f32_32x32x16_bf16 a[32:47], v[160:163], v[132:135], a[32:47]
buffer_load_dwordx4 v[112:115], v170, s[40:43], s48 offen offset:1024 sc1
v_mfma_f32_32x32x16_bf16 a[16:31], v[164:167], v[128:131], a[16:31]
buffer_load_dwordx4 v[116:119], v171, s[40:43], s48 offen offset:1024 sc1
v_mfma_f32_32x32x16_bf16 a[48:63], v[164:167], v[132:135], a[48:63]
s_sub_u32 s50, s50, 8
.LgD_310:
s_waitcnt lgkmcnt(4)
v_mfma_f32_32x32x16_bf16 a[0:15], v[136:139], v[8:11], a[0:15]
s_waitcnt vmcnt(25) lgkmcnt(0)
s_barrier
ds_read_b64_tr_b16 v[152:153], v168 offset:4096
ds_read_b64_tr_b16 v[154:155], v168 offset:5120
v_mfma_f32_32x32x16_bf16 a[32:47], v[136:139], v[12:15], a[32:47]
ds_read_b64_tr_b16 v[156:157], v169 offset:4096
ds_read_b64_tr_b16 v[158:159], v169 offset:5120
s_add_u32 m0, s56, 28672
s_nop 0
buffer_load_dwordx4 v172, s[44:47], s49 offen lds
s_add_u32 s49, s49, s54
v_mfma_f32_32x32x16_bf16 a[16:31], v[140:143], v[8:11], a[16:31]
ds_read_b64_tr_b16 v[160:161], v168 offset:6144
ds_read_b64_tr_b16 v[162:163], v168 offset:7168
buffer_load_dwordx4 v[120:123], v170, s[40:43], s48 offen offset:2048 sc1
v_mfma_f32_32x32x16_bf16 a[48:63], v[140:143], v[12:15], a[48:63]
ds_read_b64_tr_b16 v[164:165], v169 offset:6144
ds_read_b64_tr_b16 v[166:167], v169 offset:7168
buffer_load_dwordx4 v[124:127], v171, s[40:43], s48 offen offset:2048 sc1
v_mfma_f32_32x32x16_bf16 a[0:15], v[144:147], v[16:19], a[0:15]
buffer_load_dwordx4 v[128:131], v170, s[40:43], s48 offen offset:3072 sc1
v_mfma_f32_32x32x16_bf16 a[32:47], v[144:147], v[20:23], a[32:47]
buffer_load_dwordx4 v[132:135], v171, s[40:43], s48 offen offset:3072 sc1
s_add_u32 s48, s48, 4096
v_mfma_f32_32x32x16_bf16 a[16:31], v[148:151], v[16:19], a[16:31]
s_cmp_eq_u32 s50, 8
s_cselect_b32 s42, 0, s42
s_cselect_b32 s46, 0, s46
v_mfma_f32_32x32x16_bf16 a[48:63], v[148:151], v[20:23], a[48:63]
s_waitcnt lgkmcnt(4)
v_mfma_f32_32x32x16_bf16 a[0:15], v[152:155], v[24:27], a[0:15]
s_waitcnt vmcnt(25) lgkmcnt(0)
s_barrier
ds_read_b64_tr_b16 v[136:137], v168 offset:8192
ds_read_b64_tr_b16 v[138:139], v168 offset:9216
v_mfma_f32_32x32x16_bf16 a[32:47], v[152:155], v[28:31], a[32:47]
ds_read_b64_tr_b16 v[140:141], v169 offset:8192
ds_read_b64_tr_b16 v[142:143], v169 offset:9216
s_add_u32 m0, s56, 0
s_nop 0
buffer_load_dwordx4 v172, s[44:47], s49 offen lds
s_add_u32 s49, s49, s54
v_mfma_f32_32x32x16_bf16 a[16:31], v[156:159], v[24:27], a[16:31]
ds_read_b64_tr_b16 v[144:145], v168 offset:10240
ds_read_b64_tr_b16 v[146:147], v168 offset:11264
buffer_load_dwordx4 v[8:11], v170, s[40:43], s48 offen offset:0 sc1
v_mfma_f32_32x32x16_bf16 a[48:63], v[156:159], v[28:31], a[48:63]
ds_read_b64_tr_b16 v[148:149], v169 offset:10240
ds_read_b64_tr_b16 v[150:151], v169 offset:11264
buffer_load_dwordx4 v[12:15], v171, s[40:43], s48 offen offset:0 sc1
v_mfma_f32_32x32x16_bf16 a[0:15], v[160:163], v[32:35], a[0:15]
v_mfma_f32_32x32x16_bf16 a[32:47], v[160:163], v[36:39], a[32:47]
buffer_load_dwordx4 v[16:19], v170, s[40:43], s48 offen offset:1024 sc1
v_mfma_f32_32x32x16_bf16 a[16:31], v[164:167], v[32:35], a[16:31]
buffer_load_dwordx4 v[20:23], v171, s[40:43], s48 offen offset:1024 sc1
v_mfma_f32_32x32x16_bf16 a[48:63], v[164:167], v[36:39], a[48:63]
s_waitcnt lgkmcnt(4)
v_mfma_f32_32x32x16_bf16 a[0:15], v[136:139], v[40:43], a[0:15]
s_waitcnt vmcnt(25) lgkmcnt(0)
s_barrier
ds_read_b64_tr_b16 v[152:153], v168 offset:12288
ds_read_b64_tr_b16 v[154:155], v168 offset:13312
v_mfma_f32_32x32x16_bf16 a[32:47], v[136:139], v[44:47], a[32:47]
ds_read_b64_tr_b16 v[156:157], v169 offset:12288
ds_read_b64_tr_b16 v[158:159], v169 offset:13312
s_add_u32 m0, s56, 4096
s_nop 0
buffer_load_dwordx4 v172, s[44:47], s49 offen lds
s_add_u32 s49, s49, s54
v_mfma_f32_32x32x16_bf16 a[16:31], v[140:143], v[40:43], a[16:31]
ds_read_b64_tr_b16 v[160:161], v168 offset:14336
ds_read_b64_tr_b16 v[162:163], v168 offset:15360
buffer_load_dwordx4 v[24:27], v170, s[40:43], s48 offen offset:2048 sc1
v_mfma_f32_32x32x16_bf16 a[48:63], v[140:143], v[44:47], a[48:63]
ds_read_b64_tr_b16 v[164:165], v169 offset:14336
ds_read_b64_tr_b16 v[166:167], v169 offset:15360
buffer_load_dwordx4 v[28:31], v171, s[40:43], s48 offen offset:2048 sc1
v_mfma_f32_32x32x16_bf16 a[0:15], v[144:147], v[48:51], a[0:15]
v_mfma_f32_32x32x16_bf16 a[32:47], v[144:147], v[52:55], a[32:47]
buffer_load_dwordx4 v[32:35], v170, s[40:43], s48 offen offset:3072 sc1
v_mfma_f32_32x32x16_bf16 a[16:31], v[148:151], v[48:51], a[16:31]
buffer_load_dwordx4 v[36:39], v171, s[40:43], s48 offen offset:3072 sc1
s_add_u32 s48, s48, 4096
v_mfma_f32_32x32x16_bf16 a[48:63], v[148:151], v[52:55], a[48:63]
s_waitcnt lgkmcnt(4)
v_mfma_f32_32x32x16_bf16 a[0:15], v[152:155], v[56:59], a[0:15]
s_waitcnt vmcnt(25) lgkmcnt(0)
s_barrier
ds_read_b64_tr_b16 v[136:137], v168 offset:16384
ds_read_b64_tr_b16 v[138:139], v168 offset:17408
v_mfma_f32_32x32x16_bf16 a[32:47], v[152:155], v[60:63], a[32:47]
ds_read_b64_tr_b16 v[140:141], v169 offset:16384
ds_read_b64_tr_b16 v[142:143], v169 offset:17408
s_add_u32 m0, s56, 8192
s_nop 0
buffer_load_dwordx4 v172, s[44:47], s49 offen lds
s_add_u32 s49, s49, s54
v_mfma_f32_32x32x16_bf16 a[16:31], v[156:159], v[56:59], a[16:31]
ds_read_b64_tr_b16 v[144:145], v168 offset:18432
ds_read_b64_tr_b16 v[146:147], v168 offset:19456
buffer_load_dwordx4 v[40:43], v170, s[40:43], s48 offen offset:0 sc1
v_mfma_f32_32x32x16_bf16 a[48:63], v[156:159], v[60:63], a[48:63]
ds_read_b64_tr_b16 v[148:149], v169 offset:18432
ds_read_b64_tr_b16 v[150:151], v169 offset:19456
buffer_load_dwordx4 v[44:47], v171, s[40:43], s48 offen offset:0 sc1
v_mfma_f32_32x32x16_bf16 a[0:15], v[160:163], v[64:67], a[0:15]
v_mfma_f32_32x32x16_bf16 a[32:47], v[160:163], v[68:71], a[32:47]
buffer_load_dwordx4 v[48:51], v170, s[40:43], s48 offen offset:1024 sc1
v_mfma_f32_32x32x16_bf16 a[16:31], v[164:167], v[64:67], a[16:31]
buffer_load_dwordx4 v[52:55], v171, s[40:43], s48 offen offset:1024 sc1
v_mfma_f32_32x32x16_bf16 a[48:63], v[164:167], v[68:71], a[48:63]
s_waitcnt lgkmcnt(4)
v_mfma_f32_32x32x16_bf16 a[0:15], v[136:139], v[72:75], a[0:15]
s_waitcnt vmcnt(25) lgkmcnt(0)
s_barrier
ds_read_b64_tr_b16 v[152:153], v168 offset:20480
ds_read_b64_tr_b16 v[154:155], v168 offset:21504
v_mfma_f32_32x32x16_bf16 a[32:47], v[136:139], v[76:79], a[32:47]
ds_read_b64_tr_b16 v[156:157], v169 offset:20480
ds_read_b64_tr_b16 v[158:159], v169 offset:21504
s_add_u32 m0, s56, 12288
s_nop 0
buffer_load_dwordx4 v172, s[44:47], s49 offen lds
s_add_u32 s49, s49, s54
v_mfma_f32_32x32x16_bf16 a[16:31], v[140:143], v[72:75], a[16:31]
ds_read_b64_tr_b16 v[160:161], v168 offset:22528
ds_read_b64_tr_b16 v[162:163], v168 offset:23552
buffer_load_dwordx4 v[56:59], v170, s[40:43], s48 offen offset:2048 sc1
v_mfma_f32_32x32x16_bf16 a[48:63], v[140:143], v[76:79], a[48:63]
ds_read_b64_tr_b16 v[164:165], v169 offset:22528
ds_read_b64_tr_b16 v[166:167], v169 offset:23552
buffer_load_dwordx4 v[60:63], v171, s[40:43], s48 offen offset:2048 sc1
v_mfma_f32_32x32x16_bf16 a[0:15], v[144:147], v[80:83], a[0:15]
v_mfma_f32_32x32x16_bf16 a[32:47], v[144:147], v[84:87], a[32:47]
buffer_load_dwordx4 v[64:67], v170, s[40:43], s48 offen offset:3072 sc1
v_mfma_f32_32x32x16_bf16 a[16:31], v[148:151], v[80:83], a[16:31]
buffer_load_dwordx4 v[68:71], v171, s[40:43], s48 offen offset:3072 sc1
s_add_u32 s48, s48, 4096
v_mfma_f32_32x32x16_bf16 a[48:63], v[148:151], v[84:87], a[48:63]
s_waitcnt lgkmcnt(4)
v_mfma_f32_32x32x16_bf16 a[0:15], v[152:155], v[88:91], a[0:15]
s_waitcnt vmcnt(25) lgkmcnt(0)
s_barrier
ds_read_b64_tr_b16 v[136:137], v168 offset:24576
ds_read_b64_tr_b16 v[138:139], v168 offset:25600
v_mfma_f32_32x32x16_bf16 a[32:47], v[152:155], v[92:95], a[32:47]
ds_read_b64_tr_b16 v[140:141], v169 offset:24576
ds_read_b64_tr_b16 v[142:143], v169 offset:25600
s_add_u32 m0, s56, 16384
s_nop 0
buffer_load_dwordx4 v172, s[44:47], s49 offen lds
s_add_u32 s49, s49, s54
v_mfma_f32_32x32x16_bf16 a[16:31], v[156:159], v[88:91], a[16:31]
ds_read_b64_tr_b16 v[144:145], v168 offset:26624
ds_read_b64_tr_b16 v[146:147], v168 offset:27648
buffer_load_dwordx4 v[72:75], v170, s[40:43], s48 offen offset:0 sc1
v_mfma_f32_32x32x16_bf16 a[48:63], v[156:159], v[92:95], a[48:63]
ds_read_b64_tr_b16 v[148:149], v169 offset:26624
ds_read_b64_tr_b16 v[150:151], v169 offset:27648
buffer_load_dwordx4 v[76:79], v171, s[40:43], s48 offen offset:0 sc1
v_mfma_f32_32x32x16_bf16 a[0:15], v[160:163], v[96:99], a[0:15]
v_mfma_f32_32x32x16_bf16 a[32:47], v[160:163], v[100:103], a[32:47]
buffer_load_dwordx4 v[80:83], v170, s[40:43], s48 offen offset:1024 sc1
v_mfma_f32_32x32x16_bf16 a[16:31], v[164:167], v[96:99], a[16:31]
buffer_load_dwordx4 v[84:87], v171, s[40:43], s48 offen offset:1024 sc1
v_mfma_f32_32x32x16_bf16 a[48:63], v[164:167], v[100:103], a[48:63]
s_waitcnt lgkmcnt(4)
v_mfma_f32_32x32x16_bf16 a[0:15], v[136:139], v[104:107], a[0:15]
s_waitcnt vmcnt(25) lgkmcnt(0)
s_barrier
ds_read_b64_tr_b16 v[152:153], v168 offset:28672
ds_read_b64_tr_b16 v[154:155], v168 offset:29696
v_mfma_f32_32x32x16_bf16 a[32:47], v[136:139], v[108:111], a[32:47]
ds_read_b64_tr_b16 v[156:157], v169 offset:28672
ds_read_b64_tr_b16 v[158:159], v169 offset:29696
s_add_u32 m0, s56, 20480
s_nop 0
buffer_load_dwordx4 v172, s[44:47], s49 offen lds
s_add_u32 s49, s49, s54
v_mfma_f32_32x32x16_bf16 a[16:31], v[140:143], v[104:107], a[16:31]
ds_read_b64_tr_b16 v[160:161], v168 offset:30720
ds_read_b64_tr_b16 v[162:163], v168 offset:31744
buffer_load_dwordx4 v[88:91], v170, s[40:43], s48 offen offset:2048 sc1
v_mfma_f32_32x32x16_bf16 a[48:63], v[140:143], v[108:111], a[48:63]
ds_read_b64_tr_b16 v[164:165], v169 offset:30720
ds_read_b64_tr_b16 v[166:167], v169 offset:31744
buffer_load_dwordx4 v[92:95], v171, s[40:43], s48 offen offset:2048 sc1
v_mfma_f32_32x32x16_bf16 a[0:15], v[144:147], v[112:115], a[0:15]
v_mfma_f32_32x32x16_bf16 a[32:47], v[144:147], v[116:119], a[32:47]
buffer_load_dwordx4 v[96:99], v170, s[40:43], s48 offen offset:3072 sc1
v_mfma_f32_32x32x16_bf16 a[16:31], v[148:151], v[112:115], a[16:31]
buffer_load_dwordx4 v[100:103], v171, s[40:43], s48 offen offset:3072 sc1
s_add_u32 s48, s48, 4096
v_mfma_f32_32x32x16_bf16 a[48:63], v[148:151], v[116:119], a[48:63]
s_waitcnt lgkmcnt(4)
v_mfma_f32_32x32x16_bf16 a[0:15], v[152:155], v[120:123], a[0:15]
s_waitcnt vmcnt(25) lgkmcnt(0)
s_barrier
ds_read_b64_tr_b16 v[136:137], v168 offset:0
ds_read_b64_tr_b16 v[138:139], v168 offset:1024
v_mfma_f32_32x32x16_bf16 a[32:47], v[152:155], v[124:127], a[32:47]
ds_read_b64_tr_b16 v[140:141], v169 offset:0
ds_read_b64_tr_b16 v[142:143], v169 offset:1024
s_add_u32 m0, s56, 24576
s_nop 0
buffer_load_dwordx4 v172, s[44:47], s49 offen lds
s_add_u32 s49, s49, s54
v_mfma_f32_32x32x16_bf16 a[16:31], v[156:159], v[120:123], a[16:31]
ds_read_b64_tr_b16 v[144:145], v168 offset:2048
ds_read_b64_tr_b16 v[146:147], v168 offset:3072
buffer_load_dwordx4 v[104:107], v170, s[40:43], s48 offen offset:0 sc1
v_mfma_f32_32x32x16_bf16 a[48:63], v[156:159], v[124:127], a[48:63]
ds_read_b64_tr_b16 v[148:149], v169 offset:2048
ds_read_b64_tr_b16 v[150:151], v169 offset:3072
buffer_load_dwordx4 v[108:111], v171, s[40:43], s48 offen offset:0 sc1
v_mfma_f32_32x32x16_bf16 a[0:15], v[160:163], v[128:131], a[0:15]
v_mfma_f32_32x32x16_bf16 a[32:47], v[160:163], v[132:135], a[32:47]
buffer_load_dwordx4 v[112:115], v170, s[40:43], s48 offen offset:1024 sc1
v_mfma_f32_32x32x16_bf16 a[16:31], v[164:167], v[128:131], a[16:31]
buffer_load_dwordx4 v[116:119], v171, s[40:43], s48 offen offset:1024 sc1
v_mfma_f32_32x32x16_bf16 a[48:63], v[164:167], v[132:135], a[48:63]
s_sub_u32 s50, s50, 8
s_cmp_gt_u32 s50, 0
s_cbranch_scc1 .LgD_310
s_waitcnt vmcnt(0) lgkmcnt(0)
s_nop 15
s_branch .Lepi_309
.Lvt_308:
v_accvgpr_write_b32 a0, 0
v_accvgpr_write_b32 a1, 0
v_accvgpr_write_b32 a2, 0
v_accvgpr_write_b32 a3, 0
v_accvgpr_write_b32 a4, 0
v_accvgpr_write_b32 a5, 0
v_accvgpr_write_b32 a6, 0
v_accvgpr_write_b32 a7, 0
v_accvgpr_write_b32 a8, 0
v_accvgpr_write_b32 a9, 0
v_accvgpr_write_b32 a10, 0
v_accvgpr_write_b32 a11, 0
v_accvgpr_write_b32 a12, 0
v_accvgpr_write_b32 a13, 0
v_accvgpr_write_b32 a14, 0
v_accvgpr_write_b32 a15, 0
v_accvgpr_write_b32 a16, 0
v_accvgpr_write_b32 a17, 0
v_accvgpr_write_b32 a18, 0
v_accvgpr_write_b32 a19, 0
v_accvgpr_write_b32 a20, 0
v_accvgpr_write_b32 a21, 0
v_accvgpr_write_b32 a22, 0
v_accvgpr_write_b32 a23, 0
v_accvgpr_write_b32 a24, 0
v_accvgpr_write_b32 a25, 0
v_accvgpr_write_b32 a26, 0
v_accvgpr_write_b32 a27, 0
v_accvgpr_write_b32 a28, 0
v_accvgpr_write_b32 a29, 0
v_accvgpr_write_b32 a30, 0
v_accvgpr_write_b32 a31, 0
v_accvgpr_write_b32 a32, 0
v_accvgpr_write_b32 a33, 0
v_accvgpr_write_b32 a34, 0
v_accvgpr_write_b32 a35, 0
v_accvgpr_write_b32 a36, 0
v_accvgpr_write_b32 a37, 0
v_accvgpr_write_b32 a38, 0
v_accvgpr_write_b32 a39, 0
v_accvgpr_write_b32 a40, 0
v_accvgpr_write_b32 a41, 0
v_accvgpr_write_b32 a42, 0
v_accvgpr_write_b32 a43, 0
v_accvgpr_write_b32 a44, 0
v_accvgpr_write_b32 a45, 0
v_accvgpr_write_b32 a46, 0
v_accvgpr_write_b32 a47, 0
v_accvgpr_write_b32 a48, 0
v_accvgpr_write_b32 a49, 0
v_accvgpr_write_b32 a50, 0
v_accvgpr_write_b32 a51, 0
v_accvgpr_write_b32 a52, 0
v_accvgpr_write_b32 a53, 0
v_accvgpr_write_b32 a54, 0
v_accvgpr_write_b32 a55, 0
v_accvgpr_write_b32 a56, 0
v_accvgpr_write_b32 a57, 0
v_accvgpr_write_b32 a58, 0
v_accvgpr_write_b32 a59, 0
v_accvgpr_write_b32 a60, 0
v_accvgpr_write_b32 a61, 0
v_accvgpr_write_b32 a62, 0
v_accvgpr_write_b32 a63, 0
s_waitcnt vmcnt(24)
s_barrier
ds_read_b64_tr_b16 v[136:137], v168 offset:0
ds_read_b64_tr_b16 v[138:139], v168 offset:1024
ds_read_b64_tr_b16 v[140:141], v169 offset:0
ds_read_b64_tr_b16 v[142:143], v169 offset:1024
ds_read_b64_tr_b16 v[144:145], v168 offset:2048
ds_read_b64_tr_b16 v[146:147], v168 offset:3072
ds_read_b64_tr_b16 v[148:149], v169 offset:2048
ds_read_b64_tr_b16 v[150:151], v169 offset:3072
s_waitcnt lgkmcnt(4)
v_mfma_f32_32x32x16_bf16 a[0:15], v[8:11], v[136:139], a[0:15]
s_waitcnt vmcnt(20) lgkmcnt(0)
s_barrier
ds_read_b64_tr_b16 v[152:153], v168 offset:4096
ds_read_b64_tr_b16 v[154:155], v168 offset:5120
v_mfma_f32_32x32x16_bf16 a[32:47], v[12:15], v[136:139], a[32:47]
ds_read_b64_tr_b16 v[156:157], v169 offset:4096
ds_read_b64_tr_b16 v[158:159], v169 offset:5120
s_add_u32 m0, s56, 28672
s_nop 0
buffer_load_dwordx4 v172, s[44:47], s49 offen lds
s_add_u32 s49, s49, s54
v_mfma_f32_32x32x16_bf16 a[16:31], v[8:11], v[140:143], a[16:31]
ds_read_b64_tr_b16 v[160:161], v168 offset:6144
ds_read_b64_tr_b16 v[162:163], v168 offset:7168
buffer_load_dwordx4 v[120:123], v170, s[40:43], s48 offen offset:2048 sc1
v_mfma_f32_32x32x16_bf16 a[48:63], v[12:15], v[140:143], a[48:63]
ds_read_b64_tr_b16 v[164:165], v169 offset:6144
ds_read_b64_tr_b16 v[166:167], v169 offset:7168
buffer_load_dwordx4 v[124:127], v171, s[40:43], s48 offen offset:2048 sc1
v_mfma_f32_32x32x16_bf16 a[0:15], v[16:19], v[144:147], a[0:15]
buffer_load_dwordx4 v[128:131], v170, s[40:43], s48 offen offset:3072 sc1
v_mfma_f32_32x32x16_bf16 a[32:47], v[20:23], v[144:147], a[32:47]
buffer_load_dwordx4 v[132:135], v171, s[40:43], s48 offen offset:3072 sc1
s_add_u32 s48, s48, 4096
v_mfma_f32_32x32x16_bf16 a[16:31], v[16:19], v[148:151], a[16:31]
s_cmp_eq_u32 s50, 8
s_cselect_b32 s42, 0, s42
s_cselect_b32 s46, 0, s46
v_mfma_f32_32x32x16_bf16 a[48:63], v[20:23], v[148:151], a[48:63]
s_waitcnt lgkmcnt(4)
v_mfma_f32_32x32x16_bf16 a[0:15], v[24:27], v[152:155], a[0:15]
s_waitcnt vmcnt(21) lgkmcnt(0)
s_barrier
ds_read_b64_tr_b16 v[136:137], v168 offset:8192
ds_read_b64_tr_b16 v[138:139], v168 offset:9216
v_mfma_f32_32x32x16_bf16 a[32:47], v[28:31], v[152:155], a[32:47]
ds_read_b64_tr_b16 v[140:141], v169 offset:8192
ds_read_b64_tr_b16 v[142:143], v169 offset:9216
s_add_u32 m0, s56, 0
s_nop 0
buffer_load_dwordx4 v172, s[44:47], s49 offen lds
s_add_u32 s49, s49, s54
v_mfma_f32_32x32x16_bf16 a[16:31], v[24:27], v[156:159], a[16:31]
ds_read_b64_tr_b16 v[144:145], v168 offset:10240
ds_read_b64_tr_b16 v[146:147], v168 offset:11264
buffer_load_dwordx4 v[8:11], v170, s[40:43], s48 offen offset:0 sc1
v_mfma_f32_32x32x16_bf16 a[48:63], v[28:31], v[156:159], a[48:63]
ds_read_b64_tr_b16 v[148:149], v169 offset:10240
ds_read_b64_tr_b16 v[150:151], v169 offset:11264
buffer_load_dwordx4 v[12:15], v171, s[40:43], s48 offen offset:0 sc1
v_mfma_f32_32x32x16_bf16 a[0:15], v[32:35], v[160:163], a[0:15]
v_mfma_f32_32x32x16_bf16 a[32:47], v[36:39], v[160:163], a[32:47]
buffer_load_dwordx4 v[16:19], v170, s[40:43], s48 offen offset:1024 sc1
v_mfma_f32_32x32x16_bf16 a[16:31], v[32:35], v[164:167], a[16:31]
buffer_load_dwordx4 v[20:23], v171, s[40:43], s48 offen offset:1024 sc1
v_mfma_f32_32x32x16_bf16 a[48:63], v[36:39], v[164:167], a[48:63]
s_waitcnt lgkmcnt(4)
v_mfma_f32_32x32x16_bf16 a[0:15], v[40:43], v[136:139], a[0:15]
s_waitcnt vmcnt(22) lgkmcnt(0)
s_barrier
ds_read_b64_tr_b16 v[152:153], v168 offset:12288
ds_read_b64_tr_b16 v[154:155], v168 offset:13312
v_mfma_f32_32x32x16_bf16 a[32:47], v[44:47], v[136:139], a[32:47]
ds_read_b64_tr_b16 v[156:157], v169 offset:12288
ds_read_b64_tr_b16 v[158:159], v169 offset:13312
s_add_u32 m0, s56, 4096
s_nop 0
buffer_load_dwordx4 v172, s[44:47], s49 offen lds
s_add_u32 s49, s49, s54
v_mfma_f32_32x32x16_bf16 a[16:31], v[40:43], v[140:143], a[16:31]
ds_read_b64_tr_b16 v[160:161], v168 offset:14336
ds_read_b64_tr_b16 v[162:163], v168 offset:15360
buffer_load_dwordx4 v[24:27], v170, s[40:43], s48 offen offset:2048 sc1
v_mfma_f32_32x32x16_bf16 a[48:63], v[44:47], v[140:143], a[48:63]
ds_read_b64_tr_b16 v[164:165], v169 offset:14336
ds_read_b64_tr_b16 v[166:167], v169 offset:15360
buffer_load_dwordx4 v[28:31], v171, s[40:43], s48 offen offset:2048 sc1
v_mfma_f32_32x32x16_bf16 a[0:15], v[48:51], v[144:147], a[0:15]
v_mfma_f32_32x32x16_bf16 a[32:47], v[52:55], v[144:147], a[32:47]
buffer_load_dwordx4 v[32:35], v170, s[40:43], s48 offen offset:3072 sc1
v_mfma_f32_32x32x16_bf16 a[16:31], v[48:51], v[148:151], a[16:31]
buffer_load_dwordx4 v[36:39], v171, s[40:43], s48 offen offset:3072 sc1
s_add_u32 s48, s48, 4096
v_mfma_f32_32x32x16_bf16 a[48:63], v[52:55], v[148:151], a[48:63]
s_waitcnt lgkmcnt(4)
v_mfma_f32_32x32x16_bf16 a[0:15], v[56:59], v[152:155], a[0:15]
s_waitcnt vmcnt(23) lgkmcnt(0)
s_barrier
ds_read_b64_tr_b16 v[136:137], v168 offset:16384
ds_read_b64_tr_b16 v[138:139], v168 offset:17408
v_mfma_f32_32x32x16_bf16 a[32:47], v[60:63], v[152:155], a[32:47]
ds_read_b64_tr_b16 v[140:141], v169 offset:16384
ds_read_b64_tr_b16 v[142:143], v169 offset:17408
s_add_u32 m0, s56, 8192
s_nop 0
buffer_load_dwordx4 v172, s[44:47], s49 offen lds
s_add_u32 s49, s49, s54
v_mfma_f32_32x32x16_bf16 a[16:31], v[56:59], v[156:159], a[16:31]
ds_read_b64_tr_b16 v[144:145], v168 offset:18432
ds_read_b64_tr_b16 v[146:147], v168 offset:19456
buffer_load_dwordx4 v[40:43], v170, s[40:43], s48 offen offset:0 sc1
v_mfma_f32_32x32x16_bf16 a[48:63], v[60:63], v[156:159], a[48:63]
ds_read_b64_tr_b16 v[148:149], v169 offset:18432
ds_read_b64_tr_b16 v[150:151], v169 offset:19456
buffer_load_dwordx4 v[44:47], v171, s[40:43], s48 offen offset:0 sc1
v_mfma_f32_32x32x16_bf16 a[0:15], v[64:67], v[160:163], a[0:15]
v_mfma_f32_32x32x16_bf16 a[32:47], v[68:71], v[160:163], a[32:47]
buffer_load_dwordx4 v[48:51], v170, s[40:43], s48 offen offset:1024 sc1
v_mfma_f32_32x32x16_bf16 a[16:31], v[64:67], v[164:167], a[16:31]
buffer_load_dwordx4 v[52:55], v171, s[40:43], s48 offen offset:1024 sc1
v_mfma_f32_32x32x16_bf16 a[48:63], v[68:71], v[164:167], a[48:63]
s_waitcnt lgkmcnt(4)
v_mfma_f32_32x32x16_bf16 a[0:15], v[72:75], v[136:139], a[0:15]
s_waitcnt vmcnt(24) lgkmcnt(0)
s_barrier
ds_read_b64_tr_b16 v[152:153], v168 offset:20480
ds_read_b64_tr_b16 v[154:155], v168 offset:21504
v_mfma_f32_32x32x16_bf16 a[32:47], v[76:79], v[136:139], a[32:47]
ds_read_b64_tr_b16 v[156:157], v169 offset:20480
ds_read_b64_tr_b16 v[158:159], v169 offset:21504
s_add_u32 m0, s56, 12288
s_nop 0
buffer_load_dwordx4 v172, s[44:47], s49 offen lds
s_add_u32 s49, s49, s54
v_mfma_f32_32x32x16_bf16 a[16:31], v[72:75], v[140:143], a[16:31]
ds_read_b64_tr_b16 v[160:161], v168 offset:22528
ds_read_b64_tr_b16 v[162:163], v168 offset:23552
buffer_load_dwordx4 v[56:59], v170, s[40:43], s48 offen offset:2048 sc1
v_mfma_f32_32x32x16_bf16 a[48:63], v[76:79], v[140:143], a[48:63]
ds_read_b64_tr_b16 v[164:165], v169 offset:22528
ds_read_b64_tr_b16 v[166:167], v169 offset:23552
buffer_load_dwordx4 v[60:63], v171, s[40:43], s48 offen offset:2048 sc1
v_mfma_f32_32x32x16_bf16 a[0:15], v[80:83], v[144:147], a[0:15]
v_mfma_f32_32x32x16_bf16 a[32:47], v[84:87], v[144:147], a[32:47]
buffer_load_dwordx4 v[64:67], v170, s[40:43], s48 offen offset:3072 sc1
v_mfma_f32_32x32x16_bf16 a[16:31], v[80:83], v[148:151], a[16:31]
buffer_load_dwordx4 v[68:71], v171, s[40:43], s48 offen offset:3072 sc1
s_add_u32 s48, s48, 4096
v_mfma_f32_32x32x16_bf16 a[48:63], v[84:87], v[148:151], a[48:63]
s_waitcnt lgkmcnt(4)
v_mfma_f32_32x32x16_bf16 a[0:15], v[88:91], v[152:155], a[0:15]
s_waitcnt vmcnt(25) lgkmcnt(0)
s_barrier
ds_read_b64_tr_b16 v[136:137], v168 offset:24576
ds_read_b64_tr_b16 v[138:139], v168 offset:25600
v_mfma_f32_32x32x16_bf16 a[32:47], v[92:95], v[152:155], a[32:47]
ds_read_b64_tr_b16 v[140:141], v169 offset:24576
ds_read_b64_tr_b16 v[142:143], v169 offset:25600
s_add_u32 m0, s56, 16384
s_nop 0
buffer_load_dwordx4 v172, s[44:47], s49 offen lds
s_add_u32 s49, s49, s54
v_mfma_f32_32x32x16_bf16 a[16:31], v[88:91], v[156:159], a[16:31]
ds_read_b64_tr_b16 v[144:145], v168 offset:26624
ds_read_b64_tr_b16 v[146:147], v168 offset:27648
buffer_load_dwordx4 v[72:75], v170, s[40:43], s48 offen offset:0 sc1
v_mfma_f32_32x32x16_bf16 a[48:63], v[92:95], v[156:159], a[48:63]
ds_read_b64_tr_b16 v[148:149], v169 offset:26624
ds_read_b64_tr_b16 v[150:151], v169 offset:27648
buffer_load_dwordx4 v[76:79], v171, s[40:43], s48 offen offset:0 sc1
v_mfma_f32_32x32x16_bf16 a[0:15], v[96:99], v[160:163], a[0:15]
v_mfma_f32_32x32x16_bf16 a[32:47], v[100:103], v[160:163], a[32:47]
buffer_load_dwordx4 v[80:83], v170, s[40:43], s48 offen offset:1024 sc1
v_mfma_f32_32x32x16_bf16 a[16:31], v[96:99], v[164:167], a[16:31]
buffer_load_dwordx4 v[84:87], v171, s[40:43], s48 offen offset:1024 sc1
v_mfma_f32_32x32x16_bf16 a[48:63], v[100:103], v[164:167], a[48:63]
s_waitcnt lgkmcnt(4)
v_mfma_f32_32x32x16_bf16 a[0:15], v[104:107], v[136:139], a[0:15]
s_waitcnt vmcnt(25) lgkmcnt(0)
s_barrier
ds_read_b64_tr_b16 v[152:153], v168 offset:28672
ds_read_b64_tr_b16 v[154:155], v168 offset:29696
v_mfma_f32_32x32x16_bf16 a[32:47], v[108:111], v[136:139], a[32:47]
ds_read_b64_tr_b16 v[156:157], v169 offset:28672
ds_read_b64_tr_b16 v[158:159], v169 offset:29696
s_add_u32 m0, s56, 20480
s_nop 0
buffer_load_dwordx4 v172, s[44:47], s49 offen lds
s_add_u32 s49, s49, s54
v_mfma_f32_32x32x16_bf16 a[16:31], v[104:107], v[140:143], a[16:31]
ds_read_b64_tr_b16 v[160:161], v168 offset:30720
ds_read_b64_tr_b16 v[162:163], v168 offset:31744
buffer_load_dwordx4 v[88:91], v170, s[40:43], s48 offen offset:2048 sc1
v_mfma_f32_32x32x16_bf16 a[48:63], v[108:111], v[140:143], a[48:63]
ds_read_b64_tr_b16 v[164:165], v169 offset:30720
ds_read_b64_tr_b16 v[166:167], v169 offset:31744
buffer_load_dwordx4 v[92:95], v171, s[40:43], s48 offen offset:2048 sc1
v_mfma_f32_32x32x16_bf16 a[0:15], v[112:115], v[144:147], a[0:15]
v_mfma_f32_32x32x16_bf16 a[32:47], v[116:119], v[144:147], a[32:47]
buffer_load_dwordx4 v[96:99], v170, s[40:43], s48 offen offset:3072 sc1
v_mfma_f32_32x32x16_bf16 a[16:31], v[112:115], v[148:151], a[16:31]
buffer_load_dwordx4 v[100:103], v171, s[40:43], s48 offen offset:3072 sc1
s_add_u32 s48, s48, 4096
v_mfma_f32_32x32x16_bf16 a[48:63], v[116:119], v[148:151], a[48:63]
s_waitcnt lgkmcnt(4)
v_mfma_f32_32x32x16_bf16 a[0:15], v[120:123], v[152:155], a[0:15]
s_waitcnt vmcnt(25) lgkmcnt(0)
s_barrier
ds_read_b64_tr_b16 v[136:137], v168 offset:0
ds_read_b64_tr_b16 v[138:139], v168 offset:1024
v_mfma_f32_32x32x16_bf16 a[32:47], v[124:127], v[152:155], a[32:47]
ds_read_b64_tr_b16 v[140:141], v169 offset:0
ds_read_b64_tr_b16 v[142:143], v169 offset:1024
s_add_u32 m0, s56, 24576
s_nop 0
buffer_load_dwordx4 v172, s[44:47], s49 offen lds
s_add_u32 s49, s49, s54
v_mfma_f32_32x32x16_bf16 a[16:31], v[120:123], v[156:159], a[16:31]
ds_read_b64_tr_b16 v[144:145], v168 offset:2048
ds_read_b64_tr_b16 v[146:147], v168 offset:3072
buffer_load_dwordx4 v[104:107], v170, s[40:43], s48 offen offset:0 sc1
v_mfma_f32_32x32x16_bf16 a[48:63], v[124:127], v[156:159], a[48:63]
ds_read_b64_tr_b16 v[148:149], v169 offset:2048
ds_read_b64_tr_b16 v[150:151], v169 offset:3072
buffer_load_dwordx4 v[108:111], v171, s[40:43], s48 offen offset:0 sc1
v_mfma_f32_32x32x16_bf16 a[0:15], v[128:131], v[160:163], a[0:15]
v_mfma_f32_32x32x16_bf16 a[32:47], v[132:135], v[160:163], a[32:47]
buffer_load_dwordx4 v[112:115], v170, s[40:43], s48 offen offset:1024 sc1
v_mfma_f32_32x32x16_bf16 a[16:31], v[128:131], v[164:167], a[16:31]
buffer_load_dwordx4 v[116:119], v171, s[40:43], s48 offen offset:1024 sc1
v_mfma_f32_32x32x16_bf16 a[48:63], v[132:135], v[164:167], a[48:63]
s_sub_u32 s50, s50, 8
.LgD_312:
s_waitcnt lgkmcnt(4)
v_mfma_f32_32x32x16_bf16 a[0:15], v[8:11], v[136:139], a[0:15]
s_waitcnt vmcnt(25) lgkmcnt(0)
s_barrier
ds_read_b64_tr_b16 v[152:153], v168 offset:4096
ds_read_b64_tr_b16 v[154:155], v168 offset:5120
v_mfma_f32_32x32x16_bf16 a[32:47], v[12:15], v[136:139], a[32:47]
ds_read_b64_tr_b16 v[156:157], v169 offset:4096
ds_read_b64_tr_b16 v[158:159], v169 offset:5120
s_add_u32 m0, s56, 28672
s_nop 0
buffer_load_dwordx4 v172, s[44:47], s49 offen lds
s_add_u32 s49, s49, s54
v_mfma_f32_32x32x16_bf16 a[16:31], v[8:11], v[140:143], a[16:31]
ds_read_b64_tr_b16 v[160:161], v168 offset:6144
ds_read_b64_tr_b16 v[162:163], v168 offset:7168
buffer_load_dwordx4 v[120:123], v170, s[40:43], s48 offen offset:2048 sc1
v_mfma_f32_32x32x16_bf16 a[48:63], v[12:15], v[140:143], a[48:63]
ds_read_b64_tr_b16 v[164:165], v169 offset:6144
ds_read_b64_tr_b16 v[166:167], v169 offset:7168
buffer_load_dwordx4 v[124:127], v171, s[40:43], s48 offen offset:2048 sc1
v_mfma_f32_32x32x16_bf16 a[0:15], v[16:19], v[144:147], a[0:15]
buffer_load_dwordx4 v[128:131], v170, s[40:43], s48 offen offset:3072 sc1
v_mfma_f32_32x32x16_bf16 a[32:47], v[20:23], v[144:147], a[32:47]
buffer_load_dwordx4 v[132:135], v171, s[40:43], s48 offen offset:3072 sc1
s_add_u32 s48, s48, 4096
v_mfma_f32_32x32x16_bf16 a[16:31], v[16:19], v[148:151], a[16:31]
s_cmp_eq_u32 s50, 8
s_cselect_b32 s42, 0, s42
s_cselect_b32 s46, 0, s46
v_mfma_f32_32x32x16_bf16 a[48:63], v[20:23], v[148:151], a[48:63]
s_waitcnt lgkmcnt(4)
v_mfma_f32_32x32x16_bf16 a[0:15], v[24:27], v[152:155], a[0:15]
s_waitcnt vmcnt(25) lgkmcnt(0)
s_barrier
ds_read_b64_tr_b16 v[136:137], v168 offset:8192
ds_read_b64_tr_b16 v[138:139], v168 offset:9216
v_mfma_f32_32x32x16_bf16 a[32:47], v[28:31], v[152:155], a[32:47]
ds_read_b64_tr_b16 v[140:141], v169 offset:8192
ds_read_b64_tr_b16 v[142:143], v169 offset:9216
s_add_u32 m0, s56, 0
s_nop 0
buffer_load_dwordx4 v172, s[44:47], s49 offen lds
s_add_u32 s49, s49, s54
v_mfma_f32_32x32x16_bf16 a[16:31], v[24:27], v[156:159], a[16:31]
ds_read_b64_tr_b16 v[144:145], v168 offset:10240
ds_read_b64_tr_b16 v[146:147], v168 offset:11264
buffer_load_dwordx4 v[8:11], v170, s[40:43], s48 offen offset:0 sc1
v_mfma_f32_32x32x16_bf16 a[48:63], v[28:31], v[156:159], a[48:63]
ds_read_b64_tr_b16 v[148:149], v169 offset:10240
ds_read_b64_tr_b16 v[150:151], v169 offset:11264
buffer_load_dwordx4 v[12:15], v171, s[40:43], s48 offen offset:0 sc1
v_mfma_f32_32x32x16_bf16 a[0:15], v[32:35], v[160:163], a[0:15]
v_mfma_f32_32x32x16_bf16 a[32:47], v[36:39], v[160:163], a[32:47]
buffer_load_dwordx4 v[16:19], v170, s[40:43], s48 offen offset:1024 sc1
v_mfma_f32_32x32x16_bf16 a[16:31], v[32:35], v[164:167], a[16:31]
buffer_load_dwordx4 v[20:23], v171, s[40:43], s48 offen offset:1024 sc1
v_mfma_f32_32x32x16_bf16 a[48:63], v[36:39], v[164:167], a[48:63]
s_waitcnt lgkmcnt(4)
v_mfma_f32_32x32x16_bf16 a[0:15], v[40:43], v[136:139], a[0:15]
s_waitcnt vmcnt(25) lgkmcnt(0)
s_barrier
ds_read_b64_tr_b16 v[152:153], v168 offset:12288
ds_read_b64_tr_b16 v[154:155], v168 offset:13312
v_mfma_f32_32x32x16_bf16 a[32:47], v[44:47], v[136:139], a[32:47]
ds_read_b64_tr_b16 v[156:157], v169 offset:12288
ds_read_b64_tr_b16 v[158:159], v169 offset:13312
s_add_u32 m0, s56, 4096
s_nop 0
buffer_load_dwordx4 v172, s[44:47], s49 offen lds
s_add_u32 s49, s49, s54
v_mfma_f32_32x32x16_bf16 a[16:31], v[40:43], v[140:143], a[16:31]
ds_read_b64_tr_b16 v[160:161], v168 offset:14336
ds_read_b64_tr_b16 v[162:163], v168 offset:15360
buffer_load_dwordx4 v[24:27], v170, s[40:43], s48 offen offset:2048 sc1
v_mfma_f32_32x32x16_bf16 a[48:63], v[44:47], v[140:143], a[48:63]
ds_read_b64_tr_b16 v[164:165], v169 offset:14336
ds_read_b64_tr_b16 v[166:167], v169 offset:15360
buffer_load_dwordx4 v[28:31], v171, s[40:43], s48 offen offset:2048 sc1
v_mfma_f32_32x32x16_bf16 a[0:15], v[48:51], v[144:147], a[0:15]
v_mfma_f32_32x32x16_bf16 a[32:47], v[52:55], v[144:147], a[32:47]
buffer_load_dwordx4 v[32:35], v170, s[40:43], s48 offen offset:3072 sc1
v_mfma_f32_32x32x16_bf16 a[16:31], v[48:51], v[148:151], a[16:31]
buffer_load_dwordx4 v[36:39], v171, s[40:43], s48 offen offset:3072 sc1
s_add_u32 s48, s48, 4096
v_mfma_f32_32x32x16_bf16 a[48:63], v[52:55], v[148:151], a[48:63]
s_waitcnt lgkmcnt(4)
v_mfma_f32_32x32x16_bf16 a[0:15], v[56:59], v[152:155], a[0:15]
s_waitcnt vmcnt(25) lgkmcnt(0)
s_barrier
ds_read_b64_tr_b16 v[136:137], v168 offset:16384
ds_read_b64_tr_b16 v[138:139], v168 offset:17408
v_mfma_f32_32x32x16_bf16 a[32:47], v[60:63], v[152:155], a[32:47]
ds_read_b64_tr_b16 v[140:141], v169 offset:16384
ds_read_b64_tr_b16 v[142:143], v169 offset:17408
s_add_u32 m0, s56, 8192
s_nop 0
buffer_load_dwordx4 v172, s[44:47], s49 offen lds
s_add_u32 s49, s49, s54
v_mfma_f32_32x32x16_bf16 a[16:31], v[56:59], v[156:159], a[16:31]
ds_read_b64_tr_b16 v[144:145], v168 offset:18432
ds_read_b64_tr_b16 v[146:147], v168 offset:19456
buffer_load_dwordx4 v[40:43], v170, s[40:43], s48 offen offset:0 sc1
v_mfma_f32_32x32x16_bf16 a[48:63], v[60:63], v[156:159], a[48:63]
ds_read_b64_tr_b16 v[148:149], v169 offset:18432
ds_read_b64_tr_b16 v[150:151], v169 offset:19456
buffer_load_dwordx4 v[44:47], v171, s[40:43], s48 offen offset:0 sc1
v_mfma_f32_32x32x16_bf16 a[0:15], v[64:67], v[160:163], a[0:15]
v_mfma_f32_32x32x16_bf16 a[32:47], v[68:71], v[160:163], a[32:47]
buffer_load_dwordx4 v[48:51], v170, s[40:43], s48 offen offset:1024 sc1
v_mfma_f32_32x32x16_bf16 a[16:31], v[64:67], v[164:167], a[16:31]
buffer_load_dwordx4 v[52:55], v171, s[40:43], s48 offen offset:1024 sc1
v_mfma_f32_32x32x16_bf16 a[48:63], v[68:71], v[164:167], a[48:63]
s_waitcnt lgkmcnt(4)
v_mfma_f32_32x32x16_bf16 a[0:15], v[72:75], v[136:139], a[0:15]
s_waitcnt vmcnt(25) lgkmcnt(0)
s_barrier
ds_read_b64_tr_b16 v[152:153], v168 offset:20480
ds_read_b64_tr_b16 v[154:155], v168 offset:21504
v_mfma_f32_32x32x16_bf16 a[32:47], v[76:79], v[136:139], a[32:47]
ds_read_b64_tr_b16 v[156:157], v169 offset:20480
ds_read_b64_tr_b16 v[158:159], v169 offset:21504
s_add_u32 m0, s56, 12288
s_nop 0
buffer_load_dwordx4 v172, s[44:47], s49 offen lds
s_add_u32 s49, s49, s54
v_mfma_f32_32x32x16_bf16 a[16:31], v[72:75], v[140:143], a[16:31]
ds_read_b64_tr_b16 v[160:161], v168 offset:22528
ds_read_b64_tr_b16 v[162:163], v168 offset:23552
buffer_load_dwordx4 v[56:59], v170, s[40:43], s48 offen offset:2048 sc1
v_mfma_f32_32x32x16_bf16 a[48:63], v[76:79], v[140:143], a[48:63]
ds_read_b64_tr_b16 v[164:165], v169 offset:22528
ds_read_b64_tr_b16 v[166:167], v169 offset:23552
buffer_load_dwordx4 v[60:63], v171, s[40:43], s48 offen offset:2048 sc1
v_mfma_f32_32x32x16_bf16 a[0:15], v[80:83], v[144:147], a[0:15]
v_mfma_f32_32x32x16_bf16 a[32:47], v[84:87], v[144:147], a[32:47]
buffer_load_dwordx4 v[64:67], v170, s[40:43], s48 offen offset:3072 sc1
v_mfma_f32_32x32x16_bf16 a[16:31], v[80:83], v[148:151], a[16:31]
buffer_load_dwordx4 v[68:71], v171, s[40:43], s48 offen offset:3072 sc1
s_add_u32 s48, s48, 4096
v_mfma_f32_32x32x16_bf16 a[48:63], v[84:87], v[148:151], a[48:63]
s_waitcnt lgkmcnt(4)
v_mfma_f32_32x32x16_bf16 a[0:15], v[88:91], v[152:155], a[0:15]
s_waitcnt vmcnt(25) lgkmcnt(0)
s_barrier
ds_read_b64_tr_b16 v[136:137], v168 offset:24576
ds_read_b64_tr_b16 v[138:139], v168 offset:25600
v_mfma_f32_32x32x16_bf16 a[32:47], v[92:95], v[152:155], a[32:47]
ds_read_b64_tr_b16 v[140:141], v169 offset:24576
ds_read_b64_tr_b16 v[142:143], v169 offset:25600
s_add_u32 m0, s56, 16384
s_nop 0
buffer_load_dwordx4 v172, s[44:47], s49 offen lds
s_add_u32 s49, s49, s54
v_mfma_f32_32x32x16_bf16 a[16:31], v[88:91], v[156:159], a[16:31]
ds_read_b64_tr_b16 v[144:145], v168 offset:26624
ds_read_b64_tr_b16 v[146:147], v168 offset:27648
buffer_load_dwordx4 v[72:75], v170, s[40:43], s48 offen offset:0 sc1
v_mfma_f32_32x32x16_bf16 a[48:63], v[92:95], v[156:159], a[48:63]
ds_read_b64_tr_b16 v[148:149], v169 offset:26624
ds_read_b64_tr_b16 v[150:151], v169 offset:27648
buffer_load_dwordx4 v[76:79], v171, s[40:43], s48 offen offset:0 sc1
v_mfma_f32_32x32x16_bf16 a[0:15], v[96:99], v[160:163], a[0:15]
v_mfma_f32_32x32x16_bf16 a[32:47], v[100:103], v[160:163], a[32:47]
buffer_load_dwordx4 v[80:83], v170, s[40:43], s48 offen offset:1024 sc1
v_mfma_f32_32x32x16_bf16 a[16:31], v[96:99], v[164:167], a[16:31]
buffer_load_dwordx4 v[84:87], v171, s[40:43], s48 offen offset:1024 sc1
v_mfma_f32_32x32x16_bf16 a[48:63], v[100:103], v[164:167], a[48:63]
s_waitcnt lgkmcnt(4)
v_mfma_f32_32x32x16_bf16 a[0:15], v[104:107], v[136:139], a[0:15]
s_waitcnt vmcnt(25) lgkmcnt(0)
s_barrier
ds_read_b64_tr_b16 v[152:153], v168 offset:28672
ds_read_b64_tr_b16 v[154:155], v168 offset:29696
v_mfma_f32_32x32x16_bf16 a[32:47], v[108:111], v[136:139], a[32:47]
ds_read_b64_tr_b16 v[156:157], v169 offset:28672
ds_read_b64_tr_b16 v[158:159], v169 offset:29696
s_add_u32 m0, s56, 20480
s_nop 0
buffer_load_dwordx4 v172, s[44:47], s49 offen lds
s_add_u32 s49, s49, s54
v_mfma_f32_32x32x16_bf16 a[16:31], v[104:107], v[140:143], a[16:31]
ds_read_b64_tr_b16 v[160:161], v168 offset:30720
ds_read_b64_tr_b16 v[162:163], v168 offset:31744
buffer_load_dwordx4 v[88:91], v170, s[40:43], s48 offen offset:2048 sc1
v_mfma_f32_32x32x16_bf16 a[48:63], v[108:111], v[140:143], a[48:63]
ds_read_b64_tr_b16 v[164:165], v169 offset:30720
ds_read_b64_tr_b16 v[166:167], v169 offset:31744
buffer_load_dwordx4 v[92:95], v171, s[40:43], s48 offen offset:2048 sc1
v_mfma_f32_32x32x16_bf16 a[0:15], v[112:115], v[144:147], a[0:15]
v_mfma_f32_32x32x16_bf16 a[32:47], v[116:119], v[144:147], a[32:47]
buffer_load_dwordx4 v[96:99], v170, s[40:43], s48 offen offset:3072 sc1
v_mfma_f32_32x32x16_bf16 a[16:31], v[112:115], v[148:151], a[16:31]
buffer_load_dwordx4 v[100:103], v171, s[40:43], s48 offen offset:3072 sc1
s_add_u32 s48, s48, 4096
v_mfma_f32_32x32x16_bf16 a[48:63], v[116:119], v[148:151], a[48:63]
s_waitcnt lgkmcnt(4)
v_mfma_f32_32x32x16_bf16 a[0:15], v[120:123], v[152:155], a[0:15]
s_waitcnt vmcnt(25) lgkmcnt(0)
s_barrier
ds_read_b64_tr_b16 v[136:137], v168 offset:0
ds_read_b64_tr_b16 v[138:139], v168 offset:1024
v_mfma_f32_32x32x16_bf16 a[32:47], v[124:127], v[152:155], a[32:47]
ds_read_b64_tr_b16 v[140:141], v169 offset:0
ds_read_b64_tr_b16 v[142:143], v169 offset:1024
s_add_u32 m0, s56, 24576
s_nop 0
buffer_load_dwordx4 v172, s[44:47], s49 offen lds
s_add_u32 s49, s49, s54
v_mfma_f32_32x32x16_bf16 a[16:31], v[120:123], v[156:159], a[16:31]
ds_read_b64_tr_b16 v[144:145], v168 offset:2048
ds_read_b64_tr_b16 v[146:147], v168 offset:3072
buffer_load_dwordx4 v[104:107], v170, s[40:43], s48 offen offset:0 sc1
v_mfma_f32_32x32x16_bf16 a[48:63], v[124:127], v[156:159], a[48:63]
ds_read_b64_tr_b16 v[148:149], v169 offset:2048
ds_read_b64_tr_b16 v[150:151], v169 offset:3072
buffer_load_dwordx4 v[108:111], v171, s[40:43], s48 offen offset:0 sc1
v_mfma_f32_32x32x16_bf16 a[0:15], v[128:131], v[160:163], a[0:15]
v_mfma_f32_32x32x16_bf16 a[32:47], v[132:135], v[160:163], a[32:47]
buffer_load_dwordx4 v[112:115], v170, s[40:43], s48 offen offset:1024 sc1
v_mfma_f32_32x32x16_bf16 a[16:31], v[128:131], v[164:167], a[16:31]
buffer_load_dwordx4 v[116:119], v171, s[40:43], s48 offen offset:1024 sc1
v_mfma_f32_32x32x16_bf16 a[48:63], v[132:135], v[164:167], a[48:63]
s_sub_u32 s50, s50, 8
s_cmp_gt_u32 s50, 0
s_cbranch_scc1 .LgD_312
s_waitcnt vmcnt(0) lgkmcnt(0)
s_nop 15
.Lepi_309:
s_add_u32 s57, s12, 0
v_accvgpr_read_b32 v8, a0
v_accvgpr_read_b32 v9, a1
v_accvgpr_read_b32 v10, a2
v_accvgpr_read_b32 v11, a3
v_accvgpr_read_b32 v12, a4
v_accvgpr_read_b32 v13, a5
v_accvgpr_read_b32 v14, a6
v_accvgpr_read_b32 v15, a7
v_cvt_pk_bf16_f32 v16, v8, v9
v_cvt_pk_bf16_f32 v17, v10, v11
v_cvt_pk_bf16_f32 v18, v12, v13
v_cvt_pk_bf16_f32 v19, v14, v15
buffer_store_dwordx4 v[16:19], v2, s[36:39], s57 offen offset:0 sc1
v_accvgpr_read_b32 v20, a8
v_accvgpr_read_b32 v21, a9
v_accvgpr_read_b32 v22, a10
v_accvgpr_read_b32 v23, a11
v_accvgpr_read_b32 v24, a12
v_accvgpr_read_b32 v25, a13
v_accvgpr_read_b32 v26, a14
v_accvgpr_read_b32 v27, a15
v_cvt_pk_bf16_f32 v28, v20, v21
v_cvt_pk_bf16_f32 v29, v22, v23
v_cvt_pk_bf16_f32 v30, v24, v25
v_cvt_pk_bf16_f32 v31, v26, v27
buffer_store_dwordx4 v[28:31], v2, s[36:39], s57 offen offset:1024 sc1
v_accvgpr_read_b32 v8, a16
v_accvgpr_read_b32 v9, a17
v_accvgpr_read_b32 v10, a18
v_accvgpr_read_b32 v11, a19
v_accvgpr_read_b32 v12, a20
v_accvgpr_read_b32 v13, a21
v_accvgpr_read_b32 v14, a22
v_accvgpr_read_b32 v15, a23
v_cvt_pk_bf16_f32 v16, v8, v9
v_cvt_pk_bf16_f32 v17, v10, v11
v_cvt_pk_bf16_f32 v18, v12, v13
v_cvt_pk_bf16_f32 v19, v14, v15
buffer_store_dwordx4 v[16:19], v2, s[36:39], s57 offen offset:2048 sc1
v_accvgpr_read_b32 v20, a24
v_accvgpr_read_b32 v21, a25
v_accvgpr_read_b32 v22, a26
v_accvgpr_read_b32 v23, a27
v_accvgpr_read_b32 v24, a28
v_accvgpr_read_b32 v25, a29
v_accvgpr_read_b32 v26, a30
v_accvgpr_read_b32 v27, a31
v_cvt_pk_bf16_f32 v28, v20, v21
v_cvt_pk_bf16_f32 v29, v22, v23
v_cvt_pk_bf16_f32 v30, v24, v25
v_cvt_pk_bf16_f32 v31, v26, v27
buffer_store_dwordx4 v[28:31], v2, s[36:39], s57 offen offset:3072 sc1
s_add_u32 s57, s12, 262144
v_accvgpr_read_b32 v8, a32
v_accvgpr_read_b32 v9, a33
v_accvgpr_read_b32 v10, a34
v_accvgpr_read_b32 v11, a35
v_accvgpr_read_b32 v12, a36
v_accvgpr_read_b32 v13, a37
v_accvgpr_read_b32 v14, a38
v_accvgpr_read_b32 v15, a39
v_cvt_pk_bf16_f32 v16, v8, v9
v_cvt_pk_bf16_f32 v17, v10, v11
v_cvt_pk_bf16_f32 v18, v12, v13
v_cvt_pk_bf16_f32 v19, v14, v15
buffer_store_dwordx4 v[16:19], v2, s[36:39], s57 offen offset:0 sc1
v_accvgpr_read_b32 v20, a40
v_accvgpr_read_b32 v21, a41
v_accvgpr_read_b32 v22, a42
v_accvgpr_read_b32 v23, a43
v_accvgpr_read_b32 v24, a44
v_accvgpr_read_b32 v25, a45
v_accvgpr_read_b32 v26, a46
v_accvgpr_read_b32 v27, a47
v_cvt_pk_bf16_f32 v28, v20, v21
v_cvt_pk_bf16_f32 v29, v22, v23
v_cvt_pk_bf16_f32 v30, v24, v25
v_cvt_pk_bf16_f32 v31, v26, v27
buffer_store_dwordx4 v[28:31], v2, s[36:39], s57 offen offset:1024 sc1
v_accvgpr_read_b32 v8, a48
v_accvgpr_read_b32 v9, a49
v_accvgpr_read_b32 v10, a50
v_accvgpr_read_b32 v11, a51
v_accvgpr_read_b32 v12, a52
v_accvgpr_read_b32 v13, a53
v_accvgpr_read_b32 v14, a54
v_accvgpr_read_b32 v15, a55
v_cvt_pk_bf16_f32 v16, v8, v9
v_cvt_pk_bf16_f32 v17, v10, v11
v_cvt_pk_bf16_f32 v18, v12, v13
v_cvt_pk_bf16_f32 v19, v14, v15
buffer_store_dwordx4 v[16:19], v2, s[36:39], s57 offen offset:2048 sc1
v_accvgpr_read_b32 v20, a56
v_accvgpr_read_b32 v21, a57
v_accvgpr_read_b32 v22, a58
v_accvgpr_read_b32 v23, a59
v_accvgpr_read_b32 v24, a60
v_accvgpr_read_b32 v25, a61
v_accvgpr_read_b32 v26, a62
v_accvgpr_read_b32 v27, a63
v_cvt_pk_bf16_f32 v28, v20, v21
v_cvt_pk_bf16_f32 v29, v22, v23
v_cvt_pk_bf16_f32 v30, v24, v25
v_cvt_pk_bf16_f32 v31, v26, v27
buffer_store_dwordx4 v[28:31], v2, s[36:39], s57 offen offset:3072 sc1
s_lshl_b32 s86, s84, 2
s_add_u32 s86, s86, s76
s_lshl_b32 s86, s86, 7
s_add_u32 s86, s86, 2048
s_waitcnt vmcnt(0)
s_barrier
s_cmp_lg_u32 s3, 0
s_cbranch_scc1 .Lsg_314
v_mov_b32 v1, 1
v_mul_u32_u24 v2, 0, v0
s_mov_b64 exec, 1
buffer_atomic_add v1, v2, s[88:91], s86 offen sc1
s_mov_b64 exec, -1
.Lsg_314:
s_lshr_b32 s84, s77, 4
s_add_u32 s84, s84, 1
s_bfe_u32 s83, s77, 0x10003
s_add_u32 s83, s83, 1
s_and_b32 s85, s77, 7
s_lshl_b32 s81, s76, 3
s_add_u32 s85, s85, s81
s_mov_b32 s79, 1
.Lhalf_315:
s_lshl_b32 s13, s83, 3
s_add_u32 s13, s13, 16
s_load_dwordx2 s[6:7], s[0:1], s13
s_add_u32 s40, s4, 0x0
s_addc_u32 s41, s5, 0
s_mov_b32 s42, 0x400000
s_mov_b32 s43, 0x00020000
v_lshrrev_b32 v207, 2, v0
v_and_b32 v207, 3, v207
v_lshrrev_b32 v208, 5, v0
v_lshlrev_b32 v208, 2, v208
v_add_u32 v208, v208, v207
v_mul_u32_u24 v208, 256, v208
v_and_b32 v209, 3, v0
v_lshlrev_b32 v209, 3, v209
v_add_u32 v208, v208, v209
v_and_b32 v209, 16, v0
v_lshlrev_b32 v209, 1, v209
v_add_u32 v208, v208, v209
s_and_b32 s53, s3, 0
s_mul_i32 s53, s53, 4
s_add_u32 s57, s53, 0
v_xor_b32 v209, s57, v207
v_lshlrev_b32 v209, 6, v209
v_add_u32 v200, v208, v209
s_add_u32 s57, s53, 1
v_xor_b32 v209, s57, v207
v_lshlrev_b32 v209, 6, v209
v_add_u32 v201, v208, v209
s_add_u32 s57, s53, 2
v_xor_b32 v209, s57, v207
v_lshlrev_b32 v209, 6, v209
v_add_u32 v202, v208, v209
s_add_u32 s57, s53, 3
v_xor_b32 v209, s57, v207
v_lshlrev_b32 v209, 6, v209
v_add_u32 v203, v208, v209
s_lshr_b32 s53, s3, 0
s_mul_i32 s53, s53, 131072
v_lshlrev_b32 v204, 4, v0
v_add_u32 v204, s53, v204
v_add_u32 v205, 65536, v204
v_lshrrev_b32 v207, 4, v0
s_mul_i32 s53, s3, 4
v_add_u32 v207, s53, v207
v_and_b32 v208, 3, v207
v_and_b32 v209, 15, v0
v_lshrrev_b32 v209, 2, v209
v_xor_b32 v208, v208, v209
v_lshlrev_b32 v208, 6, v208
v_and_b32 v209, 3, v0
v_lshlrev_b32 v209, 4, v209
v_add_u32 v208, v208, v209
s_mov_b32 s53, 8192
v_mul_lo_u32 v207, v207, s53
v_add_u32 v206, v207, v208
s_mul_i32 s54, s53, 16
s_lshl_b32 s56, s3, 10
s_waitcnt lgkmcnt(0)
s_mov_b32 s44, s6
s_mov_b32 s45, s7
s_mov_b32 s46, 0x800000
s_mov_b32 s47, 0x00020000
s_mul_i32 s48, s84, 524288
s_mul_i32 s49, s85, 256
s_mov_b32 s50, 32
s_add_u32 m0, s56, 0
s_nop 0
buffer_load_dwordx4 v206, s[44:47], s49 offen lds
s_add_u32 s49, s49, s54
s_add_u32 m0, s56, 4096
s_nop 0
buffer_load_dwordx4 v206, s[44:47], s49 offen lds
s_add_u32 s49, s49, s54
s_add_u32 m0, s56, 8192
s_nop 0
buffer_load_dwordx4 v206, s[44:47], s49 offen lds
s_add_u32 s49, s49, s54
s_add_u32 m0, s56, 12288
s_nop 0
buffer_load_dwordx4 v206, s[44:47], s49 offen lds
s_add_u32 s49, s49, s54
s_add_u32 m0, s56, 16384
s_nop 0
buffer_load_dwordx4 v206, s[44:47], s49 offen lds
s_add_u32 s49, s49, s54
s_add_u32 m0, s56, 20480
s_nop 0
buffer_load_dwordx4 v206, s[44:47], s49 offen lds
s_add_u32 s49, s49, s54
s_add_u32 m0, s56, 24576
s_nop 0
buffer_load_dwordx4 v206, s[44:47], s49 offen lds
s_add_u32 s49, s49, s54
s_add_u32 m0, s56, 28672
s_nop 0
buffer_load_dwordx4 v206, s[44:47], s49 offen lds
s_add_u32 s49, s49, s54
s_add_u32 m0, s56, 32768
s_nop 0
buffer_load_dwordx4 v206, s[44:47], s49 offen lds
s_add_u32 s49, s49, s54
s_add_u32 m0, s56, 36864
s_nop 0
buffer_load_dwordx4 v206, s[44:47], s49 offen lds
s_add_u32 s49, s49, s54
s_add_u32 m0, s56, 40960
s_nop 0
buffer_load_dwordx4 v206, s[44:47], s49 offen lds
s_add_u32 s49, s49, s54
s_add_u32 m0, s56, 45056
s_nop 0
buffer_load_dwordx4 v206, s[44:47], s49 offen lds
s_add_u32 s49, s49, s54
s_add_u32 m0, s56, 49152
s_nop 0
buffer_load_dwordx4 v206, s[44:47], s49 offen lds
s_add_u32 s49, s49, s54
s_add_u32 m0, s56, 53248
s_nop 0
buffer_load_dwordx4 v206, s[44:47], s49 offen lds
s_add_u32 s49, s49, s54
s_mov_b32 s86, 28672
s_cmp_lg_u32 s3, 0
s_cbranch_scc1 .Lws_324
v_mul_u32_u24 v1, 128, v0
v_add_u32 v1, s86, v1
v_mov_b32 v2, 32
s_mov_b64 exec, 255
.Lwl_325:
buffer_load_dword v3, v1, s[88:91], 0 offen sc1
s_waitcnt vmcnt(0)
v_cmp_lt_u32 vcc, v3, v2
s_cbranch_vccz .Lwo_326
s_cmp_eq_u32 s80, 0
s_cbranch_scc1 .Lwo_326
s_sub_u32 s80, s80, 1
s_branch .Lwl_325
.Lwo_326:
s_mov_b64 exec, -1
.Lws_324:
s_barrier
buffer_load_dwordx4 v[8:11], v204, s[40:43], s48 offen offset:0 sc1
buffer_load_dwordx4 v[12:15], v205, s[40:43], s48 offen offset:0 sc1
buffer_load_dwordx4 v[16:19], v204, s[40:43], s48 offen offset:1024 sc1
buffer_load_dwordx4 v[20:23], v205, s[40:43], s48 offen offset:1024 sc1
buffer_load_dwordx4 v[24:27], v204, s[40:43], s48 offen offset:2048 sc1
buffer_load_dwordx4 v[28:31], v205, s[40:43], s48 offen offset:2048 sc1
buffer_load_dwordx4 v[32:35], v204, s[40:43], s48 offen offset:3072 sc1
buffer_load_dwordx4 v[36:39], v205, s[40:43], s48 offen offset:3072 sc1
s_add_u32 s48, s48, 4096
buffer_load_dwordx4 v[40:43], v204, s[40:43], s48 offen offset:0 sc1
buffer_load_dwordx4 v[44:47], v205, s[40:43], s48 offen offset:0 sc1
buffer_load_dwordx4 v[48:51], v204, s[40:43], s48 offen offset:1024 sc1
buffer_load_dwordx4 v[52:55], v205, s[40:43], s48 offen offset:1024 sc1
buffer_load_dwordx4 v[56:59], v204, s[40:43], s48 offen offset:2048 sc1
buffer_load_dwordx4 v[60:63], v205, s[40:43], s48 offen offset:2048 sc1
buffer_load_dwordx4 v[64:67], v204, s[40:43], s48 offen offset:3072 sc1
buffer_load_dwordx4 v[68:71], v205, s[40:43], s48 offen offset:3072 sc1
s_add_u32 s48, s48, 4096
buffer_load_dwordx4 v[72:75], v204, s[40:43], s48 offen offset:0 sc1
buffer_load_dwordx4 v[76:79], v205, s[40:43], s48 offen offset:0 sc1
buffer_load_dwordx4 v[80:83], v204, s[40:43], s48 offen offset:1024 sc1
buffer_load_dwordx4 v[84:87], v205, s[40:43], s48 offen offset:1024 sc1
buffer_load_dwordx4 v[88:91], v204, s[40:43], s48 offen offset:2048 sc1
buffer_load_dwordx4 v[92:95], v205, s[40:43], s48 offen offset:2048 sc1
buffer_load_dwordx4 v[96:99], v204, s[40:43], s48 offen offset:3072 sc1
buffer_load_dwordx4 v[100:103], v205, s[40:43], s48 offen offset:3072 sc1
s_add_u32 s48, s48, 4096
buffer_load_dwordx4 v[104:107], v204, s[40:43], s48 offen offset:0 sc1
buffer_load_dwordx4 v[108:111], v205, s[40:43], s48 offen offset:0 sc1
buffer_load_dwordx4 v[112:115], v204, s[40:43], s48 offen offset:1024 sc1
buffer_load_dwordx4 v[116:119], v205, s[40:43], s48 offen offset:1024 sc1
s_cmp_eq_u32 s83, 2
s_cbranch_scc1 .Lvt_327
v_accvgpr_write_b32 a0, 0
v_accvgpr_write_b32 a1, 0
v_accvgpr_write_b32 a2, 0
v_accvgpr_write_b32 a3, 0
v_accvgpr_write_b32 a4, 0
v_accvgpr_write_b32 a5, 0
v_accvgpr_write_b32 a6, 0
v_accvgpr_write_b32 a7, 0
v_accvgpr_write_b32 a8, 0
v_accvgpr_write_b32 a9, 0
v_accvgpr_write_b32 a10, 0
v_accvgpr_write_b32 a11, 0
v_accvgpr_write_b32 a12, 0
v_accvgpr_write_b32 a13, 0
v_accvgpr_write_b32 a14, 0
v_accvgpr_write_b32 a15, 0
v_accvgpr_write_b32 a16, 0
v_accvgpr_write_b32 a17, 0
v_accvgpr_write_b32 a18, 0
v_accvgpr_write_b32 a19, 0
v_accvgpr_write_b32 a20, 0
v_accvgpr_write_b32 a21, 0
v_accvgpr_write_b32 a22, 0
v_accvgpr_write_b32 a23, 0
v_accvgpr_write_b32 a24, 0
v_accvgpr_write_b32 a25, 0
v_accvgpr_write_b32 a26, 0
v_accvgpr_write_b32 a27, 0
v_accvgpr_write_b32 a28, 0
v_accvgpr_write_b32 a29, 0
v_accvgpr_write_b32 a30, 0
v_accvgpr_write_b32 a31, 0
v_accvgpr_write_b32 a32, 0
v_accvgpr_write_b32 a33, 0
v_accvgpr_write_b32 a34, 0
v_accvgpr_write_b32 a35, 0
v_accvgpr_write_b32 a36, 0
v_accvgpr_write_b32 a37, 0
v_accvgpr_write_b32 a38, 0
v_accvgpr_write_b32 a39, 0
v_accvgpr_write_b32 a40, 0
v_accvgpr_write_b32 a41, 0
v_accvgpr_write_b32 a42, 0
v_accvgpr_write_b32 a43, 0
v_accvgpr_write_b32 a44, 0
v_accvgpr_write_b32 a45, 0
v_accvgpr_write_b32 a46, 0
v_accvgpr_write_b32 a47, 0
v_accvgpr_write_b32 a48, 0
v_accvgpr_write_b32 a49, 0
v_accvgpr_write_b32 a50, 0
v_accvgpr_write_b32 a51, 0
v_accvgpr_write_b32 a52, 0
v_accvgpr_write_b32 a53, 0
v_accvgpr_write_b32 a54, 0
v_accvgpr_write_b32 a55, 0
v_accvgpr_write_b32 a56, 0
v_accvgpr_write_b32 a57, 0
v_accvgpr_write_b32 a58, 0
v_accvgpr_write_b32 a59, 0
v_accvgpr_write_b32 a60, 0
v_accvgpr_write_b32 a61, 0
v_accvgpr_write_b32 a62, 0
v_accvgpr_write_b32 a63, 0
v_accvgpr_write_b32 a64, 0
v_accvgpr_write_b32 a65, 0
v_accvgpr_write_b32 a66, 0
v_accvgpr_write_b32 a67, 0
v_accvgpr_write_b32 a68, 0
v_accvgpr_write_b32 a69, 0
v_accvgpr_write_b32 a70, 0
v_accvgpr_write_b32 a71, 0
v_accvgpr_write_b32 a72, 0
v_accvgpr_write_b32 a73, 0
v_accvgpr_write_b32 a74, 0
v_accvgpr_write_b32 a75, 0
v_accvgpr_write_b32 a76, 0
v_accvgpr_write_b32 a77, 0
v_accvgpr_write_b32 a78, 0
v_accvgpr_write_b32 a79, 0
v_accvgpr_write_b32 a80, 0
v_accvgpr_write_b32 a81, 0
v_accvgpr_write_b32 a82, 0
v_accvgpr_write_b32 a83, 0
v_accvgpr_write_b32 a84, 0
v_accvgpr_write_b32 a85, 0
v_accvgpr_write_b32 a86, 0
v_accvgpr_write_b32 a87, 0
v_accvgpr_write_b32 a88, 0
v_accvgpr_write_b32 a89, 0
v_accvgpr_write_b32 a90, 0
v_accvgpr_write_b32 a91, 0
v_accvgpr_write_b32 a92, 0
v_accvgpr_write_b32 a93, 0
v_accvgpr_write_b32 a94, 0
v_accvgpr_write_b32 a95, 0
v_accvgpr_write_b32 a96, 0
v_accvgpr_write_b32 a97, 0
v_accvgpr_write_b32 a98, 0
v_accvgpr_write_b32 a99, 0
v_accvgpr_write_b32 a100, 0
v_accvgpr_write_b32 a101, 0
v_accvgpr_write_b32 a102, 0
v_accvgpr_write_b32 a103, 0
v_accvgpr_write_b32 a104, 0
v_accvgpr_write_b32 a105, 0
v_accvgpr_write_b32 a106, 0
v_accvgpr_write_b32 a107, 0
v_accvgpr_write_b32 a108, 0
v_accvgpr_write_b32 a109, 0
v_accvgpr_write_b32 a110, 0
v_accvgpr_write_b32 a111, 0
v_accvgpr_write_b32 a112, 0
v_accvgpr_write_b32 a113, 0
v_accvgpr_write_b32 a114, 0
v_accvgpr_write_b32 a115, 0
v_accvgpr_write_b32 a116, 0
v_accvgpr_write_b32 a117, 0
v_accvgpr_write_b32 a118, 0
v_accvgpr_write_b32 a119, 0
v_accvgpr_write_b32 a120, 0
v_accvgpr_write_b32 a121, 0
v_accvgpr_write_b32 a122, 0
v_accvgpr_write_b32 a123, 0
v_accvgpr_write_b32 a124, 0
v_accvgpr_write_b32 a125, 0
v_accvgpr_write_b32 a126, 0
v_accvgpr_write_b32 a127, 0
s_waitcnt vmcnt(24)
s_barrier
ds_read_b64_tr_b16 v[136:137], v200 offset:0
ds_read_b64_tr_b16 v[138:139], v200 offset:2048
ds_read_b64_tr_b16 v[140:141], v201 offset:0
ds_read_b64_tr_b16 v[142:143], v201 offset:2048
ds_read_b64_tr_b16 v[144:145], v202 offset:0
ds_read_b64_tr_b16 v[146:147], v202 offset:2048
ds_read_b64_tr_b16 v[148:149], v203 offset:0
ds_read_b64_tr_b16 v[150:151], v203 offset:2048
ds_read_b64_tr_b16 v[152:153], v200 offset:4096
ds_read_b64_tr_b16 v[154:155], v200 offset:6144
ds_read_b64_tr_b16 v[156:157], v201 offset:4096
ds_read_b64_tr_b16 v[158:159], v201 offset:6144
ds_read_b64_tr_b16 v[160:161], v202 offset:4096
ds_read_b64_tr_b16 v[162:163], v202 offset:6144
ds_read_b64_tr_b16 v[164:165], v203 offset:4096
ds_read_b64_tr_b16 v[166:167], v203 offset:6144
s_waitcnt lgkmcnt(8)
v_mfma_f32_32x32x16_bf16 a[0:15], v[136:139], v[8:11], a[0:15]
s_waitcnt vmcnt(20) lgkmcnt(0)
s_barrier
ds_read_b64_tr_b16 v[168:169], v200 offset:8192
ds_read_b64_tr_b16 v[170:171], v200 offset:10240
v_mfma_f32_32x32x16_bf16 a[64:79], v[136:139], v[12:15], a[64:79]
ds_read_b64_tr_b16 v[172:173], v201 offset:8192
ds_read_b64_tr_b16 v[174:175], v201 offset:10240
s_add_u32 m0, s56, 57344
s_nop 0
buffer_load_dwordx4 v206, s[44:47], s49 offen lds
s_add_u32 s49, s49, s54
v_mfma_f32_32x32x16_bf16 a[16:31], v[140:143], v[8:11], a[16:31]
ds_read_b64_tr_b16 v[176:177], v202 offset:8192
ds_read_b64_tr_b16 v[178:179], v202 offset:10240
v_mfma_f32_32x32x16_bf16 a[80:95], v[140:143], v[12:15], a[80:95]
ds_read_b64_tr_b16 v[180:181], v203 offset:8192
ds_read_b64_tr_b16 v[182:183], v203 offset:10240
s_add_u32 m0, s56, 61440
s_nop 0
buffer_load_dwordx4 v206, s[44:47], s49 offen lds
s_add_u32 s49, s49, s54
v_mfma_f32_32x32x16_bf16 a[32:47], v[144:147], v[8:11], a[32:47]
ds_read_b64_tr_b16 v[184:185], v200 offset:12288
ds_read_b64_tr_b16 v[186:187], v200 offset:14336
v_mfma_f32_32x32x16_bf16 a[96:111], v[144:147], v[12:15], a[96:111]
ds_read_b64_tr_b16 v[188:189], v201 offset:12288
ds_read_b64_tr_b16 v[190:191], v201 offset:14336
buffer_load_dwordx4 v[120:123], v204, s[40:43], s48 offen offset:2048 sc1
v_mfma_f32_32x32x16_bf16 a[48:63], v[148:151], v[8:11], a[48:63]
ds_read_b64_tr_b16 v[192:193], v202 offset:12288
ds_read_b64_tr_b16 v[194:195], v202 offset:14336
v_mfma_f32_32x32x16_bf16 a[112:127], v[148:151], v[12:15], a[112:127]
ds_read_b64_tr_b16 v[196:197], v203 offset:12288
ds_read_b64_tr_b16 v[198:199], v203 offset:14336
buffer_load_dwordx4 v[124:127], v205, s[40:43], s48 offen offset:2048 sc1
v_mfma_f32_32x32x16_bf16 a[0:15], v[152:155], v[16:19], a[0:15]
v_mfma_f32_32x32x16_bf16 a[64:79], v[152:155], v[20:23], a[64:79]
buffer_load_dwordx4 v[128:131], v204, s[40:43], s48 offen offset:3072 sc1
v_mfma_f32_32x32x16_bf16 a[16:31], v[156:159], v[16:19], a[16:31]
v_mfma_f32_32x32x16_bf16 a[80:95], v[156:159], v[20:23], a[80:95]
buffer_load_dwordx4 v[132:135], v205, s[40:43], s48 offen offset:3072 sc1
s_add_u32 s48, s48, 4096
v_mfma_f32_32x32x16_bf16 a[32:47], v[160:163], v[16:19], a[32:47]
v_mfma_f32_32x32x16_bf16 a[96:111], v[160:163], v[20:23], a[96:111]
s_cmp_eq_u32 s50, 8
s_cselect_b32 s42, 0, s42
s_cselect_b32 s46, 0, s46
v_mfma_f32_32x32x16_bf16 a[48:63], v[164:167], v[16:19], a[48:63]
v_mfma_f32_32x32x16_bf16 a[112:127], v[164:167], v[20:23], a[112:127]
s_waitcnt lgkmcnt(8)
v_mfma_f32_32x32x16_bf16 a[0:15], v[168:171], v[24:27], a[0:15]
s_waitcnt vmcnt(22) lgkmcnt(0)
s_barrier
ds_read_b64_tr_b16 v[136:137], v200 offset:16384
ds_read_b64_tr_b16 v[138:139], v200 offset:18432
v_mfma_f32_32x32x16_bf16 a[64:79], v[168:171], v[28:31], a[64:79]
ds_read_b64_tr_b16 v[140:141], v201 offset:16384
ds_read_b64_tr_b16 v[142:143], v201 offset:18432
s_add_u32 m0, s56, 0
s_nop 0
buffer_load_dwordx4 v206, s[44:47], s49 offen lds
s_add_u32 s49, s49, s54
v_mfma_f32_32x32x16_bf16 a[16:31], v[172:175], v[24:27], a[16:31]
ds_read_b64_tr_b16 v[144:145], v202 offset:16384
ds_read_b64_tr_b16 v[146:147], v202 offset:18432
v_mfma_f32_32x32x16_bf16 a[80:95], v[172:175], v[28:31], a[80:95]
ds_read_b64_tr_b16 v[148:149], v203 offset:16384
ds_read_b64_tr_b16 v[150:151], v203 offset:18432
s_add_u32 m0, s56, 4096
s_nop 0
buffer_load_dwordx4 v206, s[44:47], s49 offen lds
s_add_u32 s49, s49, s54
v_mfma_f32_32x32x16_bf16 a[32:47], v[176:179], v[24:27], a[32:47]
ds_read_b64_tr_b16 v[152:153], v200 offset:20480
ds_read_b64_tr_b16 v[154:155], v200 offset:22528
v_mfma_f32_32x32x16_bf16 a[96:111], v[176:179], v[28:31], a[96:111]
ds_read_b64_tr_b16 v[156:157], v201 offset:20480
ds_read_b64_tr_b16 v[158:159], v201 offset:22528
v_mfma_f32_32x32x16_bf16 a[48:63], v[180:183], v[24:27], a[48:63]
ds_read_b64_tr_b16 v[160:161], v202 offset:20480
ds_read_b64_tr_b16 v[162:163], v202 offset:22528
buffer_load_dwordx4 v[8:11], v204, s[40:43], s48 offen offset:0 sc1
v_mfma_f32_32x32x16_bf16 a[112:127], v[180:183], v[28:31], a[112:127]
ds_read_b64_tr_b16 v[164:165], v203 offset:20480
ds_read_b64_tr_b16 v[166:167], v203 offset:22528
v_mfma_f32_32x32x16_bf16 a[0:15], v[184:187], v[32:35], a[0:15]
buffer_load_dwordx4 v[12:15], v205, s[40:43], s48 offen offset:0 sc1
v_mfma_f32_32x32x16_bf16 a[64:79], v[184:187], v[36:39], a[64:79]
v_mfma_f32_32x32x16_bf16 a[16:31], v[188:191], v[32:35], a[16:31]
v_mfma_f32_32x32x16_bf16 a[80:95], v[188:191], v[36:39], a[80:95]
buffer_load_dwordx4 v[16:19], v204, s[40:43], s48 offen offset:1024 sc1
v_mfma_f32_32x32x16_bf16 a[32:47], v[192:195], v[32:35], a[32:47]
v_mfma_f32_32x32x16_bf16 a[96:111], v[192:195], v[36:39], a[96:111]
buffer_load_dwordx4 v[20:23], v205, s[40:43], s48 offen offset:1024 sc1
v_mfma_f32_32x32x16_bf16 a[48:63], v[196:199], v[32:35], a[48:63]
v_mfma_f32_32x32x16_bf16 a[112:127], v[196:199], v[36:39], a[112:127]
s_waitcnt lgkmcnt(8)
v_mfma_f32_32x32x16_bf16 a[0:15], v[136:139], v[40:43], a[0:15]
s_waitcnt vmcnt(24) lgkmcnt(0)
s_barrier
ds_read_b64_tr_b16 v[168:169], v200 offset:24576
ds_read_b64_tr_b16 v[170:171], v200 offset:26624
v_mfma_f32_32x32x16_bf16 a[64:79], v[136:139], v[44:47], a[64:79]
ds_read_b64_tr_b16 v[172:173], v201 offset:24576
ds_read_b64_tr_b16 v[174:175], v201 offset:26624
s_add_u32 m0, s56, 8192
s_nop 0
buffer_load_dwordx4 v206, s[44:47], s49 offen lds
s_add_u32 s49, s49, s54
v_mfma_f32_32x32x16_bf16 a[16:31], v[140:143], v[40:43], a[16:31]
ds_read_b64_tr_b16 v[176:177], v202 offset:24576
ds_read_b64_tr_b16 v[178:179], v202 offset:26624
v_mfma_f32_32x32x16_bf16 a[80:95], v[140:143], v[44:47], a[80:95]
ds_read_b64_tr_b16 v[180:181], v203 offset:24576
ds_read_b64_tr_b16 v[182:183], v203 offset:26624
s_add_u32 m0, s56, 12288
s_nop 0
buffer_load_dwordx4 v206, s[44:47], s49 offen lds
s_add_u32 s49, s49, s54
v_mfma_f32_32x32x16_bf16 a[32:47], v[144:147], v[40:43], a[32:47]
ds_read_b64_tr_b16 v[184:185], v200 offset:28672
ds_read_b64_tr_b16 v[186:187], v200 offset:30720
v_mfma_f32_32x32x16_bf16 a[96:111], v[144:147], v[44:47], a[96:111]
ds_read_b64_tr_b16 v[188:189], v201 offset:28672
ds_read_b64_tr_b16 v[190:191], v201 offset:30720
v_mfma_f32_32x32x16_bf16 a[48:63], v[148:151], v[40:43], a[48:63]
ds_read_b64_tr_b16 v[192:193], v202 offset:28672
ds_read_b64_tr_b16 v[194:195], v202 offset:30720
buffer_load_dwordx4 v[24:27], v204, s[40:43], s48 offen offset:2048 sc1
v_mfma_f32_32x32x16_bf16 a[112:127], v[148:151], v[44:47], a[112:127]
ds_read_b64_tr_b16 v[196:197], v203 offset:28672
ds_read_b64_tr_b16 v[198:199], v203 offset:30720
v_mfma_f32_32x32x16_bf16 a[0:15], v[152:155], v[48:51], a[0:15]
buffer_load_dwordx4 v[28:31], v205, s[40:43], s48 offen offset:2048 sc1
v_mfma_f32_32x32x16_bf16 a[64:79], v[152:155], v[52:55], a[64:79]
v_mfma_f32_32x32x16_bf16 a[16:31], v[156:159], v[48:51], a[16:31]
v_mfma_f32_32x32x16_bf16 a[80:95], v[156:159], v[52:55], a[80:95]
buffer_load_dwordx4 v[32:35], v204, s[40:43], s48 offen offset:3072 sc1
v_mfma_f32_32x32x16_bf16 a[32:47], v[160:163], v[48:51], a[32:47]
v_mfma_f32_32x32x16_bf16 a[96:111], v[160:163], v[52:55], a[96:111]
buffer_load_dwordx4 v[36:39], v205, s[40:43], s48 offen offset:3072 sc1
s_add_u32 s48, s48, 4096
v_mfma_f32_32x32x16_bf16 a[48:63], v[164:167], v[48:51], a[48:63]
v_mfma_f32_32x32x16_bf16 a[112:127], v[164:167], v[52:55], a[112:127]
s_waitcnt lgkmcnt(8)
v_mfma_f32_32x32x16_bf16 a[0:15], v[168:171], v[56:59], a[0:15]
s_waitcnt vmcnt(26) lgkmcnt(0)
s_barrier
ds_read_b64_tr_b16 v[136:137], v200 offset:32768
ds_read_b64_tr_b16 v[138:139], v200 offset:34816
v_mfma_f32_32x32x16_bf16 a[64:79], v[168:171], v[60:63], a[64:79]
ds_read_b64_tr_b16 v[140:141], v201 offset:32768
ds_read_b64_tr_b16 v[142:143], v201 offset:34816
s_add_u32 m0, s56, 16384
s_nop 0
buffer_load_dwordx4 v206, s[44:47], s49 offen lds
s_add_u32 s49, s49, s54
v_mfma_f32_32x32x16_bf16 a[16:31], v[172:175], v[56:59], a[16:31]
ds_read_b64_tr_b16 v[144:145], v202 offset:32768
ds_read_b64_tr_b16 v[146:147], v202 offset:34816
v_mfma_f32_32x32x16_bf16 a[80:95], v[172:175], v[60:63], a[80:95]
ds_read_b64_tr_b16 v[148:149], v203 offset:32768
ds_read_b64_tr_b16 v[150:151], v203 offset:34816
s_add_u32 m0, s56, 20480
s_nop 0
buffer_load_dwordx4 v206, s[44:47], s49 offen lds
s_add_u32 s49, s49, s54
v_mfma_f32_32x32x16_bf16 a[32:47], v[176:179], v[56:59], a[32:47]
ds_read_b64_tr_b16 v[152:153], v200 offset:36864
ds_read_b64_tr_b16 v[154:155], v200 offset:38912
v_mfma_f32_32x32x16_bf16 a[96:111], v[176:179], v[60:63], a[96:111]
ds_read_b64_tr_b16 v[156:157], v201 offset:36864
ds_read_b64_tr_b16 v[158:159], v201 offset:38912
v_mfma_f32_32x32x16_bf16 a[48:63], v[180:183], v[56:59], a[48:63]
ds_read_b64_tr_b16 v[160:161], v202 offset:36864
ds_read_b64_tr_b16 v[162:163], v202 offset:38912
buffer_load_dwordx4 v[40:43], v204, s[40:43], s48 offen offset:0 sc1
v_mfma_f32_32x32x16_bf16 a[112:127], v[180:183], v[60:63], a[112:127]
ds_read_b64_tr_b16 v[164:165], v203 offset:36864
ds_read_b64_tr_b16 v[166:167], v203 offset:38912
v_mfma_f32_32x32x16_bf16 a[0:15], v[184:187], v[64:67], a[0:15]
buffer_load_dwordx4 v[44:47], v205, s[40:43], s48 offen offset:0 sc1
v_mfma_f32_32x32x16_bf16 a[64:79], v[184:187], v[68:71], a[64:79]
v_mfma_f32_32x32x16_bf16 a[16:31], v[188:191], v[64:67], a[16:31]
v_mfma_f32_32x32x16_bf16 a[80:95], v[188:191], v[68:71], a[80:95]
buffer_load_dwordx4 v[48:51], v204, s[40:43], s48 offen offset:1024 sc1
v_mfma_f32_32x32x16_bf16 a[32:47], v[192:195], v[64:67], a[32:47]
v_mfma_f32_32x32x16_bf16 a[96:111], v[192:195], v[68:71], a[96:111]
buffer_load_dwordx4 v[52:55], v205, s[40:43], s48 offen offset:1024 sc1
v_mfma_f32_32x32x16_bf16 a[48:63], v[196:199], v[64:67], a[48:63]
v_mfma_f32_32x32x16_bf16 a[112:127], v[196:199], v[68:71], a[112:127]
s_waitcnt lgkmcnt(8)
v_mfma_f32_32x32x16_bf16 a[0:15], v[136:139], v[72:75], a[0:15]
s_waitcnt vmcnt(28) lgkmcnt(0)
s_barrier
ds_read_b64_tr_b16 v[168:169], v200 offset:40960
ds_read_b64_tr_b16 v[170:171], v200 offset:43008
v_mfma_f32_32x32x16_bf16 a[64:79], v[136:139], v[76:79], a[64:79]
ds_read_b64_tr_b16 v[172:173], v201 offset:40960
ds_read_b64_tr_b16 v[174:175], v201 offset:43008
s_add_u32 m0, s56, 24576
s_nop 0
buffer_load_dwordx4 v206, s[44:47], s49 offen lds
s_add_u32 s49, s49, s54
v_mfma_f32_32x32x16_bf16 a[16:31], v[140:143], v[72:75], a[16:31]
ds_read_b64_tr_b16 v[176:177], v202 offset:40960
ds_read_b64_tr_b16 v[178:179], v202 offset:43008
v_mfma_f32_32x32x16_bf16 a[80:95], v[140:143], v[76:79], a[80:95]
ds_read_b64_tr_b16 v[180:181], v203 offset:40960
ds_read_b64_tr_b16 v[182:183], v203 offset:43008
s_add_u32 m0, s56, 28672
s_nop 0
buffer_load_dwordx4 v206, s[44:47], s49 offen lds
s_add_u32 s49, s49, s54
v_mfma_f32_32x32x16_bf16 a[32:47], v[144:147], v[72:75], a[32:47]
ds_read_b64_tr_b16 v[184:185], v200 offset:45056
ds_read_b64_tr_b16 v[186:187], v200 offset:47104
v_mfma_f32_32x32x16_bf16 a[96:111], v[144:147], v[76:79], a[96:111]
ds_read_b64_tr_b16 v[188:189], v201 offset:45056
ds_read_b64_tr_b16 v[190:191], v201 offset:47104
v_mfma_f32_32x32x16_bf16 a[48:63], v[148:151], v[72:75], a[48:63]
ds_read_b64_tr_b16 v[192:193], v202 offset:45056
ds_read_b64_tr_b16 v[194:195], v202 offset:47104
buffer_load_dwordx4 v[56:59], v204, s[40:43], s48 offen offset:2048 sc1
v_mfma_f32_32x32x16_bf16 a[112:127], v[148:151], v[76:79], a[112:127]
ds_read_b64_tr_b16 v[196:197], v203 offset:45056
ds_read_b64_tr_b16 v[198:199], v203 offset:47104
v_mfma_f32_32x32x16_bf16 a[0:15], v[152:155], v[80:83], a[0:15]
buffer_load_dwordx4 v[60:63], v205, s[40:43], s48 offen offset:2048 sc1
v_mfma_f32_32x32x16_bf16 a[64:79], v[152:155], v[84:87], a[64:79]
v_mfma_f32_32x32x16_bf16 a[16:31], v[156:159], v[80:83], a[16:31]
v_mfma_f32_32x32x16_bf16 a[80:95], v[156:159], v[84:87], a[80:95]
buffer_load_dwordx4 v[64:67], v204, s[40:43], s48 offen offset:3072 sc1
v_mfma_f32_32x32x16_bf16 a[32:47], v[160:163], v[80:83], a[32:47]
v_mfma_f32_32x32x16_bf16 a[96:111], v[160:163], v[84:87], a[96:111]
buffer_load_dwordx4 v[68:71], v205, s[40:43], s48 offen offset:3072 sc1
s_add_u32 s48, s48, 4096
v_mfma_f32_32x32x16_bf16 a[48:63], v[164:167], v[80:83], a[48:63]
v_mfma_f32_32x32x16_bf16 a[112:127], v[164:167], v[84:87], a[112:127]
s_waitcnt lgkmcnt(8)
v_mfma_f32_32x32x16_bf16 a[0:15], v[168:171], v[88:91], a[0:15]
s_waitcnt vmcnt(30) lgkmcnt(0)
s_barrier
ds_read_b64_tr_b16 v[136:137], v200 offset:49152
ds_read_b64_tr_b16 v[138:139], v200 offset:51200
v_mfma_f32_32x32x16_bf16 a[64:79], v[168:171], v[92:95], a[64:79]
ds_read_b64_tr_b16 v[140:141], v201 offset:49152
ds_read_b64_tr_b16 v[142:143], v201 offset:51200
s_add_u32 m0, s56, 32768
s_nop 0
buffer_load_dwordx4 v206, s[44:47], s49 offen lds
s_add_u32 s49, s49, s54
v_mfma_f32_32x32x16_bf16 a[16:31], v[172:175], v[88:91], a[16:31]
ds_read_b64_tr_b16 v[144:145], v202 offset:49152
ds_read_b64_tr_b16 v[146:147], v202 offset:51200
v_mfma_f32_32x32x16_bf16 a[80:95], v[172:175], v[92:95], a[80:95]
ds_read_b64_tr_b16 v[148:149], v203 offset:49152
ds_read_b64_tr_b16 v[150:151], v203 offset:51200
s_add_u32 m0, s56, 36864
s_nop 0
buffer_load_dwordx4 v206, s[44:47], s49 offen lds
s_add_u32 s49, s49, s54
v_mfma_f32_32x32x16_bf16 a[32:47], v[176:179], v[88:91], a[32:47]
ds_read_b64_tr_b16 v[152:153], v200 offset:53248
ds_read_b64_tr_b16 v[154:155], v200 offset:55296
v_mfma_f32_32x32x16_bf16 a[96:111], v[176:179], v[92:95], a[96:111]
ds_read_b64_tr_b16 v[156:157], v201 offset:53248
ds_read_b64_tr_b16 v[158:159], v201 offset:55296
v_mfma_f32_32x32x16_bf16 a[48:63], v[180:183], v[88:91], a[48:63]
ds_read_b64_tr_b16 v[160:161], v202 offset:53248
ds_read_b64_tr_b16 v[162:163], v202 offset:55296
buffer_load_dwordx4 v[72:75], v204, s[40:43], s48 offen offset:0 sc1
v_mfma_f32_32x32x16_bf16 a[112:127], v[180:183], v[92:95], a[112:127]
ds_read_b64_tr_b16 v[164:165], v203 offset:53248
ds_read_b64_tr_b16 v[166:167], v203 offset:55296
v_mfma_f32_32x32x16_bf16 a[0:15], v[184:187], v[96:99], a[0:15]
buffer_load_dwordx4 v[76:79], v205, s[40:43], s48 offen offset:0 sc1
v_mfma_f32_32x32x16_bf16 a[64:79], v[184:187], v[100:103], a[64:79]
v_mfma_f32_32x32x16_bf16 a[16:31], v[188:191], v[96:99], a[16:31]
v_mfma_f32_32x32x16_bf16 a[80:95], v[188:191], v[100:103], a[80:95]
buffer_load_dwordx4 v[80:83], v204, s[40:43], s48 offen offset:1024 sc1
v_mfma_f32_32x32x16_bf16 a[32:47], v[192:195], v[96:99], a[32:47]
v_mfma_f32_32x32x16_bf16 a[96:111], v[192:195], v[100:103], a[96:111]
buffer_load_dwordx4 v[84:87], v205, s[40:43], s48 offen offset:1024 sc1
v_mfma_f32_32x32x16_bf16 a[48:63], v[196:199], v[96:99], a[48:63]
v_mfma_f32_32x32x16_bf16 a[112:127], v[196:199], v[100:103], a[112:127]
s_waitcnt lgkmcnt(8)
v_mfma_f32_32x32x16_bf16 a[0:15], v[136:139], v[104:107], a[0:15]
s_waitcnt vmcnt(30) lgkmcnt(0)
s_barrier
ds_read_b64_tr_b16 v[168:169], v200 offset:57344
ds_read_b64_tr_b16 v[170:171], v200 offset:59392
v_mfma_f32_32x32x16_bf16 a[64:79], v[136:139], v[108:111], a[64:79]
ds_read_b64_tr_b16 v[172:173], v201 offset:57344
ds_read_b64_tr_b16 v[174:175], v201 offset:59392
s_add_u32 m0, s56, 40960
s_nop 0
buffer_load_dwordx4 v206, s[44:47], s49 offen lds
s_add_u32 s49, s49, s54
v_mfma_f32_32x32x16_bf16 a[16:31], v[140:143], v[104:107], a[16:31]
ds_read_b64_tr_b16 v[176:177], v202 offset:57344
ds_read_b64_tr_b16 v[178:179], v202 offset:59392
v_mfma_f32_32x32x16_bf16 a[80:95], v[140:143], v[108:111], a[80:95]
ds_read_b64_tr_b16 v[180:181], v203 offset:57344
ds_read_b64_tr_b16 v[182:183], v203 offset:59392
s_add_u32 m0, s56, 45056
s_nop 0
buffer_load_dwordx4 v206, s[44:47], s49 offen lds
s_add_u32 s49, s49, s54
v_mfma_f32_32x32x16_bf16 a[32:47], v[144:147], v[104:107], a[32:47]
ds_read_b64_tr_b16 v[184:185], v200 offset:61440
ds_read_b64_tr_b16 v[186:187], v200 offset:63488
v_mfma_f32_32x32x16_bf16 a[96:111], v[144:147], v[108:111], a[96:111]
ds_read_b64_tr_b16 v[188:189], v201 offset:61440
ds_read_b64_tr_b16 v[190:191], v201 offset:63488
v_mfma_f32_32x32x16_bf16 a[48:63], v[148:151], v[104:107], a[48:63]
ds_read_b64_tr_b16 v[192:193], v202 offset:61440
ds_read_b64_tr_b16 v[194:195], v202 offset:63488
buffer_load_dwordx4 v[88:91], v204, s[40:43], s48 offen offset:2048 sc1
v_mfma_f32_32x32x16_bf16 a[112:127], v[148:151], v[108:111], a[112:127]
ds_read_b64_tr_b16 v[196:197], v203 offset:61440
ds_read_b64_tr_b16 v[198:199], v203 offset:63488
v_mfma_f32_32x32x16_bf16 a[0:15], v[152:155], v[112:115], a[0:15]
buffer_load_dwordx4 v[92:95], v205, s[40:43], s48 offen offset:2048 sc1
v_mfma_f32_32x32x16_bf16 a[64:79], v[152:155], v[116:119], a[64:79]
v_mfma_f32_32x32x16_bf16 a[16:31], v[156:159], v[112:115], a[16:31]
v_mfma_f32_32x32x16_bf16 a[80:95], v[156:159], v[116:119], a[80:95]
buffer_load_dwordx4 v[96:99], v204, s[40:43], s48 offen offset:3072 sc1
v_mfma_f32_32x32x16_bf16 a[32:47], v[160:163], v[112:115], a[32:47]
v_mfma_f32_32x32x16_bf16 a[96:111], v[160:163], v[116:119], a[96:111]
buffer_load_dwordx4 v[100:103], v205, s[40:43], s48 offen offset:3072 sc1
s_add_u32 s48, s48, 4096
v_mfma_f32_32x32x16_bf16 a[48:63], v[164:167], v[112:115], a[48:63]
v_mfma_f32_32x32x16_bf16 a[112:127], v[164:167], v[116:119], a[112:127]
s_waitcnt lgkmcnt(8)
v_mfma_f32_32x32x16_bf16 a[0:15], v[168:171], v[120:123], a[0:15]
s_waitcnt vmcnt(30) lgkmcnt(0)
s_barrier
ds_read_b64_tr_b16 v[136:137], v200 offset:0
ds_read_b64_tr_b16 v[138:139], v200 offset:2048
v_mfma_f32_32x32x16_bf16 a[64:79], v[168:171], v[124:127], a[64:79]
ds_read_b64_tr_b16 v[140:141], v201 offset:0
ds_read_b64_tr_b16 v[142:143], v201 offset:2048
s_add_u32 m0, s56, 49152
s_nop 0
buffer_load_dwordx4 v206, s[44:47], s49 offen lds
s_add_u32 s49, s49, s54
v_mfma_f32_32x32x16_bf16 a[16:31], v[172:175], v[120:123], a[16:31]
ds_read_b64_tr_b16 v[144:145], v202 offset:0
ds_read_b64_tr_b16 v[146:147], v202 offset:2048
v_mfma_f32_32x32x16_bf16 a[80:95], v[172:175], v[124:127], a[80:95]
ds_read_b64_tr_b16 v[148:149], v203 offset:0
ds_read_b64_tr_b16 v[150:151], v203 offset:2048
s_add_u32 m0, s56, 53248
s_nop 0
buffer_load_dwordx4 v206, s[44:47], s49 offen lds
s_add_u32 s49, s49, s54
v_mfma_f32_32x32x16_bf16 a[32:47], v[176:179], v[120:123], a[32:47]
ds_read_b64_tr_b16 v[152:153], v200 offset:4096
ds_read_b64_tr_b16 v[154:155], v200 offset:6144
v_mfma_f32_32x32x16_bf16 a[96:111], v[176:179], v[124:127], a[96:111]
ds_read_b64_tr_b16 v[156:157], v201 offset:4096
ds_read_b64_tr_b16 v[158:159], v201 offset:6144
v_mfma_f32_32x32x16_bf16 a[48:63], v[180:183], v[120:123], a[48:63]
ds_read_b64_tr_b16 v[160:161], v202 offset:4096
ds_read_b64_tr_b16 v[162:163], v202 offset:6144
buffer_load_dwordx4 v[104:107], v204, s[40:43], s48 offen offset:0 sc1
v_mfma_f32_32x32x16_bf16 a[112:127], v[180:183], v[124:127], a[112:127]
ds_read_b64_tr_b16 v[164:165], v203 offset:4096
ds_read_b64_tr_b16 v[166:167], v203 offset:6144
v_mfma_f32_32x32x16_bf16 a[0:15], v[184:187], v[128:131], a[0:15]
buffer_load_dwordx4 v[108:111], v205, s[40:43], s48 offen offset:0 sc1
v_mfma_f32_32x32x16_bf16 a[64:79], v[184:187], v[132:135], a[64:79]
v_mfma_f32_32x32x16_bf16 a[16:31], v[188:191], v[128:131], a[16:31]
v_mfma_f32_32x32x16_bf16 a[80:95], v[188:191], v[132:135], a[80:95]
buffer_load_dwordx4 v[112:115], v204, s[40:43], s48 offen offset:1024 sc1
v_mfma_f32_32x32x16_bf16 a[32:47], v[192:195], v[128:131], a[32:47]
v_mfma_f32_32x32x16_bf16 a[96:111], v[192:195], v[132:135], a[96:111]
buffer_load_dwordx4 v[116:119], v205, s[40:43], s48 offen offset:1024 sc1
v_mfma_f32_32x32x16_bf16 a[48:63], v[196:199], v[128:131], a[48:63]
v_mfma_f32_32x32x16_bf16 a[112:127], v[196:199], v[132:135], a[112:127]
s_sub_u32 s50, s50, 8
.LgD_329:
s_waitcnt lgkmcnt(8)
v_mfma_f32_32x32x16_bf16 a[0:15], v[136:139], v[8:11], a[0:15]
s_waitcnt vmcnt(30) lgkmcnt(0)
s_barrier
ds_read_b64_tr_b16 v[168:169], v200 offset:8192
ds_read_b64_tr_b16 v[170:171], v200 offset:10240
v_mfma_f32_32x32x16_bf16 a[64:79], v[136:139], v[12:15], a[64:79]
ds_read_b64_tr_b16 v[172:173], v201 offset:8192
ds_read_b64_tr_b16 v[174:175], v201 offset:10240
s_add_u32 m0, s56, 57344
s_nop 0
buffer_load_dwordx4 v206, s[44:47], s49 offen lds
s_add_u32 s49, s49, s54
v_mfma_f32_32x32x16_bf16 a[16:31], v[140:143], v[8:11], a[16:31]
ds_read_b64_tr_b16 v[176:177], v202 offset:8192
ds_read_b64_tr_b16 v[178:179], v202 offset:10240
v_mfma_f32_32x32x16_bf16 a[80:95], v[140:143], v[12:15], a[80:95]
ds_read_b64_tr_b16 v[180:181], v203 offset:8192
ds_read_b64_tr_b16 v[182:183], v203 offset:10240
s_add_u32 m0, s56, 61440
s_nop 0
buffer_load_dwordx4 v206, s[44:47], s49 offen lds
s_add_u32 s49, s49, s54
v_mfma_f32_32x32x16_bf16 a[32:47], v[144:147], v[8:11], a[32:47]
ds_read_b64_tr_b16 v[184:185], v200 offset:12288
ds_read_b64_tr_b16 v[186:187], v200 offset:14336
v_mfma_f32_32x32x16_bf16 a[96:111], v[144:147], v[12:15], a[96:111]
ds_read_b64_tr_b16 v[188:189], v201 offset:12288
ds_read_b64_tr_b16 v[190:191], v201 offset:14336
buffer_load_dwordx4 v[120:123], v204, s[40:43], s48 offen offset:2048 sc1
v_mfma_f32_32x32x16_bf16 a[48:63], v[148:151], v[8:11], a[48:63]
ds_read_b64_tr_b16 v[192:193], v202 offset:12288
ds_read_b64_tr_b16 v[194:195], v202 offset:14336
v_mfma_f32_32x32x16_bf16 a[112:127], v[148:151], v[12:15], a[112:127]
ds_read_b64_tr_b16 v[196:197], v203 offset:12288
ds_read_b64_tr_b16 v[198:199], v203 offset:14336
buffer_load_dwordx4 v[124:127], v205, s[40:43], s48 offen offset:2048 sc1
v_mfma_f32_32x32x16_bf16 a[0:15], v[152:155], v[16:19], a[0:15]
v_mfma_f32_32x32x16_bf16 a[64:79], v[152:155], v[20:23], a[64:79]
buffer_load_dwordx4 v[128:131], v204, s[40:43], s48 offen offset:3072 sc1
v_mfma_f32_32x32x16_bf16 a[16:31], v[156:159], v[16:19], a[16:31]
v_mfma_f32_32x32x16_bf16 a[80:95], v[156:159], v[20:23], a[80:95]
buffer_load_dwordx4 v[132:135], v205, s[40:43], s48 offen offset:3072 sc1
s_add_u32 s48, s48, 4096
v_mfma_f32_32x32x16_bf16 a[32:47], v[160:163], v[16:19], a[32:47]
v_mfma_f32_32x32x16_bf16 a[96:111], v[160:163], v[20:23], a[96:111]
s_cmp_eq_u32 s50, 8
s_cselect_b32 s42, 0, s42
s_cselect_b32 s46, 0, s46
v_mfma_f32_32x32x16_bf16 a[48:63], v[164:167], v[16:19], a[48:63]
v_mfma_f32_32x32x16_bf16 a[112:127], v[164:167], v[20:23], a[112:127]
s_waitcnt lgkmcnt(8)
v_mfma_f32_32x32x16_bf16 a[0:15], v[168:171], v[24:27], a[0:15]
s_waitcnt vmcnt(30) lgkmcnt(0)
s_barrier
ds_read_b64_tr_b16 v[136:137], v200 offset:16384
ds_read_b64_tr_b16 v[138:139], v200 offset:18432
v_mfma_f32_32x32x16_bf16 a[64:79], v[168:171], v[28:31], a[64:79]
ds_read_b64_tr_b16 v[140:141], v201 offset:16384
ds_read_b64_tr_b16 v[142:143], v201 offset:18432
s_add_u32 m0, s56, 0
s_nop 0
buffer_load_dwordx4 v206, s[44:47], s49 offen lds
s_add_u32 s49, s49, s54
v_mfma_f32_32x32x16_bf16 a[16:31], v[172:175], v[24:27], a[16:31]
ds_read_b64_tr_b16 v[144:145], v202 offset:16384
ds_read_b64_tr_b16 v[146:147], v202 offset:18432
v_mfma_f32_32x32x16_bf16 a[80:95], v[172:175], v[28:31], a[80:95]
ds_read_b64_tr_b16 v[148:149], v203 offset:16384
ds_read_b64_tr_b16 v[150:151], v203 offset:18432
s_add_u32 m0, s56, 4096
s_nop 0
buffer_load_dwordx4 v206, s[44:47], s49 offen lds
s_add_u32 s49, s49, s54
v_mfma_f32_32x32x16_bf16 a[32:47], v[176:179], v[24:27], a[32:47]
ds_read_b64_tr_b16 v[152:153], v200 offset:20480
ds_read_b64_tr_b16 v[154:155], v200 offset:22528
v_mfma_f32_32x32x16_bf16 a[96:111], v[176:179], v[28:31], a[96:111]
ds_read_b64_tr_b16 v[156:157], v201 offset:20480
ds_read_b64_tr_b16 v[158:159], v201 offset:22528
v_mfma_f32_32x32x16_bf16 a[48:63], v[180:183], v[24:27], a[48:63]
ds_read_b64_tr_b16 v[160:161], v202 offset:20480
ds_read_b64_tr_b16 v[162:163], v202 offset:22528
buffer_load_dwordx4 v[8:11], v204, s[40:43], s48 offen offset:0 sc1
v_mfma_f32_32x32x16_bf16 a[112:127], v[180:183], v[28:31], a[112:127]
ds_read_b64_tr_b16 v[164:165], v203 offset:20480
ds_read_b64_tr_b16 v[166:167], v203 offset:22528
v_mfma_f32_32x32x16_bf16 a[0:15], v[184:187], v[32:35], a[0:15]
buffer_load_dwordx4 v[12:15], v205, s[40:43], s48 offen offset:0 sc1
v_mfma_f32_32x32x16_bf16 a[64:79], v[184:187], v[36:39], a[64:79]
v_mfma_f32_32x32x16_bf16 a[16:31], v[188:191], v[32:35], a[16:31]
v_mfma_f32_32x32x16_bf16 a[80:95], v[188:191], v[36:39], a[80:95]
buffer_load_dwordx4 v[16:19], v204, s[40:43], s48 offen offset:1024 sc1
v_mfma_f32_32x32x16_bf16 a[32:47], v[192:195], v[32:35], a[32:47]
v_mfma_f32_32x32x16_bf16 a[96:111], v[192:195], v[36:39], a[96:111]
buffer_load_dwordx4 v[20:23], v205, s[40:43], s48 offen offset:1024 sc1
v_mfma_f32_32x32x16_bf16 a[48:63], v[196:199], v[32:35], a[48:63]
v_mfma_f32_32x32x16_bf16 a[112:127], v[196:199], v[36:39], a[112:127]
s_waitcnt lgkmcnt(8)
v_mfma_f32_32x32x16_bf16 a[0:15], v[136:139], v[40:43], a[0:15]
s_waitcnt vmcnt(30) lgkmcnt(0)
s_barrier
ds_read_b64_tr_b16 v[168:169], v200 offset:24576
ds_read_b64_tr_b16 v[170:171], v200 offset:26624
v_mfma_f32_32x32x16_bf16 a[64:79], v[136:139], v[44:47], a[64:79]
ds_read_b64_tr_b16 v[172:173], v201 offset:24576
ds_read_b64_tr_b16 v[174:175], v201 offset:26624
s_add_u32 m0, s56, 8192
s_nop 0
buffer_load_dwordx4 v206, s[44:47], s49 offen lds
s_add_u32 s49, s49, s54
v_mfma_f32_32x32x16_bf16 a[16:31], v[140:143], v[40:43], a[16:31]
ds_read_b64_tr_b16 v[176:177], v202 offset:24576
ds_read_b64_tr_b16 v[178:179], v202 offset:26624
v_mfma_f32_32x32x16_bf16 a[80:95], v[140:143], v[44:47], a[80:95]
ds_read_b64_tr_b16 v[180:181], v203 offset:24576
ds_read_b64_tr_b16 v[182:183], v203 offset:26624
s_add_u32 m0, s56, 12288
s_nop 0
buffer_load_dwordx4 v206, s[44:47], s49 offen lds
s_add_u32 s49, s49, s54
v_mfma_f32_32x32x16_bf16 a[32:47], v[144:147], v[40:43], a[32:47]
ds_read_b64_tr_b16 v[184:185], v200 offset:28672
ds_read_b64_tr_b16 v[186:187], v200 offset:30720
v_mfma_f32_32x32x16_bf16 a[96:111], v[144:147], v[44:47], a[96:111]
ds_read_b64_tr_b16 v[188:189], v201 offset:28672
ds_read_b64_tr_b16 v[190:191], v201 offset:30720
v_mfma_f32_32x32x16_bf16 a[48:63], v[148:151], v[40:43], a[48:63]
ds_read_b64_tr_b16 v[192:193], v202 offset:28672
ds_read_b64_tr_b16 v[194:195], v202 offset:30720
buffer_load_dwordx4 v[24:27], v204, s[40:43], s48 offen offset:2048 sc1
v_mfma_f32_32x32x16_bf16 a[112:127], v[148:151], v[44:47], a[112:127]
ds_read_b64_tr_b16 v[196:197], v203 offset:28672
ds_read_b64_tr_b16 v[198:199], v203 offset:30720
v_mfma_f32_32x32x16_bf16 a[0:15], v[152:155], v[48:51], a[0:15]
buffer_load_dwordx4 v[28:31], v205, s[40:43], s48 offen offset:2048 sc1
v_mfma_f32_32x32x16_bf16 a[64:79], v[152:155], v[52:55], a[64:79]
v_mfma_f32_32x32x16_bf16 a[16:31], v[156:159], v[48:51], a[16:31]
v_mfma_f32_32x32x16_bf16 a[80:95], v[156:159], v[52:55], a[80:95]
buffer_load_dwordx4 v[32:35], v204, s[40:43], s48 offen offset:3072 sc1
v_mfma_f32_32x32x16_bf16 a[32:47], v[160:163], v[48:51], a[32:47]
v_mfma_f32_32x32x16_bf16 a[96:111], v[160:163], v[52:55], a[96:111]
buffer_load_dwordx4 v[36:39], v205, s[40:43], s48 offen offset:3072 sc1
s_add_u32 s48, s48, 4096
v_mfma_f32_32x32x16_bf16 a[48:63], v[164:167], v[48:51], a[48:63]
v_mfma_f32_32x32x16_bf16 a[112:127], v[164:167], v[52:55], a[112:127]
s_waitcnt lgkmcnt(8)
v_mfma_f32_32x32x16_bf16 a[0:15], v[168:171], v[56:59], a[0:15]
s_waitcnt vmcnt(30) lgkmcnt(0)
s_barrier
ds_read_b64_tr_b16 v[136:137], v200 offset:32768
ds_read_b64_tr_b16 v[138:139], v200 offset:34816
v_mfma_f32_32x32x16_bf16 a[64:79], v[168:171], v[60:63], a[64:79]
ds_read_b64_tr_b16 v[140:141], v201 offset:32768
ds_read_b64_tr_b16 v[142:143], v201 offset:34816
s_add_u32 m0, s56, 16384
s_nop 0
buffer_load_dwordx4 v206, s[44:47], s49 offen lds
s_add_u32 s49, s49, s54
v_mfma_f32_32x32x16_bf16 a[16:31], v[172:175], v[56:59], a[16:31]
ds_read_b64_tr_b16 v[144:145], v202 offset:32768
ds_read_b64_tr_b16 v[146:147], v202 offset:34816
v_mfma_f32_32x32x16_bf16 a[80:95], v[172:175], v[60:63], a[80:95]
ds_read_b64_tr_b16 v[148:149], v203 offset:32768
ds_read_b64_tr_b16 v[150:151], v203 offset:34816
s_add_u32 m0, s56, 20480
s_nop 0
buffer_load_dwordx4 v206, s[44:47], s49 offen lds
s_add_u32 s49, s49, s54
v_mfma_f32_32x32x16_bf16 a[32:47], v[176:179], v[56:59], a[32:47]
ds_read_b64_tr_b16 v[152:153], v200 offset:36864
ds_read_b64_tr_b16 v[154:155], v200 offset:38912
v_mfma_f32_32x32x16_bf16 a[96:111], v[176:179], v[60:63], a[96:111]
ds_read_b64_tr_b16 v[156:157], v201 offset:36864
ds_read_b64_tr_b16 v[158:159], v201 offset:38912
v_mfma_f32_32x32x16_bf16 a[48:63], v[180:183], v[56:59], a[48:63]
ds_read_b64_tr_b16 v[160:161], v202 offset:36864
ds_read_b64_tr_b16 v[162:163], v202 offset:38912
buffer_load_dwordx4 v[40:43], v204, s[40:43], s48 offen offset:0 sc1
v_mfma_f32_32x32x16_bf16 a[112:127], v[180:183], v[60:63], a[112:127]
ds_read_b64_tr_b16 v[164:165], v203 offset:36864
ds_read_b64_tr_b16 v[166:167], v203 offset:38912
v_mfma_f32_32x32x16_bf16 a[0:15], v[184:187], v[64:67], a[0:15]
buffer_load_dwordx4 v[44:47], v205, s[40:43], s48 offen offset:0 sc1
v_mfma_f32_32x32x16_bf16 a[64:79], v[184:187], v[68:71], a[64:79]
v_mfma_f32_32x32x16_bf16 a[16:31], v[188:191], v[64:67], a[16:31]
v_mfma_f32_32x32x16_bf16 a[80:95], v[188:191], v[68:71], a[80:95]
buffer_load_dwordx4 v[48:51], v204, s[40:43], s48 offen offset:1024 sc1
v_mfma_f32_32x32x16_bf16 a[32:47], v[192:195], v[64:67], a[32:47]
v_mfma_f32_32x32x16_bf16 a[96:111], v[192:195], v[68:71], a[96:111]
buffer_load_dwordx4 v[52:55], v205, s[40:43], s48 offen offset:1024 sc1
v_mfma_f32_32x32x16_bf16 a[48:63], v[196:199], v[64:67], a[48:63]
v_mfma_f32_32x32x16_bf16 a[112:127], v[196:199], v[68:71], a[112:127]
s_waitcnt lgkmcnt(8)
v_mfma_f32_32x32x16_bf16 a[0:15], v[136:139], v[72:75], a[0:15]
s_waitcnt vmcnt(30) lgkmcnt(0)
s_barrier
ds_read_b64_tr_b16 v[168:169], v200 offset:40960
ds_read_b64_tr_b16 v[170:171], v200 offset:43008
v_mfma_f32_32x32x16_bf16 a[64:79], v[136:139], v[76:79], a[64:79]
ds_read_b64_tr_b16 v[172:173], v201 offset:40960
ds_read_b64_tr_b16 v[174:175], v201 offset:43008
s_add_u32 m0, s56, 24576
s_nop 0
buffer_load_dwordx4 v206, s[44:47], s49 offen lds
s_add_u32 s49, s49, s54
v_mfma_f32_32x32x16_bf16 a[16:31], v[140:143], v[72:75], a[16:31]
ds_read_b64_tr_b16 v[176:177], v202 offset:40960
ds_read_b64_tr_b16 v[178:179], v202 offset:43008
v_mfma_f32_32x32x16_bf16 a[80:95], v[140:143], v[76:79], a[80:95]
ds_read_b64_tr_b16 v[180:181], v203 offset:40960
ds_read_b64_tr_b16 v[182:183], v203 offset:43008
s_add_u32 m0, s56, 28672
s_nop 0
buffer_load_dwordx4 v206, s[44:47], s49 offen lds
s_add_u32 s49, s49, s54
v_mfma_f32_32x32x16_bf16 a[32:47], v[144:147], v[72:75], a[32:47]
ds_read_b64_tr_b16 v[184:185], v200 offset:45056
ds_read_b64_tr_b16 v[186:187], v200 offset:47104
v_mfma_f32_32x32x16_bf16 a[96:111], v[144:147], v[76:79], a[96:111]
ds_read_b64_tr_b16 v[188:189], v201 offset:45056
ds_read_b64_tr_b16 v[190:191], v201 offset:47104
v_mfma_f32_32x32x16_bf16 a[48:63], v[148:151], v[72:75], a[48:63]
ds_read_b64_tr_b16 v[192:193], v202 offset:45056
ds_read_b64_tr_b16 v[194:195], v202 offset:47104
buffer_load_dwordx4 v[56:59], v204, s[40:43], s48 offen offset:2048 sc1
v_mfma_f32_32x32x16_bf16 a[112:127], v[148:151], v[76:79], a[112:127]
ds_read_b64_tr_b16 v[196:197], v203 offset:45056
ds_read_b64_tr_b16 v[198:199], v203 offset:47104
v_mfma_f32_32x32x16_bf16 a[0:15], v[152:155], v[80:83], a[0:15]
buffer_load_dwordx4 v[60:63], v205, s[40:43], s48 offen offset:2048 sc1
v_mfma_f32_32x32x16_bf16 a[64:79], v[152:155], v[84:87], a[64:79]
v_mfma_f32_32x32x16_bf16 a[16:31], v[156:159], v[80:83], a[16:31]
v_mfma_f32_32x32x16_bf16 a[80:95], v[156:159], v[84:87], a[80:95]
buffer_load_dwordx4 v[64:67], v204, s[40:43], s48 offen offset:3072 sc1
v_mfma_f32_32x32x16_bf16 a[32:47], v[160:163], v[80:83], a[32:47]
v_mfma_f32_32x32x16_bf16 a[96:111], v[160:163], v[84:87], a[96:111]
buffer_load_dwordx4 v[68:71], v205, s[40:43], s48 offen offset:3072 sc1
s_add_u32 s48, s48, 4096
v_mfma_f32_32x32x16_bf16 a[48:63], v[164:167], v[80:83], a[48:63]
v_mfma_f32_32x32x16_bf16 a[112:127], v[164:167], v[84:87], a[112:127]
s_waitcnt lgkmcnt(8)
v_mfma_f32_32x32x16_bf16 a[0:15], v[168:171], v[88:91], a[0:15]
s_waitcnt vmcnt(30) lgkmcnt(0)
s_barrier
ds_read_b64_tr_b16 v[136:137], v200 offset:49152
ds_read_b64_tr_b16 v[138:139], v200 offset:51200
v_mfma_f32_32x32x16_bf16 a[64:79], v[168:171], v[92:95], a[64:79]
ds_read_b64_tr_b16 v[140:141], v201 offset:49152
ds_read_b64_tr_b16 v[142:143], v201 offset:51200
s_add_u32 m0, s56, 32768
s_nop 0
buffer_load_dwordx4 v206, s[44:47], s49 offen lds
s_add_u32 s49, s49, s54
v_mfma_f32_32x32x16_bf16 a[16:31], v[172:175], v[88:91], a[16:31]
ds_read_b64_tr_b16 v[144:145], v202 offset:49152
ds_read_b64_tr_b16 v[146:147], v202 offset:51200
v_mfma_f32_32x32x16_bf16 a[80:95], v[172:175], v[92:95], a[80:95]
ds_read_b64_tr_b16 v[148:149], v203 offset:49152
ds_read_b64_tr_b16 v[150:151], v203 offset:51200
s_add_u32 m0, s56, 36864
s_nop 0
buffer_load_dwordx4 v206, s[44:47], s49 offen lds
s_add_u32 s49, s49, s54
v_mfma_f32_32x32x16_bf16 a[32:47], v[176:179], v[88:91], a[32:47]
ds_read_b64_tr_b16 v[152:153], v200 offset:53248
ds_read_b64_tr_b16 v[154:155], v200 offset:55296
v_mfma_f32_32x32x16_bf16 a[96:111], v[176:179], v[92:95], a[96:111]
ds_read_b64_tr_b16 v[156:157], v201 offset:53248
ds_read_b64_tr_b16 v[158:159], v201 offset:55296
v_mfma_f32_32x32x16_bf16 a[48:63], v[180:183], v[88:91], a[48:63]
ds_read_b64_tr_b16 v[160:161], v202 offset:53248
ds_read_b64_tr_b16 v[162:163], v202 offset:55296
buffer_load_dwordx4 v[72:75], v204, s[40:43], s48 offen offset:0 sc1
v_mfma_f32_32x32x16_bf16 a[112:127], v[180:183], v[92:95], a[112:127]
ds_read_b64_tr_b16 v[164:165], v203 offset:53248
ds_read_b64_tr_b16 v[166:167], v203 offset:55296
v_mfma_f32_32x32x16_bf16 a[0:15], v[184:187], v[96:99], a[0:15]
buffer_load_dwordx4 v[76:79], v205, s[40:43], s48 offen offset:0 sc1
v_mfma_f32_32x32x16_bf16 a[64:79], v[184:187], v[100:103], a[64:79]
v_mfma_f32_32x32x16_bf16 a[16:31], v[188:191], v[96:99], a[16:31]
v_mfma_f32_32x32x16_bf16 a[80:95], v[188:191], v[100:103], a[80:95]
buffer_load_dwordx4 v[80:83], v204, s[40:43], s48 offen offset:1024 sc1
v_mfma_f32_32x32x16_bf16 a[32:47], v[192:195], v[96:99], a[32:47]
v_mfma_f32_32x32x16_bf16 a[96:111], v[192:195], v[100:103], a[96:111]
buffer_load_dwordx4 v[84:87], v205, s[40:43], s48 offen offset:1024 sc1
v_mfma_f32_32x32x16_bf16 a[48:63], v[196:199], v[96:99], a[48:63]
v_mfma_f32_32x32x16_bf16 a[112:127], v[196:199], v[100:103], a[112:127]
s_waitcnt lgkmcnt(8)
v_mfma_f32_32x32x16_bf16 a[0:15], v[136:139], v[104:107], a[0:15]
s_waitcnt vmcnt(30) lgkmcnt(0)
s_barrier
ds_read_b64_tr_b16 v[168:169], v200 offset:57344
ds_read_b64_tr_b16 v[170:171], v200 offset:59392
v_mfma_f32_32x32x16_bf16 a[64:79], v[136:139], v[108:111], a[64:79]
ds_read_b64_tr_b16 v[172:173], v201 offset:57344
ds_read_b64_tr_b16 v[174:175], v201 offset:59392
s_add_u32 m0, s56, 40960
s_nop 0
buffer_load_dwordx4 v206, s[44:47], s49 offen lds
s_add_u32 s49, s49, s54
v_mfma_f32_32x32x16_bf16 a[16:31], v[140:143], v[104:107], a[16:31]
ds_read_b64_tr_b16 v[176:177], v202 offset:57344
ds_read_b64_tr_b16 v[178:179], v202 offset:59392
v_mfma_f32_32x32x16_bf16 a[80:95], v[140:143], v[108:111], a[80:95]
ds_read_b64_tr_b16 v[180:181], v203 offset:57344
ds_read_b64_tr_b16 v[182:183], v203 offset:59392
s_add_u32 m0, s56, 45056
s_nop 0
buffer_load_dwordx4 v206, s[44:47], s49 offen lds
s_add_u32 s49, s49, s54
v_mfma_f32_32x32x16_bf16 a[32:47], v[144:147], v[104:107], a[32:47]
ds_read_b64_tr_b16 v[184:185], v200 offset:61440
ds_read_b64_tr_b16 v[186:187], v200 offset:63488
v_mfma_f32_32x32x16_bf16 a[96:111], v[144:147], v[108:111], a[96:111]
ds_read_b64_tr_b16 v[188:189], v201 offset:61440
ds_read_b64_tr_b16 v[190:191], v201 offset:63488
v_mfma_f32_32x32x16_bf16 a[48:63], v[148:151], v[104:107], a[48:63]
ds_read_b64_tr_b16 v[192:193], v202 offset:61440
ds_read_b64_tr_b16 v[194:195], v202 offset:63488
buffer_load_dwordx4 v[88:91], v204, s[40:43], s48 offen offset:2048 sc1
v_mfma_f32_32x32x16_bf16 a[112:127], v[148:151], v[108:111], a[112:127]
ds_read_b64_tr_b16 v[196:197], v203 offset:61440
ds_read_b64_tr_b16 v[198:199], v203 offset:63488
v_mfma_f32_32x32x16_bf16 a[0:15], v[152:155], v[112:115], a[0:15]
buffer_load_dwordx4 v[92:95], v205, s[40:43], s48 offen offset:2048 sc1
v_mfma_f32_32x32x16_bf16 a[64:79], v[152:155], v[116:119], a[64:79]
v_mfma_f32_32x32x16_bf16 a[16:31], v[156:159], v[112:115], a[16:31]
v_mfma_f32_32x32x16_bf16 a[80:95], v[156:159], v[116:119], a[80:95]
buffer_load_dwordx4 v[96:99], v204, s[40:43], s48 offen offset:3072 sc1
v_mfma_f32_32x32x16_bf16 a[32:47], v[160:163], v[112:115], a[32:47]
v_mfma_f32_32x32x16_bf16 a[96:111], v[160:163], v[116:119], a[96:111]
buffer_load_dwordx4 v[100:103], v205, s[40:43], s48 offen offset:3072 sc1
s_add_u32 s48, s48, 4096
v_mfma_f32_32x32x16_bf16 a[48:63], v[164:167], v[112:115], a[48:63]
v_mfma_f32_32x32x16_bf16 a[112:127], v[164:167], v[116:119], a[112:127]
s_waitcnt lgkmcnt(8)
v_mfma_f32_32x32x16_bf16 a[0:15], v[168:171], v[120:123], a[0:15]
s_waitcnt vmcnt(30) lgkmcnt(0)
s_barrier
ds_read_b64_tr_b16 v[136:137], v200 offset:0
ds_read_b64_tr_b16 v[138:139], v200 offset:2048
v_mfma_f32_32x32x16_bf16 a[64:79], v[168:171], v[124:127], a[64:79]
ds_read_b64_tr_b16 v[140:141], v201 offset:0
ds_read_b64_tr_b16 v[142:143], v201 offset:2048
s_add_u32 m0, s56, 49152
s_nop 0
buffer_load_dwordx4 v206, s[44:47], s49 offen lds
s_add_u32 s49, s49, s54
v_mfma_f32_32x32x16_bf16 a[16:31], v[172:175], v[120:123], a[16:31]
ds_read_b64_tr_b16 v[144:145], v202 offset:0
ds_read_b64_tr_b16 v[146:147], v202 offset:2048
v_mfma_f32_32x32x16_bf16 a[80:95], v[172:175], v[124:127], a[80:95]
ds_read_b64_tr_b16 v[148:149], v203 offset:0
ds_read_b64_tr_b16 v[150:151], v203 offset:2048
s_add_u32 m0, s56, 53248
s_nop 0
buffer_load_dwordx4 v206, s[44:47], s49 offen lds
s_add_u32 s49, s49, s54
v_mfma_f32_32x32x16_bf16 a[32:47], v[176:179], v[120:123], a[32:47]
ds_read_b64_tr_b16 v[152:153], v200 offset:4096
ds_read_b64_tr_b16 v[154:155], v200 offset:6144
v_mfma_f32_32x32x16_bf16 a[96:111], v[176:179], v[124:127], a[96:111]
ds_read_b64_tr_b16 v[156:157], v201 offset:4096
ds_read_b64_tr_b16 v[158:159], v201 offset:6144
v_mfma_f32_32x32x16_bf16 a[48:63], v[180:183], v[120:123], a[48:63]
ds_read_b64_tr_b16 v[160:161], v202 offset:4096
ds_read_b64_tr_b16 v[162:163], v202 offset:6144
buffer_load_dwordx4 v[104:107], v204, s[40:43], s48 offen offset:0 sc1
v_mfma_f32_32x32x16_bf16 a[112:127], v[180:183], v[124:127], a[112:127]
ds_read_b64_tr_b16 v[164:165], v203 offset:4096
ds_read_b64_tr_b16 v[166:167], v203 offset:6144
v_mfma_f32_32x32x16_bf16 a[0:15], v[184:187], v[128:131], a[0:15]
buffer_load_dwordx4 v[108:111], v205, s[40:43], s48 offen offset:0 sc1
v_mfma_f32_32x32x16_bf16 a[64:79], v[184:187], v[132:135], a[64:79]
v_mfma_f32_32x32x16_bf16 a[16:31], v[188:191], v[128:131], a[16:31]
v_mfma_f32_32x32x16_bf16 a[80:95], v[188:191], v[132:135], a[80:95]
buffer_load_dwordx4 v[112:115], v204, s[40:43], s48 offen offset:1024 sc1
v_mfma_f32_32x32x16_bf16 a[32:47], v[192:195], v[128:131], a[32:47]
v_mfma_f32_32x32x16_bf16 a[96:111], v[192:195], v[132:135], a[96:111]
buffer_load_dwordx4 v[116:119], v205, s[40:43], s48 offen offset:1024 sc1
v_mfma_f32_32x32x16_bf16 a[48:63], v[196:199], v[128:131], a[48:63]
v_mfma_f32_32x32x16_bf16 a[112:127], v[196:199], v[132:135], a[112:127]
s_sub_u32 s50, s50, 8
s_cmp_gt_u32 s50, 0
s_cbranch_scc1 .LgD_329
s_waitcnt vmcnt(0) lgkmcnt(0)
s_nop 15
s_branch .Lepi_328
.Lvt_327:
v_accvgpr_write_b32 a0, 0
v_accvgpr_write_b32 a1, 0
v_accvgpr_write_b32 a2, 0
v_accvgpr_write_b32 a3, 0
v_accvgpr_write_b32 a4, 0
v_accvgpr_write_b32 a5, 0
v_accvgpr_write_b32 a6, 0
v_accvgpr_write_b32 a7, 0
v_accvgpr_write_b32 a8, 0
v_accvgpr_write_b32 a9, 0
v_accvgpr_write_b32 a10, 0
v_accvgpr_write_b32 a11, 0
v_accvgpr_write_b32 a12, 0
v_accvgpr_write_b32 a13, 0
v_accvgpr_write_b32 a14, 0
v_accvgpr_write_b32 a15, 0
v_accvgpr_write_b32 a16, 0
v_accvgpr_write_b32 a17, 0
v_accvgpr_write_b32 a18, 0
v_accvgpr_write_b32 a19, 0
v_accvgpr_write_b32 a20, 0
v_accvgpr_write_b32 a21, 0
v_accvgpr_write_b32 a22, 0
v_accvgpr_write_b32 a23, 0
v_accvgpr_write_b32 a24, 0
v_accvgpr_write_b32 a25, 0
v_accvgpr_write_b32 a26, 0
v_accvgpr_write_b32 a27, 0
v_accvgpr_write_b32 a28, 0
v_accvgpr_write_b32 a29, 0
v_accvgpr_write_b32 a30, 0
v_accvgpr_write_b32 a31, 0
v_accvgpr_write_b32 a32, 0
v_accvgpr_write_b32 a33, 0
v_accvgpr_write_b32 a34, 0
v_accvgpr_write_b32 a35, 0
v_accvgpr_write_b32 a36, 0
v_accvgpr_write_b32 a37, 0
v_accvgpr_write_b32 a38, 0
v_accvgpr_write_b32 a39, 0
v_accvgpr_write_b32 a40, 0
v_accvgpr_write_b32 a41, 0
v_accvgpr_write_b32 a42, 0
v_accvgpr_write_b32 a43, 0
v_accvgpr_write_b32 a44, 0
v_accvgpr_write_b32 a45, 0
v_accvgpr_write_b32 a46, 0
v_accvgpr_write_b32 a47, 0
v_accvgpr_write_b32 a48, 0
v_accvgpr_write_b32 a49, 0
v_accvgpr_write_b32 a50, 0
v_accvgpr_write_b32 a51, 0
v_accvgpr_write_b32 a52, 0
v_accvgpr_write_b32 a53, 0
v_accvgpr_write_b32 a54, 0
v_accvgpr_write_b32 a55, 0
v_accvgpr_write_b32 a56, 0
v_accvgpr_write_b32 a57, 0
v_accvgpr_write_b32 a58, 0
v_accvgpr_write_b32 a59, 0
v_accvgpr_write_b32 a60, 0
v_accvgpr_write_b32 a61, 0
v_accvgpr_write_b32 a62, 0
v_accvgpr_write_b32 a63, 0
v_accvgpr_write_b32 a64, 0
v_accvgpr_write_b32 a65, 0
v_accvgpr_write_b32 a66, 0
v_accvgpr_write_b32 a67, 0
v_accvgpr_write_b32 a68, 0
v_accvgpr_write_b32 a69, 0
v_accvgpr_write_b32 a70, 0
v_accvgpr_write_b32 a71, 0
v_accvgpr_write_b32 a72, 0
v_accvgpr_write_b32 a73, 0
v_accvgpr_write_b32 a74, 0
v_accvgpr_write_b32 a75, 0
v_accvgpr_write_b32 a76, 0
v_accvgpr_write_b32 a77, 0
v_accvgpr_write_b32 a78, 0
v_accvgpr_write_b32 a79, 0
v_accvgpr_write_b32 a80, 0
v_accvgpr_write_b32 a81, 0
v_accvgpr_write_b32 a82, 0
v_accvgpr_write_b32 a83, 0
v_accvgpr_write_b32 a84, 0
v_accvgpr_write_b32 a85, 0
v_accvgpr_write_b32 a86, 0
v_accvgpr_write_b32 a87, 0
v_accvgpr_write_b32 a88, 0
v_accvgpr_write_b32 a89, 0
v_accvgpr_write_b32 a90, 0
v_accvgpr_write_b32 a91, 0
v_accvgpr_write_b32 a92, 0
v_accvgpr_write_b32 a93, 0
v_accvgpr_write_b32 a94, 0
v_accvgpr_write_b32 a95, 0
v_accvgpr_write_b32 a96, 0
v_accvgpr_write_b32 a97, 0
v_accvgpr_write_b32 a98, 0
v_accvgpr_write_b32 a99, 0
v_accvgpr_write_b32 a100, 0
v_accvgpr_write_b32 a101, 0
v_accvgpr_write_b32 a102, 0
v_accvgpr_write_b32 a103, 0
v_accvgpr_write_b32 a104, 0
v_accvgpr_write_b32 a105, 0
v_accvgpr_write_b32 a106, 0
v_accvgpr_write_b32 a107, 0
v_accvgpr_write_b32 a108, 0
v_accvgpr_write_b32 a109, 0
v_accvgpr_write_b32 a110, 0
v_accvgpr_write_b32 a111, 0
v_accvgpr_write_b32 a112, 0
v_accvgpr_write_b32 a113, 0
v_accvgpr_write_b32 a114, 0
v_accvgpr_write_b32 a115, 0
v_accvgpr_write_b32 a116, 0
v_accvgpr_write_b32 a117, 0
v_accvgpr_write_b32 a118, 0
v_accvgpr_write_b32 a119, 0
v_accvgpr_write_b32 a120, 0
v_accvgpr_write_b32 a121, 0
v_accvgpr_write_b32 a122, 0
v_accvgpr_write_b32 a123, 0
v_accvgpr_write_b32 a124, 0
v_accvgpr_write_b32 a125, 0
v_accvgpr_write_b32 a126, 0
v_accvgpr_write_b32 a127, 0
s_waitcnt vmcnt(24)
s_barrier
ds_read_b64_tr_b16 v[136:137], v200 offset:0
ds_read_b64_tr_b16 v[138:139], v200 offset:2048
ds_read_b64_tr_b16 v[140:141], v201 offset:0
ds_read_b64_tr_b16 v[142:143], v201 offset:2048
ds_read_b64_tr_b16 v[144:145], v202 offset:0
ds_read_b64_tr_b16 v[146:147], v202 offset:2048
ds_read_b64_tr_b16 v[148:149], v203 offset:0
ds_read_b64_tr_b16 v[150:151], v203 offset:2048
ds_read_b64_tr_b16 v[152:153], v200 offset:4096
ds_read_b64_tr_b16 v[154:155], v200 offset:6144
ds_read_b64_tr_b16 v[156:157], v201 offset:4096
ds_read_b64_tr_b16 v[158:159], v201 offset:6144
ds_read_b64_tr_b16 v[160:161], v202 offset:4096
ds_read_b64_tr_b16 v[162:163], v202 offset:6144
ds_read_b64_tr_b16 v[164:165], v203 offset:4096
ds_read_b64_tr_b16 v[166:167], v203 offset:6144
s_waitcnt lgkmcnt(8)
v_mfma_f32_32x32x16_bf16 a[0:15], v[8:11], v[136:139], a[0:15]
s_waitcnt vmcnt(20) lgkmcnt(0)
s_barrier
ds_read_b64_tr_b16 v[168:169], v200 offset:8192
ds_read_b64_tr_b16 v[170:171], v200 offset:10240
v_mfma_f32_32x32x16_bf16 a[64:79], v[12:15], v[136:139], a[64:79]
ds_read_b64_tr_b16 v[172:173], v201 offset:8192
ds_read_b64_tr_b16 v[174:175], v201 offset:10240
s_add_u32 m0, s56, 57344
s_nop 0
buffer_load_dwordx4 v206, s[44:47], s49 offen lds
s_add_u32 s49, s49, s54
v_mfma_f32_32x32x16_bf16 a[16:31], v[8:11], v[140:143], a[16:31]
ds_read_b64_tr_b16 v[176:177], v202 offset:8192
ds_read_b64_tr_b16 v[178:179], v202 offset:10240
v_mfma_f32_32x32x16_bf16 a[80:95], v[12:15], v[140:143], a[80:95]
ds_read_b64_tr_b16 v[180:181], v203 offset:8192
ds_read_b64_tr_b16 v[182:183], v203 offset:10240
s_add_u32 m0, s56, 61440
s_nop 0
buffer_load_dwordx4 v206, s[44:47], s49 offen lds
s_add_u32 s49, s49, s54
v_mfma_f32_32x32x16_bf16 a[32:47], v[8:11], v[144:147], a[32:47]
ds_read_b64_tr_b16 v[184:185], v200 offset:12288
ds_read_b64_tr_b16 v[186:187], v200 offset:14336
v_mfma_f32_32x32x16_bf16 a[96:111], v[12:15], v[144:147], a[96:111]
ds_read_b64_tr_b16 v[188:189], v201 offset:12288
ds_read_b64_tr_b16 v[190:191], v201 offset:14336
buffer_load_dwordx4 v[120:123], v204, s[40:43], s48 offen offset:2048 sc1
v_mfma_f32_32x32x16_bf16 a[48:63], v[8:11], v[148:151], a[48:63]
ds_read_b64_tr_b16 v[192:193], v202 offset:12288
ds_read_b64_tr_b16 v[194:195], v202 offset:14336
v_mfma_f32_32x32x16_bf16 a[112:127], v[12:15], v[148:151], a[112:127]
ds_read_b64_tr_b16 v[196:197], v203 offset:12288
ds_read_b64_tr_b16 v[198:199], v203 offset:14336
buffer_load_dwordx4 v[124:127], v205, s[40:43], s48 offen offset:2048 sc1
v_mfma_f32_32x32x16_bf16 a[0:15], v[16:19], v[152:155], a[0:15]
v_mfma_f32_32x32x16_bf16 a[64:79], v[20:23], v[152:155], a[64:79]
buffer_load_dwordx4 v[128:131], v204, s[40:43], s48 offen offset:3072 sc1
v_mfma_f32_32x32x16_bf16 a[16:31], v[16:19], v[156:159], a[16:31]
v_mfma_f32_32x32x16_bf16 a[80:95], v[20:23], v[156:159], a[80:95]
buffer_load_dwordx4 v[132:135], v205, s[40:43], s48 offen offset:3072 sc1
s_add_u32 s48, s48, 4096
v_mfma_f32_32x32x16_bf16 a[32:47], v[16:19], v[160:163], a[32:47]
v_mfma_f32_32x32x16_bf16 a[96:111], v[20:23], v[160:163], a[96:111]
s_cmp_eq_u32 s50, 8
s_cselect_b32 s42, 0, s42
s_cselect_b32 s46, 0, s46
v_mfma_f32_32x32x16_bf16 a[48:63], v[16:19], v[164:167], a[48:63]
v_mfma_f32_32x32x16_bf16 a[112:127], v[20:23], v[164:167], a[112:127]
s_waitcnt lgkmcnt(8)
v_mfma_f32_32x32x16_bf16 a[0:15], v[24:27], v[168:171], a[0:15]
s_waitcnt vmcnt(22) lgkmcnt(0)
s_barrier
ds_read_b64_tr_b16 v[136:137], v200 offset:16384
ds_read_b64_tr_b16 v[138:139], v200 offset:18432
v_mfma_f32_32x32x16_bf16 a[64:79], v[28:31], v[168:171], a[64:79]
ds_read_b64_tr_b16 v[140:141], v201 offset:16384
ds_read_b64_tr_b16 v[142:143], v201 offset:18432
s_add_u32 m0, s56, 0
s_nop 0
buffer_load_dwordx4 v206, s[44:47], s49 offen lds
s_add_u32 s49, s49, s54
v_mfma_f32_32x32x16_bf16 a[16:31], v[24:27], v[172:175], a[16:31]
ds_read_b64_tr_b16 v[144:145], v202 offset:16384
ds_read_b64_tr_b16 v[146:147], v202 offset:18432
v_mfma_f32_32x32x16_bf16 a[80:95], v[28:31], v[172:175], a[80:95]
ds_read_b64_tr_b16 v[148:149], v203 offset:16384
ds_read_b64_tr_b16 v[150:151], v203 offset:18432
s_add_u32 m0, s56, 4096
s_nop 0
buffer_load_dwordx4 v206, s[44:47], s49 offen lds
s_add_u32 s49, s49, s54
v_mfma_f32_32x32x16_bf16 a[32:47], v[24:27], v[176:179], a[32:47]
ds_read_b64_tr_b16 v[152:153], v200 offset:20480
ds_read_b64_tr_b16 v[154:155], v200 offset:22528
v_mfma_f32_32x32x16_bf16 a[96:111], v[28:31], v[176:179], a[96:111]
ds_read_b64_tr_b16 v[156:157], v201 offset:20480
ds_read_b64_tr_b16 v[158:159], v201 offset:22528
v_mfma_f32_32x32x16_bf16 a[48:63], v[24:27], v[180:183], a[48:63]
ds_read_b64_tr_b16 v[160:161], v202 offset:20480
ds_read_b64_tr_b16 v[162:163], v202 offset:22528
buffer_load_dwordx4 v[8:11], v204, s[40:43], s48 offen offset:0 sc1
v_mfma_f32_32x32x16_bf16 a[112:127], v[28:31], v[180:183], a[112:127]
ds_read_b64_tr_b16 v[164:165], v203 offset:20480
ds_read_b64_tr_b16 v[166:167], v203 offset:22528
v_mfma_f32_32x32x16_bf16 a[0:15], v[32:35], v[184:187], a[0:15]
buffer_load_dwordx4 v[12:15], v205, s[40:43], s48 offen offset:0 sc1
v_mfma_f32_32x32x16_bf16 a[64:79], v[36:39], v[184:187], a[64:79]
v_mfma_f32_32x32x16_bf16 a[16:31], v[32:35], v[188:191], a[16:31]
v_mfma_f32_32x32x16_bf16 a[80:95], v[36:39], v[188:191], a[80:95]
buffer_load_dwordx4 v[16:19], v204, s[40:43], s48 offen offset:1024 sc1
v_mfma_f32_32x32x16_bf16 a[32:47], v[32:35], v[192:195], a[32:47]
v_mfma_f32_32x32x16_bf16 a[96:111], v[36:39], v[192:195], a[96:111]
buffer_load_dwordx4 v[20:23], v205, s[40:43], s48 offen offset:1024 sc1
v_mfma_f32_32x32x16_bf16 a[48:63], v[32:35], v[196:199], a[48:63]
v_mfma_f32_32x32x16_bf16 a[112:127], v[36:39], v[196:199], a[112:127]
s_waitcnt lgkmcnt(8)
v_mfma_f32_32x32x16_bf16 a[0:15], v[40:43], v[136:139], a[0:15]
s_waitcnt vmcnt(24) lgkmcnt(0)
s_barrier
ds_read_b64_tr_b16 v[168:169], v200 offset:24576
ds_read_b64_tr_b16 v[170:171], v200 offset:26624
v_mfma_f32_32x32x16_bf16 a[64:79], v[44:47], v[136:139], a[64:79]
ds_read_b64_tr_b16 v[172:173], v201 offset:24576
ds_read_b64_tr_b16 v[174:175], v201 offset:26624
s_add_u32 m0, s56, 8192
s_nop 0
buffer_load_dwordx4 v206, s[44:47], s49 offen lds
s_add_u32 s49, s49, s54
v_mfma_f32_32x32x16_bf16 a[16:31], v[40:43], v[140:143], a[16:31]
ds_read_b64_tr_b16 v[176:177], v202 offset:24576
ds_read_b64_tr_b16 v[178:179], v202 offset:26624
v_mfma_f32_32x32x16_bf16 a[80:95], v[44:47], v[140:143], a[80:95]
ds_read_b64_tr_b16 v[180:181], v203 offset:24576
ds_read_b64_tr_b16 v[182:183], v203 offset:26624
s_add_u32 m0, s56, 12288
s_nop 0
buffer_load_dwordx4 v206, s[44:47], s49 offen lds
s_add_u32 s49, s49, s54
v_mfma_f32_32x32x16_bf16 a[32:47], v[40:43], v[144:147], a[32:47]
ds_read_b64_tr_b16 v[184:185], v200 offset:28672
ds_read_b64_tr_b16 v[186:187], v200 offset:30720
v_mfma_f32_32x32x16_bf16 a[96:111], v[44:47], v[144:147], a[96:111]
ds_read_b64_tr_b16 v[188:189], v201 offset:28672
ds_read_b64_tr_b16 v[190:191], v201 offset:30720
v_mfma_f32_32x32x16_bf16 a[48:63], v[40:43], v[148:151], a[48:63]
ds_read_b64_tr_b16 v[192:193], v202 offset:28672
ds_read_b64_tr_b16 v[194:195], v202 offset:30720
buffer_load_dwordx4 v[24:27], v204, s[40:43], s48 offen offset:2048 sc1
v_mfma_f32_32x32x16_bf16 a[112:127], v[44:47], v[148:151], a[112:127]
ds_read_b64_tr_b16 v[196:197], v203 offset:28672
ds_read_b64_tr_b16 v[198:199], v203 offset:30720
v_mfma_f32_32x32x16_bf16 a[0:15], v[48:51], v[152:155], a[0:15]
buffer_load_dwordx4 v[28:31], v205, s[40:43], s48 offen offset:2048 sc1
v_mfma_f32_32x32x16_bf16 a[64:79], v[52:55], v[152:155], a[64:79]
v_mfma_f32_32x32x16_bf16 a[16:31], v[48:51], v[156:159], a[16:31]
v_mfma_f32_32x32x16_bf16 a[80:95], v[52:55], v[156:159], a[80:95]
buffer_load_dwordx4 v[32:35], v204, s[40:43], s48 offen offset:3072 sc1
v_mfma_f32_32x32x16_bf16 a[32:47], v[48:51], v[160:163], a[32:47]
v_mfma_f32_32x32x16_bf16 a[96:111], v[52:55], v[160:163], a[96:111]
buffer_load_dwordx4 v[36:39], v205, s[40:43], s48 offen offset:3072 sc1
s_add_u32 s48, s48, 4096
v_mfma_f32_32x32x16_bf16 a[48:63], v[48:51], v[164:167], a[48:63]
v_mfma_f32_32x32x16_bf16 a[112:127], v[52:55], v[164:167], a[112:127]
s_waitcnt lgkmcnt(8)
v_mfma_f32_32x32x16_bf16 a[0:15], v[56:59], v[168:171], a[0:15]
s_waitcnt vmcnt(26) lgkmcnt(0)
s_barrier
ds_read_b64_tr_b16 v[136:137], v200 offset:32768
ds_read_b64_tr_b16 v[138:139], v200 offset:34816
v_mfma_f32_32x32x16_bf16 a[64:79], v[60:63], v[168:171], a[64:79]
ds_read_b64_tr_b16 v[140:141], v201 offset:32768
ds_read_b64_tr_b16 v[142:143], v201 offset:34816
s_add_u32 m0, s56, 16384
s_nop 0
buffer_load_dwordx4 v206, s[44:47], s49 offen lds
s_add_u32 s49, s49, s54
v_mfma_f32_32x32x16_bf16 a[16:31], v[56:59], v[172:175], a[16:31]
ds_read_b64_tr_b16 v[144:145], v202 offset:32768
ds_read_b64_tr_b16 v[146:147], v202 offset:34816
v_mfma_f32_32x32x16_bf16 a[80:95], v[60:63], v[172:175], a[80:95]
ds_read_b64_tr_b16 v[148:149], v203 offset:32768
ds_read_b64_tr_b16 v[150:151], v203 offset:34816
s_add_u32 m0, s56, 20480
s_nop 0
buffer_load_dwordx4 v206, s[44:47], s49 offen lds
s_add_u32 s49, s49, s54
v_mfma_f32_32x32x16_bf16 a[32:47], v[56:59], v[176:179], a[32:47]
ds_read_b64_tr_b16 v[152:153], v200 offset:36864
ds_read_b64_tr_b16 v[154:155], v200 offset:38912
v_mfma_f32_32x32x16_bf16 a[96:111], v[60:63], v[176:179], a[96:111]
ds_read_b64_tr_b16 v[156:157], v201 offset:36864
ds_read_b64_tr_b16 v[158:159], v201 offset:38912
v_mfma_f32_32x32x16_bf16 a[48:63], v[56:59], v[180:183], a[48:63]
ds_read_b64_tr_b16 v[160:161], v202 offset:36864
ds_read_b64_tr_b16 v[162:163], v202 offset:38912
buffer_load_dwordx4 v[40:43], v204, s[40:43], s48 offen offset:0 sc1
v_mfma_f32_32x32x16_bf16 a[112:127], v[60:63], v[180:183], a[112:127]
ds_read_b64_tr_b16 v[164:165], v203 offset:36864
ds_read_b64_tr_b16 v[166:167], v203 offset:38912
v_mfma_f32_32x32x16_bf16 a[0:15], v[64:67], v[184:187], a[0:15]
buffer_load_dwordx4 v[44:47], v205, s[40:43], s48 offen offset:0 sc1
v_mfma_f32_32x32x16_bf16 a[64:79], v[68:71], v[184:187], a[64:79]
v_mfma_f32_32x32x16_bf16 a[16:31], v[64:67], v[188:191], a[16:31]
v_mfma_f32_32x32x16_bf16 a[80:95], v[68:71], v[188:191], a[80:95]
buffer_load_dwordx4 v[48:51], v204, s[40:43], s48 offen offset:1024 sc1
v_mfma_f32_32x32x16_bf16 a[32:47], v[64:67], v[192:195], a[32:47]
v_mfma_f32_32x32x16_bf16 a[96:111], v[68:71], v[192:195], a[96:111]
buffer_load_dwordx4 v[52:55], v205, s[40:43], s48 offen offset:1024 sc1
v_mfma_f32_32x32x16_bf16 a[48:63], v[64:67], v[196:199], a[48:63]
v_mfma_f32_32x32x16_bf16 a[112:127], v[68:71], v[196:199], a[112:127]
s_waitcnt lgkmcnt(8)
v_mfma_f32_32x32x16_bf16 a[0:15], v[72:75], v[136:139], a[0:15]
s_waitcnt vmcnt(28) lgkmcnt(0)
s_barrier
ds_read_b64_tr_b16 v[168:169], v200 offset:40960
ds_read_b64_tr_b16 v[170:171], v200 offset:43008
v_mfma_f32_32x32x16_bf16 a[64:79], v[76:79], v[136:139], a[64:79]
ds_read_b64_tr_b16 v[172:173], v201 offset:40960
ds_read_b64_tr_b16 v[174:175], v201 offset:43008
s_add_u32 m0, s56, 24576
s_nop 0
buffer_load_dwordx4 v206, s[44:47], s49 offen lds
s_add_u32 s49, s49, s54
v_mfma_f32_32x32x16_bf16 a[16:31], v[72:75], v[140:143], a[16:31]
ds_read_b64_tr_b16 v[176:177], v202 offset:40960
ds_read_b64_tr_b16 v[178:179], v202 offset:43008
v_mfma_f32_32x32x16_bf16 a[80:95], v[76:79], v[140:143], a[80:95]
ds_read_b64_tr_b16 v[180:181], v203 offset:40960
ds_read_b64_tr_b16 v[182:183], v203 offset:43008
s_add_u32 m0, s56, 28672
s_nop 0
buffer_load_dwordx4 v206, s[44:47], s49 offen lds
s_add_u32 s49, s49, s54
v_mfma_f32_32x32x16_bf16 a[32:47], v[72:75], v[144:147], a[32:47]
ds_read_b64_tr_b16 v[184:185], v200 offset:45056
ds_read_b64_tr_b16 v[186:187], v200 offset:47104
v_mfma_f32_32x32x16_bf16 a[96:111], v[76:79], v[144:147], a[96:111]
ds_read_b64_tr_b16 v[188:189], v201 offset:45056
ds_read_b64_tr_b16 v[190:191], v201 offset:47104
v_mfma_f32_32x32x16_bf16 a[48:63], v[72:75], v[148:151], a[48:63]
ds_read_b64_tr_b16 v[192:193], v202 offset:45056
ds_read_b64_tr_b16 v[194:195], v202 offset:47104
buffer_load_dwordx4 v[56:59], v204, s[40:43], s48 offen offset:2048 sc1
v_mfma_f32_32x32x16_bf16 a[112:127], v[76:79], v[148:151], a[112:127]
ds_read_b64_tr_b16 v[196:197], v203 offset:45056
ds_read_b64_tr_b16 v[198:199], v203 offset:47104
v_mfma_f32_32x32x16_bf16 a[0:15], v[80:83], v[152:155], a[0:15]
buffer_load_dwordx4 v[60:63], v205, s[40:43], s48 offen offset:2048 sc1
v_mfma_f32_32x32x16_bf16 a[64:79], v[84:87], v[152:155], a[64:79]
v_mfma_f32_32x32x16_bf16 a[16:31], v[80:83], v[156:159], a[16:31]
v_mfma_f32_32x32x16_bf16 a[80:95], v[84:87], v[156:159], a[80:95]
buffer_load_dwordx4 v[64:67], v204, s[40:43], s48 offen offset:3072 sc1
v_mfma_f32_32x32x16_bf16 a[32:47], v[80:83], v[160:163], a[32:47]
v_mfma_f32_32x32x16_bf16 a[96:111], v[84:87], v[160:163], a[96:111]
buffer_load_dwordx4 v[68:71], v205, s[40:43], s48 offen offset:3072 sc1
s_add_u32 s48, s48, 4096
v_mfma_f32_32x32x16_bf16 a[48:63], v[80:83], v[164:167], a[48:63]
v_mfma_f32_32x32x16_bf16 a[112:127], v[84:87], v[164:167], a[112:127]
s_waitcnt lgkmcnt(8)
v_mfma_f32_32x32x16_bf16 a[0:15], v[88:91], v[168:171], a[0:15]
s_waitcnt vmcnt(30) lgkmcnt(0)
s_barrier
ds_read_b64_tr_b16 v[136:137], v200 offset:49152
ds_read_b64_tr_b16 v[138:139], v200 offset:51200
v_mfma_f32_32x32x16_bf16 a[64:79], v[92:95], v[168:171], a[64:79]
ds_read_b64_tr_b16 v[140:141], v201 offset:49152
ds_read_b64_tr_b16 v[142:143], v201 offset:51200
s_add_u32 m0, s56, 32768
s_nop 0
buffer_load_dwordx4 v206, s[44:47], s49 offen lds
s_add_u32 s49, s49, s54
v_mfma_f32_32x32x16_bf16 a[16:31], v[88:91], v[172:175], a[16:31]
ds_read_b64_tr_b16 v[144:145], v202 offset:49152
ds_read_b64_tr_b16 v[146:147], v202 offset:51200
v_mfma_f32_32x32x16_bf16 a[80:95], v[92:95], v[172:175], a[80:95]
ds_read_b64_tr_b16 v[148:149], v203 offset:49152
ds_read_b64_tr_b16 v[150:151], v203 offset:51200
s_add_u32 m0, s56, 36864
s_nop 0
buffer_load_dwordx4 v206, s[44:47], s49 offen lds
s_add_u32 s49, s49, s54
v_mfma_f32_32x32x16_bf16 a[32:47], v[88:91], v[176:179], a[32:47]
ds_read_b64_tr_b16 v[152:153], v200 offset:53248
ds_read_b64_tr_b16 v[154:155], v200 offset:55296
v_mfma_f32_32x32x16_bf16 a[96:111], v[92:95], v[176:179], a[96:111]
ds_read_b64_tr_b16 v[156:157], v201 offset:53248
ds_read_b64_tr_b16 v[158:159], v201 offset:55296
v_mfma_f32_32x32x16_bf16 a[48:63], v[88:91], v[180:183], a[48:63]
ds_read_b64_tr_b16 v[160:161], v202 offset:53248
ds_read_b64_tr_b16 v[162:163], v202 offset:55296
buffer_load_dwordx4 v[72:75], v204, s[40:43], s48 offen offset:0 sc1
v_mfma_f32_32x32x16_bf16 a[112:127], v[92:95], v[180:183], a[112:127]
ds_read_b64_tr_b16 v[164:165], v203 offset:53248
ds_read_b64_tr_b16 v[166:167], v203 offset:55296
v_mfma_f32_32x32x16_bf16 a[0:15], v[96:99], v[184:187], a[0:15]
buffer_load_dwordx4 v[76:79], v205, s[40:43], s48 offen offset:0 sc1
v_mfma_f32_32x32x16_bf16 a[64:79], v[100:103], v[184:187], a[64:79]
v_mfma_f32_32x32x16_bf16 a[16:31], v[96:99], v[188:191], a[16:31]
v_mfma_f32_32x32x16_bf16 a[80:95], v[100:103], v[188:191], a[80:95]
buffer_load_dwordx4 v[80:83], v204, s[40:43], s48 offen offset:1024 sc1
v_mfma_f32_32x32x16_bf16 a[32:47], v[96:99], v[192:195], a[32:47]
v_mfma_f32_32x32x16_bf16 a[96:111], v[100:103], v[192:195], a[96:111]
buffer_load_dwordx4 v[84:87], v205, s[40:43], s48 offen offset:1024 sc1
v_mfma_f32_32x32x16_bf16 a[48:63], v[96:99], v[196:199], a[48:63]
v_mfma_f32_32x32x16_bf16 a[112:127], v[100:103], v[196:199], a[112:127]
s_waitcnt lgkmcnt(8)
v_mfma_f32_32x32x16_bf16 a[0:15], v[104:107], v[136:139], a[0:15]
s_waitcnt vmcnt(30) lgkmcnt(0)
s_barrier
ds_read_b64_tr_b16 v[168:169], v200 offset:57344
ds_read_b64_tr_b16 v[170:171], v200 offset:59392
v_mfma_f32_32x32x16_bf16 a[64:79], v[108:111], v[136:139], a[64:79]
ds_read_b64_tr_b16 v[172:173], v201 offset:57344
ds_read_b64_tr_b16 v[174:175], v201 offset:59392
s_add_u32 m0, s56, 40960
s_nop 0
buffer_load_dwordx4 v206, s[44:47], s49 offen lds
s_add_u32 s49, s49, s54
v_mfma_f32_32x32x16_bf16 a[16:31], v[104:107], v[140:143], a[16:31]
ds_read_b64_tr_b16 v[176:177], v202 offset:57344
ds_read_b64_tr_b16 v[178:179], v202 offset:59392
v_mfma_f32_32x32x16_bf16 a[80:95], v[108:111], v[140:143], a[80:95]
ds_read_b64_tr_b16 v[180:181], v203 offset:57344
ds_read_b64_tr_b16 v[182:183], v203 offset:59392
s_add_u32 m0, s56, 45056
s_nop 0
buffer_load_dwordx4 v206, s[44:47], s49 offen lds
s_add_u32 s49, s49, s54
v_mfma_f32_32x32x16_bf16 a[32:47], v[104:107], v[144:147], a[32:47]
ds_read_b64_tr_b16 v[184:185], v200 offset:61440
ds_read_b64_tr_b16 v[186:187], v200 offset:63488
v_mfma_f32_32x32x16_bf16 a[96:111], v[108:111], v[144:147], a[96:111]
ds_read_b64_tr_b16 v[188:189], v201 offset:61440
ds_read_b64_tr_b16 v[190:191], v201 offset:63488
v_mfma_f32_32x32x16_bf16 a[48:63], v[104:107], v[148:151], a[48:63]
ds_read_b64_tr_b16 v[192:193], v202 offset:61440
ds_read_b64_tr_b16 v[194:195], v202 offset:63488
buffer_load_dwordx4 v[88:91], v204, s[40:43], s48 offen offset:2048 sc1
v_mfma_f32_32x32x16_bf16 a[112:127], v[108:111], v[148:151], a[112:127]
ds_read_b64_tr_b16 v[196:197], v203 offset:61440
ds_read_b64_tr_b16 v[198:199], v203 offset:63488
v_mfma_f32_32x32x16_bf16 a[0:15], v[112:115], v[152:155], a[0:15]
buffer_load_dwordx4 v[92:95], v205, s[40:43], s48 offen offset:2048 sc1
v_mfma_f32_32x32x16_bf16 a[64:79], v[116:119], v[152:155], a[64:79]
v_mfma_f32_32x32x16_bf16 a[16:31], v[112:115], v[156:159], a[16:31]
v_mfma_f32_32x32x16_bf16 a[80:95], v[116:119], v[156:159], a[80:95]
buffer_load_dwordx4 v[96:99], v204, s[40:43], s48 offen offset:3072 sc1
v_mfma_f32_32x32x16_bf16 a[32:47], v[112:115], v[160:163], a[32:47]
v_mfma_f32_32x32x16_bf16 a[96:111], v[116:119], v[160:163], a[96:111]
buffer_load_dwordx4 v[100:103], v205, s[40:43], s48 offen offset:3072 sc1
s_add_u32 s48, s48, 4096
v_mfma_f32_32x32x16_bf16 a[48:63], v[112:115], v[164:167], a[48:63]
v_mfma_f32_32x32x16_bf16 a[112:127], v[116:119], v[164:167], a[112:127]
s_waitcnt lgkmcnt(8)
v_mfma_f32_32x32x16_bf16 a[0:15], v[120:123], v[168:171], a[0:15]
s_waitcnt vmcnt(30) lgkmcnt(0)
s_barrier
ds_read_b64_tr_b16 v[136:137], v200 offset:0
ds_read_b64_tr_b16 v[138:139], v200 offset:2048
v_mfma_f32_32x32x16_bf16 a[64:79], v[124:127], v[168:171], a[64:79]
ds_read_b64_tr_b16 v[140:141], v201 offset:0
ds_read_b64_tr_b16 v[142:143], v201 offset:2048
s_add_u32 m0, s56, 49152
s_nop 0
buffer_load_dwordx4 v206, s[44:47], s49 offen lds
s_add_u32 s49, s49, s54
v_mfma_f32_32x32x16_bf16 a[16:31], v[120:123], v[172:175], a[16:31]
ds_read_b64_tr_b16 v[144:145], v202 offset:0
ds_read_b64_tr_b16 v[146:147], v202 offset:2048
v_mfma_f32_32x32x16_bf16 a[80:95], v[124:127], v[172:175], a[80:95]
ds_read_b64_tr_b16 v[148:149], v203 offset:0
ds_read_b64_tr_b16 v[150:151], v203 offset:2048
s_add_u32 m0, s56, 53248
s_nop 0
buffer_load_dwordx4 v206, s[44:47], s49 offen lds
s_add_u32 s49, s49, s54
v_mfma_f32_32x32x16_bf16 a[32:47], v[120:123], v[176:179], a[32:47]
ds_read_b64_tr_b16 v[152:153], v200 offset:4096
ds_read_b64_tr_b16 v[154:155], v200 offset:6144
v_mfma_f32_32x32x16_bf16 a[96:111], v[124:127], v[176:179], a[96:111]
ds_read_b64_tr_b16 v[156:157], v201 offset:4096
ds_read_b64_tr_b16 v[158:159], v201 offset:6144
v_mfma_f32_32x32x16_bf16 a[48:63], v[120:123], v[180:183], a[48:63]
ds_read_b64_tr_b16 v[160:161], v202 offset:4096
ds_read_b64_tr_b16 v[162:163], v202 offset:6144
buffer_load_dwordx4 v[104:107], v204, s[40:43], s48 offen offset:0 sc1
v_mfma_f32_32x32x16_bf16 a[112:127], v[124:127], v[180:183], a[112:127]
ds_read_b64_tr_b16 v[164:165], v203 offset:4096
ds_read_b64_tr_b16 v[166:167], v203 offset:6144
v_mfma_f32_32x32x16_bf16 a[0:15], v[128:131], v[184:187], a[0:15]
buffer_load_dwordx4 v[108:111], v205, s[40:43], s48 offen offset:0 sc1
v_mfma_f32_32x32x16_bf16 a[64:79], v[132:135], v[184:187], a[64:79]
v_mfma_f32_32x32x16_bf16 a[16:31], v[128:131], v[188:191], a[16:31]
v_mfma_f32_32x32x16_bf16 a[80:95], v[132:135], v[188:191], a[80:95]
buffer_load_dwordx4 v[112:115], v204, s[40:43], s48 offen offset:1024 sc1
v_mfma_f32_32x32x16_bf16 a[32:47], v[128:131], v[192:195], a[32:47]
v_mfma_f32_32x32x16_bf16 a[96:111], v[132:135], v[192:195], a[96:111]
buffer_load_dwordx4 v[116:119], v205, s[40:43], s48 offen offset:1024 sc1
v_mfma_f32_32x32x16_bf16 a[48:63], v[128:131], v[196:199], a[48:63]
v_mfma_f32_32x32x16_bf16 a[112:127], v[132:135], v[196:199], a[112:127]
s_sub_u32 s50, s50, 8
.LgD_331:
s_waitcnt lgkmcnt(8)
v_mfma_f32_32x32x16_bf16 a[0:15], v[8:11], v[136:139], a[0:15]
s_waitcnt vmcnt(30) lgkmcnt(0)
s_barrier
ds_read_b64_tr_b16 v[168:169], v200 offset:8192
ds_read_b64_tr_b16 v[170:171], v200 offset:10240
v_mfma_f32_32x32x16_bf16 a[64:79], v[12:15], v[136:139], a[64:79]
ds_read_b64_tr_b16 v[172:173], v201 offset:8192
ds_read_b64_tr_b16 v[174:175], v201 offset:10240
s_add_u32 m0, s56, 57344
s_nop 0
buffer_load_dwordx4 v206, s[44:47], s49 offen lds
s_add_u32 s49, s49, s54
v_mfma_f32_32x32x16_bf16 a[16:31], v[8:11], v[140:143], a[16:31]
ds_read_b64_tr_b16 v[176:177], v202 offset:8192
ds_read_b64_tr_b16 v[178:179], v202 offset:10240
v_mfma_f32_32x32x16_bf16 a[80:95], v[12:15], v[140:143], a[80:95]
ds_read_b64_tr_b16 v[180:181], v203 offset:8192
ds_read_b64_tr_b16 v[182:183], v203 offset:10240
s_add_u32 m0, s56, 61440
s_nop 0
buffer_load_dwordx4 v206, s[44:47], s49 offen lds
s_add_u32 s49, s49, s54
v_mfma_f32_32x32x16_bf16 a[32:47], v[8:11], v[144:147], a[32:47]
ds_read_b64_tr_b16 v[184:185], v200 offset:12288
ds_read_b64_tr_b16 v[186:187], v200 offset:14336
v_mfma_f32_32x32x16_bf16 a[96:111], v[12:15], v[144:147], a[96:111]
ds_read_b64_tr_b16 v[188:189], v201 offset:12288
ds_read_b64_tr_b16 v[190:191], v201 offset:14336
buffer_load_dwordx4 v[120:123], v204, s[40:43], s48 offen offset:2048 sc1
v_mfma_f32_32x32x16_bf16 a[48:63], v[8:11], v[148:151], a[48:63]
ds_read_b64_tr_b16 v[192:193], v202 offset:12288
ds_read_b64_tr_b16 v[194:195], v202 offset:14336
v_mfma_f32_32x32x16_bf16 a[112:127], v[12:15], v[148:151], a[112:127]
ds_read_b64_tr_b16 v[196:197], v203 offset:12288
ds_read_b64_tr_b16 v[198:199], v203 offset:14336
buffer_load_dwordx4 v[124:127], v205, s[40:43], s48 offen offset:2048 sc1
v_mfma_f32_32x32x16_bf16 a[0:15], v[16:19], v[152:155], a[0:15]
v_mfma_f32_32x32x16_bf16 a[64:79], v[20:23], v[152:155], a[64:79]
buffer_load_dwordx4 v[128:131], v204, s[40:43], s48 offen offset:3072 sc1
v_mfma_f32_32x32x16_bf16 a[16:31], v[16:19], v[156:159], a[16:31]
v_mfma_f32_32x32x16_bf16 a[80:95], v[20:23], v[156:159], a[80:95]
buffer_load_dwordx4 v[132:135], v205, s[40:43], s48 offen offset:3072 sc1
s_add_u32 s48, s48, 4096
v_mfma_f32_32x32x16_bf16 a[32:47], v[16:19], v[160:163], a[32:47]
v_mfma_f32_32x32x16_bf16 a[96:111], v[20:23], v[160:163], a[96:111]
s_cmp_eq_u32 s50, 8
s_cselect_b32 s42, 0, s42
s_cselect_b32 s46, 0, s46
v_mfma_f32_32x32x16_bf16 a[48:63], v[16:19], v[164:167], a[48:63]
v_mfma_f32_32x32x16_bf16 a[112:127], v[20:23], v[164:167], a[112:127]
s_waitcnt lgkmcnt(8)
v_mfma_f32_32x32x16_bf16 a[0:15], v[24:27], v[168:171], a[0:15]
s_waitcnt vmcnt(30) lgkmcnt(0)
s_barrier
ds_read_b64_tr_b16 v[136:137], v200 offset:16384
ds_read_b64_tr_b16 v[138:139], v200 offset:18432
v_mfma_f32_32x32x16_bf16 a[64:79], v[28:31], v[168:171], a[64:79]
ds_read_b64_tr_b16 v[140:141], v201 offset:16384
ds_read_b64_tr_b16 v[142:143], v201 offset:18432
s_add_u32 m0, s56, 0
s_nop 0
buffer_load_dwordx4 v206, s[44:47], s49 offen lds
s_add_u32 s49, s49, s54
v_mfma_f32_32x32x16_bf16 a[16:31], v[24:27], v[172:175], a[16:31]
ds_read_b64_tr_b16 v[144:145], v202 offset:16384
ds_read_b64_tr_b16 v[146:147], v202 offset:18432
v_mfma_f32_32x32x16_bf16 a[80:95], v[28:31], v[172:175], a[80:95]
ds_read_b64_tr_b16 v[148:149], v203 offset:16384
ds_read_b64_tr_b16 v[150:151], v203 offset:18432
s_add_u32 m0, s56, 4096
s_nop 0
buffer_load_dwordx4 v206, s[44:47], s49 offen lds
s_add_u32 s49, s49, s54
v_mfma_f32_32x32x16_bf16 a[32:47], v[24:27], v[176:179], a[32:47]
ds_read_b64_tr_b16 v[152:153], v200 offset:20480
ds_read_b64_tr_b16 v[154:155], v200 offset:22528
v_mfma_f32_32x32x16_bf16 a[96:111], v[28:31], v[176:179], a[96:111]
ds_read_b64_tr_b16 v[156:157], v201 offset:20480
ds_read_b64_tr_b16 v[158:159], v201 offset:22528
v_mfma_f32_32x32x16_bf16 a[48:63], v[24:27], v[180:183], a[48:63]
ds_read_b64_tr_b16 v[160:161], v202 offset:20480
ds_read_b64_tr_b16 v[162:163], v202 offset:22528
buffer_load_dwordx4 v[8:11], v204, s[40:43], s48 offen offset:0 sc1
v_mfma_f32_32x32x16_bf16 a[112:127], v[28:31], v[180:183], a[112:127]
ds_read_b64_tr_b16 v[164:165], v203 offset:20480
ds_read_b64_tr_b16 v[166:167], v203 offset:22528
v_mfma_f32_32x32x16_bf16 a[0:15], v[32:35], v[184:187], a[0:15]
buffer_load_dwordx4 v[12:15], v205, s[40:43], s48 offen offset:0 sc1
v_mfma_f32_32x32x16_bf16 a[64:79], v[36:39], v[184:187], a[64:79]
v_mfma_f32_32x32x16_bf16 a[16:31], v[32:35], v[188:191], a[16:31]
v_mfma_f32_32x32x16_bf16 a[80:95], v[36:39], v[188:191], a[80:95]
buffer_load_dwordx4 v[16:19], v204, s[40:43], s48 offen offset:1024 sc1
v_mfma_f32_32x32x16_bf16 a[32:47], v[32:35], v[192:195], a[32:47]
v_mfma_f32_32x32x16_bf16 a[96:111], v[36:39], v[192:195], a[96:111]
buffer_load_dwordx4 v[20:23], v205, s[40:43], s48 offen offset:1024 sc1
v_mfma_f32_32x32x16_bf16 a[48:63], v[32:35], v[196:199], a[48:63]
v_mfma_f32_32x32x16_bf16 a[112:127], v[36:39], v[196:199], a[112:127]
s_waitcnt lgkmcnt(8)
v_mfma_f32_32x32x16_bf16 a[0:15], v[40:43], v[136:139], a[0:15]
s_waitcnt vmcnt(30) lgkmcnt(0)
s_barrier
ds_read_b64_tr_b16 v[168:169], v200 offset:24576
ds_read_b64_tr_b16 v[170:171], v200 offset:26624
v_mfma_f32_32x32x16_bf16 a[64:79], v[44:47], v[136:139], a[64:79]
ds_read_b64_tr_b16 v[172:173], v201 offset:24576
ds_read_b64_tr_b16 v[174:175], v201 offset:26624
s_add_u32 m0, s56, 8192
s_nop 0
buffer_load_dwordx4 v206, s[44:47], s49 offen lds
s_add_u32 s49, s49, s54
v_mfma_f32_32x32x16_bf16 a[16:31], v[40:43], v[140:143], a[16:31]
ds_read_b64_tr_b16 v[176:177], v202 offset:24576
ds_read_b64_tr_b16 v[178:179], v202 offset:26624
v_mfma_f32_32x32x16_bf16 a[80:95], v[44:47], v[140:143], a[80:95]
ds_read_b64_tr_b16 v[180:181], v203 offset:24576
ds_read_b64_tr_b16 v[182:183], v203 offset:26624
s_add_u32 m0, s56, 12288
s_nop 0
buffer_load_dwordx4 v206, s[44:47], s49 offen lds
s_add_u32 s49, s49, s54
v_mfma_f32_32x32x16_bf16 a[32:47], v[40:43], v[144:147], a[32:47]
ds_read_b64_tr_b16 v[184:185], v200 offset:28672
ds_read_b64_tr_b16 v[186:187], v200 offset:30720
v_mfma_f32_32x32x16_bf16 a[96:111], v[44:47], v[144:147], a[96:111]
ds_read_b64_tr_b16 v[188:189], v201 offset:28672
ds_read_b64_tr_b16 v[190:191], v201 offset:30720
v_mfma_f32_32x32x16_bf16 a[48:63], v[40:43], v[148:151], a[48:63]
ds_read_b64_tr_b16 v[192:193], v202 offset:28672
ds_read_b64_tr_b16 v[194:195], v202 offset:30720
buffer_load_dwordx4 v[24:27], v204, s[40:43], s48 offen offset:2048 sc1
v_mfma_f32_32x32x16_bf16 a[112:127], v[44:47], v[148:151], a[112:127]
ds_read_b64_tr_b16 v[196:197], v203 offset:28672
ds_read_b64_tr_b16 v[198:199], v203 offset:30720
v_mfma_f32_32x32x16_bf16 a[0:15], v[48:51], v[152:155], a[0:15]
buffer_load_dwordx4 v[28:31], v205, s[40:43], s48 offen offset:2048 sc1
v_mfma_f32_32x32x16_bf16 a[64:79], v[52:55], v[152:155], a[64:79]
v_mfma_f32_32x32x16_bf16 a[16:31], v[48:51], v[156:159], a[16:31]
v_mfma_f32_32x32x16_bf16 a[80:95], v[52:55], v[156:159], a[80:95]
buffer_load_dwordx4 v[32:35], v204, s[40:43], s48 offen offset:3072 sc1
v_mfma_f32_32x32x16_bf16 a[32:47], v[48:51], v[160:163], a[32:47]
v_mfma_f32_32x32x16_bf16 a[96:111], v[52:55], v[160:163], a[96:111]
buffer_load_dwordx4 v[36:39], v205, s[40:43], s48 offen offset:3072 sc1
s_add_u32 s48, s48, 4096
v_mfma_f32_32x32x16_bf16 a[48:63], v[48:51], v[164:167], a[48:63]
v_mfma_f32_32x32x16_bf16 a[112:127], v[52:55], v[164:167], a[112:127]
s_waitcnt lgkmcnt(8)
v_mfma_f32_32x32x16_bf16 a[0:15], v[56:59], v[168:171], a[0:15]
s_waitcnt vmcnt(30) lgkmcnt(0)
s_barrier
ds_read_b64_tr_b16 v[136:137], v200 offset:32768
ds_read_b64_tr_b16 v[138:139], v200 offset:34816
v_mfma_f32_32x32x16_bf16 a[64:79], v[60:63], v[168:171], a[64:79]
ds_read_b64_tr_b16 v[140:141], v201 offset:32768
ds_read_b64_tr_b16 v[142:143], v201 offset:34816
s_add_u32 m0, s56, 16384
s_nop 0
buffer_load_dwordx4 v206, s[44:47], s49 offen lds
s_add_u32 s49, s49, s54
v_mfma_f32_32x32x16_bf16 a[16:31], v[56:59], v[172:175], a[16:31]
ds_read_b64_tr_b16 v[144:145], v202 offset:32768
ds_read_b64_tr_b16 v[146:147], v202 offset:34816
v_mfma_f32_32x32x16_bf16 a[80:95], v[60:63], v[172:175], a[80:95]
ds_read_b64_tr_b16 v[148:149], v203 offset:32768
ds_read_b64_tr_b16 v[150:151], v203 offset:34816
s_add_u32 m0, s56, 20480
s_nop 0
buffer_load_dwordx4 v206, s[44:47], s49 offen lds
s_add_u32 s49, s49, s54
v_mfma_f32_32x32x16_bf16 a[32:47], v[56:59], v[176:179], a[32:47]
ds_read_b64_tr_b16 v[152:153], v200 offset:36864
ds_read_b64_tr_b16 v[154:155], v200 offset:38912
v_mfma_f32_32x32x16_bf16 a[96:111], v[60:63], v[176:179], a[96:111]
ds_read_b64_tr_b16 v[156:157], v201 offset:36864
ds_read_b64_tr_b16 v[158:159], v201 offset:38912
v_mfma_f32_32x32x16_bf16 a[48:63], v[56:59], v[180:183], a[48:63]
ds_read_b64_tr_b16 v[160:161], v202 offset:36864
ds_read_b64_tr_b16 v[162:163], v202 offset:38912
buffer_load_dwordx4 v[40:43], v204, s[40:43], s48 offen offset:0 sc1
v_mfma_f32_32x32x16_bf16 a[112:127], v[60:63], v[180:183], a[112:127]
ds_read_b64_tr_b16 v[164:165], v203 offset:36864
ds_read_b64_tr_b16 v[166:167], v203 offset:38912
v_mfma_f32_32x32x16_bf16 a[0:15], v[64:67], v[184:187], a[0:15]
buffer_load_dwordx4 v[44:47], v205, s[40:43], s48 offen offset:0 sc1
v_mfma_f32_32x32x16_bf16 a[64:79], v[68:71], v[184:187], a[64:79]
v_mfma_f32_32x32x16_bf16 a[16:31], v[64:67], v[188:191], a[16:31]
v_mfma_f32_32x32x16_bf16 a[80:95], v[68:71], v[188:191], a[80:95]
buffer_load_dwordx4 v[48:51], v204, s[40:43], s48 offen offset:1024 sc1
v_mfma_f32_32x32x16_bf16 a[32:47], v[64:67], v[192:195], a[32:47]
v_mfma_f32_32x32x16_bf16 a[96:111], v[68:71], v[192:195], a[96:111]
buffer_load_dwordx4 v[52:55], v205, s[40:43], s48 offen offset:1024 sc1
v_mfma_f32_32x32x16_bf16 a[48:63], v[64:67], v[196:199], a[48:63]
v_mfma_f32_32x32x16_bf16 a[112:127], v[68:71], v[196:199], a[112:127]
s_waitcnt lgkmcnt(8)
v_mfma_f32_32x32x16_bf16 a[0:15], v[72:75], v[136:139], a[0:15]
s_waitcnt vmcnt(30) lgkmcnt(0)
s_barrier
ds_read_b64_tr_b16 v[168:169], v200 offset:40960
ds_read_b64_tr_b16 v[170:171], v200 offset:43008
v_mfma_f32_32x32x16_bf16 a[64:79], v[76:79], v[136:139], a[64:79]
ds_read_b64_tr_b16 v[172:173], v201 offset:40960
ds_read_b64_tr_b16 v[174:175], v201 offset:43008
s_add_u32 m0, s56, 24576
s_nop 0
buffer_load_dwordx4 v206, s[44:47], s49 offen lds
s_add_u32 s49, s49, s54
v_mfma_f32_32x32x16_bf16 a[16:31], v[72:75], v[140:143], a[16:31]
ds_read_b64_tr_b16 v[176:177], v202 offset:40960
ds_read_b64_tr_b16 v[178:179], v202 offset:43008
v_mfma_f32_32x32x16_bf16 a[80:95], v[76:79], v[140:143], a[80:95]
ds_read_b64_tr_b16 v[180:181], v203 offset:40960
ds_read_b64_tr_b16 v[182:183], v203 offset:43008
s_add_u32 m0, s56, 28672
s_nop 0
buffer_load_dwordx4 v206, s[44:47], s49 offen lds
s_add_u32 s49, s49, s54
v_mfma_f32_32x32x16_bf16 a[32:47], v[72:75], v[144:147], a[32:47]
ds_read_b64_tr_b16 v[184:185], v200 offset:45056
ds_read_b64_tr_b16 v[186:187], v200 offset:47104
v_mfma_f32_32x32x16_bf16 a[96:111], v[76:79], v[144:147], a[96:111]
ds_read_b64_tr_b16 v[188:189], v201 offset:45056
ds_read_b64_tr_b16 v[190:191], v201 offset:47104
v_mfma_f32_32x32x16_bf16 a[48:63], v[72:75], v[148:151], a[48:63]
ds_read_b64_tr_b16 v[192:193], v202 offset:45056
ds_read_b64_tr_b16 v[194:195], v202 offset:47104
buffer_load_dwordx4 v[56:59], v204, s[40:43], s48 offen offset:2048 sc1
v_mfma_f32_32x32x16_bf16 a[112:127], v[76:79], v[148:151], a[112:127]
ds_read_b64_tr_b16 v[196:197], v203 offset:45056
ds_read_b64_tr_b16 v[198:199], v203 offset:47104
v_mfma_f32_32x32x16_bf16 a[0:15], v[80:83], v[152:155], a[0:15]
buffer_load_dwordx4 v[60:63], v205, s[40:43], s48 offen offset:2048 sc1
v_mfma_f32_32x32x16_bf16 a[64:79], v[84:87], v[152:155], a[64:79]
v_mfma_f32_32x32x16_bf16 a[16:31], v[80:83], v[156:159], a[16:31]
v_mfma_f32_32x32x16_bf16 a[80:95], v[84:87], v[156:159], a[80:95]
buffer_load_dwordx4 v[64:67], v204, s[40:43], s48 offen offset:3072 sc1
v_mfma_f32_32x32x16_bf16 a[32:47], v[80:83], v[160:163], a[32:47]
v_mfma_f32_32x32x16_bf16 a[96:111], v[84:87], v[160:163], a[96:111]
buffer_load_dwordx4 v[68:71], v205, s[40:43], s48 offen offset:3072 sc1
s_add_u32 s48, s48, 4096
v_mfma_f32_32x32x16_bf16 a[48:63], v[80:83], v[164:167], a[48:63]
v_mfma_f32_32x32x16_bf16 a[112:127], v[84:87], v[164:167], a[112:127]
s_waitcnt lgkmcnt(8)
v_mfma_f32_32x32x16_bf16 a[0:15], v[88:91], v[168:171], a[0:15]
s_waitcnt vmcnt(30) lgkmcnt(0)
s_barrier
ds_read_b64_tr_b16 v[136:137], v200 offset:49152
ds_read_b64_tr_b16 v[138:139], v200 offset:51200
v_mfma_f32_32x32x16_bf16 a[64:79], v[92:95], v[168:171], a[64:79]
ds_read_b64_tr_b16 v[140:141], v201 offset:49152
ds_read_b64_tr_b16 v[142:143], v201 offset:51200
s_add_u32 m0, s56, 32768
s_nop 0
buffer_load_dwordx4 v206, s[44:47], s49 offen lds
s_add_u32 s49, s49, s54
v_mfma_f32_32x32x16_bf16 a[16:31], v[88:91], v[172:175], a[16:31]
ds_read_b64_tr_b16 v[144:145], v202 offset:49152
ds_read_b64_tr_b16 v[146:147], v202 offset:51200
v_mfma_f32_32x32x16_bf16 a[80:95], v[92:95], v[172:175], a[80:95]
ds_read_b64_tr_b16 v[148:149], v203 offset:49152
ds_read_b64_tr_b16 v[150:151], v203 offset:51200
s_add_u32 m0, s56, 36864
s_nop 0
buffer_load_dwordx4 v206, s[44:47], s49 offen lds
s_add_u32 s49, s49, s54
v_mfma_f32_32x32x16_bf16 a[32:47], v[88:91], v[176:179], a[32:47]
ds_read_b64_tr_b16 v[152:153], v200 offset:53248
ds_read_b64_tr_b16 v[154:155], v200 offset:55296
v_mfma_f32_32x32x16_bf16 a[96:111], v[92:95], v[176:179], a[96:111]
ds_read_b64_tr_b16 v[156:157], v201 offset:53248
ds_read_b64_tr_b16 v[158:159], v201 offset:55296
v_mfma_f32_32x32x16_bf16 a[48:63], v[88:91], v[180:183], a[48:63]
ds_read_b64_tr_b16 v[160:161], v202 offset:53248
ds_read_b64_tr_b16 v[162:163], v202 offset:55296
buffer_load_dwordx4 v[72:75], v204, s[40:43], s48 offen offset:0 sc1
v_mfma_f32_32x32x16_bf16 a[112:127], v[92:95], v[180:183], a[112:127]
ds_read_b64_tr_b16 v[164:165], v203 offset:53248
ds_read_b64_tr_b16 v[166:167], v203 offset:55296
v_mfma_f32_32x32x16_bf16 a[0:15], v[96:99], v[184:187], a[0:15]
buffer_load_dwordx4 v[76:79], v205, s[40:43], s48 offen offset:0 sc1
v_mfma_f32_32x32x16_bf16 a[64:79], v[100:103], v[184:187], a[64:79]
v_mfma_f32_32x32x16_bf16 a[16:31], v[96:99], v[188:191], a[16:31]
v_mfma_f32_32x32x16_bf16 a[80:95], v[100:103], v[188:191], a[80:95]
buffer_load_dwordx4 v[80:83], v204, s[40:43], s48 offen offset:1024 sc1
v_mfma_f32_32x32x16_bf16 a[32:47], v[96:99], v[192:195], a[32:47]
v_mfma_f32_32x32x16_bf16 a[96:111], v[100:103], v[192:195], a[96:111]
buffer_load_dwordx4 v[84:87], v205, s[40:43], s48 offen offset:1024 sc1
v_mfma_f32_32x32x16_bf16 a[48:63], v[96:99], v[196:199], a[48:63]
v_mfma_f32_32x32x16_bf16 a[112:127], v[100:103], v[196:199], a[112:127]
s_waitcnt lgkmcnt(8)
v_mfma_f32_32x32x16_bf16 a[0:15], v[104:107], v[136:139], a[0:15]
s_waitcnt vmcnt(30) lgkmcnt(0)
s_barrier
ds_read_b64_tr_b16 v[168:169], v200 offset:57344
ds_read_b64_tr_b16 v[170:171], v200 offset:59392
v_mfma_f32_32x32x16_bf16 a[64:79], v[108:111], v[136:139], a[64:79]
ds_read_b64_tr_b16 v[172:173], v201 offset:57344
ds_read_b64_tr_b16 v[174:175], v201 offset:59392
s_add_u32 m0, s56, 40960
s_nop 0
buffer_load_dwordx4 v206, s[44:47], s49 offen lds
s_add_u32 s49, s49, s54
v_mfma_f32_32x32x16_bf16 a[16:31], v[104:107], v[140:143], a[16:31]
ds_read_b64_tr_b16 v[176:177], v202 offset:57344
ds_read_b64_tr_b16 v[178:179], v202 offset:59392
v_mfma_f32_32x32x16_bf16 a[80:95], v[108:111], v[140:143], a[80:95]
ds_read_b64_tr_b16 v[180:181], v203 offset:57344
ds_read_b64_tr_b16 v[182:183], v203 offset:59392
s_add_u32 m0, s56, 45056
s_nop 0
buffer_load_dwordx4 v206, s[44:47], s49 offen lds
s_add_u32 s49, s49, s54
v_mfma_f32_32x32x16_bf16 a[32:47], v[104:107], v[144:147], a[32:47]
ds_read_b64_tr_b16 v[184:185], v200 offset:61440
ds_read_b64_tr_b16 v[186:187], v200 offset:63488
v_mfma_f32_32x32x16_bf16 a[96:111], v[108:111], v[144:147], a[96:111]
ds_read_b64_tr_b16 v[188:189], v201 offset:61440
ds_read_b64_tr_b16 v[190:191], v201 offset:63488
v_mfma_f32_32x32x16_bf16 a[48:63], v[104:107], v[148:151], a[48:63]
ds_read_b64_tr_b16 v[192:193], v202 offset:61440
ds_read_b64_tr_b16 v[194:195], v202 offset:63488
buffer_load_dwordx4 v[88:91], v204, s[40:43], s48 offen offset:2048 sc1
v_mfma_f32_32x32x16_bf16 a[112:127], v[108:111], v[148:151], a[112:127]
ds_read_b64_tr_b16 v[196:197], v203 offset:61440
ds_read_b64_tr_b16 v[198:199], v203 offset:63488
v_mfma_f32_32x32x16_bf16 a[0:15], v[112:115], v[152:155], a[0:15]
buffer_load_dwordx4 v[92:95], v205, s[40:43], s48 offen offset:2048 sc1
v_mfma_f32_32x32x16_bf16 a[64:79], v[116:119], v[152:155], a[64:79]
v_mfma_f32_32x32x16_bf16 a[16:31], v[112:115], v[156:159], a[16:31]
v_mfma_f32_32x32x16_bf16 a[80:95], v[116:119], v[156:159], a[80:95]
buffer_load_dwordx4 v[96:99], v204, s[40:43], s48 offen offset:3072 sc1
v_mfma_f32_32x32x16_bf16 a[32:47], v[112:115], v[160:163], a[32:47]
v_mfma_f32_32x32x16_bf16 a[96:111], v[116:119], v[160:163], a[96:111]
buffer_load_dwordx4 v[100:103], v205, s[40:43], s48 offen offset:3072 sc1
s_add_u32 s48, s48, 4096
v_mfma_f32_32x32x16_bf16 a[48:63], v[112:115], v[164:167], a[48:63]
v_mfma_f32_32x32x16_bf16 a[112:127], v[116:119], v[164:167], a[112:127]
s_waitcnt lgkmcnt(8)
v_mfma_f32_32x32x16_bf16 a[0:15], v[120:123], v[168:171], a[0:15]
s_waitcnt vmcnt(30) lgkmcnt(0)
s_barrier
ds_read_b64_tr_b16 v[136:137], v200 offset:0
ds_read_b64_tr_b16 v[138:139], v200 offset:2048
v_mfma_f32_32x32x16_bf16 a[64:79], v[124:127], v[168:171], a[64:79]
ds_read_b64_tr_b16 v[140:141], v201 offset:0
ds_read_b64_tr_b16 v[142:143], v201 offset:2048
s_add_u32 m0, s56, 49152
s_nop 0
buffer_load_dwordx4 v206, s[44:47], s49 offen lds
s_add_u32 s49, s49, s54
v_mfma_f32_32x32x16_bf16 a[16:31], v[120:123], v[172:175], a[16:31]
ds_read_b64_tr_b16 v[144:145], v202 offset:0
ds_read_b64_tr_b16 v[146:147], v202 offset:2048
v_mfma_f32_32x32x16_bf16 a[80:95], v[124:127], v[172:175], a[80:95]
ds_read_b64_tr_b16 v[148:149], v203 offset:0
ds_read_b64_tr_b16 v[150:151], v203 offset:2048
s_add_u32 m0, s56, 53248
s_nop 0
buffer_load_dwordx4 v206, s[44:47], s49 offen lds
s_add_u32 s49, s49, s54
v_mfma_f32_32x32x16_bf16 a[32:47], v[120:123], v[176:179], a[32:47]
ds_read_b64_tr_b16 v[152:153], v200 offset:4096
ds_read_b64_tr_b16 v[154:155], v200 offset:6144
v_mfma_f32_32x32x16_bf16 a[96:111], v[124:127], v[176:179], a[96:111]
ds_read_b64_tr_b16 v[156:157], v201 offset:4096
ds_read_b64_tr_b16 v[158:159], v201 offset:6144
v_mfma_f32_32x32x16_bf16 a[48:63], v[120:123], v[180:183], a[48:63]
ds_read_b64_tr_b16 v[160:161], v202 offset:4096
ds_read_b64_tr_b16 v[162:163], v202 offset:6144
buffer_load_dwordx4 v[104:107], v204, s[40:43], s48 offen offset:0 sc1
v_mfma_f32_32x32x16_bf16 a[112:127], v[124:127], v[180:183], a[112:127]
ds_read_b64_tr_b16 v[164:165], v203 offset:4096
ds_read_b64_tr_b16 v[166:167], v203 offset:6144
v_mfma_f32_32x32x16_bf16 a[0:15], v[128:131], v[184:187], a[0:15]
buffer_load_dwordx4 v[108:111], v205, s[40:43], s48 offen offset:0 sc1
v_mfma_f32_32x32x16_bf16 a[64:79], v[132:135], v[184:187], a[64:79]
v_mfma_f32_32x32x16_bf16 a[16:31], v[128:131], v[188:191], a[16:31]
v_mfma_f32_32x32x16_bf16 a[80:95], v[132:135], v[188:191], a[80:95]
buffer_load_dwordx4 v[112:115], v204, s[40:43], s48 offen offset:1024 sc1
v_mfma_f32_32x32x16_bf16 a[32:47], v[128:131], v[192:195], a[32:47]
v_mfma_f32_32x32x16_bf16 a[96:111], v[132:135], v[192:195], a[96:111]
buffer_load_dwordx4 v[116:119], v205, s[40:43], s48 offen offset:1024 sc1
v_mfma_f32_32x32x16_bf16 a[48:63], v[128:131], v[196:199], a[48:63]
v_mfma_f32_32x32x16_bf16 a[112:127], v[132:135], v[196:199], a[112:127]
s_sub_u32 s50, s50, 8
s_cmp_gt_u32 s50, 0
s_cbranch_scc1 .LgD_331
s_waitcnt vmcnt(0) lgkmcnt(0)
s_nop 15
.Lepi_328:
s_lshl_b32 s12, s83, 24
s_add_u32 s12, s12, 16777216
s_add_u32 s36, s4, s12
s_addc_u32 s37, s5, 0
s_mov_b32 s38, 16777216
s_mov_b32 s39, 0x00020000
s_lshr_b32 s12, s3, 0
s_mul_i32 s12, s12, 2
s_lshl_b32 s13, s84, 3
s_add_u32 s12, s12, s13
s_lshl_b32 s12, s12, 18
s_and_b32 s13, s3, 0
s_mul_i32 s13, s13, 8
s_mul_i32 s14, s85, 8
s_add_u32 s13, s13, s14
s_lshl_b32 s13, s13, 10
s_add_u32 s12, s12, s13
v_lshlrev_b32 v2, 4, v0
s_lshl_b32 s86, s84, 7
s_add_u32 s86, s86, 10240
s_cmp_eq_u32 s79, 4
s_cbranch_scc1 .Le4_316
s_lshl_b32 s86, s84, 2
s_add_u32 s86, s86, s76
s_lshl_b32 s86, s86, 7
s_add_u32 s86, s86, 2048
s_lshr_b32 s81, s77, 3
s_add_u32 s84, s81, 3
s_bfe_u32 s83, s77, 0x10002
s_add_u32 s83, s83, 1
s_and_b32 s85, s77, 3
s_lshl_b32 s81, s76, 2
s_add_u32 s85, s85, s81
s_barrier
s_lshl_b32 s13, s83, 3
s_add_u32 s13, s13, 16
s_load_dwordx2 s[6:7], s[0:1], s13
s_load_dwordx2 s[20:21], s[0:1], 64
s_mov_b32 s22, 7340032
s_mov_b32 s23, 0x00020000
v_lshlrev_b32 v5, 4, v0
s_lshl_b32 s24, s76, 5
s_add_u32 s24, s24, s77
s_lshl_b32 s24, s24, 2
s_add_u32 s24, s24, s3
s_mul_i32 s24, s24, 14336
s_add_u32 s25, s24, 14336
s_add_u32 s40, s4, 0x0
s_addc_u32 s41, s5, 0
s_mov_b32 s42, 0x400000
s_mov_b32 s43, 0x00020000
s_lshr_b32 s53, s3, 1
s_mul_i32 s53, s53, 8192
v_lshlrev_b32 v72, 4, v0
v_add_u32 v72, s53, v72
v_lshrrev_b32 v84, 2, v0
v_and_b32 v84, 3, v84
v_lshrrev_b32 v85, 5, v0
v_lshlrev_b32 v85, 2, v85
v_add_u32 v85, v85, v84
v_mul_u32_u24 v85, 512, v85
v_and_b32 v86, 3, v0
v_lshlrev_b32 v86, 3, v86
v_add_u32 v85, v85, v86
v_and_b32 v86, 16, v0
v_lshlrev_b32 v86, 1, v86
v_add_u32 v85, v85, v86
v_add_u32 v85, 16384, v85
s_and_b32 s53, s3, 1
s_mul_i32 s53, s53, 4
s_add_u32 s57, s53, 0
v_xor_b32 v86, s57, v84
v_lshlrev_b32 v86, 6, v86
v_add_u32 v73, v85, v86
s_add_u32 s57, s53, 1
v_xor_b32 v86, s57, v84
v_lshlrev_b32 v86, 6, v86
v_add_u32 v74, v85, v86
s_add_u32 s57, s53, 2
v_xor_b32 v86, s57, v84
v_lshlrev_b32 v86, 6, v86
v_add_u32 v75, v85, v86
s_add_u32 s57, s53, 3
v_xor_b32 v86, s57, v84
v_lshlrev_b32 v86, 6, v86
v_add_u32 v76, v85, v86
s_mul_i32 s53, s3, 131072
v_lshlrev_b32 v82, 4, v0
v_add_u32 v82, s53, v82
v_lshrrev_b32 v84, 5, v0
s_mul_i32 s53, s3, 2
v_add_u32 v84, s53, v84
v_and_b32 v85, 3, v84
v_and_b32 v86, 31, v0
v_lshrrev_b32 v86, 2, v86
v_xor_b32 v85, v85, v86
v_lshlrev_b32 v85, 6, v85
v_and_b32 v86, 3, v0
v_lshlrev_b32 v86, 4, v86
v_add_u32 v85, v85, v86
s_mov_b32 s53, 8192
v_mul_lo_u32 v84, v84, s53
v_add_u32 v83, v84, v85
s_mov_b32 s54, 65536
s_mov_b32 s55, 262144
s_mul_i32 s56, s3, 4096
s_waitcnt lgkmcnt(0)
s_mov_b32 s44, s6
s_mov_b32 s45, s7
s_mov_b32 s46, 0x800000
s_mov_b32 s47, 0x00020000
s_mul_i32 s48, s84, 524288
s_mul_i32 s49, s85, 512
s_mov_b32 s50, 32
s_mov_b32 s52, 0
s_mov_b32 s58, s50
s_add_u32 s57, s12, 0
v_accvgpr_read_b32 v8, a0
v_accvgpr_read_b32 v9, a1
v_accvgpr_read_b32 v10, a2
v_accvgpr_read_b32 v11, a3
v_accvgpr_read_b32 v12, a4
v_accvgpr_read_b32 v13, a5
v_accvgpr_read_b32 v14, a6
v_accvgpr_read_b32 v15, a7
v_cvt_pk_bf16_f32 v16, v8, v9
v_cvt_pk_bf16_f32 v17, v10, v11
v_cvt_pk_bf16_f32 v18, v12, v13
v_cvt_pk_bf16_f32 v19, v14, v15
buffer_store_dwordx4 v[16:19], v2, s[36:39], s57 offen offset:0 sc1
v_accvgpr_read_b32 v20, a8
v_accvgpr_read_b32 v21, a9
v_accvgpr_read_b32 v22, a10
v_accvgpr_read_b32 v23, a11
v_accvgpr_read_b32 v24, a12
v_accvgpr_read_b32 v25, a13
v_accvgpr_read_b32 v26, a14
v_accvgpr_read_b32 v27, a15
v_cvt_pk_bf16_f32 v28, v20, v21
v_cvt_pk_bf16_f32 v29, v22, v23
v_cvt_pk_bf16_f32 v30, v24, v25
v_cvt_pk_bf16_f32 v31, v26, v27
buffer_store_dwordx4 v[28:31], v2, s[36:39], s57 offen offset:1024 sc1
v_accvgpr_read_b32 v8, a16
v_accvgpr_read_b32 v9, a17
v_accvgpr_read_b32 v10, a18
v_accvgpr_read_b32 v11, a19
v_accvgpr_read_b32 v12, a20
v_accvgpr_read_b32 v13, a21
v_accvgpr_read_b32 v14, a22
v_accvgpr_read_b32 v15, a23
v_cvt_pk_bf16_f32 v16, v8, v9
v_cvt_pk_bf16_f32 v17, v10, v11
v_cvt_pk_bf16_f32 v18, v12, v13
v_cvt_pk_bf16_f32 v19, v14, v15
buffer_store_dwordx4 v[16:19], v2, s[36:39], s57 offen offset:2048 sc1
v_accvgpr_read_b32 v20, a24
v_accvgpr_read_b32 v21, a25
v_accvgpr_read_b32 v22, a26
v_accvgpr_read_b32 v23, a27
v_accvgpr_read_b32 v24, a28
v_accvgpr_read_b32 v25, a29
v_accvgpr_read_b32 v26, a30
v_accvgpr_read_b32 v27, a31
v_cvt_pk_bf16_f32 v28, v20, v21
v_cvt_pk_bf16_f32 v29, v22, v23
v_cvt_pk_bf16_f32 v30, v24, v25
v_cvt_pk_bf16_f32 v31, v26, v27
buffer_store_dwordx4 v[28:31], v2, s[36:39], s57 offen offset:3072 sc1
v_accvgpr_read_b32 v8, a32
v_accvgpr_read_b32 v9, a33
v_accvgpr_read_b32 v10, a34
v_accvgpr_read_b32 v11, a35
v_accvgpr_read_b32 v12, a36
v_accvgpr_read_b32 v13, a37
v_accvgpr_read_b32 v14, a38
v_accvgpr_read_b32 v15, a39
v_cvt_pk_bf16_f32 v16, v8, v9
v_cvt_pk_bf16_f32 v17, v10, v11
v_cvt_pk_bf16_f32 v18, v12, v13
v_cvt_pk_bf16_f32 v19, v14, v15
s_add_u32 s57, s57, 4096
buffer_store_dwordx4 v[16:19], v2, s[36:39], s57 offen offset:0 sc1
v_accvgpr_read_b32 v20, a40
v_accvgpr_read_b32 v21, a41
v_accvgpr_read_b32 v22, a42
v_accvgpr_read_b32 v23, a43
v_accvgpr_read_b32 v24, a44
v_accvgpr_read_b32 v25, a45
v_accvgpr_read_b32 v26, a46
v_accvgpr_read_b32 v27, a47
v_cvt_pk_bf16_f32 v28, v20, v21
v_cvt_pk_bf16_f32 v29, v22, v23
v_cvt_pk_bf16_f32 v30, v24, v25
v_cvt_pk_bf16_f32 v31, v26, v27
buffer_store_dwordx4 v[28:31], v2, s[36:39], s57 offen offset:1024 sc1
v_accvgpr_read_b32 v8, a48
v_accvgpr_read_b32 v9, a49
v_accvgpr_read_b32 v10, a50
v_accvgpr_read_b32 v11, a51
v_accvgpr_read_b32 v12, a52
v_accvgpr_read_b32 v13, a53
v_accvgpr_read_b32 v14, a54
v_accvgpr_read_b32 v15, a55
v_cvt_pk_bf16_f32 v16, v8, v9
v_cvt_pk_bf16_f32 v17, v10, v11
v_cvt_pk_bf16_f32 v18, v12, v13
v_cvt_pk_bf16_f32 v19, v14, v15
buffer_store_dwordx4 v[16:19], v2, s[36:39], s57 offen offset:2048 sc1
v_accvgpr_read_b32 v20, a56
v_accvgpr_read_b32 v21, a57
v_accvgpr_read_b32 v22, a58
v_accvgpr_read_b32 v23, a59
v_accvgpr_read_b32 v24, a60
v_accvgpr_read_b32 v25, a61
v_accvgpr_read_b32 v26, a62
v_accvgpr_read_b32 v27, a63
v_cvt_pk_bf16_f32 v28, v20, v21
v_cvt_pk_bf16_f32 v29, v22, v23
v_cvt_pk_bf16_f32 v30, v24, v25
v_cvt_pk_bf16_f32 v31, v26, v27
buffer_store_dwordx4 v[28:31], v2, s[36:39], s57 offen offset:3072 sc1
s_add_u32 s57, s12, 262144
v_accvgpr_read_b32 v8, a64
v_accvgpr_read_b32 v9, a65
v_accvgpr_read_b32 v10, a66
v_accvgpr_read_b32 v11, a67
v_accvgpr_read_b32 v12, a68
v_accvgpr_read_b32 v13, a69
v_accvgpr_read_b32 v14, a70
v_accvgpr_read_b32 v15, a71
v_cvt_pk_bf16_f32 v16, v8, v9
v_cvt_pk_bf16_f32 v17, v10, v11
v_cvt_pk_bf16_f32 v18, v12, v13
v_cvt_pk_bf16_f32 v19, v14, v15
buffer_store_dwordx4 v[16:19], v2, s[36:39], s57 offen offset:0 sc1
v_accvgpr_read_b32 v20, a72
v_accvgpr_read_b32 v21, a73
v_accvgpr_read_b32 v22, a74
v_accvgpr_read_b32 v23, a75
v_accvgpr_read_b32 v24, a76
v_accvgpr_read_b32 v25, a77
v_accvgpr_read_b32 v26, a78
v_accvgpr_read_b32 v27, a79
v_cvt_pk_bf16_f32 v28, v20, v21
v_cvt_pk_bf16_f32 v29, v22, v23
v_cvt_pk_bf16_f32 v30, v24, v25
v_cvt_pk_bf16_f32 v31, v26, v27
buffer_store_dwordx4 v[28:31], v2, s[36:39], s57 offen offset:1024 sc1
v_accvgpr_read_b32 v8, a80
v_accvgpr_read_b32 v9, a81
v_accvgpr_read_b32 v10, a82
v_accvgpr_read_b32 v11, a83
v_accvgpr_read_b32 v12, a84
v_accvgpr_read_b32 v13, a85
v_accvgpr_read_b32 v14, a86
v_accvgpr_read_b32 v15, a87
v_cvt_pk_bf16_f32 v16, v8, v9
v_cvt_pk_bf16_f32 v17, v10, v11
v_cvt_pk_bf16_f32 v18, v12, v13
v_cvt_pk_bf16_f32 v19, v14, v15
buffer_store_dwordx4 v[16:19], v2, s[36:39], s57 offen offset:2048 sc1
v_accvgpr_read_b32 v20, a88
v_accvgpr_read_b32 v21, a89
v_accvgpr_read_b32 v22, a90
v_accvgpr_read_b32 v23, a91
v_accvgpr_read_b32 v24, a92
v_accvgpr_read_b32 v25, a93
v_accvgpr_read_b32 v26, a94
v_accvgpr_read_b32 v27, a95
v_cvt_pk_bf16_f32 v28, v20, v21
v_cvt_pk_bf16_f32 v29, v22, v23
v_cvt_pk_bf16_f32 v30, v24, v25
v_cvt_pk_bf16_f32 v31, v26, v27
buffer_store_dwordx4 v[28:31], v2, s[36:39], s57 offen offset:3072 sc1
v_accvgpr_read_b32 v8, a96
v_accvgpr_read_b32 v9, a97
v_accvgpr_read_b32 v10, a98
v_accvgpr_read_b32 v11, a99
v_accvgpr_read_b32 v12, a100
v_accvgpr_read_b32 v13, a101
v_accvgpr_read_b32 v14, a102
v_accvgpr_read_b32 v15, a103
v_cvt_pk_bf16_f32 v16, v8, v9
v_cvt_pk_bf16_f32 v17, v10, v11
v_cvt_pk_bf16_f32 v18, v12, v13
v_cvt_pk_bf16_f32 v19, v14, v15
s_add_u32 s57, s57, 4096
buffer_store_dwordx4 v[16:19], v2, s[36:39], s57 offen offset:0 sc1
v_accvgpr_read_b32 v20, a104
v_accvgpr_read_b32 v21, a105
v_accvgpr_read_b32 v22, a106
v_accvgpr_read_b32 v23, a107
v_accvgpr_read_b32 v24, a108
v_accvgpr_read_b32 v25, a109
v_accvgpr_read_b32 v26, a110
v_accvgpr_read_b32 v27, a111
v_cvt_pk_bf16_f32 v28, v20, v21
v_cvt_pk_bf16_f32 v29, v22, v23
v_cvt_pk_bf16_f32 v30, v24, v25
v_cvt_pk_bf16_f32 v31, v26, v27
buffer_store_dwordx4 v[28:31], v2, s[36:39], s57 offen offset:1024 sc1
v_accvgpr_read_b32 v8, a112
v_accvgpr_read_b32 v9, a113
v_accvgpr_read_b32 v10, a114
v_accvgpr_read_b32 v11, a115
v_accvgpr_read_b32 v12, a116
v_accvgpr_read_b32 v13, a117
v_accvgpr_read_b32 v14, a118
v_accvgpr_read_b32 v15, a119
v_cvt_pk_bf16_f32 v16, v8, v9
v_cvt_pk_bf16_f32 v17, v10, v11
v_cvt_pk_bf16_f32 v18, v12, v13
v_cvt_pk_bf16_f32 v19, v14, v15
buffer_store_dwordx4 v[16:19], v2, s[36:39], s57 offen offset:2048 sc1
v_accvgpr_read_b32 v20, a120
v_accvgpr_read_b32 v21, a121
v_accvgpr_read_b32 v22, a122
v_accvgpr_read_b32 v23, a123
v_accvgpr_read_b32 v24, a124
v_accvgpr_read_b32 v25, a125
v_accvgpr_read_b32 v26, a126
v_accvgpr_read_b32 v27, a127
v_cvt_pk_bf16_f32 v28, v20, v21
v_cvt_pk_bf16_f32 v29, v22, v23
v_cvt_pk_bf16_f32 v30, v24, v25
v_cvt_pk_bf16_f32 v31, v26, v27
buffer_store_dwordx4 v[28:31], v2, s[36:39], s57 offen offset:3072 sc1
s_waitcnt vmcnt(0)
s_barrier
s_cmp_lg_u32 s3, 0
s_cbranch_scc1 .Lsg_335
v_mov_b32 v1, 1
v_mul_u32_u24 v2, 0, v0
s_mov_b64 exec, 1
buffer_atomic_add v1, v2, s[88:91], s86 offen sc1
s_mov_b64 exec, -1
.Lsg_335:
s_add_u32 m0, s52, s56
s_nop 0
buffer_load_dwordx4 v82, s[40:43], s48 offen sc1 lds
buffer_load_dwordx4 v82, s[40:43], s48 offen offset:1024 sc1 lds
s_add_u32 m0, m0, 2048
s_add_u32 s57, s48, 65536
buffer_load_dwordx4 v82, s[40:43], s57 offen sc1 lds
buffer_load_dwordx4 v82, s[40:43], s57 offen offset:1024 sc1 lds
s_lshl_b32 s53, s3, 10
s_add_u32 s53, s53, s52
s_add_u32 m0, s53, 16384
s_mov_b32 s57, s49
buffer_load_dwordx4 v83, s[44:47], s57 offen lds
s_add_u32 m0, m0, 4096
s_add_u32 s57, s57, s54
buffer_load_dwordx4 v83, s[44:47], s57 offen lds
s_add_u32 m0, m0, 4096
s_add_u32 s57, s57, s54
buffer_load_dwordx4 v83, s[44:47], s57 offen lds
s_add_u32 m0, m0, 4096
s_add_u32 s57, s57, s54
buffer_load_dwordx4 v83, s[44:47], s57 offen lds
buffer_load_dwordx4 v[248:251], v5, s[20:23], s24 offen
s_add_u32 s24, s24, 1024
s_cmp_lt_u32 s24, s25
s_cselect_b32 s22, s22, 0
s_add_u32 s48, s48, 2048
s_add_u32 s49, s49, s55
s_add_u32 s52, s52, 32768
s_cmp_eq_u32 s52, 131072
s_cselect_b32 s52, 0, s52
s_sub_u32 s58, s58, 1
s_cmp_gt_i32 s58, 0
s_cselect_b32 s42, s42, 0
s_cselect_b32 s46, s46, 0
s_add_u32 m0, s52, s56
s_nop 0
buffer_load_dwordx4 v82, s[40:43], s48 offen sc1 lds
buffer_load_dwordx4 v82, s[40:43], s48 offen offset:1024 sc1 lds
s_add_u32 m0, m0, 2048
s_add_u32 s57, s48, 65536
buffer_load_dwordx4 v82, s[40:43], s57 offen sc1 lds
buffer_load_dwordx4 v82, s[40:43], s57 offen offset:1024 sc1 lds
s_lshl_b32 s53, s3, 10
s_add_u32 s53, s53, s52
s_add_u32 m0, s53, 16384
s_mov_b32 s57, s49
buffer_load_dwordx4 v83, s[44:47], s57 offen lds
s_add_u32 m0, m0, 4096
s_add_u32 s57, s57, s54
buffer_load_dwordx4 v83, s[44:47], s57 offen lds
s_add_u32 m0, m0, 4096
s_add_u32 s57, s57, s54
buffer_load_dwordx4 v83, s[44:47], s57 offen lds
s_add_u32 m0, m0, 4096
s_add_u32 s57, s57, s54
buffer_load_dwordx4 v83, s[44:47], s57 offen lds
buffer_load_dwordx4 v[248:251], v5, s[20:23], s24 offen
s_add_u32 s24, s24, 1024
s_cmp_lt_u32 s24, s25
s_cselect_b32 s22, s22, 0
s_add_u32 s48, s48, 2048
s_add_u32 s49, s49, s55
s_add_u32 s52, s52, 32768
s_cmp_eq_u32 s52, 131072
s_cselect_b32 s52, 0, s52
s_sub_u32 s58, s58, 1
s_cmp_gt_i32 s58, 0
s_cselect_b32 s42, s42, 0
s_cselect_b32 s46, s46, 0
s_add_u32 m0, s52, s56
s_nop 0
buffer_load_dwordx4 v82, s[40:43], s48 offen sc1 lds
buffer_load_dwordx4 v82, s[40:43], s48 offen offset:1024 sc1 lds
s_add_u32 m0, m0, 2048
s_add_u32 s57, s48, 65536
buffer_load_dwordx4 v82, s[40:43], s57 offen sc1 lds
buffer_load_dwordx4 v82, s[40:43], s57 offen offset:1024 sc1 lds
s_lshl_b32 s53, s3, 10
s_add_u32 s53, s53, s52
s_add_u32 m0, s53, 16384
s_mov_b32 s57, s49
buffer_load_dwordx4 v83, s[44:47], s57 offen lds
s_add_u32 m0, m0, 4096
s_add_u32 s57, s57, s54
buffer_load_dwordx4 v83, s[44:47], s57 offen lds
s_add_u32 m0, m0, 4096
s_add_u32 s57, s57, s54
buffer_load_dwordx4 v83, s[44:47], s57 offen lds
s_add_u32 m0, m0, 4096
s_add_u32 s57, s57, s54
buffer_load_dwordx4 v83, s[44:47], s57 offen lds
buffer_load_dwordx4 v[248:251], v5, s[20:23], s24 offen
s_add_u32 s24, s24, 1024
s_cmp_lt_u32 s24, s25
s_cselect_b32 s22, s22, 0
s_add_u32 s48, s48, 2048
s_add_u32 s49, s49, s55
s_add_u32 s52, s52, 32768
s_cmp_eq_u32 s52, 131072
s_cselect_b32 s52, 0, s52
s_sub_u32 s58, s58, 1
s_cmp_gt_i32 s58, 0
s_cselect_b32 s42, s42, 0
s_cselect_b32 s46, s46, 0
s_add_u32 m0, s52, s56
s_nop 0
buffer_load_dwordx4 v82, s[40:43], s48 offen sc1 lds
buffer_load_dwordx4 v82, s[40:43], s48 offen offset:1024 sc1 lds
s_add_u32 m0, m0, 2048
s_add_u32 s57, s48, 65536
buffer_load_dwordx4 v82, s[40:43], s57 offen sc1 lds
buffer_load_dwordx4 v82, s[40:43], s57 offen offset:1024 sc1 lds
s_branch .Lj4_333
.Le4_316:
s_add_u32 s57, s12, 0
v_accvgpr_read_b32 v8, a0
v_accvgpr_read_b32 v9, a1
v_accvgpr_read_b32 v10, a2
v_accvgpr_read_b32 v11, a3
v_accvgpr_read_b32 v12, a4
v_accvgpr_read_b32 v13, a5
v_accvgpr_read_b32 v14, a6
v_accvgpr_read_b32 v15, a7
v_cvt_pk_bf16_f32 v16, v8, v9
v_cvt_pk_bf16_f32 v17, v10, v11
v_cvt_pk_bf16_f32 v18, v12, v13
v_cvt_pk_bf16_f32 v19, v14, v15
buffer_store_dwordx4 v[16:19], v2, s[36:39], s57 offen offset:0 sc1
v_accvgpr_read_b32 v20, a8
v_accvgpr_read_b32 v21, a9
v_accvgpr_read_b32 v22, a10
v_accvgpr_read_b32 v23, a11
v_accvgpr_read_b32 v24, a12
v_accvgpr_read_b32 v25, a13
v_accvgpr_read_b32 v26, a14
v_accvgpr_read_b32 v27, a15
v_cvt_pk_bf16_f32 v28, v20, v21
v_cvt_pk_bf16_f32 v29, v22, v23
v_cvt_pk_bf16_f32 v30, v24, v25
v_cvt_pk_bf16_f32 v31, v26, v27
buffer_store_dwordx4 v[28:31], v2, s[36:39], s57 offen offset:1024 sc1
v_accvgpr_read_b32 v8, a16
v_accvgpr_read_b32 v9, a17
v_accvgpr_read_b32 v10, a18
v_accvgpr_read_b32 v11, a19
v_accvgpr_read_b32 v12, a20
v_accvgpr_read_b32 v13, a21
v_accvgpr_read_b32 v14, a22
v_accvgpr_read_b32 v15, a23
v_cvt_pk_bf16_f32 v16, v8, v9
v_cvt_pk_bf16_f32 v17, v10, v11
v_cvt_pk_bf16_f32 v18, v12, v13
v_cvt_pk_bf16_f32 v19, v14, v15
buffer_store_dwordx4 v[16:19], v2, s[36:39], s57 offen offset:2048 sc1
v_accvgpr_read_b32 v20, a24
v_accvgpr_read_b32 v21, a25
v_accvgpr_read_b32 v22, a26
v_accvgpr_read_b32 v23, a27
v_accvgpr_read_b32 v24, a28
v_accvgpr_read_b32 v25, a29
v_accvgpr_read_b32 v26, a30
v_accvgpr_read_b32 v27, a31
v_cvt_pk_bf16_f32 v28, v20, v21
v_cvt_pk_bf16_f32 v29, v22, v23
v_cvt_pk_bf16_f32 v30, v24, v25
v_cvt_pk_bf16_f32 v31, v26, v27
buffer_store_dwordx4 v[28:31], v2, s[36:39], s57 offen offset:3072 sc1
v_accvgpr_read_b32 v8, a32
v_accvgpr_read_b32 v9, a33
v_accvgpr_read_b32 v10, a34
v_accvgpr_read_b32 v11, a35
v_accvgpr_read_b32 v12, a36
v_accvgpr_read_b32 v13, a37
v_accvgpr_read_b32 v14, a38
v_accvgpr_read_b32 v15, a39
v_cvt_pk_bf16_f32 v16, v8, v9
v_cvt_pk_bf16_f32 v17, v10, v11
v_cvt_pk_bf16_f32 v18, v12, v13
v_cvt_pk_bf16_f32 v19, v14, v15
s_add_u32 s57, s57, 4096
buffer_store_dwordx4 v[16:19], v2, s[36:39], s57 offen offset:0 sc1
v_accvgpr_read_b32 v20, a40
v_accvgpr_read_b32 v21, a41
v_accvgpr_read_b32 v22, a42
v_accvgpr_read_b32 v23, a43
v_accvgpr_read_b32 v24, a44
v_accvgpr_read_b32 v25, a45
v_accvgpr_read_b32 v26, a46
v_accvgpr_read_b32 v27, a47
v_cvt_pk_bf16_f32 v28, v20, v21
v_cvt_pk_bf16_f32 v29, v22, v23
v_cvt_pk_bf16_f32 v30, v24, v25
v_cvt_pk_bf16_f32 v31, v26, v27
buffer_store_dwordx4 v[28:31], v2, s[36:39], s57 offen offset:1024 sc1
v_accvgpr_read_b32 v8, a48
v_accvgpr_read_b32 v9, a49
v_accvgpr_read_b32 v10, a50
v_accvgpr_read_b32 v11, a51
v_accvgpr_read_b32 v12, a52
v_accvgpr_read_b32 v13, a53
v_accvgpr_read_b32 v14, a54
v_accvgpr_read_b32 v15, a55
v_cvt_pk_bf16_f32 v16, v8, v9
v_cvt_pk_bf16_f32 v17, v10, v11
v_cvt_pk_bf16_f32 v18, v12, v13
v_cvt_pk_bf16_f32 v19, v14, v15
buffer_store_dwordx4 v[16:19], v2, s[36:39], s57 offen offset:2048 sc1
v_accvgpr_read_b32 v20, a56
v_accvgpr_read_b32 v21, a57
v_accvgpr_read_b32 v22, a58
v_accvgpr_read_b32 v23, a59
v_accvgpr_read_b32 v24, a60
v_accvgpr_read_b32 v25, a61
v_accvgpr_read_b32 v26, a62
v_accvgpr_read_b32 v27, a63
v_cvt_pk_bf16_f32 v28, v20, v21
v_cvt_pk_bf16_f32 v29, v22, v23
v_cvt_pk_bf16_f32 v30, v24, v25
v_cvt_pk_bf16_f32 v31, v26, v27
buffer_store_dwordx4 v[28:31], v2, s[36:39], s57 offen offset:3072 sc1
s_add_u32 s57, s12, 262144
v_accvgpr_read_b32 v8, a64
v_accvgpr_read_b32 v9, a65
v_accvgpr_read_b32 v10, a66
v_accvgpr_read_b32 v11, a67
v_accvgpr_read_b32 v12, a68
v_accvgpr_read_b32 v13, a69
v_accvgpr_read_b32 v14, a70
v_accvgpr_read_b32 v15, a71
v_cvt_pk_bf16_f32 v16, v8, v9
v_cvt_pk_bf16_f32 v17, v10, v11
v_cvt_pk_bf16_f32 v18, v12, v13
v_cvt_pk_bf16_f32 v19, v14, v15
buffer_store_dwordx4 v[16:19], v2, s[36:39], s57 offen offset:0 sc1
v_accvgpr_read_b32 v20, a72
v_accvgpr_read_b32 v21, a73
v_accvgpr_read_b32 v22, a74
v_accvgpr_read_b32 v23, a75
v_accvgpr_read_b32 v24, a76
v_accvgpr_read_b32 v25, a77
v_accvgpr_read_b32 v26, a78
v_accvgpr_read_b32 v27, a79
v_cvt_pk_bf16_f32 v28, v20, v21
v_cvt_pk_bf16_f32 v29, v22, v23
v_cvt_pk_bf16_f32 v30, v24, v25
v_cvt_pk_bf16_f32 v31, v26, v27
buffer_store_dwordx4 v[28:31], v2, s[36:39], s57 offen offset:1024 sc1
v_accvgpr_read_b32 v8, a80
v_accvgpr_read_b32 v9, a81
v_accvgpr_read_b32 v10, a82
v_accvgpr_read_b32 v11, a83
v_accvgpr_read_b32 v12, a84
v_accvgpr_read_b32 v13, a85
v_accvgpr_read_b32 v14, a86
v_accvgpr_read_b32 v15, a87
v_cvt_pk_bf16_f32 v16, v8, v9
v_cvt_pk_bf16_f32 v17, v10, v11
v_cvt_pk_bf16_f32 v18, v12, v13
v_cvt_pk_bf16_f32 v19, v14, v15
buffer_store_dwordx4 v[16:19], v2, s[36:39], s57 offen offset:2048 sc1
v_accvgpr_read_b32 v20, a88
v_accvgpr_read_b32 v21, a89
v_accvgpr_read_b32 v22, a90
v_accvgpr_read_b32 v23, a91
v_accvgpr_read_b32 v24, a92
v_accvgpr_read_b32 v25, a93
v_accvgpr_read_b32 v26, a94
v_accvgpr_read_b32 v27, a95
v_cvt_pk_bf16_f32 v28, v20, v21
v_cvt_pk_bf16_f32 v29, v22, v23
v_cvt_pk_bf16_f32 v30, v24, v25
v_cvt_pk_bf16_f32 v31, v26, v27
buffer_store_dwordx4 v[28:31], v2, s[36:39], s57 offen offset:3072 sc1
v_accvgpr_read_b32 v8, a96
v_accvgpr_read_b32 v9, a97
v_accvgpr_read_b32 v10, a98
v_accvgpr_read_b32 v11, a99
v_accvgpr_read_b32 v12, a100
v_accvgpr_read_b32 v13, a101
v_accvgpr_read_b32 v14, a102
v_accvgpr_read_b32 v15, a103
v_cvt_pk_bf16_f32 v16, v8, v9
v_cvt_pk_bf16_f32 v17, v10, v11
v_cvt_pk_bf16_f32 v18, v12, v13
v_cvt_pk_bf16_f32 v19, v14, v15
s_add_u32 s57, s57, 4096
buffer_store_dwordx4 v[16:19], v2, s[36:39], s57 offen offset:0 sc1
v_accvgpr_read_b32 v20, a104
v_accvgpr_read_b32 v21, a105
v_accvgpr_read_b32 v22, a106
v_accvgpr_read_b32 v23, a107
v_accvgpr_read_b32 v24, a108
v_accvgpr_read_b32 v25, a109
v_accvgpr_read_b32 v26, a110
v_accvgpr_read_b32 v27, a111
v_cvt_pk_bf16_f32 v28, v20, v21
v_cvt_pk_bf16_f32 v29, v22, v23
v_cvt_pk_bf16_f32 v30, v24, v25
v_cvt_pk_bf16_f32 v31, v26, v27
buffer_store_dwordx4 v[28:31], v2, s[36:39], s57 offen offset:1024 sc1
v_accvgpr_read_b32 v8, a112
v_accvgpr_read_b32 v9, a113
v_accvgpr_read_b32 v10, a114
v_accvgpr_read_b32 v11, a115
v_accvgpr_read_b32 v12, a116
v_accvgpr_read_b32 v13, a117
v_accvgpr_read_b32 v14, a118
v_accvgpr_read_b32 v15, a119
v_cvt_pk_bf16_f32 v16, v8, v9
v_cvt_pk_bf16_f32 v17, v10, v11
v_cvt_pk_bf16_f32 v18, v12, v13
v_cvt_pk_bf16_f32 v19, v14, v15
buffer_store_dwordx4 v[16:19], v2, s[36:39], s57 offen offset:2048 sc1
v_accvgpr_read_b32 v20, a120
v_accvgpr_read_b32 v21, a121
v_accvgpr_read_b32 v22, a122
v_accvgpr_read_b32 v23, a123
v_accvgpr_read_b32 v24, a124
v_accvgpr_read_b32 v25, a125
v_accvgpr_read_b32 v26, a126
v_accvgpr_read_b32 v27, a127
v_cvt_pk_bf16_f32 v28, v20, v21
v_cvt_pk_bf16_f32 v29, v22, v23
v_cvt_pk_bf16_f32 v30, v24, v25
v_cvt_pk_bf16_f32 v31, v26, v27
buffer_store_dwordx4 v[28:31], v2, s[36:39], s57 offen offset:3072 sc1
s_waitcnt vmcnt(0)
s_barrier
s_cmp_lg_u32 s3, 0
s_cbranch_scc1 .Lsg_336
v_mov_b32 v1, 1
v_mul_u32_u24 v2, 0, v0
s_mov_b64 exec, 1
buffer_atomic_add v1, v2, s[88:91], s86 offen sc1
s_mov_b64 exec, -1
.Lsg_336:
.Lj4_333:
s_cmp_eq_u32 s79, 4
s_cbranch_scc1 .Lbatch_317
s_mov_b32 s79, 2
.Lround_318:
s_cmp_eq_u32 s83, 2
s_cbranch_scc1 .Lvt_337
s_mov_b32 s51, 0
v_mov_b32 v77, v72
v_mov_b32 v78, v73
v_mov_b32 v79, v74
v_mov_b32 v80, v75
v_mov_b32 v81, v76
v_accvgpr_write_b32 a0, 0
v_accvgpr_write_b32 a1, 0
v_accvgpr_write_b32 a2, 0
v_accvgpr_write_b32 a3, 0
v_accvgpr_write_b32 a4, 0
v_accvgpr_write_b32 a5, 0
v_accvgpr_write_b32 a6, 0
v_accvgpr_write_b32 a7, 0
v_accvgpr_write_b32 a8, 0
v_accvgpr_write_b32 a9, 0
v_accvgpr_write_b32 a10, 0
v_accvgpr_write_b32 a11, 0
v_accvgpr_write_b32 a12, 0
v_accvgpr_write_b32 a13, 0
v_accvgpr_write_b32 a14, 0
v_accvgpr_write_b32 a15, 0
v_accvgpr_write_b32 a16, 0
v_accvgpr_write_b32 a17, 0
v_accvgpr_write_b32 a18, 0
v_accvgpr_write_b32 a19, 0
v_accvgpr_write_b32 a20, 0
v_accvgpr_write_b32 a21, 0
v_accvgpr_write_b32 a22, 0
v_accvgpr_write_b32 a23, 0
v_accvgpr_write_b32 a24, 0
v_accvgpr_write_b32 a25, 0
v_accvgpr_write_b32 a26, 0
v_accvgpr_write_b32 a27, 0
v_accvgpr_write_b32 a28, 0
v_accvgpr_write_b32 a29, 0
v_accvgpr_write_b32 a30, 0
v_accvgpr_write_b32 a31, 0
v_accvgpr_write_b32 a32, 0
v_accvgpr_write_b32 a33, 0
v_accvgpr_write_b32 a34, 0
v_accvgpr_write_b32 a35, 0
v_accvgpr_write_b32 a36, 0
v_accvgpr_write_b32 a37, 0
v_accvgpr_write_b32 a38, 0
v_accvgpr_write_b32 a39, 0
v_accvgpr_write_b32 a40, 0
v_accvgpr_write_b32 a41, 0
v_accvgpr_write_b32 a42, 0
v_accvgpr_write_b32 a43, 0
v_accvgpr_write_b32 a44, 0
v_accvgpr_write_b32 a45, 0
v_accvgpr_write_b32 a46, 0
v_accvgpr_write_b32 a47, 0
v_accvgpr_write_b32 a48, 0
v_accvgpr_write_b32 a49, 0
v_accvgpr_write_b32 a50, 0
v_accvgpr_write_b32 a51, 0
v_accvgpr_write_b32 a52, 0
v_accvgpr_write_b32 a53, 0
v_accvgpr_write_b32 a54, 0
v_accvgpr_write_b32 a55, 0
v_accvgpr_write_b32 a56, 0
v_accvgpr_write_b32 a57, 0
v_accvgpr_write_b32 a58, 0
v_accvgpr_write_b32 a59, 0
v_accvgpr_write_b32 a60, 0
v_accvgpr_write_b32 a61, 0
v_accvgpr_write_b32 a62, 0
v_accvgpr_write_b32 a63, 0
v_accvgpr_write_b32 a64, 0
v_accvgpr_write_b32 a65, 0
v_accvgpr_write_b32 a66, 0
v_accvgpr_write_b32 a67, 0
v_accvgpr_write_b32 a68, 0
v_accvgpr_write_b32 a69, 0
v_accvgpr_write_b32 a70, 0
v_accvgpr_write_b32 a71, 0
v_accvgpr_write_b32 a72, 0
v_accvgpr_write_b32 a73, 0
v_accvgpr_write_b32 a74, 0
v_accvgpr_write_b32 a75, 0
v_accvgpr_write_b32 a76, 0
v_accvgpr_write_b32 a77, 0
v_accvgpr_write_b32 a78, 0
v_accvgpr_write_b32 a79, 0
v_accvgpr_write_b32 a80, 0
v_accvgpr_write_b32 a81, 0
v_accvgpr_write_b32 a82, 0
v_accvgpr_write_b32 a83, 0
v_accvgpr_write_b32 a84, 0
v_accvgpr_write_b32 a85, 0
v_accvgpr_write_b32 a86, 0
v_accvgpr_write_b32 a87, 0
v_accvgpr_write_b32 a88, 0
v_accvgpr_write_b32 a89, 0
v_accvgpr_write_b32 a90, 0
v_accvgpr_write_b32 a91, 0
v_accvgpr_write_b32 a92, 0
v_accvgpr_write_b32 a93, 0
v_accvgpr_write_b32 a94, 0
v_accvgpr_write_b32 a95, 0
v_accvgpr_write_b32 a96, 0
v_accvgpr_write_b32 a97, 0
v_accvgpr_write_b32 a98, 0
v_accvgpr_write_b32 a99, 0
v_accvgpr_write_b32 a100, 0
v_accvgpr_write_b32 a101, 0
v_accvgpr_write_b32 a102, 0
v_accvgpr_write_b32 a103, 0
v_accvgpr_write_b32 a104, 0
v_accvgpr_write_b32 a105, 0
v_accvgpr_write_b32 a106, 0
v_accvgpr_write_b32 a107, 0
v_accvgpr_write_b32 a108, 0
v_accvgpr_write_b32 a109, 0
v_accvgpr_write_b32 a110, 0
v_accvgpr_write_b32 a111, 0
v_accvgpr_write_b32 a112, 0
v_accvgpr_write_b32 a113, 0
v_accvgpr_write_b32 a114, 0
v_accvgpr_write_b32 a115, 0
v_accvgpr_write_b32 a116, 0
v_accvgpr_write_b32 a117, 0
v_accvgpr_write_b32 a118, 0
v_accvgpr_write_b32 a119, 0
v_accvgpr_write_b32 a120, 0
v_accvgpr_write_b32 a121, 0
v_accvgpr_write_b32 a122, 0
v_accvgpr_write_b32 a123, 0
v_accvgpr_write_b32 a124, 0
v_accvgpr_write_b32 a125, 0
v_accvgpr_write_b32 a126, 0
v_accvgpr_write_b32 a127, 0
v_accvgpr_write_b32 a128, 0
v_accvgpr_write_b32 a129, 0
v_accvgpr_write_b32 a130, 0
v_accvgpr_write_b32 a131, 0
v_accvgpr_write_b32 a132, 0
v_accvgpr_write_b32 a133, 0
v_accvgpr_write_b32 a134, 0
v_accvgpr_write_b32 a135, 0
v_accvgpr_write_b32 a136, 0
v_accvgpr_write_b32 a137, 0
v_accvgpr_write_b32 a138, 0
v_accvgpr_write_b32 a139, 0
v_accvgpr_write_b32 a140, 0
v_accvgpr_write_b32 a141, 0
v_accvgpr_write_b32 a142, 0
v_accvgpr_write_b32 a143, 0
v_accvgpr_write_b32 a144, 0
v_accvgpr_write_b32 a145, 0
v_accvgpr_write_b32 a146, 0
v_accvgpr_write_b32 a147, 0
v_accvgpr_write_b32 a148, 0
v_accvgpr_write_b32 a149, 0
v_accvgpr_write_b32 a150, 0
v_accvgpr_write_b32 a151, 0
v_accvgpr_write_b32 a152, 0
v_accvgpr_write_b32 a153, 0
v_accvgpr_write_b32 a154, 0
v_accvgpr_write_b32 a155, 0
v_accvgpr_write_b32 a156, 0
v_accvgpr_write_b32 a157, 0
v_accvgpr_write_b32 a158, 0
v_accvgpr_write_b32 a159, 0
v_accvgpr_write_b32 a160, 0
v_accvgpr_write_b32 a161, 0
v_accvgpr_write_b32 a162, 0
v_accvgpr_write_b32 a163, 0
v_accvgpr_write_b32 a164, 0
v_accvgpr_write_b32 a165, 0
v_accvgpr_write_b32 a166, 0
v_accvgpr_write_b32 a167, 0
v_accvgpr_write_b32 a168, 0
v_accvgpr_write_b32 a169, 0
v_accvgpr_write_b32 a170, 0
v_accvgpr_write_b32 a171, 0
v_accvgpr_write_b32 a172, 0
v_accvgpr_write_b32 a173, 0
v_accvgpr_write_b32 a174, 0
v_accvgpr_write_b32 a175, 0
v_accvgpr_write_b32 a176, 0
v_accvgpr_write_b32 a177, 0
v_accvgpr_write_b32 a178, 0
v_accvgpr_write_b32 a179, 0
v_accvgpr_write_b32 a180, 0
v_accvgpr_write_b32 a181, 0
v_accvgpr_write_b32 a182, 0
v_accvgpr_write_b32 a183, 0
v_accvgpr_write_b32 a184, 0
v_accvgpr_write_b32 a185, 0
v_accvgpr_write_b32 a186, 0
v_accvgpr_write_b32 a187, 0
v_accvgpr_write_b32 a188, 0
v_accvgpr_write_b32 a189, 0
v_accvgpr_write_b32 a190, 0
v_accvgpr_write_b32 a191, 0
v_accvgpr_write_b32 a192, 0
v_accvgpr_write_b32 a193, 0
v_accvgpr_write_b32 a194, 0
v_accvgpr_write_b32 a195, 0
v_accvgpr_write_b32 a196, 0
v_accvgpr_write_b32 a197, 0
v_accvgpr_write_b32 a198, 0
v_accvgpr_write_b32 a199, 0
v_accvgpr_write_b32 a200, 0
v_accvgpr_write_b32 a201, 0
v_accvgpr_write_b32 a202, 0
v_accvgpr_write_b32 a203, 0
v_accvgpr_write_b32 a204, 0
v_accvgpr_write_b32 a205, 0
v_accvgpr_write_b32 a206, 0
v_accvgpr_write_b32 a207, 0
v_accvgpr_write_b32 a208, 0
v_accvgpr_write_b32 a209, 0
v_accvgpr_write_b32 a210, 0
v_accvgpr_write_b32 a211, 0
v_accvgpr_write_b32 a212, 0
v_accvgpr_write_b32 a213, 0
v_accvgpr_write_b32 a214, 0
v_accvgpr_write_b32 a215, 0
v_accvgpr_write_b32 a216, 0
v_accvgpr_write_b32 a217, 0
v_accvgpr_write_b32 a218, 0
v_accvgpr_write_b32 a219, 0
v_accvgpr_write_b32 a220, 0
v_accvgpr_write_b32 a221, 0
v_accvgpr_write_b32 a222, 0
v_accvgpr_write_b32 a223, 0
v_accvgpr_write_b32 a224, 0
v_accvgpr_write_b32 a225, 0
v_accvgpr_write_b32 a226, 0
v_accvgpr_write_b32 a227, 0
v_accvgpr_write_b32 a228, 0
v_accvgpr_write_b32 a229, 0
v_accvgpr_write_b32 a230, 0
v_accvgpr_write_b32 a231, 0
v_accvgpr_write_b32 a232, 0
v_accvgpr_write_b32 a233, 0
v_accvgpr_write_b32 a234, 0
v_accvgpr_write_b32 a235, 0
v_accvgpr_write_b32 a236, 0
v_accvgpr_write_b32 a237, 0
v_accvgpr_write_b32 a238, 0
v_accvgpr_write_b32 a239, 0
v_accvgpr_write_b32 a240, 0
v_accvgpr_write_b32 a241, 0
v_accvgpr_write_b32 a242, 0
v_accvgpr_write_b32 a243, 0
v_accvgpr_write_b32 a244, 0
v_accvgpr_write_b32 a245, 0
v_accvgpr_write_b32 a246, 0
v_accvgpr_write_b32 a247, 0
v_accvgpr_write_b32 a248, 0
v_accvgpr_write_b32 a249, 0
v_accvgpr_write_b32 a250, 0
v_accvgpr_write_b32 a251, 0
v_accvgpr_write_b32 a252, 0
v_accvgpr_write_b32 a253, 0
v_accvgpr_write_b32 a254, 0
v_accvgpr_write_b32 a255, 0
s_waitcnt vmcnt(22)
s_barrier
ds_read_b128 v[8:11], v77 offset:0
ds_read_b64_tr_b16 v[40:41], v78 offset:0
ds_read_b64_tr_b16 v[42:43], v78 offset:4096
ds_read_b64_tr_b16 v[44:45], v79 offset:0
ds_read_b64_tr_b16 v[46:47], v79 offset:4096
ds_read_b64_tr_b16 v[48:49], v80 offset:0
ds_read_b64_tr_b16 v[50:51], v80 offset:4096
ds_read_b64_tr_b16 v[52:53], v81 offset:0
ds_read_b64_tr_b16 v[54:55], v81 offset:4096
ds_read_b128 v[12:15], v77 offset:2048
ds_read_b128 v[16:19], v77 offset:4096
ds_read_b128 v[20:23], v77 offset:6144
.Lgl_339:
s_waitcnt lgkmcnt(0)
v_mfma_f32_32x32x16_bf16 a[0:15], v[40:43], v[8:11], a[0:15]
ds_read_b128 v[24:27], v77 offset:1024
ds_read_b64_tr_b16 v[56:57], v78 offset:8192
v_mfma_f32_32x32x16_bf16 a[16:31], v[44:47], v[8:11], a[16:31]
ds_read_b64_tr_b16 v[58:59], v78 offset:12288
ds_read_b64_tr_b16 v[60:61], v79 offset:8192
v_mfma_f32_32x32x16_bf16 a[32:47], v[48:51], v[8:11], a[32:47]
ds_read_b64_tr_b16 v[62:63], v79 offset:12288
ds_read_b64_tr_b16 v[64:65], v80 offset:8192
v_mfma_f32_32x32x16_bf16 a[48:63], v[52:55], v[8:11], a[48:63]
ds_read_b64_tr_b16 v[66:67], v80 offset:12288
ds_read_b64_tr_b16 v[68:69], v81 offset:8192
v_mfma_f32_32x32x16_bf16 a[64:79], v[40:43], v[12:15], a[64:79]
ds_read_b64_tr_b16 v[70:71], v81 offset:12288
ds_read_b128 v[28:31], v77 offset:3072
v_mfma_f32_32x32x16_bf16 a[80:95], v[44:47], v[12:15], a[80:95]
ds_read_b128 v[32:35], v77 offset:5120
ds_read_b128 v[36:39], v77 offset:7168
v_mfma_f32_32x32x16_bf16 a[96:111], v[48:51], v[12:15], a[96:111]
s_add_u32 s51, s51, 32768
s_cmp_eq_u32 s51, 131072
s_cselect_b32 s51, 0, s51
v_add_u32 v77, s51, v72
v_add_u32 v78, s51, v73
v_mfma_f32_32x32x16_bf16 a[112:127], v[52:55], v[12:15], a[112:127]
v_add_u32 v79, s51, v74
v_mfma_f32_32x32x16_bf16 a[128:143], v[40:43], v[16:19], a[128:143]
v_add_u32 v80, s51, v75
v_mfma_f32_32x32x16_bf16 a[144:159], v[44:47], v[16:19], a[144:159]
v_add_u32 v81, s51, v76
v_mfma_f32_32x32x16_bf16 a[160:175], v[48:51], v[16:19], a[160:175]
s_lshl_b32 s53, s3, 10
s_add_u32 s53, s53, s52
s_add_u32 m0, s53, 16384
s_mov_b32 s57, s49
buffer_load_dwordx4 v83, s[44:47], s57 offen lds
v_mfma_f32_32x32x16_bf16 a[176:191], v[52:55], v[16:19], a[176:191]
s_add_u32 m0, m0, 4096
s_add_u32 s57, s57, s54
buffer_load_dwordx4 v83, s[44:47], s57 offen lds
v_mfma_f32_32x32x16_bf16 a[192:207], v[40:43], v[20:23], a[192:207]
s_add_u32 m0, m0, 4096
s_add_u32 s57, s57, s54
buffer_load_dwordx4 v83, s[44:47], s57 offen lds
v_mfma_f32_32x32x16_bf16 a[208:223], v[44:47], v[20:23], a[208:223]
s_add_u32 m0, m0, 4096
s_add_u32 s57, s57, s54
buffer_load_dwordx4 v83, s[44:47], s57 offen lds
v_mfma_f32_32x32x16_bf16 a[224:239], v[48:51], v[20:23], a[224:239]
buffer_load_dwordx4 v[248:251], v5, s[20:23], s24 offen
s_add_u32 s24, s24, 1024
s_cmp_lt_u32 s24, s25
s_cselect_b32 s22, s22, 0
v_mfma_f32_32x32x16_bf16 a[240:255], v[52:55], v[20:23], a[240:255]
s_add_u32 s48, s48, 2048
s_add_u32 s49, s49, s55
s_add_u32 s52, s52, 32768
s_cmp_eq_u32 s52, 131072
s_cselect_b32 s52, 0, s52
s_sub_u32 s58, s58, 1
s_cmp_gt_i32 s58, 0
s_cselect_b32 s42, s42, 0
s_cselect_b32 s46, s46, 0
s_waitcnt lgkmcnt(0)
v_mfma_f32_32x32x16_bf16 a[0:15], v[56:59], v[24:27], a[0:15]
s_waitcnt vmcnt(18)
s_barrier
ds_read_b128 v[8:11], v77 offset:0
ds_read_b64_tr_b16 v[40:41], v78 offset:0
v_mfma_f32_32x32x16_bf16 a[16:31], v[60:63], v[24:27], a[16:31]
ds_read_b64_tr_b16 v[42:43], v78 offset:4096
ds_read_b64_tr_b16 v[44:45], v79 offset:0
v_mfma_f32_32x32x16_bf16 a[32:47], v[64:67], v[24:27], a[32:47]
ds_read_b64_tr_b16 v[46:47], v79 offset:4096
ds_read_b64_tr_b16 v[48:49], v80 offset:0
v_mfma_f32_32x32x16_bf16 a[48:63], v[68:71], v[24:27], a[48:63]
ds_read_b64_tr_b16 v[50:51], v80 offset:4096
ds_read_b64_tr_b16 v[52:53], v81 offset:0
v_mfma_f32_32x32x16_bf16 a[64:79], v[56:59], v[28:31], a[64:79]
ds_read_b64_tr_b16 v[54:55], v81 offset:4096
ds_read_b128 v[12:15], v77 offset:2048
v_mfma_f32_32x32x16_bf16 a[80:95], v[60:63], v[28:31], a[80:95]
ds_read_b128 v[16:19], v77 offset:4096
ds_read_b128 v[20:23], v77 offset:6144
v_mfma_f32_32x32x16_bf16 a[96:111], v[64:67], v[28:31], a[96:111]
s_add_u32 m0, s52, s56
s_nop 0
buffer_load_dwordx4 v82, s[40:43], s48 offen sc1 lds
v_mfma_f32_32x32x16_bf16 a[112:127], v[68:71], v[28:31], a[112:127]
v_mfma_f32_32x32x16_bf16 a[128:143], v[56:59], v[32:35], a[128:143]
buffer_load_dwordx4 v82, s[40:43], s48 offen offset:1024 sc1 lds
v_mfma_f32_32x32x16_bf16 a[144:159], v[60:63], v[32:35], a[144:159]
v_mfma_f32_32x32x16_bf16 a[160:175], v[64:67], v[32:35], a[160:175]
v_mfma_f32_32x32x16_bf16 a[176:191], v[68:71], v[32:35], a[176:191]
s_add_u32 m0, m0, 2048
s_add_u32 s57, s48, 65536
buffer_load_dwordx4 v82, s[40:43], s57 offen sc1 lds
v_mfma_f32_32x32x16_bf16 a[192:207], v[56:59], v[36:39], a[192:207]
v_mfma_f32_32x32x16_bf16 a[208:223], v[60:63], v[36:39], a[208:223]
buffer_load_dwordx4 v82, s[40:43], s57 offen offset:1024 sc1 lds
v_mfma_f32_32x32x16_bf16 a[224:239], v[64:67], v[36:39], a[224:239]
v_mfma_f32_32x32x16_bf16 a[240:255], v[68:71], v[36:39], a[240:255]
s_sub_u32 s50, s50, 1
s_cmp_lg_u32 s50, 0
s_cbranch_scc1 .Lgl_339
s_waitcnt vmcnt(0) lgkmcnt(0)
s_nop 15
s_branch .Lepi_338
.Lvt_337:
s_mov_b32 s51, 0
v_mov_b32 v77, v72
v_mov_b32 v78, v73
v_mov_b32 v79, v74
v_mov_b32 v80, v75
v_mov_b32 v81, v76
v_accvgpr_write_b32 a0, 0
v_accvgpr_write_b32 a1, 0
v_accvgpr_write_b32 a2, 0
v_accvgpr_write_b32 a3, 0
v_accvgpr_write_b32 a4, 0
v_accvgpr_write_b32 a5, 0
v_accvgpr_write_b32 a6, 0
v_accvgpr_write_b32 a7, 0
v_accvgpr_write_b32 a8, 0
v_accvgpr_write_b32 a9, 0
v_accvgpr_write_b32 a10, 0
v_accvgpr_write_b32 a11, 0
v_accvgpr_write_b32 a12, 0
v_accvgpr_write_b32 a13, 0
v_accvgpr_write_b32 a14, 0
v_accvgpr_write_b32 a15, 0
v_accvgpr_write_b32 a16, 0
v_accvgpr_write_b32 a17, 0
v_accvgpr_write_b32 a18, 0
v_accvgpr_write_b32 a19, 0
v_accvgpr_write_b32 a20, 0
v_accvgpr_write_b32 a21, 0
v_accvgpr_write_b32 a22, 0
v_accvgpr_write_b32 a23, 0
v_accvgpr_write_b32 a24, 0
v_accvgpr_write_b32 a25, 0
v_accvgpr_write_b32 a26, 0
v_accvgpr_write_b32 a27, 0
v_accvgpr_write_b32 a28, 0
v_accvgpr_write_b32 a29, 0
v_accvgpr_write_b32 a30, 0
v_accvgpr_write_b32 a31, 0
v_accvgpr_write_b32 a32, 0
v_accvgpr_write_b32 a33, 0
v_accvgpr_write_b32 a34, 0
v_accvgpr_write_b32 a35, 0
v_accvgpr_write_b32 a36, 0
v_accvgpr_write_b32 a37, 0
v_accvgpr_write_b32 a38, 0
v_accvgpr_write_b32 a39, 0
v_accvgpr_write_b32 a40, 0
v_accvgpr_write_b32 a41, 0
v_accvgpr_write_b32 a42, 0
v_accvgpr_write_b32 a43, 0
v_accvgpr_write_b32 a44, 0
v_accvgpr_write_b32 a45, 0
v_accvgpr_write_b32 a46, 0
v_accvgpr_write_b32 a47, 0
v_accvgpr_write_b32 a48, 0
v_accvgpr_write_b32 a49, 0
v_accvgpr_write_b32 a50, 0
v_accvgpr_write_b32 a51, 0
v_accvgpr_write_b32 a52, 0
v_accvgpr_write_b32 a53, 0
v_accvgpr_write_b32 a54, 0
v_accvgpr_write_b32 a55, 0
v_accvgpr_write_b32 a56, 0
v_accvgpr_write_b32 a57, 0
v_accvgpr_write_b32 a58, 0
v_accvgpr_write_b32 a59, 0
v_accvgpr_write_b32 a60, 0
v_accvgpr_write_b32 a61, 0
v_accvgpr_write_b32 a62, 0
v_accvgpr_write_b32 a63, 0
v_accvgpr_write_b32 a64, 0
v_accvgpr_write_b32 a65, 0
v_accvgpr_write_b32 a66, 0
v_accvgpr_write_b32 a67, 0
v_accvgpr_write_b32 a68, 0
v_accvgpr_write_b32 a69, 0
v_accvgpr_write_b32 a70, 0
v_accvgpr_write_b32 a71, 0
v_accvgpr_write_b32 a72, 0
v_accvgpr_write_b32 a73, 0
v_accvgpr_write_b32 a74, 0
v_accvgpr_write_b32 a75, 0
v_accvgpr_write_b32 a76, 0
v_accvgpr_write_b32 a77, 0
v_accvgpr_write_b32 a78, 0
v_accvgpr_write_b32 a79, 0
v_accvgpr_write_b32 a80, 0
v_accvgpr_write_b32 a81, 0
v_accvgpr_write_b32 a82, 0
v_accvgpr_write_b32 a83, 0
v_accvgpr_write_b32 a84, 0
v_accvgpr_write_b32 a85, 0
v_accvgpr_write_b32 a86, 0
v_accvgpr_write_b32 a87, 0
v_accvgpr_write_b32 a88, 0
v_accvgpr_write_b32 a89, 0
v_accvgpr_write_b32 a90, 0
v_accvgpr_write_b32 a91, 0
v_accvgpr_write_b32 a92, 0
v_accvgpr_write_b32 a93, 0
v_accvgpr_write_b32 a94, 0
v_accvgpr_write_b32 a95, 0
v_accvgpr_write_b32 a96, 0
v_accvgpr_write_b32 a97, 0
v_accvgpr_write_b32 a98, 0
v_accvgpr_write_b32 a99, 0
v_accvgpr_write_b32 a100, 0
v_accvgpr_write_b32 a101, 0
v_accvgpr_write_b32 a102, 0
v_accvgpr_write_b32 a103, 0
v_accvgpr_write_b32 a104, 0
v_accvgpr_write_b32 a105, 0
v_accvgpr_write_b32 a106, 0
v_accvgpr_write_b32 a107, 0
v_accvgpr_write_b32 a108, 0
v_accvgpr_write_b32 a109, 0
v_accvgpr_write_b32 a110, 0
v_accvgpr_write_b32 a111, 0
v_accvgpr_write_b32 a112, 0
v_accvgpr_write_b32 a113, 0
v_accvgpr_write_b32 a114, 0
v_accvgpr_write_b32 a115, 0
v_accvgpr_write_b32 a116, 0
v_accvgpr_write_b32 a117, 0
v_accvgpr_write_b32 a118, 0
v_accvgpr_write_b32 a119, 0
v_accvgpr_write_b32 a120, 0
v_accvgpr_write_b32 a121, 0
v_accvgpr_write_b32 a122, 0
v_accvgpr_write_b32 a123, 0
v_accvgpr_write_b32 a124, 0
v_accvgpr_write_b32 a125, 0
v_accvgpr_write_b32 a126, 0
v_accvgpr_write_b32 a127, 0
v_accvgpr_write_b32 a128, 0
v_accvgpr_write_b32 a129, 0
v_accvgpr_write_b32 a130, 0
v_accvgpr_write_b32 a131, 0
v_accvgpr_write_b32 a132, 0
v_accvgpr_write_b32 a133, 0
v_accvgpr_write_b32 a134, 0
v_accvgpr_write_b32 a135, 0
v_accvgpr_write_b32 a136, 0
v_accvgpr_write_b32 a137, 0
v_accvgpr_write_b32 a138, 0
v_accvgpr_write_b32 a139, 0
v_accvgpr_write_b32 a140, 0
v_accvgpr_write_b32 a141, 0
v_accvgpr_write_b32 a142, 0
v_accvgpr_write_b32 a143, 0
v_accvgpr_write_b32 a144, 0
v_accvgpr_write_b32 a145, 0
v_accvgpr_write_b32 a146, 0
v_accvgpr_write_b32 a147, 0
v_accvgpr_write_b32 a148, 0
v_accvgpr_write_b32 a149, 0
v_accvgpr_write_b32 a150, 0
v_accvgpr_write_b32 a151, 0
v_accvgpr_write_b32 a152, 0
v_accvgpr_write_b32 a153, 0
v_accvgpr_write_b32 a154, 0
v_accvgpr_write_b32 a155, 0
v_accvgpr_write_b32 a156, 0
v_accvgpr_write_b32 a157, 0
v_accvgpr_write_b32 a158, 0
v_accvgpr_write_b32 a159, 0
v_accvgpr_write_b32 a160, 0
v_accvgpr_write_b32 a161, 0
v_accvgpr_write_b32 a162, 0
v_accvgpr_write_b32 a163, 0
v_accvgpr_write_b32 a164, 0
v_accvgpr_write_b32 a165, 0
v_accvgpr_write_b32 a166, 0
v_accvgpr_write_b32 a167, 0
v_accvgpr_write_b32 a168, 0
v_accvgpr_write_b32 a169, 0
v_accvgpr_write_b32 a170, 0
v_accvgpr_write_b32 a171, 0
v_accvgpr_write_b32 a172, 0
v_accvgpr_write_b32 a173, 0
v_accvgpr_write_b32 a174, 0
v_accvgpr_write_b32 a175, 0
v_accvgpr_write_b32 a176, 0
v_accvgpr_write_b32 a177, 0
v_accvgpr_write_b32 a178, 0
v_accvgpr_write_b32 a179, 0
v_accvgpr_write_b32 a180, 0
v_accvgpr_write_b32 a181, 0
v_accvgpr_write_b32 a182, 0
v_accvgpr_write_b32 a183, 0
v_accvgpr_write_b32 a184, 0
v_accvgpr_write_b32 a185, 0
v_accvgpr_write_b32 a186, 0
v_accvgpr_write_b32 a187, 0
v_accvgpr_write_b32 a188, 0
v_accvgpr_write_b32 a189, 0
v_accvgpr_write_b32 a190, 0
v_accvgpr_write_b32 a191, 0
v_accvgpr_write_b32 a192, 0
v_accvgpr_write_b32 a193, 0
v_accvgpr_write_b32 a194, 0
v_accvgpr_write_b32 a195, 0
v_accvgpr_write_b32 a196, 0
v_accvgpr_write_b32 a197, 0
v_accvgpr_write_b32 a198, 0
v_accvgpr_write_b32 a199, 0
v_accvgpr_write_b32 a200, 0
v_accvgpr_write_b32 a201, 0
v_accvgpr_write_b32 a202, 0
v_accvgpr_write_b32 a203, 0
v_accvgpr_write_b32 a204, 0
v_accvgpr_write_b32 a205, 0
v_accvgpr_write_b32 a206, 0
v_accvgpr_write_b32 a207, 0
v_accvgpr_write_b32 a208, 0
v_accvgpr_write_b32 a209, 0
v_accvgpr_write_b32 a210, 0
v_accvgpr_write_b32 a211, 0
v_accvgpr_write_b32 a212, 0
v_accvgpr_write_b32 a213, 0
v_accvgpr_write_b32 a214, 0
v_accvgpr_write_b32 a215, 0
v_accvgpr_write_b32 a216, 0
v_accvgpr_write_b32 a217, 0
v_accvgpr_write_b32 a218, 0
v_accvgpr_write_b32 a219, 0
v_accvgpr_write_b32 a220, 0
v_accvgpr_write_b32 a221, 0
v_accvgpr_write_b32 a222, 0
v_accvgpr_write_b32 a223, 0
v_accvgpr_write_b32 a224, 0
v_accvgpr_write_b32 a225, 0
v_accvgpr_write_b32 a226, 0
v_accvgpr_write_b32 a227, 0
v_accvgpr_write_b32 a228, 0
v_accvgpr_write_b32 a229, 0
v_accvgpr_write_b32 a230, 0
v_accvgpr_write_b32 a231, 0
v_accvgpr_write_b32 a232, 0
v_accvgpr_write_b32 a233, 0
v_accvgpr_write_b32 a234, 0
v_accvgpr_write_b32 a235, 0
v_accvgpr_write_b32 a236, 0
v_accvgpr_write_b32 a237, 0
v_accvgpr_write_b32 a238, 0
v_accvgpr_write_b32 a239, 0
v_accvgpr_write_b32 a240, 0
v_accvgpr_write_b32 a241, 0
v_accvgpr_write_b32 a242, 0
v_accvgpr_write_b32 a243, 0
v_accvgpr_write_b32 a244, 0
v_accvgpr_write_b32 a245, 0
v_accvgpr_write_b32 a246, 0
v_accvgpr_write_b32 a247, 0
v_accvgpr_write_b32 a248, 0
v_accvgpr_write_b32 a249, 0
v_accvgpr_write_b32 a250, 0
v_accvgpr_write_b32 a251, 0
v_accvgpr_write_b32 a252, 0
v_accvgpr_write_b32 a253, 0
v_accvgpr_write_b32 a254, 0
v_accvgpr_write_b32 a255, 0
s_waitcnt vmcnt(22)
s_barrier
ds_read_b128 v[8:11], v77 offset:0
ds_read_b64_tr_b16 v[40:41], v78 offset:0
ds_read_b64_tr_b16 v[42:43], v78 offset:4096
ds_read_b64_tr_b16 v[44:45], v79 offset:0
ds_read_b64_tr_b16 v[46:47], v79 offset:4096
ds_read_b64_tr_b16 v[48:49], v80 offset:0
ds_read_b64_tr_b16 v[50:51], v80 offset:4096
ds_read_b64_tr_b16 v[52:53], v81 offset:0
ds_read_b64_tr_b16 v[54:55], v81 offset:4096
ds_read_b128 v[12:15], v77 offset:2048
ds_read_b128 v[16:19], v77 offset:4096
ds_read_b128 v[20:23], v77 offset:6144
.Lgl_340:
s_waitcnt lgkmcnt(0)
v_mfma_f32_32x32x16_bf16 a[0:15], v[8:11], v[40:43], a[0:15]
ds_read_b128 v[24:27], v77 offset:1024
ds_read_b64_tr_b16 v[56:57], v78 offset:8192
v_mfma_f32_32x32x16_bf16 a[16:31], v[8:11], v[44:47], a[16:31]
ds_read_b64_tr_b16 v[58:59], v78 offset:12288
ds_read_b64_tr_b16 v[60:61], v79 offset:8192
v_mfma_f32_32x32x16_bf16 a[32:47], v[8:11], v[48:51], a[32:47]
ds_read_b64_tr_b16 v[62:63], v79 offset:12288
ds_read_b64_tr_b16 v[64:65], v80 offset:8192
v_mfma_f32_32x32x16_bf16 a[48:63], v[8:11], v[52:55], a[48:63]
ds_read_b64_tr_b16 v[66:67], v80 offset:12288
ds_read_b64_tr_b16 v[68:69], v81 offset:8192
v_mfma_f32_32x32x16_bf16 a[64:79], v[12:15], v[40:43], a[64:79]
ds_read_b64_tr_b16 v[70:71], v81 offset:12288
ds_read_b128 v[28:31], v77 offset:3072
v_mfma_f32_32x32x16_bf16 a[80:95], v[12:15], v[44:47], a[80:95]
ds_read_b128 v[32:35], v77 offset:5120
ds_read_b128 v[36:39], v77 offset:7168
v_mfma_f32_32x32x16_bf16 a[96:111], v[12:15], v[48:51], a[96:111]
s_add_u32 s51, s51, 32768
s_cmp_eq_u32 s51, 131072
s_cselect_b32 s51, 0, s51
v_add_u32 v77, s51, v72
v_add_u32 v78, s51, v73
v_mfma_f32_32x32x16_bf16 a[112:127], v[12:15], v[52:55], a[112:127]
v_add_u32 v79, s51, v74
v_mfma_f32_32x32x16_bf16 a[128:143], v[16:19], v[40:43], a[128:143]
v_add_u32 v80, s51, v75
v_mfma_f32_32x32x16_bf16 a[144:159], v[16:19], v[44:47], a[144:159]
v_add_u32 v81, s51, v76
v_mfma_f32_32x32x16_bf16 a[160:175], v[16:19], v[48:51], a[160:175]
s_lshl_b32 s53, s3, 10
s_add_u32 s53, s53, s52
s_add_u32 m0, s53, 16384
s_mov_b32 s57, s49
buffer_load_dwordx4 v83, s[44:47], s57 offen lds
v_mfma_f32_32x32x16_bf16 a[176:191], v[16:19], v[52:55], a[176:191]
s_add_u32 m0, m0, 4096
s_add_u32 s57, s57, s54
buffer_load_dwordx4 v83, s[44:47], s57 offen lds
v_mfma_f32_32x32x16_bf16 a[192:207], v[20:23], v[40:43], a[192:207]
s_add_u32 m0, m0, 4096
s_add_u32 s57, s57, s54
buffer_load_dwordx4 v83, s[44:47], s57 offen lds
v_mfma_f32_32x32x16_bf16 a[208:223], v[20:23], v[44:47], a[208:223]
s_add_u32 m0, m0, 4096
s_add_u32 s57, s57, s54
buffer_load_dwordx4 v83, s[44:47], s57 offen lds
v_mfma_f32_32x32x16_bf16 a[224:239], v[20:23], v[48:51], a[224:239]
buffer_load_dwordx4 v[248:251], v5, s[20:23], s24 offen
s_add_u32 s24, s24, 1024
s_cmp_lt_u32 s24, s25
s_cselect_b32 s22, s22, 0
v_mfma_f32_32x32x16_bf16 a[240:255], v[20:23], v[52:55], a[240:255]
s_add_u32 s48, s48, 2048
s_add_u32 s49, s49, s55
s_add_u32 s52, s52, 32768
s_cmp_eq_u32 s52, 131072
s_cselect_b32 s52, 0, s52
s_sub_u32 s58, s58, 1
s_cmp_gt_i32 s58, 0
s_cselect_b32 s42, s42, 0
s_cselect_b32 s46, s46, 0
s_waitcnt lgkmcnt(0)
v_mfma_f32_32x32x16_bf16 a[0:15], v[24:27], v[56:59], a[0:15]
s_waitcnt vmcnt(18)
s_barrier
ds_read_b128 v[8:11], v77 offset:0
ds_read_b64_tr_b16 v[40:41], v78 offset:0
v_mfma_f32_32x32x16_bf16 a[16:31], v[24:27], v[60:63], a[16:31]
ds_read_b64_tr_b16 v[42:43], v78 offset:4096
ds_read_b64_tr_b16 v[44:45], v79 offset:0
v_mfma_f32_32x32x16_bf16 a[32:47], v[24:27], v[64:67], a[32:47]
ds_read_b64_tr_b16 v[46:47], v79 offset:4096
ds_read_b64_tr_b16 v[48:49], v80 offset:0
v_mfma_f32_32x32x16_bf16 a[48:63], v[24:27], v[68:71], a[48:63]
ds_read_b64_tr_b16 v[50:51], v80 offset:4096
ds_read_b64_tr_b16 v[52:53], v81 offset:0
v_mfma_f32_32x32x16_bf16 a[64:79], v[28:31], v[56:59], a[64:79]
ds_read_b64_tr_b16 v[54:55], v81 offset:4096
ds_read_b128 v[12:15], v77 offset:2048
v_mfma_f32_32x32x16_bf16 a[80:95], v[28:31], v[60:63], a[80:95]
ds_read_b128 v[16:19], v77 offset:4096
ds_read_b128 v[20:23], v77 offset:6144
v_mfma_f32_32x32x16_bf16 a[96:111], v[28:31], v[64:67], a[96:111]
s_add_u32 m0, s52, s56
s_nop 0
buffer_load_dwordx4 v82, s[40:43], s48 offen sc1 lds
v_mfma_f32_32x32x16_bf16 a[112:127], v[28:31], v[68:71], a[112:127]
v_mfma_f32_32x32x16_bf16 a[128:143], v[32:35], v[56:59], a[128:143]
buffer_load_dwordx4 v82, s[40:43], s48 offen offset:1024 sc1 lds
v_mfma_f32_32x32x16_bf16 a[144:159], v[32:35], v[60:63], a[144:159]
v_mfma_f32_32x32x16_bf16 a[160:175], v[32:35], v[64:67], a[160:175]
v_mfma_f32_32x32x16_bf16 a[176:191], v[32:35], v[68:71], a[176:191]
s_add_u32 m0, m0, 2048
s_add_u32 s57, s48, 65536
buffer_load_dwordx4 v82, s[40:43], s57 offen sc1 lds
v_mfma_f32_32x32x16_bf16 a[192:207], v[36:39], v[56:59], a[192:207]
v_mfma_f32_32x32x16_bf16 a[208:223], v[36:39], v[60:63], a[208:223]
buffer_load_dwordx4 v82, s[40:43], s57 offen offset:1024 sc1 lds
v_mfma_f32_32x32x16_bf16 a[224:239], v[36:39], v[64:67], a[224:239]
v_mfma_f32_32x32x16_bf16 a[240:255], v[36:39], v[68:71], a[240:255]
s_sub_u32 s50, s50, 1
s_cmp_lg_u32 s50, 0
s_cbranch_scc1 .Lgl_340
s_waitcnt vmcnt(0) lgkmcnt(0)
s_nop 15
.Lepi_338:
s_lshl_b32 s12, s83, 24
s_add_u32 s12, s12, 16777216
s_add_u32 s36, s4, s12
s_addc_u32 s37, s5, 0
s_mov_b32 s38, 16777216
s_mov_b32 s39, 0x00020000
s_lshr_b32 s12, s3, 1
s_mul_i32 s12, s12, 4
s_lshl_b32 s13, s84, 3
s_add_u32 s12, s12, s13
s_lshl_b32 s12, s12, 18
s_and_b32 s13, s3, 1
s_mul_i32 s13, s13, 8
s_mul_i32 s14, s85, 16
s_add_u32 s13, s13, s14
s_lshl_b32 s13, s13, 10
s_add_u32 s12, s12, s13
v_lshlrev_b32 v2, 4, v0
s_cmp_eq_u32 s83, 0
s_cbranch_scc1 .Lsq_322
s_lshl_b32 s86, s84, 2
s_add_u32 s86, s86, s76
s_lshl_b32 s86, s86, 7
s_add_u32 s86, s86, 2048
s_branch .Lsd_323
.Lsq_322:
s_lshl_b32 s86, s84, 7
s_add_u32 s86, s86, 10240
.Lsd_323:
s_cmp_eq_u32 s79, 3
s_cbranch_scc1 .Le3_319
s_lshr_b32 s81, s77, 3
s_add_u32 s84, s81, 7
s_bfe_u32 s83, s77, 0x10002
s_add_u32 s83, s83, 1
s_and_b32 s85, s77, 3
s_lshl_b32 s81, s76, 2
s_add_u32 s85, s85, s81
s_cmp_lt_u32 s77, 8
s_cbranch_scc1 .Lgo_321
s_mov_b32 s83, 0
s_add_u32 s84, s76, 1
s_and_b32 s84, s84, 3
s_sub_u32 s85, s77, 8
s_cmp_lt_u32 s77, 24
s_cbranch_scc1 .Lgo_321
s_lshl_b32 s81, s76, 3
s_add_u32 s81, s81, s77
s_sub_u32 s81, s81, 24
s_lshr_b32 s84, s81, 4
s_add_u32 s84, s84, 4
s_and_b32 s85, s81, 15
.Lgo_321:
s_barrier
s_lshl_b32 s13, s83, 3
s_add_u32 s13, s13, 16
s_load_dwordx2 s[6:7], s[0:1], s13
s_load_dwordx2 s[20:21], s[0:1], 72
s_mov_b32 s22, 7340032
s_mov_b32 s23, 0x00020000
v_lshlrev_b32 v5, 4, v0
s_lshl_b32 s24, s76, 5
s_add_u32 s24, s24, s77
s_lshl_b32 s24, s24, 2
s_add_u32 s24, s24, s3
s_mul_i32 s24, s24, 14336
s_add_u32 s25, s24, 14336
s_add_u32 s40, s4, 0x0
s_addc_u32 s41, s5, 0
s_mov_b32 s42, 0x400000
s_mov_b32 s43, 0x00020000
s_lshr_b32 s53, s3, 1
s_mul_i32 s53, s53, 8192
v_lshlrev_b32 v72, 4, v0
v_add_u32 v72, s53, v72
v_lshrrev_b32 v84, 2, v0
v_and_b32 v84, 3, v84
v_lshrrev_b32 v85, 5, v0
v_lshlrev_b32 v85, 2, v85
v_add_u32 v85, v85, v84
v_mul_u32_u24 v85, 512, v85
v_and_b32 v86, 3, v0
v_lshlrev_b32 v86, 3, v86
v_add_u32 v85, v85, v86
v_and_b32 v86, 16, v0
v_lshlrev_b32 v86, 1, v86
v_add_u32 v85, v85, v86
v_add_u32 v85, 16384, v85
s_and_b32 s53, s3, 1
s_mul_i32 s53, s53, 4
s_add_u32 s57, s53, 0
v_xor_b32 v86, s57, v84
v_lshlrev_b32 v86, 6, v86
v_add_u32 v73, v85, v86
s_add_u32 s57, s53, 1
v_xor_b32 v86, s57, v84
v_lshlrev_b32 v86, 6, v86
v_add_u32 v74, v85, v86
s_add_u32 s57, s53, 2
v_xor_b32 v86, s57, v84
v_lshlrev_b32 v86, 6, v86
v_add_u32 v75, v85, v86
s_add_u32 s57, s53, 3
v_xor_b32 v86, s57, v84
v_lshlrev_b32 v86, 6, v86
v_add_u32 v76, v85, v86
s_mul_i32 s53, s3, 131072
v_lshlrev_b32 v82, 4, v0
v_add_u32 v82, s53, v82
v_lshrrev_b32 v84, 5, v0
s_mul_i32 s53, s3, 2
v_add_u32 v84, s53, v84
v_and_b32 v85, 3, v84
v_and_b32 v86, 31, v0
v_lshrrev_b32 v86, 2, v86
v_xor_b32 v85, v85, v86
v_lshlrev_b32 v85, 6, v85
v_and_b32 v86, 3, v0
v_lshlrev_b32 v86, 4, v86
v_add_u32 v85, v85, v86
s_mov_b32 s53, 8192
v_mul_lo_u32 v84, v84, s53
v_add_u32 v83, v84, v85
s_mov_b32 s54, 65536
s_mov_b32 s55, 262144
s_mul_i32 s56, s3, 4096
s_waitcnt lgkmcnt(0)
s_mov_b32 s44, s6
s_mov_b32 s45, s7
s_mov_b32 s46, 0x800000
s_mov_b32 s47, 0x00020000
s_mul_i32 s48, s84, 524288
s_mul_i32 s49, s85, 512
s_mov_b32 s50, 32
s_mov_b32 s52, 0
s_mov_b32 s58, s50
s_add_u32 s57, s12, 0
v_accvgpr_read_b32 v8, a0
v_accvgpr_read_b32 v9, a1
v_accvgpr_read_b32 v10, a2
v_accvgpr_read_b32 v11, a3
v_accvgpr_read_b32 v12, a4
v_accvgpr_read_b32 v13, a5
v_accvgpr_read_b32 v14, a6
v_accvgpr_read_b32 v15, a7
v_cvt_pk_bf16_f32 v16, v8, v9
v_cvt_pk_bf16_f32 v17, v10, v11
v_cvt_pk_bf16_f32 v18, v12, v13
v_cvt_pk_bf16_f32 v19, v14, v15
buffer_store_dwordx4 v[16:19], v2, s[36:39], s57 offen offset:0 sc1
v_accvgpr_read_b32 v20, a8
v_accvgpr_read_b32 v21, a9
v_accvgpr_read_b32 v22, a10
v_accvgpr_read_b32 v23, a11
v_accvgpr_read_b32 v24, a12
v_accvgpr_read_b32 v25, a13
v_accvgpr_read_b32 v26, a14
v_accvgpr_read_b32 v27, a15
v_cvt_pk_bf16_f32 v28, v20, v21
v_cvt_pk_bf16_f32 v29, v22, v23
v_cvt_pk_bf16_f32 v30, v24, v25
v_cvt_pk_bf16_f32 v31, v26, v27
buffer_store_dwordx4 v[28:31], v2, s[36:39], s57 offen offset:1024 sc1
v_accvgpr_read_b32 v8, a16
v_accvgpr_read_b32 v9, a17
v_accvgpr_read_b32 v10, a18
v_accvgpr_read_b32 v11, a19
v_accvgpr_read_b32 v12, a20
v_accvgpr_read_b32 v13, a21
v_accvgpr_read_b32 v14, a22
v_accvgpr_read_b32 v15, a23
v_cvt_pk_bf16_f32 v16, v8, v9
v_cvt_pk_bf16_f32 v17, v10, v11
v_cvt_pk_bf16_f32 v18, v12, v13
v_cvt_pk_bf16_f32 v19, v14, v15
buffer_store_dwordx4 v[16:19], v2, s[36:39], s57 offen offset:2048 sc1
v_accvgpr_read_b32 v20, a24
v_accvgpr_read_b32 v21, a25
v_accvgpr_read_b32 v22, a26
v_accvgpr_read_b32 v23, a27
v_accvgpr_read_b32 v24, a28
v_accvgpr_read_b32 v25, a29
v_accvgpr_read_b32 v26, a30
v_accvgpr_read_b32 v27, a31
v_cvt_pk_bf16_f32 v28, v20, v21
v_cvt_pk_bf16_f32 v29, v22, v23
v_cvt_pk_bf16_f32 v30, v24, v25
v_cvt_pk_bf16_f32 v31, v26, v27
buffer_store_dwordx4 v[28:31], v2, s[36:39], s57 offen offset:3072 sc1
v_accvgpr_read_b32 v8, a32
v_accvgpr_read_b32 v9, a33
v_accvgpr_read_b32 v10, a34
v_accvgpr_read_b32 v11, a35
v_accvgpr_read_b32 v12, a36
v_accvgpr_read_b32 v13, a37
v_accvgpr_read_b32 v14, a38
v_accvgpr_read_b32 v15, a39
v_cvt_pk_bf16_f32 v16, v8, v9
v_cvt_pk_bf16_f32 v17, v10, v11
v_cvt_pk_bf16_f32 v18, v12, v13
v_cvt_pk_bf16_f32 v19, v14, v15
s_add_u32 s57, s57, 4096
buffer_store_dwordx4 v[16:19], v2, s[36:39], s57 offen offset:0 sc1
v_accvgpr_read_b32 v20, a40
v_accvgpr_read_b32 v21, a41
v_accvgpr_read_b32 v22, a42
v_accvgpr_read_b32 v23, a43
v_accvgpr_read_b32 v24, a44
v_accvgpr_read_b32 v25, a45
v_accvgpr_read_b32 v26, a46
v_accvgpr_read_b32 v27, a47
v_cvt_pk_bf16_f32 v28, v20, v21
v_cvt_pk_bf16_f32 v29, v22, v23
v_cvt_pk_bf16_f32 v30, v24, v25
v_cvt_pk_bf16_f32 v31, v26, v27
buffer_store_dwordx4 v[28:31], v2, s[36:39], s57 offen offset:1024 sc1
v_accvgpr_read_b32 v8, a48
v_accvgpr_read_b32 v9, a49
v_accvgpr_read_b32 v10, a50
v_accvgpr_read_b32 v11, a51
v_accvgpr_read_b32 v12, a52
v_accvgpr_read_b32 v13, a53
v_accvgpr_read_b32 v14, a54
v_accvgpr_read_b32 v15, a55
v_cvt_pk_bf16_f32 v16, v8, v9
v_cvt_pk_bf16_f32 v17, v10, v11
v_cvt_pk_bf16_f32 v18, v12, v13
v_cvt_pk_bf16_f32 v19, v14, v15
buffer_store_dwordx4 v[16:19], v2, s[36:39], s57 offen offset:2048 sc1
v_accvgpr_read_b32 v20, a56
v_accvgpr_read_b32 v21, a57
v_accvgpr_read_b32 v22, a58
v_accvgpr_read_b32 v23, a59
v_accvgpr_read_b32 v24, a60
v_accvgpr_read_b32 v25, a61
v_accvgpr_read_b32 v26, a62
v_accvgpr_read_b32 v27, a63
v_cvt_pk_bf16_f32 v28, v20, v21
v_cvt_pk_bf16_f32 v29, v22, v23
v_cvt_pk_bf16_f32 v30, v24, v25
v_cvt_pk_bf16_f32 v31, v26, v27
buffer_store_dwordx4 v[28:31], v2, s[36:39], s57 offen offset:3072 sc1
s_add_u32 s57, s12, 262144
v_accvgpr_read_b32 v8, a64
v_accvgpr_read_b32 v9, a65
v_accvgpr_read_b32 v10, a66
v_accvgpr_read_b32 v11, a67
v_accvgpr_read_b32 v12, a68
v_accvgpr_read_b32 v13, a69
v_accvgpr_read_b32 v14, a70
v_accvgpr_read_b32 v15, a71
v_cvt_pk_bf16_f32 v16, v8, v9
v_cvt_pk_bf16_f32 v17, v10, v11
v_cvt_pk_bf16_f32 v18, v12, v13
v_cvt_pk_bf16_f32 v19, v14, v15
buffer_store_dwordx4 v[16:19], v2, s[36:39], s57 offen offset:0 sc1
v_accvgpr_read_b32 v20, a72
v_accvgpr_read_b32 v21, a73
v_accvgpr_read_b32 v22, a74
v_accvgpr_read_b32 v23, a75
v_accvgpr_read_b32 v24, a76
v_accvgpr_read_b32 v25, a77
v_accvgpr_read_b32 v26, a78
v_accvgpr_read_b32 v27, a79
v_cvt_pk_bf16_f32 v28, v20, v21
v_cvt_pk_bf16_f32 v29, v22, v23
v_cvt_pk_bf16_f32 v30, v24, v25
v_cvt_pk_bf16_f32 v31, v26, v27
buffer_store_dwordx4 v[28:31], v2, s[36:39], s57 offen offset:1024 sc1
v_accvgpr_read_b32 v8, a80
v_accvgpr_read_b32 v9, a81
v_accvgpr_read_b32 v10, a82
v_accvgpr_read_b32 v11, a83
v_accvgpr_read_b32 v12, a84
v_accvgpr_read_b32 v13, a85
v_accvgpr_read_b32 v14, a86
v_accvgpr_read_b32 v15, a87
v_cvt_pk_bf16_f32 v16, v8, v9
v_cvt_pk_bf16_f32 v17, v10, v11
v_cvt_pk_bf16_f32 v18, v12, v13
v_cvt_pk_bf16_f32 v19, v14, v15
buffer_store_dwordx4 v[16:19], v2, s[36:39], s57 offen offset:2048 sc1
v_accvgpr_read_b32 v20, a88
v_accvgpr_read_b32 v21, a89
v_accvgpr_read_b32 v22, a90
v_accvgpr_read_b32 v23, a91
v_accvgpr_read_b32 v24, a92
v_accvgpr_read_b32 v25, a93
v_accvgpr_read_b32 v26, a94
v_accvgpr_read_b32 v27, a95
v_cvt_pk_bf16_f32 v28, v20, v21
v_cvt_pk_bf16_f32 v29, v22, v23
v_cvt_pk_bf16_f32 v30, v24, v25
v_cvt_pk_bf16_f32 v31, v26, v27
buffer_store_dwordx4 v[28:31], v2, s[36:39], s57 offen offset:3072 sc1
v_accvgpr_read_b32 v8, a96
v_accvgpr_read_b32 v9, a97
v_accvgpr_read_b32 v10, a98
v_accvgpr_read_b32 v11, a99
v_accvgpr_read_b32 v12, a100
v_accvgpr_read_b32 v13, a101
v_accvgpr_read_b32 v14, a102
v_accvgpr_read_b32 v15, a103
v_cvt_pk_bf16_f32 v16, v8, v9
v_cvt_pk_bf16_f32 v17, v10, v11
v_cvt_pk_bf16_f32 v18, v12, v13
v_cvt_pk_bf16_f32 v19, v14, v15
s_add_u32 s57, s57, 4096
buffer_store_dwordx4 v[16:19], v2, s[36:39], s57 offen offset:0 sc1
v_accvgpr_read_b32 v20, a104
v_accvgpr_read_b32 v21, a105
v_accvgpr_read_b32 v22, a106
v_accvgpr_read_b32 v23, a107
v_accvgpr_read_b32 v24, a108
v_accvgpr_read_b32 v25, a109
v_accvgpr_read_b32 v26, a110
v_accvgpr_read_b32 v27, a111
v_cvt_pk_bf16_f32 v28, v20, v21
v_cvt_pk_bf16_f32 v29, v22, v23
v_cvt_pk_bf16_f32 v30, v24, v25
v_cvt_pk_bf16_f32 v31, v26, v27
buffer_store_dwordx4 v[28:31], v2, s[36:39], s57 offen offset:1024 sc1
v_accvgpr_read_b32 v8, a112
v_accvgpr_read_b32 v9, a113
v_accvgpr_read_b32 v10, a114
v_accvgpr_read_b32 v11, a115
v_accvgpr_read_b32 v12, a116
v_accvgpr_read_b32 v13, a117
v_accvgpr_read_b32 v14, a118
v_accvgpr_read_b32 v15, a119
v_cvt_pk_bf16_f32 v16, v8, v9
v_cvt_pk_bf16_f32 v17, v10, v11
v_cvt_pk_bf16_f32 v18, v12, v13
v_cvt_pk_bf16_f32 v19, v14, v15
buffer_store_dwordx4 v[16:19], v2, s[36:39], s57 offen offset:2048 sc1
v_accvgpr_read_b32 v20, a120
v_accvgpr_read_b32 v21, a121
v_accvgpr_read_b32 v22, a122
v_accvgpr_read_b32 v23, a123
v_accvgpr_read_b32 v24, a124
v_accvgpr_read_b32 v25, a125
v_accvgpr_read_b32 v26, a126
v_accvgpr_read_b32 v27, a127
v_cvt_pk_bf16_f32 v28, v20, v21
v_cvt_pk_bf16_f32 v29, v22, v23
v_cvt_pk_bf16_f32 v30, v24, v25
v_cvt_pk_bf16_f32 v31, v26, v27
buffer_store_dwordx4 v[28:31], v2, s[36:39], s57 offen offset:3072 sc1
s_add_u32 s57, s12, 524288
v_accvgpr_read_b32 v8, a128
v_accvgpr_read_b32 v9, a129
v_accvgpr_read_b32 v10, a130
v_accvgpr_read_b32 v11, a131
v_accvgpr_read_b32 v12, a132
v_accvgpr_read_b32 v13, a133
v_accvgpr_read_b32 v14, a134
v_accvgpr_read_b32 v15, a135
v_cvt_pk_bf16_f32 v16, v8, v9
v_cvt_pk_bf16_f32 v17, v10, v11
v_cvt_pk_bf16_f32 v18, v12, v13
v_cvt_pk_bf16_f32 v19, v14, v15
buffer_store_dwordx4 v[16:19], v2, s[36:39], s57 offen offset:0 sc1
v_accvgpr_read_b32 v20, a136
v_accvgpr_read_b32 v21, a137
v_accvgpr_read_b32 v22, a138
v_accvgpr_read_b32 v23, a139
v_accvgpr_read_b32 v24, a140
v_accvgpr_read_b32 v25, a141
v_accvgpr_read_b32 v26, a142
v_accvgpr_read_b32 v27, a143
v_cvt_pk_bf16_f32 v28, v20, v21
v_cvt_pk_bf16_f32 v29, v22, v23
v_cvt_pk_bf16_f32 v30, v24, v25
v_cvt_pk_bf16_f32 v31, v26, v27
buffer_store_dwordx4 v[28:31], v2, s[36:39], s57 offen offset:1024 sc1
v_accvgpr_read_b32 v8, a144
v_accvgpr_read_b32 v9, a145
v_accvgpr_read_b32 v10, a146
v_accvgpr_read_b32 v11, a147
v_accvgpr_read_b32 v12, a148
v_accvgpr_read_b32 v13, a149
v_accvgpr_read_b32 v14, a150
v_accvgpr_read_b32 v15, a151
v_cvt_pk_bf16_f32 v16, v8, v9
v_cvt_pk_bf16_f32 v17, v10, v11
v_cvt_pk_bf16_f32 v18, v12, v13
v_cvt_pk_bf16_f32 v19, v14, v15
buffer_store_dwordx4 v[16:19], v2, s[36:39], s57 offen offset:2048 sc1
v_accvgpr_read_b32 v20, a152
v_accvgpr_read_b32 v21, a153
v_accvgpr_read_b32 v22, a154
v_accvgpr_read_b32 v23, a155
v_accvgpr_read_b32 v24, a156
v_accvgpr_read_b32 v25, a157
v_accvgpr_read_b32 v26, a158
v_accvgpr_read_b32 v27, a159
v_cvt_pk_bf16_f32 v28, v20, v21
v_cvt_pk_bf16_f32 v29, v22, v23
v_cvt_pk_bf16_f32 v30, v24, v25
v_cvt_pk_bf16_f32 v31, v26, v27
buffer_store_dwordx4 v[28:31], v2, s[36:39], s57 offen offset:3072 sc1
v_accvgpr_read_b32 v8, a160
v_accvgpr_read_b32 v9, a161
v_accvgpr_read_b32 v10, a162
v_accvgpr_read_b32 v11, a163
v_accvgpr_read_b32 v12, a164
v_accvgpr_read_b32 v13, a165
v_accvgpr_read_b32 v14, a166
v_accvgpr_read_b32 v15, a167
v_cvt_pk_bf16_f32 v16, v8, v9
v_cvt_pk_bf16_f32 v17, v10, v11
v_cvt_pk_bf16_f32 v18, v12, v13
v_cvt_pk_bf16_f32 v19, v14, v15
s_add_u32 s57, s57, 4096
buffer_store_dwordx4 v[16:19], v2, s[36:39], s57 offen offset:0 sc1
v_accvgpr_read_b32 v20, a168
v_accvgpr_read_b32 v21, a169
v_accvgpr_read_b32 v22, a170
v_accvgpr_read_b32 v23, a171
v_accvgpr_read_b32 v24, a172
v_accvgpr_read_b32 v25, a173
v_accvgpr_read_b32 v26, a174
v_accvgpr_read_b32 v27, a175
v_cvt_pk_bf16_f32 v28, v20, v21
v_cvt_pk_bf16_f32 v29, v22, v23
v_cvt_pk_bf16_f32 v30, v24, v25
v_cvt_pk_bf16_f32 v31, v26, v27
buffer_store_dwordx4 v[28:31], v2, s[36:39], s57 offen offset:1024 sc1
v_accvgpr_read_b32 v8, a176
v_accvgpr_read_b32 v9, a177
v_accvgpr_read_b32 v10, a178
v_accvgpr_read_b32 v11, a179
v_accvgpr_read_b32 v12, a180
v_accvgpr_read_b32 v13, a181
v_accvgpr_read_b32 v14, a182
v_accvgpr_read_b32 v15, a183
v_cvt_pk_bf16_f32 v16, v8, v9
v_cvt_pk_bf16_f32 v17, v10, v11
v_cvt_pk_bf16_f32 v18, v12, v13
v_cvt_pk_bf16_f32 v19, v14, v15
buffer_store_dwordx4 v[16:19], v2, s[36:39], s57 offen offset:2048 sc1
v_accvgpr_read_b32 v20, a184
v_accvgpr_read_b32 v21, a185
v_accvgpr_read_b32 v22, a186
v_accvgpr_read_b32 v23, a187
v_accvgpr_read_b32 v24, a188
v_accvgpr_read_b32 v25, a189
v_accvgpr_read_b32 v26, a190
v_accvgpr_read_b32 v27, a191
v_cvt_pk_bf16_f32 v28, v20, v21
v_cvt_pk_bf16_f32 v29, v22, v23
v_cvt_pk_bf16_f32 v30, v24, v25
v_cvt_pk_bf16_f32 v31, v26, v27
buffer_store_dwordx4 v[28:31], v2, s[36:39], s57 offen offset:3072 sc1
s_add_u32 s57, s12, 786432
v_accvgpr_read_b32 v8, a192
v_accvgpr_read_b32 v9, a193
v_accvgpr_read_b32 v10, a194
v_accvgpr_read_b32 v11, a195
v_accvgpr_read_b32 v12, a196
v_accvgpr_read_b32 v13, a197
v_accvgpr_read_b32 v14, a198
v_accvgpr_read_b32 v15, a199
v_cvt_pk_bf16_f32 v16, v8, v9
v_cvt_pk_bf16_f32 v17, v10, v11
v_cvt_pk_bf16_f32 v18, v12, v13
v_cvt_pk_bf16_f32 v19, v14, v15
buffer_store_dwordx4 v[16:19], v2, s[36:39], s57 offen offset:0 sc1
v_accvgpr_read_b32 v20, a200
v_accvgpr_read_b32 v21, a201
v_accvgpr_read_b32 v22, a202
v_accvgpr_read_b32 v23, a203
v_accvgpr_read_b32 v24, a204
v_accvgpr_read_b32 v25, a205
v_accvgpr_read_b32 v26, a206
v_accvgpr_read_b32 v27, a207
v_cvt_pk_bf16_f32 v28, v20, v21
v_cvt_pk_bf16_f32 v29, v22, v23
v_cvt_pk_bf16_f32 v30, v24, v25
v_cvt_pk_bf16_f32 v31, v26, v27
buffer_store_dwordx4 v[28:31], v2, s[36:39], s57 offen offset:1024 sc1
v_accvgpr_read_b32 v8, a208
v_accvgpr_read_b32 v9, a209
v_accvgpr_read_b32 v10, a210
v_accvgpr_read_b32 v11, a211
v_accvgpr_read_b32 v12, a212
v_accvgpr_read_b32 v13, a213
v_accvgpr_read_b32 v14, a214
v_accvgpr_read_b32 v15, a215
v_cvt_pk_bf16_f32 v16, v8, v9
v_cvt_pk_bf16_f32 v17, v10, v11
v_cvt_pk_bf16_f32 v18, v12, v13
v_cvt_pk_bf16_f32 v19, v14, v15
buffer_store_dwordx4 v[16:19], v2, s[36:39], s57 offen offset:2048 sc1
v_accvgpr_read_b32 v20, a216
v_accvgpr_read_b32 v21, a217
v_accvgpr_read_b32 v22, a218
v_accvgpr_read_b32 v23, a219
v_accvgpr_read_b32 v24, a220
v_accvgpr_read_b32 v25, a221
v_accvgpr_read_b32 v26, a222
v_accvgpr_read_b32 v27, a223
v_cvt_pk_bf16_f32 v28, v20, v21
v_cvt_pk_bf16_f32 v29, v22, v23
v_cvt_pk_bf16_f32 v30, v24, v25
v_cvt_pk_bf16_f32 v31, v26, v27
buffer_store_dwordx4 v[28:31], v2, s[36:39], s57 offen offset:3072 sc1
v_accvgpr_read_b32 v8, a224
v_accvgpr_read_b32 v9, a225
v_accvgpr_read_b32 v10, a226
v_accvgpr_read_b32 v11, a227
v_accvgpr_read_b32 v12, a228
v_accvgpr_read_b32 v13, a229
v_accvgpr_read_b32 v14, a230
v_accvgpr_read_b32 v15, a231
v_cvt_pk_bf16_f32 v16, v8, v9
v_cvt_pk_bf16_f32 v17, v10, v11
v_cvt_pk_bf16_f32 v18, v12, v13
v_cvt_pk_bf16_f32 v19, v14, v15
s_add_u32 s57, s57, 4096
buffer_store_dwordx4 v[16:19], v2, s[36:39], s57 offen offset:0 sc1
v_accvgpr_read_b32 v20, a232
v_accvgpr_read_b32 v21, a233
v_accvgpr_read_b32 v22, a234
v_accvgpr_read_b32 v23, a235
v_accvgpr_read_b32 v24, a236
v_accvgpr_read_b32 v25, a237
v_accvgpr_read_b32 v26, a238
v_accvgpr_read_b32 v27, a239
v_cvt_pk_bf16_f32 v28, v20, v21
v_cvt_pk_bf16_f32 v29, v22, v23
v_cvt_pk_bf16_f32 v30, v24, v25
v_cvt_pk_bf16_f32 v31, v26, v27
buffer_store_dwordx4 v[28:31], v2, s[36:39], s57 offen offset:1024 sc1
v_accvgpr_read_b32 v8, a240
v_accvgpr_read_b32 v9, a241
v_accvgpr_read_b32 v10, a242
v_accvgpr_read_b32 v11, a243
v_accvgpr_read_b32 v12, a244
v_accvgpr_read_b32 v13, a245
v_accvgpr_read_b32 v14, a246
v_accvgpr_read_b32 v15, a247
v_cvt_pk_bf16_f32 v16, v8, v9
v_cvt_pk_bf16_f32 v17, v10, v11
v_cvt_pk_bf16_f32 v18, v12, v13
v_cvt_pk_bf16_f32 v19, v14, v15
buffer_store_dwordx4 v[16:19], v2, s[36:39], s57 offen offset:2048 sc1
v_accvgpr_read_b32 v20, a248
v_accvgpr_read_b32 v21, a249
v_accvgpr_read_b32 v22, a250
v_accvgpr_read_b32 v23, a251
v_accvgpr_read_b32 v24, a252
v_accvgpr_read_b32 v25, a253
v_accvgpr_read_b32 v26, a254
v_accvgpr_read_b32 v27, a255
v_cvt_pk_bf16_f32 v28, v20, v21
v_cvt_pk_bf16_f32 v29, v22, v23
v_cvt_pk_bf16_f32 v30, v24, v25
v_cvt_pk_bf16_f32 v31, v26, v27
buffer_store_dwordx4 v[28:31], v2, s[36:39], s57 offen offset:3072 sc1
s_waitcnt vmcnt(0)
s_barrier
s_cmp_lg_u32 s3, 0
s_cbranch_scc1 .Lsg_341
v_mov_b32 v1, 1
v_mul_u32_u24 v2, 0, v0
s_mov_b64 exec, 1
buffer_atomic_add v1, v2, s[88:91], s86 offen sc1
s_mov_b64 exec, -1
.Lsg_341:
s_add_u32 m0, s52, s56
s_nop 0
buffer_load_dwordx4 v82, s[40:43], s48 offen sc1 lds
buffer_load_dwordx4 v82, s[40:43], s48 offen offset:1024 sc1 lds
s_add_u32 m0, m0, 2048
s_add_u32 s57, s48, 65536
buffer_load_dwordx4 v82, s[40:43], s57 offen sc1 lds
buffer_load_dwordx4 v82, s[40:43], s57 offen offset:1024 sc1 lds
s_lshl_b32 s53, s3, 10
s_add_u32 s53, s53, s52
s_add_u32 m0, s53, 16384
s_mov_b32 s57, s49
buffer_load_dwordx4 v83, s[44:47], s57 offen lds
s_add_u32 m0, m0, 4096
s_add_u32 s57, s57, s54
buffer_load_dwordx4 v83, s[44:47], s57 offen lds
s_add_u32 m0, m0, 4096
s_add_u32 s57, s57, s54
buffer_load_dwordx4 v83, s[44:47], s57 offen lds
s_add_u32 m0, m0, 4096
s_add_u32 s57, s57, s54
buffer_load_dwordx4 v83, s[44:47], s57 offen lds
buffer_load_dwordx4 v[248:251], v5, s[20:23], s24 offen
s_add_u32 s24, s24, 1024
s_cmp_lt_u32 s24, s25
s_cselect_b32 s22, s22, 0
s_add_u32 s48, s48, 2048
s_add_u32 s49, s49, s55
s_add_u32 s52, s52, 32768
s_cmp_eq_u32 s52, 131072
s_cselect_b32 s52, 0, s52
s_sub_u32 s58, s58, 1
s_cmp_gt_i32 s58, 0
s_cselect_b32 s42, s42, 0
s_cselect_b32 s46, s46, 0
s_add_u32 m0, s52, s56
s_nop 0
buffer_load_dwordx4 v82, s[40:43], s48 offen sc1 lds
buffer_load_dwordx4 v82, s[40:43], s48 offen offset:1024 sc1 lds
s_add_u32 m0, m0, 2048
s_add_u32 s57, s48, 65536
buffer_load_dwordx4 v82, s[40:43], s57 offen sc1 lds
buffer_load_dwordx4 v82, s[40:43], s57 offen offset:1024 sc1 lds
s_lshl_b32 s53, s3, 10
s_add_u32 s53, s53, s52
s_add_u32 m0, s53, 16384
s_mov_b32 s57, s49
buffer_load_dwordx4 v83, s[44:47], s57 offen lds
s_add_u32 m0, m0, 4096
s_add_u32 s57, s57, s54
buffer_load_dwordx4 v83, s[44:47], s57 offen lds
s_add_u32 m0, m0, 4096
s_add_u32 s57, s57, s54
buffer_load_dwordx4 v83, s[44:47], s57 offen lds
s_add_u32 m0, m0, 4096
s_add_u32 s57, s57, s54
buffer_load_dwordx4 v83, s[44:47], s57 offen lds
buffer_load_dwordx4 v[248:251], v5, s[20:23], s24 offen
s_add_u32 s24, s24, 1024
s_cmp_lt_u32 s24, s25
s_cselect_b32 s22, s22, 0
s_add_u32 s48, s48, 2048
s_add_u32 s49, s49, s55
s_add_u32 s52, s52, 32768
s_cmp_eq_u32 s52, 131072
s_cselect_b32 s52, 0, s52
s_sub_u32 s58, s58, 1
s_cmp_gt_i32 s58, 0
s_cselect_b32 s42, s42, 0
s_cselect_b32 s46, s46, 0
s_add_u32 m0, s52, s56
s_nop 0
buffer_load_dwordx4 v82, s[40:43], s48 offen sc1 lds
buffer_load_dwordx4 v82, s[40:43], s48 offen offset:1024 sc1 lds
s_add_u32 m0, m0, 2048
s_add_u32 s57, s48, 65536
buffer_load_dwordx4 v82, s[40:43], s57 offen sc1 lds
buffer_load_dwordx4 v82, s[40:43], s57 offen offset:1024 sc1 lds
s_lshl_b32 s53, s3, 10
s_add_u32 s53, s53, s52
s_add_u32 m0, s53, 16384
s_mov_b32 s57, s49
buffer_load_dwordx4 v83, s[44:47], s57 offen lds
s_add_u32 m0, m0, 4096
s_add_u32 s57, s57, s54
buffer_load_dwordx4 v83, s[44:47], s57 offen lds
s_add_u32 m0, m0, 4096
s_add_u32 s57, s57, s54
buffer_load_dwordx4 v83, s[44:47], s57 offen lds
s_add_u32 m0, m0, 4096
s_add_u32 s57, s57, s54
buffer_load_dwordx4 v83, s[44:47], s57 offen lds
buffer_load_dwordx4 v[248:251], v5, s[20:23], s24 offen
s_add_u32 s24, s24, 1024
s_cmp_lt_u32 s24, s25
s_cselect_b32 s22, s22, 0
s_add_u32 s48, s48, 2048
s_add_u32 s49, s49, s55
s_add_u32 s52, s52, 32768
s_cmp_eq_u32 s52, 131072
s_cselect_b32 s52, 0, s52
s_sub_u32 s58, s58, 1
s_cmp_gt_i32 s58, 0
s_cselect_b32 s42, s42, 0
s_cselect_b32 s46, s46, 0
s_add_u32 m0, s52, s56
s_nop 0
buffer_load_dwordx4 v82, s[40:43], s48 offen sc1 lds
buffer_load_dwordx4 v82, s[40:43], s48 offen offset:1024 sc1 lds
s_add_u32 m0, m0, 2048
s_add_u32 s57, s48, 65536
buffer_load_dwordx4 v82, s[40:43], s57 offen sc1 lds
buffer_load_dwordx4 v82, s[40:43], s57 offen offset:1024 sc1 lds
s_branch .Lj3_334
.Le3_319:
s_add_u32 s57, s12, 0
v_accvgpr_read_b32 v8, a0
v_accvgpr_read_b32 v9, a1
v_accvgpr_read_b32 v10, a2
v_accvgpr_read_b32 v11, a3
v_accvgpr_read_b32 v12, a4
v_accvgpr_read_b32 v13, a5
v_accvgpr_read_b32 v14, a6
v_accvgpr_read_b32 v15, a7
v_cvt_pk_bf16_f32 v16, v8, v9
v_cvt_pk_bf16_f32 v17, v10, v11
v_cvt_pk_bf16_f32 v18, v12, v13
v_cvt_pk_bf16_f32 v19, v14, v15
buffer_store_dwordx4 v[16:19], v2, s[36:39], s57 offen offset:0 sc1
v_accvgpr_read_b32 v20, a8
v_accvgpr_read_b32 v21, a9
v_accvgpr_read_b32 v22, a10
v_accvgpr_read_b32 v23, a11
v_accvgpr_read_b32 v24, a12
v_accvgpr_read_b32 v25, a13
v_accvgpr_read_b32 v26, a14
v_accvgpr_read_b32 v27, a15
v_cvt_pk_bf16_f32 v28, v20, v21
v_cvt_pk_bf16_f32 v29, v22, v23
v_cvt_pk_bf16_f32 v30, v24, v25
v_cvt_pk_bf16_f32 v31, v26, v27
buffer_store_dwordx4 v[28:31], v2, s[36:39], s57 offen offset:1024 sc1
v_accvgpr_read_b32 v8, a16
v_accvgpr_read_b32 v9, a17
v_accvgpr_read_b32 v10, a18
v_accvgpr_read_b32 v11, a19
v_accvgpr_read_b32 v12, a20
v_accvgpr_read_b32 v13, a21
v_accvgpr_read_b32 v14, a22
v_accvgpr_read_b32 v15, a23
v_cvt_pk_bf16_f32 v16, v8, v9
v_cvt_pk_bf16_f32 v17, v10, v11
v_cvt_pk_bf16_f32 v18, v12, v13
v_cvt_pk_bf16_f32 v19, v14, v15
buffer_store_dwordx4 v[16:19], v2, s[36:39], s57 offen offset:2048 sc1
v_accvgpr_read_b32 v20, a24
v_accvgpr_read_b32 v21, a25
v_accvgpr_read_b32 v22, a26
v_accvgpr_read_b32 v23, a27
v_accvgpr_read_b32 v24, a28
v_accvgpr_read_b32 v25, a29
v_accvgpr_read_b32 v26, a30
v_accvgpr_read_b32 v27, a31
v_cvt_pk_bf16_f32 v28, v20, v21
v_cvt_pk_bf16_f32 v29, v22, v23
v_cvt_pk_bf16_f32 v30, v24, v25
v_cvt_pk_bf16_f32 v31, v26, v27
buffer_store_dwordx4 v[28:31], v2, s[36:39], s57 offen offset:3072 sc1
v_accvgpr_read_b32 v8, a32
v_accvgpr_read_b32 v9, a33
v_accvgpr_read_b32 v10, a34
v_accvgpr_read_b32 v11, a35
v_accvgpr_read_b32 v12, a36
v_accvgpr_read_b32 v13, a37
v_accvgpr_read_b32 v14, a38
v_accvgpr_read_b32 v15, a39
v_cvt_pk_bf16_f32 v16, v8, v9
v_cvt_pk_bf16_f32 v17, v10, v11
v_cvt_pk_bf16_f32 v18, v12, v13
v_cvt_pk_bf16_f32 v19, v14, v15
s_add_u32 s57, s57, 4096
buffer_store_dwordx4 v[16:19], v2, s[36:39], s57 offen offset:0 sc1
v_accvgpr_read_b32 v20, a40
v_accvgpr_read_b32 v21, a41
v_accvgpr_read_b32 v22, a42
v_accvgpr_read_b32 v23, a43
v_accvgpr_read_b32 v24, a44
v_accvgpr_read_b32 v25, a45
v_accvgpr_read_b32 v26, a46
v_accvgpr_read_b32 v27, a47
v_cvt_pk_bf16_f32 v28, v20, v21
v_cvt_pk_bf16_f32 v29, v22, v23
v_cvt_pk_bf16_f32 v30, v24, v25
v_cvt_pk_bf16_f32 v31, v26, v27
buffer_store_dwordx4 v[28:31], v2, s[36:39], s57 offen offset:1024 sc1
v_accvgpr_read_b32 v8, a48
v_accvgpr_read_b32 v9, a49
v_accvgpr_read_b32 v10, a50
v_accvgpr_read_b32 v11, a51
v_accvgpr_read_b32 v12, a52
v_accvgpr_read_b32 v13, a53
v_accvgpr_read_b32 v14, a54
v_accvgpr_read_b32 v15, a55
v_cvt_pk_bf16_f32 v16, v8, v9
v_cvt_pk_bf16_f32 v17, v10, v11
v_cvt_pk_bf16_f32 v18, v12, v13
v_cvt_pk_bf16_f32 v19, v14, v15
buffer_store_dwordx4 v[16:19], v2, s[36:39], s57 offen offset:2048 sc1
v_accvgpr_read_b32 v20, a56
v_accvgpr_read_b32 v21, a57
v_accvgpr_read_b32 v22, a58
v_accvgpr_read_b32 v23, a59
v_accvgpr_read_b32 v24, a60
v_accvgpr_read_b32 v25, a61
v_accvgpr_read_b32 v26, a62
v_accvgpr_read_b32 v27, a63
v_cvt_pk_bf16_f32 v28, v20, v21
v_cvt_pk_bf16_f32 v29, v22, v23
v_cvt_pk_bf16_f32 v30, v24, v25
v_cvt_pk_bf16_f32 v31, v26, v27
buffer_store_dwordx4 v[28:31], v2, s[36:39], s57 offen offset:3072 sc1
s_add_u32 s57, s12, 262144
v_accvgpr_read_b32 v8, a64
v_accvgpr_read_b32 v9, a65
v_accvgpr_read_b32 v10, a66
v_accvgpr_read_b32 v11, a67
v_accvgpr_read_b32 v12, a68
v_accvgpr_read_b32 v13, a69
v_accvgpr_read_b32 v14, a70
v_accvgpr_read_b32 v15, a71
v_cvt_pk_bf16_f32 v16, v8, v9
v_cvt_pk_bf16_f32 v17, v10, v11
v_cvt_pk_bf16_f32 v18, v12, v13
v_cvt_pk_bf16_f32 v19, v14, v15
buffer_store_dwordx4 v[16:19], v2, s[36:39], s57 offen offset:0 sc1
v_accvgpr_read_b32 v20, a72
v_accvgpr_read_b32 v21, a73
v_accvgpr_read_b32 v22, a74
v_accvgpr_read_b32 v23, a75
v_accvgpr_read_b32 v24, a76
v_accvgpr_read_b32 v25, a77
v_accvgpr_read_b32 v26, a78
v_accvgpr_read_b32 v27, a79
v_cvt_pk_bf16_f32 v28, v20, v21
v_cvt_pk_bf16_f32 v29, v22, v23
v_cvt_pk_bf16_f32 v30, v24, v25
v_cvt_pk_bf16_f32 v31, v26, v27
buffer_store_dwordx4 v[28:31], v2, s[36:39], s57 offen offset:1024 sc1
v_accvgpr_read_b32 v8, a80
v_accvgpr_read_b32 v9, a81
v_accvgpr_read_b32 v10, a82
v_accvgpr_read_b32 v11, a83
v_accvgpr_read_b32 v12, a84
v_accvgpr_read_b32 v13, a85
v_accvgpr_read_b32 v14, a86
v_accvgpr_read_b32 v15, a87
v_cvt_pk_bf16_f32 v16, v8, v9
v_cvt_pk_bf16_f32 v17, v10, v11
v_cvt_pk_bf16_f32 v18, v12, v13
v_cvt_pk_bf16_f32 v19, v14, v15
buffer_store_dwordx4 v[16:19], v2, s[36:39], s57 offen offset:2048 sc1
v_accvgpr_read_b32 v20, a88
v_accvgpr_read_b32 v21, a89
v_accvgpr_read_b32 v22, a90
v_accvgpr_read_b32 v23, a91
v_accvgpr_read_b32 v24, a92
v_accvgpr_read_b32 v25, a93
v_accvgpr_read_b32 v26, a94
v_accvgpr_read_b32 v27, a95
v_cvt_pk_bf16_f32 v28, v20, v21
v_cvt_pk_bf16_f32 v29, v22, v23
v_cvt_pk_bf16_f32 v30, v24, v25
v_cvt_pk_bf16_f32 v31, v26, v27
buffer_store_dwordx4 v[28:31], v2, s[36:39], s57 offen offset:3072 sc1
v_accvgpr_read_b32 v8, a96
v_accvgpr_read_b32 v9, a97
v_accvgpr_read_b32 v10, a98
v_accvgpr_read_b32 v11, a99
v_accvgpr_read_b32 v12, a100
v_accvgpr_read_b32 v13, a101
v_accvgpr_read_b32 v14, a102
v_accvgpr_read_b32 v15, a103
v_cvt_pk_bf16_f32 v16, v8, v9
v_cvt_pk_bf16_f32 v17, v10, v11
v_cvt_pk_bf16_f32 v18, v12, v13
v_cvt_pk_bf16_f32 v19, v14, v15
s_add_u32 s57, s57, 4096
buffer_store_dwordx4 v[16:19], v2, s[36:39], s57 offen offset:0 sc1
v_accvgpr_read_b32 v20, a104
v_accvgpr_read_b32 v21, a105
v_accvgpr_read_b32 v22, a106
v_accvgpr_read_b32 v23, a107
v_accvgpr_read_b32 v24, a108
v_accvgpr_read_b32 v25, a109
v_accvgpr_read_b32 v26, a110
v_accvgpr_read_b32 v27, a111
v_cvt_pk_bf16_f32 v28, v20, v21
v_cvt_pk_bf16_f32 v29, v22, v23
v_cvt_pk_bf16_f32 v30, v24, v25
v_cvt_pk_bf16_f32 v31, v26, v27
buffer_store_dwordx4 v[28:31], v2, s[36:39], s57 offen offset:1024 sc1
v_accvgpr_read_b32 v8, a112
v_accvgpr_read_b32 v9, a113
v_accvgpr_read_b32 v10, a114
v_accvgpr_read_b32 v11, a115
v_accvgpr_read_b32 v12, a116
v_accvgpr_read_b32 v13, a117
v_accvgpr_read_b32 v14, a118
v_accvgpr_read_b32 v15, a119
v_cvt_pk_bf16_f32 v16, v8, v9
v_cvt_pk_bf16_f32 v17, v10, v11
v_cvt_pk_bf16_f32 v18, v12, v13
v_cvt_pk_bf16_f32 v19, v14, v15
buffer_store_dwordx4 v[16:19], v2, s[36:39], s57 offen offset:2048 sc1
v_accvgpr_read_b32 v20, a120
v_accvgpr_read_b32 v21, a121
v_accvgpr_read_b32 v22, a122
v_accvgpr_read_b32 v23, a123
v_accvgpr_read_b32 v24, a124
v_accvgpr_read_b32 v25, a125
v_accvgpr_read_b32 v26, a126
v_accvgpr_read_b32 v27, a127
v_cvt_pk_bf16_f32 v28, v20, v21
v_cvt_pk_bf16_f32 v29, v22, v23
v_cvt_pk_bf16_f32 v30, v24, v25
v_cvt_pk_bf16_f32 v31, v26, v27
buffer_store_dwordx4 v[28:31], v2, s[36:39], s57 offen offset:3072 sc1
s_add_u32 s57, s12, 524288
v_accvgpr_read_b32 v8, a128
v_accvgpr_read_b32 v9, a129
v_accvgpr_read_b32 v10, a130
v_accvgpr_read_b32 v11, a131
v_accvgpr_read_b32 v12, a132
v_accvgpr_read_b32 v13, a133
v_accvgpr_read_b32 v14, a134
v_accvgpr_read_b32 v15, a135
v_cvt_pk_bf16_f32 v16, v8, v9
v_cvt_pk_bf16_f32 v17, v10, v11
v_cvt_pk_bf16_f32 v18, v12, v13
v_cvt_pk_bf16_f32 v19, v14, v15
buffer_store_dwordx4 v[16:19], v2, s[36:39], s57 offen offset:0 sc1
v_accvgpr_read_b32 v20, a136
v_accvgpr_read_b32 v21, a137
v_accvgpr_read_b32 v22, a138
v_accvgpr_read_b32 v23, a139
v_accvgpr_read_b32 v24, a140
v_accvgpr_read_b32 v25, a141
v_accvgpr_read_b32 v26, a142
v_accvgpr_read_b32 v27, a143
v_cvt_pk_bf16_f32 v28, v20, v21
v_cvt_pk_bf16_f32 v29, v22, v23
v_cvt_pk_bf16_f32 v30, v24, v25
v_cvt_pk_bf16_f32 v31, v26, v27
buffer_store_dwordx4 v[28:31], v2, s[36:39], s57 offen offset:1024 sc1
v_accvgpr_read_b32 v8, a144
v_accvgpr_read_b32 v9, a145
v_accvgpr_read_b32 v10, a146
v_accvgpr_read_b32 v11, a147
v_accvgpr_read_b32 v12, a148
v_accvgpr_read_b32 v13, a149
v_accvgpr_read_b32 v14, a150
v_accvgpr_read_b32 v15, a151
v_cvt_pk_bf16_f32 v16, v8, v9
v_cvt_pk_bf16_f32 v17, v10, v11
v_cvt_pk_bf16_f32 v18, v12, v13
v_cvt_pk_bf16_f32 v19, v14, v15
buffer_store_dwordx4 v[16:19], v2, s[36:39], s57 offen offset:2048 sc1
v_accvgpr_read_b32 v20, a152
v_accvgpr_read_b32 v21, a153
v_accvgpr_read_b32 v22, a154
v_accvgpr_read_b32 v23, a155
v_accvgpr_read_b32 v24, a156
v_accvgpr_read_b32 v25, a157
v_accvgpr_read_b32 v26, a158
v_accvgpr_read_b32 v27, a159
v_cvt_pk_bf16_f32 v28, v20, v21
v_cvt_pk_bf16_f32 v29, v22, v23
v_cvt_pk_bf16_f32 v30, v24, v25
v_cvt_pk_bf16_f32 v31, v26, v27
buffer_store_dwordx4 v[28:31], v2, s[36:39], s57 offen offset:3072 sc1
v_accvgpr_read_b32 v8, a160
v_accvgpr_read_b32 v9, a161
v_accvgpr_read_b32 v10, a162
v_accvgpr_read_b32 v11, a163
v_accvgpr_read_b32 v12, a164
v_accvgpr_read_b32 v13, a165
v_accvgpr_read_b32 v14, a166
v_accvgpr_read_b32 v15, a167
v_cvt_pk_bf16_f32 v16, v8, v9
v_cvt_pk_bf16_f32 v17, v10, v11
v_cvt_pk_bf16_f32 v18, v12, v13
v_cvt_pk_bf16_f32 v19, v14, v15
s_add_u32 s57, s57, 4096
buffer_store_dwordx4 v[16:19], v2, s[36:39], s57 offen offset:0 sc1
v_accvgpr_read_b32 v20, a168
v_accvgpr_read_b32 v21, a169
v_accvgpr_read_b32 v22, a170
v_accvgpr_read_b32 v23, a171
v_accvgpr_read_b32 v24, a172
v_accvgpr_read_b32 v25, a173
v_accvgpr_read_b32 v26, a174
v_accvgpr_read_b32 v27, a175
v_cvt_pk_bf16_f32 v28, v20, v21
v_cvt_pk_bf16_f32 v29, v22, v23
v_cvt_pk_bf16_f32 v30, v24, v25
v_cvt_pk_bf16_f32 v31, v26, v27
buffer_store_dwordx4 v[28:31], v2, s[36:39], s57 offen offset:1024 sc1
v_accvgpr_read_b32 v8, a176
v_accvgpr_read_b32 v9, a177
v_accvgpr_read_b32 v10, a178
v_accvgpr_read_b32 v11, a179
v_accvgpr_read_b32 v12, a180
v_accvgpr_read_b32 v13, a181
v_accvgpr_read_b32 v14, a182
v_accvgpr_read_b32 v15, a183
v_cvt_pk_bf16_f32 v16, v8, v9
v_cvt_pk_bf16_f32 v17, v10, v11
v_cvt_pk_bf16_f32 v18, v12, v13
v_cvt_pk_bf16_f32 v19, v14, v15
buffer_store_dwordx4 v[16:19], v2, s[36:39], s57 offen offset:2048 sc1
v_accvgpr_read_b32 v20, a184
v_accvgpr_read_b32 v21, a185
v_accvgpr_read_b32 v22, a186
v_accvgpr_read_b32 v23, a187
v_accvgpr_read_b32 v24, a188
v_accvgpr_read_b32 v25, a189
v_accvgpr_read_b32 v26, a190
v_accvgpr_read_b32 v27, a191
v_cvt_pk_bf16_f32 v28, v20, v21
v_cvt_pk_bf16_f32 v29, v22, v23
v_cvt_pk_bf16_f32 v30, v24, v25
v_cvt_pk_bf16_f32 v31, v26, v27
buffer_store_dwordx4 v[28:31], v2, s[36:39], s57 offen offset:3072 sc1
s_add_u32 s57, s12, 786432
v_accvgpr_read_b32 v8, a192
v_accvgpr_read_b32 v9, a193
v_accvgpr_read_b32 v10, a194
v_accvgpr_read_b32 v11, a195
v_accvgpr_read_b32 v12, a196
v_accvgpr_read_b32 v13, a197
v_accvgpr_read_b32 v14, a198
v_accvgpr_read_b32 v15, a199
v_cvt_pk_bf16_f32 v16, v8, v9
v_cvt_pk_bf16_f32 v17, v10, v11
v_cvt_pk_bf16_f32 v18, v12, v13
v_cvt_pk_bf16_f32 v19, v14, v15
buffer_store_dwordx4 v[16:19], v2, s[36:39], s57 offen offset:0 sc1
v_accvgpr_read_b32 v20, a200
v_accvgpr_read_b32 v21, a201
v_accvgpr_read_b32 v22, a202
v_accvgpr_read_b32 v23, a203
v_accvgpr_read_b32 v24, a204
v_accvgpr_read_b32 v25, a205
v_accvgpr_read_b32 v26, a206
v_accvgpr_read_b32 v27, a207
v_cvt_pk_bf16_f32 v28, v20, v21
v_cvt_pk_bf16_f32 v29, v22, v23
v_cvt_pk_bf16_f32 v30, v24, v25
v_cvt_pk_bf16_f32 v31, v26, v27
buffer_store_dwordx4 v[28:31], v2, s[36:39], s57 offen offset:1024 sc1
v_accvgpr_read_b32 v8, a208
v_accvgpr_read_b32 v9, a209
v_accvgpr_read_b32 v10, a210
v_accvgpr_read_b32 v11, a211
v_accvgpr_read_b32 v12, a212
v_accvgpr_read_b32 v13, a213
v_accvgpr_read_b32 v14, a214
v_accvgpr_read_b32 v15, a215
v_cvt_pk_bf16_f32 v16, v8, v9
v_cvt_pk_bf16_f32 v17, v10, v11
v_cvt_pk_bf16_f32 v18, v12, v13
v_cvt_pk_bf16_f32 v19, v14, v15
buffer_store_dwordx4 v[16:19], v2, s[36:39], s57 offen offset:2048 sc1
v_accvgpr_read_b32 v20, a216
v_accvgpr_read_b32 v21, a217
v_accvgpr_read_b32 v22, a218
v_accvgpr_read_b32 v23, a219
v_accvgpr_read_b32 v24, a220
v_accvgpr_read_b32 v25, a221
v_accvgpr_read_b32 v26, a222
v_accvgpr_read_b32 v27, a223
v_cvt_pk_bf16_f32 v28, v20, v21
v_cvt_pk_bf16_f32 v29, v22, v23
v_cvt_pk_bf16_f32 v30, v24, v25
v_cvt_pk_bf16_f32 v31, v26, v27
buffer_store_dwordx4 v[28:31], v2, s[36:39], s57 offen offset:3072 sc1
v_accvgpr_read_b32 v8, a224
v_accvgpr_read_b32 v9, a225
v_accvgpr_read_b32 v10, a226
v_accvgpr_read_b32 v11, a227
v_accvgpr_read_b32 v12, a228
v_accvgpr_read_b32 v13, a229
v_accvgpr_read_b32 v14, a230
v_accvgpr_read_b32 v15, a231
v_cvt_pk_bf16_f32 v16, v8, v9
v_cvt_pk_bf16_f32 v17, v10, v11
v_cvt_pk_bf16_f32 v18, v12, v13
v_cvt_pk_bf16_f32 v19, v14, v15
s_add_u32 s57, s57, 4096
buffer_store_dwordx4 v[16:19], v2, s[36:39], s57 offen offset:0 sc1
v_accvgpr_read_b32 v20, a232
v_accvgpr_read_b32 v21, a233
v_accvgpr_read_b32 v22, a234
v_accvgpr_read_b32 v23, a235
v_accvgpr_read_b32 v24, a236
v_accvgpr_read_b32 v25, a237
v_accvgpr_read_b32 v26, a238
v_accvgpr_read_b32 v27, a239
v_cvt_pk_bf16_f32 v28, v20, v21
v_cvt_pk_bf16_f32 v29, v22, v23
v_cvt_pk_bf16_f32 v30, v24, v25
v_cvt_pk_bf16_f32 v31, v26, v27
buffer_store_dwordx4 v[28:31], v2, s[36:39], s57 offen offset:1024 sc1
v_accvgpr_read_b32 v8, a240
v_accvgpr_read_b32 v9, a241
v_accvgpr_read_b32 v10, a242
v_accvgpr_read_b32 v11, a243
v_accvgpr_read_b32 v12, a244
v_accvgpr_read_b32 v13, a245
v_accvgpr_read_b32 v14, a246
v_accvgpr_read_b32 v15, a247
v_cvt_pk_bf16_f32 v16, v8, v9
v_cvt_pk_bf16_f32 v17, v10, v11
v_cvt_pk_bf16_f32 v18, v12, v13
v_cvt_pk_bf16_f32 v19, v14, v15
buffer_store_dwordx4 v[16:19], v2, s[36:39], s57 offen offset:2048 sc1
v_accvgpr_read_b32 v20, a248
v_accvgpr_read_b32 v21, a249
v_accvgpr_read_b32 v22, a250
v_accvgpr_read_b32 v23, a251
v_accvgpr_read_b32 v24, a252
v_accvgpr_read_b32 v25, a253
v_accvgpr_read_b32 v26, a254
v_accvgpr_read_b32 v27, a255
v_cvt_pk_bf16_f32 v28, v20, v21
v_cvt_pk_bf16_f32 v29, v22, v23
v_cvt_pk_bf16_f32 v30, v24, v25
v_cvt_pk_bf16_f32 v31, v26, v27
buffer_store_dwordx4 v[28:31], v2, s[36:39], s57 offen offset:3072 sc1
s_waitcnt vmcnt(0)
s_barrier
s_cmp_lg_u32 s3, 0
s_cbranch_scc1 .Lsg_342
v_mov_b32 v1, 1
v_mul_u32_u24 v2, 0, v0
s_mov_b64 exec, 1
buffer_atomic_add v1, v2, s[88:91], s86 offen sc1
s_mov_b64 exec, -1
.Lsg_342:
.Lj3_334:
s_add_u32 s79, s79, 1
s_cmp_le_u32 s79, 3
s_cbranch_scc1 .Lround_318
s_mov_b32 s83, 0
s_add_u32 s84, s76, 5
s_mov_b32 s85, s77
s_sub_u32 s81, s76, 1
s_cmp_lt_u32 s81, 2
s_cbranch_scc1 .Lhalf_315
.Lbatch_317:
s_add_u32 s78, s76, 1
s_and_b32 s78, s78, 3
.Lbl_343:
s_cmp_lg_u32 s3, 0
s_cbranch_scc1 .Lws_344
s_mov_b32 s86, 2048
s_bfe_u32 s82, s78, 0x30000
s_mul_i32 s82, s82, 512
s_add_u32 s86, s86, s82
s_bfe_u32 s82, s77, 0x20000
s_mul_i32 s82, s82, 128
s_add_u32 s86, s86, s82
s_cmp_lt_u32 s78, 3
s_cselect_b32 s81, 16, 8
s_cmp_eq_u32 s78, 0
s_cselect_b32 s81, 32, s81
v_mov_b32 v1, s86
v_mov_b32 v2, s81
s_lshl_b32 s81, s78, 7
s_add_u32 s81, s81, 10240
v_writelane_b32 v1, s81, 1
v_writelane_b32 v2, 16, 1
s_mov_b64 exec, 3
.Lwl_345:
buffer_load_dword v3, v1, s[88:91], 0 offen sc1
s_waitcnt vmcnt(0)
v_cmp_lt_u32 vcc, v3, v2
s_cbranch_vccz .Lwo_346
s_cmp_eq_u32 s80, 0
s_cbranch_scc1 .Lwo_346
s_sub_u32 s80, s80, 1
s_branch .Lwl_345
.Lwo_346:
s_mov_b64 exec, -1
.Lws_344:
s_barrier
s_lshl_b32 s84, s78, 3
s_lshr_b32 s81, s77, 2
s_add_u32 s84, s84, s81
s_and_b32 s85, s77, 3
s_lshl_b32 s85, s85, 3
s_lshl_b32 s81, s3, 1
s_add_u32 s85, s85, s81
s_add_u32 s12, s4, 0x1000000
s_addc_u32 s13, s5, 0
s_mov_b32 s14, 0x5800000
s_mov_b32 s15, 0x00020000
s_lshl_b32 s16, s84, 18
s_lshl_b32 s17, s85, 13
s_add_u32 s16, s16, s17
s_add_u32 s17, s16, 16777216
s_add_u32 s18, s16, 33554432
s_add_u32 s19, s16, 50331648
s_lshl_b32 s20, s84, 16
s_lshl_b32 s21, s85, 11
s_add_u32 s20, s20, s21
s_add_u32 s21, s20, 88080384
s_add_u32 s20, s20, 83886080
v_lshlrev_b32 v8, 4, v0
v_add_u32 v9, 4096, v8
v_lshlrev_b32 v5, 3, v0
v_lshrrev_b32 v6, 5, v0
v_lshlrev_b32 v4, 7, v6
v_and_b32 v7, 7, v0
v_lshlrev_b32 v7, 4, v7
v_add_u32 v4, v4, v7
buffer_load_dwordx4 v[12:15], v8, s[12:15], s16 offen offset:0 sc1
buffer_load_dwordx4 v[44:47], v8, s[12:15], s17 offen offset:0 sc1
buffer_load_dwordx4 v[16:19], v8, s[12:15], s16 offen offset:1024 sc1
buffer_load_dwordx4 v[48:51], v8, s[12:15], s17 offen offset:1024 sc1
buffer_load_dwordx4 v[20:23], v8, s[12:15], s16 offen offset:2048 sc1
buffer_load_dwordx4 v[52:55], v8, s[12:15], s17 offen offset:2048 sc1
buffer_load_dwordx4 v[24:27], v8, s[12:15], s16 offen offset:3072 sc1
buffer_load_dwordx4 v[56:59], v8, s[12:15], s17 offen offset:3072 sc1
buffer_load_dwordx4 v[28:31], v9, s[12:15], s16 offen offset:0 sc1
buffer_load_dwordx4 v[60:63], v9, s[12:15], s17 offen offset:0 sc1
buffer_load_dwordx4 v[32:35], v9, s[12:15], s16 offen offset:1024 sc1
buffer_load_dwordx4 v[64:67], v9, s[12:15], s17 offen offset:1024 sc1
buffer_load_dwordx4 v[36:39], v9, s[12:15], s16 offen offset:2048 sc1
buffer_load_dwordx4 v[68:71], v9, s[12:15], s17 offen offset:2048 sc1
buffer_load_dwordx4 v[40:43], v9, s[12:15], s16 offen offset:3072 sc1
buffer_load_dwordx4 v[72:75], v9, s[12:15], s17 offen offset:3072 sc1
buffer_load_dwordx4 v[108:111], v8, s[12:15], s18 offen offset:0 sc1
buffer_load_dwordx4 v[112:115], v8, s[12:15], s18 offen offset:1024 sc1
buffer_load_dwordx4 v[116:119], v8, s[12:15], s18 offen offset:2048 sc1
buffer_load_dwordx4 v[120:123], v8, s[12:15], s18 offen offset:3072 sc1
buffer_load_dwordx4 v[124:127], v9, s[12:15], s18 offen offset:0 sc1
buffer_load_dwordx4 v[128:131], v9, s[12:15], s18 offen offset:1024 sc1
buffer_load_dwordx4 v[132:135], v9, s[12:15], s18 offen offset:2048 sc1
buffer_load_dwordx4 v[136:139], v9, s[12:15], s18 offen offset:3072 sc1
s_add_u32 s16, s16, 8192
s_add_u32 s17, s17, 8192
s_add_u32 s18, s18, 8192
buffer_load_dwordx4 a[12:15], v8, s[12:15], s16 offen offset:0 sc1
buffer_load_dwordx4 a[44:47], v8, s[12:15], s17 offen offset:0 sc1
buffer_load_dwordx4 a[16:19], v8, s[12:15], s16 offen offset:1024 sc1
buffer_load_dwordx4 a[48:51], v8, s[12:15], s17 offen offset:1024 sc1
buffer_load_dwordx4 a[20:23], v8, s[12:15], s16 offen offset:2048 sc1
buffer_load_dwordx4 a[52:55], v8, s[12:15], s17 offen offset:2048 sc1
buffer_load_dwordx4 a[24:27], v8, s[12:15], s16 offen offset:3072 sc1
buffer_load_dwordx4 a[56:59], v8, s[12:15], s17 offen offset:3072 sc1
buffer_load_dwordx4 a[28:31], v9, s[12:15], s16 offen offset:0 sc1
buffer_load_dwordx4 a[60:63], v9, s[12:15], s17 offen offset:0 sc1
buffer_load_dwordx4 a[32:35], v9, s[12:15], s16 offen offset:1024 sc1
buffer_load_dwordx4 a[64:67], v9, s[12:15], s17 offen offset:1024 sc1
buffer_load_dwordx4 a[36:39], v9, s[12:15], s16 offen offset:2048 sc1
buffer_load_dwordx4 a[68:71], v9, s[12:15], s17 offen offset:2048 sc1
buffer_load_dwordx4 a[40:43], v9, s[12:15], s16 offen offset:3072 sc1
buffer_load_dwordx4 a[72:75], v9, s[12:15], s17 offen offset:3072 sc1
buffer_load_dwordx4 a[108:111], v8, s[12:15], s18 offen offset:0 sc1
buffer_load_dwordx4 a[112:115], v8, s[12:15], s18 offen offset:1024 sc1
buffer_load_dwordx4 a[116:119], v8, s[12:15], s18 offen offset:2048 sc1
buffer_load_dwordx4 a[120:123], v8, s[12:15], s18 offen offset:3072 sc1
buffer_load_dwordx4 a[124:127], v9, s[12:15], s18 offen offset:0 sc1
buffer_load_dwordx4 a[128:131], v9, s[12:15], s18 offen offset:1024 sc1
buffer_load_dwordx4 a[132:135], v9, s[12:15], s18 offen offset:2048 sc1
buffer_load_dwordx4 a[136:139], v9, s[12:15], s18 offen offset:3072 sc1
s_mov_b32 s86, 6144
s_bfe_u32 s82, s78, 0x30000
s_mul_i32 s82, s82, 512
s_add_u32 s86, s86, s82
s_bfe_u32 s82, s77, 0x20000
s_mul_i32 s82, s82, 128
s_add_u32 s86, s86, s82
s_cmp_lg_u32 s3, 0
s_cbranch_scc1 .Lws_347
v_mul_u32_u24 v1, 0, v0
v_add_u32 v1, s86, v1
v_mov_b32 v2, 32
s_mov_b64 exec, 1
.Lwl_348:
buffer_load_dword v3, v1, s[88:91], 0 offen sc1
s_waitcnt vmcnt(0)
v_cmp_lt_u32 vcc, v3, v2
s_cbranch_vccz .Lwo_349
s_cmp_eq_u32 s80, 0
s_cbranch_scc1 .Lwo_349
s_sub_u32 s80, s80, 1
s_branch .Lwl_348
.Lwo_349:
s_mov_b64 exec, -1
.Lws_347:
s_barrier
s_mov_b32 exec_lo, 0xff
s_mov_b32 exec_hi, 0xff
buffer_load_dwordx4 v[76:79], v4, s[12:15], s20 offen offset:0 sc1
buffer_load_dwordx4 v[80:83], v4, s[12:15], s20 offen offset:256 sc1
buffer_load_dwordx4 v[84:87], v4, s[12:15], s20 offen offset:512 sc1
buffer_load_dwordx4 v[88:91], v4, s[12:15], s20 offen offset:768 sc1
buffer_load_dwordx4 v[92:95], v4, s[12:15], s20 offen offset:1024 sc1
buffer_load_dwordx4 v[96:99], v4, s[12:15], s20 offen offset:1280 sc1
buffer_load_dwordx4 v[100:103], v4, s[12:15], s20 offen offset:1536 sc1
buffer_load_dwordx4 v[104:107], v4, s[12:15], s20 offen offset:1792 sc1
s_mov_b64 exec, -1
buffer_load_dwordx2 v[140:141], v5, s[12:15], s21 offen offset:0 sc1
v_mov_b32 v142, 0
v_mov_b32 v143, 0
buffer_load_dwordx2 v[144:145], v5, s[12:15], s21 offen offset:512 sc1
v_mov_b32 v146, 0
v_mov_b32 v147, 0
buffer_load_dwordx2 v[148:149], v5, s[12:15], s21 offen offset:1024 sc1
v_mov_b32 v150, 0
v_mov_b32 v151, 0
buffer_load_dwordx2 v[152:153], v5, s[12:15], s21 offen offset:1536 sc1
v_mov_b32 v154, 0
v_mov_b32 v155, 0
s_mov_b32 exec_lo, 0xff
s_mov_b32 exec_hi, 0xff
buffer_load_dwordx4 a[76:79], v4, s[12:15], s20 offen offset:2048 sc1
buffer_load_dwordx4 a[80:83], v4, s[12:15], s20 offen offset:2304 sc1
buffer_load_dwordx4 a[84:87], v4, s[12:15], s20 offen offset:2560 sc1
buffer_load_dwordx4 a[88:91], v4, s[12:15], s20 offen offset:2816 sc1
buffer_load_dwordx4 a[92:95], v4, s[12:15], s20 offen offset:3072 sc1
buffer_load_dwordx4 a[96:99], v4, s[12:15], s20 offen offset:3328 sc1
buffer_load_dwordx4 a[100:103], v4, s[12:15], s20 offen offset:3584 sc1
buffer_load_dwordx4 a[104:107], v4, s[12:15], s20 offen offset:3840 sc1
s_mov_b64 exec, -1
buffer_load_dwordx2 a[140:141], v5, s[12:15], s21 offen offset:2048 sc1
v_accvgpr_write_b32 a142, 0
v_accvgpr_write_b32 a143, 0
buffer_load_dwordx2 a[144:145], v5, s[12:15], s21 offen offset:2560 sc1
v_accvgpr_write_b32 a146, 0
v_accvgpr_write_b32 a147, 0
buffer_load_dwordx2 a[148:149], v5, s[12:15], s21 offen offset:3072 sc1
v_accvgpr_write_b32 a150, 0
v_accvgpr_write_b32 a151, 0
buffer_load_dwordx2 a[152:153], v5, s[12:15], s21 offen offset:3584 sc1
v_accvgpr_write_b32 a154, 0
v_accvgpr_write_b32 a155, 0
v_and_b32 v7, 31, v0
v_lshlrev_b32 v6, 2, v6
v_sub_u32 v7, v7, v6
s_waitcnt vmcnt(63)
v_mfma_f32_32x32x16_bf16 v[156:171], v[44:47], v[12:15], 0
s_waitcnt vmcnt(63)
v_mfma_f32_32x32x16_bf16 v[156:171], v[48:51], v[16:19], v[156:171]
s_waitcnt vmcnt(63)
v_mfma_f32_32x32x16_bf16 v[156:171], v[52:55], v[20:23], v[156:171]
s_waitcnt vmcnt(63)
v_mfma_f32_32x32x16_bf16 v[156:171], v[56:59], v[24:27], v[156:171]
s_waitcnt vmcnt(62)
v_mfma_f32_32x32x16_bf16 v[156:171], v[60:63], v[28:31], v[156:171]
s_waitcnt vmcnt(60)
v_mfma_f32_32x32x16_bf16 v[156:171], v[64:67], v[32:35], v[156:171]
s_waitcnt vmcnt(58)
v_mfma_f32_32x32x16_bf16 v[156:171], v[68:71], v[36:39], v[156:171]
s_waitcnt vmcnt(56)
v_mfma_f32_32x32x16_bf16 v[156:171], v[72:75], v[40:43], v[156:171]
s_waitcnt vmcnt(16)
v_mfma_f32_32x32x16_bf16 v[172:187], v[76:79], v[12:15], 0
v_mfma_f32_32x32x16_bf16 v[172:187], v[80:83], v[16:19], v[172:187]
v_mfma_f32_32x32x16_bf16 v[172:187], v[84:87], v[20:23], v[172:187]
v_mfma_f32_32x32x16_bf16 v[172:187], v[88:91], v[24:27], v[172:187]
v_mfma_f32_32x32x16_bf16 v[172:187], v[92:95], v[28:31], v[172:187]
v_mfma_f32_32x32x16_bf16 v[172:187], v[96:99], v[32:35], v[172:187]
v_mfma_f32_32x32x16_bf16 v[172:187], v[100:103], v[36:39], v[172:187]
v_mfma_f32_32x32x16_bf16 v[172:187], v[104:107], v[40:43], v[172:187]
s_nop 2
v_cvt_pk_bf16_f32 v188, v156, v157
v_cvt_pk_bf16_f32 v189, v158, v159
v_cvt_pk_bf16_f32 v190, v160, v161
v_cvt_pk_bf16_f32 v191, v162, v163
v_cvt_pk_bf16_f32 v192, v164, v165
v_cvt_pk_bf16_f32 v193, v166, v167
v_cvt_pk_bf16_f32 v194, v168, v169
v_cvt_pk_bf16_f32 v195, v170, v171
s_nop 0
v_cvt_pk_bf16_f32 v196, v172, v173
v_cvt_pk_bf16_f32 v197, v174, v175
v_lshlrev_b32 v156, 16, v188
v_and_b32 v157, 0xffff0000, v188
v_lshlrev_b32 v158, 16, v189
v_and_b32 v159, 0xffff0000, v189
v_lshlrev_b32 v160, 16, v190
v_and_b32 v161, 0xffff0000, v190
v_lshlrev_b32 v162, 16, v191
v_and_b32 v163, 0xffff0000, v191
v_lshlrev_b32 v164, 16, v192
v_and_b32 v165, 0xffff0000, v192
v_lshlrev_b32 v166, 16, v193
v_and_b32 v167, 0xffff0000, v193
v_lshlrev_b32 v168, 16, v194
v_and_b32 v169, 0xffff0000, v194
v_lshlrev_b32 v170, 16, v195
v_and_b32 v171, 0xffff0000, v195
v_lshlrev_b32 v172, 16, v196
v_and_b32 v173, 0xffff0000, v196
v_lshlrev_b32 v174, 16, v197
v_and_b32 v175, 0xffff0000, v197
v_mul_f32 v156, 0x3db504f3, v156
v_mul_f32 v157, 0x3db504f3, v157
v_mul_f32 v158, 0x3db504f3, v158
v_mul_f32 v159, 0x3db504f3, v159
v_mul_f32 v160, 0x3db504f3, v160
v_mul_f32 v161, 0x3db504f3, v161
v_mul_f32 v162, 0x3db504f3, v162
v_mul_f32 v163, 0x3db504f3, v163
v_mul_f32 v164, 0x3db504f3, v164
v_mul_f32 v165, 0x3db504f3, v165
v_mul_f32 v166, 0x3db504f3, v166
v_mul_f32 v167, 0x3db504f3, v167
v_mul_f32 v168, 0x3db504f3, v168
v_mul_f32 v169, 0x3db504f3, v169
v_mul_f32 v170, 0x3db504f3, v170
v_mul_f32 v171, 0x3db504f3, v171
v_mul_f32 v172, 0x3db504f3, v172
v_mul_f32 v173, 0x3db504f3, v173
v_mul_f32 v174, 0x3db504f3, v174
v_mul_f32 v175, 0x3db504f3, v175
v_cvt_pk_bf16_f32 v188, v156, v157
v_cvt_pk_bf16_f32 v189, v158, v159
v_cvt_pk_bf16_f32 v190, v160, v161
v_cvt_pk_bf16_f32 v191, v162, v163
v_cvt_pk_bf16_f32 v192, v164, v165
v_cvt_pk_bf16_f32 v193, v166, v167
v_cvt_pk_bf16_f32 v194, v168, v169
v_cvt_pk_bf16_f32 v195, v170, v171
v_cvt_pk_bf16_f32 v196, v172, v173
v_cvt_pk_bf16_f32 v197, v174, v175
v_lshlrev_b32 v156, 16, v188
v_and_b32 v157, 0xffff0000, v188
v_lshlrev_b32 v158, 16, v189
v_and_b32 v159, 0xffff0000, v189
v_lshlrev_b32 v160, 16, v190
v_and_b32 v161, 0xffff0000, v190
v_lshlrev_b32 v162, 16, v191
v_and_b32 v163, 0xffff0000, v191
v_lshlrev_b32 v164, 16, v192
v_and_b32 v165, 0xffff0000, v192
v_lshlrev_b32 v166, 16, v193
v_and_b32 v167, 0xffff0000, v193
v_lshlrev_b32 v168, 16, v194
v_and_b32 v169, 0xffff0000, v194
v_lshlrev_b32 v170, 16, v195
v_and_b32 v171, 0xffff0000, v195
v_lshlrev_b32 v172, 16, v196
v_and_b32 v173, 0xffff0000, v196
v_lshlrev_b32 v174, 16, v197
v_and_b32 v175, 0xffff0000, v197
v_mov_b32 v6, 0xff800000
v_cmp_le_i32 s[24:25], 0, v7
v_cmp_le_i32 s[26:27], 1, v7
v_cmp_le_i32 s[28:29], 2, v7
v_cmp_le_i32 s[30:31], 3, v7
v_cndmask_b32 v156, v6, v156, s[24:25]
v_cndmask_b32 v157, v6, v157, s[26:27]
v_cndmask_b32 v158, v6, v158, s[28:29]
v_cndmask_b32 v159, v6, v159, s[30:31]
v_cmp_le_i32 s[24:25], 8, v7
v_cmp_le_i32 s[26:27], 9, v7
v_cmp_le_i32 s[28:29], 10, v7
v_cmp_le_i32 s[30:31], 11, v7
v_cndmask_b32 v160, v6, v160, s[24:25]
v_cndmask_b32 v161, v6, v161, s[26:27]
v_cndmask_b32 v162, v6, v162, s[28:29]
v_cndmask_b32 v163, v6, v163, s[30:31]
v_cmp_le_i32 s[24:25], 16, v7
v_cmp_le_i32 s[26:27], 17, v7
v_cmp_le_i32 s[28:29], 18, v7
v_cmp_le_i32 s[30:31], 19, v7
v_cndmask_b32 v164, v6, v164, s[24:25]
v_cndmask_b32 v165, v6, v165, s[26:27]
v_cndmask_b32 v166, v6, v166, s[28:29]
v_cndmask_b32 v167, v6, v167, s[30:31]
v_cmp_le_i32 s[24:25], 24, v7
v_cmp_le_i32 s[26:27], 25, v7
v_cmp_le_i32 s[28:29], 26, v7
v_cmp_le_i32 s[30:31], 27, v7
v_cndmask_b32 v168, v6, v168, s[24:25]
v_cndmask_b32 v169, v6, v169, s[26:27]
v_cndmask_b32 v170, v6, v170, s[28:29]
v_cndmask_b32 v171, v6, v171, s[30:31]
v_max3_f32 v188, v156, v157, v158
v_max3_f32 v189, v159, v160, v161
v_max3_f32 v188, v188, v162, v163
v_max3_f32 v189, v189, v164, v165
v_max3_f32 v188, v188, v166, v167
v_max3_f32 v189, v189, v168, v169
v_max3_f32 v188, v188, v170, v171
v_max3_f32 v189, v189, v172, v173
v_max3_f32 v188, v188, v174, v175
v_max_f32 v188, v188, v189
v_mov_b32 v189, v188
s_nop 1
v_permlane32_swap_b32 v188, v189
v_max_f32 v188, v188, v189
v_mul_f32 v188, 0xbfb8aa3b, v188
s_mov_b32 s22, 0x3fb8aa3b
v_fma_f32 v156, v156, s22, v188
v_fma_f32 v157, v157, s22, v188
v_fma_f32 v158, v158, s22, v188
v_fma_f32 v159, v159, s22, v188
v_fma_f32 v160, v160, s22, v188
v_fma_f32 v161, v161, s22, v188
v_fma_f32 v162, v162, s22, v188
v_fma_f32 v163, v163, s22, v188
v_fma_f32 v164, v164, s22, v188
v_fma_f32 v165, v165, s22, v188
v_fma_f32 v166, v166, s22, v188
v_fma_f32 v167, v167, s22, v188
v_fma_f32 v168, v168, s22, v188
v_fma_f32 v169, v169, s22, v188
v_fma_f32 v170, v170, s22, v188
v_fma_f32 v171, v171, s22, v188
v_fma_f32 v172, v172, s22, v188
v_fma_f32 v173, v173, s22, v188
v_fma_f32 v174, v174, s22, v188
v_fma_f32 v175, v175, s22, v188
v_exp_f32 v156, v156
v_exp_f32 v157, v157
v_exp_f32 v158, v158
v_exp_f32 v159, v159
v_exp_f32 v160, v160
v_exp_f32 v161, v161
v_exp_f32 v162, v162
v_exp_f32 v163, v163
v_exp_f32 v164, v164
v_exp_f32 v165, v165
v_exp_f32 v166, v166
v_exp_f32 v167, v167
v_exp_f32 v168, v168
v_exp_f32 v169, v169
v_exp_f32 v170, v170
v_exp_f32 v171, v171
v_exp_f32 v172, v172
v_exp_f32 v173, v173
v_exp_f32 v174, v174
v_exp_f32 v175, v175
v_add_f32 v188, v156, v157
v_add_f32 v189, v158, v159
v_add_f32 v188, v188, v160
v_add_f32 v189, v189, v161
v_add_f32 v188, v188, v162
v_add_f32 v189, v189, v163
v_add_f32 v188, v188, v164
v_add_f32 v189, v189, v165
v_add_f32 v188, v188, v166
v_add_f32 v189, v189, v167
v_add_f32 v188, v188, v168
v_add_f32 v189, v189, v169
v_add_f32 v188, v188, v170
v_add_f32 v189, v189, v171
v_add_f32 v188, v188, v172
v_add_f32 v189, v189, v173
v_add_f32 v188, v188, v174
v_add_f32 v189, v189, v175
v_add_f32 v188, v188, v189
v_mov_b32 v189, v188
s_nop 1
v_permlane32_swap_b32 v188, v189
v_add_f32 v188, v188, v189
v_rcp_f32 v188, v188
s_nop 0
v_mul_f32 v156, v156, v188
v_mul_f32 v157, v157, v188
v_mul_f32 v158, v158, v188
v_mul_f32 v159, v159, v188
v_mul_f32 v160, v160, v188
v_mul_f32 v161, v161, v188
v_mul_f32 v162, v162, v188
v_mul_f32 v163, v163, v188
v_mul_f32 v164, v164, v188
v_mul_f32 v165, v165, v188
v_mul_f32 v166, v166, v188
v_mul_f32 v167, v167, v188
v_mul_f32 v168, v168, v188
v_mul_f32 v169, v169, v188
v_mul_f32 v170, v170, v188
v_mul_f32 v171, v171, v188
v_mul_f32 v172, v172, v188
v_mul_f32 v173, v173, v188
v_mul_f32 v174, v174, v188
v_mul_f32 v175, v175, v188
v_cvt_pk_bf16_f32 v192, v156, v157
v_cvt_pk_bf16_f32 v193, v158, v159
v_cvt_pk_bf16_f32 v194, v160, v161
v_cvt_pk_bf16_f32 v195, v162, v163
v_cvt_pk_bf16_f32 v196, v164, v165
v_cvt_pk_bf16_f32 v197, v166, v167
v_cvt_pk_bf16_f32 v198, v168, v169
v_cvt_pk_bf16_f32 v199, v170, v171
v_cvt_pk_bf16_f32 v200, v172, v173
v_cvt_pk_bf16_f32 v201, v174, v175
v_mov_b32 v202, 0
v_mov_b32 v203, 0
s_waitcnt vmcnt(12)
v_mfma_f32_32x32x16_bf16 v[12:27], v[108:111], v[192:195], 0
v_mfma_f32_32x32x16_bf16 v[28:43], v[116:119], v[192:195], 0
v_mfma_f32_32x32x16_bf16 v[44:59], v[124:127], v[192:195], 0
v_mfma_f32_32x32x16_bf16 v[60:75], v[132:135], v[192:195], 0
v_mfma_f32_32x32x16_bf16 v[12:27], v[112:115], v[196:199], v[12:27]
v_mfma_f32_32x32x16_bf16 v[28:43], v[120:123], v[196:199], v[28:43]
v_mfma_f32_32x32x16_bf16 v[44:59], v[128:131], v[196:199], v[44:59]
v_mfma_f32_32x32x16_bf16 v[60:75], v[136:139], v[196:199], v[60:75]
v_mfma_f32_32x32x16_bf16 v[12:27], v[140:143], v[200:203], v[12:27]
v_mfma_f32_32x32x16_bf16 v[28:43], v[144:147], v[200:203], v[28:43]
v_mfma_f32_32x32x16_bf16 v[44:59], v[148:151], v[200:203], v[44:59]
v_mfma_f32_32x32x16_bf16 v[60:75], v[152:155], v[200:203], v[60:75]
s_nop 8
v_cvt_pk_bf16_f32 v76, v12, v13
v_cvt_pk_bf16_f32 v77, v14, v15
v_cvt_pk_bf16_f32 v78, v16, v17
v_cvt_pk_bf16_f32 v79, v18, v19
buffer_store_dwordx4 v[76:79], v8, s[12:15], s19 offen offset:0 sc1
v_cvt_pk_bf16_f32 v80, v20, v21
v_cvt_pk_bf16_f32 v81, v22, v23
v_cvt_pk_bf16_f32 v82, v24, v25
v_cvt_pk_bf16_f32 v83, v26, v27
buffer_store_dwordx4 v[80:83], v8, s[12:15], s19 offen offset:1024 sc1
v_cvt_pk_bf16_f32 v84, v28, v29
v_cvt_pk_bf16_f32 v85, v30, v31
v_cvt_pk_bf16_f32 v86, v32, v33
v_cvt_pk_bf16_f32 v87, v34, v35
buffer_store_dwordx4 v[84:87], v8, s[12:15], s19 offen offset:2048 sc1
v_cvt_pk_bf16_f32 v88, v36, v37
v_cvt_pk_bf16_f32 v89, v38, v39
v_cvt_pk_bf16_f32 v90, v40, v41
v_cvt_pk_bf16_f32 v91, v42, v43
buffer_store_dwordx4 v[88:91], v8, s[12:15], s19 offen offset:3072 sc1
v_cvt_pk_bf16_f32 v92, v44, v45
v_cvt_pk_bf16_f32 v93, v46, v47
v_cvt_pk_bf16_f32 v94, v48, v49
v_cvt_pk_bf16_f32 v95, v50, v51
buffer_store_dwordx4 v[92:95], v9, s[12:15], s19 offen offset:0 sc1
v_cvt_pk_bf16_f32 v96, v52, v53
v_cvt_pk_bf16_f32 v97, v54, v55
v_cvt_pk_bf16_f32 v98, v56, v57
v_cvt_pk_bf16_f32 v99, v58, v59
buffer_store_dwordx4 v[96:99], v9, s[12:15], s19 offen offset:1024 sc1
v_cvt_pk_bf16_f32 v100, v60, v61
v_cvt_pk_bf16_f32 v101, v62, v63
v_cvt_pk_bf16_f32 v102, v64, v65
v_cvt_pk_bf16_f32 v103, v66, v67
buffer_store_dwordx4 v[100:103], v9, s[12:15], s19 offen offset:2048 sc1
v_cvt_pk_bf16_f32 v104, v68, v69
v_cvt_pk_bf16_f32 v105, v70, v71
v_cvt_pk_bf16_f32 v106, v72, v73
v_cvt_pk_bf16_f32 v107, v74, v75
buffer_store_dwordx4 v[104:107], v9, s[12:15], s19 offen offset:3072 sc1
v_mfma_f32_32x32x16_bf16 v[156:171], a[44:47], a[12:15], 0
v_mfma_f32_32x32x16_bf16 v[156:171], a[48:51], a[16:19], v[156:171]
v_mfma_f32_32x32x16_bf16 v[156:171], a[52:55], a[20:23], v[156:171]
v_mfma_f32_32x32x16_bf16 v[156:171], a[56:59], a[24:27], v[156:171]
v_mfma_f32_32x32x16_bf16 v[156:171], a[60:63], a[28:31], v[156:171]
v_mfma_f32_32x32x16_bf16 v[156:171], a[64:67], a[32:35], v[156:171]
v_mfma_f32_32x32x16_bf16 v[156:171], a[68:71], a[36:39], v[156:171]
v_mfma_f32_32x32x16_bf16 v[156:171], a[72:75], a[40:43], v[156:171]
s_waitcnt vmcnt(12)
v_mfma_f32_32x32x16_bf16 v[172:187], a[76:79], a[12:15], 0
v_mfma_f32_32x32x16_bf16 v[172:187], a[80:83], a[16:19], v[172:187]
v_mfma_f32_32x32x16_bf16 v[172:187], a[84:87], a[20:23], v[172:187]
v_mfma_f32_32x32x16_bf16 v[172:187], a[88:91], a[24:27], v[172:187]
v_mfma_f32_32x32x16_bf16 v[172:187], a[92:95], a[28:31], v[172:187]
v_mfma_f32_32x32x16_bf16 v[172:187], a[96:99], a[32:35], v[172:187]
v_mfma_f32_32x32x16_bf16 v[172:187], a[100:103], a[36:39], v[172:187]
v_mfma_f32_32x32x16_bf16 v[172:187], a[104:107], a[40:43], v[172:187]
s_nop 2
v_cvt_pk_bf16_f32 v188, v156, v157
v_cvt_pk_bf16_f32 v189, v158, v159
v_cvt_pk_bf16_f32 v190, v160, v161
v_cvt_pk_bf16_f32 v191, v162, v163
v_cvt_pk_bf16_f32 v192, v164, v165
v_cvt_pk_bf16_f32 v193, v166, v167
v_cvt_pk_bf16_f32 v194, v168, v169
v_cvt_pk_bf16_f32 v195, v170, v171
s_nop 0
v_cvt_pk_bf16_f32 v196, v172, v173
v_cvt_pk_bf16_f32 v197, v174, v175
v_lshlrev_b32 v156, 16, v188
v_and_b32 v157, 0xffff0000, v188
v_lshlrev_b32 v158, 16, v189
v_and_b32 v159, 0xffff0000, v189
v_lshlrev_b32 v160, 16, v190
v_and_b32 v161, 0xffff0000, v190
v_lshlrev_b32 v162, 16, v191
v_and_b32 v163, 0xffff0000, v191
v_lshlrev_b32 v164, 16, v192
v_and_b32 v165, 0xffff0000, v192
v_lshlrev_b32 v166, 16, v193
v_and_b32 v167, 0xffff0000, v193
v_lshlrev_b32 v168, 16, v194
v_and_b32 v169, 0xffff0000, v194
v_lshlrev_b32 v170, 16, v195
v_and_b32 v171, 0xffff0000, v195
v_lshlrev_b32 v172, 16, v196
v_and_b32 v173, 0xffff0000, v196
v_lshlrev_b32 v174, 16, v197
v_and_b32 v175, 0xffff0000, v197
v_mul_f32 v156, 0x3db504f3, v156
v_mul_f32 v157, 0x3db504f3, v157
v_mul_f32 v158, 0x3db504f3, v158
v_mul_f32 v159, 0x3db504f3, v159
v_mul_f32 v160, 0x3db504f3, v160
v_mul_f32 v161, 0x3db504f3, v161
v_mul_f32 v162, 0x3db504f3, v162
v_mul_f32 v163, 0x3db504f3, v163
v_mul_f32 v164, 0x3db504f3, v164
v_mul_f32 v165, 0x3db504f3, v165
v_mul_f32 v166, 0x3db504f3, v166
v_mul_f32 v167, 0x3db504f3, v167
v_mul_f32 v168, 0x3db504f3, v168
v_mul_f32 v169, 0x3db504f3, v169
v_mul_f32 v170, 0x3db504f3, v170
v_mul_f32 v171, 0x3db504f3, v171
v_mul_f32 v172, 0x3db504f3, v172
v_mul_f32 v173, 0x3db504f3, v173
v_mul_f32 v174, 0x3db504f3, v174
v_mul_f32 v175, 0x3db504f3, v175
v_cvt_pk_bf16_f32 v188, v156, v157
v_cvt_pk_bf16_f32 v189, v158, v159
v_cvt_pk_bf16_f32 v190, v160, v161
v_cvt_pk_bf16_f32 v191, v162, v163
v_cvt_pk_bf16_f32 v192, v164, v165
v_cvt_pk_bf16_f32 v193, v166, v167
v_cvt_pk_bf16_f32 v194, v168, v169
v_cvt_pk_bf16_f32 v195, v170, v171
v_cvt_pk_bf16_f32 v196, v172, v173
v_cvt_pk_bf16_f32 v197, v174, v175
v_lshlrev_b32 v156, 16, v188
v_and_b32 v157, 0xffff0000, v188
v_lshlrev_b32 v158, 16, v189
v_and_b32 v159, 0xffff0000, v189
v_lshlrev_b32 v160, 16, v190
v_and_b32 v161, 0xffff0000, v190
v_lshlrev_b32 v162, 16, v191
v_and_b32 v163, 0xffff0000, v191
v_lshlrev_b32 v164, 16, v192
v_and_b32 v165, 0xffff0000, v192
v_lshlrev_b32 v166, 16, v193
v_and_b32 v167, 0xffff0000, v193
v_lshlrev_b32 v168, 16, v194
v_and_b32 v169, 0xffff0000, v194
v_lshlrev_b32 v170, 16, v195
v_and_b32 v171, 0xffff0000, v195
v_lshlrev_b32 v172, 16, v196
v_and_b32 v173, 0xffff0000, v196
v_lshlrev_b32 v174, 16, v197
v_and_b32 v175, 0xffff0000, v197
v_mov_b32 v6, 0xff800000
v_cmp_le_i32 s[24:25], 0, v7
v_cmp_le_i32 s[26:27], 1, v7
v_cmp_le_i32 s[28:29], 2, v7
v_cmp_le_i32 s[30:31], 3, v7
v_cndmask_b32 v156, v6, v156, s[24:25]
v_cndmask_b32 v157, v6, v157, s[26:27]
v_cndmask_b32 v158, v6, v158, s[28:29]
v_cndmask_b32 v159, v6, v159, s[30:31]
v_cmp_le_i32 s[24:25], 8, v7
v_cmp_le_i32 s[26:27], 9, v7
v_cmp_le_i32 s[28:29], 10, v7
v_cmp_le_i32 s[30:31], 11, v7
v_cndmask_b32 v160, v6, v160, s[24:25]
v_cndmask_b32 v161, v6, v161, s[26:27]
v_cndmask_b32 v162, v6, v162, s[28:29]
v_cndmask_b32 v163, v6, v163, s[30:31]
v_cmp_le_i32 s[24:25], 16, v7
v_cmp_le_i32 s[26:27], 17, v7
v_cmp_le_i32 s[28:29], 18, v7
v_cmp_le_i32 s[30:31], 19, v7
v_cndmask_b32 v164, v6, v164, s[24:25]
v_cndmask_b32 v165, v6, v165, s[26:27]
v_cndmask_b32 v166, v6, v166, s[28:29]
v_cndmask_b32 v167, v6, v167, s[30:31]
v_cmp_le_i32 s[24:25], 24, v7
v_cmp_le_i32 s[26:27], 25, v7
v_cmp_le_i32 s[28:29], 26, v7
v_cmp_le_i32 s[30:31], 27, v7
v_cndmask_b32 v168, v6, v168, s[24:25]
v_cndmask_b32 v169, v6, v169, s[26:27]
v_cndmask_b32 v170, v6, v170, s[28:29]
v_cndmask_b32 v171, v6, v171, s[30:31]
v_max3_f32 v188, v156, v157, v158
v_max3_f32 v189, v159, v160, v161
v_max3_f32 v188, v188, v162, v163
v_max3_f32 v189, v189, v164, v165
v_max3_f32 v188, v188, v166, v167
v_max3_f32 v189, v189, v168, v169
v_max3_f32 v188, v188, v170, v171
v_max3_f32 v189, v189, v172, v173
v_max3_f32 v188, v188, v174, v175
v_max_f32 v188, v188, v189
v_mov_b32 v189, v188
s_nop 1
v_permlane32_swap_b32 v188, v189
v_max_f32 v188, v188, v189
v_mul_f32 v188, 0xbfb8aa3b, v188
s_mov_b32 s22, 0x3fb8aa3b
v_fma_f32 v156, v156, s22, v188
v_fma_f32 v157, v157, s22, v188
v_fma_f32 v158, v158, s22, v188
v_fma_f32 v159, v159, s22, v188
v_fma_f32 v160, v160, s22, v188
v_fma_f32 v161, v161, s22, v188
v_fma_f32 v162, v162, s22, v188
v_fma_f32 v163, v163, s22, v188
v_fma_f32 v164, v164, s22, v188
v_fma_f32 v165, v165, s22, v188
v_fma_f32 v166, v166, s22, v188
v_fma_f32 v167, v167, s22, v188
v_fma_f32 v168, v168, s22, v188
v_fma_f32 v169, v169, s22, v188
v_fma_f32 v170, v170, s22, v188
v_fma_f32 v171, v171, s22, v188
v_fma_f32 v172, v172, s22, v188
v_fma_f32 v173, v173, s22, v188
v_fma_f32 v174, v174, s22, v188
v_fma_f32 v175, v175, s22, v188
v_exp_f32 v156, v156
v_exp_f32 v157, v157
v_exp_f32 v158, v158
v_exp_f32 v159, v159
v_exp_f32 v160, v160
v_exp_f32 v161, v161
v_exp_f32 v162, v162
v_exp_f32 v163, v163
v_exp_f32 v164, v164
v_exp_f32 v165, v165
v_exp_f32 v166, v166
v_exp_f32 v167, v167
v_exp_f32 v168, v168
v_exp_f32 v169, v169
v_exp_f32 v170, v170
v_exp_f32 v171, v171
v_exp_f32 v172, v172
v_exp_f32 v173, v173
v_exp_f32 v174, v174
v_exp_f32 v175, v175
v_add_f32 v188, v156, v157
v_add_f32 v189, v158, v159
v_add_f32 v188, v188, v160
v_add_f32 v189, v189, v161
v_add_f32 v188, v188, v162
v_add_f32 v189, v189, v163
v_add_f32 v188, v188, v164
v_add_f32 v189, v189, v165
v_add_f32 v188, v188, v166
v_add_f32 v189, v189, v167
v_add_f32 v188, v188, v168
v_add_f32 v189, v189, v169
v_add_f32 v188, v188, v170
v_add_f32 v189, v189, v171
v_add_f32 v188, v188, v172
v_add_f32 v189, v189, v173
v_add_f32 v188, v188, v174
v_add_f32 v189, v189, v175
v_add_f32 v188, v188, v189
v_mov_b32 v189, v188
s_nop 1
v_permlane32_swap_b32 v188, v189
v_add_f32 v188, v188, v189
v_rcp_f32 v188, v188
s_nop 0
v_mul_f32 v156, v156, v188
v_mul_f32 v157, v157, v188
v_mul_f32 v158, v158, v188
v_mul_f32 v159, v159, v188
v_mul_f32 v160, v160, v188
v_mul_f32 v161, v161, v188
v_mul_f32 v162, v162, v188
v_mul_f32 v163, v163, v188
v_mul_f32 v164, v164, v188
v_mul_f32 v165, v165, v188
v_mul_f32 v166, v166, v188
v_mul_f32 v167, v167, v188
v_mul_f32 v168, v168, v188
v_mul_f32 v169, v169, v188
v_mul_f32 v170, v170, v188
v_mul_f32 v171, v171, v188
v_mul_f32 v172, v172, v188
v_mul_f32 v173, v173, v188
v_mul_f32 v174, v174, v188
v_mul_f32 v175, v175, v188
v_cvt_pk_bf16_f32 v192, v156, v157
v_cvt_pk_bf16_f32 v193, v158, v159
v_cvt_pk_bf16_f32 v194, v160, v161
v_cvt_pk_bf16_f32 v195, v162, v163
v_cvt_pk_bf16_f32 v196, v164, v165
v_cvt_pk_bf16_f32 v197, v166, v167
v_cvt_pk_bf16_f32 v198, v168, v169
v_cvt_pk_bf16_f32 v199, v170, v171
v_cvt_pk_bf16_f32 v200, v172, v173
v_cvt_pk_bf16_f32 v201, v174, v175
v_mov_b32 v202, 0
v_mov_b32 v203, 0
s_waitcnt vmcnt(8)
v_mfma_f32_32x32x16_bf16 v[12:27], a[108:111], v[192:195], 0
v_mfma_f32_32x32x16_bf16 v[28:43], a[116:119], v[192:195], 0
v_mfma_f32_32x32x16_bf16 v[44:59], a[124:127], v[192:195], 0
v_mfma_f32_32x32x16_bf16 v[60:75], a[132:135], v[192:195], 0
v_mfma_f32_32x32x16_bf16 v[12:27], a[112:115], v[196:199], v[12:27]
v_mfma_f32_32x32x16_bf16 v[28:43], a[120:123], v[196:199], v[28:43]
v_mfma_f32_32x32x16_bf16 v[44:59], a[128:131], v[196:199], v[44:59]
v_mfma_f32_32x32x16_bf16 v[60:75], a[136:139], v[196:199], v[60:75]
v_mfma_f32_32x32x16_bf16 v[12:27], a[140:143], v[200:203], v[12:27]
v_mfma_f32_32x32x16_bf16 v[28:43], a[144:147], v[200:203], v[28:43]
v_mfma_f32_32x32x16_bf16 v[44:59], a[148:151], v[200:203], v[44:59]
v_mfma_f32_32x32x16_bf16 v[60:75], a[152:155], v[200:203], v[60:75]
s_add_u32 s19, s19, 8192
s_nop 7
v_cvt_pk_bf16_f32 v108, v12, v13
v_cvt_pk_bf16_f32 v109, v14, v15
v_cvt_pk_bf16_f32 v110, v16, v17
v_cvt_pk_bf16_f32 v111, v18, v19
buffer_store_dwordx4 v[108:111], v8, s[12:15], s19 offen offset:0 sc1
v_cvt_pk_bf16_f32 v112, v20, v21
v_cvt_pk_bf16_f32 v113, v22, v23
v_cvt_pk_bf16_f32 v114, v24, v25
v_cvt_pk_bf16_f32 v115, v26, v27
buffer_store_dwordx4 v[112:115], v8, s[12:15], s19 offen offset:1024 sc1
v_cvt_pk_bf16_f32 v116, v28, v29
v_cvt_pk_bf16_f32 v117, v30, v31
v_cvt_pk_bf16_f32 v118, v32, v33
v_cvt_pk_bf16_f32 v119, v34, v35
buffer_store_dwordx4 v[116:119], v8, s[12:15], s19 offen offset:2048 sc1
v_cvt_pk_bf16_f32 v120, v36, v37
v_cvt_pk_bf16_f32 v121, v38, v39
v_cvt_pk_bf16_f32 v122, v40, v41
v_cvt_pk_bf16_f32 v123, v42, v43
buffer_store_dwordx4 v[120:123], v8, s[12:15], s19 offen offset:3072 sc1
v_cvt_pk_bf16_f32 v124, v44, v45
v_cvt_pk_bf16_f32 v125, v46, v47
v_cvt_pk_bf16_f32 v126, v48, v49
v_cvt_pk_bf16_f32 v127, v50, v51
buffer_store_dwordx4 v[124:127], v9, s[12:15], s19 offen offset:0 sc1
v_cvt_pk_bf16_f32 v128, v52, v53
v_cvt_pk_bf16_f32 v129, v54, v55
v_cvt_pk_bf16_f32 v130, v56, v57
v_cvt_pk_bf16_f32 v131, v58, v59
buffer_store_dwordx4 v[128:131], v9, s[12:15], s19 offen offset:1024 sc1
v_cvt_pk_bf16_f32 v132, v60, v61
v_cvt_pk_bf16_f32 v133, v62, v63
v_cvt_pk_bf16_f32 v134, v64, v65
v_cvt_pk_bf16_f32 v135, v66, v67
buffer_store_dwordx4 v[132:135], v9, s[12:15], s19 offen offset:2048 sc1
v_cvt_pk_bf16_f32 v136, v68, v69
v_cvt_pk_bf16_f32 v137, v70, v71
v_cvt_pk_bf16_f32 v138, v72, v73
v_cvt_pk_bf16_f32 v139, v74, v75
buffer_store_dwordx4 v[136:139], v9, s[12:15], s19 offen offset:3072 sc1
v_mov_b32 v1, 1408
buffer_load_dword v1, v1, s[88:91], 0 offen sc1
s_waitcnt vmcnt(0)
v_readfirstlane_b32 s70, v1
s_cmp_eq_u32 s70, 1
s_cselect_b32 s70, 8192, 0
s_add_u32 s86, s70, 119554048
s_bfe_u32 s82, s78, 0x30000
s_mul_i32 s82, s82, 1024
s_add_u32 s86, s86, s82
s_bfe_u32 s82, s77, 0x10004
s_mul_i32 s82, s82, 128
s_add_u32 s86, s86, s82
s_waitcnt vmcnt(0)
s_barrier
s_cmp_lg_u32 s3, 0
s_cbranch_scc1 .Lsg_350
v_mov_b32 v1, 1
v_mul_u32_u24 v2, 0, v0
s_mov_b64 exec, 1
buffer_atomic_add v1, v2, s[88:91], s86 offen sc1
s_mov_b64 exec, -1
.Lsg_350:
s_lshl_b32 s84, s78, 1
s_and_b32 s81, s77, 1
s_add_u32 s84, s84, s81
s_lshr_b32 s85, s77, 1
s_add_u32 s86, s70, 119554048
s_bfe_u32 s82, s78, 0x30000
s_mul_i32 s82, s82, 1024
s_add_u32 s86, s86, s82
s_bfe_u32 s82, s77, 0x10000
s_mul_i32 s82, s82, 128
s_add_u32 s86, s86, s82
s_load_dwordx2 s[6:7], s[0:1], 40
s_add_u32 s40, s4, 0x4000000
s_addc_u32 s41, s5, 0
s_mov_b32 s42, 0x1000000
s_mov_b32 s43, 0x00020000
s_and_b32 s18, s85, 7
s_mov_b32 s19, 2048
s_cmp_eq_u32 s18, 3
s_cselect_b32 s19, 128, s19
v_lshrrev_b32 v142, 2, v0
v_and_b32 v142, 3, v142
v_lshrrev_b32 v143, 5, v0
v_lshlrev_b32 v143, 2, v143
v_add_u32 v143, v143, v142
v_mul_u32_u24 v143, 128, v143
v_and_b32 v144, 3, v0
v_lshlrev_b32 v144, 3, v144
v_add_u32 v143, v143, v144
v_and_b32 v144, 16, v0
v_lshlrev_b32 v144, 1, v144
v_add_u32 v143, v143, v144
v_lshrrev_b32 v142, 1, v142
s_and_b32 s53, s3, 0
s_mul_i32 s53, s53, 2
s_add_u32 s57, s53, 0
v_xor_b32 v144, s57, v142
v_lshlrev_b32 v144, 6, v144
v_add_u32 v136, v143, v144
s_add_u32 s57, s53, 1
v_xor_b32 v144, s57, v142
v_lshlrev_b32 v144, 6, v144
v_add_u32 v137, v143, v144
s_lshr_b32 s53, s3, 0
s_mul_i32 s53, s53, 262144
v_lshlrev_b32 v140, 4, v0
v_add_u32 v140, s53, v140
v_lshrrev_b32 v142, 3, v0
s_mul_i32 s53, s3, 8
v_add_u32 v142, s53, v142
v_and_b32 v143, 3, v142
v_lshrrev_b32 v143, 1, v143
v_and_b32 v144, 7, v0
v_lshrrev_b32 v144, 2, v144
v_xor_b32 v143, v143, v144
v_lshlrev_b32 v143, 6, v143
v_and_b32 v144, 3, v0
v_lshlrev_b32 v144, 4, v144
v_add_u32 v143, v143, v144
s_mov_b32 s53, s19
v_mul_lo_u32 v142, v142, s53
v_add_u32 v141, v142, v143
s_mul_i32 s54, s53, 32
s_lshl_b32 s56, s3, 10
s_waitcnt lgkmcnt(0)
s_mul_i32 s48, s84, 1048576
s_mul_i32 s49, s85, 128
s_mov_b32 s50, 128
s_add_u32 s16, s4, 113246208
s_addc_u32 s17, s5, 0
s_lshr_b32 s18, s85, 3
s_lshl_b32 s18, s18, 19
s_cmp_eq_u32 s19, 128
s_cselect_b32 s6, s16, s6
s_cselect_b32 s7, s17, s7
s_cselect_b32 s49, s18, s49
s_mov_b32 s44, s6
s_mov_b32 s45, s7
s_mov_b32 s46, 0x800000
s_mov_b32 s47, 0x00020000
s_add_u32 m0, s56, 0
s_nop 0
buffer_load_dwordx4 v141, s[44:47], s49 offen lds
s_add_u32 s49, s49, s54
s_add_u32 m0, s56, 4096
s_nop 0
buffer_load_dwordx4 v141, s[44:47], s49 offen lds
s_add_u32 s49, s49, s54
s_add_u32 m0, s56, 8192
s_nop 0
buffer_load_dwordx4 v141, s[44:47], s49 offen lds
s_add_u32 s49, s49, s54
s_add_u32 m0, s56, 12288
s_nop 0
buffer_load_dwordx4 v141, s[44:47], s49 offen lds
s_add_u32 s49, s49, s54
s_add_u32 m0, s56, 16384
s_nop 0
buffer_load_dwordx4 v141, s[44:47], s49 offen lds
s_add_u32 s49, s49, s54
s_add_u32 m0, s56, 20480
s_nop 0
buffer_load_dwordx4 v141, s[44:47], s49 offen lds
s_add_u32 s49, s49, s54
s_add_u32 m0, s56, 24576
s_nop 0
buffer_load_dwordx4 v141, s[44:47], s49 offen lds
s_add_u32 s49, s49, s54
s_add_u32 m0, s56, 28672
s_nop 0
buffer_load_dwordx4 v141, s[44:47], s49 offen lds
s_add_u32 s49, s49, s54
s_add_u32 m0, s56, 32768
s_nop 0
buffer_load_dwordx4 v141, s[44:47], s49 offen lds
s_add_u32 s49, s49, s54
s_add_u32 m0, s56, 36864
s_nop 0
buffer_load_dwordx4 v141, s[44:47], s49 offen lds
s_add_u32 s49, s49, s54
s_add_u32 m0, s56, 40960
s_nop 0
buffer_load_dwordx4 v141, s[44:47], s49 offen lds
s_add_u32 s49, s49, s54
s_add_u32 m0, s56, 45056
s_nop 0
buffer_load_dwordx4 v141, s[44:47], s49 offen lds
s_add_u32 s49, s49, s54
s_add_u32 m0, s56, 49152
s_nop 0
buffer_load_dwordx4 v141, s[44:47], s49 offen lds
s_add_u32 s49, s49, s54
s_add_u32 m0, s56, 53248
s_nop 0
buffer_load_dwordx4 v141, s[44:47], s49 offen lds
s_add_u32 s49, s49, s54
s_add_u32 m0, s56, 57344
s_nop 0
buffer_load_dwordx4 v141, s[44:47], s49 offen lds
s_add_u32 s49, s49, s54
s_add_u32 m0, s56, 61440
s_nop 0
buffer_load_dwordx4 v141, s[44:47], s49 offen lds
s_add_u32 s49, s49, s54
s_add_u32 m0, s56, 65536
s_nop 0
buffer_load_dwordx4 v141, s[44:47], s49 offen lds
s_add_u32 s49, s49, s54
s_add_u32 m0, s56, 69632
s_nop 0
buffer_load_dwordx4 v141, s[44:47], s49 offen lds
s_add_u32 s49, s49, s54
s_add_u32 m0, s56, 73728
s_nop 0
buffer_load_dwordx4 v141, s[44:47], s49 offen lds
s_add_u32 s49, s49, s54
s_add_u32 m0, s56, 77824
s_nop 0
buffer_load_dwordx4 v141, s[44:47], s49 offen lds
s_add_u32 s49, s49, s54
s_add_u32 m0, s56, 81920
s_nop 0
buffer_load_dwordx4 v141, s[44:47], s49 offen lds
s_add_u32 s49, s49, s54
s_add_u32 m0, s56, 86016
s_nop 0
buffer_load_dwordx4 v141, s[44:47], s49 offen lds
s_add_u32 s49, s49, s54
s_add_u32 m0, s56, 90112
s_nop 0
buffer_load_dwordx4 v141, s[44:47], s49 offen lds
s_add_u32 s49, s49, s54
s_add_u32 m0, s56, 94208
s_nop 0
buffer_load_dwordx4 v141, s[44:47], s49 offen lds
s_add_u32 s49, s49, s54
s_lshr_b32 s16, s3, 0
s_mul_i32 s16, s16, 1
s_mul_i32 s18, s84, 4
s_add_u32 s16, s16, s18
s_and_b32 s17, s3, 0
s_mul_i32 s17, s17, 4
s_mul_i32 s18, s85, 4
s_add_u32 s17, s17, s18
v_lshlrev_b32 v4, 4, v0
s_add_u32 s36, s4, 0x400000
s_addc_u32 s37, s5, 0
s_mov_b32 s38, 0x400000
s_mov_b32 s39, 0x00020000
s_add_u32 s32, s4, 0xc02000
s_addc_u32 s33, s5, 0
s_mov_b32 s34, 0x1000
s_mov_b32 s35, 0x00020000
s_lshl_b32 s12, s16, 16
s_lshl_b32 s18, s17, 10
s_add_u32 s12, s12, s18
s_lshl_b32 s13, s17, 6
v_lshrrev_b32 v5, 5, v0
v_lshlrev_b32 v6, 4, v5
v_lshlrev_b32 v5, 5, v5
buffer_load_dwordx4 v[148:151], v5, s[32:35], s13 offen offset:0
buffer_load_dwordx4 v[152:155], v5, s[32:35], s13 offen offset:16
buffer_load_dwordx4 v[156:159], v5, s[32:35], s13 offen offset:64
buffer_load_dwordx4 v[160:163], v5, s[32:35], s13 offen offset:80
buffer_load_dwordx4 v[164:167], v5, s[32:35], s13 offen offset:128
buffer_load_dwordx4 v[168:171], v5, s[32:35], s13 offen offset:144
buffer_load_dwordx4 v[172:175], v5, s[32:35], s13 offen offset:192
buffer_load_dwordx4 v[176:179], v5, s[32:35], s13 offen offset:208
s_add_u32 s57, s12, 0
buffer_load_dwordx4 v[180:183], v4, s[36:39], s57 offen offset:0 sc1
buffer_load_dwordx4 v[184:187], v4, s[36:39], s57 offen offset:1024 sc1
buffer_load_dwordx4 v[188:191], v4, s[36:39], s57 offen offset:2048 sc1
buffer_load_dwordx4 v[192:195], v4, s[36:39], s57 offen offset:3072 sc1
s_cmp_lg_u32 s3, 0
s_cbranch_scc1 .Lws_351
v_mul_u32_u24 v1, 0, v0
v_add_u32 v1, s86, v1
v_mov_b32 v2, 16
s_mov_b64 exec, 1
.Lwl_352:
buffer_load_dword v3, v1, s[88:91], 0 offen sc1
s_waitcnt vmcnt(0)
v_cmp_lt_u32 vcc, v3, v2
s_cbranch_vccz .Lwo_353
s_cmp_eq_u32 s80, 0
s_cbranch_scc1 .Lwo_353
s_sub_u32 s80, s80, 1
s_branch .Lwl_352
.Lwo_353:
s_mov_b64 exec, -1
.Lws_351:
s_barrier
buffer_load_dwordx4 v[8:11], v140, s[40:43], s48 offen offset:0 sc1
buffer_load_dwordx4 v[12:15], v140, s[40:43], s48 offen offset:1024 sc1
buffer_load_dwordx4 v[16:19], v140, s[40:43], s48 offen offset:2048 sc1
buffer_load_dwordx4 v[20:23], v140, s[40:43], s48 offen offset:3072 sc1
s_add_u32 s48, s48, 4096
buffer_load_dwordx4 v[24:27], v140, s[40:43], s48 offen offset:0 sc1
buffer_load_dwordx4 v[28:31], v140, s[40:43], s48 offen offset:1024 sc1
buffer_load_dwordx4 v[32:35], v140, s[40:43], s48 offen offset:2048 sc1
buffer_load_dwordx4 v[36:39], v140, s[40:43], s48 offen offset:3072 sc1
s_add_u32 s48, s48, 4096
buffer_load_dwordx4 v[40:43], v140, s[40:43], s48 offen offset:0 sc1
buffer_load_dwordx4 v[44:47], v140, s[40:43], s48 offen offset:1024 sc1
buffer_load_dwordx4 v[48:51], v140, s[40:43], s48 offen offset:2048 sc1
buffer_load_dwordx4 v[52:55], v140, s[40:43], s48 offen offset:3072 sc1
s_add_u32 s48, s48, 4096
buffer_load_dwordx4 v[56:59], v140, s[40:43], s48 offen offset:0 sc1
buffer_load_dwordx4 v[60:63], v140, s[40:43], s48 offen offset:1024 sc1
v_accvgpr_write_b32 a0, 0
v_accvgpr_write_b32 a1, 0
v_accvgpr_write_b32 a2, 0
v_accvgpr_write_b32 a3, 0
v_accvgpr_write_b32 a4, 0
v_accvgpr_write_b32 a5, 0
v_accvgpr_write_b32 a6, 0
v_accvgpr_write_b32 a7, 0
v_accvgpr_write_b32 a8, 0
v_accvgpr_write_b32 a9, 0
v_accvgpr_write_b32 a10, 0
v_accvgpr_write_b32 a11, 0
v_accvgpr_write_b32 a12, 0
v_accvgpr_write_b32 a13, 0
v_accvgpr_write_b32 a14, 0
v_accvgpr_write_b32 a15, 0
v_accvgpr_write_b32 a16, 0
v_accvgpr_write_b32 a17, 0
v_accvgpr_write_b32 a18, 0
v_accvgpr_write_b32 a19, 0
v_accvgpr_write_b32 a20, 0
v_accvgpr_write_b32 a21, 0
v_accvgpr_write_b32 a22, 0
v_accvgpr_write_b32 a23, 0
v_accvgpr_write_b32 a24, 0
v_accvgpr_write_b32 a25, 0
v_accvgpr_write_b32 a26, 0
v_accvgpr_write_b32 a27, 0
v_accvgpr_write_b32 a28, 0
v_accvgpr_write_b32 a29, 0
v_accvgpr_write_b32 a30, 0
v_accvgpr_write_b32 a31, 0
s_waitcnt vmcnt(10)
s_barrier
s_mov_b32 s51, 0
s_add_u32 s52, s56, 98304
v_mov_b32 v138, v136
v_mov_b32 v139, v137
ds_read_b64_tr_b16 v[72:73], v138 offset:0
ds_read_b64_tr_b16 v[74:75], v138 offset:1024
ds_read_b64_tr_b16 v[76:77], v139 offset:0
ds_read_b64_tr_b16 v[78:79], v139 offset:1024
ds_read_b64_tr_b16 v[80:81], v138 offset:2048
ds_read_b64_tr_b16 v[82:83], v138 offset:3072
ds_read_b64_tr_b16 v[84:85], v139 offset:2048
ds_read_b64_tr_b16 v[86:87], v139 offset:3072
ds_read_b64_tr_b16 v[88:89], v138 offset:4096
ds_read_b64_tr_b16 v[90:91], v138 offset:5120
ds_read_b64_tr_b16 v[92:93], v139 offset:4096
ds_read_b64_tr_b16 v[94:95], v139 offset:5120
ds_read_b64_tr_b16 v[96:97], v138 offset:6144
ds_read_b64_tr_b16 v[98:99], v138 offset:7168
ds_read_b64_tr_b16 v[100:101], v139 offset:6144
ds_read_b64_tr_b16 v[102:103], v139 offset:7168
s_waitcnt lgkmcnt(8)
v_mfma_f32_32x32x16_bf16 a[0:15], v[72:75], v[8:11], a[0:15]
s_waitcnt vmcnt(8)
s_barrier
ds_read_b64_tr_b16 v[104:105], v138 offset:8192
ds_read_b64_tr_b16 v[106:107], v138 offset:9216
v_mfma_f32_32x32x16_bf16 a[16:31], v[76:79], v[8:11], a[16:31]
ds_read_b64_tr_b16 v[108:109], v139 offset:8192
ds_read_b64_tr_b16 v[110:111], v139 offset:9216
s_add_u32 m0, s52, 0
s_nop 0
buffer_load_dwordx4 v141, s[44:47], s49 offen lds
s_add_u32 s49, s49, s54
v_mfma_f32_32x32x16_bf16 a[0:15], v[80:83], v[12:15], a[0:15]
ds_read_b64_tr_b16 v[112:113], v138 offset:10240
ds_read_b64_tr_b16 v[114:115], v138 offset:11264
buffer_load_dwordx4 v[64:67], v140, s[40:43], s48 offen offset:2048 sc1
v_mfma_f32_32x32x16_bf16 a[16:31], v[84:87], v[12:15], a[16:31]
ds_read_b64_tr_b16 v[116:117], v139 offset:10240
ds_read_b64_tr_b16 v[118:119], v139 offset:11264
buffer_load_dwordx4 v[68:71], v140, s[40:43], s48 offen offset:3072 sc1
s_add_u32 s48, s48, 4096
s_waitcnt lgkmcnt(8)
v_mfma_f32_32x32x16_bf16 a[0:15], v[88:91], v[16:19], a[0:15]
s_waitcnt vmcnt(9)
s_barrier
ds_read_b64_tr_b16 v[120:121], v138 offset:12288
ds_read_b64_tr_b16 v[122:123], v138 offset:13312
v_mfma_f32_32x32x16_bf16 a[16:31], v[92:95], v[16:19], a[16:31]
ds_read_b64_tr_b16 v[124:125], v139 offset:12288
ds_read_b64_tr_b16 v[126:127], v139 offset:13312
s_add_u32 m0, s52, 4096
s_nop 0
buffer_load_dwordx4 v141, s[44:47], s49 offen lds
s_add_u32 s49, s49, s54
v_mfma_f32_32x32x16_bf16 a[0:15], v[96:99], v[20:23], a[0:15]
ds_read_b64_tr_b16 v[128:129], v138 offset:14336
ds_read_b64_tr_b16 v[130:131], v138 offset:15360
buffer_load_dwordx4 v[8:11], v140, s[40:43], s48 offen offset:0 sc1
v_mfma_f32_32x32x16_bf16 a[16:31], v[100:103], v[20:23], a[16:31]
ds_read_b64_tr_b16 v[132:133], v139 offset:14336
ds_read_b64_tr_b16 v[134:135], v139 offset:15360
buffer_load_dwordx4 v[12:15], v140, s[40:43], s48 offen offset:1024 sc1
s_waitcnt lgkmcnt(8)
v_mfma_f32_32x32x16_bf16 a[0:15], v[104:107], v[24:27], a[0:15]
s_waitcnt vmcnt(10)
s_barrier
ds_read_b64_tr_b16 v[72:73], v138 offset:16384
ds_read_b64_tr_b16 v[74:75], v138 offset:17408
v_mfma_f32_32x32x16_bf16 a[16:31], v[108:111], v[24:27], a[16:31]
ds_read_b64_tr_b16 v[76:77], v139 offset:16384
ds_read_b64_tr_b16 v[78:79], v139 offset:17408
s_add_u32 m0, s52, 8192
s_nop 0
buffer_load_dwordx4 v141, s[44:47], s49 offen lds
s_add_u32 s49, s49, s54
v_mfma_f32_32x32x16_bf16 a[0:15], v[112:115], v[28:31], a[0:15]
ds_read_b64_tr_b16 v[80:81], v138 offset:18432
ds_read_b64_tr_b16 v[82:83], v138 offset:19456
buffer_load_dwordx4 v[16:19], v140, s[40:43], s48 offen offset:2048 sc1
v_mfma_f32_32x32x16_bf16 a[16:31], v[116:119], v[28:31], a[16:31]
ds_read_b64_tr_b16 v[84:85], v139 offset:18432
ds_read_b64_tr_b16 v[86:87], v139 offset:19456
buffer_load_dwordx4 v[20:23], v140, s[40:43], s48 offen offset:3072 sc1
s_add_u32 s48, s48, 4096
s_waitcnt lgkmcnt(8)
v_mfma_f32_32x32x16_bf16 a[0:15], v[120:123], v[32:35], a[0:15]
s_waitcnt vmcnt(11)
s_barrier
ds_read_b64_tr_b16 v[88:89], v138 offset:20480
ds_read_b64_tr_b16 v[90:91], v138 offset:21504
v_mfma_f32_32x32x16_bf16 a[16:31], v[124:127], v[32:35], a[16:31]
ds_read_b64_tr_b16 v[92:93], v139 offset:20480
ds_read_b64_tr_b16 v[94:95], v139 offset:21504
s_add_u32 m0, s52, 12288
s_nop 0
buffer_load_dwordx4 v141, s[44:47], s49 offen lds
s_add_u32 s49, s49, s54
v_mfma_f32_32x32x16_bf16 a[0:15], v[128:131], v[36:39], a[0:15]
ds_read_b64_tr_b16 v[96:97], v138 offset:22528
ds_read_b64_tr_b16 v[98:99], v138 offset:23552
buffer_load_dwordx4 v[24:27], v140, s[40:43], s48 offen offset:0 sc1
v_mfma_f32_32x32x16_bf16 a[16:31], v[132:135], v[36:39], a[16:31]
ds_read_b64_tr_b16 v[100:101], v139 offset:22528
ds_read_b64_tr_b16 v[102:103], v139 offset:23552
buffer_load_dwordx4 v[28:31], v140, s[40:43], s48 offen offset:1024 sc1
s_waitcnt lgkmcnt(8)
v_mfma_f32_32x32x16_bf16 a[0:15], v[72:75], v[40:43], a[0:15]
s_waitcnt vmcnt(12)
s_barrier
ds_read_b64_tr_b16 v[104:105], v138 offset:24576
ds_read_b64_tr_b16 v[106:107], v138 offset:25600
v_mfma_f32_32x32x16_bf16 a[16:31], v[76:79], v[40:43], a[16:31]
ds_read_b64_tr_b16 v[108:109], v139 offset:24576
ds_read_b64_tr_b16 v[110:111], v139 offset:25600
s_add_u32 m0, s52, 16384
s_nop 0
buffer_load_dwordx4 v141, s[44:47], s49 offen lds
s_add_u32 s49, s49, s54
v_mfma_f32_32x32x16_bf16 a[0:15], v[80:83], v[44:47], a[0:15]
ds_read_b64_tr_b16 v[112:113], v138 offset:26624
ds_read_b64_tr_b16 v[114:115], v138 offset:27648
buffer_load_dwordx4 v[32:35], v140, s[40:43], s48 offen offset:2048 sc1
v_mfma_f32_32x32x16_bf16 a[16:31], v[84:87], v[44:47], a[16:31]
ds_read_b64_tr_b16 v[116:117], v139 offset:26624
ds_read_b64_tr_b16 v[118:119], v139 offset:27648
buffer_load_dwordx4 v[36:39], v140, s[40:43], s48 offen offset:3072 sc1
s_add_u32 s48, s48, 4096
s_waitcnt lgkmcnt(8)
v_mfma_f32_32x32x16_bf16 a[0:15], v[88:91], v[48:51], a[0:15]
s_waitcnt vmcnt(12)
s_barrier
ds_read_b64_tr_b16 v[120:121], v138 offset:28672
ds_read_b64_tr_b16 v[122:123], v138 offset:29696
v_mfma_f32_32x32x16_bf16 a[16:31], v[92:95], v[48:51], a[16:31]
ds_read_b64_tr_b16 v[124:125], v139 offset:28672
ds_read_b64_tr_b16 v[126:127], v139 offset:29696
s_add_u32 m0, s52, 20480
s_nop 0
buffer_load_dwordx4 v141, s[44:47], s49 offen lds
s_add_u32 s49, s49, s54
v_mfma_f32_32x32x16_bf16 a[0:15], v[96:99], v[52:55], a[0:15]
ds_read_b64_tr_b16 v[128:129], v138 offset:30720
ds_read_b64_tr_b16 v[130:131], v138 offset:31744
buffer_load_dwordx4 v[40:43], v140, s[40:43], s48 offen offset:0 sc1
v_mfma_f32_32x32x16_bf16 a[16:31], v[100:103], v[52:55], a[16:31]
ds_read_b64_tr_b16 v[132:133], v139 offset:30720
ds_read_b64_tr_b16 v[134:135], v139 offset:31744
buffer_load_dwordx4 v[44:47], v140, s[40:43], s48 offen offset:1024 sc1
s_waitcnt lgkmcnt(8)
v_mfma_f32_32x32x16_bf16 a[0:15], v[104:107], v[56:59], a[0:15]
s_waitcnt vmcnt(12)
s_barrier
s_add_u32 s58, s51, s56
s_add_u32 s51, s51, 32768
s_cmp_eq_u32 s51, 131072
s_cselect_b32 s51, 0, s51
v_add_u32 v138, s51, v136
v_add_u32 v139, s51, v137
ds_read_b64_tr_b16 v[72:73], v138 offset:0
ds_read_b64_tr_b16 v[74:75], v138 offset:1024
v_mfma_f32_32x32x16_bf16 a[16:31], v[108:111], v[56:59], a[16:31]
ds_read_b64_tr_b16 v[76:77], v139 offset:0
ds_read_b64_tr_b16 v[78:79], v139 offset:1024
s_add_u32 m0, s52, 24576
s_nop 0
buffer_load_dwordx4 v141, s[44:47], s49 offen lds
s_add_u32 s49, s49, s54
v_mfma_f32_32x32x16_bf16 a[0:15], v[112:115], v[60:63], a[0:15]
ds_read_b64_tr_b16 v[80:81], v138 offset:2048
ds_read_b64_tr_b16 v[82:83], v138 offset:3072
buffer_load_dwordx4 v[48:51], v140, s[40:43], s48 offen offset:2048 sc1
v_mfma_f32_32x32x16_bf16 a[16:31], v[116:119], v[60:63], a[16:31]
ds_read_b64_tr_b16 v[84:85], v139 offset:2048
ds_read_b64_tr_b16 v[86:87], v139 offset:3072
buffer_load_dwordx4 v[52:55], v140, s[40:43], s48 offen offset:3072 sc1
s_add_u32 s48, s48, 4096
s_waitcnt lgkmcnt(8)
v_mfma_f32_32x32x16_bf16 a[0:15], v[120:123], v[64:67], a[0:15]
s_waitcnt vmcnt(12)
s_barrier
ds_read_b64_tr_b16 v[88:89], v138 offset:4096
ds_read_b64_tr_b16 v[90:91], v138 offset:5120
v_mfma_f32_32x32x16_bf16 a[16:31], v[124:127], v[64:67], a[16:31]
ds_read_b64_tr_b16 v[92:93], v139 offset:4096
ds_read_b64_tr_b16 v[94:95], v139 offset:5120
s_add_u32 m0, s52, 28672
s_nop 0
buffer_load_dwordx4 v141, s[44:47], s49 offen lds
s_add_u32 s49, s49, s54
v_mfma_f32_32x32x16_bf16 a[0:15], v[128:131], v[68:71], a[0:15]
ds_read_b64_tr_b16 v[96:97], v138 offset:6144
ds_read_b64_tr_b16 v[98:99], v138 offset:7168
buffer_load_dwordx4 v[56:59], v140, s[40:43], s48 offen offset:0 sc1
v_mfma_f32_32x32x16_bf16 a[16:31], v[132:135], v[68:71], a[16:31]
ds_read_b64_tr_b16 v[100:101], v139 offset:6144
ds_read_b64_tr_b16 v[102:103], v139 offset:7168
buffer_load_dwordx4 v[60:63], v140, s[40:43], s48 offen offset:1024 sc1
s_sub_u32 s50, s50, 8
s_mov_b32 s52, s58
s_cmp_le_u32 s50, 24
s_cbranch_scc1 .LgB_355
.LgD_354:
s_waitcnt lgkmcnt(8)
v_mfma_f32_32x32x16_bf16 a[0:15], v[72:75], v[8:11], a[0:15]
s_waitcnt vmcnt(12)
s_barrier
ds_read_b64_tr_b16 v[104:105], v138 offset:8192
ds_read_b64_tr_b16 v[106:107], v138 offset:9216
v_mfma_f32_32x32x16_bf16 a[16:31], v[76:79], v[8:11], a[16:31]
ds_read_b64_tr_b16 v[108:109], v139 offset:8192
ds_read_b64_tr_b16 v[110:111], v139 offset:9216
s_add_u32 m0, s52, 0
s_nop 0
buffer_load_dwordx4 v141, s[44:47], s49 offen lds
s_add_u32 s49, s49, s54
v_mfma_f32_32x32x16_bf16 a[0:15], v[80:83], v[12:15], a[0:15]
ds_read_b64_tr_b16 v[112:113], v138 offset:10240
ds_read_b64_tr_b16 v[114:115], v138 offset:11264
buffer_load_dwordx4 v[64:67], v140, s[40:43], s48 offen offset:2048 sc1
v_mfma_f32_32x32x16_bf16 a[16:31], v[84:87], v[12:15], a[16:31]
ds_read_b64_tr_b16 v[116:117], v139 offset:10240
ds_read_b64_tr_b16 v[118:119], v139 offset:11264
buffer_load_dwordx4 v[68:71], v140, s[40:43], s48 offen offset:3072 sc1
s_add_u32 s48, s48, 4096
s_waitcnt lgkmcnt(8)
v_mfma_f32_32x32x16_bf16 a[0:15], v[88:91], v[16:19], a[0:15]
s_waitcnt vmcnt(12)
s_barrier
ds_read_b64_tr_b16 v[120:121], v138 offset:12288
ds_read_b64_tr_b16 v[122:123], v138 offset:13312
v_mfma_f32_32x32x16_bf16 a[16:31], v[92:95], v[16:19], a[16:31]
ds_read_b64_tr_b16 v[124:125], v139 offset:12288
ds_read_b64_tr_b16 v[126:127], v139 offset:13312
s_add_u32 m0, s52, 4096
s_nop 0
buffer_load_dwordx4 v141, s[44:47], s49 offen lds
s_add_u32 s49, s49, s54
v_mfma_f32_32x32x16_bf16 a[0:15], v[96:99], v[20:23], a[0:15]
ds_read_b64_tr_b16 v[128:129], v138 offset:14336
ds_read_b64_tr_b16 v[130:131], v138 offset:15360
buffer_load_dwordx4 v[8:11], v140, s[40:43], s48 offen offset:0 sc1
v_mfma_f32_32x32x16_bf16 a[16:31], v[100:103], v[20:23], a[16:31]
ds_read_b64_tr_b16 v[132:133], v139 offset:14336
ds_read_b64_tr_b16 v[134:135], v139 offset:15360
buffer_load_dwordx4 v[12:15], v140, s[40:43], s48 offen offset:1024 sc1
s_waitcnt lgkmcnt(8)
v_mfma_f32_32x32x16_bf16 a[0:15], v[104:107], v[24:27], a[0:15]
s_waitcnt vmcnt(12)
s_barrier
ds_read_b64_tr_b16 v[72:73], v138 offset:16384
ds_read_b64_tr_b16 v[74:75], v138 offset:17408
v_mfma_f32_32x32x16_bf16 a[16:31], v[108:111], v[24:27], a[16:31]
ds_read_b64_tr_b16 v[76:77], v139 offset:16384
ds_read_b64_tr_b16 v[78:79], v139 offset:17408
s_add_u32 m0, s52, 8192
s_nop 0
buffer_load_dwordx4 v141, s[44:47], s49 offen lds
s_add_u32 s49, s49, s54
v_mfma_f32_32x32x16_bf16 a[0:15], v[112:115], v[28:31], a[0:15]
ds_read_b64_tr_b16 v[80:81], v138 offset:18432
ds_read_b64_tr_b16 v[82:83], v138 offset:19456
buffer_load_dwordx4 v[16:19], v140, s[40:43], s48 offen offset:2048 sc1
v_mfma_f32_32x32x16_bf16 a[16:31], v[116:119], v[28:31], a[16:31]
ds_read_b64_tr_b16 v[84:85], v139 offset:18432
ds_read_b64_tr_b16 v[86:87], v139 offset:19456
buffer_load_dwordx4 v[20:23], v140, s[40:43], s48 offen offset:3072 sc1
s_add_u32 s48, s48, 4096
s_waitcnt lgkmcnt(8)
v_mfma_f32_32x32x16_bf16 a[0:15], v[120:123], v[32:35], a[0:15]
s_waitcnt vmcnt(12)
s_barrier
ds_read_b64_tr_b16 v[88:89], v138 offset:20480
ds_read_b64_tr_b16 v[90:91], v138 offset:21504
v_mfma_f32_32x32x16_bf16 a[16:31], v[124:127], v[32:35], a[16:31]
ds_read_b64_tr_b16 v[92:93], v139 offset:20480
ds_read_b64_tr_b16 v[94:95], v139 offset:21504
s_add_u32 m0, s52, 12288
s_nop 0
buffer_load_dwordx4 v141, s[44:47], s49 offen lds
s_add_u32 s49, s49, s54
v_mfma_f32_32x32x16_bf16 a[0:15], v[128:131], v[36:39], a[0:15]
ds_read_b64_tr_b16 v[96:97], v138 offset:22528
ds_read_b64_tr_b16 v[98:99], v138 offset:23552
buffer_load_dwordx4 v[24:27], v140, s[40:43], s48 offen offset:0 sc1
v_mfma_f32_32x32x16_bf16 a[16:31], v[132:135], v[36:39], a[16:31]
ds_read_b64_tr_b16 v[100:101], v139 offset:22528
ds_read_b64_tr_b16 v[102:103], v139 offset:23552
buffer_load_dwordx4 v[28:31], v140, s[40:43], s48 offen offset:1024 sc1
s_waitcnt lgkmcnt(8)
v_mfma_f32_32x32x16_bf16 a[0:15], v[72:75], v[40:43], a[0:15]
s_waitcnt vmcnt(12)
s_barrier
ds_read_b64_tr_b16 v[104:105], v138 offset:24576
ds_read_b64_tr_b16 v[106:107], v138 offset:25600
v_mfma_f32_32x32x16_bf16 a[16:31], v[76:79], v[40:43], a[16:31]
ds_read_b64_tr_b16 v[108:109], v139 offset:24576
ds_read_b64_tr_b16 v[110:111], v139 offset:25600
s_add_u32 m0, s52, 16384
s_nop 0
buffer_load_dwordx4 v141, s[44:47], s49 offen lds
s_add_u32 s49, s49, s54
v_mfma_f32_32x32x16_bf16 a[0:15], v[80:83], v[44:47], a[0:15]
ds_read_b64_tr_b16 v[112:113], v138 offset:26624
ds_read_b64_tr_b16 v[114:115], v138 offset:27648
buffer_load_dwordx4 v[32:35], v140, s[40:43], s48 offen offset:2048 sc1
v_mfma_f32_32x32x16_bf16 a[16:31], v[84:87], v[44:47], a[16:31]
ds_read_b64_tr_b16 v[116:117], v139 offset:26624
ds_read_b64_tr_b16 v[118:119], v139 offset:27648
buffer_load_dwordx4 v[36:39], v140, s[40:43], s48 offen offset:3072 sc1
s_add_u32 s48, s48, 4096
s_waitcnt lgkmcnt(8)
v_mfma_f32_32x32x16_bf16 a[0:15], v[88:91], v[48:51], a[0:15]
s_waitcnt vmcnt(12)
s_barrier
ds_read_b64_tr_b16 v[120:121], v138 offset:28672
ds_read_b64_tr_b16 v[122:123], v138 offset:29696
v_mfma_f32_32x32x16_bf16 a[16:31], v[92:95], v[48:51], a[16:31]
ds_read_b64_tr_b16 v[124:125], v139 offset:28672
ds_read_b64_tr_b16 v[126:127], v139 offset:29696
s_add_u32 m0, s52, 20480
s_nop 0
buffer_load_dwordx4 v141, s[44:47], s49 offen lds
s_add_u32 s49, s49, s54
v_mfma_f32_32x32x16_bf16 a[0:15], v[96:99], v[52:55], a[0:15]
ds_read_b64_tr_b16 v[128:129], v138 offset:30720
ds_read_b64_tr_b16 v[130:131], v138 offset:31744
buffer_load_dwordx4 v[40:43], v140, s[40:43], s48 offen offset:0 sc1
v_mfma_f32_32x32x16_bf16 a[16:31], v[100:103], v[52:55], a[16:31]
ds_read_b64_tr_b16 v[132:133], v139 offset:30720
ds_read_b64_tr_b16 v[134:135], v139 offset:31744
buffer_load_dwordx4 v[44:47], v140, s[40:43], s48 offen offset:1024 sc1
s_waitcnt lgkmcnt(8)
v_mfma_f32_32x32x16_bf16 a[0:15], v[104:107], v[56:59], a[0:15]
s_waitcnt vmcnt(12)
s_barrier
s_add_u32 s58, s51, s56
s_add_u32 s51, s51, 32768
s_cmp_eq_u32 s51, 131072
s_cselect_b32 s51, 0, s51
v_add_u32 v138, s51, v136
v_add_u32 v139, s51, v137
ds_read_b64_tr_b16 v[72:73], v138 offset:0
ds_read_b64_tr_b16 v[74:75], v138 offset:1024
v_mfma_f32_32x32x16_bf16 a[16:31], v[108:111], v[56:59], a[16:31]
ds_read_b64_tr_b16 v[76:77], v139 offset:0
ds_read_b64_tr_b16 v[78:79], v139 offset:1024
s_add_u32 m0, s52, 24576
s_nop 0
buffer_load_dwordx4 v141, s[44:47], s49 offen lds
s_add_u32 s49, s49, s54
v_mfma_f32_32x32x16_bf16 a[0:15], v[112:115], v[60:63], a[0:15]
ds_read_b64_tr_b16 v[80:81], v138 offset:2048
ds_read_b64_tr_b16 v[82:83], v138 offset:3072
buffer_load_dwordx4 v[48:51], v140, s[40:43], s48 offen offset:2048 sc1
v_mfma_f32_32x32x16_bf16 a[16:31], v[116:119], v[60:63], a[16:31]
ds_read_b64_tr_b16 v[84:85], v139 offset:2048
ds_read_b64_tr_b16 v[86:87], v139 offset:3072
buffer_load_dwordx4 v[52:55], v140, s[40:43], s48 offen offset:3072 sc1
s_add_u32 s48, s48, 4096
s_waitcnt lgkmcnt(8)
v_mfma_f32_32x32x16_bf16 a[0:15], v[120:123], v[64:67], a[0:15]
s_waitcnt vmcnt(12)
s_barrier
ds_read_b64_tr_b16 v[88:89], v138 offset:4096
ds_read_b64_tr_b16 v[90:91], v138 offset:5120
v_mfma_f32_32x32x16_bf16 a[16:31], v[124:127], v[64:67], a[16:31]
ds_read_b64_tr_b16 v[92:93], v139 offset:4096
ds_read_b64_tr_b16 v[94:95], v139 offset:5120
s_add_u32 m0, s52, 28672
s_nop 0
buffer_load_dwordx4 v141, s[44:47], s49 offen lds
s_add_u32 s49, s49, s54
v_mfma_f32_32x32x16_bf16 a[0:15], v[128:131], v[68:71], a[0:15]
ds_read_b64_tr_b16 v[96:97], v138 offset:6144
ds_read_b64_tr_b16 v[98:99], v138 offset:7168
buffer_load_dwordx4 v[56:59], v140, s[40:43], s48 offen offset:0 sc1
v_mfma_f32_32x32x16_bf16 a[16:31], v[132:135], v[68:71], a[16:31]
ds_read_b64_tr_b16 v[100:101], v139 offset:6144
ds_read_b64_tr_b16 v[102:103], v139 offset:7168
buffer_load_dwordx4 v[60:63], v140, s[40:43], s48 offen offset:1024 sc1
s_sub_u32 s50, s50, 8
s_mov_b32 s52, s58
s_cmp_gt_u32 s50, 24
s_cbranch_scc1 .LgD_354
.LgB_355:
s_waitcnt lgkmcnt(8)
v_mfma_f32_32x32x16_bf16 a[0:15], v[72:75], v[8:11], a[0:15]
s_waitcnt vmcnt(8)
s_barrier
ds_read_b64_tr_b16 v[104:105], v138 offset:8192
ds_read_b64_tr_b16 v[106:107], v138 offset:9216
v_mfma_f32_32x32x16_bf16 a[16:31], v[76:79], v[8:11], a[16:31]
ds_read_b64_tr_b16 v[108:109], v139 offset:8192
ds_read_b64_tr_b16 v[110:111], v139 offset:9216
buffer_load_dwordx4 v[64:67], v140, s[40:43], s48 offen offset:2048 sc1
v_mfma_f32_32x32x16_bf16 a[0:15], v[80:83], v[12:15], a[0:15]
ds_read_b64_tr_b16 v[112:113], v138 offset:10240
ds_read_b64_tr_b16 v[114:115], v138 offset:11264
buffer_load_dwordx4 v[68:71], v140, s[40:43], s48 offen offset:3072 sc1
s_add_u32 s48, s48, 4096
v_mfma_f32_32x32x16_bf16 a[16:31], v[84:87], v[12:15], a[16:31]
ds_read_b64_tr_b16 v[116:117], v139 offset:10240
ds_read_b64_tr_b16 v[118:119], v139 offset:11264
s_cmp_eq_u32 s50, 8
s_cselect_b32 s42, 0, s42
s_waitcnt lgkmcnt(8)
v_mfma_f32_32x32x16_bf16 a[0:15], v[88:91], v[16:19], a[0:15]
s_waitcnt vmcnt(8)
s_barrier
ds_read_b64_tr_b16 v[120:121], v138 offset:12288
ds_read_b64_tr_b16 v[122:123], v138 offset:13312
v_mfma_f32_32x32x16_bf16 a[16:31], v[92:95], v[16:19], a[16:31]
ds_read_b64_tr_b16 v[124:125], v139 offset:12288
ds_read_b64_tr_b16 v[126:127], v139 offset:13312
buffer_load_dwordx4 v[8:11], v140, s[40:43], s48 offen offset:0 sc1
v_mfma_f32_32x32x16_bf16 a[0:15], v[96:99], v[20:23], a[0:15]
ds_read_b64_tr_b16 v[128:129], v138 offset:14336
ds_read_b64_tr_b16 v[130:131], v138 offset:15360
buffer_load_dwordx4 v[12:15], v140, s[40:43], s48 offen offset:1024 sc1
v_mfma_f32_32x32x16_bf16 a[16:31], v[100:103], v[20:23], a[16:31]
ds_read_b64_tr_b16 v[132:133], v139 offset:14336
ds_read_b64_tr_b16 v[134:135], v139 offset:15360
s_waitcnt lgkmcnt(8)
v_mfma_f32_32x32x16_bf16 a[0:15], v[104:107], v[24:27], a[0:15]
s_waitcnt vmcnt(8)
s_barrier
ds_read_b64_tr_b16 v[72:73], v138 offset:16384
ds_read_b64_tr_b16 v[74:75], v138 offset:17408
v_mfma_f32_32x32x16_bf16 a[16:31], v[108:111], v[24:27], a[16:31]
ds_read_b64_tr_b16 v[76:77], v139 offset:16384
ds_read_b64_tr_b16 v[78:79], v139 offset:17408
buffer_load_dwordx4 v[16:19], v140, s[40:43], s48 offen offset:2048 sc1
v_mfma_f32_32x32x16_bf16 a[0:15], v[112:115], v[28:31], a[0:15]
ds_read_b64_tr_b16 v[80:81], v138 offset:18432
ds_read_b64_tr_b16 v[82:83], v138 offset:19456
buffer_load_dwordx4 v[20:23], v140, s[40:43], s48 offen offset:3072 sc1
s_add_u32 s48, s48, 4096
v_mfma_f32_32x32x16_bf16 a[16:31], v[116:119], v[28:31], a[16:31]
ds_read_b64_tr_b16 v[84:85], v139 offset:18432
ds_read_b64_tr_b16 v[86:87], v139 offset:19456
s_waitcnt lgkmcnt(8)
v_mfma_f32_32x32x16_bf16 a[0:15], v[120:123], v[32:35], a[0:15]
s_waitcnt vmcnt(8)
s_barrier
ds_read_b64_tr_b16 v[88:89], v138 offset:20480
ds_read_b64_tr_b16 v[90:91], v138 offset:21504
v_mfma_f32_32x32x16_bf16 a[16:31], v[124:127], v[32:35], a[16:31]
ds_read_b64_tr_b16 v[92:93], v139 offset:20480
ds_read_b64_tr_b16 v[94:95], v139 offset:21504
buffer_load_dwordx4 v[24:27], v140, s[40:43], s48 offen offset:0 sc1
v_mfma_f32_32x32x16_bf16 a[0:15], v[128:131], v[36:39], a[0:15]
ds_read_b64_tr_b16 v[96:97], v138 offset:22528
ds_read_b64_tr_b16 v[98:99], v138 offset:23552
buffer_load_dwordx4 v[28:31], v140, s[40:43], s48 offen offset:1024 sc1
v_mfma_f32_32x32x16_bf16 a[16:31], v[132:135], v[36:39], a[16:31]
ds_read_b64_tr_b16 v[100:101], v139 offset:22528
ds_read_b64_tr_b16 v[102:103], v139 offset:23552
s_waitcnt lgkmcnt(8)
v_mfma_f32_32x32x16_bf16 a[0:15], v[72:75], v[40:43], a[0:15]
s_waitcnt vmcnt(8)
s_barrier
ds_read_b64_tr_b16 v[104:105], v138 offset:24576
ds_read_b64_tr_b16 v[106:107], v138 offset:25600
v_mfma_f32_32x32x16_bf16 a[16:31], v[76:79], v[40:43], a[16:31]
ds_read_b64_tr_b16 v[108:109], v139 offset:24576
ds_read_b64_tr_b16 v[110:111], v139 offset:25600
buffer_load_dwordx4 v[32:35], v140, s[40:43], s48 offen offset:2048 sc1
v_mfma_f32_32x32x16_bf16 a[0:15], v[80:83], v[44:47], a[0:15]
ds_read_b64_tr_b16 v[112:113], v138 offset:26624
ds_read_b64_tr_b16 v[114:115], v138 offset:27648
buffer_load_dwordx4 v[36:39], v140, s[40:43], s48 offen offset:3072 sc1
s_add_u32 s48, s48, 4096
v_mfma_f32_32x32x16_bf16 a[16:31], v[84:87], v[44:47], a[16:31]
ds_read_b64_tr_b16 v[116:117], v139 offset:26624
ds_read_b64_tr_b16 v[118:119], v139 offset:27648
s_waitcnt lgkmcnt(8)
v_mfma_f32_32x32x16_bf16 a[0:15], v[88:91], v[48:51], a[0:15]
s_waitcnt vmcnt(8)
s_barrier
ds_read_b64_tr_b16 v[120:121], v138 offset:28672
ds_read_b64_tr_b16 v[122:123], v138 offset:29696
v_mfma_f32_32x32x16_bf16 a[16:31], v[92:95], v[48:51], a[16:31]
ds_read_b64_tr_b16 v[124:125], v139 offset:28672
ds_read_b64_tr_b16 v[126:127], v139 offset:29696
buffer_load_dwordx4 v[40:43], v140, s[40:43], s48 offen offset:0 sc1
v_mfma_f32_32x32x16_bf16 a[0:15], v[96:99], v[52:55], a[0:15]
ds_read_b64_tr_b16 v[128:129], v138 offset:30720
ds_read_b64_tr_b16 v[130:131], v138 offset:31744
buffer_load_dwordx4 v[44:47], v140, s[40:43], s48 offen offset:1024 sc1
v_mfma_f32_32x32x16_bf16 a[16:31], v[100:103], v[52:55], a[16:31]
ds_read_b64_tr_b16 v[132:133], v139 offset:30720
ds_read_b64_tr_b16 v[134:135], v139 offset:31744
s_waitcnt lgkmcnt(8)
v_mfma_f32_32x32x16_bf16 a[0:15], v[104:107], v[56:59], a[0:15]
s_waitcnt vmcnt(8)
s_barrier
s_add_u32 s58, s51, s56
s_add_u32 s51, s51, 32768
s_cmp_eq_u32 s51, 131072
s_cselect_b32 s51, 0, s51
v_add_u32 v138, s51, v136
v_add_u32 v139, s51, v137
ds_read_b64_tr_b16 v[72:73], v138 offset:0
ds_read_b64_tr_b16 v[74:75], v138 offset:1024
v_mfma_f32_32x32x16_bf16 a[16:31], v[108:111], v[56:59], a[16:31]
ds_read_b64_tr_b16 v[76:77], v139 offset:0
ds_read_b64_tr_b16 v[78:79], v139 offset:1024
buffer_load_dwordx4 v[48:51], v140, s[40:43], s48 offen offset:2048 sc1
v_mfma_f32_32x32x16_bf16 a[0:15], v[112:115], v[60:63], a[0:15]
ds_read_b64_tr_b16 v[80:81], v138 offset:2048
ds_read_b64_tr_b16 v[82:83], v138 offset:3072
buffer_load_dwordx4 v[52:55], v140, s[40:43], s48 offen offset:3072 sc1
s_add_u32 s48, s48, 4096
v_mfma_f32_32x32x16_bf16 a[16:31], v[116:119], v[60:63], a[16:31]
ds_read_b64_tr_b16 v[84:85], v139 offset:2048
ds_read_b64_tr_b16 v[86:87], v139 offset:3072
s_waitcnt lgkmcnt(8)
v_mfma_f32_32x32x16_bf16 a[0:15], v[120:123], v[64:67], a[0:15]
s_waitcnt vmcnt(8)
s_barrier
ds_read_b64_tr_b16 v[88:89], v138 offset:4096
ds_read_b64_tr_b16 v[90:91], v138 offset:5120
v_mfma_f32_32x32x16_bf16 a[16:31], v[124:127], v[64:67], a[16:31]
ds_read_b64_tr_b16 v[92:93], v139 offset:4096
ds_read_b64_tr_b16 v[94:95], v139 offset:5120
buffer_load_dwordx4 v[56:59], v140, s[40:43], s48 offen offset:0 sc1
v_mfma_f32_32x32x16_bf16 a[0:15], v[128:131], v[68:71], a[0:15]
ds_read_b64_tr_b16 v[96:97], v138 offset:6144
ds_read_b64_tr_b16 v[98:99], v138 offset:7168
buffer_load_dwordx4 v[60:63], v140, s[40:43], s48 offen offset:1024 sc1
v_mfma_f32_32x32x16_bf16 a[16:31], v[132:135], v[68:71], a[16:31]
ds_read_b64_tr_b16 v[100:101], v139 offset:6144
ds_read_b64_tr_b16 v[102:103], v139 offset:7168
s_sub_u32 s50, s50, 8
s_cmp_lg_u32 s50, 0
s_cbranch_scc1 .LgB_355
s_waitcnt vmcnt(0) lgkmcnt(0)
s_nop 15
s_add_u32 s57, s12, 0
v_accvgpr_read_b32 v196, a0
v_accvgpr_read_b32 v197, a1
v_accvgpr_read_b32 v198, a2
v_accvgpr_read_b32 v199, a3
v_accvgpr_read_b32 v200, a4
v_accvgpr_read_b32 v201, a5
v_accvgpr_read_b32 v202, a6
v_accvgpr_read_b32 v203, a7
v_cvt_pk_bf16_f32 v204, v196, v197
v_cvt_pk_bf16_f32 v205, v198, v199
v_cvt_pk_bf16_f32 v206, v200, v201
v_cvt_pk_bf16_f32 v207, v202, v203
v_lshlrev_b32 v196, 16, v204
v_and_b32 v197, 0xffff0000, v204
v_lshlrev_b32 v198, 16, v205
v_and_b32 v199, 0xffff0000, v205
v_lshlrev_b32 v200, 16, v206
v_and_b32 v201, 0xffff0000, v206
v_lshlrev_b32 v202, 16, v207
v_and_b32 v203, 0xffff0000, v207
v_mul_f32 v196, v196, v148
v_mul_f32 v197, v197, v149
v_mul_f32 v198, v198, v150
v_mul_f32 v199, v199, v151
v_mul_f32 v200, v200, v152
v_mul_f32 v201, v201, v153
v_mul_f32 v202, v202, v154
v_mul_f32 v203, v203, v155
v_cvt_pk_bf16_f32 v204, v196, v197
v_cvt_pk_bf16_f32 v205, v198, v199
v_cvt_pk_bf16_f32 v206, v200, v201
v_cvt_pk_bf16_f32 v207, v202, v203
v_lshlrev_b32 v196, 16, v204
v_and_b32 v197, 0xffff0000, v204
v_lshlrev_b32 v204, 16, v180
v_and_b32 v180, 0xffff0000, v180
v_lshlrev_b32 v198, 16, v205
v_and_b32 v199, 0xffff0000, v205
v_lshlrev_b32 v205, 16, v181
v_and_b32 v181, 0xffff0000, v181
v_lshlrev_b32 v200, 16, v206
v_and_b32 v201, 0xffff0000, v206
v_lshlrev_b32 v206, 16, v182
v_and_b32 v182, 0xffff0000, v182
v_lshlrev_b32 v202, 16, v207
v_and_b32 v203, 0xffff0000, v207
v_lshlrev_b32 v207, 16, v183
v_and_b32 v183, 0xffff0000, v183
v_add_f32 v196, v196, v204
v_add_f32 v197, v197, v180
v_add_f32 v198, v198, v205
v_add_f32 v199, v199, v181
v_add_f32 v200, v200, v206
v_add_f32 v201, v201, v182
v_add_f32 v202, v202, v207
v_add_f32 v203, v203, v183
v_cvt_pk_bf16_f32 v180, v196, v197
v_cvt_pk_bf16_f32 v181, v198, v199
v_cvt_pk_bf16_f32 v182, v200, v201
v_cvt_pk_bf16_f32 v183, v202, v203
buffer_store_dwordx4 v[180:183], v4, s[36:39], s57 offen offset:0 sc1
v_accvgpr_read_b32 v196, a8
v_accvgpr_read_b32 v197, a9
v_accvgpr_read_b32 v198, a10
v_accvgpr_read_b32 v199, a11
v_accvgpr_read_b32 v200, a12
v_accvgpr_read_b32 v201, a13
v_accvgpr_read_b32 v202, a14
v_accvgpr_read_b32 v203, a15
v_cvt_pk_bf16_f32 v204, v196, v197
v_cvt_pk_bf16_f32 v205, v198, v199
v_cvt_pk_bf16_f32 v206, v200, v201
v_cvt_pk_bf16_f32 v207, v202, v203
v_lshlrev_b32 v196, 16, v204
v_and_b32 v197, 0xffff0000, v204
v_lshlrev_b32 v198, 16, v205
v_and_b32 v199, 0xffff0000, v205
v_lshlrev_b32 v200, 16, v206
v_and_b32 v201, 0xffff0000, v206
v_lshlrev_b32 v202, 16, v207
v_and_b32 v203, 0xffff0000, v207
v_mul_f32 v196, v196, v156
v_mul_f32 v197, v197, v157
v_mul_f32 v198, v198, v158
v_mul_f32 v199, v199, v159
v_mul_f32 v200, v200, v160
v_mul_f32 v201, v201, v161
v_mul_f32 v202, v202, v162
v_mul_f32 v203, v203, v163
v_cvt_pk_bf16_f32 v204, v196, v197
v_cvt_pk_bf16_f32 v205, v198, v199
v_cvt_pk_bf16_f32 v206, v200, v201
v_cvt_pk_bf16_f32 v207, v202, v203
v_lshlrev_b32 v196, 16, v204
v_and_b32 v197, 0xffff0000, v204
v_lshlrev_b32 v204, 16, v184
v_and_b32 v184, 0xffff0000, v184
v_lshlrev_b32 v198, 16, v205
v_and_b32 v199, 0xffff0000, v205
v_lshlrev_b32 v205, 16, v185
v_and_b32 v185, 0xffff0000, v185
v_lshlrev_b32 v200, 16, v206
v_and_b32 v201, 0xffff0000, v206
v_lshlrev_b32 v206, 16, v186
v_and_b32 v186, 0xffff0000, v186
v_lshlrev_b32 v202, 16, v207
v_and_b32 v203, 0xffff0000, v207
v_lshlrev_b32 v207, 16, v187
v_and_b32 v187, 0xffff0000, v187
v_add_f32 v196, v196, v204
v_add_f32 v197, v197, v184
v_add_f32 v198, v198, v205
v_add_f32 v199, v199, v185
v_add_f32 v200, v200, v206
v_add_f32 v201, v201, v186
v_add_f32 v202, v202, v207
v_add_f32 v203, v203, v187
v_cvt_pk_bf16_f32 v184, v196, v197
v_cvt_pk_bf16_f32 v185, v198, v199
v_cvt_pk_bf16_f32 v186, v200, v201
v_cvt_pk_bf16_f32 v187, v202, v203
buffer_store_dwordx4 v[184:187], v4, s[36:39], s57 offen offset:1024 sc1
v_accvgpr_read_b32 v196, a16
v_accvgpr_read_b32 v197, a17
v_accvgpr_read_b32 v198, a18
v_accvgpr_read_b32 v199, a19
v_accvgpr_read_b32 v200, a20
v_accvgpr_read_b32 v201, a21
v_accvgpr_read_b32 v202, a22
v_accvgpr_read_b32 v203, a23
v_cvt_pk_bf16_f32 v204, v196, v197
v_cvt_pk_bf16_f32 v205, v198, v199
v_cvt_pk_bf16_f32 v206, v200, v201
v_cvt_pk_bf16_f32 v207, v202, v203
v_lshlrev_b32 v196, 16, v204
v_and_b32 v197, 0xffff0000, v204
v_lshlrev_b32 v198, 16, v205
v_and_b32 v199, 0xffff0000, v205
v_lshlrev_b32 v200, 16, v206
v_and_b32 v201, 0xffff0000, v206
v_lshlrev_b32 v202, 16, v207
v_and_b32 v203, 0xffff0000, v207
v_mul_f32 v196, v196, v164
v_mul_f32 v197, v197, v165
v_mul_f32 v198, v198, v166
v_mul_f32 v199, v199, v167
v_mul_f32 v200, v200, v168
v_mul_f32 v201, v201, v169
v_mul_f32 v202, v202, v170
v_mul_f32 v203, v203, v171
v_cvt_pk_bf16_f32 v204, v196, v197
v_cvt_pk_bf16_f32 v205, v198, v199
v_cvt_pk_bf16_f32 v206, v200, v201
v_cvt_pk_bf16_f32 v207, v202, v203
v_lshlrev_b32 v196, 16, v204
v_and_b32 v197, 0xffff0000, v204
v_lshlrev_b32 v204, 16, v188
v_and_b32 v188, 0xffff0000, v188
v_lshlrev_b32 v198, 16, v205
v_and_b32 v199, 0xffff0000, v205
v_lshlrev_b32 v205, 16, v189
v_and_b32 v189, 0xffff0000, v189
v_lshlrev_b32 v200, 16, v206
v_and_b32 v201, 0xffff0000, v206
v_lshlrev_b32 v206, 16, v190
v_and_b32 v190, 0xffff0000, v190
v_lshlrev_b32 v202, 16, v207
v_and_b32 v203, 0xffff0000, v207
v_lshlrev_b32 v207, 16, v191
v_and_b32 v191, 0xffff0000, v191
v_add_f32 v196, v196, v204
v_add_f32 v197, v197, v188
v_add_f32 v198, v198, v205
v_add_f32 v199, v199, v189
v_add_f32 v200, v200, v206
v_add_f32 v201, v201, v190
v_add_f32 v202, v202, v207
v_add_f32 v203, v203, v191
v_cvt_pk_bf16_f32 v188, v196, v197
v_cvt_pk_bf16_f32 v189, v198, v199
v_cvt_pk_bf16_f32 v190, v200, v201
v_cvt_pk_bf16_f32 v191, v202, v203
buffer_store_dwordx4 v[188:191], v4, s[36:39], s57 offen offset:2048 sc1
v_accvgpr_read_b32 v196, a24
v_accvgpr_read_b32 v197, a25
v_accvgpr_read_b32 v198, a26
v_accvgpr_read_b32 v199, a27
v_accvgpr_read_b32 v200, a28
v_accvgpr_read_b32 v201, a29
v_accvgpr_read_b32 v202, a30
v_accvgpr_read_b32 v203, a31
v_cvt_pk_bf16_f32 v204, v196, v197
v_cvt_pk_bf16_f32 v205, v198, v199
v_cvt_pk_bf16_f32 v206, v200, v201
v_cvt_pk_bf16_f32 v207, v202, v203
v_lshlrev_b32 v196, 16, v204
v_and_b32 v197, 0xffff0000, v204
v_lshlrev_b32 v198, 16, v205
v_and_b32 v199, 0xffff0000, v205
v_lshlrev_b32 v200, 16, v206
v_and_b32 v201, 0xffff0000, v206
v_lshlrev_b32 v202, 16, v207
v_and_b32 v203, 0xffff0000, v207
v_mul_f32 v196, v196, v172
v_mul_f32 v197, v197, v173
v_mul_f32 v198, v198, v174
v_mul_f32 v199, v199, v175
v_mul_f32 v200, v200, v176
v_mul_f32 v201, v201, v177
v_mul_f32 v202, v202, v178
v_mul_f32 v203, v203, v179
v_cvt_pk_bf16_f32 v204, v196, v197
v_cvt_pk_bf16_f32 v205, v198, v199
v_cvt_pk_bf16_f32 v206, v200, v201
v_cvt_pk_bf16_f32 v207, v202, v203
v_lshlrev_b32 v196, 16, v204
v_and_b32 v197, 0xffff0000, v204
v_lshlrev_b32 v204, 16, v192
v_and_b32 v192, 0xffff0000, v192
v_lshlrev_b32 v198, 16, v205
v_and_b32 v199, 0xffff0000, v205
v_lshlrev_b32 v205, 16, v193
v_and_b32 v193, 0xffff0000, v193
v_lshlrev_b32 v200, 16, v206
v_and_b32 v201, 0xffff0000, v206
v_lshlrev_b32 v206, 16, v194
v_and_b32 v194, 0xffff0000, v194
v_lshlrev_b32 v202, 16, v207
v_and_b32 v203, 0xffff0000, v207
v_lshlrev_b32 v207, 16, v195
v_and_b32 v195, 0xffff0000, v195
v_add_f32 v196, v196, v204
v_add_f32 v197, v197, v192
v_add_f32 v198, v198, v205
v_add_f32 v199, v199, v193
v_add_f32 v200, v200, v206
v_add_f32 v201, v201, v194
v_add_f32 v202, v202, v207
v_add_f32 v203, v203, v195
v_cvt_pk_bf16_f32 v192, v196, v197
v_cvt_pk_bf16_f32 v193, v198, v199
v_cvt_pk_bf16_f32 v194, v200, v201
v_cvt_pk_bf16_f32 v195, v202, v203
buffer_store_dwordx4 v[192:195], v4, s[36:39], s57 offen offset:3072 sc1
s_add_u32 s86, s70, 119554304
s_bfe_u32 s82, s78, 0x30000
s_mul_i32 s82, s82, 1024
s_add_u32 s86, s86, s82
s_bfe_u32 s82, s77, 0x10000
s_mul_i32 s82, s82, 128
s_add_u32 s86, s86, s82
s_waitcnt vmcnt(0)
s_barrier
s_cmp_lg_u32 s3, 0
s_cbranch_scc1 .Lsg_356
v_mov_b32 v1, 1
v_mul_u32_u24 v2, 0, v0
s_mov_b64 exec, 1
buffer_atomic_add v1, v2, s[88:91], s86 offen sc1
s_mov_b64 exec, -1
.Lsg_356:
s_add_u32 s86, s70, 119554304
s_bfe_u32 s82, s78, 0x30000
s_mul_i32 s82, s82, 1024
s_add_u32 s86, s86, s82
s_bfe_u32 s82, s77, 0x10004
s_mul_i32 s82, s82, 128
s_add_u32 s86, s86, s82
s_lshl_b32 s84, s78, 3
s_lshr_b32 s81, s77, 2
s_add_u32 s84, s84, s81
s_and_b32 s85, s77, 3
s_cmp_lg_u32 s3, 0
s_cbranch_scc1 .Lws_357
v_mul_u32_u24 v1, 0, v0
v_add_u32 v1, s86, v1
v_mov_b32 v2, 16
s_mov_b64 exec, 1
.Lwl_358:
buffer_load_dword v3, v1, s[88:91], 0 offen sc1
s_waitcnt vmcnt(0)
v_cmp_lt_u32 vcc, v3, v2
s_cbranch_vccz .Lwo_359
s_cmp_eq_u32 s80, 0
s_cbranch_scc1 .Lwo_359
s_sub_u32 s80, s80, 1
s_branch .Lwl_358
.Lwo_359:
s_mov_b64 exec, -1
.Lws_357:
s_barrier
s_add_u32 s12, s4, 0x400000
s_addc_u32 s13, s5, 0
s_mov_b32 s14, 0x400000
s_mov_b32 s15, 0x00020000
s_add_u32 s16, s4, 0xc03000
s_addc_u32 s17, s5, 0
s_mov_b32 s18, 0x2000
s_mov_b32 s19, 0x00020000
s_add_u32 s20, s4, 0x800000
s_addc_u32 s21, s5, 0
s_mov_b32 s22, 0x400000
s_mov_b32 s23, 0x00020000
v_and_b32 v2, 31, v0
v_lshrrev_b32 v3, 5, v0
v_lshlrev_b32 v4, 4, v0
s_lshl_b32 s24, s84, 16
s_lshl_b32 s25, s3, 14
s_add_u32 s24, s24, s25
s_add_u32 s25, s85, 0
s_and_b32 s25, s25, 3
s_lshl_b32 s25, s25, 12
s_add_u32 s25, s25, s24
buffer_load_dwordx4 v[32:35], v4, s[12:15], s25 offen offset:0 sc1
buffer_load_dwordx4 v[36:39], v4, s[12:15], s25 offen offset:1024 sc1
buffer_load_dwordx4 v[40:43], v4, s[12:15], s25 offen offset:2048 sc1
buffer_load_dwordx4 v[44:47], v4, s[12:15], s25 offen offset:3072 sc1
s_add_u32 s25, s85, 1
s_and_b32 s25, s25, 3
s_lshl_b32 s25, s25, 12
s_add_u32 s25, s25, s24
buffer_load_dwordx4 v[48:51], v4, s[12:15], s25 offen offset:0 sc1
buffer_load_dwordx4 v[52:55], v4, s[12:15], s25 offen offset:1024 sc1
buffer_load_dwordx4 v[56:59], v4, s[12:15], s25 offen offset:2048 sc1
buffer_load_dwordx4 v[60:63], v4, s[12:15], s25 offen offset:3072 sc1
s_add_u32 s25, s85, 2
s_and_b32 s25, s25, 3
s_lshl_b32 s25, s25, 12
s_add_u32 s25, s25, s24
buffer_load_dwordx4 v[64:67], v4, s[12:15], s25 offen offset:0 sc1
buffer_load_dwordx4 v[68:71], v4, s[12:15], s25 offen offset:1024 sc1
buffer_load_dwordx4 v[72:75], v4, s[12:15], s25 offen offset:2048 sc1
buffer_load_dwordx4 v[76:79], v4, s[12:15], s25 offen offset:3072 sc1
s_add_u32 s25, s85, 3
s_and_b32 s25, s25, 3
s_lshl_b32 s25, s25, 12
s_add_u32 s25, s25, s24
buffer_load_dwordx4 v[80:83], v4, s[12:15], s25 offen offset:0 sc1
buffer_load_dwordx4 v[84:87], v4, s[12:15], s25 offen offset:1024 sc1
buffer_load_dwordx4 v[88:91], v4, s[12:15], s25 offen offset:2048 sc1
buffer_load_dwordx4 v[92:95], v4, s[12:15], s25 offen offset:3072 sc1
s_lshl_b32 s25, s3, 10
s_lshl_b32 s26, s85, 8
s_add_u32 s25, s25, s26
v_lshlrev_b32 v5, 5, v3
s_add_u32 s26, s25, 4096
buffer_load_dwordx4 v[96:99], v5, s[16:19], s25 offen offset:0
buffer_load_dwordx4 v[128:131], v5, s[16:19], s26 offen offset:0
buffer_load_dwordx4 v[100:103], v5, s[16:19], s25 offen offset:16
buffer_load_dwordx4 v[132:135], v5, s[16:19], s26 offen offset:16
buffer_load_dwordx4 v[104:107], v5, s[16:19], s25 offen offset:64
buffer_load_dwordx4 v[136:139], v5, s[16:19], s26 offen offset:64
buffer_load_dwordx4 v[108:111], v5, s[16:19], s25 offen offset:80
buffer_load_dwordx4 v[140:143], v5, s[16:19], s26 offen offset:80
buffer_load_dwordx4 v[112:115], v5, s[16:19], s25 offen offset:128
buffer_load_dwordx4 v[144:147], v5, s[16:19], s26 offen offset:128
buffer_load_dwordx4 v[116:119], v5, s[16:19], s25 offen offset:144
buffer_load_dwordx4 v[148:151], v5, s[16:19], s26 offen offset:144
buffer_load_dwordx4 v[120:123], v5, s[16:19], s25 offen offset:192
buffer_load_dwordx4 v[152:155], v5, s[16:19], s26 offen offset:192
buffer_load_dwordx4 v[124:127], v5, s[16:19], s25 offen offset:208
buffer_load_dwordx4 v[156:159], v5, s[16:19], s26 offen offset:208
v_mov_b32 v6, 0x3f803f80
v_mov_b32 v8, 0
v_mov_b32 v9, 0
v_mov_b32 v10, 0
v_mov_b32 v11, 0
s_waitcnt vmcnt(28)
v_dot2c_f32_bf16 v8, v32, v6
v_dot2c_f32_bf16 v9, v32, v32
v_dot2c_f32_bf16 v10, v33, v6
v_dot2c_f32_bf16 v11, v33, v33
v_dot2c_f32_bf16 v8, v34, v6
v_dot2c_f32_bf16 v9, v34, v34
v_dot2c_f32_bf16 v10, v35, v6
v_dot2c_f32_bf16 v11, v35, v35
v_dot2c_f32_bf16 v8, v36, v6
v_dot2c_f32_bf16 v9, v36, v36
v_dot2c_f32_bf16 v10, v37, v6
v_dot2c_f32_bf16 v11, v37, v37
v_dot2c_f32_bf16 v8, v38, v6
v_dot2c_f32_bf16 v9, v38, v38
v_dot2c_f32_bf16 v10, v39, v6
v_dot2c_f32_bf16 v11, v39, v39
v_dot2c_f32_bf16 v8, v40, v6
v_dot2c_f32_bf16 v9, v40, v40
v_dot2c_f32_bf16 v10, v41, v6
v_dot2c_f32_bf16 v11, v41, v41
v_dot2c_f32_bf16 v8, v42, v6
v_dot2c_f32_bf16 v9, v42, v42
v_dot2c_f32_bf16 v10, v43, v6
v_dot2c_f32_bf16 v11, v43, v43
v_dot2c_f32_bf16 v8, v44, v6
v_dot2c_f32_bf16 v9, v44, v44
v_dot2c_f32_bf16 v10, v45, v6
v_dot2c_f32_bf16 v11, v45, v45
v_dot2c_f32_bf16 v8, v46, v6
v_dot2c_f32_bf16 v9, v46, v46
v_dot2c_f32_bf16 v10, v47, v6
v_dot2c_f32_bf16 v11, v47, v47
s_waitcnt vmcnt(24)
v_dot2c_f32_bf16 v8, v48, v6
v_dot2c_f32_bf16 v9, v48, v48
v_dot2c_f32_bf16 v10, v49, v6
v_dot2c_f32_bf16 v11, v49, v49
v_dot2c_f32_bf16 v8, v50, v6
v_dot2c_f32_bf16 v9, v50, v50
v_dot2c_f32_bf16 v10, v51, v6
v_dot2c_f32_bf16 v11, v51, v51
v_dot2c_f32_bf16 v8, v52, v6
v_dot2c_f32_bf16 v9, v52, v52
v_dot2c_f32_bf16 v10, v53, v6
v_dot2c_f32_bf16 v11, v53, v53
v_dot2c_f32_bf16 v8, v54, v6
v_dot2c_f32_bf16 v9, v54, v54
v_dot2c_f32_bf16 v10, v55, v6
v_dot2c_f32_bf16 v11, v55, v55
v_dot2c_f32_bf16 v8, v56, v6
v_dot2c_f32_bf16 v9, v56, v56
v_dot2c_f32_bf16 v10, v57, v6
v_dot2c_f32_bf16 v11, v57, v57
v_dot2c_f32_bf16 v8, v58, v6
v_dot2c_f32_bf16 v9, v58, v58
v_dot2c_f32_bf16 v10, v59, v6
v_dot2c_f32_bf16 v11, v59, v59
v_dot2c_f32_bf16 v8, v60, v6
v_dot2c_f32_bf16 v9, v60, v60
v_dot2c_f32_bf16 v10, v61, v6
v_dot2c_f32_bf16 v11, v61, v61
v_dot2c_f32_bf16 v8, v62, v6
v_dot2c_f32_bf16 v9, v62, v62
v_dot2c_f32_bf16 v10, v63, v6
v_dot2c_f32_bf16 v11, v63, v63
s_waitcnt vmcnt(20)
v_dot2c_f32_bf16 v8, v64, v6
v_dot2c_f32_bf16 v9, v64, v64
v_dot2c_f32_bf16 v10, v65, v6
v_dot2c_f32_bf16 v11, v65, v65
v_dot2c_f32_bf16 v8, v66, v6
v_dot2c_f32_bf16 v9, v66, v66
v_dot2c_f32_bf16 v10, v67, v6
v_dot2c_f32_bf16 v11, v67, v67
v_dot2c_f32_bf16 v8, v68, v6
v_dot2c_f32_bf16 v9, v68, v68
v_dot2c_f32_bf16 v10, v69, v6
v_dot2c_f32_bf16 v11, v69, v69
v_dot2c_f32_bf16 v8, v70, v6
v_dot2c_f32_bf16 v9, v70, v70
v_dot2c_f32_bf16 v10, v71, v6
v_dot2c_f32_bf16 v11, v71, v71
v_dot2c_f32_bf16 v8, v72, v6
v_dot2c_f32_bf16 v9, v72, v72
v_dot2c_f32_bf16 v10, v73, v6
v_dot2c_f32_bf16 v11, v73, v73
v_dot2c_f32_bf16 v8, v74, v6
v_dot2c_f32_bf16 v9, v74, v74
v_dot2c_f32_bf16 v10, v75, v6
v_dot2c_f32_bf16 v11, v75, v75
v_dot2c_f32_bf16 v8, v76, v6
v_dot2c_f32_bf16 v9, v76, v76
v_dot2c_f32_bf16 v10, v77, v6
v_dot2c_f32_bf16 v11, v77, v77
v_dot2c_f32_bf16 v8, v78, v6
v_dot2c_f32_bf16 v9, v78, v78
v_dot2c_f32_bf16 v10, v79, v6
v_dot2c_f32_bf16 v11, v79, v79
s_waitcnt vmcnt(16)
v_dot2c_f32_bf16 v8, v80, v6
v_dot2c_f32_bf16 v9, v80, v80
v_dot2c_f32_bf16 v10, v81, v6
v_dot2c_f32_bf16 v11, v81, v81
v_dot2c_f32_bf16 v8, v82, v6
v_dot2c_f32_bf16 v9, v82, v82
v_dot2c_f32_bf16 v10, v83, v6
v_dot2c_f32_bf16 v11, v83, v83
v_dot2c_f32_bf16 v8, v84, v6
v_dot2c_f32_bf16 v9, v84, v84
v_dot2c_f32_bf16 v10, v85, v6
v_dot2c_f32_bf16 v11, v85, v85
v_dot2c_f32_bf16 v8, v86, v6
v_dot2c_f32_bf16 v9, v86, v86
v_dot2c_f32_bf16 v10, v87, v6
v_dot2c_f32_bf16 v11, v87, v87
v_dot2c_f32_bf16 v8, v88, v6
v_dot2c_f32_bf16 v9, v88, v88
v_dot2c_f32_bf16 v10, v89, v6
v_dot2c_f32_bf16 v11, v89, v89
v_dot2c_f32_bf16 v8, v90, v6
v_dot2c_f32_bf16 v9, v90, v90
v_dot2c_f32_bf16 v10, v91, v6
v_dot2c_f32_bf16 v11, v91, v91
v_dot2c_f32_bf16 v8, v92, v6
v_dot2c_f32_bf16 v9, v92, v92
v_dot2c_f32_bf16 v10, v93, v6
v_dot2c_f32_bf16 v11, v93, v93
v_dot2c_f32_bf16 v8, v94, v6
v_dot2c_f32_bf16 v9, v94, v94
v_dot2c_f32_bf16 v10, v95, v6
v_dot2c_f32_bf16 v11, v95, v95
s_nop 1
v_add_f32 v8, v8, v10
v_add_f32 v9, v9, v11
v_mov_b32 v10, v8
v_mov_b32 v11, v9
s_nop 0
v_permlane32_swap_b32 v8, v10
v_permlane32_swap_b32 v9, v11
v_add_f32 v8, v8, v10
v_add_f32 v9, v9, v11
v_lshlrev_b32 v7, 3, v2
s_lshl_b32 s25, s3, 8
v_add_u32 v12, s25, v7
ds_write_b64 v12, v[8:9] offset:0
s_lshl_b32 s24, s84, 16
s_lshl_b32 s25, s3, 14
s_add_u32 s24, s24, s25
s_lshl_b32 s25, s85, 12
s_add_u32 s24, s24, s25
v_lshlrev_b32 v4, 4, v0
s_waitcnt lgkmcnt(0)
s_barrier
ds_read_b64 v[8:9], v7 offset:0
ds_read_b64 v[10:11], v7 offset:256
ds_read_b64 v[12:13], v7 offset:512
ds_read_b64 v[14:15], v7 offset:768
s_waitcnt lgkmcnt(0)
v_add_f32 v8, v8, v10
v_add_f32 v9, v9, v11
v_add_f32 v12, v12, v14
v_add_f32 v13, v13, v15
v_add_f32 v8, v8, v12
v_add_f32 v9, v9, v13
v_mul_f32 v8, 0x3a800000, v8
v_mul_f32 v9, 0x3a800000, v9
v_fma_f32 v9, -v8, v8, v9
v_max_f32 v9, 0, v9
v_cvt_pk_bf16_f32 v10, v8, v9
v_lshlrev_b32 v8, 16, v10
v_and_b32 v9, 0xffff0000, v10
v_add_f32 v9, 0x3727c5ac, v9
v_cvt_pk_bf16_f32 v9, v9, v9
v_lshlrev_b32 v9, 16, v9
v_sqrt_f32 v9, v9
s_nop 0
v_cvt_pk_bf16_f32 v9, v9, v9
v_lshlrev_b32 v9, 16, v9
v_rcp_f32 v9, v9
s_waitcnt vmcnt(0)
v_lshlrev_b32 v12, 16, v32
v_and_b32 v13, 0xffff0000, v32
v_lshlrev_b32 v14, 16, v33
v_and_b32 v15, 0xffff0000, v33
v_lshlrev_b32 v16, 16, v34
v_and_b32 v17, 0xffff0000, v34
v_lshlrev_b32 v18, 16, v35
v_and_b32 v19, 0xffff0000, v35
v_sub_f32 v12, v12, v8
v_sub_f32 v13, v13, v8
v_sub_f32 v14, v14, v8
v_sub_f32 v15, v15, v8
v_sub_f32 v16, v16, v8
v_sub_f32 v17, v17, v8
v_sub_f32 v18, v18, v8
v_sub_f32 v19, v19, v8
v_cvt_pk_bf16_f32 v20, v12, v13
v_cvt_pk_bf16_f32 v21, v14, v15
v_cvt_pk_bf16_f32 v22, v16, v17
v_cvt_pk_bf16_f32 v23, v18, v19
v_lshlrev_b32 v12, 16, v20
v_and_b32 v13, 0xffff0000, v20
v_lshlrev_b32 v14, 16, v21
v_and_b32 v15, 0xffff0000, v21
v_lshlrev_b32 v16, 16, v22
v_and_b32 v17, 0xffff0000, v22
v_lshlrev_b32 v18, 16, v23
v_and_b32 v19, 0xffff0000, v23
v_mul_f32 v12, v12, v9
v_mul_f32 v13, v13, v9
v_mul_f32 v14, v14, v9
v_mul_f32 v15, v15, v9
v_mul_f32 v16, v16, v9
v_mul_f32 v17, v17, v9
v_mul_f32 v18, v18, v9
v_mul_f32 v19, v19, v9
v_cvt_pk_bf16_f32 v20, v12, v13
v_cvt_pk_bf16_f32 v21, v14, v15
v_cvt_pk_bf16_f32 v22, v16, v17
v_cvt_pk_bf16_f32 v23, v18, v19
v_lshlrev_b32 v12, 16, v20
v_and_b32 v13, 0xffff0000, v20
v_lshlrev_b32 v14, 16, v21
v_and_b32 v15, 0xffff0000, v21
v_lshlrev_b32 v16, 16, v22
v_and_b32 v17, 0xffff0000, v22
v_lshlrev_b32 v18, 16, v23
v_and_b32 v19, 0xffff0000, v23
v_mul_f32 v12, v12, v128
v_mul_f32 v13, v13, v129
v_mul_f32 v14, v14, v130
v_mul_f32 v15, v15, v131
v_mul_f32 v16, v16, v132
v_mul_f32 v17, v17, v133
v_mul_f32 v18, v18, v134
v_mul_f32 v19, v19, v135
v_cvt_pk_bf16_f32 v20, v12, v13
v_cvt_pk_bf16_f32 v21, v14, v15
v_cvt_pk_bf16_f32 v22, v16, v17
v_cvt_pk_bf16_f32 v23, v18, v19
v_lshlrev_b32 v12, 16, v20
v_and_b32 v13, 0xffff0000, v20
v_lshlrev_b32 v14, 16, v21
v_and_b32 v15, 0xffff0000, v21
v_lshlrev_b32 v16, 16, v22
v_and_b32 v17, 0xffff0000, v22
v_lshlrev_b32 v18, 16, v23
v_and_b32 v19, 0xffff0000, v23
v_add_f32 v12, v12, v96
v_add_f32 v13, v13, v97
v_add_f32 v14, v14, v98
v_add_f32 v15, v15, v99
v_add_f32 v16, v16, v100
v_add_f32 v17, v17, v101
v_add_f32 v18, v18, v102
v_add_f32 v19, v19, v103
v_cvt_pk_bf16_f32 v32, v12, v13
v_cvt_pk_bf16_f32 v33, v14, v15
v_cvt_pk_bf16_f32 v34, v16, v17
v_cvt_pk_bf16_f32 v35, v18, v19
buffer_store_dwordx4 v[32:35], v4, s[20:23], s24 offen offset:0 sc1
v_lshlrev_b32 v12, 16, v36
v_and_b32 v13, 0xffff0000, v36
v_lshlrev_b32 v14, 16, v37
v_and_b32 v15, 0xffff0000, v37
v_lshlrev_b32 v16, 16, v38
v_and_b32 v17, 0xffff0000, v38
v_lshlrev_b32 v18, 16, v39
v_and_b32 v19, 0xffff0000, v39
v_sub_f32 v12, v12, v8
v_sub_f32 v13, v13, v8
v_sub_f32 v14, v14, v8
v_sub_f32 v15, v15, v8
v_sub_f32 v16, v16, v8
v_sub_f32 v17, v17, v8
v_sub_f32 v18, v18, v8
v_sub_f32 v19, v19, v8
v_cvt_pk_bf16_f32 v20, v12, v13
v_cvt_pk_bf16_f32 v21, v14, v15
v_cvt_pk_bf16_f32 v22, v16, v17
v_cvt_pk_bf16_f32 v23, v18, v19
v_lshlrev_b32 v12, 16, v20
v_and_b32 v13, 0xffff0000, v20
v_lshlrev_b32 v14, 16, v21
v_and_b32 v15, 0xffff0000, v21
v_lshlrev_b32 v16, 16, v22
v_and_b32 v17, 0xffff0000, v22
v_lshlrev_b32 v18, 16, v23
v_and_b32 v19, 0xffff0000, v23
v_mul_f32 v12, v12, v9
v_mul_f32 v13, v13, v9
v_mul_f32 v14, v14, v9
v_mul_f32 v15, v15, v9
v_mul_f32 v16, v16, v9
v_mul_f32 v17, v17, v9
v_mul_f32 v18, v18, v9
v_mul_f32 v19, v19, v9
v_cvt_pk_bf16_f32 v20, v12, v13
v_cvt_pk_bf16_f32 v21, v14, v15
v_cvt_pk_bf16_f32 v22, v16, v17
v_cvt_pk_bf16_f32 v23, v18, v19
v_lshlrev_b32 v12, 16, v20
v_and_b32 v13, 0xffff0000, v20
v_lshlrev_b32 v14, 16, v21
v_and_b32 v15, 0xffff0000, v21
v_lshlrev_b32 v16, 16, v22
v_and_b32 v17, 0xffff0000, v22
v_lshlrev_b32 v18, 16, v23
v_and_b32 v19, 0xffff0000, v23
v_mul_f32 v12, v12, v136
v_mul_f32 v13, v13, v137
v_mul_f32 v14, v14, v138
v_mul_f32 v15, v15, v139
v_mul_f32 v16, v16, v140
v_mul_f32 v17, v17, v141
v_mul_f32 v18, v18, v142
v_mul_f32 v19, v19, v143
v_cvt_pk_bf16_f32 v20, v12, v13
v_cvt_pk_bf16_f32 v21, v14, v15
v_cvt_pk_bf16_f32 v22, v16, v17
v_cvt_pk_bf16_f32 v23, v18, v19
v_lshlrev_b32 v12, 16, v20
v_and_b32 v13, 0xffff0000, v20
v_lshlrev_b32 v14, 16, v21
v_and_b32 v15, 0xffff0000, v21
v_lshlrev_b32 v16, 16, v22
v_and_b32 v17, 0xffff0000, v22
v_lshlrev_b32 v18, 16, v23
v_and_b32 v19, 0xffff0000, v23
v_add_f32 v12, v12, v104
v_add_f32 v13, v13, v105
v_add_f32 v14, v14, v106
v_add_f32 v15, v15, v107
v_add_f32 v16, v16, v108
v_add_f32 v17, v17, v109
v_add_f32 v18, v18, v110
v_add_f32 v19, v19, v111
v_cvt_pk_bf16_f32 v36, v12, v13
v_cvt_pk_bf16_f32 v37, v14, v15
v_cvt_pk_bf16_f32 v38, v16, v17
v_cvt_pk_bf16_f32 v39, v18, v19
buffer_store_dwordx4 v[36:39], v4, s[20:23], s24 offen offset:1024 sc1
v_lshlrev_b32 v12, 16, v40
v_and_b32 v13, 0xffff0000, v40
v_lshlrev_b32 v14, 16, v41
v_and_b32 v15, 0xffff0000, v41
v_lshlrev_b32 v16, 16, v42
v_and_b32 v17, 0xffff0000, v42
v_lshlrev_b32 v18, 16, v43
v_and_b32 v19, 0xffff0000, v43
v_sub_f32 v12, v12, v8
v_sub_f32 v13, v13, v8
v_sub_f32 v14, v14, v8
v_sub_f32 v15, v15, v8
v_sub_f32 v16, v16, v8
v_sub_f32 v17, v17, v8
v_sub_f32 v18, v18, v8
v_sub_f32 v19, v19, v8
v_cvt_pk_bf16_f32 v20, v12, v13
v_cvt_pk_bf16_f32 v21, v14, v15
v_cvt_pk_bf16_f32 v22, v16, v17
v_cvt_pk_bf16_f32 v23, v18, v19
v_lshlrev_b32 v12, 16, v20
v_and_b32 v13, 0xffff0000, v20
v_lshlrev_b32 v14, 16, v21
v_and_b32 v15, 0xffff0000, v21
v_lshlrev_b32 v16, 16, v22
v_and_b32 v17, 0xffff0000, v22
v_lshlrev_b32 v18, 16, v23
v_and_b32 v19, 0xffff0000, v23
v_mul_f32 v12, v12, v9
v_mul_f32 v13, v13, v9
v_mul_f32 v14, v14, v9
v_mul_f32 v15, v15, v9
v_mul_f32 v16, v16, v9
v_mul_f32 v17, v17, v9
v_mul_f32 v18, v18, v9
v_mul_f32 v19, v19, v9
v_cvt_pk_bf16_f32 v20, v12, v13
v_cvt_pk_bf16_f32 v21, v14, v15
v_cvt_pk_bf16_f32 v22, v16, v17
v_cvt_pk_bf16_f32 v23, v18, v19
v_lshlrev_b32 v12, 16, v20
v_and_b32 v13, 0xffff0000, v20
v_lshlrev_b32 v14, 16, v21
v_and_b32 v15, 0xffff0000, v21
v_lshlrev_b32 v16, 16, v22
v_and_b32 v17, 0xffff0000, v22
v_lshlrev_b32 v18, 16, v23
v_and_b32 v19, 0xffff0000, v23
v_mul_f32 v12, v12, v144
v_mul_f32 v13, v13, v145
v_mul_f32 v14, v14, v146
v_mul_f32 v15, v15, v147
v_mul_f32 v16, v16, v148
v_mul_f32 v17, v17, v149
v_mul_f32 v18, v18, v150
v_mul_f32 v19, v19, v151
v_cvt_pk_bf16_f32 v20, v12, v13
v_cvt_pk_bf16_f32 v21, v14, v15
v_cvt_pk_bf16_f32 v22, v16, v17
v_cvt_pk_bf16_f32 v23, v18, v19
v_lshlrev_b32 v12, 16, v20
v_and_b32 v13, 0xffff0000, v20
v_lshlrev_b32 v14, 16, v21
v_and_b32 v15, 0xffff0000, v21
v_lshlrev_b32 v16, 16, v22
v_and_b32 v17, 0xffff0000, v22
v_lshlrev_b32 v18, 16, v23
v_and_b32 v19, 0xffff0000, v23
v_add_f32 v12, v12, v112
v_add_f32 v13, v13, v113
v_add_f32 v14, v14, v114
v_add_f32 v15, v15, v115
v_add_f32 v16, v16, v116
v_add_f32 v17, v17, v117
v_add_f32 v18, v18, v118
v_add_f32 v19, v19, v119
v_cvt_pk_bf16_f32 v40, v12, v13
v_cvt_pk_bf16_f32 v41, v14, v15
v_cvt_pk_bf16_f32 v42, v16, v17
v_cvt_pk_bf16_f32 v43, v18, v19
buffer_store_dwordx4 v[40:43], v4, s[20:23], s24 offen offset:2048 sc1
v_lshlrev_b32 v12, 16, v44
v_and_b32 v13, 0xffff0000, v44
v_lshlrev_b32 v14, 16, v45
v_and_b32 v15, 0xffff0000, v45
v_lshlrev_b32 v16, 16, v46
v_and_b32 v17, 0xffff0000, v46
v_lshlrev_b32 v18, 16, v47
v_and_b32 v19, 0xffff0000, v47
v_sub_f32 v12, v12, v8
v_sub_f32 v13, v13, v8
v_sub_f32 v14, v14, v8
v_sub_f32 v15, v15, v8
v_sub_f32 v16, v16, v8
v_sub_f32 v17, v17, v8
v_sub_f32 v18, v18, v8
v_sub_f32 v19, v19, v8
v_cvt_pk_bf16_f32 v20, v12, v13
v_cvt_pk_bf16_f32 v21, v14, v15
v_cvt_pk_bf16_f32 v22, v16, v17
v_cvt_pk_bf16_f32 v23, v18, v19
v_lshlrev_b32 v12, 16, v20
v_and_b32 v13, 0xffff0000, v20
v_lshlrev_b32 v14, 16, v21
v_and_b32 v15, 0xffff0000, v21
v_lshlrev_b32 v16, 16, v22
v_and_b32 v17, 0xffff0000, v22
v_lshlrev_b32 v18, 16, v23
v_and_b32 v19, 0xffff0000, v23
v_mul_f32 v12, v12, v9
v_mul_f32 v13, v13, v9
v_mul_f32 v14, v14, v9
v_mul_f32 v15, v15, v9
v_mul_f32 v16, v16, v9
v_mul_f32 v17, v17, v9
v_mul_f32 v18, v18, v9
v_mul_f32 v19, v19, v9
v_cvt_pk_bf16_f32 v20, v12, v13
v_cvt_pk_bf16_f32 v21, v14, v15
v_cvt_pk_bf16_f32 v22, v16, v17
v_cvt_pk_bf16_f32 v23, v18, v19
v_lshlrev_b32 v12, 16, v20
v_and_b32 v13, 0xffff0000, v20
v_lshlrev_b32 v14, 16, v21
v_and_b32 v15, 0xffff0000, v21
v_lshlrev_b32 v16, 16, v22
v_and_b32 v17, 0xffff0000, v22
v_lshlrev_b32 v18, 16, v23
v_and_b32 v19, 0xffff0000, v23
v_mul_f32 v12, v12, v152
v_mul_f32 v13, v13, v153
v_mul_f32 v14, v14, v154
v_mul_f32 v15, v15, v155
v_mul_f32 v16, v16, v156
v_mul_f32 v17, v17, v157
v_mul_f32 v18, v18, v158
v_mul_f32 v19, v19, v159
v_cvt_pk_bf16_f32 v20, v12, v13
v_cvt_pk_bf16_f32 v21, v14, v15
v_cvt_pk_bf16_f32 v22, v16, v17
v_cvt_pk_bf16_f32 v23, v18, v19
v_lshlrev_b32 v12, 16, v20
v_and_b32 v13, 0xffff0000, v20
v_lshlrev_b32 v14, 16, v21
v_and_b32 v15, 0xffff0000, v21
v_lshlrev_b32 v16, 16, v22
v_and_b32 v17, 0xffff0000, v22
v_lshlrev_b32 v18, 16, v23
v_and_b32 v19, 0xffff0000, v23
v_add_f32 v12, v12, v120
v_add_f32 v13, v13, v121
v_add_f32 v14, v14, v122
v_add_f32 v15, v15, v123
v_add_f32 v16, v16, v124
v_add_f32 v17, v17, v125
v_add_f32 v18, v18, v126
v_add_f32 v19, v19, v127
v_cvt_pk_bf16_f32 v44, v12, v13
v_cvt_pk_bf16_f32 v45, v14, v15
v_cvt_pk_bf16_f32 v46, v16, v17
v_cvt_pk_bf16_f32 v47, v18, v19
buffer_store_dwordx4 v[44:47], v4, s[20:23], s24 offen offset:3072 sc1
s_add_u32 s86, s70, 119554560
s_bfe_u32 s82, s78, 0x30000
s_mul_i32 s82, s82, 1024
s_add_u32 s86, s86, s82
s_waitcnt vmcnt(0)
s_barrier
s_cmp_lg_u32 s3, 0
s_cbranch_scc1 .Lsg_360
v_mov_b32 v1, 1
v_mul_u32_u24 v2, 0, v0
s_mov_b64 exec, 1
buffer_atomic_add v1, v2, s[88:91], s86 offen sc1
s_mov_b64 exec, -1
.Lsg_360:
s_cmp_ge_u32 s77, 28
s_cbranch_scc1 .Lnf_361
s_load_dwordx2 s[6:7], s[0:1], 64
s_add_u32 s40, s4, 0x800000
s_addc_u32 s41, s5, 0
s_mov_b32 s42, 0x400000
s_mov_b32 s43, 0x00020000
v_lshrrev_b32 v207, 2, v0
v_and_b32 v207, 3, v207
v_lshrrev_b32 v208, 5, v0
v_lshlrev_b32 v208, 2, v208
v_add_u32 v208, v208, v207
v_mul_u32_u24 v208, 256, v208
v_and_b32 v209, 3, v0
v_lshlrev_b32 v209, 3, v209
v_add_u32 v208, v208, v209
v_and_b32 v209, 16, v0
v_lshlrev_b32 v209, 1, v209
v_add_u32 v208, v208, v209
s_and_b32 s53, s3, 0
s_mul_i32 s53, s53, 4
s_add_u32 s57, s53, 0
v_xor_b32 v209, s57, v207
v_lshlrev_b32 v209, 6, v209
v_add_u32 v200, v208, v209
s_add_u32 s57, s53, 1
v_xor_b32 v209, s57, v207
v_lshlrev_b32 v209, 6, v209
v_add_u32 v201, v208, v209
s_add_u32 s57, s53, 2
v_xor_b32 v209, s57, v207
v_lshlrev_b32 v209, 6, v209
v_add_u32 v202, v208, v209
s_add_u32 s57, s53, 3
v_xor_b32 v209, s57, v207
v_lshlrev_b32 v209, 6, v209
v_add_u32 v203, v208, v209
s_lshr_b32 s53, s3, 0
s_mul_i32 s53, s53, 131072
v_lshlrev_b32 v204, 4, v0
v_add_u32 v204, s53, v204
v_add_u32 v205, 65536, v204
v_lshrrev_b32 v207, 4, v0
s_mul_i32 s53, s3, 4
v_add_u32 v207, s53, v207
v_and_b32 v208, 3, v207
v_and_b32 v209, 15, v0
v_lshrrev_b32 v209, 2, v209
v_xor_b32 v208, v208, v209
v_lshlrev_b32 v208, 6, v208
v_and_b32 v209, 3, v0
v_lshlrev_b32 v209, 4, v209
v_add_u32 v208, v208, v209
s_mov_b32 s53, 7168
v_mul_lo_u32 v207, v207, s53
v_add_u32 v206, v207, v208
s_mul_i32 s54, s53, 16
s_lshl_b32 s56, s3, 10
s_waitcnt lgkmcnt(0)
s_mul_i32 s48, s78, 524288
s_mul_i32 s49, s77, 256
s_mov_b32 s50, 32
s_mov_b32 s44, s6
s_mov_b32 s45, s7
s_mov_b32 s46, 0x700000
s_mov_b32 s47, 0x00020000
s_add_u32 m0, s56, 0
s_nop 0
buffer_load_dwordx4 v206, s[44:47], s49 offen lds
s_add_u32 s49, s49, s54
s_add_u32 m0, s56, 4096
s_nop 0
buffer_load_dwordx4 v206, s[44:47], s49 offen lds
s_add_u32 s49, s49, s54
s_add_u32 m0, s56, 8192
s_nop 0
buffer_load_dwordx4 v206, s[44:47], s49 offen lds
s_add_u32 s49, s49, s54
s_add_u32 m0, s56, 12288
s_nop 0
buffer_load_dwordx4 v206, s[44:47], s49 offen lds
s_add_u32 s49, s49, s54
s_add_u32 m0, s56, 16384
s_nop 0
buffer_load_dwordx4 v206, s[44:47], s49 offen lds
s_add_u32 s49, s49, s54
s_add_u32 m0, s56, 20480
s_nop 0
buffer_load_dwordx4 v206, s[44:47], s49 offen lds
s_add_u32 s49, s49, s54
s_add_u32 m0, s56, 24576
s_nop 0
buffer_load_dwordx4 v206, s[44:47], s49 offen lds
s_add_u32 s49, s49, s54
s_add_u32 m0, s56, 28672
s_nop 0
buffer_load_dwordx4 v206, s[44:47], s49 offen lds
s_add_u32 s49, s49, s54
s_add_u32 m0, s56, 32768
s_nop 0
buffer_load_dwordx4 v206, s[44:47], s49 offen lds
s_add_u32 s49, s49, s54
s_add_u32 m0, s56, 36864
s_nop 0
buffer_load_dwordx4 v206, s[44:47], s49 offen lds
s_add_u32 s49, s49, s54
s_add_u32 m0, s56, 40960
s_nop 0
buffer_load_dwordx4 v206, s[44:47], s49 offen lds
s_add_u32 s49, s49, s54
s_add_u32 m0, s56, 45056
s_nop 0
buffer_load_dwordx4 v206, s[44:47], s49 offen lds
s_add_u32 s49, s49, s54
s_add_u32 m0, s56, 49152
s_nop 0
buffer_load_dwordx4 v206, s[44:47], s49 offen lds
s_add_u32 s49, s49, s54
s_add_u32 m0, s56, 53248
s_nop 0
buffer_load_dwordx4 v206, s[44:47], s49 offen lds
s_add_u32 s49, s49, s54
s_lshr_b32 s16, s3, 0
s_mul_i32 s16, s16, 2
s_mul_i32 s18, s78, 8
s_add_u32 s16, s16, s18
s_and_b32 s17, s3, 0
s_mul_i32 s17, s17, 8
s_mul_i32 s18, s77, 8
s_add_u32 s17, s17, s18
v_lshlrev_b32 v4, 4, v0
s_add_u32 s36, s4, 0x5000000
s_addc_u32 s37, s5, 0
s_mov_b32 s38, 0xe00000
s_mov_b32 s39, 0x00020000
s_mul_i32 s12, s16, 229376
s_lshl_b32 s18, s17, 10
s_add_u32 s12, s12, s18
s_cmp_lg_u32 s3, 0
s_cbranch_scc1 .Lws_362
v_mul_u32_u24 v1, 0, v0
v_add_u32 v1, s86, v1
v_mov_b32 v2, 32
s_mov_b64 exec, 1
.Lwl_363:
buffer_load_dword v3, v1, s[88:91], 0 offen sc1
s_waitcnt vmcnt(0)
v_cmp_lt_u32 vcc, v3, v2
s_cbranch_vccz .Lwo_364
s_cmp_eq_u32 s80, 0
s_cbranch_scc1 .Lwo_364
s_sub_u32 s80, s80, 1
s_branch .Lwl_363
.Lwo_364:
s_mov_b64 exec, -1
.Lws_362:
s_barrier
buffer_load_dwordx4 v[8:11], v204, s[40:43], s48 offen offset:0 sc1
buffer_load_dwordx4 v[12:15], v205, s[40:43], s48 offen offset:0 sc1
buffer_load_dwordx4 v[16:19], v204, s[40:43], s48 offen offset:1024 sc1
buffer_load_dwordx4 v[20:23], v205, s[40:43], s48 offen offset:1024 sc1
buffer_load_dwordx4 v[24:27], v204, s[40:43], s48 offen offset:2048 sc1
buffer_load_dwordx4 v[28:31], v205, s[40:43], s48 offen offset:2048 sc1
buffer_load_dwordx4 v[32:35], v204, s[40:43], s48 offen offset:3072 sc1
buffer_load_dwordx4 v[36:39], v205, s[40:43], s48 offen offset:3072 sc1
s_add_u32 s48, s48, 4096
buffer_load_dwordx4 v[40:43], v204, s[40:43], s48 offen offset:0 sc1
buffer_load_dwordx4 v[44:47], v205, s[40:43], s48 offen offset:0 sc1
buffer_load_dwordx4 v[48:51], v204, s[40:43], s48 offen offset:1024 sc1
buffer_load_dwordx4 v[52:55], v205, s[40:43], s48 offen offset:1024 sc1
buffer_load_dwordx4 v[56:59], v204, s[40:43], s48 offen offset:2048 sc1
buffer_load_dwordx4 v[60:63], v205, s[40:43], s48 offen offset:2048 sc1
buffer_load_dwordx4 v[64:67], v204, s[40:43], s48 offen offset:3072 sc1
buffer_load_dwordx4 v[68:71], v205, s[40:43], s48 offen offset:3072 sc1
s_add_u32 s48, s48, 4096
buffer_load_dwordx4 v[72:75], v204, s[40:43], s48 offen offset:0 sc1
buffer_load_dwordx4 v[76:79], v205, s[40:43], s48 offen offset:0 sc1
buffer_load_dwordx4 v[80:83], v204, s[40:43], s48 offen offset:1024 sc1
buffer_load_dwordx4 v[84:87], v205, s[40:43], s48 offen offset:1024 sc1
buffer_load_dwordx4 v[88:91], v204, s[40:43], s48 offen offset:2048 sc1
buffer_load_dwordx4 v[92:95], v205, s[40:43], s48 offen offset:2048 sc1
buffer_load_dwordx4 v[96:99], v204, s[40:43], s48 offen offset:3072 sc1
buffer_load_dwordx4 v[100:103], v205, s[40:43], s48 offen offset:3072 sc1
s_add_u32 s48, s48, 4096
buffer_load_dwordx4 v[104:107], v204, s[40:43], s48 offen offset:0 sc1
buffer_load_dwordx4 v[108:111], v205, s[40:43], s48 offen offset:0 sc1
buffer_load_dwordx4 v[112:115], v204, s[40:43], s48 offen offset:1024 sc1
buffer_load_dwordx4 v[116:119], v205, s[40:43], s48 offen offset:1024 sc1
v_accvgpr_write_b32 a0, 0
v_accvgpr_write_b32 a1, 0
v_accvgpr_write_b32 a2, 0
v_accvgpr_write_b32 a3, 0
v_accvgpr_write_b32 a4, 0
v_accvgpr_write_b32 a5, 0
v_accvgpr_write_b32 a6, 0
v_accvgpr_write_b32 a7, 0
v_accvgpr_write_b32 a8, 0
v_accvgpr_write_b32 a9, 0
v_accvgpr_write_b32 a10, 0
v_accvgpr_write_b32 a11, 0
v_accvgpr_write_b32 a12, 0
v_accvgpr_write_b32 a13, 0
v_accvgpr_write_b32 a14, 0
v_accvgpr_write_b32 a15, 0
v_accvgpr_write_b32 a16, 0
v_accvgpr_write_b32 a17, 0
v_accvgpr_write_b32 a18, 0
v_accvgpr_write_b32 a19, 0
v_accvgpr_write_b32 a20, 0
v_accvgpr_write_b32 a21, 0
v_accvgpr_write_b32 a22, 0
v_accvgpr_write_b32 a23, 0
v_accvgpr_write_b32 a24, 0
v_accvgpr_write_b32 a25, 0
v_accvgpr_write_b32 a26, 0
v_accvgpr_write_b32 a27, 0
v_accvgpr_write_b32 a28, 0
v_accvgpr_write_b32 a29, 0
v_accvgpr_write_b32 a30, 0
v_accvgpr_write_b32 a31, 0
v_accvgpr_write_b32 a32, 0
v_accvgpr_write_b32 a33, 0
v_accvgpr_write_b32 a34, 0
v_accvgpr_write_b32 a35, 0
v_accvgpr_write_b32 a36, 0
v_accvgpr_write_b32 a37, 0
v_accvgpr_write_b32 a38, 0
v_accvgpr_write_b32 a39, 0
v_accvgpr_write_b32 a40, 0
v_accvgpr_write_b32 a41, 0
v_accvgpr_write_b32 a42, 0
v_accvgpr_write_b32 a43, 0
v_accvgpr_write_b32 a44, 0
v_accvgpr_write_b32 a45, 0
v_accvgpr_write_b32 a46, 0
v_accvgpr_write_b32 a47, 0
v_accvgpr_write_b32 a48, 0
v_accvgpr_write_b32 a49, 0
v_accvgpr_write_b32 a50, 0
v_accvgpr_write_b32 a51, 0
v_accvgpr_write_b32 a52, 0
v_accvgpr_write_b32 a53, 0
v_accvgpr_write_b32 a54, 0
v_accvgpr_write_b32 a55, 0
v_accvgpr_write_b32 a56, 0
v_accvgpr_write_b32 a57, 0
v_accvgpr_write_b32 a58, 0
v_accvgpr_write_b32 a59, 0
v_accvgpr_write_b32 a60, 0
v_accvgpr_write_b32 a61, 0
v_accvgpr_write_b32 a62, 0
v_accvgpr_write_b32 a63, 0
v_accvgpr_write_b32 a64, 0
v_accvgpr_write_b32 a65, 0
v_accvgpr_write_b32 a66, 0
v_accvgpr_write_b32 a67, 0
v_accvgpr_write_b32 a68, 0
v_accvgpr_write_b32 a69, 0
v_accvgpr_write_b32 a70, 0
v_accvgpr_write_b32 a71, 0
v_accvgpr_write_b32 a72, 0
v_accvgpr_write_b32 a73, 0
v_accvgpr_write_b32 a74, 0
v_accvgpr_write_b32 a75, 0
v_accvgpr_write_b32 a76, 0
v_accvgpr_write_b32 a77, 0
v_accvgpr_write_b32 a78, 0
v_accvgpr_write_b32 a79, 0
v_accvgpr_write_b32 a80, 0
v_accvgpr_write_b32 a81, 0
v_accvgpr_write_b32 a82, 0
v_accvgpr_write_b32 a83, 0
v_accvgpr_write_b32 a84, 0
v_accvgpr_write_b32 a85, 0
v_accvgpr_write_b32 a86, 0
v_accvgpr_write_b32 a87, 0
v_accvgpr_write_b32 a88, 0
v_accvgpr_write_b32 a89, 0
v_accvgpr_write_b32 a90, 0
v_accvgpr_write_b32 a91, 0
v_accvgpr_write_b32 a92, 0
v_accvgpr_write_b32 a93, 0
v_accvgpr_write_b32 a94, 0
v_accvgpr_write_b32 a95, 0
v_accvgpr_write_b32 a96, 0
v_accvgpr_write_b32 a97, 0
v_accvgpr_write_b32 a98, 0
v_accvgpr_write_b32 a99, 0
v_accvgpr_write_b32 a100, 0
v_accvgpr_write_b32 a101, 0
v_accvgpr_write_b32 a102, 0
v_accvgpr_write_b32 a103, 0
v_accvgpr_write_b32 a104, 0
v_accvgpr_write_b32 a105, 0
v_accvgpr_write_b32 a106, 0
v_accvgpr_write_b32 a107, 0
v_accvgpr_write_b32 a108, 0
v_accvgpr_write_b32 a109, 0
v_accvgpr_write_b32 a110, 0
v_accvgpr_write_b32 a111, 0
v_accvgpr_write_b32 a112, 0
v_accvgpr_write_b32 a113, 0
v_accvgpr_write_b32 a114, 0
v_accvgpr_write_b32 a115, 0
v_accvgpr_write_b32 a116, 0
v_accvgpr_write_b32 a117, 0
v_accvgpr_write_b32 a118, 0
v_accvgpr_write_b32 a119, 0
v_accvgpr_write_b32 a120, 0
v_accvgpr_write_b32 a121, 0
v_accvgpr_write_b32 a122, 0
v_accvgpr_write_b32 a123, 0
v_accvgpr_write_b32 a124, 0
v_accvgpr_write_b32 a125, 0
v_accvgpr_write_b32 a126, 0
v_accvgpr_write_b32 a127, 0
s_waitcnt vmcnt(24)
s_barrier
ds_read_b64_tr_b16 v[136:137], v200 offset:0
ds_read_b64_tr_b16 v[138:139], v200 offset:2048
ds_read_b64_tr_b16 v[140:141], v201 offset:0
ds_read_b64_tr_b16 v[142:143], v201 offset:2048
ds_read_b64_tr_b16 v[144:145], v202 offset:0
ds_read_b64_tr_b16 v[146:147], v202 offset:2048
ds_read_b64_tr_b16 v[148:149], v203 offset:0
ds_read_b64_tr_b16 v[150:151], v203 offset:2048
ds_read_b64_tr_b16 v[152:153], v200 offset:4096
ds_read_b64_tr_b16 v[154:155], v200 offset:6144
ds_read_b64_tr_b16 v[156:157], v201 offset:4096
ds_read_b64_tr_b16 v[158:159], v201 offset:6144
ds_read_b64_tr_b16 v[160:161], v202 offset:4096
ds_read_b64_tr_b16 v[162:163], v202 offset:6144
ds_read_b64_tr_b16 v[164:165], v203 offset:4096
ds_read_b64_tr_b16 v[166:167], v203 offset:6144
s_waitcnt lgkmcnt(8)
v_mfma_f32_32x32x16_bf16 a[0:15], v[136:139], v[8:11], a[0:15]
s_waitcnt vmcnt(20) lgkmcnt(0)
s_barrier
ds_read_b64_tr_b16 v[168:169], v200 offset:8192
ds_read_b64_tr_b16 v[170:171], v200 offset:10240
v_mfma_f32_32x32x16_bf16 a[64:79], v[136:139], v[12:15], a[64:79]
ds_read_b64_tr_b16 v[172:173], v201 offset:8192
ds_read_b64_tr_b16 v[174:175], v201 offset:10240
s_add_u32 m0, s56, 57344
s_nop 0
buffer_load_dwordx4 v206, s[44:47], s49 offen lds
s_add_u32 s49, s49, s54
v_mfma_f32_32x32x16_bf16 a[16:31], v[140:143], v[8:11], a[16:31]
ds_read_b64_tr_b16 v[176:177], v202 offset:8192
ds_read_b64_tr_b16 v[178:179], v202 offset:10240
v_mfma_f32_32x32x16_bf16 a[80:95], v[140:143], v[12:15], a[80:95]
ds_read_b64_tr_b16 v[180:181], v203 offset:8192
ds_read_b64_tr_b16 v[182:183], v203 offset:10240
s_add_u32 m0, s56, 61440
s_nop 0
buffer_load_dwordx4 v206, s[44:47], s49 offen lds
s_add_u32 s49, s49, s54
v_mfma_f32_32x32x16_bf16 a[32:47], v[144:147], v[8:11], a[32:47]
ds_read_b64_tr_b16 v[184:185], v200 offset:12288
ds_read_b64_tr_b16 v[186:187], v200 offset:14336
v_mfma_f32_32x32x16_bf16 a[96:111], v[144:147], v[12:15], a[96:111]
ds_read_b64_tr_b16 v[188:189], v201 offset:12288
ds_read_b64_tr_b16 v[190:191], v201 offset:14336
buffer_load_dwordx4 v[120:123], v204, s[40:43], s48 offen offset:2048 sc1
v_mfma_f32_32x32x16_bf16 a[48:63], v[148:151], v[8:11], a[48:63]
ds_read_b64_tr_b16 v[192:193], v202 offset:12288
ds_read_b64_tr_b16 v[194:195], v202 offset:14336
v_mfma_f32_32x32x16_bf16 a[112:127], v[148:151], v[12:15], a[112:127]
ds_read_b64_tr_b16 v[196:197], v203 offset:12288
ds_read_b64_tr_b16 v[198:199], v203 offset:14336
buffer_load_dwordx4 v[124:127], v205, s[40:43], s48 offen offset:2048 sc1
v_mfma_f32_32x32x16_bf16 a[0:15], v[152:155], v[16:19], a[0:15]
v_mfma_f32_32x32x16_bf16 a[64:79], v[152:155], v[20:23], a[64:79]
buffer_load_dwordx4 v[128:131], v204, s[40:43], s48 offen offset:3072 sc1
v_mfma_f32_32x32x16_bf16 a[16:31], v[156:159], v[16:19], a[16:31]
v_mfma_f32_32x32x16_bf16 a[80:95], v[156:159], v[20:23], a[80:95]
buffer_load_dwordx4 v[132:135], v205, s[40:43], s48 offen offset:3072 sc1
s_add_u32 s48, s48, 4096
v_mfma_f32_32x32x16_bf16 a[32:47], v[160:163], v[16:19], a[32:47]
v_mfma_f32_32x32x16_bf16 a[96:111], v[160:163], v[20:23], a[96:111]
s_cmp_eq_u32 s50, 8
s_cselect_b32 s42, 0, s42
s_cselect_b32 s46, 0, s46
v_mfma_f32_32x32x16_bf16 a[48:63], v[164:167], v[16:19], a[48:63]
v_mfma_f32_32x32x16_bf16 a[112:127], v[164:167], v[20:23], a[112:127]
s_waitcnt lgkmcnt(8)
v_mfma_f32_32x32x16_bf16 a[0:15], v[168:171], v[24:27], a[0:15]
s_waitcnt vmcnt(22) lgkmcnt(0)
s_barrier
ds_read_b64_tr_b16 v[136:137], v200 offset:16384
ds_read_b64_tr_b16 v[138:139], v200 offset:18432
v_mfma_f32_32x32x16_bf16 a[64:79], v[168:171], v[28:31], a[64:79]
ds_read_b64_tr_b16 v[140:141], v201 offset:16384
ds_read_b64_tr_b16 v[142:143], v201 offset:18432
s_add_u32 m0, s56, 0
s_nop 0
buffer_load_dwordx4 v206, s[44:47], s49 offen lds
s_add_u32 s49, s49, s54
v_mfma_f32_32x32x16_bf16 a[16:31], v[172:175], v[24:27], a[16:31]
ds_read_b64_tr_b16 v[144:145], v202 offset:16384
ds_read_b64_tr_b16 v[146:147], v202 offset:18432
v_mfma_f32_32x32x16_bf16 a[80:95], v[172:175], v[28:31], a[80:95]
ds_read_b64_tr_b16 v[148:149], v203 offset:16384
ds_read_b64_tr_b16 v[150:151], v203 offset:18432
s_add_u32 m0, s56, 4096
s_nop 0
buffer_load_dwordx4 v206, s[44:47], s49 offen lds
s_add_u32 s49, s49, s54
v_mfma_f32_32x32x16_bf16 a[32:47], v[176:179], v[24:27], a[32:47]
ds_read_b64_tr_b16 v[152:153], v200 offset:20480
ds_read_b64_tr_b16 v[154:155], v200 offset:22528
v_mfma_f32_32x32x16_bf16 a[96:111], v[176:179], v[28:31], a[96:111]
ds_read_b64_tr_b16 v[156:157], v201 offset:20480
ds_read_b64_tr_b16 v[158:159], v201 offset:22528
v_mfma_f32_32x32x16_bf16 a[48:63], v[180:183], v[24:27], a[48:63]
ds_read_b64_tr_b16 v[160:161], v202 offset:20480
ds_read_b64_tr_b16 v[162:163], v202 offset:22528
buffer_load_dwordx4 v[8:11], v204, s[40:43], s48 offen offset:0 sc1
v_mfma_f32_32x32x16_bf16 a[112:127], v[180:183], v[28:31], a[112:127]
ds_read_b64_tr_b16 v[164:165], v203 offset:20480
ds_read_b64_tr_b16 v[166:167], v203 offset:22528
v_mfma_f32_32x32x16_bf16 a[0:15], v[184:187], v[32:35], a[0:15]
buffer_load_dwordx4 v[12:15], v205, s[40:43], s48 offen offset:0 sc1
v_mfma_f32_32x32x16_bf16 a[64:79], v[184:187], v[36:39], a[64:79]
v_mfma_f32_32x32x16_bf16 a[16:31], v[188:191], v[32:35], a[16:31]
v_mfma_f32_32x32x16_bf16 a[80:95], v[188:191], v[36:39], a[80:95]
buffer_load_dwordx4 v[16:19], v204, s[40:43], s48 offen offset:1024 sc1
v_mfma_f32_32x32x16_bf16 a[32:47], v[192:195], v[32:35], a[32:47]
v_mfma_f32_32x32x16_bf16 a[96:111], v[192:195], v[36:39], a[96:111]
buffer_load_dwordx4 v[20:23], v205, s[40:43], s48 offen offset:1024 sc1
v_mfma_f32_32x32x16_bf16 a[48:63], v[196:199], v[32:35], a[48:63]
v_mfma_f32_32x32x16_bf16 a[112:127], v[196:199], v[36:39], a[112:127]
s_waitcnt lgkmcnt(8)
v_mfma_f32_32x32x16_bf16 a[0:15], v[136:139], v[40:43], a[0:15]
s_waitcnt vmcnt(24) lgkmcnt(0)
s_barrier
ds_read_b64_tr_b16 v[168:169], v200 offset:24576
ds_read_b64_tr_b16 v[170:171], v200 offset:26624
v_mfma_f32_32x32x16_bf16 a[64:79], v[136:139], v[44:47], a[64:79]
ds_read_b64_tr_b16 v[172:173], v201 offset:24576
ds_read_b64_tr_b16 v[174:175], v201 offset:26624
s_add_u32 m0, s56, 8192
s_nop 0
buffer_load_dwordx4 v206, s[44:47], s49 offen lds
s_add_u32 s49, s49, s54
v_mfma_f32_32x32x16_bf16 a[16:31], v[140:143], v[40:43], a[16:31]
ds_read_b64_tr_b16 v[176:177], v202 offset:24576
ds_read_b64_tr_b16 v[178:179], v202 offset:26624
v_mfma_f32_32x32x16_bf16 a[80:95], v[140:143], v[44:47], a[80:95]
ds_read_b64_tr_b16 v[180:181], v203 offset:24576
ds_read_b64_tr_b16 v[182:183], v203 offset:26624
s_add_u32 m0, s56, 12288
s_nop 0
buffer_load_dwordx4 v206, s[44:47], s49 offen lds
s_add_u32 s49, s49, s54
v_mfma_f32_32x32x16_bf16 a[32:47], v[144:147], v[40:43], a[32:47]
ds_read_b64_tr_b16 v[184:185], v200 offset:28672
ds_read_b64_tr_b16 v[186:187], v200 offset:30720
v_mfma_f32_32x32x16_bf16 a[96:111], v[144:147], v[44:47], a[96:111]
ds_read_b64_tr_b16 v[188:189], v201 offset:28672
ds_read_b64_tr_b16 v[190:191], v201 offset:30720
v_mfma_f32_32x32x16_bf16 a[48:63], v[148:151], v[40:43], a[48:63]
ds_read_b64_tr_b16 v[192:193], v202 offset:28672
ds_read_b64_tr_b16 v[194:195], v202 offset:30720
buffer_load_dwordx4 v[24:27], v204, s[40:43], s48 offen offset:2048 sc1
v_mfma_f32_32x32x16_bf16 a[112:127], v[148:151], v[44:47], a[112:127]
ds_read_b64_tr_b16 v[196:197], v203 offset:28672
ds_read_b64_tr_b16 v[198:199], v203 offset:30720
v_mfma_f32_32x32x16_bf16 a[0:15], v[152:155], v[48:51], a[0:15]
buffer_load_dwordx4 v[28:31], v205, s[40:43], s48 offen offset:2048 sc1
v_mfma_f32_32x32x16_bf16 a[64:79], v[152:155], v[52:55], a[64:79]
v_mfma_f32_32x32x16_bf16 a[16:31], v[156:159], v[48:51], a[16:31]
v_mfma_f32_32x32x16_bf16 a[80:95], v[156:159], v[52:55], a[80:95]
buffer_load_dwordx4 v[32:35], v204, s[40:43], s48 offen offset:3072 sc1
v_mfma_f32_32x32x16_bf16 a[32:47], v[160:163], v[48:51], a[32:47]
v_mfma_f32_32x32x16_bf16 a[96:111], v[160:163], v[52:55], a[96:111]
buffer_load_dwordx4 v[36:39], v205, s[40:43], s48 offen offset:3072 sc1
s_add_u32 s48, s48, 4096
v_mfma_f32_32x32x16_bf16 a[48:63], v[164:167], v[48:51], a[48:63]
v_mfma_f32_32x32x16_bf16 a[112:127], v[164:167], v[52:55], a[112:127]
s_waitcnt lgkmcnt(8)
v_mfma_f32_32x32x16_bf16 a[0:15], v[168:171], v[56:59], a[0:15]
s_waitcnt vmcnt(26) lgkmcnt(0)
s_barrier
ds_read_b64_tr_b16 v[136:137], v200 offset:32768
ds_read_b64_tr_b16 v[138:139], v200 offset:34816
v_mfma_f32_32x32x16_bf16 a[64:79], v[168:171], v[60:63], a[64:79]
ds_read_b64_tr_b16 v[140:141], v201 offset:32768
ds_read_b64_tr_b16 v[142:143], v201 offset:34816
s_add_u32 m0, s56, 16384
s_nop 0
buffer_load_dwordx4 v206, s[44:47], s49 offen lds
s_add_u32 s49, s49, s54
v_mfma_f32_32x32x16_bf16 a[16:31], v[172:175], v[56:59], a[16:31]
ds_read_b64_tr_b16 v[144:145], v202 offset:32768
ds_read_b64_tr_b16 v[146:147], v202 offset:34816
v_mfma_f32_32x32x16_bf16 a[80:95], v[172:175], v[60:63], a[80:95]
ds_read_b64_tr_b16 v[148:149], v203 offset:32768
ds_read_b64_tr_b16 v[150:151], v203 offset:34816
s_add_u32 m0, s56, 20480
s_nop 0
buffer_load_dwordx4 v206, s[44:47], s49 offen lds
s_add_u32 s49, s49, s54
v_mfma_f32_32x32x16_bf16 a[32:47], v[176:179], v[56:59], a[32:47]
ds_read_b64_tr_b16 v[152:153], v200 offset:36864
ds_read_b64_tr_b16 v[154:155], v200 offset:38912
v_mfma_f32_32x32x16_bf16 a[96:111], v[176:179], v[60:63], a[96:111]
ds_read_b64_tr_b16 v[156:157], v201 offset:36864
ds_read_b64_tr_b16 v[158:159], v201 offset:38912
v_mfma_f32_32x32x16_bf16 a[48:63], v[180:183], v[56:59], a[48:63]
ds_read_b64_tr_b16 v[160:161], v202 offset:36864
ds_read_b64_tr_b16 v[162:163], v202 offset:38912
buffer_load_dwordx4 v[40:43], v204, s[40:43], s48 offen offset:0 sc1
v_mfma_f32_32x32x16_bf16 a[112:127], v[180:183], v[60:63], a[112:127]
ds_read_b64_tr_b16 v[164:165], v203 offset:36864
ds_read_b64_tr_b16 v[166:167], v203 offset:38912
v_mfma_f32_32x32x16_bf16 a[0:15], v[184:187], v[64:67], a[0:15]
buffer_load_dwordx4 v[44:47], v205, s[40:43], s48 offen offset:0 sc1
v_mfma_f32_32x32x16_bf16 a[64:79], v[184:187], v[68:71], a[64:79]
v_mfma_f32_32x32x16_bf16 a[16:31], v[188:191], v[64:67], a[16:31]
v_mfma_f32_32x32x16_bf16 a[80:95], v[188:191], v[68:71], a[80:95]
buffer_load_dwordx4 v[48:51], v204, s[40:43], s48 offen offset:1024 sc1
v_mfma_f32_32x32x16_bf16 a[32:47], v[192:195], v[64:67], a[32:47]
v_mfma_f32_32x32x16_bf16 a[96:111], v[192:195], v[68:71], a[96:111]
buffer_load_dwordx4 v[52:55], v205, s[40:43], s48 offen offset:1024 sc1
v_mfma_f32_32x32x16_bf16 a[48:63], v[196:199], v[64:67], a[48:63]
v_mfma_f32_32x32x16_bf16 a[112:127], v[196:199], v[68:71], a[112:127]
s_waitcnt lgkmcnt(8)
v_mfma_f32_32x32x16_bf16 a[0:15], v[136:139], v[72:75], a[0:15]
s_waitcnt vmcnt(28) lgkmcnt(0)
s_barrier
ds_read_b64_tr_b16 v[168:169], v200 offset:40960
ds_read_b64_tr_b16 v[170:171], v200 offset:43008
v_mfma_f32_32x32x16_bf16 a[64:79], v[136:139], v[76:79], a[64:79]
ds_read_b64_tr_b16 v[172:173], v201 offset:40960
ds_read_b64_tr_b16 v[174:175], v201 offset:43008
s_add_u32 m0, s56, 24576
s_nop 0
buffer_load_dwordx4 v206, s[44:47], s49 offen lds
s_add_u32 s49, s49, s54
v_mfma_f32_32x32x16_bf16 a[16:31], v[140:143], v[72:75], a[16:31]
ds_read_b64_tr_b16 v[176:177], v202 offset:40960
ds_read_b64_tr_b16 v[178:179], v202 offset:43008
v_mfma_f32_32x32x16_bf16 a[80:95], v[140:143], v[76:79], a[80:95]
ds_read_b64_tr_b16 v[180:181], v203 offset:40960
ds_read_b64_tr_b16 v[182:183], v203 offset:43008
s_add_u32 m0, s56, 28672
s_nop 0
buffer_load_dwordx4 v206, s[44:47], s49 offen lds
s_add_u32 s49, s49, s54
v_mfma_f32_32x32x16_bf16 a[32:47], v[144:147], v[72:75], a[32:47]
ds_read_b64_tr_b16 v[184:185], v200 offset:45056
ds_read_b64_tr_b16 v[186:187], v200 offset:47104
v_mfma_f32_32x32x16_bf16 a[96:111], v[144:147], v[76:79], a[96:111]
ds_read_b64_tr_b16 v[188:189], v201 offset:45056
ds_read_b64_tr_b16 v[190:191], v201 offset:47104
v_mfma_f32_32x32x16_bf16 a[48:63], v[148:151], v[72:75], a[48:63]
ds_read_b64_tr_b16 v[192:193], v202 offset:45056
ds_read_b64_tr_b16 v[194:195], v202 offset:47104
buffer_load_dwordx4 v[56:59], v204, s[40:43], s48 offen offset:2048 sc1
v_mfma_f32_32x32x16_bf16 a[112:127], v[148:151], v[76:79], a[112:127]
ds_read_b64_tr_b16 v[196:197], v203 offset:45056
ds_read_b64_tr_b16 v[198:199], v203 offset:47104
v_mfma_f32_32x32x16_bf16 a[0:15], v[152:155], v[80:83], a[0:15]
buffer_load_dwordx4 v[60:63], v205, s[40:43], s48 offen offset:2048 sc1
v_mfma_f32_32x32x16_bf16 a[64:79], v[152:155], v[84:87], a[64:79]
v_mfma_f32_32x32x16_bf16 a[16:31], v[156:159], v[80:83], a[16:31]
v_mfma_f32_32x32x16_bf16 a[80:95], v[156:159], v[84:87], a[80:95]
buffer_load_dwordx4 v[64:67], v204, s[40:43], s48 offen offset:3072 sc1
v_mfma_f32_32x32x16_bf16 a[32:47], v[160:163], v[80:83], a[32:47]
v_mfma_f32_32x32x16_bf16 a[96:111], v[160:163], v[84:87], a[96:111]
buffer_load_dwordx4 v[68:71], v205, s[40:43], s48 offen offset:3072 sc1
s_add_u32 s48, s48, 4096
v_mfma_f32_32x32x16_bf16 a[48:63], v[164:167], v[80:83], a[48:63]
v_mfma_f32_32x32x16_bf16 a[112:127], v[164:167], v[84:87], a[112:127]
s_waitcnt lgkmcnt(8)
v_mfma_f32_32x32x16_bf16 a[0:15], v[168:171], v[88:91], a[0:15]
s_waitcnt vmcnt(30) lgkmcnt(0)
s_barrier
ds_read_b64_tr_b16 v[136:137], v200 offset:49152
ds_read_b64_tr_b16 v[138:139], v200 offset:51200
v_mfma_f32_32x32x16_bf16 a[64:79], v[168:171], v[92:95], a[64:79]
ds_read_b64_tr_b16 v[140:141], v201 offset:49152
ds_read_b64_tr_b16 v[142:143], v201 offset:51200
s_add_u32 m0, s56, 32768
s_nop 0
buffer_load_dwordx4 v206, s[44:47], s49 offen lds
s_add_u32 s49, s49, s54
v_mfma_f32_32x32x16_bf16 a[16:31], v[172:175], v[88:91], a[16:31]
ds_read_b64_tr_b16 v[144:145], v202 offset:49152
ds_read_b64_tr_b16 v[146:147], v202 offset:51200
v_mfma_f32_32x32x16_bf16 a[80:95], v[172:175], v[92:95], a[80:95]
ds_read_b64_tr_b16 v[148:149], v203 offset:49152
ds_read_b64_tr_b16 v[150:151], v203 offset:51200
s_add_u32 m0, s56, 36864
s_nop 0
buffer_load_dwordx4 v206, s[44:47], s49 offen lds
s_add_u32 s49, s49, s54
v_mfma_f32_32x32x16_bf16 a[32:47], v[176:179], v[88:91], a[32:47]
ds_read_b64_tr_b16 v[152:153], v200 offset:53248
ds_read_b64_tr_b16 v[154:155], v200 offset:55296
v_mfma_f32_32x32x16_bf16 a[96:111], v[176:179], v[92:95], a[96:111]
ds_read_b64_tr_b16 v[156:157], v201 offset:53248
ds_read_b64_tr_b16 v[158:159], v201 offset:55296
v_mfma_f32_32x32x16_bf16 a[48:63], v[180:183], v[88:91], a[48:63]
ds_read_b64_tr_b16 v[160:161], v202 offset:53248
ds_read_b64_tr_b16 v[162:163], v202 offset:55296
buffer_load_dwordx4 v[72:75], v204, s[40:43], s48 offen offset:0 sc1
v_mfma_f32_32x32x16_bf16 a[112:127], v[180:183], v[92:95], a[112:127]
ds_read_b64_tr_b16 v[164:165], v203 offset:53248
ds_read_b64_tr_b16 v[166:167], v203 offset:55296
v_mfma_f32_32x32x16_bf16 a[0:15], v[184:187], v[96:99], a[0:15]
buffer_load_dwordx4 v[76:79], v205, s[40:43], s48 offen offset:0 sc1
v_mfma_f32_32x32x16_bf16 a[64:79], v[184:187], v[100:103], a[64:79]
v_mfma_f32_32x32x16_bf16 a[16:31], v[188:191], v[96:99], a[16:31]
v_mfma_f32_32x32x16_bf16 a[80:95], v[188:191], v[100:103], a[80:95]
buffer_load_dwordx4 v[80:83], v204, s[40:43], s48 offen offset:1024 sc1
v_mfma_f32_32x32x16_bf16 a[32:47], v[192:195], v[96:99], a[32:47]
v_mfma_f32_32x32x16_bf16 a[96:111], v[192:195], v[100:103], a[96:111]
buffer_load_dwordx4 v[84:87], v205, s[40:43], s48 offen offset:1024 sc1
v_mfma_f32_32x32x16_bf16 a[48:63], v[196:199], v[96:99], a[48:63]
v_mfma_f32_32x32x16_bf16 a[112:127], v[196:199], v[100:103], a[112:127]
s_waitcnt lgkmcnt(8)
v_mfma_f32_32x32x16_bf16 a[0:15], v[136:139], v[104:107], a[0:15]
s_waitcnt vmcnt(30) lgkmcnt(0)
s_barrier
ds_read_b64_tr_b16 v[168:169], v200 offset:57344
ds_read_b64_tr_b16 v[170:171], v200 offset:59392
v_mfma_f32_32x32x16_bf16 a[64:79], v[136:139], v[108:111], a[64:79]
ds_read_b64_tr_b16 v[172:173], v201 offset:57344
ds_read_b64_tr_b16 v[174:175], v201 offset:59392
s_add_u32 m0, s56, 40960
s_nop 0
buffer_load_dwordx4 v206, s[44:47], s49 offen lds
s_add_u32 s49, s49, s54
v_mfma_f32_32x32x16_bf16 a[16:31], v[140:143], v[104:107], a[16:31]
ds_read_b64_tr_b16 v[176:177], v202 offset:57344
ds_read_b64_tr_b16 v[178:179], v202 offset:59392
v_mfma_f32_32x32x16_bf16 a[80:95], v[140:143], v[108:111], a[80:95]
ds_read_b64_tr_b16 v[180:181], v203 offset:57344
ds_read_b64_tr_b16 v[182:183], v203 offset:59392
s_add_u32 m0, s56, 45056
s_nop 0
buffer_load_dwordx4 v206, s[44:47], s49 offen lds
s_add_u32 s49, s49, s54
v_mfma_f32_32x32x16_bf16 a[32:47], v[144:147], v[104:107], a[32:47]
ds_read_b64_tr_b16 v[184:185], v200 offset:61440
ds_read_b64_tr_b16 v[186:187], v200 offset:63488
v_mfma_f32_32x32x16_bf16 a[96:111], v[144:147], v[108:111], a[96:111]
ds_read_b64_tr_b16 v[188:189], v201 offset:61440
ds_read_b64_tr_b16 v[190:191], v201 offset:63488
v_mfma_f32_32x32x16_bf16 a[48:63], v[148:151], v[104:107], a[48:63]
ds_read_b64_tr_b16 v[192:193], v202 offset:61440
ds_read_b64_tr_b16 v[194:195], v202 offset:63488
buffer_load_dwordx4 v[88:91], v204, s[40:43], s48 offen offset:2048 sc1
v_mfma_f32_32x32x16_bf16 a[112:127], v[148:151], v[108:111], a[112:127]
ds_read_b64_tr_b16 v[196:197], v203 offset:61440
ds_read_b64_tr_b16 v[198:199], v203 offset:63488
v_mfma_f32_32x32x16_bf16 a[0:15], v[152:155], v[112:115], a[0:15]
buffer_load_dwordx4 v[92:95], v205, s[40:43], s48 offen offset:2048 sc1
v_mfma_f32_32x32x16_bf16 a[64:79], v[152:155], v[116:119], a[64:79]
v_mfma_f32_32x32x16_bf16 a[16:31], v[156:159], v[112:115], a[16:31]
v_mfma_f32_32x32x16_bf16 a[80:95], v[156:159], v[116:119], a[80:95]
buffer_load_dwordx4 v[96:99], v204, s[40:43], s48 offen offset:3072 sc1
v_mfma_f32_32x32x16_bf16 a[32:47], v[160:163], v[112:115], a[32:47]
v_mfma_f32_32x32x16_bf16 a[96:111], v[160:163], v[116:119], a[96:111]
buffer_load_dwordx4 v[100:103], v205, s[40:43], s48 offen offset:3072 sc1
s_add_u32 s48, s48, 4096
v_mfma_f32_32x32x16_bf16 a[48:63], v[164:167], v[112:115], a[48:63]
v_mfma_f32_32x32x16_bf16 a[112:127], v[164:167], v[116:119], a[112:127]
s_waitcnt lgkmcnt(8)
v_mfma_f32_32x32x16_bf16 a[0:15], v[168:171], v[120:123], a[0:15]
s_waitcnt vmcnt(30) lgkmcnt(0)
s_barrier
ds_read_b64_tr_b16 v[136:137], v200 offset:0
ds_read_b64_tr_b16 v[138:139], v200 offset:2048
v_mfma_f32_32x32x16_bf16 a[64:79], v[168:171], v[124:127], a[64:79]
ds_read_b64_tr_b16 v[140:141], v201 offset:0
ds_read_b64_tr_b16 v[142:143], v201 offset:2048
s_add_u32 m0, s56, 49152
s_nop 0
buffer_load_dwordx4 v206, s[44:47], s49 offen lds
s_add_u32 s49, s49, s54
v_mfma_f32_32x32x16_bf16 a[16:31], v[172:175], v[120:123], a[16:31]
ds_read_b64_tr_b16 v[144:145], v202 offset:0
ds_read_b64_tr_b16 v[146:147], v202 offset:2048
v_mfma_f32_32x32x16_bf16 a[80:95], v[172:175], v[124:127], a[80:95]
ds_read_b64_tr_b16 v[148:149], v203 offset:0
ds_read_b64_tr_b16 v[150:151], v203 offset:2048
s_add_u32 m0, s56, 53248
s_nop 0
buffer_load_dwordx4 v206, s[44:47], s49 offen lds
s_add_u32 s49, s49, s54
v_mfma_f32_32x32x16_bf16 a[32:47], v[176:179], v[120:123], a[32:47]
ds_read_b64_tr_b16 v[152:153], v200 offset:4096
ds_read_b64_tr_b16 v[154:155], v200 offset:6144
v_mfma_f32_32x32x16_bf16 a[96:111], v[176:179], v[124:127], a[96:111]
ds_read_b64_tr_b16 v[156:157], v201 offset:4096
ds_read_b64_tr_b16 v[158:159], v201 offset:6144
v_mfma_f32_32x32x16_bf16 a[48:63], v[180:183], v[120:123], a[48:63]
ds_read_b64_tr_b16 v[160:161], v202 offset:4096
ds_read_b64_tr_b16 v[162:163], v202 offset:6144
buffer_load_dwordx4 v[104:107], v204, s[40:43], s48 offen offset:0 sc1
v_mfma_f32_32x32x16_bf16 a[112:127], v[180:183], v[124:127], a[112:127]
ds_read_b64_tr_b16 v[164:165], v203 offset:4096
ds_read_b64_tr_b16 v[166:167], v203 offset:6144
v_mfma_f32_32x32x16_bf16 a[0:15], v[184:187], v[128:131], a[0:15]
buffer_load_dwordx4 v[108:111], v205, s[40:43], s48 offen offset:0 sc1
v_mfma_f32_32x32x16_bf16 a[64:79], v[184:187], v[132:135], a[64:79]
v_mfma_f32_32x32x16_bf16 a[16:31], v[188:191], v[128:131], a[16:31]
v_mfma_f32_32x32x16_bf16 a[80:95], v[188:191], v[132:135], a[80:95]
buffer_load_dwordx4 v[112:115], v204, s[40:43], s48 offen offset:1024 sc1
v_mfma_f32_32x32x16_bf16 a[32:47], v[192:195], v[128:131], a[32:47]
v_mfma_f32_32x32x16_bf16 a[96:111], v[192:195], v[132:135], a[96:111]
buffer_load_dwordx4 v[116:119], v205, s[40:43], s48 offen offset:1024 sc1
v_mfma_f32_32x32x16_bf16 a[48:63], v[196:199], v[128:131], a[48:63]
v_mfma_f32_32x32x16_bf16 a[112:127], v[196:199], v[132:135], a[112:127]
s_sub_u32 s50, s50, 8
.LgD_365:
s_waitcnt lgkmcnt(8)
v_mfma_f32_32x32x16_bf16 a[0:15], v[136:139], v[8:11], a[0:15]
s_waitcnt vmcnt(30) lgkmcnt(0)
s_barrier
ds_read_b64_tr_b16 v[168:169], v200 offset:8192
ds_read_b64_tr_b16 v[170:171], v200 offset:10240
v_mfma_f32_32x32x16_bf16 a[64:79], v[136:139], v[12:15], a[64:79]
ds_read_b64_tr_b16 v[172:173], v201 offset:8192
ds_read_b64_tr_b16 v[174:175], v201 offset:10240
s_add_u32 m0, s56, 57344
s_nop 0
buffer_load_dwordx4 v206, s[44:47], s49 offen lds
s_add_u32 s49, s49, s54
v_mfma_f32_32x32x16_bf16 a[16:31], v[140:143], v[8:11], a[16:31]
ds_read_b64_tr_b16 v[176:177], v202 offset:8192
ds_read_b64_tr_b16 v[178:179], v202 offset:10240
v_mfma_f32_32x32x16_bf16 a[80:95], v[140:143], v[12:15], a[80:95]
ds_read_b64_tr_b16 v[180:181], v203 offset:8192
ds_read_b64_tr_b16 v[182:183], v203 offset:10240
s_add_u32 m0, s56, 61440
s_nop 0
buffer_load_dwordx4 v206, s[44:47], s49 offen lds
s_add_u32 s49, s49, s54
v_mfma_f32_32x32x16_bf16 a[32:47], v[144:147], v[8:11], a[32:47]
ds_read_b64_tr_b16 v[184:185], v200 offset:12288
ds_read_b64_tr_b16 v[186:187], v200 offset:14336
v_mfma_f32_32x32x16_bf16 a[96:111], v[144:147], v[12:15], a[96:111]
ds_read_b64_tr_b16 v[188:189], v201 offset:12288
ds_read_b64_tr_b16 v[190:191], v201 offset:14336
buffer_load_dwordx4 v[120:123], v204, s[40:43], s48 offen offset:2048 sc1
v_mfma_f32_32x32x16_bf16 a[48:63], v[148:151], v[8:11], a[48:63]
ds_read_b64_tr_b16 v[192:193], v202 offset:12288
ds_read_b64_tr_b16 v[194:195], v202 offset:14336
v_mfma_f32_32x32x16_bf16 a[112:127], v[148:151], v[12:15], a[112:127]
ds_read_b64_tr_b16 v[196:197], v203 offset:12288
ds_read_b64_tr_b16 v[198:199], v203 offset:14336
buffer_load_dwordx4 v[124:127], v205, s[40:43], s48 offen offset:2048 sc1
v_mfma_f32_32x32x16_bf16 a[0:15], v[152:155], v[16:19], a[0:15]
v_mfma_f32_32x32x16_bf16 a[64:79], v[152:155], v[20:23], a[64:79]
buffer_load_dwordx4 v[128:131], v204, s[40:43], s48 offen offset:3072 sc1
v_mfma_f32_32x32x16_bf16 a[16:31], v[156:159], v[16:19], a[16:31]
v_mfma_f32_32x32x16_bf16 a[80:95], v[156:159], v[20:23], a[80:95]
buffer_load_dwordx4 v[132:135], v205, s[40:43], s48 offen offset:3072 sc1
s_add_u32 s48, s48, 4096
v_mfma_f32_32x32x16_bf16 a[32:47], v[160:163], v[16:19], a[32:47]
v_mfma_f32_32x32x16_bf16 a[96:111], v[160:163], v[20:23], a[96:111]
s_cmp_eq_u32 s50, 8
s_cselect_b32 s42, 0, s42
s_cselect_b32 s46, 0, s46
v_mfma_f32_32x32x16_bf16 a[48:63], v[164:167], v[16:19], a[48:63]
v_mfma_f32_32x32x16_bf16 a[112:127], v[164:167], v[20:23], a[112:127]
s_waitcnt lgkmcnt(8)
v_mfma_f32_32x32x16_bf16 a[0:15], v[168:171], v[24:27], a[0:15]
s_waitcnt vmcnt(30) lgkmcnt(0)
s_barrier
ds_read_b64_tr_b16 v[136:137], v200 offset:16384
ds_read_b64_tr_b16 v[138:139], v200 offset:18432
v_mfma_f32_32x32x16_bf16 a[64:79], v[168:171], v[28:31], a[64:79]
ds_read_b64_tr_b16 v[140:141], v201 offset:16384
ds_read_b64_tr_b16 v[142:143], v201 offset:18432
s_add_u32 m0, s56, 0
s_nop 0
buffer_load_dwordx4 v206, s[44:47], s49 offen lds
s_add_u32 s49, s49, s54
v_mfma_f32_32x32x16_bf16 a[16:31], v[172:175], v[24:27], a[16:31]
ds_read_b64_tr_b16 v[144:145], v202 offset:16384
ds_read_b64_tr_b16 v[146:147], v202 offset:18432
v_mfma_f32_32x32x16_bf16 a[80:95], v[172:175], v[28:31], a[80:95]
ds_read_b64_tr_b16 v[148:149], v203 offset:16384
ds_read_b64_tr_b16 v[150:151], v203 offset:18432
s_add_u32 m0, s56, 4096
s_nop 0
buffer_load_dwordx4 v206, s[44:47], s49 offen lds
s_add_u32 s49, s49, s54
v_mfma_f32_32x32x16_bf16 a[32:47], v[176:179], v[24:27], a[32:47]
ds_read_b64_tr_b16 v[152:153], v200 offset:20480
ds_read_b64_tr_b16 v[154:155], v200 offset:22528
v_mfma_f32_32x32x16_bf16 a[96:111], v[176:179], v[28:31], a[96:111]
ds_read_b64_tr_b16 v[156:157], v201 offset:20480
ds_read_b64_tr_b16 v[158:159], v201 offset:22528
v_mfma_f32_32x32x16_bf16 a[48:63], v[180:183], v[24:27], a[48:63]
ds_read_b64_tr_b16 v[160:161], v202 offset:20480
ds_read_b64_tr_b16 v[162:163], v202 offset:22528
buffer_load_dwordx4 v[8:11], v204, s[40:43], s48 offen offset:0 sc1
v_mfma_f32_32x32x16_bf16 a[112:127], v[180:183], v[28:31], a[112:127]
ds_read_b64_tr_b16 v[164:165], v203 offset:20480
ds_read_b64_tr_b16 v[166:167], v203 offset:22528
v_mfma_f32_32x32x16_bf16 a[0:15], v[184:187], v[32:35], a[0:15]
buffer_load_dwordx4 v[12:15], v205, s[40:43], s48 offen offset:0 sc1
v_mfma_f32_32x32x16_bf16 a[64:79], v[184:187], v[36:39], a[64:79]
v_mfma_f32_32x32x16_bf16 a[16:31], v[188:191], v[32:35], a[16:31]
v_mfma_f32_32x32x16_bf16 a[80:95], v[188:191], v[36:39], a[80:95]
buffer_load_dwordx4 v[16:19], v204, s[40:43], s48 offen offset:1024 sc1
v_mfma_f32_32x32x16_bf16 a[32:47], v[192:195], v[32:35], a[32:47]
v_mfma_f32_32x32x16_bf16 a[96:111], v[192:195], v[36:39], a[96:111]
buffer_load_dwordx4 v[20:23], v205, s[40:43], s48 offen offset:1024 sc1
v_mfma_f32_32x32x16_bf16 a[48:63], v[196:199], v[32:35], a[48:63]
v_mfma_f32_32x32x16_bf16 a[112:127], v[196:199], v[36:39], a[112:127]
s_waitcnt lgkmcnt(8)
v_mfma_f32_32x32x16_bf16 a[0:15], v[136:139], v[40:43], a[0:15]
s_waitcnt vmcnt(30) lgkmcnt(0)
s_barrier
ds_read_b64_tr_b16 v[168:169], v200 offset:24576
ds_read_b64_tr_b16 v[170:171], v200 offset:26624
v_mfma_f32_32x32x16_bf16 a[64:79], v[136:139], v[44:47], a[64:79]
ds_read_b64_tr_b16 v[172:173], v201 offset:24576
ds_read_b64_tr_b16 v[174:175], v201 offset:26624
s_add_u32 m0, s56, 8192
s_nop 0
buffer_load_dwordx4 v206, s[44:47], s49 offen lds
s_add_u32 s49, s49, s54
v_mfma_f32_32x32x16_bf16 a[16:31], v[140:143], v[40:43], a[16:31]
ds_read_b64_tr_b16 v[176:177], v202 offset:24576
ds_read_b64_tr_b16 v[178:179], v202 offset:26624
v_mfma_f32_32x32x16_bf16 a[80:95], v[140:143], v[44:47], a[80:95]
ds_read_b64_tr_b16 v[180:181], v203 offset:24576
ds_read_b64_tr_b16 v[182:183], v203 offset:26624
s_add_u32 m0, s56, 12288
s_nop 0
buffer_load_dwordx4 v206, s[44:47], s49 offen lds
s_add_u32 s49, s49, s54
v_mfma_f32_32x32x16_bf16 a[32:47], v[144:147], v[40:43], a[32:47]
ds_read_b64_tr_b16 v[184:185], v200 offset:28672
ds_read_b64_tr_b16 v[186:187], v200 offset:30720
v_mfma_f32_32x32x16_bf16 a[96:111], v[144:147], v[44:47], a[96:111]
ds_read_b64_tr_b16 v[188:189], v201 offset:28672
ds_read_b64_tr_b16 v[190:191], v201 offset:30720
v_mfma_f32_32x32x16_bf16 a[48:63], v[148:151], v[40:43], a[48:63]
ds_read_b64_tr_b16 v[192:193], v202 offset:28672
ds_read_b64_tr_b16 v[194:195], v202 offset:30720
buffer_load_dwordx4 v[24:27], v204, s[40:43], s48 offen offset:2048 sc1
v_mfma_f32_32x32x16_bf16 a[112:127], v[148:151], v[44:47], a[112:127]
ds_read_b64_tr_b16 v[196:197], v203 offset:28672
ds_read_b64_tr_b16 v[198:199], v203 offset:30720
v_mfma_f32_32x32x16_bf16 a[0:15], v[152:155], v[48:51], a[0:15]
buffer_load_dwordx4 v[28:31], v205, s[40:43], s48 offen offset:2048 sc1
v_mfma_f32_32x32x16_bf16 a[64:79], v[152:155], v[52:55], a[64:79]
v_mfma_f32_32x32x16_bf16 a[16:31], v[156:159], v[48:51], a[16:31]
v_mfma_f32_32x32x16_bf16 a[80:95], v[156:159], v[52:55], a[80:95]
buffer_load_dwordx4 v[32:35], v204, s[40:43], s48 offen offset:3072 sc1
v_mfma_f32_32x32x16_bf16 a[32:47], v[160:163], v[48:51], a[32:47]
v_mfma_f32_32x32x16_bf16 a[96:111], v[160:163], v[52:55], a[96:111]
buffer_load_dwordx4 v[36:39], v205, s[40:43], s48 offen offset:3072 sc1
s_add_u32 s48, s48, 4096
v_mfma_f32_32x32x16_bf16 a[48:63], v[164:167], v[48:51], a[48:63]
v_mfma_f32_32x32x16_bf16 a[112:127], v[164:167], v[52:55], a[112:127]
s_waitcnt lgkmcnt(8)
v_mfma_f32_32x32x16_bf16 a[0:15], v[168:171], v[56:59], a[0:15]
s_waitcnt vmcnt(30) lgkmcnt(0)
s_barrier
ds_read_b64_tr_b16 v[136:137], v200 offset:32768
ds_read_b64_tr_b16 v[138:139], v200 offset:34816
v_mfma_f32_32x32x16_bf16 a[64:79], v[168:171], v[60:63], a[64:79]
ds_read_b64_tr_b16 v[140:141], v201 offset:32768
ds_read_b64_tr_b16 v[142:143], v201 offset:34816
s_add_u32 m0, s56, 16384
s_nop 0
buffer_load_dwordx4 v206, s[44:47], s49 offen lds
s_add_u32 s49, s49, s54
v_mfma_f32_32x32x16_bf16 a[16:31], v[172:175], v[56:59], a[16:31]
ds_read_b64_tr_b16 v[144:145], v202 offset:32768
ds_read_b64_tr_b16 v[146:147], v202 offset:34816
v_mfma_f32_32x32x16_bf16 a[80:95], v[172:175], v[60:63], a[80:95]
ds_read_b64_tr_b16 v[148:149], v203 offset:32768
ds_read_b64_tr_b16 v[150:151], v203 offset:34816
s_add_u32 m0, s56, 20480
s_nop 0
buffer_load_dwordx4 v206, s[44:47], s49 offen lds
s_add_u32 s49, s49, s54
v_mfma_f32_32x32x16_bf16 a[32:47], v[176:179], v[56:59], a[32:47]
ds_read_b64_tr_b16 v[152:153], v200 offset:36864
ds_read_b64_tr_b16 v[154:155], v200 offset:38912
v_mfma_f32_32x32x16_bf16 a[96:111], v[176:179], v[60:63], a[96:111]
ds_read_b64_tr_b16 v[156:157], v201 offset:36864
ds_read_b64_tr_b16 v[158:159], v201 offset:38912
v_mfma_f32_32x32x16_bf16 a[48:63], v[180:183], v[56:59], a[48:63]
ds_read_b64_tr_b16 v[160:161], v202 offset:36864
ds_read_b64_tr_b16 v[162:163], v202 offset:38912
buffer_load_dwordx4 v[40:43], v204, s[40:43], s48 offen offset:0 sc1
v_mfma_f32_32x32x16_bf16 a[112:127], v[180:183], v[60:63], a[112:127]
ds_read_b64_tr_b16 v[164:165], v203 offset:36864
ds_read_b64_tr_b16 v[166:167], v203 offset:38912
v_mfma_f32_32x32x16_bf16 a[0:15], v[184:187], v[64:67], a[0:15]
buffer_load_dwordx4 v[44:47], v205, s[40:43], s48 offen offset:0 sc1
v_mfma_f32_32x32x16_bf16 a[64:79], v[184:187], v[68:71], a[64:79]
v_mfma_f32_32x32x16_bf16 a[16:31], v[188:191], v[64:67], a[16:31]
v_mfma_f32_32x32x16_bf16 a[80:95], v[188:191], v[68:71], a[80:95]
buffer_load_dwordx4 v[48:51], v204, s[40:43], s48 offen offset:1024 sc1
v_mfma_f32_32x32x16_bf16 a[32:47], v[192:195], v[64:67], a[32:47]
v_mfma_f32_32x32x16_bf16 a[96:111], v[192:195], v[68:71], a[96:111]
buffer_load_dwordx4 v[52:55], v205, s[40:43], s48 offen offset:1024 sc1
v_mfma_f32_32x32x16_bf16 a[48:63], v[196:199], v[64:67], a[48:63]
v_mfma_f32_32x32x16_bf16 a[112:127], v[196:199], v[68:71], a[112:127]
s_waitcnt lgkmcnt(8)
v_mfma_f32_32x32x16_bf16 a[0:15], v[136:139], v[72:75], a[0:15]
s_waitcnt vmcnt(30) lgkmcnt(0)
s_barrier
ds_read_b64_tr_b16 v[168:169], v200 offset:40960
ds_read_b64_tr_b16 v[170:171], v200 offset:43008
v_mfma_f32_32x32x16_bf16 a[64:79], v[136:139], v[76:79], a[64:79]
ds_read_b64_tr_b16 v[172:173], v201 offset:40960
ds_read_b64_tr_b16 v[174:175], v201 offset:43008
s_add_u32 m0, s56, 24576
s_nop 0
buffer_load_dwordx4 v206, s[44:47], s49 offen lds
s_add_u32 s49, s49, s54
v_mfma_f32_32x32x16_bf16 a[16:31], v[140:143], v[72:75], a[16:31]
ds_read_b64_tr_b16 v[176:177], v202 offset:40960
ds_read_b64_tr_b16 v[178:179], v202 offset:43008
v_mfma_f32_32x32x16_bf16 a[80:95], v[140:143], v[76:79], a[80:95]
ds_read_b64_tr_b16 v[180:181], v203 offset:40960
ds_read_b64_tr_b16 v[182:183], v203 offset:43008
s_add_u32 m0, s56, 28672
s_nop 0
buffer_load_dwordx4 v206, s[44:47], s49 offen lds
s_add_u32 s49, s49, s54
v_mfma_f32_32x32x16_bf16 a[32:47], v[144:147], v[72:75], a[32:47]
ds_read_b64_tr_b16 v[184:185], v200 offset:45056
ds_read_b64_tr_b16 v[186:187], v200 offset:47104
v_mfma_f32_32x32x16_bf16 a[96:111], v[144:147], v[76:79], a[96:111]
ds_read_b64_tr_b16 v[188:189], v201 offset:45056
ds_read_b64_tr_b16 v[190:191], v201 offset:47104
v_mfma_f32_32x32x16_bf16 a[48:63], v[148:151], v[72:75], a[48:63]
ds_read_b64_tr_b16 v[192:193], v202 offset:45056
ds_read_b64_tr_b16 v[194:195], v202 offset:47104
buffer_load_dwordx4 v[56:59], v204, s[40:43], s48 offen offset:2048 sc1
v_mfma_f32_32x32x16_bf16 a[112:127], v[148:151], v[76:79], a[112:127]
ds_read_b64_tr_b16 v[196:197], v203 offset:45056
ds_read_b64_tr_b16 v[198:199], v203 offset:47104
v_mfma_f32_32x32x16_bf16 a[0:15], v[152:155], v[80:83], a[0:15]
buffer_load_dwordx4 v[60:63], v205, s[40:43], s48 offen offset:2048 sc1
v_mfma_f32_32x32x16_bf16 a[64:79], v[152:155], v[84:87], a[64:79]
v_mfma_f32_32x32x16_bf16 a[16:31], v[156:159], v[80:83], a[16:31]
v_mfma_f32_32x32x16_bf16 a[80:95], v[156:159], v[84:87], a[80:95]
buffer_load_dwordx4 v[64:67], v204, s[40:43], s48 offen offset:3072 sc1
v_mfma_f32_32x32x16_bf16 a[32:47], v[160:163], v[80:83], a[32:47]
v_mfma_f32_32x32x16_bf16 a[96:111], v[160:163], v[84:87], a[96:111]
buffer_load_dwordx4 v[68:71], v205, s[40:43], s48 offen offset:3072 sc1
s_add_u32 s48, s48, 4096
v_mfma_f32_32x32x16_bf16 a[48:63], v[164:167], v[80:83], a[48:63]
v_mfma_f32_32x32x16_bf16 a[112:127], v[164:167], v[84:87], a[112:127]
s_waitcnt lgkmcnt(8)
v_mfma_f32_32x32x16_bf16 a[0:15], v[168:171], v[88:91], a[0:15]
s_waitcnt vmcnt(30) lgkmcnt(0)
s_barrier
ds_read_b64_tr_b16 v[136:137], v200 offset:49152
ds_read_b64_tr_b16 v[138:139], v200 offset:51200
v_mfma_f32_32x32x16_bf16 a[64:79], v[168:171], v[92:95], a[64:79]
ds_read_b64_tr_b16 v[140:141], v201 offset:49152
ds_read_b64_tr_b16 v[142:143], v201 offset:51200
s_add_u32 m0, s56, 32768
s_nop 0
buffer_load_dwordx4 v206, s[44:47], s49 offen lds
s_add_u32 s49, s49, s54
v_mfma_f32_32x32x16_bf16 a[16:31], v[172:175], v[88:91], a[16:31]
ds_read_b64_tr_b16 v[144:145], v202 offset:49152
ds_read_b64_tr_b16 v[146:147], v202 offset:51200
v_mfma_f32_32x32x16_bf16 a[80:95], v[172:175], v[92:95], a[80:95]
ds_read_b64_tr_b16 v[148:149], v203 offset:49152
ds_read_b64_tr_b16 v[150:151], v203 offset:51200
s_add_u32 m0, s56, 36864
s_nop 0
buffer_load_dwordx4 v206, s[44:47], s49 offen lds
s_add_u32 s49, s49, s54
v_mfma_f32_32x32x16_bf16 a[32:47], v[176:179], v[88:91], a[32:47]
ds_read_b64_tr_b16 v[152:153], v200 offset:53248
ds_read_b64_tr_b16 v[154:155], v200 offset:55296
v_mfma_f32_32x32x16_bf16 a[96:111], v[176:179], v[92:95], a[96:111]
ds_read_b64_tr_b16 v[156:157], v201 offset:53248
ds_read_b64_tr_b16 v[158:159], v201 offset:55296
v_mfma_f32_32x32x16_bf16 a[48:63], v[180:183], v[88:91], a[48:63]
ds_read_b64_tr_b16 v[160:161], v202 offset:53248
ds_read_b64_tr_b16 v[162:163], v202 offset:55296
buffer_load_dwordx4 v[72:75], v204, s[40:43], s48 offen offset:0 sc1
v_mfma_f32_32x32x16_bf16 a[112:127], v[180:183], v[92:95], a[112:127]
ds_read_b64_tr_b16 v[164:165], v203 offset:53248
ds_read_b64_tr_b16 v[166:167], v203 offset:55296
v_mfma_f32_32x32x16_bf16 a[0:15], v[184:187], v[96:99], a[0:15]
buffer_load_dwordx4 v[76:79], v205, s[40:43], s48 offen offset:0 sc1
v_mfma_f32_32x32x16_bf16 a[64:79], v[184:187], v[100:103], a[64:79]
v_mfma_f32_32x32x16_bf16 a[16:31], v[188:191], v[96:99], a[16:31]
v_mfma_f32_32x32x16_bf16 a[80:95], v[188:191], v[100:103], a[80:95]
buffer_load_dwordx4 v[80:83], v204, s[40:43], s48 offen offset:1024 sc1
v_mfma_f32_32x32x16_bf16 a[32:47], v[192:195], v[96:99], a[32:47]
v_mfma_f32_32x32x16_bf16 a[96:111], v[192:195], v[100:103], a[96:111]
buffer_load_dwordx4 v[84:87], v205, s[40:43], s48 offen offset:1024 sc1
v_mfma_f32_32x32x16_bf16 a[48:63], v[196:199], v[96:99], a[48:63]
v_mfma_f32_32x32x16_bf16 a[112:127], v[196:199], v[100:103], a[112:127]
s_waitcnt lgkmcnt(8)
v_mfma_f32_32x32x16_bf16 a[0:15], v[136:139], v[104:107], a[0:15]
s_waitcnt vmcnt(30) lgkmcnt(0)
s_barrier
ds_read_b64_tr_b16 v[168:169], v200 offset:57344
ds_read_b64_tr_b16 v[170:171], v200 offset:59392
v_mfma_f32_32x32x16_bf16 a[64:79], v[136:139], v[108:111], a[64:79]
ds_read_b64_tr_b16 v[172:173], v201 offset:57344
ds_read_b64_tr_b16 v[174:175], v201 offset:59392
s_add_u32 m0, s56, 40960
s_nop 0
buffer_load_dwordx4 v206, s[44:47], s49 offen lds
s_add_u32 s49, s49, s54
v_mfma_f32_32x32x16_bf16 a[16:31], v[140:143], v[104:107], a[16:31]
ds_read_b64_tr_b16 v[176:177], v202 offset:57344
ds_read_b64_tr_b16 v[178:179], v202 offset:59392
v_mfma_f32_32x32x16_bf16 a[80:95], v[140:143], v[108:111], a[80:95]
ds_read_b64_tr_b16 v[180:181], v203 offset:57344
ds_read_b64_tr_b16 v[182:183], v203 offset:59392
s_add_u32 m0, s56, 45056
s_nop 0
buffer_load_dwordx4 v206, s[44:47], s49 offen lds
s_add_u32 s49, s49, s54
v_mfma_f32_32x32x16_bf16 a[32:47], v[144:147], v[104:107], a[32:47]
ds_read_b64_tr_b16 v[184:185], v200 offset:61440
ds_read_b64_tr_b16 v[186:187], v200 offset:63488
v_mfma_f32_32x32x16_bf16 a[96:111], v[144:147], v[108:111], a[96:111]
ds_read_b64_tr_b16 v[188:189], v201 offset:61440
ds_read_b64_tr_b16 v[190:191], v201 offset:63488
v_mfma_f32_32x32x16_bf16 a[48:63], v[148:151], v[104:107], a[48:63]
ds_read_b64_tr_b16 v[192:193], v202 offset:61440
ds_read_b64_tr_b16 v[194:195], v202 offset:63488
buffer_load_dwordx4 v[88:91], v204, s[40:43], s48 offen offset:2048 sc1
v_mfma_f32_32x32x16_bf16 a[112:127], v[148:151], v[108:111], a[112:127]
ds_read_b64_tr_b16 v[196:197], v203 offset:61440
ds_read_b64_tr_b16 v[198:199], v203 offset:63488
v_mfma_f32_32x32x16_bf16 a[0:15], v[152:155], v[112:115], a[0:15]
buffer_load_dwordx4 v[92:95], v205, s[40:43], s48 offen offset:2048 sc1
v_mfma_f32_32x32x16_bf16 a[64:79], v[152:155], v[116:119], a[64:79]
v_mfma_f32_32x32x16_bf16 a[16:31], v[156:159], v[112:115], a[16:31]
v_mfma_f32_32x32x16_bf16 a[80:95], v[156:159], v[116:119], a[80:95]
buffer_load_dwordx4 v[96:99], v204, s[40:43], s48 offen offset:3072 sc1
v_mfma_f32_32x32x16_bf16 a[32:47], v[160:163], v[112:115], a[32:47]
v_mfma_f32_32x32x16_bf16 a[96:111], v[160:163], v[116:119], a[96:111]
buffer_load_dwordx4 v[100:103], v205, s[40:43], s48 offen offset:3072 sc1
s_add_u32 s48, s48, 4096
v_mfma_f32_32x32x16_bf16 a[48:63], v[164:167], v[112:115], a[48:63]
v_mfma_f32_32x32x16_bf16 a[112:127], v[164:167], v[116:119], a[112:127]
s_waitcnt lgkmcnt(8)
v_mfma_f32_32x32x16_bf16 a[0:15], v[168:171], v[120:123], a[0:15]
s_waitcnt vmcnt(30) lgkmcnt(0)
s_barrier
ds_read_b64_tr_b16 v[136:137], v200 offset:0
ds_read_b64_tr_b16 v[138:139], v200 offset:2048
v_mfma_f32_32x32x16_bf16 a[64:79], v[168:171], v[124:127], a[64:79]
ds_read_b64_tr_b16 v[140:141], v201 offset:0
ds_read_b64_tr_b16 v[142:143], v201 offset:2048
s_add_u32 m0, s56, 49152
s_nop 0
buffer_load_dwordx4 v206, s[44:47], s49 offen lds
s_add_u32 s49, s49, s54
v_mfma_f32_32x32x16_bf16 a[16:31], v[172:175], v[120:123], a[16:31]
ds_read_b64_tr_b16 v[144:145], v202 offset:0
ds_read_b64_tr_b16 v[146:147], v202 offset:2048
v_mfma_f32_32x32x16_bf16 a[80:95], v[172:175], v[124:127], a[80:95]
ds_read_b64_tr_b16 v[148:149], v203 offset:0
ds_read_b64_tr_b16 v[150:151], v203 offset:2048
s_add_u32 m0, s56, 53248
s_nop 0
buffer_load_dwordx4 v206, s[44:47], s49 offen lds
s_add_u32 s49, s49, s54
v_mfma_f32_32x32x16_bf16 a[32:47], v[176:179], v[120:123], a[32:47]
ds_read_b64_tr_b16 v[152:153], v200 offset:4096
ds_read_b64_tr_b16 v[154:155], v200 offset:6144
v_mfma_f32_32x32x16_bf16 a[96:111], v[176:179], v[124:127], a[96:111]
ds_read_b64_tr_b16 v[156:157], v201 offset:4096
ds_read_b64_tr_b16 v[158:159], v201 offset:6144
v_mfma_f32_32x32x16_bf16 a[48:63], v[180:183], v[120:123], a[48:63]
ds_read_b64_tr_b16 v[160:161], v202 offset:4096
ds_read_b64_tr_b16 v[162:163], v202 offset:6144
buffer_load_dwordx4 v[104:107], v204, s[40:43], s48 offen offset:0 sc1
v_mfma_f32_32x32x16_bf16 a[112:127], v[180:183], v[124:127], a[112:127]
ds_read_b64_tr_b16 v[164:165], v203 offset:4096
ds_read_b64_tr_b16 v[166:167], v203 offset:6144
v_mfma_f32_32x32x16_bf16 a[0:15], v[184:187], v[128:131], a[0:15]
buffer_load_dwordx4 v[108:111], v205, s[40:43], s48 offen offset:0 sc1
v_mfma_f32_32x32x16_bf16 a[64:79], v[184:187], v[132:135], a[64:79]
v_mfma_f32_32x32x16_bf16 a[16:31], v[188:191], v[128:131], a[16:31]
v_mfma_f32_32x32x16_bf16 a[80:95], v[188:191], v[132:135], a[80:95]
buffer_load_dwordx4 v[112:115], v204, s[40:43], s48 offen offset:1024 sc1
v_mfma_f32_32x32x16_bf16 a[32:47], v[192:195], v[128:131], a[32:47]
v_mfma_f32_32x32x16_bf16 a[96:111], v[192:195], v[132:135], a[96:111]
buffer_load_dwordx4 v[116:119], v205, s[40:43], s48 offen offset:1024 sc1
v_mfma_f32_32x32x16_bf16 a[48:63], v[196:199], v[128:131], a[48:63]
v_mfma_f32_32x32x16_bf16 a[112:127], v[196:199], v[132:135], a[112:127]
s_sub_u32 s50, s50, 8
s_cmp_gt_u32 s50, 0
s_cbranch_scc1 .LgD_365
s_waitcnt vmcnt(0) lgkmcnt(0)
s_nop 15
s_add_u32 s57, s12, 0
v_accvgpr_read_b32 v8, a0
v_accvgpr_read_b32 v9, a1
v_accvgpr_read_b32 v10, a2
v_accvgpr_read_b32 v11, a3
v_accvgpr_read_b32 v12, a4
v_accvgpr_read_b32 v13, a5
v_accvgpr_read_b32 v14, a6
v_accvgpr_read_b32 v15, a7
v_max_f32 v8, 0, v8
v_max_f32 v9, 0, v9
v_max_f32 v10, 0, v10
v_max_f32 v11, 0, v11
v_max_f32 v12, 0, v12
v_max_f32 v13, 0, v13
v_max_f32 v14, 0, v14
v_max_f32 v15, 0, v15
v_cvt_pk_bf16_f32 v16, v8, v9
v_cvt_pk_bf16_f32 v17, v10, v11
v_cvt_pk_bf16_f32 v18, v12, v13
v_cvt_pk_bf16_f32 v19, v14, v15
buffer_store_dwordx4 v[16:19], v4, s[36:39], s57 offen offset:0 sc1
v_accvgpr_read_b32 v20, a8
v_accvgpr_read_b32 v21, a9
v_accvgpr_read_b32 v22, a10
v_accvgpr_read_b32 v23, a11
v_accvgpr_read_b32 v24, a12
v_accvgpr_read_b32 v25, a13
v_accvgpr_read_b32 v26, a14
v_accvgpr_read_b32 v27, a15
v_max_f32 v20, 0, v20
v_max_f32 v21, 0, v21
v_max_f32 v22, 0, v22
v_max_f32 v23, 0, v23
v_max_f32 v24, 0, v24
v_max_f32 v25, 0, v25
v_max_f32 v26, 0, v26
v_max_f32 v27, 0, v27
v_cvt_pk_bf16_f32 v28, v20, v21
v_cvt_pk_bf16_f32 v29, v22, v23
v_cvt_pk_bf16_f32 v30, v24, v25
v_cvt_pk_bf16_f32 v31, v26, v27
buffer_store_dwordx4 v[28:31], v4, s[36:39], s57 offen offset:1024 sc1
v_accvgpr_read_b32 v8, a16
v_accvgpr_read_b32 v9, a17
v_accvgpr_read_b32 v10, a18
v_accvgpr_read_b32 v11, a19
v_accvgpr_read_b32 v12, a20
v_accvgpr_read_b32 v13, a21
v_accvgpr_read_b32 v14, a22
v_accvgpr_read_b32 v15, a23
v_max_f32 v8, 0, v8
v_max_f32 v9, 0, v9
v_max_f32 v10, 0, v10
v_max_f32 v11, 0, v11
v_max_f32 v12, 0, v12
v_max_f32 v13, 0, v13
v_max_f32 v14, 0, v14
v_max_f32 v15, 0, v15
v_cvt_pk_bf16_f32 v16, v8, v9
v_cvt_pk_bf16_f32 v17, v10, v11
v_cvt_pk_bf16_f32 v18, v12, v13
v_cvt_pk_bf16_f32 v19, v14, v15
buffer_store_dwordx4 v[16:19], v4, s[36:39], s57 offen offset:2048 sc1
v_accvgpr_read_b32 v20, a24
v_accvgpr_read_b32 v21, a25
v_accvgpr_read_b32 v22, a26
v_accvgpr_read_b32 v23, a27
v_accvgpr_read_b32 v24, a28
v_accvgpr_read_b32 v25, a29
v_accvgpr_read_b32 v26, a30
v_accvgpr_read_b32 v27, a31
v_max_f32 v20, 0, v20
v_max_f32 v21, 0, v21
v_max_f32 v22, 0, v22
v_max_f32 v23, 0, v23
v_max_f32 v24, 0, v24
v_max_f32 v25, 0, v25
v_max_f32 v26, 0, v26
v_max_f32 v27, 0, v27
v_cvt_pk_bf16_f32 v28, v20, v21
v_cvt_pk_bf16_f32 v29, v22, v23
v_cvt_pk_bf16_f32 v30, v24, v25
v_cvt_pk_bf16_f32 v31, v26, v27
buffer_store_dwordx4 v[28:31], v4, s[36:39], s57 offen offset:3072 sc1
v_accvgpr_read_b32 v8, a32
v_accvgpr_read_b32 v9, a33
v_accvgpr_read_b32 v10, a34
v_accvgpr_read_b32 v11, a35
v_accvgpr_read_b32 v12, a36
v_accvgpr_read_b32 v13, a37
v_accvgpr_read_b32 v14, a38
v_accvgpr_read_b32 v15, a39
v_max_f32 v8, 0, v8
v_max_f32 v9, 0, v9
v_max_f32 v10, 0, v10
v_max_f32 v11, 0, v11
v_max_f32 v12, 0, v12
v_max_f32 v13, 0, v13
v_max_f32 v14, 0, v14
v_max_f32 v15, 0, v15
v_cvt_pk_bf16_f32 v16, v8, v9
v_cvt_pk_bf16_f32 v17, v10, v11
v_cvt_pk_bf16_f32 v18, v12, v13
v_cvt_pk_bf16_f32 v19, v14, v15
s_add_u32 s57, s57, 4096
buffer_store_dwordx4 v[16:19], v4, s[36:39], s57 offen offset:0 sc1
v_accvgpr_read_b32 v20, a40
v_accvgpr_read_b32 v21, a41
v_accvgpr_read_b32 v22, a42
v_accvgpr_read_b32 v23, a43
v_accvgpr_read_b32 v24, a44
v_accvgpr_read_b32 v25, a45
v_accvgpr_read_b32 v26, a46
v_accvgpr_read_b32 v27, a47
v_max_f32 v20, 0, v20
v_max_f32 v21, 0, v21
v_max_f32 v22, 0, v22
v_max_f32 v23, 0, v23
v_max_f32 v24, 0, v24
v_max_f32 v25, 0, v25
v_max_f32 v26, 0, v26
v_max_f32 v27, 0, v27
v_cvt_pk_bf16_f32 v28, v20, v21
v_cvt_pk_bf16_f32 v29, v22, v23
v_cvt_pk_bf16_f32 v30, v24, v25
v_cvt_pk_bf16_f32 v31, v26, v27
buffer_store_dwordx4 v[28:31], v4, s[36:39], s57 offen offset:1024 sc1
v_accvgpr_read_b32 v8, a48
v_accvgpr_read_b32 v9, a49
v_accvgpr_read_b32 v10, a50
v_accvgpr_read_b32 v11, a51
v_accvgpr_read_b32 v12, a52
v_accvgpr_read_b32 v13, a53
v_accvgpr_read_b32 v14, a54
v_accvgpr_read_b32 v15, a55
v_max_f32 v8, 0, v8
v_max_f32 v9, 0, v9
v_max_f32 v10, 0, v10
v_max_f32 v11, 0, v11
v_max_f32 v12, 0, v12
v_max_f32 v13, 0, v13
v_max_f32 v14, 0, v14
v_max_f32 v15, 0, v15
v_cvt_pk_bf16_f32 v16, v8, v9
v_cvt_pk_bf16_f32 v17, v10, v11
v_cvt_pk_bf16_f32 v18, v12, v13
v_cvt_pk_bf16_f32 v19, v14, v15
buffer_store_dwordx4 v[16:19], v4, s[36:39], s57 offen offset:2048 sc1
v_accvgpr_read_b32 v20, a56
v_accvgpr_read_b32 v21, a57
v_accvgpr_read_b32 v22, a58
v_accvgpr_read_b32 v23, a59
v_accvgpr_read_b32 v24, a60
v_accvgpr_read_b32 v25, a61
v_accvgpr_read_b32 v26, a62
v_accvgpr_read_b32 v27, a63
v_max_f32 v20, 0, v20
v_max_f32 v21, 0, v21
v_max_f32 v22, 0, v22
v_max_f32 v23, 0, v23
v_max_f32 v24, 0, v24
v_max_f32 v25, 0, v25
v_max_f32 v26, 0, v26
v_max_f32 v27, 0, v27
v_cvt_pk_bf16_f32 v28, v20, v21
v_cvt_pk_bf16_f32 v29, v22, v23
v_cvt_pk_bf16_f32 v30, v24, v25
v_cvt_pk_bf16_f32 v31, v26, v27
buffer_store_dwordx4 v[28:31], v4, s[36:39], s57 offen offset:3072 sc1
s_add_u32 s57, s12, 229376
v_accvgpr_read_b32 v8, a64
v_accvgpr_read_b32 v9, a65
v_accvgpr_read_b32 v10, a66
v_accvgpr_read_b32 v11, a67
v_accvgpr_read_b32 v12, a68
v_accvgpr_read_b32 v13, a69
v_accvgpr_read_b32 v14, a70
v_accvgpr_read_b32 v15, a71
v_max_f32 v8, 0, v8
v_max_f32 v9, 0, v9
v_max_f32 v10, 0, v10
v_max_f32 v11, 0, v11
v_max_f32 v12, 0, v12
v_max_f32 v13, 0, v13
v_max_f32 v14, 0, v14
v_max_f32 v15, 0, v15
v_cvt_pk_bf16_f32 v16, v8, v9
v_cvt_pk_bf16_f32 v17, v10, v11
v_cvt_pk_bf16_f32 v18, v12, v13
v_cvt_pk_bf16_f32 v19, v14, v15
buffer_store_dwordx4 v[16:19], v4, s[36:39], s57 offen offset:0 sc1
v_accvgpr_read_b32 v20, a72
v_accvgpr_read_b32 v21, a73
v_accvgpr_read_b32 v22, a74
v_accvgpr_read_b32 v23, a75
v_accvgpr_read_b32 v24, a76
v_accvgpr_read_b32 v25, a77
v_accvgpr_read_b32 v26, a78
v_accvgpr_read_b32 v27, a79
v_max_f32 v20, 0, v20
v_max_f32 v21, 0, v21
v_max_f32 v22, 0, v22
v_max_f32 v23, 0, v23
v_max_f32 v24, 0, v24
v_max_f32 v25, 0, v25
v_max_f32 v26, 0, v26
v_max_f32 v27, 0, v27
v_cvt_pk_bf16_f32 v28, v20, v21
v_cvt_pk_bf16_f32 v29, v22, v23
v_cvt_pk_bf16_f32 v30, v24, v25
v_cvt_pk_bf16_f32 v31, v26, v27
buffer_store_dwordx4 v[28:31], v4, s[36:39], s57 offen offset:1024 sc1
v_accvgpr_read_b32 v8, a80
v_accvgpr_read_b32 v9, a81
v_accvgpr_read_b32 v10, a82
v_accvgpr_read_b32 v11, a83
v_accvgpr_read_b32 v12, a84
v_accvgpr_read_b32 v13, a85
v_accvgpr_read_b32 v14, a86
v_accvgpr_read_b32 v15, a87
v_max_f32 v8, 0, v8
v_max_f32 v9, 0, v9
v_max_f32 v10, 0, v10
v_max_f32 v11, 0, v11
v_max_f32 v12, 0, v12
v_max_f32 v13, 0, v13
v_max_f32 v14, 0, v14
v_max_f32 v15, 0, v15
v_cvt_pk_bf16_f32 v16, v8, v9
v_cvt_pk_bf16_f32 v17, v10, v11
v_cvt_pk_bf16_f32 v18, v12, v13
v_cvt_pk_bf16_f32 v19, v14, v15
buffer_store_dwordx4 v[16:19], v4, s[36:39], s57 offen offset:2048 sc1
v_accvgpr_read_b32 v20, a88
v_accvgpr_read_b32 v21, a89
v_accvgpr_read_b32 v22, a90
v_accvgpr_read_b32 v23, a91
v_accvgpr_read_b32 v24, a92
v_accvgpr_read_b32 v25, a93
v_accvgpr_read_b32 v26, a94
v_accvgpr_read_b32 v27, a95
v_max_f32 v20, 0, v20
v_max_f32 v21, 0, v21
v_max_f32 v22, 0, v22
v_max_f32 v23, 0, v23
v_max_f32 v24, 0, v24
v_max_f32 v25, 0, v25
v_max_f32 v26, 0, v26
v_max_f32 v27, 0, v27
v_cvt_pk_bf16_f32 v28, v20, v21
v_cvt_pk_bf16_f32 v29, v22, v23
v_cvt_pk_bf16_f32 v30, v24, v25
v_cvt_pk_bf16_f32 v31, v26, v27
buffer_store_dwordx4 v[28:31], v4, s[36:39], s57 offen offset:3072 sc1
v_accvgpr_read_b32 v8, a96
v_accvgpr_read_b32 v9, a97
v_accvgpr_read_b32 v10, a98
v_accvgpr_read_b32 v11, a99
v_accvgpr_read_b32 v12, a100
v_accvgpr_read_b32 v13, a101
v_accvgpr_read_b32 v14, a102
v_accvgpr_read_b32 v15, a103
v_max_f32 v8, 0, v8
v_max_f32 v9, 0, v9
v_max_f32 v10, 0, v10
v_max_f32 v11, 0, v11
v_max_f32 v12, 0, v12
v_max_f32 v13, 0, v13
v_max_f32 v14, 0, v14
v_max_f32 v15, 0, v15
v_cvt_pk_bf16_f32 v16, v8, v9
v_cvt_pk_bf16_f32 v17, v10, v11
v_cvt_pk_bf16_f32 v18, v12, v13
v_cvt_pk_bf16_f32 v19, v14, v15
s_add_u32 s57, s57, 4096
buffer_store_dwordx4 v[16:19], v4, s[36:39], s57 offen offset:0 sc1
v_accvgpr_read_b32 v20, a104
v_accvgpr_read_b32 v21, a105
v_accvgpr_read_b32 v22, a106
v_accvgpr_read_b32 v23, a107
v_accvgpr_read_b32 v24, a108
v_accvgpr_read_b32 v25, a109
v_accvgpr_read_b32 v26, a110
v_accvgpr_read_b32 v27, a111
v_max_f32 v20, 0, v20
v_max_f32 v21, 0, v21
v_max_f32 v22, 0, v22
v_max_f32 v23, 0, v23
v_max_f32 v24, 0, v24
v_max_f32 v25, 0, v25
v_max_f32 v26, 0, v26
v_max_f32 v27, 0, v27
v_cvt_pk_bf16_f32 v28, v20, v21
v_cvt_pk_bf16_f32 v29, v22, v23
v_cvt_pk_bf16_f32 v30, v24, v25
v_cvt_pk_bf16_f32 v31, v26, v27
buffer_store_dwordx4 v[28:31], v4, s[36:39], s57 offen offset:1024 sc1
v_accvgpr_read_b32 v8, a112
v_accvgpr_read_b32 v9, a113
v_accvgpr_read_b32 v10, a114
v_accvgpr_read_b32 v11, a115
v_accvgpr_read_b32 v12, a116
v_accvgpr_read_b32 v13, a117
v_accvgpr_read_b32 v14, a118
v_accvgpr_read_b32 v15, a119
v_max_f32 v8, 0, v8
v_max_f32 v9, 0, v9
v_max_f32 v10, 0, v10
v_max_f32 v11, 0, v11
v_max_f32 v12, 0, v12
v_max_f32 v13, 0, v13
v_max_f32 v14, 0, v14
v_max_f32 v15, 0, v15
v_cvt_pk_bf16_f32 v16, v8, v9
v_cvt_pk_bf16_f32 v17, v10, v11
v_cvt_pk_bf16_f32 v18, v12, v13
v_cvt_pk_bf16_f32 v19, v14, v15
buffer_store_dwordx4 v[16:19], v4, s[36:39], s57 offen offset:2048 sc1
v_accvgpr_read_b32 v20, a120
v_accvgpr_read_b32 v21, a121
v_accvgpr_read_b32 v22, a122
v_accvgpr_read_b32 v23, a123
v_accvgpr_read_b32 v24, a124
v_accvgpr_read_b32 v25, a125
v_accvgpr_read_b32 v26, a126
v_accvgpr_read_b32 v27, a127
v_max_f32 v20, 0, v20
v_max_f32 v21, 0, v21
v_max_f32 v22, 0, v22
v_max_f32 v23, 0, v23
v_max_f32 v24, 0, v24
v_max_f32 v25, 0, v25
v_max_f32 v26, 0, v26
v_max_f32 v27, 0, v27
v_cvt_pk_bf16_f32 v28, v20, v21
v_cvt_pk_bf16_f32 v29, v22, v23
v_cvt_pk_bf16_f32 v30, v24, v25
v_cvt_pk_bf16_f32 v31, v26, v27
buffer_store_dwordx4 v[28:31], v4, s[36:39], s57 offen offset:3072 sc1
s_add_u32 s86, s70, 119554688
s_bfe_u32 s82, s78, 0x30000
s_mul_i32 s82, s82, 1024
s_add_u32 s86, s86, s82
s_waitcnt vmcnt(0)
s_barrier
s_cmp_lg_u32 s3, 0
s_cbranch_scc1 .Lsg_367
v_mov_b32 v1, 1
v_mul_u32_u24 v2, 0, v0
s_mov_b64 exec, 1
buffer_atomic_add v1, v2, s[88:91], s86 offen sc1
s_mov_b64 exec, -1
.Lsg_367:
.Lnf_361:
s_lshl_b32 s84, s78, 1
s_and_b32 s81, s77, 1
s_add_u32 s84, s84, s81
s_lshr_b32 s85, s77, 1
s_add_u32 s86, s70, 119554688
s_bfe_u32 s82, s78, 0x30000
s_mul_i32 s82, s82, 1024
s_add_u32 s86, s86, s82
s_load_dwordx2 s[6:7], s[0:1], 72
s_load_dwordx2 s[14:15], s[0:1], 96
s_add_u32 s40, s4, 0x5000000
s_addc_u32 s41, s5, 0
s_mov_b32 s42, 0xe00000
s_mov_b32 s43, 0x00020000
s_and_b32 s18, s85, 7
s_mov_b32 s19, 2048
s_cmp_eq_u32 s18, 3
s_cselect_b32 s19, 128, s19
v_lshrrev_b32 v142, 2, v0
v_and_b32 v142, 3, v142
v_lshrrev_b32 v143, 5, v0
v_lshlrev_b32 v143, 2, v143
v_add_u32 v143, v143, v142
v_mul_u32_u24 v143, 128, v143
v_and_b32 v144, 3, v0
v_lshlrev_b32 v144, 3, v144
v_add_u32 v143, v143, v144
v_and_b32 v144, 16, v0
v_lshlrev_b32 v144, 1, v144
v_add_u32 v143, v143, v144
v_lshrrev_b32 v142, 1, v142
s_and_b32 s53, s3, 0
s_mul_i32 s53, s53, 2
s_add_u32 s57, s53, 0
v_xor_b32 v144, s57, v142
v_lshlrev_b32 v144, 6, v144
v_add_u32 v136, v143, v144
s_add_u32 s57, s53, 1
v_xor_b32 v144, s57, v142
v_lshlrev_b32 v144, 6, v144
v_add_u32 v137, v143, v144
s_lshr_b32 s53, s3, 0
s_mul_i32 s53, s53, 229376
v_lshlrev_b32 v140, 4, v0
v_add_u32 v140, s53, v140
v_lshrrev_b32 v142, 3, v0
s_mul_i32 s53, s3, 8
v_add_u32 v142, s53, v142
v_and_b32 v143, 3, v142
v_lshrrev_b32 v143, 1, v143
v_and_b32 v144, 7, v0
v_lshrrev_b32 v144, 2, v144
v_xor_b32 v143, v143, v144
v_lshlrev_b32 v143, 6, v143
v_and_b32 v144, 3, v0
v_lshlrev_b32 v144, 4, v144
v_add_u32 v143, v143, v144
s_mov_b32 s53, s19
v_mul_lo_u32 v142, v142, s53
v_add_u32 v141, v142, v143
s_mul_i32 s54, s53, 32
s_lshl_b32 s56, s3, 10
s_waitcnt lgkmcnt(0)
s_mul_i32 s48, s84, 917504
s_mul_i32 s49, s85, 128
s_mov_b32 s50, 112
s_add_u32 s16, s4, 114294784
s_addc_u32 s17, s5, 0
s_lshr_b32 s18, s85, 3
s_lshl_b32 s18, s18, 19
s_cmp_eq_u32 s19, 128
s_cselect_b32 s6, s16, s6
s_cselect_b32 s7, s17, s7
s_cselect_b32 s49, s18, s49
s_mov_b32 s44, s6
s_mov_b32 s45, s7
s_mov_b32 s46, 0x700000
s_mov_b32 s47, 0x00020000
s_add_u32 m0, s56, 0
s_nop 0
buffer_load_dwordx4 v141, s[44:47], s49 offen lds
s_add_u32 s49, s49, s54
s_add_u32 m0, s56, 4096
s_nop 0
buffer_load_dwordx4 v141, s[44:47], s49 offen lds
s_add_u32 s49, s49, s54
s_add_u32 m0, s56, 8192
s_nop 0
buffer_load_dwordx4 v141, s[44:47], s49 offen lds
s_add_u32 s49, s49, s54
s_add_u32 m0, s56, 12288
s_nop 0
buffer_load_dwordx4 v141, s[44:47], s49 offen lds
s_add_u32 s49, s49, s54
s_add_u32 m0, s56, 16384
s_nop 0
buffer_load_dwordx4 v141, s[44:47], s49 offen lds
s_add_u32 s49, s49, s54
s_add_u32 m0, s56, 20480
s_nop 0
buffer_load_dwordx4 v141, s[44:47], s49 offen lds
s_add_u32 s49, s49, s54
s_add_u32 m0, s56, 24576
s_nop 0
buffer_load_dwordx4 v141, s[44:47], s49 offen lds
s_add_u32 s49, s49, s54
s_add_u32 m0, s56, 28672
s_nop 0
buffer_load_dwordx4 v141, s[44:47], s49 offen lds
s_add_u32 s49, s49, s54
s_add_u32 m0, s56, 32768
s_nop 0
buffer_load_dwordx4 v141, s[44:47], s49 offen lds
s_add_u32 s49, s49, s54
s_add_u32 m0, s56, 36864
s_nop 0
buffer_load_dwordx4 v141, s[44:47], s49 offen lds
s_add_u32 s49, s49, s54
s_add_u32 m0, s56, 40960
s_nop 0
buffer_load_dwordx4 v141, s[44:47], s49 offen lds
s_add_u32 s49, s49, s54
s_add_u32 m0, s56, 45056
s_nop 0
buffer_load_dwordx4 v141, s[44:47], s49 offen lds
s_add_u32 s49, s49, s54
s_add_u32 m0, s56, 49152
s_nop 0
buffer_load_dwordx4 v141, s[44:47], s49 offen lds
s_add_u32 s49, s49, s54
s_add_u32 m0, s56, 53248
s_nop 0
buffer_load_dwordx4 v141, s[44:47], s49 offen lds
s_add_u32 s49, s49, s54
s_add_u32 m0, s56, 57344
s_nop 0
buffer_load_dwordx4 v141, s[44:47], s49 offen lds
s_add_u32 s49, s49, s54
s_add_u32 m0, s56, 61440
s_nop 0
buffer_load_dwordx4 v141, s[44:47], s49 offen lds
s_add_u32 s49, s49, s54
s_add_u32 m0, s56, 65536
s_nop 0
buffer_load_dwordx4 v141, s[44:47], s49 offen lds
s_add_u32 s49, s49, s54
s_add_u32 m0, s56, 69632
s_nop 0
buffer_load_dwordx4 v141, s[44:47], s49 offen lds
s_add_u32 s49, s49, s54
s_add_u32 m0, s56, 73728
s_nop 0
buffer_load_dwordx4 v141, s[44:47], s49 offen lds
s_add_u32 s49, s49, s54
s_add_u32 m0, s56, 77824
s_nop 0
buffer_load_dwordx4 v141, s[44:47], s49 offen lds
s_add_u32 s49, s49, s54
s_add_u32 m0, s56, 81920
s_nop 0
buffer_load_dwordx4 v141, s[44:47], s49 offen lds
s_add_u32 s49, s49, s54
s_add_u32 m0, s56, 86016
s_nop 0
buffer_load_dwordx4 v141, s[44:47], s49 offen lds
s_add_u32 s49, s49, s54
s_add_u32 m0, s56, 90112
s_nop 0
buffer_load_dwordx4 v141, s[44:47], s49 offen lds
s_add_u32 s49, s49, s54
s_add_u32 m0, s56, 94208
s_nop 0
buffer_load_dwordx4 v141, s[44:47], s49 offen lds
s_add_u32 s49, s49, s54
s_lshr_b32 s16, s3, 0
s_mul_i32 s16, s16, 1
s_mul_i32 s18, s84, 4
s_add_u32 s16, s16, s18
s_and_b32 s17, s3, 0
s_mul_i32 s17, s17, 4
s_mul_i32 s18, s85, 4
s_add_u32 s17, s17, s18
v_lshlrev_b32 v4, 4, v0
s_add_u32 s36, s4, 0x400000
s_addc_u32 s37, s5, 0
s_mov_b32 s38, 0x400000
s_mov_b32 s39, 0x00020000
s_add_u32 s32, s4, 0xc05000
s_addc_u32 s33, s5, 0
s_mov_b32 s34, 0x1000
s_mov_b32 s35, 0x00020000
s_lshl_b32 s12, s16, 16
s_lshl_b32 s18, s17, 10
s_add_u32 s12, s12, s18
s_lshl_b32 s13, s17, 6
v_lshrrev_b32 v5, 5, v0
v_lshlrev_b32 v6, 4, v5
v_lshlrev_b32 v5, 5, v5
s_mov_b32 s28, s14
s_mov_b32 s29, s15
s_mov_b32 s30, 0x400000
s_mov_b32 s31, 0x00020000
s_lshl_b32 s19, s16, 16
s_lshl_b32 s18, s17, 5
s_add_u32 s19, s19, s18
v_and_b32 v7, 31, v0
v_lshlrev_b32 v7, 11, v7
v_add_u32 v6, v6, v7
buffer_load_dwordx4 v[148:151], v5, s[32:35], s13 offen offset:0
buffer_load_dwordx4 v[152:155], v5, s[32:35], s13 offen offset:16
buffer_load_dwordx4 v[156:159], v5, s[32:35], s13 offen offset:64
buffer_load_dwordx4 v[160:163], v5, s[32:35], s13 offen offset:80
buffer_load_dwordx4 v[164:167], v5, s[32:35], s13 offen offset:128
buffer_load_dwordx4 v[168:171], v5, s[32:35], s13 offen offset:144
buffer_load_dwordx4 v[172:175], v5, s[32:35], s13 offen offset:192
buffer_load_dwordx4 v[176:179], v5, s[32:35], s13 offen offset:208
s_add_u32 s57, s12, 0
buffer_load_dwordx4 v[180:183], v4, s[36:39], s57 offen offset:0 sc1
buffer_load_dwordx4 v[184:187], v4, s[36:39], s57 offen offset:1024 sc1
buffer_load_dwordx4 v[188:191], v4, s[36:39], s57 offen offset:2048 sc1
buffer_load_dwordx4 v[192:195], v4, s[36:39], s57 offen offset:3072 sc1
s_cmp_lg_u32 s3, 0
s_cbranch_scc1 .Lws_368
v_mul_u32_u24 v1, 0, v0
v_add_u32 v1, s86, v1
v_mov_b32 v2, 28
s_mov_b64 exec, 1
.Lwl_369:
buffer_load_dword v3, v1, s[88:91], 0 offen sc1
s_waitcnt vmcnt(0)
v_cmp_lt_u32 vcc, v3, v2
s_cbranch_vccz .Lwo_370
s_cmp_eq_u32 s80, 0
s_cbranch_scc1 .Lwo_370
s_sub_u32 s80, s80, 1
s_branch .Lwl_369
.Lwo_370:
s_mov_b64 exec, -1
.Lws_368:
s_barrier
buffer_load_dwordx4 v[8:11], v140, s[40:43], s48 offen offset:0 sc1
buffer_load_dwordx4 v[12:15], v140, s[40:43], s48 offen offset:1024 sc1
buffer_load_dwordx4 v[16:19], v140, s[40:43], s48 offen offset:2048 sc1
buffer_load_dwordx4 v[20:23], v140, s[40:43], s48 offen offset:3072 sc1
s_add_u32 s48, s48, 4096
buffer_load_dwordx4 v[24:27], v140, s[40:43], s48 offen offset:0 sc1
buffer_load_dwordx4 v[28:31], v140, s[40:43], s48 offen offset:1024 sc1
buffer_load_dwordx4 v[32:35], v140, s[40:43], s48 offen offset:2048 sc1
buffer_load_dwordx4 v[36:39], v140, s[40:43], s48 offen offset:3072 sc1
s_add_u32 s48, s48, 4096
buffer_load_dwordx4 v[40:43], v140, s[40:43], s48 offen offset:0 sc1
buffer_load_dwordx4 v[44:47], v140, s[40:43], s48 offen offset:1024 sc1
buffer_load_dwordx4 v[48:51], v140, s[40:43], s48 offen offset:2048 sc1
buffer_load_dwordx4 v[52:55], v140, s[40:43], s48 offen offset:3072 sc1
s_add_u32 s48, s48, 4096
buffer_load_dwordx4 v[56:59], v140, s[40:43], s48 offen offset:0 sc1
buffer_load_dwordx4 v[60:63], v140, s[40:43], s48 offen offset:1024 sc1
v_accvgpr_write_b32 a0, 0
v_accvgpr_write_b32 a1, 0
v_accvgpr_write_b32 a2, 0
v_accvgpr_write_b32 a3, 0
v_accvgpr_write_b32 a4, 0
v_accvgpr_write_b32 a5, 0
v_accvgpr_write_b32 a6, 0
v_accvgpr_write_b32 a7, 0
v_accvgpr_write_b32 a8, 0
v_accvgpr_write_b32 a9, 0
v_accvgpr_write_b32 a10, 0
v_accvgpr_write_b32 a11, 0
v_accvgpr_write_b32 a12, 0
v_accvgpr_write_b32 a13, 0
v_accvgpr_write_b32 a14, 0
v_accvgpr_write_b32 a15, 0
v_accvgpr_write_b32 a16, 0
v_accvgpr_write_b32 a17, 0
v_accvgpr_write_b32 a18, 0
v_accvgpr_write_b32 a19, 0
v_accvgpr_write_b32 a20, 0
v_accvgpr_write_b32 a21, 0
v_accvgpr_write_b32 a22, 0
v_accvgpr_write_b32 a23, 0
v_accvgpr_write_b32 a24, 0
v_accvgpr_write_b32 a25, 0
v_accvgpr_write_b32 a26, 0
v_accvgpr_write_b32 a27, 0
v_accvgpr_write_b32 a28, 0
v_accvgpr_write_b32 a29, 0
v_accvgpr_write_b32 a30, 0
v_accvgpr_write_b32 a31, 0
s_waitcnt vmcnt(10)
s_barrier
s_mov_b32 s51, 0
s_add_u32 s52, s56, 98304
v_mov_b32 v138, v136
v_mov_b32 v139, v137
ds_read_b64_tr_b16 v[72:73], v138 offset:0
ds_read_b64_tr_b16 v[74:75], v138 offset:1024
ds_read_b64_tr_b16 v[76:77], v139 offset:0
ds_read_b64_tr_b16 v[78:79], v139 offset:1024
ds_read_b64_tr_b16 v[80:81], v138 offset:2048
ds_read_b64_tr_b16 v[82:83], v138 offset:3072
ds_read_b64_tr_b16 v[84:85], v139 offset:2048
ds_read_b64_tr_b16 v[86:87], v139 offset:3072
ds_read_b64_tr_b16 v[88:89], v138 offset:4096
ds_read_b64_tr_b16 v[90:91], v138 offset:5120
ds_read_b64_tr_b16 v[92:93], v139 offset:4096
ds_read_b64_tr_b16 v[94:95], v139 offset:5120
ds_read_b64_tr_b16 v[96:97], v138 offset:6144
ds_read_b64_tr_b16 v[98:99], v138 offset:7168
ds_read_b64_tr_b16 v[100:101], v139 offset:6144
ds_read_b64_tr_b16 v[102:103], v139 offset:7168
s_waitcnt lgkmcnt(8)
v_mfma_f32_32x32x16_bf16 a[0:15], v[72:75], v[8:11], a[0:15]
s_waitcnt vmcnt(8)
s_barrier
ds_read_b64_tr_b16 v[104:105], v138 offset:8192
ds_read_b64_tr_b16 v[106:107], v138 offset:9216
v_mfma_f32_32x32x16_bf16 a[16:31], v[76:79], v[8:11], a[16:31]
ds_read_b64_tr_b16 v[108:109], v139 offset:8192
ds_read_b64_tr_b16 v[110:111], v139 offset:9216
s_add_u32 m0, s52, 0
s_nop 0
buffer_load_dwordx4 v141, s[44:47], s49 offen lds
s_add_u32 s49, s49, s54
v_mfma_f32_32x32x16_bf16 a[0:15], v[80:83], v[12:15], a[0:15]
ds_read_b64_tr_b16 v[112:113], v138 offset:10240
ds_read_b64_tr_b16 v[114:115], v138 offset:11264
buffer_load_dwordx4 v[64:67], v140, s[40:43], s48 offen offset:2048 sc1
v_mfma_f32_32x32x16_bf16 a[16:31], v[84:87], v[12:15], a[16:31]
ds_read_b64_tr_b16 v[116:117], v139 offset:10240
ds_read_b64_tr_b16 v[118:119], v139 offset:11264
buffer_load_dwordx4 v[68:71], v140, s[40:43], s48 offen offset:3072 sc1
s_add_u32 s48, s48, 4096
s_waitcnt lgkmcnt(8)
v_mfma_f32_32x32x16_bf16 a[0:15], v[88:91], v[16:19], a[0:15]
s_waitcnt vmcnt(9)
s_barrier
ds_read_b64_tr_b16 v[120:121], v138 offset:12288
ds_read_b64_tr_b16 v[122:123], v138 offset:13312
v_mfma_f32_32x32x16_bf16 a[16:31], v[92:95], v[16:19], a[16:31]
ds_read_b64_tr_b16 v[124:125], v139 offset:12288
ds_read_b64_tr_b16 v[126:127], v139 offset:13312
s_add_u32 m0, s52, 4096
s_nop 0
buffer_load_dwordx4 v141, s[44:47], s49 offen lds
s_add_u32 s49, s49, s54
v_mfma_f32_32x32x16_bf16 a[0:15], v[96:99], v[20:23], a[0:15]
ds_read_b64_tr_b16 v[128:129], v138 offset:14336
ds_read_b64_tr_b16 v[130:131], v138 offset:15360
buffer_load_dwordx4 v[8:11], v140, s[40:43], s48 offen offset:0 sc1
v_mfma_f32_32x32x16_bf16 a[16:31], v[100:103], v[20:23], a[16:31]
ds_read_b64_tr_b16 v[132:133], v139 offset:14336
ds_read_b64_tr_b16 v[134:135], v139 offset:15360
buffer_load_dwordx4 v[12:15], v140, s[40:43], s48 offen offset:1024 sc1
s_waitcnt lgkmcnt(8)
v_mfma_f32_32x32x16_bf16 a[0:15], v[104:107], v[24:27], a[0:15]
s_waitcnt vmcnt(10)
s_barrier
ds_read_b64_tr_b16 v[72:73], v138 offset:16384
ds_read_b64_tr_b16 v[74:75], v138 offset:17408
v_mfma_f32_32x32x16_bf16 a[16:31], v[108:111], v[24:27], a[16:31]
ds_read_b64_tr_b16 v[76:77], v139 offset:16384
ds_read_b64_tr_b16 v[78:79], v139 offset:17408
s_add_u32 m0, s52, 8192
s_nop 0
buffer_load_dwordx4 v141, s[44:47], s49 offen lds
s_add_u32 s49, s49, s54
v_mfma_f32_32x32x16_bf16 a[0:15], v[112:115], v[28:31], a[0:15]
ds_read_b64_tr_b16 v[80:81], v138 offset:18432
ds_read_b64_tr_b16 v[82:83], v138 offset:19456
buffer_load_dwordx4 v[16:19], v140, s[40:43], s48 offen offset:2048 sc1
v_mfma_f32_32x32x16_bf16 a[16:31], v[116:119], v[28:31], a[16:31]
ds_read_b64_tr_b16 v[84:85], v139 offset:18432
ds_read_b64_tr_b16 v[86:87], v139 offset:19456
buffer_load_dwordx4 v[20:23], v140, s[40:43], s48 offen offset:3072 sc1
s_add_u32 s48, s48, 4096
s_waitcnt lgkmcnt(8)
v_mfma_f32_32x32x16_bf16 a[0:15], v[120:123], v[32:35], a[0:15]
s_waitcnt vmcnt(11)
s_barrier
ds_read_b64_tr_b16 v[88:89], v138 offset:20480
ds_read_b64_tr_b16 v[90:91], v138 offset:21504
v_mfma_f32_32x32x16_bf16 a[16:31], v[124:127], v[32:35], a[16:31]
ds_read_b64_tr_b16 v[92:93], v139 offset:20480
ds_read_b64_tr_b16 v[94:95], v139 offset:21504
s_add_u32 m0, s52, 12288
s_nop 0
buffer_load_dwordx4 v141, s[44:47], s49 offen lds
s_add_u32 s49, s49, s54
v_mfma_f32_32x32x16_bf16 a[0:15], v[128:131], v[36:39], a[0:15]
ds_read_b64_tr_b16 v[96:97], v138 offset:22528
ds_read_b64_tr_b16 v[98:99], v138 offset:23552
buffer_load_dwordx4 v[24:27], v140, s[40:43], s48 offen offset:0 sc1
v_mfma_f32_32x32x16_bf16 a[16:31], v[132:135], v[36:39], a[16:31]
ds_read_b64_tr_b16 v[100:101], v139 offset:22528
ds_read_b64_tr_b16 v[102:103], v139 offset:23552
buffer_load_dwordx4 v[28:31], v140, s[40:43], s48 offen offset:1024 sc1
s_waitcnt lgkmcnt(8)
v_mfma_f32_32x32x16_bf16 a[0:15], v[72:75], v[40:43], a[0:15]
s_waitcnt vmcnt(12)
s_barrier
ds_read_b64_tr_b16 v[104:105], v138 offset:24576
ds_read_b64_tr_b16 v[106:107], v138 offset:25600
v_mfma_f32_32x32x16_bf16 a[16:31], v[76:79], v[40:43], a[16:31]
ds_read_b64_tr_b16 v[108:109], v139 offset:24576
ds_read_b64_tr_b16 v[110:111], v139 offset:25600
s_add_u32 m0, s52, 16384
s_nop 0
buffer_load_dwordx4 v141, s[44:47], s49 offen lds
s_add_u32 s49, s49, s54
v_mfma_f32_32x32x16_bf16 a[0:15], v[80:83], v[44:47], a[0:15]
ds_read_b64_tr_b16 v[112:113], v138 offset:26624
ds_read_b64_tr_b16 v[114:115], v138 offset:27648
buffer_load_dwordx4 v[32:35], v140, s[40:43], s48 offen offset:2048 sc1
v_mfma_f32_32x32x16_bf16 a[16:31], v[84:87], v[44:47], a[16:31]
ds_read_b64_tr_b16 v[116:117], v139 offset:26624
ds_read_b64_tr_b16 v[118:119], v139 offset:27648
buffer_load_dwordx4 v[36:39], v140, s[40:43], s48 offen offset:3072 sc1
s_add_u32 s48, s48, 4096
s_waitcnt lgkmcnt(8)
v_mfma_f32_32x32x16_bf16 a[0:15], v[88:91], v[48:51], a[0:15]
s_waitcnt vmcnt(12)
s_barrier
ds_read_b64_tr_b16 v[120:121], v138 offset:28672
ds_read_b64_tr_b16 v[122:123], v138 offset:29696
v_mfma_f32_32x32x16_bf16 a[16:31], v[92:95], v[48:51], a[16:31]
ds_read_b64_tr_b16 v[124:125], v139 offset:28672
ds_read_b64_tr_b16 v[126:127], v139 offset:29696
s_add_u32 m0, s52, 20480
s_nop 0
buffer_load_dwordx4 v141, s[44:47], s49 offen lds
s_add_u32 s49, s49, s54
v_mfma_f32_32x32x16_bf16 a[0:15], v[96:99], v[52:55], a[0:15]
ds_read_b64_tr_b16 v[128:129], v138 offset:30720
ds_read_b64_tr_b16 v[130:131], v138 offset:31744
buffer_load_dwordx4 v[40:43], v140, s[40:43], s48 offen offset:0 sc1
v_mfma_f32_32x32x16_bf16 a[16:31], v[100:103], v[52:55], a[16:31]
ds_read_b64_tr_b16 v[132:133], v139 offset:30720
ds_read_b64_tr_b16 v[134:135], v139 offset:31744
buffer_load_dwordx4 v[44:47], v140, s[40:43], s48 offen offset:1024 sc1
s_waitcnt lgkmcnt(8)
v_mfma_f32_32x32x16_bf16 a[0:15], v[104:107], v[56:59], a[0:15]
s_waitcnt vmcnt(12)
s_barrier
s_add_u32 s58, s51, s56
s_add_u32 s51, s51, 32768
s_cmp_eq_u32 s51, 131072
s_cselect_b32 s51, 0, s51
v_add_u32 v138, s51, v136
v_add_u32 v139, s51, v137
ds_read_b64_tr_b16 v[72:73], v138 offset:0
ds_read_b64_tr_b16 v[74:75], v138 offset:1024
v_mfma_f32_32x32x16_bf16 a[16:31], v[108:111], v[56:59], a[16:31]
ds_read_b64_tr_b16 v[76:77], v139 offset:0
ds_read_b64_tr_b16 v[78:79], v139 offset:1024
s_add_u32 m0, s52, 24576
s_nop 0
buffer_load_dwordx4 v141, s[44:47], s49 offen lds
s_add_u32 s49, s49, s54
v_mfma_f32_32x32x16_bf16 a[0:15], v[112:115], v[60:63], a[0:15]
ds_read_b64_tr_b16 v[80:81], v138 offset:2048
ds_read_b64_tr_b16 v[82:83], v138 offset:3072
buffer_load_dwordx4 v[48:51], v140, s[40:43], s48 offen offset:2048 sc1
v_mfma_f32_32x32x16_bf16 a[16:31], v[116:119], v[60:63], a[16:31]
ds_read_b64_tr_b16 v[84:85], v139 offset:2048
ds_read_b64_tr_b16 v[86:87], v139 offset:3072
buffer_load_dwordx4 v[52:55], v140, s[40:43], s48 offen offset:3072 sc1
s_add_u32 s48, s48, 4096
s_waitcnt lgkmcnt(8)
v_mfma_f32_32x32x16_bf16 a[0:15], v[120:123], v[64:67], a[0:15]
s_waitcnt vmcnt(12)
s_barrier
ds_read_b64_tr_b16 v[88:89], v138 offset:4096
ds_read_b64_tr_b16 v[90:91], v138 offset:5120
v_mfma_f32_32x32x16_bf16 a[16:31], v[124:127], v[64:67], a[16:31]
ds_read_b64_tr_b16 v[92:93], v139 offset:4096
ds_read_b64_tr_b16 v[94:95], v139 offset:5120
s_add_u32 m0, s52, 28672
s_nop 0
buffer_load_dwordx4 v141, s[44:47], s49 offen lds
s_add_u32 s49, s49, s54
v_mfma_f32_32x32x16_bf16 a[0:15], v[128:131], v[68:71], a[0:15]
ds_read_b64_tr_b16 v[96:97], v138 offset:6144
ds_read_b64_tr_b16 v[98:99], v138 offset:7168
buffer_load_dwordx4 v[56:59], v140, s[40:43], s48 offen offset:0 sc1
v_mfma_f32_32x32x16_bf16 a[16:31], v[132:135], v[68:71], a[16:31]
ds_read_b64_tr_b16 v[100:101], v139 offset:6144
ds_read_b64_tr_b16 v[102:103], v139 offset:7168
buffer_load_dwordx4 v[60:63], v140, s[40:43], s48 offen offset:1024 sc1
s_sub_u32 s50, s50, 8
s_mov_b32 s52, s58
s_cmp_le_u32 s50, 24
s_cbranch_scc1 .LgB_372
.LgD_371:
s_waitcnt lgkmcnt(8)
v_mfma_f32_32x32x16_bf16 a[0:15], v[72:75], v[8:11], a[0:15]
s_waitcnt vmcnt(12)
s_barrier
ds_read_b64_tr_b16 v[104:105], v138 offset:8192
ds_read_b64_tr_b16 v[106:107], v138 offset:9216
v_mfma_f32_32x32x16_bf16 a[16:31], v[76:79], v[8:11], a[16:31]
ds_read_b64_tr_b16 v[108:109], v139 offset:8192
ds_read_b64_tr_b16 v[110:111], v139 offset:9216
s_add_u32 m0, s52, 0
s_nop 0
buffer_load_dwordx4 v141, s[44:47], s49 offen lds
s_add_u32 s49, s49, s54
v_mfma_f32_32x32x16_bf16 a[0:15], v[80:83], v[12:15], a[0:15]
ds_read_b64_tr_b16 v[112:113], v138 offset:10240
ds_read_b64_tr_b16 v[114:115], v138 offset:11264
buffer_load_dwordx4 v[64:67], v140, s[40:43], s48 offen offset:2048 sc1
v_mfma_f32_32x32x16_bf16 a[16:31], v[84:87], v[12:15], a[16:31]
ds_read_b64_tr_b16 v[116:117], v139 offset:10240
ds_read_b64_tr_b16 v[118:119], v139 offset:11264
buffer_load_dwordx4 v[68:71], v140, s[40:43], s48 offen offset:3072 sc1
s_add_u32 s48, s48, 4096
s_waitcnt lgkmcnt(8)
v_mfma_f32_32x32x16_bf16 a[0:15], v[88:91], v[16:19], a[0:15]
s_waitcnt vmcnt(12)
s_barrier
ds_read_b64_tr_b16 v[120:121], v138 offset:12288
ds_read_b64_tr_b16 v[122:123], v138 offset:13312
v_mfma_f32_32x32x16_bf16 a[16:31], v[92:95], v[16:19], a[16:31]
ds_read_b64_tr_b16 v[124:125], v139 offset:12288
ds_read_b64_tr_b16 v[126:127], v139 offset:13312
s_add_u32 m0, s52, 4096
s_nop 0
buffer_load_dwordx4 v141, s[44:47], s49 offen lds
s_add_u32 s49, s49, s54
v_mfma_f32_32x32x16_bf16 a[0:15], v[96:99], v[20:23], a[0:15]
ds_read_b64_tr_b16 v[128:129], v138 offset:14336
ds_read_b64_tr_b16 v[130:131], v138 offset:15360
buffer_load_dwordx4 v[8:11], v140, s[40:43], s48 offen offset:0 sc1
v_mfma_f32_32x32x16_bf16 a[16:31], v[100:103], v[20:23], a[16:31]
ds_read_b64_tr_b16 v[132:133], v139 offset:14336
ds_read_b64_tr_b16 v[134:135], v139 offset:15360
buffer_load_dwordx4 v[12:15], v140, s[40:43], s48 offen offset:1024 sc1
s_waitcnt lgkmcnt(8)
v_mfma_f32_32x32x16_bf16 a[0:15], v[104:107], v[24:27], a[0:15]
s_waitcnt vmcnt(12)
s_barrier
ds_read_b64_tr_b16 v[72:73], v138 offset:16384
ds_read_b64_tr_b16 v[74:75], v138 offset:17408
v_mfma_f32_32x32x16_bf16 a[16:31], v[108:111], v[24:27], a[16:31]
ds_read_b64_tr_b16 v[76:77], v139 offset:16384
ds_read_b64_tr_b16 v[78:79], v139 offset:17408
s_add_u32 m0, s52, 8192
s_nop 0
buffer_load_dwordx4 v141, s[44:47], s49 offen lds
s_add_u32 s49, s49, s54
v_mfma_f32_32x32x16_bf16 a[0:15], v[112:115], v[28:31], a[0:15]
ds_read_b64_tr_b16 v[80:81], v138 offset:18432
ds_read_b64_tr_b16 v[82:83], v138 offset:19456
buffer_load_dwordx4 v[16:19], v140, s[40:43], s48 offen offset:2048 sc1
v_mfma_f32_32x32x16_bf16 a[16:31], v[116:119], v[28:31], a[16:31]
ds_read_b64_tr_b16 v[84:85], v139 offset:18432
ds_read_b64_tr_b16 v[86:87], v139 offset:19456
buffer_load_dwordx4 v[20:23], v140, s[40:43], s48 offen offset:3072 sc1
s_add_u32 s48, s48, 4096
s_waitcnt lgkmcnt(8)
v_mfma_f32_32x32x16_bf16 a[0:15], v[120:123], v[32:35], a[0:15]
s_waitcnt vmcnt(12)
s_barrier
ds_read_b64_tr_b16 v[88:89], v138 offset:20480
ds_read_b64_tr_b16 v[90:91], v138 offset:21504
v_mfma_f32_32x32x16_bf16 a[16:31], v[124:127], v[32:35], a[16:31]
ds_read_b64_tr_b16 v[92:93], v139 offset:20480
ds_read_b64_tr_b16 v[94:95], v139 offset:21504
s_add_u32 m0, s52, 12288
s_nop 0
buffer_load_dwordx4 v141, s[44:47], s49 offen lds
s_add_u32 s49, s49, s54
v_mfma_f32_32x32x16_bf16 a[0:15], v[128:131], v[36:39], a[0:15]
ds_read_b64_tr_b16 v[96:97], v138 offset:22528
ds_read_b64_tr_b16 v[98:99], v138 offset:23552
buffer_load_dwordx4 v[24:27], v140, s[40:43], s48 offen offset:0 sc1
v_mfma_f32_32x32x16_bf16 a[16:31], v[132:135], v[36:39], a[16:31]
ds_read_b64_tr_b16 v[100:101], v139 offset:22528
ds_read_b64_tr_b16 v[102:103], v139 offset:23552
buffer_load_dwordx4 v[28:31], v140, s[40:43], s48 offen offset:1024 sc1
s_waitcnt lgkmcnt(8)
v_mfma_f32_32x32x16_bf16 a[0:15], v[72:75], v[40:43], a[0:15]
s_waitcnt vmcnt(12)
s_barrier
ds_read_b64_tr_b16 v[104:105], v138 offset:24576
ds_read_b64_tr_b16 v[106:107], v138 offset:25600
v_mfma_f32_32x32x16_bf16 a[16:31], v[76:79], v[40:43], a[16:31]
ds_read_b64_tr_b16 v[108:109], v139 offset:24576
ds_read_b64_tr_b16 v[110:111], v139 offset:25600
s_add_u32 m0, s52, 16384
s_nop 0
buffer_load_dwordx4 v141, s[44:47], s49 offen lds
s_add_u32 s49, s49, s54
v_mfma_f32_32x32x16_bf16 a[0:15], v[80:83], v[44:47], a[0:15]
ds_read_b64_tr_b16 v[112:113], v138 offset:26624
ds_read_b64_tr_b16 v[114:115], v138 offset:27648
buffer_load_dwordx4 v[32:35], v140, s[40:43], s48 offen offset:2048 sc1
v_mfma_f32_32x32x16_bf16 a[16:31], v[84:87], v[44:47], a[16:31]
ds_read_b64_tr_b16 v[116:117], v139 offset:26624
ds_read_b64_tr_b16 v[118:119], v139 offset:27648
buffer_load_dwordx4 v[36:39], v140, s[40:43], s48 offen offset:3072 sc1
s_add_u32 s48, s48, 4096
s_waitcnt lgkmcnt(8)
v_mfma_f32_32x32x16_bf16 a[0:15], v[88:91], v[48:51], a[0:15]
s_waitcnt vmcnt(12)
s_barrier
ds_read_b64_tr_b16 v[120:121], v138 offset:28672
ds_read_b64_tr_b16 v[122:123], v138 offset:29696
v_mfma_f32_32x32x16_bf16 a[16:31], v[92:95], v[48:51], a[16:31]
ds_read_b64_tr_b16 v[124:125], v139 offset:28672
ds_read_b64_tr_b16 v[126:127], v139 offset:29696
s_add_u32 m0, s52, 20480
s_nop 0
buffer_load_dwordx4 v141, s[44:47], s49 offen lds
s_add_u32 s49, s49, s54
v_mfma_f32_32x32x16_bf16 a[0:15], v[96:99], v[52:55], a[0:15]
ds_read_b64_tr_b16 v[128:129], v138 offset:30720
ds_read_b64_tr_b16 v[130:131], v138 offset:31744
buffer_load_dwordx4 v[40:43], v140, s[40:43], s48 offen offset:0 sc1
v_mfma_f32_32x32x16_bf16 a[16:31], v[100:103], v[52:55], a[16:31]
ds_read_b64_tr_b16 v[132:133], v139 offset:30720
ds_read_b64_tr_b16 v[134:135], v139 offset:31744
buffer_load_dwordx4 v[44:47], v140, s[40:43], s48 offen offset:1024 sc1
s_waitcnt lgkmcnt(8)
v_mfma_f32_32x32x16_bf16 a[0:15], v[104:107], v[56:59], a[0:15]
s_waitcnt vmcnt(12)
s_barrier
s_add_u32 s58, s51, s56
s_add_u32 s51, s51, 32768
s_cmp_eq_u32 s51, 131072
s_cselect_b32 s51, 0, s51
v_add_u32 v138, s51, v136
v_add_u32 v139, s51, v137
ds_read_b64_tr_b16 v[72:73], v138 offset:0
ds_read_b64_tr_b16 v[74:75], v138 offset:1024
v_mfma_f32_32x32x16_bf16 a[16:31], v[108:111], v[56:59], a[16:31]
ds_read_b64_tr_b16 v[76:77], v139 offset:0
ds_read_b64_tr_b16 v[78:79], v139 offset:1024
s_add_u32 m0, s52, 24576
s_nop 0
buffer_load_dwordx4 v141, s[44:47], s49 offen lds
s_add_u32 s49, s49, s54
v_mfma_f32_32x32x16_bf16 a[0:15], v[112:115], v[60:63], a[0:15]
ds_read_b64_tr_b16 v[80:81], v138 offset:2048
ds_read_b64_tr_b16 v[82:83], v138 offset:3072
buffer_load_dwordx4 v[48:51], v140, s[40:43], s48 offen offset:2048 sc1
v_mfma_f32_32x32x16_bf16 a[16:31], v[116:119], v[60:63], a[16:31]
ds_read_b64_tr_b16 v[84:85], v139 offset:2048
ds_read_b64_tr_b16 v[86:87], v139 offset:3072
buffer_load_dwordx4 v[52:55], v140, s[40:43], s48 offen offset:3072 sc1
s_add_u32 s48, s48, 4096
s_waitcnt lgkmcnt(8)
v_mfma_f32_32x32x16_bf16 a[0:15], v[120:123], v[64:67], a[0:15]
s_waitcnt vmcnt(12)
s_barrier
ds_read_b64_tr_b16 v[88:89], v138 offset:4096
ds_read_b64_tr_b16 v[90:91], v138 offset:5120
v_mfma_f32_32x32x16_bf16 a[16:31], v[124:127], v[64:67], a[16:31]
ds_read_b64_tr_b16 v[92:93], v139 offset:4096
ds_read_b64_tr_b16 v[94:95], v139 offset:5120
s_add_u32 m0, s52, 28672
s_nop 0
buffer_load_dwordx4 v141, s[44:47], s49 offen lds
s_add_u32 s49, s49, s54
v_mfma_f32_32x32x16_bf16 a[0:15], v[128:131], v[68:71], a[0:15]
ds_read_b64_tr_b16 v[96:97], v138 offset:6144
ds_read_b64_tr_b16 v[98:99], v138 offset:7168
buffer_load_dwordx4 v[56:59], v140, s[40:43], s48 offen offset:0 sc1
v_mfma_f32_32x32x16_bf16 a[16:31], v[132:135], v[68:71], a[16:31]
ds_read_b64_tr_b16 v[100:101], v139 offset:6144
ds_read_b64_tr_b16 v[102:103], v139 offset:7168
buffer_load_dwordx4 v[60:63], v140, s[40:43], s48 offen offset:1024 sc1
s_sub_u32 s50, s50, 8
s_mov_b32 s52, s58
s_cmp_gt_u32 s50, 24
s_cbranch_scc1 .LgD_371
.LgB_372:
s_waitcnt lgkmcnt(8)
v_mfma_f32_32x32x16_bf16 a[0:15], v[72:75], v[8:11], a[0:15]
s_waitcnt vmcnt(8)
s_barrier
ds_read_b64_tr_b16 v[104:105], v138 offset:8192
ds_read_b64_tr_b16 v[106:107], v138 offset:9216
v_mfma_f32_32x32x16_bf16 a[16:31], v[76:79], v[8:11], a[16:31]
ds_read_b64_tr_b16 v[108:109], v139 offset:8192
ds_read_b64_tr_b16 v[110:111], v139 offset:9216
buffer_load_dwordx4 v[64:67], v140, s[40:43], s48 offen offset:2048 sc1
v_mfma_f32_32x32x16_bf16 a[0:15], v[80:83], v[12:15], a[0:15]
ds_read_b64_tr_b16 v[112:113], v138 offset:10240
ds_read_b64_tr_b16 v[114:115], v138 offset:11264
buffer_load_dwordx4 v[68:71], v140, s[40:43], s48 offen offset:3072 sc1
s_add_u32 s48, s48, 4096
v_mfma_f32_32x32x16_bf16 a[16:31], v[84:87], v[12:15], a[16:31]
ds_read_b64_tr_b16 v[116:117], v139 offset:10240
ds_read_b64_tr_b16 v[118:119], v139 offset:11264
s_cmp_eq_u32 s50, 8
s_cselect_b32 s42, 0, s42
s_waitcnt lgkmcnt(8)
v_mfma_f32_32x32x16_bf16 a[0:15], v[88:91], v[16:19], a[0:15]
s_waitcnt vmcnt(8)
s_barrier
ds_read_b64_tr_b16 v[120:121], v138 offset:12288
ds_read_b64_tr_b16 v[122:123], v138 offset:13312
v_mfma_f32_32x32x16_bf16 a[16:31], v[92:95], v[16:19], a[16:31]
ds_read_b64_tr_b16 v[124:125], v139 offset:12288
ds_read_b64_tr_b16 v[126:127], v139 offset:13312
buffer_load_dwordx4 v[8:11], v140, s[40:43], s48 offen offset:0 sc1
v_mfma_f32_32x32x16_bf16 a[0:15], v[96:99], v[20:23], a[0:15]
ds_read_b64_tr_b16 v[128:129], v138 offset:14336
ds_read_b64_tr_b16 v[130:131], v138 offset:15360
buffer_load_dwordx4 v[12:15], v140, s[40:43], s48 offen offset:1024 sc1
v_mfma_f32_32x32x16_bf16 a[16:31], v[100:103], v[20:23], a[16:31]
ds_read_b64_tr_b16 v[132:133], v139 offset:14336
ds_read_b64_tr_b16 v[134:135], v139 offset:15360
s_waitcnt lgkmcnt(8)
v_mfma_f32_32x32x16_bf16 a[0:15], v[104:107], v[24:27], a[0:15]
s_waitcnt vmcnt(8)
s_barrier
ds_read_b64_tr_b16 v[72:73], v138 offset:16384
ds_read_b64_tr_b16 v[74:75], v138 offset:17408
v_mfma_f32_32x32x16_bf16 a[16:31], v[108:111], v[24:27], a[16:31]
ds_read_b64_tr_b16 v[76:77], v139 offset:16384
ds_read_b64_tr_b16 v[78:79], v139 offset:17408
buffer_load_dwordx4 v[16:19], v140, s[40:43], s48 offen offset:2048 sc1
v_mfma_f32_32x32x16_bf16 a[0:15], v[112:115], v[28:31], a[0:15]
ds_read_b64_tr_b16 v[80:81], v138 offset:18432
ds_read_b64_tr_b16 v[82:83], v138 offset:19456
buffer_load_dwordx4 v[20:23], v140, s[40:43], s48 offen offset:3072 sc1
s_add_u32 s48, s48, 4096
v_mfma_f32_32x32x16_bf16 a[16:31], v[116:119], v[28:31], a[16:31]
ds_read_b64_tr_b16 v[84:85], v139 offset:18432
ds_read_b64_tr_b16 v[86:87], v139 offset:19456
s_waitcnt lgkmcnt(8)
v_mfma_f32_32x32x16_bf16 a[0:15], v[120:123], v[32:35], a[0:15]
s_waitcnt vmcnt(8)
s_barrier
ds_read_b64_tr_b16 v[88:89], v138 offset:20480
ds_read_b64_tr_b16 v[90:91], v138 offset:21504
v_mfma_f32_32x32x16_bf16 a[16:31], v[124:127], v[32:35], a[16:31]
ds_read_b64_tr_b16 v[92:93], v139 offset:20480
ds_read_b64_tr_b16 v[94:95], v139 offset:21504
buffer_load_dwordx4 v[24:27], v140, s[40:43], s48 offen offset:0 sc1
v_mfma_f32_32x32x16_bf16 a[0:15], v[128:131], v[36:39], a[0:15]
ds_read_b64_tr_b16 v[96:97], v138 offset:22528
ds_read_b64_tr_b16 v[98:99], v138 offset:23552
buffer_load_dwordx4 v[28:31], v140, s[40:43], s48 offen offset:1024 sc1
v_mfma_f32_32x32x16_bf16 a[16:31], v[132:135], v[36:39], a[16:31]
ds_read_b64_tr_b16 v[100:101], v139 offset:22528
ds_read_b64_tr_b16 v[102:103], v139 offset:23552
s_waitcnt lgkmcnt(8)
v_mfma_f32_32x32x16_bf16 a[0:15], v[72:75], v[40:43], a[0:15]
s_waitcnt vmcnt(8)
s_barrier
ds_read_b64_tr_b16 v[104:105], v138 offset:24576
ds_read_b64_tr_b16 v[106:107], v138 offset:25600
v_mfma_f32_32x32x16_bf16 a[16:31], v[76:79], v[40:43], a[16:31]
ds_read_b64_tr_b16 v[108:109], v139 offset:24576
ds_read_b64_tr_b16 v[110:111], v139 offset:25600
buffer_load_dwordx4 v[32:35], v140, s[40:43], s48 offen offset:2048 sc1
v_mfma_f32_32x32x16_bf16 a[0:15], v[80:83], v[44:47], a[0:15]
ds_read_b64_tr_b16 v[112:113], v138 offset:26624
ds_read_b64_tr_b16 v[114:115], v138 offset:27648
buffer_load_dwordx4 v[36:39], v140, s[40:43], s48 offen offset:3072 sc1
s_add_u32 s48, s48, 4096
v_mfma_f32_32x32x16_bf16 a[16:31], v[84:87], v[44:47], a[16:31]
ds_read_b64_tr_b16 v[116:117], v139 offset:26624
ds_read_b64_tr_b16 v[118:119], v139 offset:27648
s_waitcnt lgkmcnt(8)
v_mfma_f32_32x32x16_bf16 a[0:15], v[88:91], v[48:51], a[0:15]
s_waitcnt vmcnt(8)
s_barrier
ds_read_b64_tr_b16 v[120:121], v138 offset:28672
ds_read_b64_tr_b16 v[122:123], v138 offset:29696
v_mfma_f32_32x32x16_bf16 a[16:31], v[92:95], v[48:51], a[16:31]
ds_read_b64_tr_b16 v[124:125], v139 offset:28672
ds_read_b64_tr_b16 v[126:127], v139 offset:29696
buffer_load_dwordx4 v[40:43], v140, s[40:43], s48 offen offset:0 sc1
v_mfma_f32_32x32x16_bf16 a[0:15], v[96:99], v[52:55], a[0:15]
ds_read_b64_tr_b16 v[128:129], v138 offset:30720
ds_read_b64_tr_b16 v[130:131], v138 offset:31744
buffer_load_dwordx4 v[44:47], v140, s[40:43], s48 offen offset:1024 sc1
v_mfma_f32_32x32x16_bf16 a[16:31], v[100:103], v[52:55], a[16:31]
ds_read_b64_tr_b16 v[132:133], v139 offset:30720
ds_read_b64_tr_b16 v[134:135], v139 offset:31744
s_waitcnt lgkmcnt(8)
v_mfma_f32_32x32x16_bf16 a[0:15], v[104:107], v[56:59], a[0:15]
s_waitcnt vmcnt(8)
s_barrier
s_add_u32 s58, s51, s56
s_add_u32 s51, s51, 32768
s_cmp_eq_u32 s51, 131072
s_cselect_b32 s51, 0, s51
v_add_u32 v138, s51, v136
v_add_u32 v139, s51, v137
ds_read_b64_tr_b16 v[72:73], v138 offset:0
ds_read_b64_tr_b16 v[74:75], v138 offset:1024
v_mfma_f32_32x32x16_bf16 a[16:31], v[108:111], v[56:59], a[16:31]
ds_read_b64_tr_b16 v[76:77], v139 offset:0
ds_read_b64_tr_b16 v[78:79], v139 offset:1024
buffer_load_dwordx4 v[48:51], v140, s[40:43], s48 offen offset:2048 sc1
v_mfma_f32_32x32x16_bf16 a[0:15], v[112:115], v[60:63], a[0:15]
ds_read_b64_tr_b16 v[80:81], v138 offset:2048
ds_read_b64_tr_b16 v[82:83], v138 offset:3072
buffer_load_dwordx4 v[52:55], v140, s[40:43], s48 offen offset:3072 sc1
s_add_u32 s48, s48, 4096
v_mfma_f32_32x32x16_bf16 a[16:31], v[116:119], v[60:63], a[16:31]
ds_read_b64_tr_b16 v[84:85], v139 offset:2048
ds_read_b64_tr_b16 v[86:87], v139 offset:3072
s_waitcnt lgkmcnt(8)
v_mfma_f32_32x32x16_bf16 a[0:15], v[120:123], v[64:67], a[0:15]
s_waitcnt vmcnt(8)
s_barrier
ds_read_b64_tr_b16 v[88:89], v138 offset:4096
ds_read_b64_tr_b16 v[90:91], v138 offset:5120
v_mfma_f32_32x32x16_bf16 a[16:31], v[124:127], v[64:67], a[16:31]
ds_read_b64_tr_b16 v[92:93], v139 offset:4096
ds_read_b64_tr_b16 v[94:95], v139 offset:5120
buffer_load_dwordx4 v[56:59], v140, s[40:43], s48 offen offset:0 sc1
v_mfma_f32_32x32x16_bf16 a[0:15], v[128:131], v[68:71], a[0:15]
ds_read_b64_tr_b16 v[96:97], v138 offset:6144
ds_read_b64_tr_b16 v[98:99], v138 offset:7168
buffer_load_dwordx4 v[60:63], v140, s[40:43], s48 offen offset:1024 sc1
v_mfma_f32_32x32x16_bf16 a[16:31], v[132:135], v[68:71], a[16:31]
ds_read_b64_tr_b16 v[100:101], v139 offset:6144
ds_read_b64_tr_b16 v[102:103], v139 offset:7168
s_sub_u32 s50, s50, 8
s_cmp_lg_u32 s50, 0
s_cbranch_scc1 .LgB_372
s_waitcnt vmcnt(0) lgkmcnt(0)
s_nop 15
s_add_u32 s57, s19, 0
v_accvgpr_read_b32 v196, a0
v_accvgpr_read_b32 v197, a1
v_accvgpr_read_b32 v198, a2
v_accvgpr_read_b32 v199, a3
v_accvgpr_read_b32 v200, a4
v_accvgpr_read_b32 v201, a5
v_accvgpr_read_b32 v202, a6
v_accvgpr_read_b32 v203, a7
v_cvt_pk_bf16_f32 v204, v196, v197
v_cvt_pk_bf16_f32 v205, v198, v199
v_cvt_pk_bf16_f32 v206, v200, v201
v_cvt_pk_bf16_f32 v207, v202, v203
v_lshlrev_b32 v196, 16, v204
v_and_b32 v197, 0xffff0000, v204
v_lshlrev_b32 v198, 16, v205
v_and_b32 v199, 0xffff0000, v205
v_lshlrev_b32 v200, 16, v206
v_and_b32 v201, 0xffff0000, v206
v_lshlrev_b32 v202, 16, v207
v_and_b32 v203, 0xffff0000, v207
v_mul_f32 v196, v196, v148
v_mul_f32 v197, v197, v149
v_mul_f32 v198, v198, v150
v_mul_f32 v199, v199, v151
v_mul_f32 v200, v200, v152
v_mul_f32 v201, v201, v153
v_mul_f32 v202, v202, v154
v_mul_f32 v203, v203, v155
v_cvt_pk_bf16_f32 v204, v196, v197
v_cvt_pk_bf16_f32 v205, v198, v199
v_cvt_pk_bf16_f32 v206, v200, v201
v_cvt_pk_bf16_f32 v207, v202, v203
v_lshlrev_b32 v196, 16, v204
v_and_b32 v197, 0xffff0000, v204
v_lshlrev_b32 v204, 16, v180
v_and_b32 v180, 0xffff0000, v180
v_lshlrev_b32 v198, 16, v205
v_and_b32 v199, 0xffff0000, v205
v_lshlrev_b32 v205, 16, v181
v_and_b32 v181, 0xffff0000, v181
v_lshlrev_b32 v200, 16, v206
v_and_b32 v201, 0xffff0000, v206
v_lshlrev_b32 v206, 16, v182
v_and_b32 v182, 0xffff0000, v182
v_lshlrev_b32 v202, 16, v207
v_and_b32 v203, 0xffff0000, v207
v_lshlrev_b32 v207, 16, v183
v_and_b32 v183, 0xffff0000, v183
v_add_f32 v196, v196, v204
v_add_f32 v197, v197, v180
v_add_f32 v198, v198, v205
v_add_f32 v199, v199, v181
v_add_f32 v200, v200, v206
v_add_f32 v201, v201, v182
v_add_f32 v202, v202, v207
v_add_f32 v203, v203, v183
v_cvt_pk_bf16_f32 v180, v196, v197
v_cvt_pk_bf16_f32 v181, v198, v199
v_cvt_pk_bf16_f32 v182, v200, v201
v_cvt_pk_bf16_f32 v183, v202, v203
s_nop 0
v_permlane32_swap_b32 v180, v182
v_permlane32_swap_b32 v181, v183
buffer_store_dwordx4 v[180:183], v6, s[28:31], s57 offen offset:0
v_accvgpr_read_b32 v196, a8
v_accvgpr_read_b32 v197, a9
v_accvgpr_read_b32 v198, a10
v_accvgpr_read_b32 v199, a11
v_accvgpr_read_b32 v200, a12
v_accvgpr_read_b32 v201, a13
v_accvgpr_read_b32 v202, a14
v_accvgpr_read_b32 v203, a15
v_cvt_pk_bf16_f32 v204, v196, v197
v_cvt_pk_bf16_f32 v205, v198, v199
v_cvt_pk_bf16_f32 v206, v200, v201
v_cvt_pk_bf16_f32 v207, v202, v203
v_lshlrev_b32 v196, 16, v204
v_and_b32 v197, 0xffff0000, v204
v_lshlrev_b32 v198, 16, v205
v_and_b32 v199, 0xffff0000, v205
v_lshlrev_b32 v200, 16, v206
v_and_b32 v201, 0xffff0000, v206
v_lshlrev_b32 v202, 16, v207
v_and_b32 v203, 0xffff0000, v207
v_mul_f32 v196, v196, v156
v_mul_f32 v197, v197, v157
v_mul_f32 v198, v198, v158
v_mul_f32 v199, v199, v159
v_mul_f32 v200, v200, v160
v_mul_f32 v201, v201, v161
v_mul_f32 v202, v202, v162
v_mul_f32 v203, v203, v163
v_cvt_pk_bf16_f32 v204, v196, v197
v_cvt_pk_bf16_f32 v205, v198, v199
v_cvt_pk_bf16_f32 v206, v200, v201
v_cvt_pk_bf16_f32 v207, v202, v203
v_lshlrev_b32 v196, 16, v204
v_and_b32 v197, 0xffff0000, v204
v_lshlrev_b32 v204, 16, v184
v_and_b32 v184, 0xffff0000, v184
v_lshlrev_b32 v198, 16, v205
v_and_b32 v199, 0xffff0000, v205
v_lshlrev_b32 v205, 16, v185
v_and_b32 v185, 0xffff0000, v185
v_lshlrev_b32 v200, 16, v206
v_and_b32 v201, 0xffff0000, v206
v_lshlrev_b32 v206, 16, v186
v_and_b32 v186, 0xffff0000, v186
v_lshlrev_b32 v202, 16, v207
v_and_b32 v203, 0xffff0000, v207
v_lshlrev_b32 v207, 16, v187
v_and_b32 v187, 0xffff0000, v187
v_add_f32 v196, v196, v204
v_add_f32 v197, v197, v184
v_add_f32 v198, v198, v205
v_add_f32 v199, v199, v185
v_add_f32 v200, v200, v206
v_add_f32 v201, v201, v186
v_add_f32 v202, v202, v207
v_add_f32 v203, v203, v187
v_cvt_pk_bf16_f32 v184, v196, v197
v_cvt_pk_bf16_f32 v185, v198, v199
v_cvt_pk_bf16_f32 v186, v200, v201
v_cvt_pk_bf16_f32 v187, v202, v203
s_nop 0
v_permlane32_swap_b32 v184, v186
v_permlane32_swap_b32 v185, v187
buffer_store_dwordx4 v[184:187], v6, s[28:31], s57 offen offset:32
v_accvgpr_read_b32 v196, a16
v_accvgpr_read_b32 v197, a17
v_accvgpr_read_b32 v198, a18
v_accvgpr_read_b32 v199, a19
v_accvgpr_read_b32 v200, a20
v_accvgpr_read_b32 v201, a21
v_accvgpr_read_b32 v202, a22
v_accvgpr_read_b32 v203, a23
v_cvt_pk_bf16_f32 v204, v196, v197
v_cvt_pk_bf16_f32 v205, v198, v199
v_cvt_pk_bf16_f32 v206, v200, v201
v_cvt_pk_bf16_f32 v207, v202, v203
v_lshlrev_b32 v196, 16, v204
v_and_b32 v197, 0xffff0000, v204
v_lshlrev_b32 v198, 16, v205
v_and_b32 v199, 0xffff0000, v205
v_lshlrev_b32 v200, 16, v206
v_and_b32 v201, 0xffff0000, v206
v_lshlrev_b32 v202, 16, v207
v_and_b32 v203, 0xffff0000, v207
v_mul_f32 v196, v196, v164
v_mul_f32 v197, v197, v165
v_mul_f32 v198, v198, v166
v_mul_f32 v199, v199, v167
v_mul_f32 v200, v200, v168
v_mul_f32 v201, v201, v169
v_mul_f32 v202, v202, v170
v_mul_f32 v203, v203, v171
v_cvt_pk_bf16_f32 v204, v196, v197
v_cvt_pk_bf16_f32 v205, v198, v199
v_cvt_pk_bf16_f32 v206, v200, v201
v_cvt_pk_bf16_f32 v207, v202, v203
v_lshlrev_b32 v196, 16, v204
v_and_b32 v197, 0xffff0000, v204
v_lshlrev_b32 v204, 16, v188
v_and_b32 v188, 0xffff0000, v188
v_lshlrev_b32 v198, 16, v205
v_and_b32 v199, 0xffff0000, v205
v_lshlrev_b32 v205, 16, v189
v_and_b32 v189, 0xffff0000, v189
v_lshlrev_b32 v200, 16, v206
v_and_b32 v201, 0xffff0000, v206
v_lshlrev_b32 v206, 16, v190
v_and_b32 v190, 0xffff0000, v190
v_lshlrev_b32 v202, 16, v207
v_and_b32 v203, 0xffff0000, v207
v_lshlrev_b32 v207, 16, v191
v_and_b32 v191, 0xffff0000, v191
v_add_f32 v196, v196, v204
v_add_f32 v197, v197, v188
v_add_f32 v198, v198, v205
v_add_f32 v199, v199, v189
v_add_f32 v200, v200, v206
v_add_f32 v201, v201, v190
v_add_f32 v202, v202, v207
v_add_f32 v203, v203, v191
v_cvt_pk_bf16_f32 v188, v196, v197
v_cvt_pk_bf16_f32 v189, v198, v199
v_cvt_pk_bf16_f32 v190, v200, v201
v_cvt_pk_bf16_f32 v191, v202, v203
s_nop 0
v_permlane32_swap_b32 v188, v190
v_permlane32_swap_b32 v189, v191
buffer_store_dwordx4 v[188:191], v6, s[28:31], s57 offen offset:64
v_accvgpr_read_b32 v196, a24
v_accvgpr_read_b32 v197, a25
v_accvgpr_read_b32 v198, a26
v_accvgpr_read_b32 v199, a27
v_accvgpr_read_b32 v200, a28
v_accvgpr_read_b32 v201, a29
v_accvgpr_read_b32 v202, a30
v_accvgpr_read_b32 v203, a31
v_cvt_pk_bf16_f32 v204, v196, v197
v_cvt_pk_bf16_f32 v205, v198, v199
v_cvt_pk_bf16_f32 v206, v200, v201
v_cvt_pk_bf16_f32 v207, v202, v203
v_lshlrev_b32 v196, 16, v204
v_and_b32 v197, 0xffff0000, v204
v_lshlrev_b32 v198, 16, v205
v_and_b32 v199, 0xffff0000, v205
v_lshlrev_b32 v200, 16, v206
v_and_b32 v201, 0xffff0000, v206
v_lshlrev_b32 v202, 16, v207
v_and_b32 v203, 0xffff0000, v207
v_mul_f32 v196, v196, v172
v_mul_f32 v197, v197, v173
v_mul_f32 v198, v198, v174
v_mul_f32 v199, v199, v175
v_mul_f32 v200, v200, v176
v_mul_f32 v201, v201, v177
v_mul_f32 v202, v202, v178
v_mul_f32 v203, v203, v179
v_cvt_pk_bf16_f32 v204, v196, v197
v_cvt_pk_bf16_f32 v205, v198, v199
v_cvt_pk_bf16_f32 v206, v200, v201
v_cvt_pk_bf16_f32 v207, v202, v203
v_lshlrev_b32 v196, 16, v204
v_and_b32 v197, 0xffff0000, v204
v_lshlrev_b32 v204, 16, v192
v_and_b32 v192, 0xffff0000, v192
v_lshlrev_b32 v198, 16, v205
v_and_b32 v199, 0xffff0000, v205
v_lshlrev_b32 v205, 16, v193
v_and_b32 v193, 0xffff0000, v193
v_lshlrev_b32 v200, 16, v206
v_and_b32 v201, 0xffff0000, v206
v_lshlrev_b32 v206, 16, v194
v_and_b32 v194, 0xffff0000, v194
v_lshlrev_b32 v202, 16, v207
v_and_b32 v203, 0xffff0000, v207
v_lshlrev_b32 v207, 16, v195
v_and_b32 v195, 0xffff0000, v195
v_add_f32 v196, v196, v204
v_add_f32 v197, v197, v192
v_add_f32 v198, v198, v205
v_add_f32 v199, v199, v193
v_add_f32 v200, v200, v206
v_add_f32 v201, v201, v194
v_add_f32 v202, v202, v207
v_add_f32 v203, v203, v195
v_cvt_pk_bf16_f32 v192, v196, v197
v_cvt_pk_bf16_f32 v193, v198, v199
v_cvt_pk_bf16_f32 v194, v200, v201
v_cvt_pk_bf16_f32 v195, v202, v203
s_nop 0
v_permlane32_swap_b32 v192, v194
v_permlane32_swap_b32 v193, v195
buffer_store_dwordx4 v[192:195], v6, s[28:31], s57 offen offset:96
s_add_u32 s78, s78, 4
s_cmp_lt_u32 s78, 6
s_cbranch_scc1 .Lbl_343
s_cmp_ge_u32 s78, 8
s_cbranch_scc1 .Ldone_373
s_sub_u32 s87, s76, 1
s_mov_b32 s78, 6
s_cmp_lg_u32 s3, 0
s_cbranch_scc1 .Lws_374
s_mov_b32 s86, 5120
s_bfe_u32 s82, s87, 0x10000
s_mul_i32 s82, s82, 256
s_add_u32 s86, s86, s82
s_bfe_u32 s82, s77, 0x10001
s_mul_i32 s82, s82, 128
s_add_u32 s86, s86, s82
v_mov_b32 v1, s86
v_mov_b32 v2, 8
s_mov_b32 s81, 11008
v_writelane_b32 v1, s81, 1
v_writelane_b32 v2, 32, 1
s_mov_b64 exec, 3
.Lwl_375:
buffer_load_dword v3, v1, s[88:91], 0 offen sc1
s_waitcnt vmcnt(0)
v_cmp_lt_u32 vcc, v3, v2
s_cbranch_vccz .Lwo_376
s_cmp_eq_u32 s80, 0
s_cbranch_scc1 .Lwo_376
s_sub_u32 s80, s80, 1
s_branch .Lwl_375
.Lwo_376:
s_mov_b64 exec, -1
.Lws_374:
s_barrier
s_lshr_b32 s84, s77, 2
s_add_u32 s84, s84, 48
s_and_b32 s85, s77, 3
s_lshl_b32 s85, s85, 2
s_add_u32 s85, s85, s3
s_lshl_b32 s81, s87, 4
s_add_u32 s85, s85, s81
s_add_u32 s12, s4, 0x1000000
s_addc_u32 s13, s5, 0
s_mov_b32 s14, 0x5800000
s_mov_b32 s15, 0x00020000
s_lshl_b32 s16, s84, 18
s_lshl_b32 s17, s85, 13
s_add_u32 s16, s16, s17
s_add_u32 s17, s16, 16777216
s_add_u32 s18, s16, 33554432
s_add_u32 s19, s16, 50331648
s_lshl_b32 s20, s84, 16
s_lshl_b32 s21, s85, 11
s_add_u32 s20, s20, s21
s_add_u32 s21, s20, 88080384
s_add_u32 s20, s20, 83886080
v_lshlrev_b32 v8, 4, v0
v_add_u32 v9, 4096, v8
v_lshlrev_b32 v5, 3, v0
v_lshrrev_b32 v6, 5, v0
v_lshlrev_b32 v4, 7, v6
v_and_b32 v7, 7, v0
v_lshlrev_b32 v7, 4, v7
v_add_u32 v4, v4, v7
buffer_load_dwordx4 v[12:15], v8, s[12:15], s16 offen offset:0 sc1
buffer_load_dwordx4 v[44:47], v8, s[12:15], s17 offen offset:0 sc1
buffer_load_dwordx4 v[16:19], v8, s[12:15], s16 offen offset:1024 sc1
buffer_load_dwordx4 v[48:51], v8, s[12:15], s17 offen offset:1024 sc1
buffer_load_dwordx4 v[20:23], v8, s[12:15], s16 offen offset:2048 sc1
buffer_load_dwordx4 v[52:55], v8, s[12:15], s17 offen offset:2048 sc1
buffer_load_dwordx4 v[24:27], v8, s[12:15], s16 offen offset:3072 sc1
buffer_load_dwordx4 v[56:59], v8, s[12:15], s17 offen offset:3072 sc1
buffer_load_dwordx4 v[28:31], v9, s[12:15], s16 offen offset:0 sc1
buffer_load_dwordx4 v[60:63], v9, s[12:15], s17 offen offset:0 sc1
buffer_load_dwordx4 v[32:35], v9, s[12:15], s16 offen offset:1024 sc1
buffer_load_dwordx4 v[64:67], v9, s[12:15], s17 offen offset:1024 sc1
buffer_load_dwordx4 v[36:39], v9, s[12:15], s16 offen offset:2048 sc1
buffer_load_dwordx4 v[68:71], v9, s[12:15], s17 offen offset:2048 sc1
buffer_load_dwordx4 v[40:43], v9, s[12:15], s16 offen offset:3072 sc1
buffer_load_dwordx4 v[72:75], v9, s[12:15], s17 offen offset:3072 sc1
buffer_load_dwordx4 v[108:111], v8, s[12:15], s18 offen offset:0 sc1
buffer_load_dwordx4 v[112:115], v8, s[12:15], s18 offen offset:1024 sc1
buffer_load_dwordx4 v[116:119], v8, s[12:15], s18 offen offset:2048 sc1
buffer_load_dwordx4 v[120:123], v8, s[12:15], s18 offen offset:3072 sc1
buffer_load_dwordx4 v[124:127], v9, s[12:15], s18 offen offset:0 sc1
buffer_load_dwordx4 v[128:131], v9, s[12:15], s18 offen offset:1024 sc1
buffer_load_dwordx4 v[132:135], v9, s[12:15], s18 offen offset:2048 sc1
buffer_load_dwordx4 v[136:139], v9, s[12:15], s18 offen offset:3072 sc1
s_mov_b32 s86, 9216
s_bfe_u32 s82, s87, 0x10000
s_mul_i32 s82, s82, 256
s_add_u32 s86, s86, s82
s_bfe_u32 s82, s77, 0x10001
s_mul_i32 s82, s82, 128
s_add_u32 s86, s86, s82
s_cmp_lg_u32 s3, 0
s_cbranch_scc1 .Lws_377
v_mul_u32_u24 v1, 0, v0
v_add_u32 v1, s86, v1
v_mov_b32 v2, 32
s_mov_b64 exec, 1
.Lwl_378:
buffer_load_dword v3, v1, s[88:91], 0 offen sc1
s_waitcnt vmcnt(0)
v_cmp_lt_u32 vcc, v3, v2
s_cbranch_vccz .Lwo_379
s_cmp_eq_u32 s80, 0
s_cbranch_scc1 .Lwo_379
s_sub_u32 s80, s80, 1
s_branch .Lwl_378
.Lwo_379:
s_mov_b64 exec, -1
.Lws_377:
s_barrier
s_mov_b32 exec_lo, 0xff
s_mov_b32 exec_hi, 0xff
buffer_load_dwordx4 v[76:79], v4, s[12:15], s20 offen offset:0 sc1
buffer_load_dwordx4 v[80:83], v4, s[12:15], s20 offen offset:256 sc1
buffer_load_dwordx4 v[84:87], v4, s[12:15], s20 offen offset:512 sc1
buffer_load_dwordx4 v[88:91], v4, s[12:15], s20 offen offset:768 sc1
buffer_load_dwordx4 v[92:95], v4, s[12:15], s20 offen offset:1024 sc1
buffer_load_dwordx4 v[96:99], v4, s[12:15], s20 offen offset:1280 sc1
buffer_load_dwordx4 v[100:103], v4, s[12:15], s20 offen offset:1536 sc1
buffer_load_dwordx4 v[104:107], v4, s[12:15], s20 offen offset:1792 sc1
s_mov_b64 exec, -1
buffer_load_dwordx2 v[140:141], v5, s[12:15], s21 offen offset:0 sc1
v_mov_b32 v142, 0
v_mov_b32 v143, 0
buffer_load_dwordx2 v[144:145], v5, s[12:15], s21 offen offset:512 sc1
v_mov_b32 v146, 0
v_mov_b32 v147, 0
buffer_load_dwordx2 v[148:149], v5, s[12:15], s21 offen offset:1024 sc1
v_mov_b32 v150, 0
v_mov_b32 v151, 0
buffer_load_dwordx2 v[152:153], v5, s[12:15], s21 offen offset:1536 sc1
v_mov_b32 v154, 0
v_mov_b32 v155, 0
v_and_b32 v7, 31, v0
v_lshlrev_b32 v6, 2, v6
v_sub_u32 v7, v7, v6
s_waitcnt vmcnt(34)
v_mfma_f32_32x32x16_bf16 v[156:171], v[44:47], v[12:15], 0
s_waitcnt vmcnt(32)
v_mfma_f32_32x32x16_bf16 v[156:171], v[48:51], v[16:19], v[156:171]
s_waitcnt vmcnt(30)
v_mfma_f32_32x32x16_bf16 v[156:171], v[52:55], v[20:23], v[156:171]
s_waitcnt vmcnt(28)
v_mfma_f32_32x32x16_bf16 v[156:171], v[56:59], v[24:27], v[156:171]
s_waitcnt vmcnt(26)
v_mfma_f32_32x32x16_bf16 v[156:171], v[60:63], v[28:31], v[156:171]
s_waitcnt vmcnt(24)
v_mfma_f32_32x32x16_bf16 v[156:171], v[64:67], v[32:35], v[156:171]
s_waitcnt vmcnt(22)
v_mfma_f32_32x32x16_bf16 v[156:171], v[68:71], v[36:39], v[156:171]
s_waitcnt vmcnt(20)
v_mfma_f32_32x32x16_bf16 v[156:171], v[72:75], v[40:43], v[156:171]
s_waitcnt vmcnt(4)
v_mfma_f32_32x32x16_bf16 v[172:187], v[76:79], v[12:15], 0
v_mfma_f32_32x32x16_bf16 v[172:187], v[80:83], v[16:19], v[172:187]
v_mfma_f32_32x32x16_bf16 v[172:187], v[84:87], v[20:23], v[172:187]
v_mfma_f32_32x32x16_bf16 v[172:187], v[88:91], v[24:27], v[172:187]
v_mfma_f32_32x32x16_bf16 v[172:187], v[92:95], v[28:31], v[172:187]
v_mfma_f32_32x32x16_bf16 v[172:187], v[96:99], v[32:35], v[172:187]
v_mfma_f32_32x32x16_bf16 v[172:187], v[100:103], v[36:39], v[172:187]
v_mfma_f32_32x32x16_bf16 v[172:187], v[104:107], v[40:43], v[172:187]
s_nop 2
v_cvt_pk_bf16_f32 v188, v156, v157
v_cvt_pk_bf16_f32 v189, v158, v159
v_cvt_pk_bf16_f32 v190, v160, v161
v_cvt_pk_bf16_f32 v191, v162, v163
v_cvt_pk_bf16_f32 v192, v164, v165
v_cvt_pk_bf16_f32 v193, v166, v167
v_cvt_pk_bf16_f32 v194, v168, v169
v_cvt_pk_bf16_f32 v195, v170, v171
s_nop 0
v_cvt_pk_bf16_f32 v196, v172, v173
v_cvt_pk_bf16_f32 v197, v174, v175
v_lshlrev_b32 v156, 16, v188
v_and_b32 v157, 0xffff0000, v188
v_lshlrev_b32 v158, 16, v189
v_and_b32 v159, 0xffff0000, v189
v_lshlrev_b32 v160, 16, v190
v_and_b32 v161, 0xffff0000, v190
v_lshlrev_b32 v162, 16, v191
v_and_b32 v163, 0xffff0000, v191
v_lshlrev_b32 v164, 16, v192
v_and_b32 v165, 0xffff0000, v192
v_lshlrev_b32 v166, 16, v193
v_and_b32 v167, 0xffff0000, v193
v_lshlrev_b32 v168, 16, v194
v_and_b32 v169, 0xffff0000, v194
v_lshlrev_b32 v170, 16, v195
v_and_b32 v171, 0xffff0000, v195
v_lshlrev_b32 v172, 16, v196
v_and_b32 v173, 0xffff0000, v196
v_lshlrev_b32 v174, 16, v197
v_and_b32 v175, 0xffff0000, v197
v_mul_f32 v156, 0x3db504f3, v156
v_mul_f32 v157, 0x3db504f3, v157
v_mul_f32 v158, 0x3db504f3, v158
v_mul_f32 v159, 0x3db504f3, v159
v_mul_f32 v160, 0x3db504f3, v160
v_mul_f32 v161, 0x3db504f3, v161
v_mul_f32 v162, 0x3db504f3, v162
v_mul_f32 v163, 0x3db504f3, v163
v_mul_f32 v164, 0x3db504f3, v164
v_mul_f32 v165, 0x3db504f3, v165
v_mul_f32 v166, 0x3db504f3, v166
v_mul_f32 v167, 0x3db504f3, v167
v_mul_f32 v168, 0x3db504f3, v168
v_mul_f32 v169, 0x3db504f3, v169
v_mul_f32 v170, 0x3db504f3, v170
v_mul_f32 v171, 0x3db504f3, v171
v_mul_f32 v172, 0x3db504f3, v172
v_mul_f32 v173, 0x3db504f3, v173
v_mul_f32 v174, 0x3db504f3, v174
v_mul_f32 v175, 0x3db504f3, v175
v_cvt_pk_bf16_f32 v188, v156, v157
v_cvt_pk_bf16_f32 v189, v158, v159
v_cvt_pk_bf16_f32 v190, v160, v161
v_cvt_pk_bf16_f32 v191, v162, v163
v_cvt_pk_bf16_f32 v192, v164, v165
v_cvt_pk_bf16_f32 v193, v166, v167
v_cvt_pk_bf16_f32 v194, v168, v169
v_cvt_pk_bf16_f32 v195, v170, v171
v_cvt_pk_bf16_f32 v196, v172, v173
v_cvt_pk_bf16_f32 v197, v174, v175
v_lshlrev_b32 v156, 16, v188
v_and_b32 v157, 0xffff0000, v188
v_lshlrev_b32 v158, 16, v189
v_and_b32 v159, 0xffff0000, v189
v_lshlrev_b32 v160, 16, v190
v_and_b32 v161, 0xffff0000, v190
v_lshlrev_b32 v162, 16, v191
v_and_b32 v163, 0xffff0000, v191
v_lshlrev_b32 v164, 16, v192
v_and_b32 v165, 0xffff0000, v192
v_lshlrev_b32 v166, 16, v193
v_and_b32 v167, 0xffff0000, v193
v_lshlrev_b32 v168, 16, v194
v_and_b32 v169, 0xffff0000, v194
v_lshlrev_b32 v170, 16, v195
v_and_b32 v171, 0xffff0000, v195
v_lshlrev_b32 v172, 16, v196
v_and_b32 v173, 0xffff0000, v196
v_lshlrev_b32 v174, 16, v197
v_and_b32 v175, 0xffff0000, v197
v_mov_b32 v6, 0xff800000
v_cmp_le_i32 s[24:25], 0, v7
v_cmp_le_i32 s[26:27], 1, v7
v_cmp_le_i32 s[28:29], 2, v7
v_cmp_le_i32 s[30:31], 3, v7
v_cndmask_b32 v156, v6, v156, s[24:25]
v_cndmask_b32 v157, v6, v157, s[26:27]
v_cndmask_b32 v158, v6, v158, s[28:29]
v_cndmask_b32 v159, v6, v159, s[30:31]
v_cmp_le_i32 s[24:25], 8, v7
v_cmp_le_i32 s[26:27], 9, v7
v_cmp_le_i32 s[28:29], 10, v7
v_cmp_le_i32 s[30:31], 11, v7
v_cndmask_b32 v160, v6, v160, s[24:25]
v_cndmask_b32 v161, v6, v161, s[26:27]
v_cndmask_b32 v162, v6, v162, s[28:29]
v_cndmask_b32 v163, v6, v163, s[30:31]
v_cmp_le_i32 s[24:25], 16, v7
v_cmp_le_i32 s[26:27], 17, v7
v_cmp_le_i32 s[28:29], 18, v7
v_cmp_le_i32 s[30:31], 19, v7
v_cndmask_b32 v164, v6, v164, s[24:25]
v_cndmask_b32 v165, v6, v165, s[26:27]
v_cndmask_b32 v166, v6, v166, s[28:29]
v_cndmask_b32 v167, v6, v167, s[30:31]
v_cmp_le_i32 s[24:25], 24, v7
v_cmp_le_i32 s[26:27], 25, v7
v_cmp_le_i32 s[28:29], 26, v7
v_cmp_le_i32 s[30:31], 27, v7
v_cndmask_b32 v168, v6, v168, s[24:25]
v_cndmask_b32 v169, v6, v169, s[26:27]
v_cndmask_b32 v170, v6, v170, s[28:29]
v_cndmask_b32 v171, v6, v171, s[30:31]
v_max3_f32 v188, v156, v157, v158
v_max3_f32 v189, v159, v160, v161
v_max3_f32 v188, v188, v162, v163
v_max3_f32 v189, v189, v164, v165
v_max3_f32 v188, v188, v166, v167
v_max3_f32 v189, v189, v168, v169
v_max3_f32 v188, v188, v170, v171
v_max3_f32 v189, v189, v172, v173
v_max3_f32 v188, v188, v174, v175
v_max_f32 v188, v188, v189
v_mov_b32 v189, v188
s_nop 1
v_permlane32_swap_b32 v188, v189
v_max_f32 v188, v188, v189
v_mul_f32 v188, 0xbfb8aa3b, v188
s_mov_b32 s22, 0x3fb8aa3b
v_fma_f32 v156, v156, s22, v188
v_fma_f32 v157, v157, s22, v188
v_fma_f32 v158, v158, s22, v188
v_fma_f32 v159, v159, s22, v188
v_fma_f32 v160, v160, s22, v188
v_fma_f32 v161, v161, s22, v188
v_fma_f32 v162, v162, s22, v188
v_fma_f32 v163, v163, s22, v188
v_fma_f32 v164, v164, s22, v188
v_fma_f32 v165, v165, s22, v188
v_fma_f32 v166, v166, s22, v188
v_fma_f32 v167, v167, s22, v188
v_fma_f32 v168, v168, s22, v188
v_fma_f32 v169, v169, s22, v188
v_fma_f32 v170, v170, s22, v188
v_fma_f32 v171, v171, s22, v188
v_fma_f32 v172, v172, s22, v188
v_fma_f32 v173, v173, s22, v188
v_fma_f32 v174, v174, s22, v188
v_fma_f32 v175, v175, s22, v188
v_exp_f32 v156, v156
v_exp_f32 v157, v157
v_exp_f32 v158, v158
v_exp_f32 v159, v159
v_exp_f32 v160, v160
v_exp_f32 v161, v161
v_exp_f32 v162, v162
v_exp_f32 v163, v163
v_exp_f32 v164, v164
v_exp_f32 v165, v165
v_exp_f32 v166, v166
v_exp_f32 v167, v167
v_exp_f32 v168, v168
v_exp_f32 v169, v169
v_exp_f32 v170, v170
v_exp_f32 v171, v171
v_exp_f32 v172, v172
v_exp_f32 v173, v173
v_exp_f32 v174, v174
v_exp_f32 v175, v175
v_add_f32 v188, v156, v157
v_add_f32 v189, v158, v159
v_add_f32 v188, v188, v160
v_add_f32 v189, v189, v161
v_add_f32 v188, v188, v162
v_add_f32 v189, v189, v163
v_add_f32 v188, v188, v164
v_add_f32 v189, v189, v165
v_add_f32 v188, v188, v166
v_add_f32 v189, v189, v167
v_add_f32 v188, v188, v168
v_add_f32 v189, v189, v169
v_add_f32 v188, v188, v170
v_add_f32 v189, v189, v171
v_add_f32 v188, v188, v172
v_add_f32 v189, v189, v173
v_add_f32 v188, v188, v174
v_add_f32 v189, v189, v175
v_add_f32 v188, v188, v189
v_mov_b32 v189, v188
s_nop 1
v_permlane32_swap_b32 v188, v189
v_add_f32 v188, v188, v189
v_rcp_f32 v188, v188
s_nop 0
v_mul_f32 v156, v156, v188
v_mul_f32 v157, v157, v188
v_mul_f32 v158, v158, v188
v_mul_f32 v159, v159, v188
v_mul_f32 v160, v160, v188
v_mul_f32 v161, v161, v188
v_mul_f32 v162, v162, v188
v_mul_f32 v163, v163, v188
v_mul_f32 v164, v164, v188
v_mul_f32 v165, v165, v188
v_mul_f32 v166, v166, v188
v_mul_f32 v167, v167, v188
v_mul_f32 v168, v168, v188
v_mul_f32 v169, v169, v188
v_mul_f32 v170, v170, v188
v_mul_f32 v171, v171, v188
v_mul_f32 v172, v172, v188
v_mul_f32 v173, v173, v188
v_mul_f32 v174, v174, v188
v_mul_f32 v175, v175, v188
v_cvt_pk_bf16_f32 v192, v156, v157
v_cvt_pk_bf16_f32 v193, v158, v159
v_cvt_pk_bf16_f32 v194, v160, v161
v_cvt_pk_bf16_f32 v195, v162, v163
v_cvt_pk_bf16_f32 v196, v164, v165
v_cvt_pk_bf16_f32 v197, v166, v167
v_cvt_pk_bf16_f32 v198, v168, v169
v_cvt_pk_bf16_f32 v199, v170, v171
v_cvt_pk_bf16_f32 v200, v172, v173
v_cvt_pk_bf16_f32 v201, v174, v175
v_mov_b32 v202, 0
v_mov_b32 v203, 0
s_waitcnt vmcnt(0)
v_mfma_f32_32x32x16_bf16 v[12:27], v[108:111], v[192:195], 0
v_mfma_f32_32x32x16_bf16 v[28:43], v[116:119], v[192:195], 0
v_mfma_f32_32x32x16_bf16 v[44:59], v[124:127], v[192:195], 0
v_mfma_f32_32x32x16_bf16 v[60:75], v[132:135], v[192:195], 0
v_mfma_f32_32x32x16_bf16 v[12:27], v[112:115], v[196:199], v[12:27]
v_mfma_f32_32x32x16_bf16 v[28:43], v[120:123], v[196:199], v[28:43]
v_mfma_f32_32x32x16_bf16 v[44:59], v[128:131], v[196:199], v[44:59]
v_mfma_f32_32x32x16_bf16 v[60:75], v[136:139], v[196:199], v[60:75]
v_mfma_f32_32x32x16_bf16 v[12:27], v[140:143], v[200:203], v[12:27]
v_mfma_f32_32x32x16_bf16 v[28:43], v[144:147], v[200:203], v[28:43]
v_mfma_f32_32x32x16_bf16 v[44:59], v[148:151], v[200:203], v[44:59]
v_mfma_f32_32x32x16_bf16 v[60:75], v[152:155], v[200:203], v[60:75]
s_nop 8
v_cvt_pk_bf16_f32 v76, v12, v13
v_cvt_pk_bf16_f32 v77, v14, v15
v_cvt_pk_bf16_f32 v78, v16, v17
v_cvt_pk_bf16_f32 v79, v18, v19
buffer_store_dwordx4 v[76:79], v8, s[12:15], s19 offen offset:0 sc1
v_cvt_pk_bf16_f32 v80, v20, v21
v_cvt_pk_bf16_f32 v81, v22, v23
v_cvt_pk_bf16_f32 v82, v24, v25
v_cvt_pk_bf16_f32 v83, v26, v27
buffer_store_dwordx4 v[80:83], v8, s[12:15], s19 offen offset:1024 sc1
v_cvt_pk_bf16_f32 v84, v28, v29
v_cvt_pk_bf16_f32 v85, v30, v31
v_cvt_pk_bf16_f32 v86, v32, v33
v_cvt_pk_bf16_f32 v87, v34, v35
buffer_store_dwordx4 v[84:87], v8, s[12:15], s19 offen offset:2048 sc1
v_cvt_pk_bf16_f32 v88, v36, v37
v_cvt_pk_bf16_f32 v89, v38, v39
v_cvt_pk_bf16_f32 v90, v40, v41
v_cvt_pk_bf16_f32 v91, v42, v43
buffer_store_dwordx4 v[88:91], v8, s[12:15], s19 offen offset:3072 sc1
v_cvt_pk_bf16_f32 v92, v44, v45
v_cvt_pk_bf16_f32 v93, v46, v47
v_cvt_pk_bf16_f32 v94, v48, v49
v_cvt_pk_bf16_f32 v95, v50, v51
buffer_store_dwordx4 v[92:95], v9, s[12:15], s19 offen offset:0 sc1
v_cvt_pk_bf16_f32 v96, v52, v53
v_cvt_pk_bf16_f32 v97, v54, v55
v_cvt_pk_bf16_f32 v98, v56, v57
v_cvt_pk_bf16_f32 v99, v58, v59
buffer_store_dwordx4 v[96:99], v9, s[12:15], s19 offen offset:1024 sc1
v_cvt_pk_bf16_f32 v100, v60, v61
v_cvt_pk_bf16_f32 v101, v62, v63
v_cvt_pk_bf16_f32 v102, v64, v65
v_cvt_pk_bf16_f32 v103, v66, v67
buffer_store_dwordx4 v[100:103], v9, s[12:15], s19 offen offset:2048 sc1
v_cvt_pk_bf16_f32 v104, v68, v69
v_cvt_pk_bf16_f32 v105, v70, v71
v_cvt_pk_bf16_f32 v106, v72, v73
v_cvt_pk_bf16_f32 v107, v74, v75
buffer_store_dwordx4 v[104:107], v9, s[12:15], s19 offen offset:3072 sc1
s_add_u32 s86, s70, 119570432
s_bfe_u32 s82, s77, 0x10004
s_mul_i32 s82, s82, 512
s_add_u32 s86, s86, s82
s_bfe_u32 s82, s87, 0x10000
s_mul_i32 s82, s82, 128
s_add_u32 s86, s86, s82
s_waitcnt vmcnt(0)
s_barrier
s_cmp_lg_u32 s3, 0
s_cbranch_scc1 .Lsg_380
v_mov_b32 v1, 1
v_mul_u32_u24 v2, 0, v0
s_mov_b64 exec, 1
buffer_atomic_add v1, v2, s[88:91], s86 offen sc1
s_mov_b64 exec, -1
.Lsg_380:
s_and_b32 s84, s77, 1
s_add_u32 s84, s84, 12
s_lshr_b32 s85, s77, 1
s_add_u32 s86, s70, 119570432
s_bfe_u32 s82, s77, 0x10000
s_mul_i32 s82, s82, 512
s_add_u32 s86, s86, s82
s_bfe_u32 s82, s87, 0x10000
s_mul_i32 s82, s82, 128
s_add_u32 s86, s86, s82
s_load_dwordx2 s[6:7], s[0:1], 40
s_add_u32 s40, s4, 0x4000000
s_addc_u32 s41, s5, 0
s_mov_b32 s42, 0x1000000
s_mov_b32 s43, 0x00020000
s_and_b32 s18, s85, 7
s_mov_b32 s19, 2048
s_cmp_eq_u32 s18, 3
s_cselect_b32 s19, 128, s19
v_lshrrev_b32 v142, 2, v0
v_and_b32 v142, 3, v142
v_lshrrev_b32 v143, 5, v0
v_lshlrev_b32 v143, 2, v143
v_add_u32 v143, v143, v142
v_mul_u32_u24 v143, 128, v143
v_and_b32 v144, 3, v0
v_lshlrev_b32 v144, 3, v144
v_add_u32 v143, v143, v144
v_and_b32 v144, 16, v0
v_lshlrev_b32 v144, 1, v144
v_add_u32 v143, v143, v144
v_lshrrev_b32 v142, 1, v142
s_and_b32 s53, s3, 0
s_mul_i32 s53, s53, 2
s_add_u32 s57, s53, 0
v_xor_b32 v144, s57, v142
v_lshlrev_b32 v144, 6, v144
v_add_u32 v136, v143, v144
s_add_u32 s57, s53, 1
v_xor_b32 v144, s57, v142
v_lshlrev_b32 v144, 6, v144
v_add_u32 v137, v143, v144
s_lshr_b32 s53, s3, 0
s_mul_i32 s53, s53, 262144
v_lshlrev_b32 v140, 4, v0
v_add_u32 v140, s53, v140
v_lshrrev_b32 v142, 3, v0
s_mul_i32 s53, s3, 8
v_add_u32 v142, s53, v142
v_and_b32 v143, 3, v142
v_lshrrev_b32 v143, 1, v143
v_and_b32 v144, 7, v0
v_lshrrev_b32 v144, 2, v144
v_xor_b32 v143, v143, v144
v_lshlrev_b32 v143, 6, v143
v_and_b32 v144, 3, v0
v_lshlrev_b32 v144, 4, v144
v_add_u32 v143, v143, v144
s_mov_b32 s53, s19
v_mul_lo_u32 v142, v142, s53
v_add_u32 v141, v142, v143
s_mul_i32 s54, s53, 32
s_lshl_b32 s56, s3, 10
s_waitcnt lgkmcnt(0)
s_mul_i32 s48, s84, 1048576
s_mul_i32 s49, s85, 128
s_mov_b32 s50, 128
s_add_u32 s16, s4, 113246208
s_addc_u32 s17, s5, 0
s_lshr_b32 s18, s85, 3
s_lshl_b32 s18, s18, 19
s_cmp_eq_u32 s19, 128
s_cselect_b32 s6, s16, s6
s_cselect_b32 s7, s17, s7
s_cselect_b32 s49, s18, s49
s_mul_i32 s18, s87, 64
s_mov_b32 s50, 64
s_lshl_b32 s16, s18, 11
s_add_u32 s48, s48, s16
s_mul_i32 s16, s18, s19
s_lshl_b32 s16, s16, 5
s_add_u32 s49, s49, s16
s_mov_b32 s44, s6
s_mov_b32 s45, s7
s_mov_b32 s46, 0x800000
s_mov_b32 s47, 0x00020000
s_add_u32 m0, s56, 0
s_nop 0
buffer_load_dwordx4 v141, s[44:47], s49 offen lds
s_add_u32 s49, s49, s54
s_add_u32 m0, s56, 4096
s_nop 0
buffer_load_dwordx4 v141, s[44:47], s49 offen lds
s_add_u32 s49, s49, s54
s_add_u32 m0, s56, 8192
s_nop 0
buffer_load_dwordx4 v141, s[44:47], s49 offen lds
s_add_u32 s49, s49, s54
s_add_u32 m0, s56, 12288
s_nop 0
buffer_load_dwordx4 v141, s[44:47], s49 offen lds
s_add_u32 s49, s49, s54
s_add_u32 m0, s56, 16384
s_nop 0
buffer_load_dwordx4 v141, s[44:47], s49 offen lds
s_add_u32 s49, s49, s54
s_add_u32 m0, s56, 20480
s_nop 0
buffer_load_dwordx4 v141, s[44:47], s49 offen lds
s_add_u32 s49, s49, s54
s_add_u32 m0, s56, 24576
s_nop 0
buffer_load_dwordx4 v141, s[44:47], s49 offen lds
s_add_u32 s49, s49, s54
s_add_u32 m0, s56, 28672
s_nop 0
buffer_load_dwordx4 v141, s[44:47], s49 offen lds
s_add_u32 s49, s49, s54
s_add_u32 m0, s56, 32768
s_nop 0
buffer_load_dwordx4 v141, s[44:47], s49 offen lds
s_add_u32 s49, s49, s54
s_add_u32 m0, s56, 36864
s_nop 0
buffer_load_dwordx4 v141, s[44:47], s49 offen lds
s_add_u32 s49, s49, s54
s_add_u32 m0, s56, 40960
s_nop 0
buffer_load_dwordx4 v141, s[44:47], s49 offen lds
s_add_u32 s49, s49, s54
s_add_u32 m0, s56, 45056
s_nop 0
buffer_load_dwordx4 v141, s[44:47], s49 offen lds
s_add_u32 s49, s49, s54
s_add_u32 m0, s56, 49152
s_nop 0
buffer_load_dwordx4 v141, s[44:47], s49 offen lds
s_add_u32 s49, s49, s54
s_add_u32 m0, s56, 53248
s_nop 0
buffer_load_dwordx4 v141, s[44:47], s49 offen lds
s_add_u32 s49, s49, s54
s_add_u32 m0, s56, 57344
s_nop 0
buffer_load_dwordx4 v141, s[44:47], s49 offen lds
s_add_u32 s49, s49, s54
s_add_u32 m0, s56, 61440
s_nop 0
buffer_load_dwordx4 v141, s[44:47], s49 offen lds
s_add_u32 s49, s49, s54
s_add_u32 m0, s56, 65536
s_nop 0
buffer_load_dwordx4 v141, s[44:47], s49 offen lds
s_add_u32 s49, s49, s54
s_add_u32 m0, s56, 69632
s_nop 0
buffer_load_dwordx4 v141, s[44:47], s49 offen lds
s_add_u32 s49, s49, s54
s_add_u32 m0, s56, 73728
s_nop 0
buffer_load_dwordx4 v141, s[44:47], s49 offen lds
s_add_u32 s49, s49, s54
s_add_u32 m0, s56, 77824
s_nop 0
buffer_load_dwordx4 v141, s[44:47], s49 offen lds
s_add_u32 s49, s49, s54
s_add_u32 m0, s56, 81920
s_nop 0
buffer_load_dwordx4 v141, s[44:47], s49 offen lds
s_add_u32 s49, s49, s54
s_add_u32 m0, s56, 86016
s_nop 0
buffer_load_dwordx4 v141, s[44:47], s49 offen lds
s_add_u32 s49, s49, s54
s_add_u32 m0, s56, 90112
s_nop 0
buffer_load_dwordx4 v141, s[44:47], s49 offen lds
s_add_u32 s49, s49, s54
s_add_u32 m0, s56, 94208
s_nop 0
buffer_load_dwordx4 v141, s[44:47], s49 offen lds
s_add_u32 s49, s49, s54
s_lshr_b32 s16, s3, 0
s_mul_i32 s16, s16, 1
s_mul_i32 s18, s84, 4
s_add_u32 s16, s16, s18
s_and_b32 s17, s3, 0
s_mul_i32 s17, s17, 4
s_mul_i32 s18, s85, 4
s_add_u32 s17, s17, s18
v_lshlrev_b32 v4, 4, v0
s_add_u32 s36, s4, 0x7400000
s_addc_u32 s37, s5, 0
s_mov_b32 s38, 0x200000
s_mov_b32 s39, 0x00020000
s_and_b32 s16, s16, 7
s_lshl_b32 s12, s16, 17
s_lshl_b32 s18, s17, 11
s_add_u32 s12, s12, s18
s_lshl_b32 s18, s87, 20
s_add_u32 s12, s12, s18
v_bfe_u32 v4, v0, 2, 3
v_lshlrev_b32 v4, 7, v4
v_lshrrev_b32 v5, 5, v0
v_lshl_add_u32 v4, v5, 6, v4
v_and_b32 v5, 3, v0
v_lshl_add_u32 v4, v5, 4, v4
s_cmp_lg_u32 s3, 0
s_cbranch_scc1 .Lws_381
v_mul_u32_u24 v1, 0, v0
v_add_u32 v1, s86, v1
v_mov_b32 v2, 16
s_mov_b64 exec, 1
.Lwl_382:
buffer_load_dword v3, v1, s[88:91], 0 offen sc1
s_waitcnt vmcnt(0)
v_cmp_lt_u32 vcc, v3, v2
s_cbranch_vccz .Lwo_383
s_cmp_eq_u32 s80, 0
s_cbranch_scc1 .Lwo_383
s_sub_u32 s80, s80, 1
s_branch .Lwl_382
.Lwo_383:
s_mov_b64 exec, -1
.Lws_381:
s_barrier
buffer_load_dwordx4 v[8:11], v140, s[40:43], s48 offen offset:0 sc1
buffer_load_dwordx4 v[12:15], v140, s[40:43], s48 offen offset:1024 sc1
buffer_load_dwordx4 v[16:19], v140, s[40:43], s48 offen offset:2048 sc1
buffer_load_dwordx4 v[20:23], v140, s[40:43], s48 offen offset:3072 sc1
s_add_u32 s48, s48, 4096
buffer_load_dwordx4 v[24:27], v140, s[40:43], s48 offen offset:0 sc1
buffer_load_dwordx4 v[28:31], v140, s[40:43], s48 offen offset:1024 sc1
buffer_load_dwordx4 v[32:35], v140, s[40:43], s48 offen offset:2048 sc1
buffer_load_dwordx4 v[36:39], v140, s[40:43], s48 offen offset:3072 sc1
s_add_u32 s48, s48, 4096
buffer_load_dwordx4 v[40:43], v140, s[40:43], s48 offen offset:0 sc1
buffer_load_dwordx4 v[44:47], v140, s[40:43], s48 offen offset:1024 sc1
buffer_load_dwordx4 v[48:51], v140, s[40:43], s48 offen offset:2048 sc1
buffer_load_dwordx4 v[52:55], v140, s[40:43], s48 offen offset:3072 sc1
s_add_u32 s48, s48, 4096
buffer_load_dwordx4 v[56:59], v140, s[40:43], s48 offen offset:0 sc1
buffer_load_dwordx4 v[60:63], v140, s[40:43], s48 offen offset:1024 sc1
v_accvgpr_write_b32 a0, 0
v_accvgpr_write_b32 a1, 0
v_accvgpr_write_b32 a2, 0
v_accvgpr_write_b32 a3, 0
v_accvgpr_write_b32 a4, 0
v_accvgpr_write_b32 a5, 0
v_accvgpr_write_b32 a6, 0
v_accvgpr_write_b32 a7, 0
v_accvgpr_write_b32 a8, 0
v_accvgpr_write_b32 a9, 0
v_accvgpr_write_b32 a10, 0
v_accvgpr_write_b32 a11, 0
v_accvgpr_write_b32 a12, 0
v_accvgpr_write_b32 a13, 0
v_accvgpr_write_b32 a14, 0
v_accvgpr_write_b32 a15, 0
v_accvgpr_write_b32 a16, 0
v_accvgpr_write_b32 a17, 0
v_accvgpr_write_b32 a18, 0
v_accvgpr_write_b32 a19, 0
v_accvgpr_write_b32 a20, 0
v_accvgpr_write_b32 a21, 0
v_accvgpr_write_b32 a22, 0
v_accvgpr_write_b32 a23, 0
v_accvgpr_write_b32 a24, 0
v_accvgpr_write_b32 a25, 0
v_accvgpr_write_b32 a26, 0
v_accvgpr_write_b32 a27, 0
v_accvgpr_write_b32 a28, 0
v_accvgpr_write_b32 a29, 0
v_accvgpr_write_b32 a30, 0
v_accvgpr_write_b32 a31, 0
s_waitcnt vmcnt(10)
s_barrier
s_mov_b32 s51, 0
s_add_u32 s52, s56, 98304
v_mov_b32 v138, v136
v_mov_b32 v139, v137
ds_read_b64_tr_b16 v[72:73], v138 offset:0
ds_read_b64_tr_b16 v[74:75], v138 offset:1024
ds_read_b64_tr_b16 v[76:77], v139 offset:0
ds_read_b64_tr_b16 v[78:79], v139 offset:1024
ds_read_b64_tr_b16 v[80:81], v138 offset:2048
ds_read_b64_tr_b16 v[82:83], v138 offset:3072
ds_read_b64_tr_b16 v[84:85], v139 offset:2048
ds_read_b64_tr_b16 v[86:87], v139 offset:3072
ds_read_b64_tr_b16 v[88:89], v138 offset:4096
ds_read_b64_tr_b16 v[90:91], v138 offset:5120
ds_read_b64_tr_b16 v[92:93], v139 offset:4096
ds_read_b64_tr_b16 v[94:95], v139 offset:5120
ds_read_b64_tr_b16 v[96:97], v138 offset:6144
ds_read_b64_tr_b16 v[98:99], v138 offset:7168
ds_read_b64_tr_b16 v[100:101], v139 offset:6144
ds_read_b64_tr_b16 v[102:103], v139 offset:7168
s_waitcnt lgkmcnt(8)
v_mfma_f32_32x32x16_bf16 a[0:15], v[72:75], v[8:11], a[0:15]
s_waitcnt vmcnt(8)
s_barrier
ds_read_b64_tr_b16 v[104:105], v138 offset:8192
ds_read_b64_tr_b16 v[106:107], v138 offset:9216
v_mfma_f32_32x32x16_bf16 a[16:31], v[76:79], v[8:11], a[16:31]
ds_read_b64_tr_b16 v[108:109], v139 offset:8192
ds_read_b64_tr_b16 v[110:111], v139 offset:9216
s_add_u32 m0, s52, 0
s_nop 0
buffer_load_dwordx4 v141, s[44:47], s49 offen lds
s_add_u32 s49, s49, s54
v_mfma_f32_32x32x16_bf16 a[0:15], v[80:83], v[12:15], a[0:15]
ds_read_b64_tr_b16 v[112:113], v138 offset:10240
ds_read_b64_tr_b16 v[114:115], v138 offset:11264
buffer_load_dwordx4 v[64:67], v140, s[40:43], s48 offen offset:2048 sc1
v_mfma_f32_32x32x16_bf16 a[16:31], v[84:87], v[12:15], a[16:31]
ds_read_b64_tr_b16 v[116:117], v139 offset:10240
ds_read_b64_tr_b16 v[118:119], v139 offset:11264
buffer_load_dwordx4 v[68:71], v140, s[40:43], s48 offen offset:3072 sc1
s_add_u32 s48, s48, 4096
s_waitcnt lgkmcnt(8)
v_mfma_f32_32x32x16_bf16 a[0:15], v[88:91], v[16:19], a[0:15]
s_waitcnt vmcnt(9)
s_barrier
ds_read_b64_tr_b16 v[120:121], v138 offset:12288
ds_read_b64_tr_b16 v[122:123], v138 offset:13312
v_mfma_f32_32x32x16_bf16 a[16:31], v[92:95], v[16:19], a[16:31]
ds_read_b64_tr_b16 v[124:125], v139 offset:12288
ds_read_b64_tr_b16 v[126:127], v139 offset:13312
s_add_u32 m0, s52, 4096
s_nop 0
buffer_load_dwordx4 v141, s[44:47], s49 offen lds
s_add_u32 s49, s49, s54
v_mfma_f32_32x32x16_bf16 a[0:15], v[96:99], v[20:23], a[0:15]
ds_read_b64_tr_b16 v[128:129], v138 offset:14336
ds_read_b64_tr_b16 v[130:131], v138 offset:15360
buffer_load_dwordx4 v[8:11], v140, s[40:43], s48 offen offset:0 sc1
v_mfma_f32_32x32x16_bf16 a[16:31], v[100:103], v[20:23], a[16:31]
ds_read_b64_tr_b16 v[132:133], v139 offset:14336
ds_read_b64_tr_b16 v[134:135], v139 offset:15360
buffer_load_dwordx4 v[12:15], v140, s[40:43], s48 offen offset:1024 sc1
s_waitcnt lgkmcnt(8)
v_mfma_f32_32x32x16_bf16 a[0:15], v[104:107], v[24:27], a[0:15]
s_waitcnt vmcnt(10)
s_barrier
ds_read_b64_tr_b16 v[72:73], v138 offset:16384
ds_read_b64_tr_b16 v[74:75], v138 offset:17408
v_mfma_f32_32x32x16_bf16 a[16:31], v[108:111], v[24:27], a[16:31]
ds_read_b64_tr_b16 v[76:77], v139 offset:16384
ds_read_b64_tr_b16 v[78:79], v139 offset:17408
s_add_u32 m0, s52, 8192
s_nop 0
buffer_load_dwordx4 v141, s[44:47], s49 offen lds
s_add_u32 s49, s49, s54
v_mfma_f32_32x32x16_bf16 a[0:15], v[112:115], v[28:31], a[0:15]
ds_read_b64_tr_b16 v[80:81], v138 offset:18432
ds_read_b64_tr_b16 v[82:83], v138 offset:19456
buffer_load_dwordx4 v[16:19], v140, s[40:43], s48 offen offset:2048 sc1
v_mfma_f32_32x32x16_bf16 a[16:31], v[116:119], v[28:31], a[16:31]
ds_read_b64_tr_b16 v[84:85], v139 offset:18432
ds_read_b64_tr_b16 v[86:87], v139 offset:19456
buffer_load_dwordx4 v[20:23], v140, s[40:43], s48 offen offset:3072 sc1
s_add_u32 s48, s48, 4096
s_waitcnt lgkmcnt(8)
v_mfma_f32_32x32x16_bf16 a[0:15], v[120:123], v[32:35], a[0:15]
s_waitcnt vmcnt(11)
s_barrier
ds_read_b64_tr_b16 v[88:89], v138 offset:20480
ds_read_b64_tr_b16 v[90:91], v138 offset:21504
v_mfma_f32_32x32x16_bf16 a[16:31], v[124:127], v[32:35], a[16:31]
ds_read_b64_tr_b16 v[92:93], v139 offset:20480
ds_read_b64_tr_b16 v[94:95], v139 offset:21504
s_add_u32 m0, s52, 12288
s_nop 0
buffer_load_dwordx4 v141, s[44:47], s49 offen lds
s_add_u32 s49, s49, s54
v_mfma_f32_32x32x16_bf16 a[0:15], v[128:131], v[36:39], a[0:15]
ds_read_b64_tr_b16 v[96:97], v138 offset:22528
ds_read_b64_tr_b16 v[98:99], v138 offset:23552
buffer_load_dwordx4 v[24:27], v140, s[40:43], s48 offen offset:0 sc1
v_mfma_f32_32x32x16_bf16 a[16:31], v[132:135], v[36:39], a[16:31]
ds_read_b64_tr_b16 v[100:101], v139 offset:22528
ds_read_b64_tr_b16 v[102:103], v139 offset:23552
buffer_load_dwordx4 v[28:31], v140, s[40:43], s48 offen offset:1024 sc1
s_waitcnt lgkmcnt(8)
v_mfma_f32_32x32x16_bf16 a[0:15], v[72:75], v[40:43], a[0:15]
s_waitcnt vmcnt(12)
s_barrier
ds_read_b64_tr_b16 v[104:105], v138 offset:24576
ds_read_b64_tr_b16 v[106:107], v138 offset:25600
v_mfma_f32_32x32x16_bf16 a[16:31], v[76:79], v[40:43], a[16:31]
ds_read_b64_tr_b16 v[108:109], v139 offset:24576
ds_read_b64_tr_b16 v[110:111], v139 offset:25600
s_add_u32 m0, s52, 16384
s_nop 0
buffer_load_dwordx4 v141, s[44:47], s49 offen lds
s_add_u32 s49, s49, s54
v_mfma_f32_32x32x16_bf16 a[0:15], v[80:83], v[44:47], a[0:15]
ds_read_b64_tr_b16 v[112:113], v138 offset:26624
ds_read_b64_tr_b16 v[114:115], v138 offset:27648
buffer_load_dwordx4 v[32:35], v140, s[40:43], s48 offen offset:2048 sc1
v_mfma_f32_32x32x16_bf16 a[16:31], v[84:87], v[44:47], a[16:31]
ds_read_b64_tr_b16 v[116:117], v139 offset:26624
ds_read_b64_tr_b16 v[118:119], v139 offset:27648
buffer_load_dwordx4 v[36:39], v140, s[40:43], s48 offen offset:3072 sc1
s_add_u32 s48, s48, 4096
s_waitcnt lgkmcnt(8)
v_mfma_f32_32x32x16_bf16 a[0:15], v[88:91], v[48:51], a[0:15]
s_waitcnt vmcnt(12)
s_barrier
ds_read_b64_tr_b16 v[120:121], v138 offset:28672
ds_read_b64_tr_b16 v[122:123], v138 offset:29696
v_mfma_f32_32x32x16_bf16 a[16:31], v[92:95], v[48:51], a[16:31]
ds_read_b64_tr_b16 v[124:125], v139 offset:28672
ds_read_b64_tr_b16 v[126:127], v139 offset:29696
s_add_u32 m0, s52, 20480
s_nop 0
buffer_load_dwordx4 v141, s[44:47], s49 offen lds
s_add_u32 s49, s49, s54
v_mfma_f32_32x32x16_bf16 a[0:15], v[96:99], v[52:55], a[0:15]
ds_read_b64_tr_b16 v[128:129], v138 offset:30720
ds_read_b64_tr_b16 v[130:131], v138 offset:31744
buffer_load_dwordx4 v[40:43], v140, s[40:43], s48 offen offset:0 sc1
v_mfma_f32_32x32x16_bf16 a[16:31], v[100:103], v[52:55], a[16:31]
ds_read_b64_tr_b16 v[132:133], v139 offset:30720
ds_read_b64_tr_b16 v[134:135], v139 offset:31744
buffer_load_dwordx4 v[44:47], v140, s[40:43], s48 offen offset:1024 sc1
s_waitcnt lgkmcnt(8)
v_mfma_f32_32x32x16_bf16 a[0:15], v[104:107], v[56:59], a[0:15]
s_waitcnt vmcnt(12)
s_barrier
s_add_u32 s58, s51, s56
s_add_u32 s51, s51, 32768
s_cmp_eq_u32 s51, 131072
s_cselect_b32 s51, 0, s51
v_add_u32 v138, s51, v136
v_add_u32 v139, s51, v137
ds_read_b64_tr_b16 v[72:73], v138 offset:0
ds_read_b64_tr_b16 v[74:75], v138 offset:1024
v_mfma_f32_32x32x16_bf16 a[16:31], v[108:111], v[56:59], a[16:31]
ds_read_b64_tr_b16 v[76:77], v139 offset:0
ds_read_b64_tr_b16 v[78:79], v139 offset:1024
s_add_u32 m0, s52, 24576
s_nop 0
buffer_load_dwordx4 v141, s[44:47], s49 offen lds
s_add_u32 s49, s49, s54
v_mfma_f32_32x32x16_bf16 a[0:15], v[112:115], v[60:63], a[0:15]
ds_read_b64_tr_b16 v[80:81], v138 offset:2048
ds_read_b64_tr_b16 v[82:83], v138 offset:3072
buffer_load_dwordx4 v[48:51], v140, s[40:43], s48 offen offset:2048 sc1
v_mfma_f32_32x32x16_bf16 a[16:31], v[116:119], v[60:63], a[16:31]
ds_read_b64_tr_b16 v[84:85], v139 offset:2048
ds_read_b64_tr_b16 v[86:87], v139 offset:3072
buffer_load_dwordx4 v[52:55], v140, s[40:43], s48 offen offset:3072 sc1
s_add_u32 s48, s48, 4096
s_waitcnt lgkmcnt(8)
v_mfma_f32_32x32x16_bf16 a[0:15], v[120:123], v[64:67], a[0:15]
s_waitcnt vmcnt(12)
s_barrier
ds_read_b64_tr_b16 v[88:89], v138 offset:4096
ds_read_b64_tr_b16 v[90:91], v138 offset:5120
v_mfma_f32_32x32x16_bf16 a[16:31], v[124:127], v[64:67], a[16:31]
ds_read_b64_tr_b16 v[92:93], v139 offset:4096
ds_read_b64_tr_b16 v[94:95], v139 offset:5120
s_add_u32 m0, s52, 28672
s_nop 0
buffer_load_dwordx4 v141, s[44:47], s49 offen lds
s_add_u32 s49, s49, s54
v_mfma_f32_32x32x16_bf16 a[0:15], v[128:131], v[68:71], a[0:15]
ds_read_b64_tr_b16 v[96:97], v138 offset:6144
ds_read_b64_tr_b16 v[98:99], v138 offset:7168
buffer_load_dwordx4 v[56:59], v140, s[40:43], s48 offen offset:0 sc1
v_mfma_f32_32x32x16_bf16 a[16:31], v[132:135], v[68:71], a[16:31]
ds_read_b64_tr_b16 v[100:101], v139 offset:6144
ds_read_b64_tr_b16 v[102:103], v139 offset:7168
buffer_load_dwordx4 v[60:63], v140, s[40:43], s48 offen offset:1024 sc1
s_sub_u32 s50, s50, 8
s_mov_b32 s52, s58
s_cmp_le_u32 s50, 24
s_cbranch_scc1 .LgB_385
.LgD_384:
s_waitcnt lgkmcnt(8)
v_mfma_f32_32x32x16_bf16 a[0:15], v[72:75], v[8:11], a[0:15]
s_waitcnt vmcnt(12)
s_barrier
ds_read_b64_tr_b16 v[104:105], v138 offset:8192
ds_read_b64_tr_b16 v[106:107], v138 offset:9216
v_mfma_f32_32x32x16_bf16 a[16:31], v[76:79], v[8:11], a[16:31]
ds_read_b64_tr_b16 v[108:109], v139 offset:8192
ds_read_b64_tr_b16 v[110:111], v139 offset:9216
s_add_u32 m0, s52, 0
s_nop 0
buffer_load_dwordx4 v141, s[44:47], s49 offen lds
s_add_u32 s49, s49, s54
v_mfma_f32_32x32x16_bf16 a[0:15], v[80:83], v[12:15], a[0:15]
ds_read_b64_tr_b16 v[112:113], v138 offset:10240
ds_read_b64_tr_b16 v[114:115], v138 offset:11264
buffer_load_dwordx4 v[64:67], v140, s[40:43], s48 offen offset:2048 sc1
v_mfma_f32_32x32x16_bf16 a[16:31], v[84:87], v[12:15], a[16:31]
ds_read_b64_tr_b16 v[116:117], v139 offset:10240
ds_read_b64_tr_b16 v[118:119], v139 offset:11264
buffer_load_dwordx4 v[68:71], v140, s[40:43], s48 offen offset:3072 sc1
s_add_u32 s48, s48, 4096
s_waitcnt lgkmcnt(8)
v_mfma_f32_32x32x16_bf16 a[0:15], v[88:91], v[16:19], a[0:15]
s_waitcnt vmcnt(12)
s_barrier
ds_read_b64_tr_b16 v[120:121], v138 offset:12288
ds_read_b64_tr_b16 v[122:123], v138 offset:13312
v_mfma_f32_32x32x16_bf16 a[16:31], v[92:95], v[16:19], a[16:31]
ds_read_b64_tr_b16 v[124:125], v139 offset:12288
ds_read_b64_tr_b16 v[126:127], v139 offset:13312
s_add_u32 m0, s52, 4096
s_nop 0
buffer_load_dwordx4 v141, s[44:47], s49 offen lds
s_add_u32 s49, s49, s54
v_mfma_f32_32x32x16_bf16 a[0:15], v[96:99], v[20:23], a[0:15]
ds_read_b64_tr_b16 v[128:129], v138 offset:14336
ds_read_b64_tr_b16 v[130:131], v138 offset:15360
buffer_load_dwordx4 v[8:11], v140, s[40:43], s48 offen offset:0 sc1
v_mfma_f32_32x32x16_bf16 a[16:31], v[100:103], v[20:23], a[16:31]
ds_read_b64_tr_b16 v[132:133], v139 offset:14336
ds_read_b64_tr_b16 v[134:135], v139 offset:15360
buffer_load_dwordx4 v[12:15], v140, s[40:43], s48 offen offset:1024 sc1
s_waitcnt lgkmcnt(8)
v_mfma_f32_32x32x16_bf16 a[0:15], v[104:107], v[24:27], a[0:15]
s_waitcnt vmcnt(12)
s_barrier
ds_read_b64_tr_b16 v[72:73], v138 offset:16384
ds_read_b64_tr_b16 v[74:75], v138 offset:17408
v_mfma_f32_32x32x16_bf16 a[16:31], v[108:111], v[24:27], a[16:31]
ds_read_b64_tr_b16 v[76:77], v139 offset:16384
ds_read_b64_tr_b16 v[78:79], v139 offset:17408
s_add_u32 m0, s52, 8192
s_nop 0
buffer_load_dwordx4 v141, s[44:47], s49 offen lds
s_add_u32 s49, s49, s54
v_mfma_f32_32x32x16_bf16 a[0:15], v[112:115], v[28:31], a[0:15]
ds_read_b64_tr_b16 v[80:81], v138 offset:18432
ds_read_b64_tr_b16 v[82:83], v138 offset:19456
buffer_load_dwordx4 v[16:19], v140, s[40:43], s48 offen offset:2048 sc1
v_mfma_f32_32x32x16_bf16 a[16:31], v[116:119], v[28:31], a[16:31]
ds_read_b64_tr_b16 v[84:85], v139 offset:18432
ds_read_b64_tr_b16 v[86:87], v139 offset:19456
buffer_load_dwordx4 v[20:23], v140, s[40:43], s48 offen offset:3072 sc1
s_add_u32 s48, s48, 4096
s_waitcnt lgkmcnt(8)
v_mfma_f32_32x32x16_bf16 a[0:15], v[120:123], v[32:35], a[0:15]
s_waitcnt vmcnt(12)
s_barrier
ds_read_b64_tr_b16 v[88:89], v138 offset:20480
ds_read_b64_tr_b16 v[90:91], v138 offset:21504
v_mfma_f32_32x32x16_bf16 a[16:31], v[124:127], v[32:35], a[16:31]
ds_read_b64_tr_b16 v[92:93], v139 offset:20480
ds_read_b64_tr_b16 v[94:95], v139 offset:21504
s_add_u32 m0, s52, 12288
s_nop 0
buffer_load_dwordx4 v141, s[44:47], s49 offen lds
s_add_u32 s49, s49, s54
v_mfma_f32_32x32x16_bf16 a[0:15], v[128:131], v[36:39], a[0:15]
ds_read_b64_tr_b16 v[96:97], v138 offset:22528
ds_read_b64_tr_b16 v[98:99], v138 offset:23552
buffer_load_dwordx4 v[24:27], v140, s[40:43], s48 offen offset:0 sc1
v_mfma_f32_32x32x16_bf16 a[16:31], v[132:135], v[36:39], a[16:31]
ds_read_b64_tr_b16 v[100:101], v139 offset:22528
ds_read_b64_tr_b16 v[102:103], v139 offset:23552
buffer_load_dwordx4 v[28:31], v140, s[40:43], s48 offen offset:1024 sc1
s_waitcnt lgkmcnt(8)
v_mfma_f32_32x32x16_bf16 a[0:15], v[72:75], v[40:43], a[0:15]
s_waitcnt vmcnt(12)
s_barrier
ds_read_b64_tr_b16 v[104:105], v138 offset:24576
ds_read_b64_tr_b16 v[106:107], v138 offset:25600
v_mfma_f32_32x32x16_bf16 a[16:31], v[76:79], v[40:43], a[16:31]
ds_read_b64_tr_b16 v[108:109], v139 offset:24576
ds_read_b64_tr_b16 v[110:111], v139 offset:25600
s_add_u32 m0, s52, 16384
s_nop 0
buffer_load_dwordx4 v141, s[44:47], s49 offen lds
s_add_u32 s49, s49, s54
v_mfma_f32_32x32x16_bf16 a[0:15], v[80:83], v[44:47], a[0:15]
ds_read_b64_tr_b16 v[112:113], v138 offset:26624
ds_read_b64_tr_b16 v[114:115], v138 offset:27648
buffer_load_dwordx4 v[32:35], v140, s[40:43], s48 offen offset:2048 sc1
v_mfma_f32_32x32x16_bf16 a[16:31], v[84:87], v[44:47], a[16:31]
ds_read_b64_tr_b16 v[116:117], v139 offset:26624
ds_read_b64_tr_b16 v[118:119], v139 offset:27648
buffer_load_dwordx4 v[36:39], v140, s[40:43], s48 offen offset:3072 sc1
s_add_u32 s48, s48, 4096
s_waitcnt lgkmcnt(8)
v_mfma_f32_32x32x16_bf16 a[0:15], v[88:91], v[48:51], a[0:15]
s_waitcnt vmcnt(12)
s_barrier
ds_read_b64_tr_b16 v[120:121], v138 offset:28672
ds_read_b64_tr_b16 v[122:123], v138 offset:29696
v_mfma_f32_32x32x16_bf16 a[16:31], v[92:95], v[48:51], a[16:31]
ds_read_b64_tr_b16 v[124:125], v139 offset:28672
ds_read_b64_tr_b16 v[126:127], v139 offset:29696
s_add_u32 m0, s52, 20480
s_nop 0
buffer_load_dwordx4 v141, s[44:47], s49 offen lds
s_add_u32 s49, s49, s54
v_mfma_f32_32x32x16_bf16 a[0:15], v[96:99], v[52:55], a[0:15]
ds_read_b64_tr_b16 v[128:129], v138 offset:30720
ds_read_b64_tr_b16 v[130:131], v138 offset:31744
buffer_load_dwordx4 v[40:43], v140, s[40:43], s48 offen offset:0 sc1
v_mfma_f32_32x32x16_bf16 a[16:31], v[100:103], v[52:55], a[16:31]
ds_read_b64_tr_b16 v[132:133], v139 offset:30720
ds_read_b64_tr_b16 v[134:135], v139 offset:31744
buffer_load_dwordx4 v[44:47], v140, s[40:43], s48 offen offset:1024 sc1
s_waitcnt lgkmcnt(8)
v_mfma_f32_32x32x16_bf16 a[0:15], v[104:107], v[56:59], a[0:15]
s_waitcnt vmcnt(12)
s_barrier
s_add_u32 s58, s51, s56
s_add_u32 s51, s51, 32768
s_cmp_eq_u32 s51, 131072
s_cselect_b32 s51, 0, s51
v_add_u32 v138, s51, v136
v_add_u32 v139, s51, v137
ds_read_b64_tr_b16 v[72:73], v138 offset:0
ds_read_b64_tr_b16 v[74:75], v138 offset:1024
v_mfma_f32_32x32x16_bf16 a[16:31], v[108:111], v[56:59], a[16:31]
ds_read_b64_tr_b16 v[76:77], v139 offset:0
ds_read_b64_tr_b16 v[78:79], v139 offset:1024
s_add_u32 m0, s52, 24576
s_nop 0
buffer_load_dwordx4 v141, s[44:47], s49 offen lds
s_add_u32 s49, s49, s54
v_mfma_f32_32x32x16_bf16 a[0:15], v[112:115], v[60:63], a[0:15]
ds_read_b64_tr_b16 v[80:81], v138 offset:2048
ds_read_b64_tr_b16 v[82:83], v138 offset:3072
buffer_load_dwordx4 v[48:51], v140, s[40:43], s48 offen offset:2048 sc1
v_mfma_f32_32x32x16_bf16 a[16:31], v[116:119], v[60:63], a[16:31]
ds_read_b64_tr_b16 v[84:85], v139 offset:2048
ds_read_b64_tr_b16 v[86:87], v139 offset:3072
buffer_load_dwordx4 v[52:55], v140, s[40:43], s48 offen offset:3072 sc1
s_add_u32 s48, s48, 4096
s_waitcnt lgkmcnt(8)
v_mfma_f32_32x32x16_bf16 a[0:15], v[120:123], v[64:67], a[0:15]
s_waitcnt vmcnt(12)
s_barrier
ds_read_b64_tr_b16 v[88:89], v138 offset:4096
ds_read_b64_tr_b16 v[90:91], v138 offset:5120
v_mfma_f32_32x32x16_bf16 a[16:31], v[124:127], v[64:67], a[16:31]
ds_read_b64_tr_b16 v[92:93], v139 offset:4096
ds_read_b64_tr_b16 v[94:95], v139 offset:5120
s_add_u32 m0, s52, 28672
s_nop 0
buffer_load_dwordx4 v141, s[44:47], s49 offen lds
s_add_u32 s49, s49, s54
v_mfma_f32_32x32x16_bf16 a[0:15], v[128:131], v[68:71], a[0:15]
ds_read_b64_tr_b16 v[96:97], v138 offset:6144
ds_read_b64_tr_b16 v[98:99], v138 offset:7168
buffer_load_dwordx4 v[56:59], v140, s[40:43], s48 offen offset:0 sc1
v_mfma_f32_32x32x16_bf16 a[16:31], v[132:135], v[68:71], a[16:31]
ds_read_b64_tr_b16 v[100:101], v139 offset:6144
ds_read_b64_tr_b16 v[102:103], v139 offset:7168
buffer_load_dwordx4 v[60:63], v140, s[40:43], s48 offen offset:1024 sc1
s_sub_u32 s50, s50, 8
s_mov_b32 s52, s58
s_cmp_gt_u32 s50, 24
s_cbranch_scc1 .LgD_384
.LgB_385:
s_waitcnt lgkmcnt(8)
v_mfma_f32_32x32x16_bf16 a[0:15], v[72:75], v[8:11], a[0:15]
s_waitcnt vmcnt(8)
s_barrier
ds_read_b64_tr_b16 v[104:105], v138 offset:8192
ds_read_b64_tr_b16 v[106:107], v138 offset:9216
v_mfma_f32_32x32x16_bf16 a[16:31], v[76:79], v[8:11], a[16:31]
ds_read_b64_tr_b16 v[108:109], v139 offset:8192
ds_read_b64_tr_b16 v[110:111], v139 offset:9216
buffer_load_dwordx4 v[64:67], v140, s[40:43], s48 offen offset:2048 sc1
v_mfma_f32_32x32x16_bf16 a[0:15], v[80:83], v[12:15], a[0:15]
ds_read_b64_tr_b16 v[112:113], v138 offset:10240
ds_read_b64_tr_b16 v[114:115], v138 offset:11264
buffer_load_dwordx4 v[68:71], v140, s[40:43], s48 offen offset:3072 sc1
s_add_u32 s48, s48, 4096
v_mfma_f32_32x32x16_bf16 a[16:31], v[84:87], v[12:15], a[16:31]
ds_read_b64_tr_b16 v[116:117], v139 offset:10240
ds_read_b64_tr_b16 v[118:119], v139 offset:11264
s_cmp_eq_u32 s50, 8
s_cselect_b32 s42, 0, s42
s_waitcnt lgkmcnt(8)
v_mfma_f32_32x32x16_bf16 a[0:15], v[88:91], v[16:19], a[0:15]
s_waitcnt vmcnt(8)
s_barrier
ds_read_b64_tr_b16 v[120:121], v138 offset:12288
ds_read_b64_tr_b16 v[122:123], v138 offset:13312
v_mfma_f32_32x32x16_bf16 a[16:31], v[92:95], v[16:19], a[16:31]
ds_read_b64_tr_b16 v[124:125], v139 offset:12288
ds_read_b64_tr_b16 v[126:127], v139 offset:13312
buffer_load_dwordx4 v[8:11], v140, s[40:43], s48 offen offset:0 sc1
v_mfma_f32_32x32x16_bf16 a[0:15], v[96:99], v[20:23], a[0:15]
ds_read_b64_tr_b16 v[128:129], v138 offset:14336
ds_read_b64_tr_b16 v[130:131], v138 offset:15360
buffer_load_dwordx4 v[12:15], v140, s[40:43], s48 offen offset:1024 sc1
v_mfma_f32_32x32x16_bf16 a[16:31], v[100:103], v[20:23], a[16:31]
ds_read_b64_tr_b16 v[132:133], v139 offset:14336
ds_read_b64_tr_b16 v[134:135], v139 offset:15360
s_waitcnt lgkmcnt(8)
v_mfma_f32_32x32x16_bf16 a[0:15], v[104:107], v[24:27], a[0:15]
s_waitcnt vmcnt(8)
s_barrier
ds_read_b64_tr_b16 v[72:73], v138 offset:16384
ds_read_b64_tr_b16 v[74:75], v138 offset:17408
v_mfma_f32_32x32x16_bf16 a[16:31], v[108:111], v[24:27], a[16:31]
ds_read_b64_tr_b16 v[76:77], v139 offset:16384
ds_read_b64_tr_b16 v[78:79], v139 offset:17408
buffer_load_dwordx4 v[16:19], v140, s[40:43], s48 offen offset:2048 sc1
v_mfma_f32_32x32x16_bf16 a[0:15], v[112:115], v[28:31], a[0:15]
ds_read_b64_tr_b16 v[80:81], v138 offset:18432
ds_read_b64_tr_b16 v[82:83], v138 offset:19456
buffer_load_dwordx4 v[20:23], v140, s[40:43], s48 offen offset:3072 sc1
s_add_u32 s48, s48, 4096
v_mfma_f32_32x32x16_bf16 a[16:31], v[116:119], v[28:31], a[16:31]
ds_read_b64_tr_b16 v[84:85], v139 offset:18432
ds_read_b64_tr_b16 v[86:87], v139 offset:19456
s_waitcnt lgkmcnt(8)
v_mfma_f32_32x32x16_bf16 a[0:15], v[120:123], v[32:35], a[0:15]
s_waitcnt vmcnt(8)
s_barrier
ds_read_b64_tr_b16 v[88:89], v138 offset:20480
ds_read_b64_tr_b16 v[90:91], v138 offset:21504
v_mfma_f32_32x32x16_bf16 a[16:31], v[124:127], v[32:35], a[16:31]
ds_read_b64_tr_b16 v[92:93], v139 offset:20480
ds_read_b64_tr_b16 v[94:95], v139 offset:21504
buffer_load_dwordx4 v[24:27], v140, s[40:43], s48 offen offset:0 sc1
v_mfma_f32_32x32x16_bf16 a[0:15], v[128:131], v[36:39], a[0:15]
ds_read_b64_tr_b16 v[96:97], v138 offset:22528
ds_read_b64_tr_b16 v[98:99], v138 offset:23552
buffer_load_dwordx4 v[28:31], v140, s[40:43], s48 offen offset:1024 sc1
v_mfma_f32_32x32x16_bf16 a[16:31], v[132:135], v[36:39], a[16:31]
ds_read_b64_tr_b16 v[100:101], v139 offset:22528
ds_read_b64_tr_b16 v[102:103], v139 offset:23552
s_waitcnt lgkmcnt(8)
v_mfma_f32_32x32x16_bf16 a[0:15], v[72:75], v[40:43], a[0:15]
s_waitcnt vmcnt(8)
s_barrier
ds_read_b64_tr_b16 v[104:105], v138 offset:24576
ds_read_b64_tr_b16 v[106:107], v138 offset:25600
v_mfma_f32_32x32x16_bf16 a[16:31], v[76:79], v[40:43], a[16:31]
ds_read_b64_tr_b16 v[108:109], v139 offset:24576
ds_read_b64_tr_b16 v[110:111], v139 offset:25600
buffer_load_dwordx4 v[32:35], v140, s[40:43], s48 offen offset:2048 sc1
v_mfma_f32_32x32x16_bf16 a[0:15], v[80:83], v[44:47], a[0:15]
ds_read_b64_tr_b16 v[112:113], v138 offset:26624
ds_read_b64_tr_b16 v[114:115], v138 offset:27648
buffer_load_dwordx4 v[36:39], v140, s[40:43], s48 offen offset:3072 sc1
s_add_u32 s48, s48, 4096
v_mfma_f32_32x32x16_bf16 a[16:31], v[84:87], v[44:47], a[16:31]
ds_read_b64_tr_b16 v[116:117], v139 offset:26624
ds_read_b64_tr_b16 v[118:119], v139 offset:27648
s_waitcnt lgkmcnt(8)
v_mfma_f32_32x32x16_bf16 a[0:15], v[88:91], v[48:51], a[0:15]
s_waitcnt vmcnt(8)
s_barrier
ds_read_b64_tr_b16 v[120:121], v138 offset:28672
ds_read_b64_tr_b16 v[122:123], v138 offset:29696
v_mfma_f32_32x32x16_bf16 a[16:31], v[92:95], v[48:51], a[16:31]
ds_read_b64_tr_b16 v[124:125], v139 offset:28672
ds_read_b64_tr_b16 v[126:127], v139 offset:29696
buffer_load_dwordx4 v[40:43], v140, s[40:43], s48 offen offset:0 sc1
v_mfma_f32_32x32x16_bf16 a[0:15], v[96:99], v[52:55], a[0:15]
ds_read_b64_tr_b16 v[128:129], v138 offset:30720
ds_read_b64_tr_b16 v[130:131], v138 offset:31744
buffer_load_dwordx4 v[44:47], v140, s[40:43], s48 offen offset:1024 sc1
v_mfma_f32_32x32x16_bf16 a[16:31], v[100:103], v[52:55], a[16:31]
ds_read_b64_tr_b16 v[132:133], v139 offset:30720
ds_read_b64_tr_b16 v[134:135], v139 offset:31744
s_waitcnt lgkmcnt(8)
v_mfma_f32_32x32x16_bf16 a[0:15], v[104:107], v[56:59], a[0:15]
s_waitcnt vmcnt(8)
s_barrier
s_add_u32 s58, s51, s56
s_add_u32 s51, s51, 32768
s_cmp_eq_u32 s51, 131072
s_cselect_b32 s51, 0, s51
v_add_u32 v138, s51, v136
v_add_u32 v139, s51, v137
ds_read_b64_tr_b16 v[72:73], v138 offset:0
ds_read_b64_tr_b16 v[74:75], v138 offset:1024
v_mfma_f32_32x32x16_bf16 a[16:31], v[108:111], v[56:59], a[16:31]
ds_read_b64_tr_b16 v[76:77], v139 offset:0
ds_read_b64_tr_b16 v[78:79], v139 offset:1024
buffer_load_dwordx4 v[48:51], v140, s[40:43], s48 offen offset:2048 sc1
v_mfma_f32_32x32x16_bf16 a[0:15], v[112:115], v[60:63], a[0:15]
ds_read_b64_tr_b16 v[80:81], v138 offset:2048
ds_read_b64_tr_b16 v[82:83], v138 offset:3072
buffer_load_dwordx4 v[52:55], v140, s[40:43], s48 offen offset:3072 sc1
s_add_u32 s48, s48, 4096
v_mfma_f32_32x32x16_bf16 a[16:31], v[116:119], v[60:63], a[16:31]
ds_read_b64_tr_b16 v[84:85], v139 offset:2048
ds_read_b64_tr_b16 v[86:87], v139 offset:3072
s_waitcnt lgkmcnt(8)
v_mfma_f32_32x32x16_bf16 a[0:15], v[120:123], v[64:67], a[0:15]
s_waitcnt vmcnt(8)
s_barrier
ds_read_b64_tr_b16 v[88:89], v138 offset:4096
ds_read_b64_tr_b16 v[90:91], v138 offset:5120
v_mfma_f32_32x32x16_bf16 a[16:31], v[124:127], v[64:67], a[16:31]
ds_read_b64_tr_b16 v[92:93], v139 offset:4096
ds_read_b64_tr_b16 v[94:95], v139 offset:5120
buffer_load_dwordx4 v[56:59], v140, s[40:43], s48 offen offset:0 sc1
v_mfma_f32_32x32x16_bf16 a[0:15], v[128:131], v[68:71], a[0:15]
ds_read_b64_tr_b16 v[96:97], v138 offset:6144
ds_read_b64_tr_b16 v[98:99], v138 offset:7168
buffer_load_dwordx4 v[60:63], v140, s[40:43], s48 offen offset:1024 sc1
v_mfma_f32_32x32x16_bf16 a[16:31], v[132:135], v[68:71], a[16:31]
ds_read_b64_tr_b16 v[100:101], v139 offset:6144
ds_read_b64_tr_b16 v[102:103], v139 offset:7168
s_sub_u32 s50, s50, 8
s_cmp_lg_u32 s50, 0
s_cbranch_scc1 .LgB_385
s_waitcnt vmcnt(0) lgkmcnt(0)
s_nop 15
s_add_u32 s57, s12, 0
buffer_store_dwordx4 a[0:3], v4, s[36:39], s57 offen offset:0 sc1
buffer_store_dwordx4 a[4:7], v4, s[36:39], s57 offen offset:1024 sc1
buffer_store_dwordx4 a[8:11], v4, s[36:39], s57 offen offset:2048 sc1
buffer_store_dwordx4 a[12:15], v4, s[36:39], s57 offen offset:3072 sc1
s_add_u32 s57, s12, 4096
buffer_store_dwordx4 a[16:19], v4, s[36:39], s57 offen offset:0 sc1
buffer_store_dwordx4 a[20:23], v4, s[36:39], s57 offen offset:1024 sc1
buffer_store_dwordx4 a[24:27], v4, s[36:39], s57 offen offset:2048 sc1
buffer_store_dwordx4 a[28:31], v4, s[36:39], s57 offen offset:3072 sc1
s_add_u32 s86, s70, 119571456
s_bfe_u32 s82, s77, 0x10000
s_mul_i32 s82, s82, 512
s_add_u32 s86, s86, s82
s_bfe_u32 s82, s87, 0x10000
s_mul_i32 s82, s82, 128
s_add_u32 s86, s86, s82
s_waitcnt vmcnt(0)
s_barrier
s_cmp_lg_u32 s3, 0
s_cbranch_scc1 .Lsg_386
v_mov_b32 v1, 1
v_mul_u32_u24 v2, 0, v0
s_mov_b64 exec, 1
buffer_atomic_add v1, v2, s[88:91], s86 offen sc1
s_mov_b64 exec, -1
.Lsg_386:
s_lshl_b32 s84, s87, 2
s_lshr_b32 s81, s77, 3
s_add_u32 s84, s84, s81
s_add_u32 s84, s84, 48
s_and_b32 s85, s77, 7
s_add_u32 s12, s4, 0x400000
s_addc_u32 s13, s5, 0
s_mov_b32 s14, 0x400000
s_mov_b32 s15, 0x00020000
s_add_u32 s16, s4, 0xc00000
s_addc_u32 s17, s5, 0
s_mov_b32 s18, 0x6000
s_mov_b32 s19, 0x00020000
s_add_u32 s24, s4, 0x7400000
s_addc_u32 s25, s5, 0
s_mov_b32 s26, 0x200000
s_mov_b32 s27, 0x00020000
v_and_b32 v4, 3, v0
v_bfe_u32 v5, v0, 2, 1
v_lshrrev_b32 v6, 3, v0
s_lshl_b32 s28, s85, 2
v_add_u32 v4, s28, v4
s_mul_i32 s28, s3, 16
v_add_u32 v6, s28, v6
v_lshl_add_u32 v7, v5, 5, v4
v_lshlrev_b32 v7, 4, v7
v_lshl_add_u32 v8, v6, 10, v7
v_lshrrev_b32 v7, 2, v4
v_lshlrev_b32 v7, 7, v7
v_lshl_add_u32 v7, v5, 6, v7
v_and_b32 v9, 3, v4
v_lshl_add_u32 v7, v9, 4, v7
v_lshl_add_u32 v9, v6, 11, v7
v_lshlrev_b32 v10, 5, v5
v_lshl_add_u32 v10, v6, 6, v10
s_lshl_b32 s28, s84, 16
s_and_b32 s29, s84, 7
s_lshl_b32 s29, s29, 17
s_mov_b32 s30, 8192
buffer_load_dwordx4 v[208:211], v10, s[16:19], s30 offen offset:0
buffer_load_dwordx4 v[212:215], v10, s[16:19], s30 offen offset:16
buffer_load_dwordx4 v[216:219], v10, s[16:19], s30 offen offset:512
buffer_load_dwordx4 v[220:223], v10, s[16:19], s30 offen offset:528
s_add_u32 s20, s4, 0x800000
s_addc_u32 s21, s5, 0
s_mov_b32 s22, 0x400000
s_mov_b32 s23, 0x00020000
s_add_u32 s31, s28, 0
buffer_load_dwordx4 v[192:195], v8, s[12:15], s31 offen sc1
s_add_u32 s31, s28, 8192
buffer_load_dwordx4 v[196:199], v8, s[12:15], s31 offen sc1
s_add_u32 s86, s70, 119571456
s_bfe_u32 s82, s87, 0x10000
s_mul_i32 s82, s82, 512
s_add_u32 s86, s86, s82
s_cmp_lg_u32 s3, 0
s_cbranch_scc1 .Lws_387
v_mul_u32_u24 v1, 128, v0
v_add_u32 v1, s86, v1
v_mov_b32 v2, 16
s_mov_b64 exec, 3
.Lwl_388:
buffer_load_dword v3, v1, s[88:91], 0 offen sc1
s_waitcnt vmcnt(0)
v_cmp_lt_u32 vcc, v3, v2
s_cbranch_vccz .Lwo_389
s_cmp_eq_u32 s80, 0
s_cbranch_scc1 .Lwo_389
s_sub_u32 s80, s80, 1
s_branch .Lwl_388
.Lwo_389:
s_mov_b64 exec, -1
.Lws_387:
s_barrier
s_add_u32 s31, s29, 0
buffer_load_dwordx4 v[64:67], v9, s[24:27], s31 offen offset:0 sc1
buffer_load_dwordx4 v[68:71], v9, s[24:27], s31 offen offset:1024 sc1
s_add_u32 s31, s29, 1048576
buffer_load_dwordx4 v[72:75], v9, s[24:27], s31 offen offset:0 sc1
buffer_load_dwordx4 v[76:79], v9, s[24:27], s31 offen offset:1024 sc1
s_add_u32 s31, s29, 16384
buffer_load_dwordx4 v[96:99], v9, s[24:27], s31 offen offset:0 sc1
buffer_load_dwordx4 v[100:103], v9, s[24:27], s31 offen offset:1024 sc1
s_add_u32 s31, s29, 1064960
buffer_load_dwordx4 v[104:107], v9, s[24:27], s31 offen offset:0 sc1
buffer_load_dwordx4 v[108:111], v9, s[24:27], s31 offen offset:1024 sc1
v_mov_b32 v12, 0x3f803f80
v_mov_b32 v16, 0
v_mov_b32 v17, 0
v_mov_b32 v18, 0
v_mov_b32 v19, 0
s_waitcnt vmcnt(4)
v_pk_add_f32 v[64:65], v[64:65], v[72:73]
v_pk_add_f32 v[66:67], v[66:67], v[74:75]
v_pk_add_f32 v[68:69], v[68:69], v[76:77]
v_pk_add_f32 v[70:71], v[70:71], v[78:79]
v_cvt_pk_bf16_f32 v248, v64, v65
v_cvt_pk_bf16_f32 v249, v66, v67
v_cvt_pk_bf16_f32 v250, v68, v69
v_cvt_pk_bf16_f32 v251, v70, v71
v_lshlrev_b32 v240, 16, v248
v_and_b32 v241, 0xffff0000, v248
v_lshlrev_b32 v242, 16, v249
v_and_b32 v243, 0xffff0000, v249
v_lshlrev_b32 v244, 16, v250
v_and_b32 v245, 0xffff0000, v250
v_lshlrev_b32 v246, 16, v251
v_and_b32 v247, 0xffff0000, v251
v_mul_f32 v240, v240, v208
v_mul_f32 v241, v241, v209
v_mul_f32 v242, v242, v210
v_mul_f32 v243, v243, v211
v_mul_f32 v244, v244, v212
v_mul_f32 v245, v245, v213
v_mul_f32 v246, v246, v214
v_mul_f32 v247, v247, v215
v_cvt_pk_bf16_f32 v248, v240, v241
v_cvt_pk_bf16_f32 v249, v242, v243
v_cvt_pk_bf16_f32 v250, v244, v245
v_cvt_pk_bf16_f32 v251, v246, v247
v_lshlrev_b32 v240, 16, v248
v_and_b32 v241, 0xffff0000, v248
v_lshlrev_b32 v248, 16, v192
v_and_b32 v192, 0xffff0000, v192
v_lshlrev_b32 v242, 16, v249
v_and_b32 v243, 0xffff0000, v249
v_lshlrev_b32 v249, 16, v193
v_and_b32 v193, 0xffff0000, v193
v_lshlrev_b32 v244, 16, v250
v_and_b32 v245, 0xffff0000, v250
v_lshlrev_b32 v250, 16, v194
v_and_b32 v194, 0xffff0000, v194
v_lshlrev_b32 v246, 16, v251
v_and_b32 v247, 0xffff0000, v251
v_lshlrev_b32 v251, 16, v195
v_and_b32 v195, 0xffff0000, v195
v_add_f32 v240, v240, v248
v_add_f32 v241, v241, v192
v_add_f32 v242, v242, v249
v_add_f32 v243, v243, v193
v_add_f32 v244, v244, v250
v_add_f32 v245, v245, v194
v_add_f32 v246, v246, v251
v_add_f32 v247, v247, v195
v_cvt_pk_bf16_f32 v192, v240, v241
v_cvt_pk_bf16_f32 v193, v242, v243
v_cvt_pk_bf16_f32 v194, v244, v245
v_cvt_pk_bf16_f32 v195, v246, v247
s_add_u32 s31, s28, 0
buffer_store_dwordx4 v[192:195], v8, s[12:15], s31 offen sc1
v_dot2c_f32_bf16 v16, v192, v12
v_dot2c_f32_bf16 v17, v192, v192
v_dot2c_f32_bf16 v18, v193, v12
v_dot2c_f32_bf16 v19, v193, v193
v_dot2c_f32_bf16 v16, v194, v12
v_dot2c_f32_bf16 v17, v194, v194
v_dot2c_f32_bf16 v18, v195, v12
v_dot2c_f32_bf16 v19, v195, v195
s_waitcnt vmcnt(1)
v_pk_add_f32 v[96:97], v[96:97], v[104:105]
v_pk_add_f32 v[98:99], v[98:99], v[106:107]
v_pk_add_f32 v[100:101], v[100:101], v[108:109]
v_pk_add_f32 v[102:103], v[102:103], v[110:111]
v_cvt_pk_bf16_f32 v248, v96, v97
v_cvt_pk_bf16_f32 v249, v98, v99
v_cvt_pk_bf16_f32 v250, v100, v101
v_cvt_pk_bf16_f32 v251, v102, v103
v_lshlrev_b32 v240, 16, v248
v_and_b32 v241, 0xffff0000, v248
v_lshlrev_b32 v242, 16, v249
v_and_b32 v243, 0xffff0000, v249
v_lshlrev_b32 v244, 16, v250
v_and_b32 v245, 0xffff0000, v250
v_lshlrev_b32 v246, 16, v251
v_and_b32 v247, 0xffff0000, v251
v_mul_f32 v240, v240, v216
v_mul_f32 v241, v241, v217
v_mul_f32 v242, v242, v218
v_mul_f32 v243, v243, v219
v_mul_f32 v244, v244, v220
v_mul_f32 v245, v245, v221
v_mul_f32 v246, v246, v222
v_mul_f32 v247, v247, v223
v_cvt_pk_bf16_f32 v248, v240, v241
v_cvt_pk_bf16_f32 v249, v242, v243
v_cvt_pk_bf16_f32 v250, v244, v245
v_cvt_pk_bf16_f32 v251, v246, v247
v_lshlrev_b32 v240, 16, v248
v_and_b32 v241, 0xffff0000, v248
v_lshlrev_b32 v248, 16, v196
v_and_b32 v196, 0xffff0000, v196
v_lshlrev_b32 v242, 16, v249
v_and_b32 v243, 0xffff0000, v249
v_lshlrev_b32 v249, 16, v197
v_and_b32 v197, 0xffff0000, v197
v_lshlrev_b32 v244, 16, v250
v_and_b32 v245, 0xffff0000, v250
v_lshlrev_b32 v250, 16, v198
v_and_b32 v198, 0xffff0000, v198
v_lshlrev_b32 v246, 16, v251
v_and_b32 v247, 0xffff0000, v251
v_lshlrev_b32 v251, 16, v199
v_and_b32 v199, 0xffff0000, v199
v_add_f32 v240, v240, v248
v_add_f32 v241, v241, v196
v_add_f32 v242, v242, v249
v_add_f32 v243, v243, v197
v_add_f32 v244, v244, v250
v_add_f32 v245, v245, v198
v_add_f32 v246, v246, v251
v_add_f32 v247, v247, v199
v_cvt_pk_bf16_f32 v196, v240, v241
v_cvt_pk_bf16_f32 v197, v242, v243
v_cvt_pk_bf16_f32 v198, v244, v245
v_cvt_pk_bf16_f32 v199, v246, v247
s_add_u32 s31, s28, 8192
buffer_store_dwordx4 v[196:199], v8, s[12:15], s31 offen sc1
v_dot2c_f32_bf16 v16, v196, v12
v_dot2c_f32_bf16 v17, v196, v196
v_dot2c_f32_bf16 v18, v197, v12
v_dot2c_f32_bf16 v19, v197, v197
v_dot2c_f32_bf16 v16, v198, v12
v_dot2c_f32_bf16 v17, v198, v198
v_dot2c_f32_bf16 v18, v199, v12
v_dot2c_f32_bf16 v19, v199, v199
s_mov_b32 s30, 12288
s_mov_b32 s31, 16384
buffer_load_dwordx4 v[64:67], v10, s[16:19], s30 offen offset:0
buffer_load_dwordx4 v[96:99], v10, s[16:19], s31 offen offset:0
buffer_load_dwordx4 v[68:71], v10, s[16:19], s30 offen offset:16
buffer_load_dwordx4 v[100:103], v10, s[16:19], s31 offen offset:16
buffer_load_dwordx4 v[72:75], v10, s[16:19], s30 offen offset:512
buffer_load_dwordx4 v[104:107], v10, s[16:19], s31 offen offset:512
buffer_load_dwordx4 v[76:79], v10, s[16:19], s30 offen offset:528
buffer_load_dwordx4 v[108:111], v10, s[16:19], s31 offen offset:528
v_add_f32 v16, v16, v18
v_add_f32 v17, v17, v19
s_nop 0
v_add_f32_dpp v16, v16, v16 row_ror:4 row_mask:0xf bank_mask:0xf
v_add_f32_dpp v17, v17, v17 row_ror:4 row_mask:0xf bank_mask:0xf
s_nop 0
v_add_f32_dpp v16, v16, v16 row_ror:8 row_mask:0xf bank_mask:0xf
v_add_f32_dpp v17, v17, v17 row_ror:8 row_mask:0xf bank_mask:0xf
v_mov_b32 v18, v16
v_mov_b32 v19, v17
s_nop 0
v_permlane16_swap_b32 v16, v18
v_permlane16_swap_b32 v17, v19
v_add_f32 v16, v16, v18
v_add_f32 v17, v17, v19
v_mov_b32 v18, v16
v_mov_b32 v19, v17
s_nop 0
v_permlane32_swap_b32 v16, v18
v_permlane32_swap_b32 v17, v19
v_add_f32 v16, v16, v18
v_add_f32 v17, v17, v19
v_and_b32 v13, 3, v0
v_lshlrev_b32 v13, 3, v13
s_lshl_b32 s31, s3, 6
v_add_u32 v14, s31, v13
ds_write_b64 v14, v[16:17]
s_waitcnt lgkmcnt(0)
s_barrier
ds_read_b64 v[16:17], v13 offset:0
ds_read_b64 v[18:19], v13 offset:64
ds_read_b64 v[20:21], v13 offset:128
ds_read_b64 v[22:23], v13 offset:192
s_waitcnt lgkmcnt(0)
v_add_f32 v16, v16, v18
v_add_f32 v17, v17, v19
v_add_f32 v20, v20, v22
v_add_f32 v21, v21, v23
v_add_f32 v16, v16, v20
v_add_f32 v17, v17, v21
v_mul_f32 v16, 0x3a800000, v16
v_mul_f32 v17, 0x3a800000, v17
v_fma_f32 v17, -v16, v16, v17
v_max_f32 v17, 0, v17
v_cvt_pk_bf16_f32 v18, v16, v17
v_lshlrev_b32 v16, 16, v18
v_and_b32 v17, 0xffff0000, v18
v_add_f32 v17, 0x3727c5ac, v17
v_cvt_pk_bf16_f32 v17, v17, v17
v_lshlrev_b32 v17, 16, v17
v_sqrt_f32 v17, v17
s_nop 0
v_cvt_pk_bf16_f32 v17, v17, v17
v_lshlrev_b32 v17, 16, v17
v_rcp_f32 v17, v17
s_waitcnt vmcnt(0)
v_lshlrev_b32 v240, 16, v192
v_and_b32 v241, 0xffff0000, v192
v_lshlrev_b32 v242, 16, v193
v_and_b32 v243, 0xffff0000, v193
v_lshlrev_b32 v244, 16, v194
v_and_b32 v245, 0xffff0000, v194
v_lshlrev_b32 v246, 16, v195
v_and_b32 v247, 0xffff0000, v195
v_sub_f32 v240, v240, v16
v_sub_f32 v241, v241, v16
v_sub_f32 v242, v242, v16
v_sub_f32 v243, v243, v16
v_sub_f32 v244, v244, v16
v_sub_f32 v245, v245, v16
v_sub_f32 v246, v246, v16
v_sub_f32 v247, v247, v16
v_cvt_pk_bf16_f32 v248, v240, v241
v_cvt_pk_bf16_f32 v249, v242, v243
v_cvt_pk_bf16_f32 v250, v244, v245
v_cvt_pk_bf16_f32 v251, v246, v247
v_lshlrev_b32 v240, 16, v248
v_and_b32 v241, 0xffff0000, v248
v_lshlrev_b32 v242, 16, v249
v_and_b32 v243, 0xffff0000, v249
v_lshlrev_b32 v244, 16, v250
v_and_b32 v245, 0xffff0000, v250
v_lshlrev_b32 v246, 16, v251
v_and_b32 v247, 0xffff0000, v251
v_mul_f32 v240, v240, v17
v_mul_f32 v241, v241, v17
v_mul_f32 v242, v242, v17
v_mul_f32 v243, v243, v17
v_mul_f32 v244, v244, v17
v_mul_f32 v245, v245, v17
v_mul_f32 v246, v246, v17
v_mul_f32 v247, v247, v17
v_cvt_pk_bf16_f32 v248, v240, v241
v_cvt_pk_bf16_f32 v249, v242, v243
v_cvt_pk_bf16_f32 v250, v244, v245
v_cvt_pk_bf16_f32 v251, v246, v247
v_lshlrev_b32 v240, 16, v248
v_and_b32 v241, 0xffff0000, v248
v_lshlrev_b32 v242, 16, v249
v_and_b32 v243, 0xffff0000, v249
v_lshlrev_b32 v244, 16, v250
v_and_b32 v245, 0xffff0000, v250
v_lshlrev_b32 v246, 16, v251
v_and_b32 v247, 0xffff0000, v251
v_mul_f32 v240, v240, v96
v_mul_f32 v241, v241, v97
v_mul_f32 v242, v242, v98
v_mul_f32 v243, v243, v99
v_mul_f32 v244, v244, v100
v_mul_f32 v245, v245, v101
v_mul_f32 v246, v246, v102
v_mul_f32 v247, v247, v103
v_cvt_pk_bf16_f32 v248, v240, v241
v_cvt_pk_bf16_f32 v249, v242, v243
v_cvt_pk_bf16_f32 v250, v244, v245
v_cvt_pk_bf16_f32 v251, v246, v247
v_lshlrev_b32 v240, 16, v248
v_and_b32 v241, 0xffff0000, v248
v_lshlrev_b32 v242, 16, v249
v_and_b32 v243, 0xffff0000, v249
v_lshlrev_b32 v244, 16, v250
v_and_b32 v245, 0xffff0000, v250
v_lshlrev_b32 v246, 16, v251
v_and_b32 v247, 0xffff0000, v251
v_add_f32 v240, v240, v64
v_add_f32 v241, v241, v65
v_add_f32 v242, v242, v66
v_add_f32 v243, v243, v67
v_add_f32 v244, v244, v68
v_add_f32 v245, v245, v69
v_add_f32 v246, v246, v70
v_add_f32 v247, v247, v71
v_cvt_pk_bf16_f32 v192, v240, v241
v_cvt_pk_bf16_f32 v193, v242, v243
v_cvt_pk_bf16_f32 v194, v244, v245
v_cvt_pk_bf16_f32 v195, v246, v247
s_add_u32 s31, s28, 0
buffer_store_dwordx4 v[192:195], v8, s[20:23], s31 offen sc1
v_lshlrev_b32 v240, 16, v196
v_and_b32 v241, 0xffff0000, v196
v_lshlrev_b32 v242, 16, v197
v_and_b32 v243, 0xffff0000, v197
v_lshlrev_b32 v244, 16, v198
v_and_b32 v245, 0xffff0000, v198
v_lshlrev_b32 v246, 16, v199
v_and_b32 v247, 0xffff0000, v199
v_sub_f32 v240, v240, v16
v_sub_f32 v241, v241, v16
v_sub_f32 v242, v242, v16
v_sub_f32 v243, v243, v16
v_sub_f32 v244, v244, v16
v_sub_f32 v245, v245, v16
v_sub_f32 v246, v246, v16
v_sub_f32 v247, v247, v16
v_cvt_pk_bf16_f32 v248, v240, v241
v_cvt_pk_bf16_f32 v249, v242, v243
v_cvt_pk_bf16_f32 v250, v244, v245
v_cvt_pk_bf16_f32 v251, v246, v247
v_lshlrev_b32 v240, 16, v248
v_and_b32 v241, 0xffff0000, v248
v_lshlrev_b32 v242, 16, v249
v_and_b32 v243, 0xffff0000, v249
v_lshlrev_b32 v244, 16, v250
v_and_b32 v245, 0xffff0000, v250
v_lshlrev_b32 v246, 16, v251
v_and_b32 v247, 0xffff0000, v251
v_mul_f32 v240, v240, v17
v_mul_f32 v241, v241, v17
v_mul_f32 v242, v242, v17
v_mul_f32 v243, v243, v17
v_mul_f32 v244, v244, v17
v_mul_f32 v245, v245, v17
v_mul_f32 v246, v246, v17
v_mul_f32 v247, v247, v17
v_cvt_pk_bf16_f32 v248, v240, v241
v_cvt_pk_bf16_f32 v249, v242, v243
v_cvt_pk_bf16_f32 v250, v244, v245
v_cvt_pk_bf16_f32 v251, v246, v247
v_lshlrev_b32 v240, 16, v248
v_and_b32 v241, 0xffff0000, v248
v_lshlrev_b32 v242, 16, v249
v_and_b32 v243, 0xffff0000, v249
v_lshlrev_b32 v244, 16, v250
v_and_b32 v245, 0xffff0000, v250
v_lshlrev_b32 v246, 16, v251
v_and_b32 v247, 0xffff0000, v251
v_mul_f32 v240, v240, v104
v_mul_f32 v241, v241, v105
v_mul_f32 v242, v242, v106
v_mul_f32 v243, v243, v107
v_mul_f32 v244, v244, v108
v_mul_f32 v245, v245, v109
v_mul_f32 v246, v246, v110
v_mul_f32 v247, v247, v111
v_cvt_pk_bf16_f32 v248, v240, v241
v_cvt_pk_bf16_f32 v249, v242, v243
v_cvt_pk_bf16_f32 v250, v244, v245
v_cvt_pk_bf16_f32 v251, v246, v247
v_lshlrev_b32 v240, 16, v248
v_and_b32 v241, 0xffff0000, v248
v_lshlrev_b32 v242, 16, v249
v_and_b32 v243, 0xffff0000, v249
v_lshlrev_b32 v244, 16, v250
v_and_b32 v245, 0xffff0000, v250
v_lshlrev_b32 v246, 16, v251
v_and_b32 v247, 0xffff0000, v251
v_add_f32 v240, v240, v72
v_add_f32 v241, v241, v73
v_add_f32 v242, v242, v74
v_add_f32 v243, v243, v75
v_add_f32 v244, v244, v76
v_add_f32 v245, v245, v77
v_add_f32 v246, v246, v78
v_add_f32 v247, v247, v79
v_cvt_pk_bf16_f32 v196, v240, v241
v_cvt_pk_bf16_f32 v197, v242, v243
v_cvt_pk_bf16_f32 v198, v244, v245
v_cvt_pk_bf16_f32 v199, v246, v247
s_add_u32 s31, s28, 8192
buffer_store_dwordx4 v[196:199], v8, s[20:23], s31 offen sc1
s_add_u32 s86, s70, 119572480
s_bfe_u32 s82, s87, 0x10000
s_mul_i32 s82, s82, 512
s_add_u32 s86, s86, s82
s_waitcnt vmcnt(0)
s_barrier
s_cmp_lg_u32 s3, 0
s_cbranch_scc1 .Lsg_390
v_mov_b32 v1, 1
v_mul_u32_u24 v2, 128, v0
s_mov_b64 exec, 3
buffer_atomic_add v1, v2, s[88:91], s86 offen sc1
s_mov_b64 exec, -1
.Lsg_390:
s_cmp_ge_u32 s77, 28
s_cbranch_scc1 .Lnf_391
s_mul_i32 s85, s87, 28
s_add_u32 s85, s85, s77
s_add_u32 s86, s70, 119572480
s_bfe_u32 s82, s87, 0x10000
s_mul_i32 s82, s82, 128
s_add_u32 s86, s86, s82
s_load_dwordx2 s[6:7], s[0:1], 64
s_add_u32 s40, s4, 0x800000
s_addc_u32 s41, s5, 0
s_mov_b32 s42, 0x400000
s_mov_b32 s43, 0x00020000
v_lshrrev_b32 v207, 2, v0
v_and_b32 v207, 3, v207
v_lshrrev_b32 v208, 5, v0
v_lshlrev_b32 v208, 2, v208
v_add_u32 v208, v208, v207
v_mul_u32_u24 v208, 128, v208
v_and_b32 v209, 3, v0
v_lshlrev_b32 v209, 3, v209
v_add_u32 v208, v208, v209
v_and_b32 v209, 16, v0
v_lshlrev_b32 v209, 1, v209
v_add_u32 v208, v208, v209
v_lshrrev_b32 v207, 1, v207
s_and_b32 s53, s3, 0
s_mul_i32 s53, s53, 2
s_add_u32 s57, s53, 0
v_xor_b32 v209, s57, v207
v_lshlrev_b32 v209, 6, v209
v_add_u32 v200, v208, v209
s_add_u32 s57, s53, 1
v_xor_b32 v209, s57, v207
v_lshlrev_b32 v209, 6, v209
v_add_u32 v201, v208, v209
s_lshr_b32 s53, s3, 0
s_mul_i32 s53, s53, 131072
v_lshlrev_b32 v204, 4, v0
v_add_u32 v204, s53, v204
v_add_u32 v205, 65536, v204
v_lshrrev_b32 v207, 3, v0
s_mul_i32 s53, s3, 8
v_add_u32 v207, s53, v207
v_and_b32 v208, 3, v207
v_lshrrev_b32 v208, 1, v208
v_and_b32 v209, 7, v0
v_lshrrev_b32 v209, 2, v209
v_xor_b32 v208, v208, v209
v_lshlrev_b32 v208, 6, v208
v_and_b32 v209, 3, v0
v_lshlrev_b32 v209, 4, v209
v_add_u32 v208, v208, v209
s_mov_b32 s53, 7168
v_mul_lo_u32 v207, v207, s53
v_add_u32 v206, v207, v208
s_mul_i32 s54, s53, 32
s_lshl_b32 s56, s3, 10
s_waitcnt lgkmcnt(0)
s_mul_i32 s48, s78, 524288
s_mul_i32 s49, s85, 128
s_mov_b32 s50, 32
s_mov_b32 s44, s6
s_mov_b32 s45, s7
s_mov_b32 s46, 0x700000
s_mov_b32 s47, 0x00020000
s_add_u32 m0, s56, 0
s_nop 0
buffer_load_dwordx4 v206, s[44:47], s49 offen lds
s_add_u32 s49, s49, s54
s_add_u32 m0, s56, 4096
s_nop 0
buffer_load_dwordx4 v206, s[44:47], s49 offen lds
s_add_u32 s49, s49, s54
s_add_u32 m0, s56, 8192
s_nop 0
buffer_load_dwordx4 v206, s[44:47], s49 offen lds
s_add_u32 s49, s49, s54
s_add_u32 m0, s56, 12288
s_nop 0
buffer_load_dwordx4 v206, s[44:47], s49 offen lds
s_add_u32 s49, s49, s54
s_add_u32 m0, s56, 16384
s_nop 0
buffer_load_dwordx4 v206, s[44:47], s49 offen lds
s_add_u32 s49, s49, s54
s_add_u32 m0, s56, 20480
s_nop 0
buffer_load_dwordx4 v206, s[44:47], s49 offen lds
s_add_u32 s49, s49, s54
s_add_u32 m0, s56, 24576
s_nop 0
buffer_load_dwordx4 v206, s[44:47], s49 offen lds
s_add_u32 s49, s49, s54
s_add_u32 m0, s56, 28672
s_nop 0
buffer_load_dwordx4 v206, s[44:47], s49 offen lds
s_add_u32 s49, s49, s54
s_add_u32 m0, s56, 32768
s_nop 0
buffer_load_dwordx4 v206, s[44:47], s49 offen lds
s_add_u32 s49, s49, s54
s_add_u32 m0, s56, 36864
s_nop 0
buffer_load_dwordx4 v206, s[44:47], s49 offen lds
s_add_u32 s49, s49, s54
s_add_u32 m0, s56, 40960
s_nop 0
buffer_load_dwordx4 v206, s[44:47], s49 offen lds
s_add_u32 s49, s49, s54
s_add_u32 m0, s56, 45056
s_nop 0
buffer_load_dwordx4 v206, s[44:47], s49 offen lds
s_add_u32 s49, s49, s54
s_add_u32 m0, s56, 49152
s_nop 0
buffer_load_dwordx4 v206, s[44:47], s49 offen lds
s_add_u32 s49, s49, s54
s_add_u32 m0, s56, 53248
s_nop 0
buffer_load_dwordx4 v206, s[44:47], s49 offen lds
s_add_u32 s49, s49, s54
s_add_u32 m0, s56, 57344
s_nop 0
buffer_load_dwordx4 v206, s[44:47], s49 offen lds
s_add_u32 s49, s49, s54
s_add_u32 m0, s56, 61440
s_nop 0
buffer_load_dwordx4 v206, s[44:47], s49 offen lds
s_add_u32 s49, s49, s54
s_add_u32 m0, s56, 65536
s_nop 0
buffer_load_dwordx4 v206, s[44:47], s49 offen lds
s_add_u32 s49, s49, s54
s_add_u32 m0, s56, 69632
s_nop 0
buffer_load_dwordx4 v206, s[44:47], s49 offen lds
s_add_u32 s49, s49, s54
s_add_u32 m0, s56, 73728
s_nop 0
buffer_load_dwordx4 v206, s[44:47], s49 offen lds
s_add_u32 s49, s49, s54
s_add_u32 m0, s56, 77824
s_nop 0
buffer_load_dwordx4 v206, s[44:47], s49 offen lds
s_add_u32 s49, s49, s54
s_add_u32 m0, s56, 81920
s_nop 0
buffer_load_dwordx4 v206, s[44:47], s49 offen lds
s_add_u32 s49, s49, s54
s_add_u32 m0, s56, 86016
s_nop 0
buffer_load_dwordx4 v206, s[44:47], s49 offen lds
s_add_u32 s49, s49, s54
s_add_u32 m0, s56, 90112
s_nop 0
buffer_load_dwordx4 v206, s[44:47], s49 offen lds
s_add_u32 s49, s49, s54
s_add_u32 m0, s56, 94208
s_nop 0
buffer_load_dwordx4 v206, s[44:47], s49 offen lds
s_add_u32 s49, s49, s54
s_lshr_b32 s16, s3, 0
s_mul_i32 s16, s16, 2
s_mul_i32 s18, s78, 8
s_add_u32 s16, s16, s18
s_and_b32 s17, s3, 0
s_mul_i32 s17, s17, 4
s_mul_i32 s18, s85, 4
s_add_u32 s17, s17, s18
v_lshlrev_b32 v4, 4, v0
s_add_u32 s36, s4, 0x5000000
s_addc_u32 s37, s5, 0
s_mov_b32 s38, 0xe00000
s_mov_b32 s39, 0x00020000
s_mul_i32 s12, s16, 229376
s_lshl_b32 s18, s17, 10
s_add_u32 s12, s12, s18
s_cmp_lg_u32 s3, 0
s_cbranch_scc1 .Lws_392
v_mul_u32_u24 v1, 512, v0
v_add_u32 v1, s86, v1
v_mov_b32 v2, 32
s_mov_b64 exec, 3
.Lwl_393:
buffer_load_dword v3, v1, s[88:91], 0 offen sc1
s_waitcnt vmcnt(0)
v_cmp_lt_u32 vcc, v3, v2
s_cbranch_vccz .Lwo_394
s_cmp_eq_u32 s80, 0
s_cbranch_scc1 .Lwo_394
s_sub_u32 s80, s80, 1
s_branch .Lwl_393
.Lwo_394:
s_mov_b64 exec, -1
.Lws_392:
s_barrier
buffer_load_dwordx4 v[8:11], v204, s[40:43], s48 offen offset:0 sc1
buffer_load_dwordx4 v[12:15], v205, s[40:43], s48 offen offset:0 sc1
buffer_load_dwordx4 v[16:19], v204, s[40:43], s48 offen offset:1024 sc1
buffer_load_dwordx4 v[20:23], v205, s[40:43], s48 offen offset:1024 sc1
buffer_load_dwordx4 v[24:27], v204, s[40:43], s48 offen offset:2048 sc1
buffer_load_dwordx4 v[28:31], v205, s[40:43], s48 offen offset:2048 sc1
buffer_load_dwordx4 v[32:35], v204, s[40:43], s48 offen offset:3072 sc1
buffer_load_dwordx4 v[36:39], v205, s[40:43], s48 offen offset:3072 sc1
s_add_u32 s48, s48, 4096
buffer_load_dwordx4 v[40:43], v204, s[40:43], s48 offen offset:0 sc1
buffer_load_dwordx4 v[44:47], v205, s[40:43], s48 offen offset:0 sc1
buffer_load_dwordx4 v[48:51], v204, s[40:43], s48 offen offset:1024 sc1
buffer_load_dwordx4 v[52:55], v205, s[40:43], s48 offen offset:1024 sc1
buffer_load_dwordx4 v[56:59], v204, s[40:43], s48 offen offset:2048 sc1
buffer_load_dwordx4 v[60:63], v205, s[40:43], s48 offen offset:2048 sc1
buffer_load_dwordx4 v[64:67], v204, s[40:43], s48 offen offset:3072 sc1
buffer_load_dwordx4 v[68:71], v205, s[40:43], s48 offen offset:3072 sc1
s_add_u32 s48, s48, 4096
buffer_load_dwordx4 v[72:75], v204, s[40:43], s48 offen offset:0 sc1
buffer_load_dwordx4 v[76:79], v205, s[40:43], s48 offen offset:0 sc1
buffer_load_dwordx4 v[80:83], v204, s[40:43], s48 offen offset:1024 sc1
buffer_load_dwordx4 v[84:87], v205, s[40:43], s48 offen offset:1024 sc1
buffer_load_dwordx4 v[88:91], v204, s[40:43], s48 offen offset:2048 sc1
buffer_load_dwordx4 v[92:95], v205, s[40:43], s48 offen offset:2048 sc1
buffer_load_dwordx4 v[96:99], v204, s[40:43], s48 offen offset:3072 sc1
buffer_load_dwordx4 v[100:103], v205, s[40:43], s48 offen offset:3072 sc1
s_add_u32 s48, s48, 4096
buffer_load_dwordx4 v[104:107], v204, s[40:43], s48 offen offset:0 sc1
buffer_load_dwordx4 v[108:111], v205, s[40:43], s48 offen offset:0 sc1
buffer_load_dwordx4 v[112:115], v204, s[40:43], s48 offen offset:1024 sc1
buffer_load_dwordx4 v[116:119], v205, s[40:43], s48 offen offset:1024 sc1
v_accvgpr_write_b32 a0, 0
v_accvgpr_write_b32 a1, 0
v_accvgpr_write_b32 a2, 0
v_accvgpr_write_b32 a3, 0
v_accvgpr_write_b32 a4, 0
v_accvgpr_write_b32 a5, 0
v_accvgpr_write_b32 a6, 0
v_accvgpr_write_b32 a7, 0
v_accvgpr_write_b32 a8, 0
v_accvgpr_write_b32 a9, 0
v_accvgpr_write_b32 a10, 0
v_accvgpr_write_b32 a11, 0
v_accvgpr_write_b32 a12, 0
v_accvgpr_write_b32 a13, 0
v_accvgpr_write_b32 a14, 0
v_accvgpr_write_b32 a15, 0
v_accvgpr_write_b32 a16, 0
v_accvgpr_write_b32 a17, 0
v_accvgpr_write_b32 a18, 0
v_accvgpr_write_b32 a19, 0
v_accvgpr_write_b32 a20, 0
v_accvgpr_write_b32 a21, 0
v_accvgpr_write_b32 a22, 0
v_accvgpr_write_b32 a23, 0
v_accvgpr_write_b32 a24, 0
v_accvgpr_write_b32 a25, 0
v_accvgpr_write_b32 a26, 0
v_accvgpr_write_b32 a27, 0
v_accvgpr_write_b32 a28, 0
v_accvgpr_write_b32 a29, 0
v_accvgpr_write_b32 a30, 0
v_accvgpr_write_b32 a31, 0
v_accvgpr_write_b32 a32, 0
v_accvgpr_write_b32 a33, 0
v_accvgpr_write_b32 a34, 0
v_accvgpr_write_b32 a35, 0
v_accvgpr_write_b32 a36, 0
v_accvgpr_write_b32 a37, 0
v_accvgpr_write_b32 a38, 0
v_accvgpr_write_b32 a39, 0
v_accvgpr_write_b32 a40, 0
v_accvgpr_write_b32 a41, 0
v_accvgpr_write_b32 a42, 0
v_accvgpr_write_b32 a43, 0
v_accvgpr_write_b32 a44, 0
v_accvgpr_write_b32 a45, 0
v_accvgpr_write_b32 a46, 0
v_accvgpr_write_b32 a47, 0
v_accvgpr_write_b32 a48, 0
v_accvgpr_write_b32 a49, 0
v_accvgpr_write_b32 a50, 0
v_accvgpr_write_b32 a51, 0
v_accvgpr_write_b32 a52, 0
v_accvgpr_write_b32 a53, 0
v_accvgpr_write_b32 a54, 0
v_accvgpr_write_b32 a55, 0
v_accvgpr_write_b32 a56, 0
v_accvgpr_write_b32 a57, 0
v_accvgpr_write_b32 a58, 0
v_accvgpr_write_b32 a59, 0
v_accvgpr_write_b32 a60, 0
v_accvgpr_write_b32 a61, 0
v_accvgpr_write_b32 a62, 0
v_accvgpr_write_b32 a63, 0
s_waitcnt vmcnt(20)
s_barrier
s_mov_b32 s51, 0
s_add_u32 s52, s56, 98304
v_mov_b32 v202, v200
v_mov_b32 v203, v201
ds_read_b64_tr_b16 v[136:137], v202 offset:0
ds_read_b64_tr_b16 v[138:139], v202 offset:1024
ds_read_b64_tr_b16 v[140:141], v203 offset:0
ds_read_b64_tr_b16 v[142:143], v203 offset:1024
ds_read_b64_tr_b16 v[144:145], v202 offset:2048
ds_read_b64_tr_b16 v[146:147], v202 offset:3072
ds_read_b64_tr_b16 v[148:149], v203 offset:2048
ds_read_b64_tr_b16 v[150:151], v203 offset:3072
ds_read_b64_tr_b16 v[152:153], v202 offset:4096
ds_read_b64_tr_b16 v[154:155], v202 offset:5120
ds_read_b64_tr_b16 v[156:157], v203 offset:4096
ds_read_b64_tr_b16 v[158:159], v203 offset:5120
ds_read_b64_tr_b16 v[160:161], v202 offset:6144
ds_read_b64_tr_b16 v[162:163], v202 offset:7168
ds_read_b64_tr_b16 v[164:165], v203 offset:6144
ds_read_b64_tr_b16 v[166:167], v203 offset:7168
s_waitcnt lgkmcnt(8)
v_mfma_f32_32x32x16_bf16 a[0:15], v[136:139], v[8:11], a[0:15]
s_waitcnt vmcnt(16)
s_barrier
ds_read_b64_tr_b16 v[168:169], v202 offset:8192
v_mfma_f32_32x32x16_bf16 a[32:47], v[136:139], v[12:15], a[32:47]
ds_read_b64_tr_b16 v[170:171], v202 offset:9216
s_add_u32 m0, s52, 0
s_nop 0
buffer_load_dwordx4 v206, s[44:47], s49 offen lds
s_add_u32 s49, s49, s54
v_mfma_f32_32x32x16_bf16 a[16:31], v[140:143], v[8:11], a[16:31]
ds_read_b64_tr_b16 v[172:173], v203 offset:8192
buffer_load_dwordx4 v[120:123], v204, s[40:43], s48 offen offset:2048 sc1
v_mfma_f32_32x32x16_bf16 a[48:63], v[140:143], v[12:15], a[48:63]
ds_read_b64_tr_b16 v[174:175], v203 offset:9216
buffer_load_dwordx4 v[124:127], v205, s[40:43], s48 offen offset:2048 sc1
v_mfma_f32_32x32x16_bf16 a[0:15], v[144:147], v[16:19], a[0:15]
ds_read_b64_tr_b16 v[176:177], v202 offset:10240
v_mfma_f32_32x32x16_bf16 a[32:47], v[144:147], v[20:23], a[32:47]
ds_read_b64_tr_b16 v[178:179], v202 offset:11264
buffer_load_dwordx4 v[128:131], v204, s[40:43], s48 offen offset:3072 sc1
v_mfma_f32_32x32x16_bf16 a[16:31], v[148:151], v[16:19], a[16:31]
ds_read_b64_tr_b16 v[180:181], v203 offset:10240
buffer_load_dwordx4 v[132:135], v205, s[40:43], s48 offen offset:3072 sc1
s_add_u32 s48, s48, 4096
v_mfma_f32_32x32x16_bf16 a[48:63], v[148:151], v[20:23], a[48:63]
ds_read_b64_tr_b16 v[182:183], v203 offset:11264
s_waitcnt lgkmcnt(8)
v_mfma_f32_32x32x16_bf16 a[0:15], v[152:155], v[24:27], a[0:15]
s_waitcnt vmcnt(17)
s_barrier
ds_read_b64_tr_b16 v[184:185], v202 offset:12288
v_mfma_f32_32x32x16_bf16 a[32:47], v[152:155], v[28:31], a[32:47]
ds_read_b64_tr_b16 v[186:187], v202 offset:13312
s_add_u32 m0, s52, 4096
s_nop 0
buffer_load_dwordx4 v206, s[44:47], s49 offen lds
s_add_u32 s49, s49, s54
v_mfma_f32_32x32x16_bf16 a[16:31], v[156:159], v[24:27], a[16:31]
ds_read_b64_tr_b16 v[188:189], v203 offset:12288
buffer_load_dwordx4 v[8:11], v204, s[40:43], s48 offen offset:0 sc1
v_mfma_f32_32x32x16_bf16 a[48:63], v[156:159], v[28:31], a[48:63]
ds_read_b64_tr_b16 v[190:191], v203 offset:13312
buffer_load_dwordx4 v[12:15], v205, s[40:43], s48 offen offset:0 sc1
v_mfma_f32_32x32x16_bf16 a[0:15], v[160:163], v[32:35], a[0:15]
ds_read_b64_tr_b16 v[192:193], v202 offset:14336
v_mfma_f32_32x32x16_bf16 a[32:47], v[160:163], v[36:39], a[32:47]
ds_read_b64_tr_b16 v[194:195], v202 offset:15360
buffer_load_dwordx4 v[16:19], v204, s[40:43], s48 offen offset:1024 sc1
v_mfma_f32_32x32x16_bf16 a[16:31], v[164:167], v[32:35], a[16:31]
ds_read_b64_tr_b16 v[196:197], v203 offset:14336
buffer_load_dwordx4 v[20:23], v205, s[40:43], s48 offen offset:1024 sc1
v_mfma_f32_32x32x16_bf16 a[48:63], v[164:167], v[36:39], a[48:63]
ds_read_b64_tr_b16 v[198:199], v203 offset:15360
s_waitcnt lgkmcnt(8)
v_mfma_f32_32x32x16_bf16 a[0:15], v[168:171], v[40:43], a[0:15]
s_waitcnt vmcnt(18)
s_barrier
ds_read_b64_tr_b16 v[136:137], v202 offset:16384
v_mfma_f32_32x32x16_bf16 a[32:47], v[168:171], v[44:47], a[32:47]
ds_read_b64_tr_b16 v[138:139], v202 offset:17408
s_add_u32 m0, s52, 8192
s_nop 0
buffer_load_dwordx4 v206, s[44:47], s49 offen lds
s_add_u32 s49, s49, s54
v_mfma_f32_32x32x16_bf16 a[16:31], v[172:175], v[40:43], a[16:31]
ds_read_b64_tr_b16 v[140:141], v203 offset:16384
buffer_load_dwordx4 v[24:27], v204, s[40:43], s48 offen offset:2048 sc1
v_mfma_f32_32x32x16_bf16 a[48:63], v[172:175], v[44:47], a[48:63]
ds_read_b64_tr_b16 v[142:143], v203 offset:17408
buffer_load_dwordx4 v[28:31], v205, s[40:43], s48 offen offset:2048 sc1
v_mfma_f32_32x32x16_bf16 a[0:15], v[176:179], v[48:51], a[0:15]
ds_read_b64_tr_b16 v[144:145], v202 offset:18432
v_mfma_f32_32x32x16_bf16 a[32:47], v[176:179], v[52:55], a[32:47]
ds_read_b64_tr_b16 v[146:147], v202 offset:19456
buffer_load_dwordx4 v[32:35], v204, s[40:43], s48 offen offset:3072 sc1
v_mfma_f32_32x32x16_bf16 a[16:31], v[180:183], v[48:51], a[16:31]
ds_read_b64_tr_b16 v[148:149], v203 offset:18432
buffer_load_dwordx4 v[36:39], v205, s[40:43], s48 offen offset:3072 sc1
s_add_u32 s48, s48, 4096
v_mfma_f32_32x32x16_bf16 a[48:63], v[180:183], v[52:55], a[48:63]
ds_read_b64_tr_b16 v[150:151], v203 offset:19456
s_waitcnt lgkmcnt(8)
v_mfma_f32_32x32x16_bf16 a[0:15], v[184:187], v[56:59], a[0:15]
s_waitcnt vmcnt(19)
s_barrier
ds_read_b64_tr_b16 v[152:153], v202 offset:20480
v_mfma_f32_32x32x16_bf16 a[32:47], v[184:187], v[60:63], a[32:47]
ds_read_b64_tr_b16 v[154:155], v202 offset:21504
s_add_u32 m0, s52, 12288
s_nop 0
buffer_load_dwordx4 v206, s[44:47], s49 offen lds
s_add_u32 s49, s49, s54
v_mfma_f32_32x32x16_bf16 a[16:31], v[188:191], v[56:59], a[16:31]
ds_read_b64_tr_b16 v[156:157], v203 offset:20480
buffer_load_dwordx4 v[40:43], v204, s[40:43], s48 offen offset:0 sc1
v_mfma_f32_32x32x16_bf16 a[48:63], v[188:191], v[60:63], a[48:63]
ds_read_b64_tr_b16 v[158:159], v203 offset:21504
buffer_load_dwordx4 v[44:47], v205, s[40:43], s48 offen offset:0 sc1
v_mfma_f32_32x32x16_bf16 a[0:15], v[192:195], v[64:67], a[0:15]
ds_read_b64_tr_b16 v[160:161], v202 offset:22528
v_mfma_f32_32x32x16_bf16 a[32:47], v[192:195], v[68:71], a[32:47]
ds_read_b64_tr_b16 v[162:163], v202 offset:23552
buffer_load_dwordx4 v[48:51], v204, s[40:43], s48 offen offset:1024 sc1
v_mfma_f32_32x32x16_bf16 a[16:31], v[196:199], v[64:67], a[16:31]
ds_read_b64_tr_b16 v[164:165], v203 offset:22528
buffer_load_dwordx4 v[52:55], v205, s[40:43], s48 offen offset:1024 sc1
v_mfma_f32_32x32x16_bf16 a[48:63], v[196:199], v[68:71], a[48:63]
ds_read_b64_tr_b16 v[166:167], v203 offset:23552
s_waitcnt lgkmcnt(8)
v_mfma_f32_32x32x16_bf16 a[0:15], v[136:139], v[72:75], a[0:15]
s_waitcnt vmcnt(20)
s_barrier
ds_read_b64_tr_b16 v[168:169], v202 offset:24576
v_mfma_f32_32x32x16_bf16 a[32:47], v[136:139], v[76:79], a[32:47]
ds_read_b64_tr_b16 v[170:171], v202 offset:25600
s_add_u32 m0, s52, 16384
s_nop 0
buffer_load_dwordx4 v206, s[44:47], s49 offen lds
s_add_u32 s49, s49, s54
v_mfma_f32_32x32x16_bf16 a[16:31], v[140:143], v[72:75], a[16:31]
ds_read_b64_tr_b16 v[172:173], v203 offset:24576
buffer_load_dwordx4 v[56:59], v204, s[40:43], s48 offen offset:2048 sc1
v_mfma_f32_32x32x16_bf16 a[48:63], v[140:143], v[76:79], a[48:63]
ds_read_b64_tr_b16 v[174:175], v203 offset:25600
buffer_load_dwordx4 v[60:63], v205, s[40:43], s48 offen offset:2048 sc1
v_mfma_f32_32x32x16_bf16 a[0:15], v[144:147], v[80:83], a[0:15]
ds_read_b64_tr_b16 v[176:177], v202 offset:26624
v_mfma_f32_32x32x16_bf16 a[32:47], v[144:147], v[84:87], a[32:47]
ds_read_b64_tr_b16 v[178:179], v202 offset:27648
buffer_load_dwordx4 v[64:67], v204, s[40:43], s48 offen offset:3072 sc1
v_mfma_f32_32x32x16_bf16 a[16:31], v[148:151], v[80:83], a[16:31]
ds_read_b64_tr_b16 v[180:181], v203 offset:26624
buffer_load_dwordx4 v[68:71], v205, s[40:43], s48 offen offset:3072 sc1
s_add_u32 s48, s48, 4096
v_mfma_f32_32x32x16_bf16 a[48:63], v[148:151], v[84:87], a[48:63]
ds_read_b64_tr_b16 v[182:183], v203 offset:27648
s_waitcnt lgkmcnt(8)
v_mfma_f32_32x32x16_bf16 a[0:15], v[152:155], v[88:91], a[0:15]
s_waitcnt vmcnt(20)
s_barrier
ds_read_b64_tr_b16 v[184:185], v202 offset:28672
v_mfma_f32_32x32x16_bf16 a[32:47], v[152:155], v[92:95], a[32:47]
ds_read_b64_tr_b16 v[186:187], v202 offset:29696
s_add_u32 m0, s52, 20480
s_nop 0
buffer_load_dwordx4 v206, s[44:47], s49 offen lds
s_add_u32 s49, s49, s54
v_mfma_f32_32x32x16_bf16 a[16:31], v[156:159], v[88:91], a[16:31]
ds_read_b64_tr_b16 v[188:189], v203 offset:28672
buffer_load_dwordx4 v[72:75], v204, s[40:43], s48 offen offset:0 sc1
v_mfma_f32_32x32x16_bf16 a[48:63], v[156:159], v[92:95], a[48:63]
ds_read_b64_tr_b16 v[190:191], v203 offset:29696
buffer_load_dwordx4 v[76:79], v205, s[40:43], s48 offen offset:0 sc1
v_mfma_f32_32x32x16_bf16 a[0:15], v[160:163], v[96:99], a[0:15]
ds_read_b64_tr_b16 v[192:193], v202 offset:30720
v_mfma_f32_32x32x16_bf16 a[32:47], v[160:163], v[100:103], a[32:47]
ds_read_b64_tr_b16 v[194:195], v202 offset:31744
buffer_load_dwordx4 v[80:83], v204, s[40:43], s48 offen offset:1024 sc1
v_mfma_f32_32x32x16_bf16 a[16:31], v[164:167], v[96:99], a[16:31]
ds_read_b64_tr_b16 v[196:197], v203 offset:30720
buffer_load_dwordx4 v[84:87], v205, s[40:43], s48 offen offset:1024 sc1
v_mfma_f32_32x32x16_bf16 a[48:63], v[164:167], v[100:103], a[48:63]
ds_read_b64_tr_b16 v[198:199], v203 offset:31744
s_waitcnt lgkmcnt(8)
v_mfma_f32_32x32x16_bf16 a[0:15], v[168:171], v[104:107], a[0:15]
s_waitcnt vmcnt(20)
s_barrier
s_add_u32 s58, s51, s56
s_add_u32 s51, s51, 32768
s_cmp_eq_u32 s51, 131072
s_cselect_b32 s51, 0, s51
v_add_u32 v202, s51, v200
v_add_u32 v203, s51, v201
ds_read_b64_tr_b16 v[136:137], v202 offset:0
v_mfma_f32_32x32x16_bf16 a[32:47], v[168:171], v[108:111], a[32:47]
ds_read_b64_tr_b16 v[138:139], v202 offset:1024
s_add_u32 m0, s52, 24576
s_nop 0
buffer_load_dwordx4 v206, s[44:47], s49 offen lds
s_add_u32 s49, s49, s54
v_mfma_f32_32x32x16_bf16 a[16:31], v[172:175], v[104:107], a[16:31]
ds_read_b64_tr_b16 v[140:141], v203 offset:0
buffer_load_dwordx4 v[88:91], v204, s[40:43], s48 offen offset:2048 sc1
v_mfma_f32_32x32x16_bf16 a[48:63], v[172:175], v[108:111], a[48:63]
ds_read_b64_tr_b16 v[142:143], v203 offset:1024
buffer_load_dwordx4 v[92:95], v205, s[40:43], s48 offen offset:2048 sc1
v_mfma_f32_32x32x16_bf16 a[0:15], v[176:179], v[112:115], a[0:15]
ds_read_b64_tr_b16 v[144:145], v202 offset:2048
v_mfma_f32_32x32x16_bf16 a[32:47], v[176:179], v[116:119], a[32:47]
ds_read_b64_tr_b16 v[146:147], v202 offset:3072
buffer_load_dwordx4 v[96:99], v204, s[40:43], s48 offen offset:3072 sc1
v_mfma_f32_32x32x16_bf16 a[16:31], v[180:183], v[112:115], a[16:31]
ds_read_b64_tr_b16 v[148:149], v203 offset:2048
buffer_load_dwordx4 v[100:103], v205, s[40:43], s48 offen offset:3072 sc1
s_add_u32 s48, s48, 4096
v_mfma_f32_32x32x16_bf16 a[48:63], v[180:183], v[116:119], a[48:63]
ds_read_b64_tr_b16 v[150:151], v203 offset:3072
s_waitcnt lgkmcnt(8)
v_mfma_f32_32x32x16_bf16 a[0:15], v[184:187], v[120:123], a[0:15]
s_waitcnt vmcnt(20)
s_barrier
ds_read_b64_tr_b16 v[152:153], v202 offset:4096
v_mfma_f32_32x32x16_bf16 a[32:47], v[184:187], v[124:127], a[32:47]
ds_read_b64_tr_b16 v[154:155], v202 offset:5120
s_add_u32 m0, s52, 28672
s_nop 0
buffer_load_dwordx4 v206, s[44:47], s49 offen lds
s_add_u32 s49, s49, s54
v_mfma_f32_32x32x16_bf16 a[16:31], v[188:191], v[120:123], a[16:31]
ds_read_b64_tr_b16 v[156:157], v203 offset:4096
buffer_load_dwordx4 v[104:107], v204, s[40:43], s48 offen offset:0 sc1
v_mfma_f32_32x32x16_bf16 a[48:63], v[188:191], v[124:127], a[48:63]
ds_read_b64_tr_b16 v[158:159], v203 offset:5120
buffer_load_dwordx4 v[108:111], v205, s[40:43], s48 offen offset:0 sc1
v_mfma_f32_32x32x16_bf16 a[0:15], v[192:195], v[128:131], a[0:15]
ds_read_b64_tr_b16 v[160:161], v202 offset:6144
v_mfma_f32_32x32x16_bf16 a[32:47], v[192:195], v[132:135], a[32:47]
ds_read_b64_tr_b16 v[162:163], v202 offset:7168
buffer_load_dwordx4 v[112:115], v204, s[40:43], s48 offen offset:1024 sc1
v_mfma_f32_32x32x16_bf16 a[16:31], v[196:199], v[128:131], a[16:31]
ds_read_b64_tr_b16 v[164:165], v203 offset:6144
buffer_load_dwordx4 v[116:119], v205, s[40:43], s48 offen offset:1024 sc1
v_mfma_f32_32x32x16_bf16 a[48:63], v[196:199], v[132:135], a[48:63]
ds_read_b64_tr_b16 v[166:167], v203 offset:7168
s_sub_u32 s50, s50, 8
s_mov_b32 s52, s58
s_cmp_le_u32 s50, 24
s_cbranch_scc1 .LgB_396
.LgD_395:
s_waitcnt lgkmcnt(8)
v_mfma_f32_32x32x16_bf16 a[0:15], v[136:139], v[8:11], a[0:15]
s_waitcnt vmcnt(20)
s_barrier
ds_read_b64_tr_b16 v[168:169], v202 offset:8192
v_mfma_f32_32x32x16_bf16 a[32:47], v[136:139], v[12:15], a[32:47]
ds_read_b64_tr_b16 v[170:171], v202 offset:9216
s_add_u32 m0, s52, 0
s_nop 0
buffer_load_dwordx4 v206, s[44:47], s49 offen lds
s_add_u32 s49, s49, s54
v_mfma_f32_32x32x16_bf16 a[16:31], v[140:143], v[8:11], a[16:31]
ds_read_b64_tr_b16 v[172:173], v203 offset:8192
buffer_load_dwordx4 v[120:123], v204, s[40:43], s48 offen offset:2048 sc1
v_mfma_f32_32x32x16_bf16 a[48:63], v[140:143], v[12:15], a[48:63]
ds_read_b64_tr_b16 v[174:175], v203 offset:9216
buffer_load_dwordx4 v[124:127], v205, s[40:43], s48 offen offset:2048 sc1
v_mfma_f32_32x32x16_bf16 a[0:15], v[144:147], v[16:19], a[0:15]
ds_read_b64_tr_b16 v[176:177], v202 offset:10240
v_mfma_f32_32x32x16_bf16 a[32:47], v[144:147], v[20:23], a[32:47]
ds_read_b64_tr_b16 v[178:179], v202 offset:11264
buffer_load_dwordx4 v[128:131], v204, s[40:43], s48 offen offset:3072 sc1
v_mfma_f32_32x32x16_bf16 a[16:31], v[148:151], v[16:19], a[16:31]
ds_read_b64_tr_b16 v[180:181], v203 offset:10240
buffer_load_dwordx4 v[132:135], v205, s[40:43], s48 offen offset:3072 sc1
s_add_u32 s48, s48, 4096
v_mfma_f32_32x32x16_bf16 a[48:63], v[148:151], v[20:23], a[48:63]
ds_read_b64_tr_b16 v[182:183], v203 offset:11264
s_waitcnt lgkmcnt(8)
v_mfma_f32_32x32x16_bf16 a[0:15], v[152:155], v[24:27], a[0:15]
s_waitcnt vmcnt(20)
s_barrier
ds_read_b64_tr_b16 v[184:185], v202 offset:12288
v_mfma_f32_32x32x16_bf16 a[32:47], v[152:155], v[28:31], a[32:47]
ds_read_b64_tr_b16 v[186:187], v202 offset:13312
s_add_u32 m0, s52, 4096
s_nop 0
buffer_load_dwordx4 v206, s[44:47], s49 offen lds
s_add_u32 s49, s49, s54
v_mfma_f32_32x32x16_bf16 a[16:31], v[156:159], v[24:27], a[16:31]
ds_read_b64_tr_b16 v[188:189], v203 offset:12288
buffer_load_dwordx4 v[8:11], v204, s[40:43], s48 offen offset:0 sc1
v_mfma_f32_32x32x16_bf16 a[48:63], v[156:159], v[28:31], a[48:63]
ds_read_b64_tr_b16 v[190:191], v203 offset:13312
buffer_load_dwordx4 v[12:15], v205, s[40:43], s48 offen offset:0 sc1
v_mfma_f32_32x32x16_bf16 a[0:15], v[160:163], v[32:35], a[0:15]
ds_read_b64_tr_b16 v[192:193], v202 offset:14336
v_mfma_f32_32x32x16_bf16 a[32:47], v[160:163], v[36:39], a[32:47]
ds_read_b64_tr_b16 v[194:195], v202 offset:15360
buffer_load_dwordx4 v[16:19], v204, s[40:43], s48 offen offset:1024 sc1
v_mfma_f32_32x32x16_bf16 a[16:31], v[164:167], v[32:35], a[16:31]
ds_read_b64_tr_b16 v[196:197], v203 offset:14336
buffer_load_dwordx4 v[20:23], v205, s[40:43], s48 offen offset:1024 sc1
v_mfma_f32_32x32x16_bf16 a[48:63], v[164:167], v[36:39], a[48:63]
ds_read_b64_tr_b16 v[198:199], v203 offset:15360
s_waitcnt lgkmcnt(8)
v_mfma_f32_32x32x16_bf16 a[0:15], v[168:171], v[40:43], a[0:15]
s_waitcnt vmcnt(20)
s_barrier
ds_read_b64_tr_b16 v[136:137], v202 offset:16384
v_mfma_f32_32x32x16_bf16 a[32:47], v[168:171], v[44:47], a[32:47]
ds_read_b64_tr_b16 v[138:139], v202 offset:17408
s_add_u32 m0, s52, 8192
s_nop 0
buffer_load_dwordx4 v206, s[44:47], s49 offen lds
s_add_u32 s49, s49, s54
v_mfma_f32_32x32x16_bf16 a[16:31], v[172:175], v[40:43], a[16:31]
ds_read_b64_tr_b16 v[140:141], v203 offset:16384
buffer_load_dwordx4 v[24:27], v204, s[40:43], s48 offen offset:2048 sc1
v_mfma_f32_32x32x16_bf16 a[48:63], v[172:175], v[44:47], a[48:63]
ds_read_b64_tr_b16 v[142:143], v203 offset:17408
buffer_load_dwordx4 v[28:31], v205, s[40:43], s48 offen offset:2048 sc1
v_mfma_f32_32x32x16_bf16 a[0:15], v[176:179], v[48:51], a[0:15]
ds_read_b64_tr_b16 v[144:145], v202 offset:18432
v_mfma_f32_32x32x16_bf16 a[32:47], v[176:179], v[52:55], a[32:47]
ds_read_b64_tr_b16 v[146:147], v202 offset:19456
buffer_load_dwordx4 v[32:35], v204, s[40:43], s48 offen offset:3072 sc1
v_mfma_f32_32x32x16_bf16 a[16:31], v[180:183], v[48:51], a[16:31]
ds_read_b64_tr_b16 v[148:149], v203 offset:18432
buffer_load_dwordx4 v[36:39], v205, s[40:43], s48 offen offset:3072 sc1
s_add_u32 s48, s48, 4096
v_mfma_f32_32x32x16_bf16 a[48:63], v[180:183], v[52:55], a[48:63]
ds_read_b64_tr_b16 v[150:151], v203 offset:19456
s_waitcnt lgkmcnt(8)
v_mfma_f32_32x32x16_bf16 a[0:15], v[184:187], v[56:59], a[0:15]
s_waitcnt vmcnt(20)
s_barrier
ds_read_b64_tr_b16 v[152:153], v202 offset:20480
v_mfma_f32_32x32x16_bf16 a[32:47], v[184:187], v[60:63], a[32:47]
ds_read_b64_tr_b16 v[154:155], v202 offset:21504
s_add_u32 m0, s52, 12288
s_nop 0
buffer_load_dwordx4 v206, s[44:47], s49 offen lds
s_add_u32 s49, s49, s54
v_mfma_f32_32x32x16_bf16 a[16:31], v[188:191], v[56:59], a[16:31]
ds_read_b64_tr_b16 v[156:157], v203 offset:20480
buffer_load_dwordx4 v[40:43], v204, s[40:43], s48 offen offset:0 sc1
v_mfma_f32_32x32x16_bf16 a[48:63], v[188:191], v[60:63], a[48:63]
ds_read_b64_tr_b16 v[158:159], v203 offset:21504
buffer_load_dwordx4 v[44:47], v205, s[40:43], s48 offen offset:0 sc1
v_mfma_f32_32x32x16_bf16 a[0:15], v[192:195], v[64:67], a[0:15]
ds_read_b64_tr_b16 v[160:161], v202 offset:22528
v_mfma_f32_32x32x16_bf16 a[32:47], v[192:195], v[68:71], a[32:47]
ds_read_b64_tr_b16 v[162:163], v202 offset:23552
buffer_load_dwordx4 v[48:51], v204, s[40:43], s48 offen offset:1024 sc1
v_mfma_f32_32x32x16_bf16 a[16:31], v[196:199], v[64:67], a[16:31]
ds_read_b64_tr_b16 v[164:165], v203 offset:22528
buffer_load_dwordx4 v[52:55], v205, s[40:43], s48 offen offset:1024 sc1
v_mfma_f32_32x32x16_bf16 a[48:63], v[196:199], v[68:71], a[48:63]
ds_read_b64_tr_b16 v[166:167], v203 offset:23552
s_waitcnt lgkmcnt(8)
v_mfma_f32_32x32x16_bf16 a[0:15], v[136:139], v[72:75], a[0:15]
s_waitcnt vmcnt(20)
s_barrier
ds_read_b64_tr_b16 v[168:169], v202 offset:24576
v_mfma_f32_32x32x16_bf16 a[32:47], v[136:139], v[76:79], a[32:47]
ds_read_b64_tr_b16 v[170:171], v202 offset:25600
s_add_u32 m0, s52, 16384
s_nop 0
buffer_load_dwordx4 v206, s[44:47], s49 offen lds
s_add_u32 s49, s49, s54
v_mfma_f32_32x32x16_bf16 a[16:31], v[140:143], v[72:75], a[16:31]
ds_read_b64_tr_b16 v[172:173], v203 offset:24576
buffer_load_dwordx4 v[56:59], v204, s[40:43], s48 offen offset:2048 sc1
v_mfma_f32_32x32x16_bf16 a[48:63], v[140:143], v[76:79], a[48:63]
ds_read_b64_tr_b16 v[174:175], v203 offset:25600
buffer_load_dwordx4 v[60:63], v205, s[40:43], s48 offen offset:2048 sc1
v_mfma_f32_32x32x16_bf16 a[0:15], v[144:147], v[80:83], a[0:15]
ds_read_b64_tr_b16 v[176:177], v202 offset:26624
v_mfma_f32_32x32x16_bf16 a[32:47], v[144:147], v[84:87], a[32:47]
ds_read_b64_tr_b16 v[178:179], v202 offset:27648
buffer_load_dwordx4 v[64:67], v204, s[40:43], s48 offen offset:3072 sc1
v_mfma_f32_32x32x16_bf16 a[16:31], v[148:151], v[80:83], a[16:31]
ds_read_b64_tr_b16 v[180:181], v203 offset:26624
buffer_load_dwordx4 v[68:71], v205, s[40:43], s48 offen offset:3072 sc1
s_add_u32 s48, s48, 4096
v_mfma_f32_32x32x16_bf16 a[48:63], v[148:151], v[84:87], a[48:63]
ds_read_b64_tr_b16 v[182:183], v203 offset:27648
s_waitcnt lgkmcnt(8)
v_mfma_f32_32x32x16_bf16 a[0:15], v[152:155], v[88:91], a[0:15]
s_waitcnt vmcnt(20)
s_barrier
ds_read_b64_tr_b16 v[184:185], v202 offset:28672
v_mfma_f32_32x32x16_bf16 a[32:47], v[152:155], v[92:95], a[32:47]
ds_read_b64_tr_b16 v[186:187], v202 offset:29696
s_add_u32 m0, s52, 20480
s_nop 0
buffer_load_dwordx4 v206, s[44:47], s49 offen lds
s_add_u32 s49, s49, s54
v_mfma_f32_32x32x16_bf16 a[16:31], v[156:159], v[88:91], a[16:31]
ds_read_b64_tr_b16 v[188:189], v203 offset:28672
buffer_load_dwordx4 v[72:75], v204, s[40:43], s48 offen offset:0 sc1
v_mfma_f32_32x32x16_bf16 a[48:63], v[156:159], v[92:95], a[48:63]
ds_read_b64_tr_b16 v[190:191], v203 offset:29696
buffer_load_dwordx4 v[76:79], v205, s[40:43], s48 offen offset:0 sc1
v_mfma_f32_32x32x16_bf16 a[0:15], v[160:163], v[96:99], a[0:15]
ds_read_b64_tr_b16 v[192:193], v202 offset:30720
v_mfma_f32_32x32x16_bf16 a[32:47], v[160:163], v[100:103], a[32:47]
ds_read_b64_tr_b16 v[194:195], v202 offset:31744
buffer_load_dwordx4 v[80:83], v204, s[40:43], s48 offen offset:1024 sc1
v_mfma_f32_32x32x16_bf16 a[16:31], v[164:167], v[96:99], a[16:31]
ds_read_b64_tr_b16 v[196:197], v203 offset:30720
buffer_load_dwordx4 v[84:87], v205, s[40:43], s48 offen offset:1024 sc1
v_mfma_f32_32x32x16_bf16 a[48:63], v[164:167], v[100:103], a[48:63]
ds_read_b64_tr_b16 v[198:199], v203 offset:31744
s_waitcnt lgkmcnt(8)
v_mfma_f32_32x32x16_bf16 a[0:15], v[168:171], v[104:107], a[0:15]
s_waitcnt vmcnt(20)
s_barrier
s_add_u32 s58, s51, s56
s_add_u32 s51, s51, 32768
s_cmp_eq_u32 s51, 131072
s_cselect_b32 s51, 0, s51
v_add_u32 v202, s51, v200
v_add_u32 v203, s51, v201
ds_read_b64_tr_b16 v[136:137], v202 offset:0
v_mfma_f32_32x32x16_bf16 a[32:47], v[168:171], v[108:111], a[32:47]
ds_read_b64_tr_b16 v[138:139], v202 offset:1024
s_add_u32 m0, s52, 24576
s_nop 0
buffer_load_dwordx4 v206, s[44:47], s49 offen lds
s_add_u32 s49, s49, s54
v_mfma_f32_32x32x16_bf16 a[16:31], v[172:175], v[104:107], a[16:31]
ds_read_b64_tr_b16 v[140:141], v203 offset:0
buffer_load_dwordx4 v[88:91], v204, s[40:43], s48 offen offset:2048 sc1
v_mfma_f32_32x32x16_bf16 a[48:63], v[172:175], v[108:111], a[48:63]
ds_read_b64_tr_b16 v[142:143], v203 offset:1024
buffer_load_dwordx4 v[92:95], v205, s[40:43], s48 offen offset:2048 sc1
v_mfma_f32_32x32x16_bf16 a[0:15], v[176:179], v[112:115], a[0:15]
ds_read_b64_tr_b16 v[144:145], v202 offset:2048
v_mfma_f32_32x32x16_bf16 a[32:47], v[176:179], v[116:119], a[32:47]
ds_read_b64_tr_b16 v[146:147], v202 offset:3072
buffer_load_dwordx4 v[96:99], v204, s[40:43], s48 offen offset:3072 sc1
v_mfma_f32_32x32x16_bf16 a[16:31], v[180:183], v[112:115], a[16:31]
ds_read_b64_tr_b16 v[148:149], v203 offset:2048
buffer_load_dwordx4 v[100:103], v205, s[40:43], s48 offen offset:3072 sc1
s_add_u32 s48, s48, 4096
v_mfma_f32_32x32x16_bf16 a[48:63], v[180:183], v[116:119], a[48:63]
ds_read_b64_tr_b16 v[150:151], v203 offset:3072
s_waitcnt lgkmcnt(8)
v_mfma_f32_32x32x16_bf16 a[0:15], v[184:187], v[120:123], a[0:15]
s_waitcnt vmcnt(20)
s_barrier
ds_read_b64_tr_b16 v[152:153], v202 offset:4096
v_mfma_f32_32x32x16_bf16 a[32:47], v[184:187], v[124:127], a[32:47]
ds_read_b64_tr_b16 v[154:155], v202 offset:5120
s_add_u32 m0, s52, 28672
s_nop 0
buffer_load_dwordx4 v206, s[44:47], s49 offen lds
s_add_u32 s49, s49, s54
v_mfma_f32_32x32x16_bf16 a[16:31], v[188:191], v[120:123], a[16:31]
ds_read_b64_tr_b16 v[156:157], v203 offset:4096
buffer_load_dwordx4 v[104:107], v204, s[40:43], s48 offen offset:0 sc1
v_mfma_f32_32x32x16_bf16 a[48:63], v[188:191], v[124:127], a[48:63]
ds_read_b64_tr_b16 v[158:159], v203 offset:5120
buffer_load_dwordx4 v[108:111], v205, s[40:43], s48 offen offset:0 sc1
v_mfma_f32_32x32x16_bf16 a[0:15], v[192:195], v[128:131], a[0:15]
ds_read_b64_tr_b16 v[160:161], v202 offset:6144
v_mfma_f32_32x32x16_bf16 a[32:47], v[192:195], v[132:135], a[32:47]
ds_read_b64_tr_b16 v[162:163], v202 offset:7168
buffer_load_dwordx4 v[112:115], v204, s[40:43], s48 offen offset:1024 sc1
v_mfma_f32_32x32x16_bf16 a[16:31], v[196:199], v[128:131], a[16:31]
ds_read_b64_tr_b16 v[164:165], v203 offset:6144
buffer_load_dwordx4 v[116:119], v205, s[40:43], s48 offen offset:1024 sc1
v_mfma_f32_32x32x16_bf16 a[48:63], v[196:199], v[132:135], a[48:63]
ds_read_b64_tr_b16 v[166:167], v203 offset:7168
s_sub_u32 s50, s50, 8
s_mov_b32 s52, s58
s_cmp_gt_u32 s50, 24
s_cbranch_scc1 .LgD_395
.LgB_396:
s_waitcnt lgkmcnt(8)
v_mfma_f32_32x32x16_bf16 a[0:15], v[136:139], v[8:11], a[0:15]
s_waitcnt vmcnt(16)
s_barrier
ds_read_b64_tr_b16 v[168:169], v202 offset:8192
v_mfma_f32_32x32x16_bf16 a[32:47], v[136:139], v[12:15], a[32:47]
ds_read_b64_tr_b16 v[170:171], v202 offset:9216
buffer_load_dwordx4 v[120:123], v204, s[40:43], s48 offen offset:2048 sc1
v_mfma_f32_32x32x16_bf16 a[16:31], v[140:143], v[8:11], a[16:31]
ds_read_b64_tr_b16 v[172:173], v203 offset:8192
buffer_load_dwordx4 v[124:127], v205, s[40:43], s48 offen offset:2048 sc1
v_mfma_f32_32x32x16_bf16 a[48:63], v[140:143], v[12:15], a[48:63]
ds_read_b64_tr_b16 v[174:175], v203 offset:9216
buffer_load_dwordx4 v[128:131], v204, s[40:43], s48 offen offset:3072 sc1
v_mfma_f32_32x32x16_bf16 a[0:15], v[144:147], v[16:19], a[0:15]
ds_read_b64_tr_b16 v[176:177], v202 offset:10240
v_mfma_f32_32x32x16_bf16 a[32:47], v[144:147], v[20:23], a[32:47]
ds_read_b64_tr_b16 v[178:179], v202 offset:11264
buffer_load_dwordx4 v[132:135], v205, s[40:43], s48 offen offset:3072 sc1
s_add_u32 s48, s48, 4096
v_mfma_f32_32x32x16_bf16 a[16:31], v[148:151], v[16:19], a[16:31]
ds_read_b64_tr_b16 v[180:181], v203 offset:10240
s_cmp_eq_u32 s50, 8
s_cselect_b32 s42, 0, s42
v_mfma_f32_32x32x16_bf16 a[48:63], v[148:151], v[20:23], a[48:63]
ds_read_b64_tr_b16 v[182:183], v203 offset:11264
s_waitcnt lgkmcnt(8)
v_mfma_f32_32x32x16_bf16 a[0:15], v[152:155], v[24:27], a[0:15]
s_waitcnt vmcnt(16)
s_barrier
ds_read_b64_tr_b16 v[184:185], v202 offset:12288
v_mfma_f32_32x32x16_bf16 a[32:47], v[152:155], v[28:31], a[32:47]
ds_read_b64_tr_b16 v[186:187], v202 offset:13312
buffer_load_dwordx4 v[8:11], v204, s[40:43], s48 offen offset:0 sc1
v_mfma_f32_32x32x16_bf16 a[16:31], v[156:159], v[24:27], a[16:31]
ds_read_b64_tr_b16 v[188:189], v203 offset:12288
buffer_load_dwordx4 v[12:15], v205, s[40:43], s48 offen offset:0 sc1
v_mfma_f32_32x32x16_bf16 a[48:63], v[156:159], v[28:31], a[48:63]
ds_read_b64_tr_b16 v[190:191], v203 offset:13312
v_mfma_f32_32x32x16_bf16 a[0:15], v[160:163], v[32:35], a[0:15]
ds_read_b64_tr_b16 v[192:193], v202 offset:14336
buffer_load_dwordx4 v[16:19], v204, s[40:43], s48 offen offset:1024 sc1
v_mfma_f32_32x32x16_bf16 a[32:47], v[160:163], v[36:39], a[32:47]
ds_read_b64_tr_b16 v[194:195], v202 offset:15360
v_mfma_f32_32x32x16_bf16 a[16:31], v[164:167], v[32:35], a[16:31]
ds_read_b64_tr_b16 v[196:197], v203 offset:14336
buffer_load_dwordx4 v[20:23], v205, s[40:43], s48 offen offset:1024 sc1
v_mfma_f32_32x32x16_bf16 a[48:63], v[164:167], v[36:39], a[48:63]
ds_read_b64_tr_b16 v[198:199], v203 offset:15360
s_waitcnt lgkmcnt(8)
v_mfma_f32_32x32x16_bf16 a[0:15], v[168:171], v[40:43], a[0:15]
s_waitcnt vmcnt(16)
s_barrier
ds_read_b64_tr_b16 v[136:137], v202 offset:16384
v_mfma_f32_32x32x16_bf16 a[32:47], v[168:171], v[44:47], a[32:47]
ds_read_b64_tr_b16 v[138:139], v202 offset:17408
buffer_load_dwordx4 v[24:27], v204, s[40:43], s48 offen offset:2048 sc1
v_mfma_f32_32x32x16_bf16 a[16:31], v[172:175], v[40:43], a[16:31]
ds_read_b64_tr_b16 v[140:141], v203 offset:16384
buffer_load_dwordx4 v[28:31], v205, s[40:43], s48 offen offset:2048 sc1
v_mfma_f32_32x32x16_bf16 a[48:63], v[172:175], v[44:47], a[48:63]
ds_read_b64_tr_b16 v[142:143], v203 offset:17408
v_mfma_f32_32x32x16_bf16 a[0:15], v[176:179], v[48:51], a[0:15]
ds_read_b64_tr_b16 v[144:145], v202 offset:18432
buffer_load_dwordx4 v[32:35], v204, s[40:43], s48 offen offset:3072 sc1
v_mfma_f32_32x32x16_bf16 a[32:47], v[176:179], v[52:55], a[32:47]
ds_read_b64_tr_b16 v[146:147], v202 offset:19456
v_mfma_f32_32x32x16_bf16 a[16:31], v[180:183], v[48:51], a[16:31]
ds_read_b64_tr_b16 v[148:149], v203 offset:18432
buffer_load_dwordx4 v[36:39], v205, s[40:43], s48 offen offset:3072 sc1
s_add_u32 s48, s48, 4096
v_mfma_f32_32x32x16_bf16 a[48:63], v[180:183], v[52:55], a[48:63]
ds_read_b64_tr_b16 v[150:151], v203 offset:19456
s_waitcnt lgkmcnt(8)
v_mfma_f32_32x32x16_bf16 a[0:15], v[184:187], v[56:59], a[0:15]
s_waitcnt vmcnt(16)
s_barrier
ds_read_b64_tr_b16 v[152:153], v202 offset:20480
v_mfma_f32_32x32x16_bf16 a[32:47], v[184:187], v[60:63], a[32:47]
ds_read_b64_tr_b16 v[154:155], v202 offset:21504
buffer_load_dwordx4 v[40:43], v204, s[40:43], s48 offen offset:0 sc1
v_mfma_f32_32x32x16_bf16 a[16:31], v[188:191], v[56:59], a[16:31]
ds_read_b64_tr_b16 v[156:157], v203 offset:20480
buffer_load_dwordx4 v[44:47], v205, s[40:43], s48 offen offset:0 sc1
v_mfma_f32_32x32x16_bf16 a[48:63], v[188:191], v[60:63], a[48:63]
ds_read_b64_tr_b16 v[158:159], v203 offset:21504
v_mfma_f32_32x32x16_bf16 a[0:15], v[192:195], v[64:67], a[0:15]
ds_read_b64_tr_b16 v[160:161], v202 offset:22528
buffer_load_dwordx4 v[48:51], v204, s[40:43], s48 offen offset:1024 sc1
v_mfma_f32_32x32x16_bf16 a[32:47], v[192:195], v[68:71], a[32:47]
ds_read_b64_tr_b16 v[162:163], v202 offset:23552
v_mfma_f32_32x32x16_bf16 a[16:31], v[196:199], v[64:67], a[16:31]
ds_read_b64_tr_b16 v[164:165], v203 offset:22528
buffer_load_dwordx4 v[52:55], v205, s[40:43], s48 offen offset:1024 sc1
v_mfma_f32_32x32x16_bf16 a[48:63], v[196:199], v[68:71], a[48:63]
ds_read_b64_tr_b16 v[166:167], v203 offset:23552
s_waitcnt lgkmcnt(8)
v_mfma_f32_32x32x16_bf16 a[0:15], v[136:139], v[72:75], a[0:15]
s_waitcnt vmcnt(16)
s_barrier
ds_read_b64_tr_b16 v[168:169], v202 offset:24576
v_mfma_f32_32x32x16_bf16 a[32:47], v[136:139], v[76:79], a[32:47]
ds_read_b64_tr_b16 v[170:171], v202 offset:25600
buffer_load_dwordx4 v[56:59], v204, s[40:43], s48 offen offset:2048 sc1
v_mfma_f32_32x32x16_bf16 a[16:31], v[140:143], v[72:75], a[16:31]
ds_read_b64_tr_b16 v[172:173], v203 offset:24576
buffer_load_dwordx4 v[60:63], v205, s[40:43], s48 offen offset:2048 sc1
v_mfma_f32_32x32x16_bf16 a[48:63], v[140:143], v[76:79], a[48:63]
ds_read_b64_tr_b16 v[174:175], v203 offset:25600
v_mfma_f32_32x32x16_bf16 a[0:15], v[144:147], v[80:83], a[0:15]
ds_read_b64_tr_b16 v[176:177], v202 offset:26624
buffer_load_dwordx4 v[64:67], v204, s[40:43], s48 offen offset:3072 sc1
v_mfma_f32_32x32x16_bf16 a[32:47], v[144:147], v[84:87], a[32:47]
ds_read_b64_tr_b16 v[178:179], v202 offset:27648
v_mfma_f32_32x32x16_bf16 a[16:31], v[148:151], v[80:83], a[16:31]
ds_read_b64_tr_b16 v[180:181], v203 offset:26624
buffer_load_dwordx4 v[68:71], v205, s[40:43], s48 offen offset:3072 sc1
s_add_u32 s48, s48, 4096
v_mfma_f32_32x32x16_bf16 a[48:63], v[148:151], v[84:87], a[48:63]
ds_read_b64_tr_b16 v[182:183], v203 offset:27648
s_waitcnt lgkmcnt(8)
v_mfma_f32_32x32x16_bf16 a[0:15], v[152:155], v[88:91], a[0:15]
s_waitcnt vmcnt(16)
s_barrier
ds_read_b64_tr_b16 v[184:185], v202 offset:28672
v_mfma_f32_32x32x16_bf16 a[32:47], v[152:155], v[92:95], a[32:47]
ds_read_b64_tr_b16 v[186:187], v202 offset:29696
buffer_load_dwordx4 v[72:75], v204, s[40:43], s48 offen offset:0 sc1
v_mfma_f32_32x32x16_bf16 a[16:31], v[156:159], v[88:91], a[16:31]
ds_read_b64_tr_b16 v[188:189], v203 offset:28672
buffer_load_dwordx4 v[76:79], v205, s[40:43], s48 offen offset:0 sc1
v_mfma_f32_32x32x16_bf16 a[48:63], v[156:159], v[92:95], a[48:63]
ds_read_b64_tr_b16 v[190:191], v203 offset:29696
v_mfma_f32_32x32x16_bf16 a[0:15], v[160:163], v[96:99], a[0:15]
ds_read_b64_tr_b16 v[192:193], v202 offset:30720
buffer_load_dwordx4 v[80:83], v204, s[40:43], s48 offen offset:1024 sc1
v_mfma_f32_32x32x16_bf16 a[32:47], v[160:163], v[100:103], a[32:47]
ds_read_b64_tr_b16 v[194:195], v202 offset:31744
v_mfma_f32_32x32x16_bf16 a[16:31], v[164:167], v[96:99], a[16:31]
ds_read_b64_tr_b16 v[196:197], v203 offset:30720
buffer_load_dwordx4 v[84:87], v205, s[40:43], s48 offen offset:1024 sc1
v_mfma_f32_32x32x16_bf16 a[48:63], v[164:167], v[100:103], a[48:63]
ds_read_b64_tr_b16 v[198:199], v203 offset:31744
s_waitcnt lgkmcnt(8)
v_mfma_f32_32x32x16_bf16 a[0:15], v[168:171], v[104:107], a[0:15]
s_waitcnt vmcnt(16)
s_barrier
s_add_u32 s58, s51, s56
s_add_u32 s51, s51, 32768
s_cmp_eq_u32 s51, 131072
s_cselect_b32 s51, 0, s51
v_add_u32 v202, s51, v200
v_add_u32 v203, s51, v201
ds_read_b64_tr_b16 v[136:137], v202 offset:0
v_mfma_f32_32x32x16_bf16 a[32:47], v[168:171], v[108:111], a[32:47]
ds_read_b64_tr_b16 v[138:139], v202 offset:1024
buffer_load_dwordx4 v[88:91], v204, s[40:43], s48 offen offset:2048 sc1
v_mfma_f32_32x32x16_bf16 a[16:31], v[172:175], v[104:107], a[16:31]
ds_read_b64_tr_b16 v[140:141], v203 offset:0
buffer_load_dwordx4 v[92:95], v205, s[40:43], s48 offen offset:2048 sc1
v_mfma_f32_32x32x16_bf16 a[48:63], v[172:175], v[108:111], a[48:63]
ds_read_b64_tr_b16 v[142:143], v203 offset:1024
v_mfma_f32_32x32x16_bf16 a[0:15], v[176:179], v[112:115], a[0:15]
ds_read_b64_tr_b16 v[144:145], v202 offset:2048
buffer_load_dwordx4 v[96:99], v204, s[40:43], s48 offen offset:3072 sc1
v_mfma_f32_32x32x16_bf16 a[32:47], v[176:179], v[116:119], a[32:47]
ds_read_b64_tr_b16 v[146:147], v202 offset:3072
v_mfma_f32_32x32x16_bf16 a[16:31], v[180:183], v[112:115], a[16:31]
ds_read_b64_tr_b16 v[148:149], v203 offset:2048
buffer_load_dwordx4 v[100:103], v205, s[40:43], s48 offen offset:3072 sc1
s_add_u32 s48, s48, 4096
v_mfma_f32_32x32x16_bf16 a[48:63], v[180:183], v[116:119], a[48:63]
ds_read_b64_tr_b16 v[150:151], v203 offset:3072
s_waitcnt lgkmcnt(8)
v_mfma_f32_32x32x16_bf16 a[0:15], v[184:187], v[120:123], a[0:15]
s_waitcnt vmcnt(16)
s_barrier
ds_read_b64_tr_b16 v[152:153], v202 offset:4096
v_mfma_f32_32x32x16_bf16 a[32:47], v[184:187], v[124:127], a[32:47]
ds_read_b64_tr_b16 v[154:155], v202 offset:5120
buffer_load_dwordx4 v[104:107], v204, s[40:43], s48 offen offset:0 sc1
v_mfma_f32_32x32x16_bf16 a[16:31], v[188:191], v[120:123], a[16:31]
ds_read_b64_tr_b16 v[156:157], v203 offset:4096
buffer_load_dwordx4 v[108:111], v205, s[40:43], s48 offen offset:0 sc1
v_mfma_f32_32x32x16_bf16 a[48:63], v[188:191], v[124:127], a[48:63]
ds_read_b64_tr_b16 v[158:159], v203 offset:5120
v_mfma_f32_32x32x16_bf16 a[0:15], v[192:195], v[128:131], a[0:15]
ds_read_b64_tr_b16 v[160:161], v202 offset:6144
buffer_load_dwordx4 v[112:115], v204, s[40:43], s48 offen offset:1024 sc1
v_mfma_f32_32x32x16_bf16 a[32:47], v[192:195], v[132:135], a[32:47]
ds_read_b64_tr_b16 v[162:163], v202 offset:7168
v_mfma_f32_32x32x16_bf16 a[16:31], v[196:199], v[128:131], a[16:31]
ds_read_b64_tr_b16 v[164:165], v203 offset:6144
buffer_load_dwordx4 v[116:119], v205, s[40:43], s48 offen offset:1024 sc1
v_mfma_f32_32x32x16_bf16 a[48:63], v[196:199], v[132:135], a[48:63]
ds_read_b64_tr_b16 v[166:167], v203 offset:7168
s_sub_u32 s50, s50, 8
s_cmp_lg_u32 s50, 0
s_cbranch_scc1 .LgB_396
s_waitcnt vmcnt(0) lgkmcnt(0)
s_nop 15
s_add_u32 s57, s12, 0
v_accvgpr_read_b32 v8, a0
v_accvgpr_read_b32 v9, a1
v_accvgpr_read_b32 v10, a2
v_accvgpr_read_b32 v11, a3
v_accvgpr_read_b32 v12, a4
v_accvgpr_read_b32 v13, a5
v_accvgpr_read_b32 v14, a6
v_accvgpr_read_b32 v15, a7
v_max_f32 v8, 0, v8
v_max_f32 v9, 0, v9
v_max_f32 v10, 0, v10
v_max_f32 v11, 0, v11
v_max_f32 v12, 0, v12
v_max_f32 v13, 0, v13
v_max_f32 v14, 0, v14
v_max_f32 v15, 0, v15
v_cvt_pk_bf16_f32 v16, v8, v9
v_cvt_pk_bf16_f32 v17, v10, v11
v_cvt_pk_bf16_f32 v18, v12, v13
v_cvt_pk_bf16_f32 v19, v14, v15
buffer_store_dwordx4 v[16:19], v4, s[36:39], s57 offen offset:0 sc1
v_accvgpr_read_b32 v20, a8
v_accvgpr_read_b32 v21, a9
v_accvgpr_read_b32 v22, a10
v_accvgpr_read_b32 v23, a11
v_accvgpr_read_b32 v24, a12
v_accvgpr_read_b32 v25, a13
v_accvgpr_read_b32 v26, a14
v_accvgpr_read_b32 v27, a15
v_max_f32 v20, 0, v20
v_max_f32 v21, 0, v21
v_max_f32 v22, 0, v22
v_max_f32 v23, 0, v23
v_max_f32 v24, 0, v24
v_max_f32 v25, 0, v25
v_max_f32 v26, 0, v26
v_max_f32 v27, 0, v27
v_cvt_pk_bf16_f32 v28, v20, v21
v_cvt_pk_bf16_f32 v29, v22, v23
v_cvt_pk_bf16_f32 v30, v24, v25
v_cvt_pk_bf16_f32 v31, v26, v27
buffer_store_dwordx4 v[28:31], v4, s[36:39], s57 offen offset:1024 sc1
v_accvgpr_read_b32 v8, a16
v_accvgpr_read_b32 v9, a17
v_accvgpr_read_b32 v10, a18
v_accvgpr_read_b32 v11, a19
v_accvgpr_read_b32 v12, a20
v_accvgpr_read_b32 v13, a21
v_accvgpr_read_b32 v14, a22
v_accvgpr_read_b32 v15, a23
v_max_f32 v8, 0, v8
v_max_f32 v9, 0, v9
v_max_f32 v10, 0, v10
v_max_f32 v11, 0, v11
v_max_f32 v12, 0, v12
v_max_f32 v13, 0, v13
v_max_f32 v14, 0, v14
v_max_f32 v15, 0, v15
v_cvt_pk_bf16_f32 v16, v8, v9
v_cvt_pk_bf16_f32 v17, v10, v11
v_cvt_pk_bf16_f32 v18, v12, v13
v_cvt_pk_bf16_f32 v19, v14, v15
buffer_store_dwordx4 v[16:19], v4, s[36:39], s57 offen offset:2048 sc1
v_accvgpr_read_b32 v20, a24
v_accvgpr_read_b32 v21, a25
v_accvgpr_read_b32 v22, a26
v_accvgpr_read_b32 v23, a27
v_accvgpr_read_b32 v24, a28
v_accvgpr_read_b32 v25, a29
v_accvgpr_read_b32 v26, a30
v_accvgpr_read_b32 v27, a31
v_max_f32 v20, 0, v20
v_max_f32 v21, 0, v21
v_max_f32 v22, 0, v22
v_max_f32 v23, 0, v23
v_max_f32 v24, 0, v24
v_max_f32 v25, 0, v25
v_max_f32 v26, 0, v26
v_max_f32 v27, 0, v27
v_cvt_pk_bf16_f32 v28, v20, v21
v_cvt_pk_bf16_f32 v29, v22, v23
v_cvt_pk_bf16_f32 v30, v24, v25
v_cvt_pk_bf16_f32 v31, v26, v27
buffer_store_dwordx4 v[28:31], v4, s[36:39], s57 offen offset:3072 sc1
s_add_u32 s57, s12, 229376
v_accvgpr_read_b32 v8, a32
v_accvgpr_read_b32 v9, a33
v_accvgpr_read_b32 v10, a34
v_accvgpr_read_b32 v11, a35
v_accvgpr_read_b32 v12, a36
v_accvgpr_read_b32 v13, a37
v_accvgpr_read_b32 v14, a38
v_accvgpr_read_b32 v15, a39
v_max_f32 v8, 0, v8
v_max_f32 v9, 0, v9
v_max_f32 v10, 0, v10
v_max_f32 v11, 0, v11
v_max_f32 v12, 0, v12
v_max_f32 v13, 0, v13
v_max_f32 v14, 0, v14
v_max_f32 v15, 0, v15
v_cvt_pk_bf16_f32 v16, v8, v9
v_cvt_pk_bf16_f32 v17, v10, v11
v_cvt_pk_bf16_f32 v18, v12, v13
v_cvt_pk_bf16_f32 v19, v14, v15
buffer_store_dwordx4 v[16:19], v4, s[36:39], s57 offen offset:0 sc1
v_accvgpr_read_b32 v20, a40
v_accvgpr_read_b32 v21, a41
v_accvgpr_read_b32 v22, a42
v_accvgpr_read_b32 v23, a43
v_accvgpr_read_b32 v24, a44
v_accvgpr_read_b32 v25, a45
v_accvgpr_read_b32 v26, a46
v_accvgpr_read_b32 v27, a47
v_max_f32 v20, 0, v20
v_max_f32 v21, 0, v21
v_max_f32 v22, 0, v22
v_max_f32 v23, 0, v23
v_max_f32 v24, 0, v24
v_max_f32 v25, 0, v25
v_max_f32 v26, 0, v26
v_max_f32 v27, 0, v27
v_cvt_pk_bf16_f32 v28, v20, v21
v_cvt_pk_bf16_f32 v29, v22, v23
v_cvt_pk_bf16_f32 v30, v24, v25
v_cvt_pk_bf16_f32 v31, v26, v27
buffer_store_dwordx4 v[28:31], v4, s[36:39], s57 offen offset:1024 sc1
v_accvgpr_read_b32 v8, a48
v_accvgpr_read_b32 v9, a49
v_accvgpr_read_b32 v10, a50
v_accvgpr_read_b32 v11, a51
v_accvgpr_read_b32 v12, a52
v_accvgpr_read_b32 v13, a53
v_accvgpr_read_b32 v14, a54
v_accvgpr_read_b32 v15, a55
v_max_f32 v8, 0, v8
v_max_f32 v9, 0, v9
v_max_f32 v10, 0, v10
v_max_f32 v11, 0, v11
v_max_f32 v12, 0, v12
v_max_f32 v13, 0, v13
v_max_f32 v14, 0, v14
v_max_f32 v15, 0, v15
v_cvt_pk_bf16_f32 v16, v8, v9
v_cvt_pk_bf16_f32 v17, v10, v11
v_cvt_pk_bf16_f32 v18, v12, v13
v_cvt_pk_bf16_f32 v19, v14, v15
buffer_store_dwordx4 v[16:19], v4, s[36:39], s57 offen offset:2048 sc1
v_accvgpr_read_b32 v20, a56
v_accvgpr_read_b32 v21, a57
v_accvgpr_read_b32 v22, a58
v_accvgpr_read_b32 v23, a59
v_accvgpr_read_b32 v24, a60
v_accvgpr_read_b32 v25, a61
v_accvgpr_read_b32 v26, a62
v_accvgpr_read_b32 v27, a63
v_max_f32 v20, 0, v20
v_max_f32 v21, 0, v21
v_max_f32 v22, 0, v22
v_max_f32 v23, 0, v23
v_max_f32 v24, 0, v24
v_max_f32 v25, 0, v25
v_max_f32 v26, 0, v26
v_max_f32 v27, 0, v27
v_cvt_pk_bf16_f32 v28, v20, v21
v_cvt_pk_bf16_f32 v29, v22, v23
v_cvt_pk_bf16_f32 v30, v24, v25
v_cvt_pk_bf16_f32 v31, v26, v27
buffer_store_dwordx4 v[28:31], v4, s[36:39], s57 offen offset:3072 sc1
s_add_u32 s86, s70, 119573504
s_bfe_u32 s82, s87, 0x10000
s_mul_i32 s82, s82, 128
s_add_u32 s86, s86, s82
s_waitcnt vmcnt(0)
s_barrier
s_cmp_lg_u32 s3, 0
s_cbranch_scc1 .Lsg_397
v_mov_b32 v1, 1
v_mul_u32_u24 v2, 0, v0
s_mov_b64 exec, 1
buffer_atomic_add v1, v2, s[88:91], s86 offen sc1
s_mov_b64 exec, -1
.Lsg_397:
.Lnf_391:
s_and_b32 s84, s77, 1
s_add_u32 s84, s84, 12
s_lshr_b32 s85, s77, 1
s_add_u32 s86, s70, 119573504
s_bfe_u32 s82, s87, 0x10000
s_mul_i32 s82, s82, 128
s_add_u32 s86, s86, s82
s_load_dwordx2 s[6:7], s[0:1], 72
s_add_u32 s40, s4, 0x5000000
s_addc_u32 s41, s5, 0
s_mov_b32 s42, 0xe00000
s_mov_b32 s43, 0x00020000
s_and_b32 s18, s85, 7
s_mov_b32 s19, 2048
s_cmp_eq_u32 s18, 3
s_cselect_b32 s19, 128, s19
v_lshrrev_b32 v142, 2, v0
v_and_b32 v142, 3, v142
v_lshrrev_b32 v143, 5, v0
v_lshlrev_b32 v143, 2, v143
v_add_u32 v143, v143, v142
v_mul_u32_u24 v143, 128, v143
v_and_b32 v144, 3, v0
v_lshlrev_b32 v144, 3, v144
v_add_u32 v143, v143, v144
v_and_b32 v144, 16, v0
v_lshlrev_b32 v144, 1, v144
v_add_u32 v143, v143, v144
v_lshrrev_b32 v142, 1, v142
s_and_b32 s53, s3, 0
s_mul_i32 s53, s53, 2
s_add_u32 s57, s53, 0
v_xor_b32 v144, s57, v142
v_lshlrev_b32 v144, 6, v144
v_add_u32 v136, v143, v144
s_add_u32 s57, s53, 1
v_xor_b32 v144, s57, v142
v_lshlrev_b32 v144, 6, v144
v_add_u32 v137, v143, v144
s_lshr_b32 s53, s3, 0
s_mul_i32 s53, s53, 229376
v_lshlrev_b32 v140, 4, v0
v_add_u32 v140, s53, v140
v_lshrrev_b32 v142, 3, v0
s_mul_i32 s53, s3, 8
v_add_u32 v142, s53, v142
v_and_b32 v143, 3, v142
v_lshrrev_b32 v143, 1, v143
v_and_b32 v144, 7, v0
v_lshrrev_b32 v144, 2, v144
v_xor_b32 v143, v143, v144
v_lshlrev_b32 v143, 6, v143
v_and_b32 v144, 3, v0
v_lshlrev_b32 v144, 4, v144
v_add_u32 v143, v143, v144
s_mov_b32 s53, s19
v_mul_lo_u32 v142, v142, s53
v_add_u32 v141, v142, v143
s_mul_i32 s54, s53, 32
s_lshl_b32 s56, s3, 10
s_waitcnt lgkmcnt(0)
s_mul_i32 s48, s84, 917504
s_mul_i32 s49, s85, 128
s_mov_b32 s50, 112
s_add_u32 s16, s4, 114294784
s_addc_u32 s17, s5, 0
s_lshr_b32 s18, s85, 3
s_lshl_b32 s18, s18, 19
s_cmp_eq_u32 s19, 128
s_cselect_b32 s6, s16, s6
s_cselect_b32 s7, s17, s7
s_cselect_b32 s49, s18, s49
s_mul_i32 s18, s87, 56
s_mov_b32 s50, 56
s_lshl_b32 s16, s18, 11
s_add_u32 s48, s48, s16
s_mul_i32 s16, s18, s19
s_lshl_b32 s16, s16, 5
s_add_u32 s49, s49, s16
s_mov_b32 s44, s6
s_mov_b32 s45, s7
s_mov_b32 s46, 0x700000
s_mov_b32 s47, 0x00020000
s_add_u32 m0, s56, 0
s_nop 0
buffer_load_dwordx4 v141, s[44:47], s49 offen lds
s_add_u32 s49, s49, s54
s_add_u32 m0, s56, 4096
s_nop 0
buffer_load_dwordx4 v141, s[44:47], s49 offen lds
s_add_u32 s49, s49, s54
s_add_u32 m0, s56, 8192
s_nop 0
buffer_load_dwordx4 v141, s[44:47], s49 offen lds
s_add_u32 s49, s49, s54
s_add_u32 m0, s56, 12288
s_nop 0
buffer_load_dwordx4 v141, s[44:47], s49 offen lds
s_add_u32 s49, s49, s54
s_add_u32 m0, s56, 16384
s_nop 0
buffer_load_dwordx4 v141, s[44:47], s49 offen lds
s_add_u32 s49, s49, s54
s_add_u32 m0, s56, 20480
s_nop 0
buffer_load_dwordx4 v141, s[44:47], s49 offen lds
s_add_u32 s49, s49, s54
s_add_u32 m0, s56, 24576
s_nop 0
buffer_load_dwordx4 v141, s[44:47], s49 offen lds
s_add_u32 s49, s49, s54
s_add_u32 m0, s56, 28672
s_nop 0
buffer_load_dwordx4 v141, s[44:47], s49 offen lds
s_add_u32 s49, s49, s54
s_add_u32 m0, s56, 32768
s_nop 0
buffer_load_dwordx4 v141, s[44:47], s49 offen lds
s_add_u32 s49, s49, s54
s_add_u32 m0, s56, 36864
s_nop 0
buffer_load_dwordx4 v141, s[44:47], s49 offen lds
s_add_u32 s49, s49, s54
s_add_u32 m0, s56, 40960
s_nop 0
buffer_load_dwordx4 v141, s[44:47], s49 offen lds
s_add_u32 s49, s49, s54
s_add_u32 m0, s56, 45056
s_nop 0
buffer_load_dwordx4 v141, s[44:47], s49 offen lds
s_add_u32 s49, s49, s54
s_add_u32 m0, s56, 49152
s_nop 0
buffer_load_dwordx4 v141, s[44:47], s49 offen lds
s_add_u32 s49, s49, s54
s_add_u32 m0, s56, 53248
s_nop 0
buffer_load_dwordx4 v141, s[44:47], s49 offen lds
s_add_u32 s49, s49, s54
s_add_u32 m0, s56, 57344
s_nop 0
buffer_load_dwordx4 v141, s[44:47], s49 offen lds
s_add_u32 s49, s49, s54
s_add_u32 m0, s56, 61440
s_nop 0
buffer_load_dwordx4 v141, s[44:47], s49 offen lds
s_add_u32 s49, s49, s54
s_add_u32 m0, s56, 65536
s_nop 0
buffer_load_dwordx4 v141, s[44:47], s49 offen lds
s_add_u32 s49, s49, s54
s_add_u32 m0, s56, 69632
s_nop 0
buffer_load_dwordx4 v141, s[44:47], s49 offen lds
s_add_u32 s49, s49, s54
s_add_u32 m0, s56, 73728
s_nop 0
buffer_load_dwordx4 v141, s[44:47], s49 offen lds
s_add_u32 s49, s49, s54
s_add_u32 m0, s56, 77824
s_nop 0
buffer_load_dwordx4 v141, s[44:47], s49 offen lds
s_add_u32 s49, s49, s54
s_add_u32 m0, s56, 81920
s_nop 0
buffer_load_dwordx4 v141, s[44:47], s49 offen lds
s_add_u32 s49, s49, s54
s_add_u32 m0, s56, 86016
s_nop 0
buffer_load_dwordx4 v141, s[44:47], s49 offen lds
s_add_u32 s49, s49, s54
s_add_u32 m0, s56, 90112
s_nop 0
buffer_load_dwordx4 v141, s[44:47], s49 offen lds
s_add_u32 s49, s49, s54
s_add_u32 m0, s56, 94208
s_nop 0
buffer_load_dwordx4 v141, s[44:47], s49 offen lds
s_add_u32 s49, s49, s54
s_lshr_b32 s16, s3, 0
s_mul_i32 s16, s16, 1
s_mul_i32 s18, s84, 4
s_add_u32 s16, s16, s18
s_and_b32 s17, s3, 0
s_mul_i32 s17, s17, 4
s_mul_i32 s18, s85, 4
s_add_u32 s17, s17, s18
v_lshlrev_b32 v4, 4, v0
s_add_u32 s36, s4, 0x7400000
s_addc_u32 s37, s5, 0
s_mov_b32 s38, 0x200000
s_mov_b32 s39, 0x00020000
s_and_b32 s16, s16, 7
s_lshl_b32 s12, s16, 17
s_lshl_b32 s18, s17, 11
s_add_u32 s12, s12, s18
s_lshl_b32 s18, s87, 20
s_add_u32 s12, s12, s18
v_bfe_u32 v4, v0, 2, 3
v_lshlrev_b32 v4, 7, v4
v_lshrrev_b32 v5, 5, v0
v_lshl_add_u32 v4, v5, 6, v4
v_and_b32 v5, 3, v0
v_lshl_add_u32 v4, v5, 4, v4
s_cmp_lg_u32 s3, 0
s_cbranch_scc1 .Lws_398
v_mul_u32_u24 v1, 0, v0
v_add_u32 v1, s86, v1
v_mov_b32 v2, 28
s_mov_b64 exec, 1
.Lwl_399:
buffer_load_dword v3, v1, s[88:91], 0 offen sc1
s_waitcnt vmcnt(0)
v_cmp_lt_u32 vcc, v3, v2
s_cbranch_vccz .Lwo_400
s_cmp_eq_u32 s80, 0
s_cbranch_scc1 .Lwo_400
s_sub_u32 s80, s80, 1
s_branch .Lwl_399
.Lwo_400:
s_mov_b64 exec, -1
.Lws_398:
s_barrier
buffer_load_dwordx4 v[8:11], v140, s[40:43], s48 offen offset:0 sc1
buffer_load_dwordx4 v[12:15], v140, s[40:43], s48 offen offset:1024 sc1
buffer_load_dwordx4 v[16:19], v140, s[40:43], s48 offen offset:2048 sc1
buffer_load_dwordx4 v[20:23], v140, s[40:43], s48 offen offset:3072 sc1
s_add_u32 s48, s48, 4096
buffer_load_dwordx4 v[24:27], v140, s[40:43], s48 offen offset:0 sc1
buffer_load_dwordx4 v[28:31], v140, s[40:43], s48 offen offset:1024 sc1
buffer_load_dwordx4 v[32:35], v140, s[40:43], s48 offen offset:2048 sc1
buffer_load_dwordx4 v[36:39], v140, s[40:43], s48 offen offset:3072 sc1
s_add_u32 s48, s48, 4096
buffer_load_dwordx4 v[40:43], v140, s[40:43], s48 offen offset:0 sc1
buffer_load_dwordx4 v[44:47], v140, s[40:43], s48 offen offset:1024 sc1
buffer_load_dwordx4 v[48:51], v140, s[40:43], s48 offen offset:2048 sc1
buffer_load_dwordx4 v[52:55], v140, s[40:43], s48 offen offset:3072 sc1
s_add_u32 s48, s48, 4096
buffer_load_dwordx4 v[56:59], v140, s[40:43], s48 offen offset:0 sc1
buffer_load_dwordx4 v[60:63], v140, s[40:43], s48 offen offset:1024 sc1
v_accvgpr_write_b32 a0, 0
v_accvgpr_write_b32 a1, 0
v_accvgpr_write_b32 a2, 0
v_accvgpr_write_b32 a3, 0
v_accvgpr_write_b32 a4, 0
v_accvgpr_write_b32 a5, 0
v_accvgpr_write_b32 a6, 0
v_accvgpr_write_b32 a7, 0
v_accvgpr_write_b32 a8, 0
v_accvgpr_write_b32 a9, 0
v_accvgpr_write_b32 a10, 0
v_accvgpr_write_b32 a11, 0
v_accvgpr_write_b32 a12, 0
v_accvgpr_write_b32 a13, 0
v_accvgpr_write_b32 a14, 0
v_accvgpr_write_b32 a15, 0
v_accvgpr_write_b32 a16, 0
v_accvgpr_write_b32 a17, 0
v_accvgpr_write_b32 a18, 0
v_accvgpr_write_b32 a19, 0
v_accvgpr_write_b32 a20, 0
v_accvgpr_write_b32 a21, 0
v_accvgpr_write_b32 a22, 0
v_accvgpr_write_b32 a23, 0
v_accvgpr_write_b32 a24, 0
v_accvgpr_write_b32 a25, 0
v_accvgpr_write_b32 a26, 0
v_accvgpr_write_b32 a27, 0
v_accvgpr_write_b32 a28, 0
v_accvgpr_write_b32 a29, 0
v_accvgpr_write_b32 a30, 0
v_accvgpr_write_b32 a31, 0
s_waitcnt vmcnt(10)
s_barrier
s_mov_b32 s51, 0
s_add_u32 s52, s56, 98304
v_mov_b32 v138, v136
v_mov_b32 v139, v137
ds_read_b64_tr_b16 v[72:73], v138 offset:0
ds_read_b64_tr_b16 v[74:75], v138 offset:1024
ds_read_b64_tr_b16 v[76:77], v139 offset:0
ds_read_b64_tr_b16 v[78:79], v139 offset:1024
ds_read_b64_tr_b16 v[80:81], v138 offset:2048
ds_read_b64_tr_b16 v[82:83], v138 offset:3072
ds_read_b64_tr_b16 v[84:85], v139 offset:2048
ds_read_b64_tr_b16 v[86:87], v139 offset:3072
ds_read_b64_tr_b16 v[88:89], v138 offset:4096
ds_read_b64_tr_b16 v[90:91], v138 offset:5120
ds_read_b64_tr_b16 v[92:93], v139 offset:4096
ds_read_b64_tr_b16 v[94:95], v139 offset:5120
ds_read_b64_tr_b16 v[96:97], v138 offset:6144
ds_read_b64_tr_b16 v[98:99], v138 offset:7168
ds_read_b64_tr_b16 v[100:101], v139 offset:6144
ds_read_b64_tr_b16 v[102:103], v139 offset:7168
s_waitcnt lgkmcnt(8)
v_mfma_f32_32x32x16_bf16 a[0:15], v[72:75], v[8:11], a[0:15]
s_waitcnt vmcnt(8)
s_barrier
ds_read_b64_tr_b16 v[104:105], v138 offset:8192
ds_read_b64_tr_b16 v[106:107], v138 offset:9216
v_mfma_f32_32x32x16_bf16 a[16:31], v[76:79], v[8:11], a[16:31]
ds_read_b64_tr_b16 v[108:109], v139 offset:8192
ds_read_b64_tr_b16 v[110:111], v139 offset:9216
s_add_u32 m0, s52, 0
s_nop 0
buffer_load_dwordx4 v141, s[44:47], s49 offen lds
s_add_u32 s49, s49, s54
v_mfma_f32_32x32x16_bf16 a[0:15], v[80:83], v[12:15], a[0:15]
ds_read_b64_tr_b16 v[112:113], v138 offset:10240
ds_read_b64_tr_b16 v[114:115], v138 offset:11264
buffer_load_dwordx4 v[64:67], v140, s[40:43], s48 offen offset:2048 sc1
v_mfma_f32_32x32x16_bf16 a[16:31], v[84:87], v[12:15], a[16:31]
ds_read_b64_tr_b16 v[116:117], v139 offset:10240
ds_read_b64_tr_b16 v[118:119], v139 offset:11264
buffer_load_dwordx4 v[68:71], v140, s[40:43], s48 offen offset:3072 sc1
s_add_u32 s48, s48, 4096
s_waitcnt lgkmcnt(8)
v_mfma_f32_32x32x16_bf16 a[0:15], v[88:91], v[16:19], a[0:15]
s_waitcnt vmcnt(9)
s_barrier
ds_read_b64_tr_b16 v[120:121], v138 offset:12288
ds_read_b64_tr_b16 v[122:123], v138 offset:13312
v_mfma_f32_32x32x16_bf16 a[16:31], v[92:95], v[16:19], a[16:31]
ds_read_b64_tr_b16 v[124:125], v139 offset:12288
ds_read_b64_tr_b16 v[126:127], v139 offset:13312
s_add_u32 m0, s52, 4096
s_nop 0
buffer_load_dwordx4 v141, s[44:47], s49 offen lds
s_add_u32 s49, s49, s54
v_mfma_f32_32x32x16_bf16 a[0:15], v[96:99], v[20:23], a[0:15]
ds_read_b64_tr_b16 v[128:129], v138 offset:14336
ds_read_b64_tr_b16 v[130:131], v138 offset:15360
buffer_load_dwordx4 v[8:11], v140, s[40:43], s48 offen offset:0 sc1
v_mfma_f32_32x32x16_bf16 a[16:31], v[100:103], v[20:23], a[16:31]
ds_read_b64_tr_b16 v[132:133], v139 offset:14336
ds_read_b64_tr_b16 v[134:135], v139 offset:15360
buffer_load_dwordx4 v[12:15], v140, s[40:43], s48 offen offset:1024 sc1
s_waitcnt lgkmcnt(8)
v_mfma_f32_32x32x16_bf16 a[0:15], v[104:107], v[24:27], a[0:15]
s_waitcnt vmcnt(10)
s_barrier
ds_read_b64_tr_b16 v[72:73], v138 offset:16384
ds_read_b64_tr_b16 v[74:75], v138 offset:17408
v_mfma_f32_32x32x16_bf16 a[16:31], v[108:111], v[24:27], a[16:31]
ds_read_b64_tr_b16 v[76:77], v139 offset:16384
ds_read_b64_tr_b16 v[78:79], v139 offset:17408
s_add_u32 m0, s52, 8192
s_nop 0
buffer_load_dwordx4 v141, s[44:47], s49 offen lds
s_add_u32 s49, s49, s54
v_mfma_f32_32x32x16_bf16 a[0:15], v[112:115], v[28:31], a[0:15]
ds_read_b64_tr_b16 v[80:81], v138 offset:18432
ds_read_b64_tr_b16 v[82:83], v138 offset:19456
buffer_load_dwordx4 v[16:19], v140, s[40:43], s48 offen offset:2048 sc1
v_mfma_f32_32x32x16_bf16 a[16:31], v[116:119], v[28:31], a[16:31]
ds_read_b64_tr_b16 v[84:85], v139 offset:18432
ds_read_b64_tr_b16 v[86:87], v139 offset:19456
buffer_load_dwordx4 v[20:23], v140, s[40:43], s48 offen offset:3072 sc1
s_add_u32 s48, s48, 4096
s_waitcnt lgkmcnt(8)
v_mfma_f32_32x32x16_bf16 a[0:15], v[120:123], v[32:35], a[0:15]
s_waitcnt vmcnt(11)
s_barrier
ds_read_b64_tr_b16 v[88:89], v138 offset:20480
ds_read_b64_tr_b16 v[90:91], v138 offset:21504
v_mfma_f32_32x32x16_bf16 a[16:31], v[124:127], v[32:35], a[16:31]
ds_read_b64_tr_b16 v[92:93], v139 offset:20480
ds_read_b64_tr_b16 v[94:95], v139 offset:21504
s_add_u32 m0, s52, 12288
s_nop 0
buffer_load_dwordx4 v141, s[44:47], s49 offen lds
s_add_u32 s49, s49, s54
v_mfma_f32_32x32x16_bf16 a[0:15], v[128:131], v[36:39], a[0:15]
ds_read_b64_tr_b16 v[96:97], v138 offset:22528
ds_read_b64_tr_b16 v[98:99], v138 offset:23552
buffer_load_dwordx4 v[24:27], v140, s[40:43], s48 offen offset:0 sc1
v_mfma_f32_32x32x16_bf16 a[16:31], v[132:135], v[36:39], a[16:31]
ds_read_b64_tr_b16 v[100:101], v139 offset:22528
ds_read_b64_tr_b16 v[102:103], v139 offset:23552
buffer_load_dwordx4 v[28:31], v140, s[40:43], s48 offen offset:1024 sc1
s_waitcnt lgkmcnt(8)
v_mfma_f32_32x32x16_bf16 a[0:15], v[72:75], v[40:43], a[0:15]
s_waitcnt vmcnt(12)
s_barrier
ds_read_b64_tr_b16 v[104:105], v138 offset:24576
ds_read_b64_tr_b16 v[106:107], v138 offset:25600
v_mfma_f32_32x32x16_bf16 a[16:31], v[76:79], v[40:43], a[16:31]
ds_read_b64_tr_b16 v[108:109], v139 offset:24576
ds_read_b64_tr_b16 v[110:111], v139 offset:25600
s_add_u32 m0, s52, 16384
s_nop 0
buffer_load_dwordx4 v141, s[44:47], s49 offen lds
s_add_u32 s49, s49, s54
v_mfma_f32_32x32x16_bf16 a[0:15], v[80:83], v[44:47], a[0:15]
ds_read_b64_tr_b16 v[112:113], v138 offset:26624
ds_read_b64_tr_b16 v[114:115], v138 offset:27648
buffer_load_dwordx4 v[32:35], v140, s[40:43], s48 offen offset:2048 sc1
v_mfma_f32_32x32x16_bf16 a[16:31], v[84:87], v[44:47], a[16:31]
ds_read_b64_tr_b16 v[116:117], v139 offset:26624
ds_read_b64_tr_b16 v[118:119], v139 offset:27648
buffer_load_dwordx4 v[36:39], v140, s[40:43], s48 offen offset:3072 sc1
s_add_u32 s48, s48, 4096
s_waitcnt lgkmcnt(8)
v_mfma_f32_32x32x16_bf16 a[0:15], v[88:91], v[48:51], a[0:15]
s_waitcnt vmcnt(12)
s_barrier
ds_read_b64_tr_b16 v[120:121], v138 offset:28672
ds_read_b64_tr_b16 v[122:123], v138 offset:29696
v_mfma_f32_32x32x16_bf16 a[16:31], v[92:95], v[48:51], a[16:31]
ds_read_b64_tr_b16 v[124:125], v139 offset:28672
ds_read_b64_tr_b16 v[126:127], v139 offset:29696
s_add_u32 m0, s52, 20480
s_nop 0
buffer_load_dwordx4 v141, s[44:47], s49 offen lds
s_add_u32 s49, s49, s54
v_mfma_f32_32x32x16_bf16 a[0:15], v[96:99], v[52:55], a[0:15]
ds_read_b64_tr_b16 v[128:129], v138 offset:30720
ds_read_b64_tr_b16 v[130:131], v138 offset:31744
buffer_load_dwordx4 v[40:43], v140, s[40:43], s48 offen offset:0 sc1
v_mfma_f32_32x32x16_bf16 a[16:31], v[100:103], v[52:55], a[16:31]
ds_read_b64_tr_b16 v[132:133], v139 offset:30720
ds_read_b64_tr_b16 v[134:135], v139 offset:31744
buffer_load_dwordx4 v[44:47], v140, s[40:43], s48 offen offset:1024 sc1
s_waitcnt lgkmcnt(8)
v_mfma_f32_32x32x16_bf16 a[0:15], v[104:107], v[56:59], a[0:15]
s_waitcnt vmcnt(12)
s_barrier
s_add_u32 s58, s51, s56
s_add_u32 s51, s51, 32768
s_cmp_eq_u32 s51, 131072
s_cselect_b32 s51, 0, s51
v_add_u32 v138, s51, v136
v_add_u32 v139, s51, v137
ds_read_b64_tr_b16 v[72:73], v138 offset:0
ds_read_b64_tr_b16 v[74:75], v138 offset:1024
v_mfma_f32_32x32x16_bf16 a[16:31], v[108:111], v[56:59], a[16:31]
ds_read_b64_tr_b16 v[76:77], v139 offset:0
ds_read_b64_tr_b16 v[78:79], v139 offset:1024
s_add_u32 m0, s52, 24576
s_nop 0
buffer_load_dwordx4 v141, s[44:47], s49 offen lds
s_add_u32 s49, s49, s54
v_mfma_f32_32x32x16_bf16 a[0:15], v[112:115], v[60:63], a[0:15]
ds_read_b64_tr_b16 v[80:81], v138 offset:2048
ds_read_b64_tr_b16 v[82:83], v138 offset:3072
buffer_load_dwordx4 v[48:51], v140, s[40:43], s48 offen offset:2048 sc1
v_mfma_f32_32x32x16_bf16 a[16:31], v[116:119], v[60:63], a[16:31]
ds_read_b64_tr_b16 v[84:85], v139 offset:2048
ds_read_b64_tr_b16 v[86:87], v139 offset:3072
buffer_load_dwordx4 v[52:55], v140, s[40:43], s48 offen offset:3072 sc1
s_add_u32 s48, s48, 4096
s_waitcnt lgkmcnt(8)
v_mfma_f32_32x32x16_bf16 a[0:15], v[120:123], v[64:67], a[0:15]
s_waitcnt vmcnt(12)
s_barrier
ds_read_b64_tr_b16 v[88:89], v138 offset:4096
ds_read_b64_tr_b16 v[90:91], v138 offset:5120
v_mfma_f32_32x32x16_bf16 a[16:31], v[124:127], v[64:67], a[16:31]
ds_read_b64_tr_b16 v[92:93], v139 offset:4096
ds_read_b64_tr_b16 v[94:95], v139 offset:5120
s_add_u32 m0, s52, 28672
s_nop 0
buffer_load_dwordx4 v141, s[44:47], s49 offen lds
s_add_u32 s49, s49, s54
v_mfma_f32_32x32x16_bf16 a[0:15], v[128:131], v[68:71], a[0:15]
ds_read_b64_tr_b16 v[96:97], v138 offset:6144
ds_read_b64_tr_b16 v[98:99], v138 offset:7168
buffer_load_dwordx4 v[56:59], v140, s[40:43], s48 offen offset:0 sc1
v_mfma_f32_32x32x16_bf16 a[16:31], v[132:135], v[68:71], a[16:31]
ds_read_b64_tr_b16 v[100:101], v139 offset:6144
ds_read_b64_tr_b16 v[102:103], v139 offset:7168
buffer_load_dwordx4 v[60:63], v140, s[40:43], s48 offen offset:1024 sc1
s_sub_u32 s50, s50, 8
s_mov_b32 s52, s58
s_cmp_le_u32 s50, 24
s_cbranch_scc1 .LgB_402
.LgD_401:
s_waitcnt lgkmcnt(8)
v_mfma_f32_32x32x16_bf16 a[0:15], v[72:75], v[8:11], a[0:15]
s_waitcnt vmcnt(12)
s_barrier
ds_read_b64_tr_b16 v[104:105], v138 offset:8192
ds_read_b64_tr_b16 v[106:107], v138 offset:9216
v_mfma_f32_32x32x16_bf16 a[16:31], v[76:79], v[8:11], a[16:31]
ds_read_b64_tr_b16 v[108:109], v139 offset:8192
ds_read_b64_tr_b16 v[110:111], v139 offset:9216
s_add_u32 m0, s52, 0
s_nop 0
buffer_load_dwordx4 v141, s[44:47], s49 offen lds
s_add_u32 s49, s49, s54
v_mfma_f32_32x32x16_bf16 a[0:15], v[80:83], v[12:15], a[0:15]
ds_read_b64_tr_b16 v[112:113], v138 offset:10240
ds_read_b64_tr_b16 v[114:115], v138 offset:11264
buffer_load_dwordx4 v[64:67], v140, s[40:43], s48 offen offset:2048 sc1
v_mfma_f32_32x32x16_bf16 a[16:31], v[84:87], v[12:15], a[16:31]
ds_read_b64_tr_b16 v[116:117], v139 offset:10240
ds_read_b64_tr_b16 v[118:119], v139 offset:11264
buffer_load_dwordx4 v[68:71], v140, s[40:43], s48 offen offset:3072 sc1
s_add_u32 s48, s48, 4096
s_waitcnt lgkmcnt(8)
v_mfma_f32_32x32x16_bf16 a[0:15], v[88:91], v[16:19], a[0:15]
s_waitcnt vmcnt(12)
s_barrier
ds_read_b64_tr_b16 v[120:121], v138 offset:12288
ds_read_b64_tr_b16 v[122:123], v138 offset:13312
v_mfma_f32_32x32x16_bf16 a[16:31], v[92:95], v[16:19], a[16:31]
ds_read_b64_tr_b16 v[124:125], v139 offset:12288
ds_read_b64_tr_b16 v[126:127], v139 offset:13312
s_add_u32 m0, s52, 4096
s_nop 0
buffer_load_dwordx4 v141, s[44:47], s49 offen lds
s_add_u32 s49, s49, s54
v_mfma_f32_32x32x16_bf16 a[0:15], v[96:99], v[20:23], a[0:15]
ds_read_b64_tr_b16 v[128:129], v138 offset:14336
ds_read_b64_tr_b16 v[130:131], v138 offset:15360
buffer_load_dwordx4 v[8:11], v140, s[40:43], s48 offen offset:0 sc1
v_mfma_f32_32x32x16_bf16 a[16:31], v[100:103], v[20:23], a[16:31]
ds_read_b64_tr_b16 v[132:133], v139 offset:14336
ds_read_b64_tr_b16 v[134:135], v139 offset:15360
buffer_load_dwordx4 v[12:15], v140, s[40:43], s48 offen offset:1024 sc1
s_waitcnt lgkmcnt(8)
v_mfma_f32_32x32x16_bf16 a[0:15], v[104:107], v[24:27], a[0:15]
s_waitcnt vmcnt(12)
s_barrier
ds_read_b64_tr_b16 v[72:73], v138 offset:16384
ds_read_b64_tr_b16 v[74:75], v138 offset:17408
v_mfma_f32_32x32x16_bf16 a[16:31], v[108:111], v[24:27], a[16:31]
ds_read_b64_tr_b16 v[76:77], v139 offset:16384
ds_read_b64_tr_b16 v[78:79], v139 offset:17408
s_add_u32 m0, s52, 8192
s_nop 0
buffer_load_dwordx4 v141, s[44:47], s49 offen lds
s_add_u32 s49, s49, s54
v_mfma_f32_32x32x16_bf16 a[0:15], v[112:115], v[28:31], a[0:15]
ds_read_b64_tr_b16 v[80:81], v138 offset:18432
ds_read_b64_tr_b16 v[82:83], v138 offset:19456
buffer_load_dwordx4 v[16:19], v140, s[40:43], s48 offen offset:2048 sc1
v_mfma_f32_32x32x16_bf16 a[16:31], v[116:119], v[28:31], a[16:31]
ds_read_b64_tr_b16 v[84:85], v139 offset:18432
ds_read_b64_tr_b16 v[86:87], v139 offset:19456
buffer_load_dwordx4 v[20:23], v140, s[40:43], s48 offen offset:3072 sc1
s_add_u32 s48, s48, 4096
s_waitcnt lgkmcnt(8)
v_mfma_f32_32x32x16_bf16 a[0:15], v[120:123], v[32:35], a[0:15]
s_waitcnt vmcnt(12)
s_barrier
ds_read_b64_tr_b16 v[88:89], v138 offset:20480
ds_read_b64_tr_b16 v[90:91], v138 offset:21504
v_mfma_f32_32x32x16_bf16 a[16:31], v[124:127], v[32:35], a[16:31]
ds_read_b64_tr_b16 v[92:93], v139 offset:20480
ds_read_b64_tr_b16 v[94:95], v139 offset:21504
s_add_u32 m0, s52, 12288
s_nop 0
buffer_load_dwordx4 v141, s[44:47], s49 offen lds
s_add_u32 s49, s49, s54
v_mfma_f32_32x32x16_bf16 a[0:15], v[128:131], v[36:39], a[0:15]
ds_read_b64_tr_b16 v[96:97], v138 offset:22528
ds_read_b64_tr_b16 v[98:99], v138 offset:23552
buffer_load_dwordx4 v[24:27], v140, s[40:43], s48 offen offset:0 sc1
v_mfma_f32_32x32x16_bf16 a[16:31], v[132:135], v[36:39], a[16:31]
ds_read_b64_tr_b16 v[100:101], v139 offset:22528
ds_read_b64_tr_b16 v[102:103], v139 offset:23552
buffer_load_dwordx4 v[28:31], v140, s[40:43], s48 offen offset:1024 sc1
s_waitcnt lgkmcnt(8)
v_mfma_f32_32x32x16_bf16 a[0:15], v[72:75], v[40:43], a[0:15]
s_waitcnt vmcnt(12)
s_barrier
ds_read_b64_tr_b16 v[104:105], v138 offset:24576
ds_read_b64_tr_b16 v[106:107], v138 offset:25600
v_mfma_f32_32x32x16_bf16 a[16:31], v[76:79], v[40:43], a[16:31]
ds_read_b64_tr_b16 v[108:109], v139 offset:24576
ds_read_b64_tr_b16 v[110:111], v139 offset:25600
s_add_u32 m0, s52, 16384
s_nop 0
buffer_load_dwordx4 v141, s[44:47], s49 offen lds
s_add_u32 s49, s49, s54
v_mfma_f32_32x32x16_bf16 a[0:15], v[80:83], v[44:47], a[0:15]
ds_read_b64_tr_b16 v[112:113], v138 offset:26624
ds_read_b64_tr_b16 v[114:115], v138 offset:27648
buffer_load_dwordx4 v[32:35], v140, s[40:43], s48 offen offset:2048 sc1
v_mfma_f32_32x32x16_bf16 a[16:31], v[84:87], v[44:47], a[16:31]
ds_read_b64_tr_b16 v[116:117], v139 offset:26624
ds_read_b64_tr_b16 v[118:119], v139 offset:27648
buffer_load_dwordx4 v[36:39], v140, s[40:43], s48 offen offset:3072 sc1
s_add_u32 s48, s48, 4096
s_waitcnt lgkmcnt(8)
v_mfma_f32_32x32x16_bf16 a[0:15], v[88:91], v[48:51], a[0:15]
s_waitcnt vmcnt(12)
s_barrier
ds_read_b64_tr_b16 v[120:121], v138 offset:28672
ds_read_b64_tr_b16 v[122:123], v138 offset:29696
v_mfma_f32_32x32x16_bf16 a[16:31], v[92:95], v[48:51], a[16:31]
ds_read_b64_tr_b16 v[124:125], v139 offset:28672
ds_read_b64_tr_b16 v[126:127], v139 offset:29696
s_add_u32 m0, s52, 20480
s_nop 0
buffer_load_dwordx4 v141, s[44:47], s49 offen lds
s_add_u32 s49, s49, s54
v_mfma_f32_32x32x16_bf16 a[0:15], v[96:99], v[52:55], a[0:15]
ds_read_b64_tr_b16 v[128:129], v138 offset:30720
ds_read_b64_tr_b16 v[130:131], v138 offset:31744
buffer_load_dwordx4 v[40:43], v140, s[40:43], s48 offen offset:0 sc1
v_mfma_f32_32x32x16_bf16 a[16:31], v[100:103], v[52:55], a[16:31]
ds_read_b64_tr_b16 v[132:133], v139 offset:30720
ds_read_b64_tr_b16 v[134:135], v139 offset:31744
buffer_load_dwordx4 v[44:47], v140, s[40:43], s48 offen offset:1024 sc1
s_waitcnt lgkmcnt(8)
v_mfma_f32_32x32x16_bf16 a[0:15], v[104:107], v[56:59], a[0:15]
s_waitcnt vmcnt(12)
s_barrier
s_add_u32 s58, s51, s56
s_add_u32 s51, s51, 32768
s_cmp_eq_u32 s51, 131072
s_cselect_b32 s51, 0, s51
v_add_u32 v138, s51, v136
v_add_u32 v139, s51, v137
ds_read_b64_tr_b16 v[72:73], v138 offset:0
ds_read_b64_tr_b16 v[74:75], v138 offset:1024
v_mfma_f32_32x32x16_bf16 a[16:31], v[108:111], v[56:59], a[16:31]
ds_read_b64_tr_b16 v[76:77], v139 offset:0
ds_read_b64_tr_b16 v[78:79], v139 offset:1024
s_add_u32 m0, s52, 24576
s_nop 0
buffer_load_dwordx4 v141, s[44:47], s49 offen lds
s_add_u32 s49, s49, s54
v_mfma_f32_32x32x16_bf16 a[0:15], v[112:115], v[60:63], a[0:15]
ds_read_b64_tr_b16 v[80:81], v138 offset:2048
ds_read_b64_tr_b16 v[82:83], v138 offset:3072
buffer_load_dwordx4 v[48:51], v140, s[40:43], s48 offen offset:2048 sc1
v_mfma_f32_32x32x16_bf16 a[16:31], v[116:119], v[60:63], a[16:31]
ds_read_b64_tr_b16 v[84:85], v139 offset:2048
ds_read_b64_tr_b16 v[86:87], v139 offset:3072
buffer_load_dwordx4 v[52:55], v140, s[40:43], s48 offen offset:3072 sc1
s_add_u32 s48, s48, 4096
s_waitcnt lgkmcnt(8)
v_mfma_f32_32x32x16_bf16 a[0:15], v[120:123], v[64:67], a[0:15]
s_waitcnt vmcnt(12)
s_barrier
ds_read_b64_tr_b16 v[88:89], v138 offset:4096
ds_read_b64_tr_b16 v[90:91], v138 offset:5120
v_mfma_f32_32x32x16_bf16 a[16:31], v[124:127], v[64:67], a[16:31]
ds_read_b64_tr_b16 v[92:93], v139 offset:4096
ds_read_b64_tr_b16 v[94:95], v139 offset:5120
s_add_u32 m0, s52, 28672
s_nop 0
buffer_load_dwordx4 v141, s[44:47], s49 offen lds
s_add_u32 s49, s49, s54
v_mfma_f32_32x32x16_bf16 a[0:15], v[128:131], v[68:71], a[0:15]
ds_read_b64_tr_b16 v[96:97], v138 offset:6144
ds_read_b64_tr_b16 v[98:99], v138 offset:7168
buffer_load_dwordx4 v[56:59], v140, s[40:43], s48 offen offset:0 sc1
v_mfma_f32_32x32x16_bf16 a[16:31], v[132:135], v[68:71], a[16:31]
ds_read_b64_tr_b16 v[100:101], v139 offset:6144
ds_read_b64_tr_b16 v[102:103], v139 offset:7168
buffer_load_dwordx4 v[60:63], v140, s[40:43], s48 offen offset:1024 sc1
s_sub_u32 s50, s50, 8
s_mov_b32 s52, s58
s_cmp_gt_u32 s50, 24
s_cbranch_scc1 .LgD_401
.LgB_402:
s_waitcnt lgkmcnt(8)
v_mfma_f32_32x32x16_bf16 a[0:15], v[72:75], v[8:11], a[0:15]
s_waitcnt vmcnt(8)
s_barrier
ds_read_b64_tr_b16 v[104:105], v138 offset:8192
ds_read_b64_tr_b16 v[106:107], v138 offset:9216
v_mfma_f32_32x32x16_bf16 a[16:31], v[76:79], v[8:11], a[16:31]
ds_read_b64_tr_b16 v[108:109], v139 offset:8192
ds_read_b64_tr_b16 v[110:111], v139 offset:9216
buffer_load_dwordx4 v[64:67], v140, s[40:43], s48 offen offset:2048 sc1
v_mfma_f32_32x32x16_bf16 a[0:15], v[80:83], v[12:15], a[0:15]
ds_read_b64_tr_b16 v[112:113], v138 offset:10240
ds_read_b64_tr_b16 v[114:115], v138 offset:11264
buffer_load_dwordx4 v[68:71], v140, s[40:43], s48 offen offset:3072 sc1
s_add_u32 s48, s48, 4096
v_mfma_f32_32x32x16_bf16 a[16:31], v[84:87], v[12:15], a[16:31]
ds_read_b64_tr_b16 v[116:117], v139 offset:10240
ds_read_b64_tr_b16 v[118:119], v139 offset:11264
s_cmp_eq_u32 s50, 8
s_cselect_b32 s42, 0, s42
s_waitcnt lgkmcnt(8)
v_mfma_f32_32x32x16_bf16 a[0:15], v[88:91], v[16:19], a[0:15]
s_waitcnt vmcnt(8)
s_barrier
ds_read_b64_tr_b16 v[120:121], v138 offset:12288
ds_read_b64_tr_b16 v[122:123], v138 offset:13312
v_mfma_f32_32x32x16_bf16 a[16:31], v[92:95], v[16:19], a[16:31]
ds_read_b64_tr_b16 v[124:125], v139 offset:12288
ds_read_b64_tr_b16 v[126:127], v139 offset:13312
buffer_load_dwordx4 v[8:11], v140, s[40:43], s48 offen offset:0 sc1
v_mfma_f32_32x32x16_bf16 a[0:15], v[96:99], v[20:23], a[0:15]
ds_read_b64_tr_b16 v[128:129], v138 offset:14336
ds_read_b64_tr_b16 v[130:131], v138 offset:15360
buffer_load_dwordx4 v[12:15], v140, s[40:43], s48 offen offset:1024 sc1
v_mfma_f32_32x32x16_bf16 a[16:31], v[100:103], v[20:23], a[16:31]
ds_read_b64_tr_b16 v[132:133], v139 offset:14336
ds_read_b64_tr_b16 v[134:135], v139 offset:15360
s_waitcnt lgkmcnt(8)
v_mfma_f32_32x32x16_bf16 a[0:15], v[104:107], v[24:27], a[0:15]
s_waitcnt vmcnt(8)
s_barrier
ds_read_b64_tr_b16 v[72:73], v138 offset:16384
ds_read_b64_tr_b16 v[74:75], v138 offset:17408
v_mfma_f32_32x32x16_bf16 a[16:31], v[108:111], v[24:27], a[16:31]
ds_read_b64_tr_b16 v[76:77], v139 offset:16384
ds_read_b64_tr_b16 v[78:79], v139 offset:17408
buffer_load_dwordx4 v[16:19], v140, s[40:43], s48 offen offset:2048 sc1
v_mfma_f32_32x32x16_bf16 a[0:15], v[112:115], v[28:31], a[0:15]
ds_read_b64_tr_b16 v[80:81], v138 offset:18432
ds_read_b64_tr_b16 v[82:83], v138 offset:19456
buffer_load_dwordx4 v[20:23], v140, s[40:43], s48 offen offset:3072 sc1
s_add_u32 s48, s48, 4096
v_mfma_f32_32x32x16_bf16 a[16:31], v[116:119], v[28:31], a[16:31]
ds_read_b64_tr_b16 v[84:85], v139 offset:18432
ds_read_b64_tr_b16 v[86:87], v139 offset:19456
s_waitcnt lgkmcnt(8)
v_mfma_f32_32x32x16_bf16 a[0:15], v[120:123], v[32:35], a[0:15]
s_waitcnt vmcnt(8)
s_barrier
ds_read_b64_tr_b16 v[88:89], v138 offset:20480
ds_read_b64_tr_b16 v[90:91], v138 offset:21504
v_mfma_f32_32x32x16_bf16 a[16:31], v[124:127], v[32:35], a[16:31]
ds_read_b64_tr_b16 v[92:93], v139 offset:20480
ds_read_b64_tr_b16 v[94:95], v139 offset:21504
buffer_load_dwordx4 v[24:27], v140, s[40:43], s48 offen offset:0 sc1
v_mfma_f32_32x32x16_bf16 a[0:15], v[128:131], v[36:39], a[0:15]
ds_read_b64_tr_b16 v[96:97], v138 offset:22528
ds_read_b64_tr_b16 v[98:99], v138 offset:23552
buffer_load_dwordx4 v[28:31], v140, s[40:43], s48 offen offset:1024 sc1
v_mfma_f32_32x32x16_bf16 a[16:31], v[132:135], v[36:39], a[16:31]
ds_read_b64_tr_b16 v[100:101], v139 offset:22528
ds_read_b64_tr_b16 v[102:103], v139 offset:23552
s_waitcnt lgkmcnt(8)
v_mfma_f32_32x32x16_bf16 a[0:15], v[72:75], v[40:43], a[0:15]
s_waitcnt vmcnt(8)
s_barrier
ds_read_b64_tr_b16 v[104:105], v138 offset:24576
ds_read_b64_tr_b16 v[106:107], v138 offset:25600
v_mfma_f32_32x32x16_bf16 a[16:31], v[76:79], v[40:43], a[16:31]
ds_read_b64_tr_b16 v[108:109], v139 offset:24576
ds_read_b64_tr_b16 v[110:111], v139 offset:25600
buffer_load_dwordx4 v[32:35], v140, s[40:43], s48 offen offset:2048 sc1
v_mfma_f32_32x32x16_bf16 a[0:15], v[80:83], v[44:47], a[0:15]
ds_read_b64_tr_b16 v[112:113], v138 offset:26624
ds_read_b64_tr_b16 v[114:115], v138 offset:27648
buffer_load_dwordx4 v[36:39], v140, s[40:43], s48 offen offset:3072 sc1
s_add_u32 s48, s48, 4096
v_mfma_f32_32x32x16_bf16 a[16:31], v[84:87], v[44:47], a[16:31]
ds_read_b64_tr_b16 v[116:117], v139 offset:26624
ds_read_b64_tr_b16 v[118:119], v139 offset:27648
s_waitcnt lgkmcnt(8)
v_mfma_f32_32x32x16_bf16 a[0:15], v[88:91], v[48:51], a[0:15]
s_waitcnt vmcnt(8)
s_barrier
ds_read_b64_tr_b16 v[120:121], v138 offset:28672
ds_read_b64_tr_b16 v[122:123], v138 offset:29696
v_mfma_f32_32x32x16_bf16 a[16:31], v[92:95], v[48:51], a[16:31]
ds_read_b64_tr_b16 v[124:125], v139 offset:28672
ds_read_b64_tr_b16 v[126:127], v139 offset:29696
buffer_load_dwordx4 v[40:43], v140, s[40:43], s48 offen offset:0 sc1
v_mfma_f32_32x32x16_bf16 a[0:15], v[96:99], v[52:55], a[0:15]
ds_read_b64_tr_b16 v[128:129], v138 offset:30720
ds_read_b64_tr_b16 v[130:131], v138 offset:31744
buffer_load_dwordx4 v[44:47], v140, s[40:43], s48 offen offset:1024 sc1
v_mfma_f32_32x32x16_bf16 a[16:31], v[100:103], v[52:55], a[16:31]
ds_read_b64_tr_b16 v[132:133], v139 offset:30720
ds_read_b64_tr_b16 v[134:135], v139 offset:31744
s_waitcnt lgkmcnt(8)
v_mfma_f32_32x32x16_bf16 a[0:15], v[104:107], v[56:59], a[0:15]
s_waitcnt vmcnt(8)
s_barrier
s_add_u32 s58, s51, s56
s_add_u32 s51, s51, 32768
s_cmp_eq_u32 s51, 131072
s_cselect_b32 s51, 0, s51
v_add_u32 v138, s51, v136
v_add_u32 v139, s51, v137
ds_read_b64_tr_b16 v[72:73], v138 offset:0
ds_read_b64_tr_b16 v[74:75], v138 offset:1024
v_mfma_f32_32x32x16_bf16 a[16:31], v[108:111], v[56:59], a[16:31]
ds_read_b64_tr_b16 v[76:77], v139 offset:0
ds_read_b64_tr_b16 v[78:79], v139 offset:1024
buffer_load_dwordx4 v[48:51], v140, s[40:43], s48 offen offset:2048 sc1
v_mfma_f32_32x32x16_bf16 a[0:15], v[112:115], v[60:63], a[0:15]
ds_read_b64_tr_b16 v[80:81], v138 offset:2048
ds_read_b64_tr_b16 v[82:83], v138 offset:3072
buffer_load_dwordx4 v[52:55], v140, s[40:43], s48 offen offset:3072 sc1
s_add_u32 s48, s48, 4096
v_mfma_f32_32x32x16_bf16 a[16:31], v[116:119], v[60:63], a[16:31]
ds_read_b64_tr_b16 v[84:85], v139 offset:2048
ds_read_b64_tr_b16 v[86:87], v139 offset:3072
s_waitcnt lgkmcnt(8)
v_mfma_f32_32x32x16_bf16 a[0:15], v[120:123], v[64:67], a[0:15]
s_waitcnt vmcnt(8)
s_barrier
ds_read_b64_tr_b16 v[88:89], v138 offset:4096
ds_read_b64_tr_b16 v[90:91], v138 offset:5120
v_mfma_f32_32x32x16_bf16 a[16:31], v[124:127], v[64:67], a[16:31]
ds_read_b64_tr_b16 v[92:93], v139 offset:4096
ds_read_b64_tr_b16 v[94:95], v139 offset:5120
buffer_load_dwordx4 v[56:59], v140, s[40:43], s48 offen offset:0 sc1
v_mfma_f32_32x32x16_bf16 a[0:15], v[128:131], v[68:71], a[0:15]
ds_read_b64_tr_b16 v[96:97], v138 offset:6144
ds_read_b64_tr_b16 v[98:99], v138 offset:7168
buffer_load_dwordx4 v[60:63], v140, s[40:43], s48 offen offset:1024 sc1
v_mfma_f32_32x32x16_bf16 a[16:31], v[132:135], v[68:71], a[16:31]
ds_read_b64_tr_b16 v[100:101], v139 offset:6144
ds_read_b64_tr_b16 v[102:103], v139 offset:7168
s_sub_u32 s50, s50, 8
s_cmp_lg_u32 s50, 0
s_cbranch_scc1 .LgB_402
s_waitcnt vmcnt(0) lgkmcnt(0)
s_nop 15
s_add_u32 s57, s12, 0
buffer_store_dwordx4 a[0:3], v4, s[36:39], s57 offen offset:0 sc1
buffer_store_dwordx4 a[4:7], v4, s[36:39], s57 offen offset:1024 sc1
buffer_store_dwordx4 a[8:11], v4, s[36:39], s57 offen offset:2048 sc1
buffer_store_dwordx4 a[12:15], v4, s[36:39], s57 offen offset:3072 sc1
s_add_u32 s57, s12, 4096
buffer_store_dwordx4 a[16:19], v4, s[36:39], s57 offen offset:0 sc1
buffer_store_dwordx4 a[20:23], v4, s[36:39], s57 offen offset:1024 sc1
buffer_store_dwordx4 a[24:27], v4, s[36:39], s57 offen offset:2048 sc1
buffer_store_dwordx4 a[28:31], v4, s[36:39], s57 offen offset:3072 sc1
s_add_u32 s86, s70, 119574528
s_bfe_u32 s82, s77, 0x10000
s_mul_i32 s82, s82, 512
s_add_u32 s86, s86, s82
s_bfe_u32 s82, s77, 0x10004
s_mul_i32 s82, s82, 128
s_add_u32 s86, s86, s82
s_waitcnt vmcnt(0)
s_barrier
s_cmp_lg_u32 s3, 0
s_cbranch_scc1 .Lsg_403
v_mov_b32 v1, 1
v_mul_u32_u24 v2, 0, v0
s_mov_b64 exec, 1
buffer_atomic_add v1, v2, s[88:91], s86 offen sc1
s_mov_b64 exec, -1
.Lsg_403:
s_and_b32 s84, s77, 1
s_lshl_b32 s84, s84, 1
s_add_u32 s84, s84, s87
s_lshl_b32 s84, s84, 1
s_bfe_u32 s81, s77, 0x10003
s_add_u32 s84, s84, s81
s_add_u32 s84, s84, 48
s_bfe_u32 s85, s77, 0x20001
s_lshr_b32 s83, s77, 4
s_lshl_b32 s83, s83, 5
s_load_dwordx2 s[6:7], s[0:1], 96
s_add_u32 s12, s4, 0x400000
s_addc_u32 s13, s5, 0
s_mov_b32 s14, 0x400000
s_mov_b32 s15, 0x00020000
s_add_u32 s16, s4, 0xc00000
s_addc_u32 s17, s5, 0
s_mov_b32 s18, 0x6000
s_mov_b32 s19, 0x00020000
s_add_u32 s24, s4, 0x7400000
s_addc_u32 s25, s5, 0
s_mov_b32 s26, 0x200000
s_mov_b32 s27, 0x00020000
v_and_b32 v4, 7, v0
v_bfe_u32 v5, v0, 3, 1
v_lshrrev_b32 v6, 4, v0
s_lshl_b32 s28, s85, 3
v_add_u32 v4, s28, v4
s_mul_i32 s28, s3, 8
s_add_u32 s28, s28, s83
v_add_u32 v6, s28, v6
v_lshl_add_u32 v7, v5, 5, v4
v_lshlrev_b32 v7, 4, v7
v_lshl_add_u32 v8, v6, 10, v7
v_lshrrev_b32 v7, 2, v4
v_lshlrev_b32 v7, 7, v7
v_lshl_add_u32 v7, v5, 6, v7
v_and_b32 v9, 3, v4
v_lshl_add_u32 v7, v9, 4, v7
v_lshl_add_u32 v9, v6, 11, v7
v_lshlrev_b32 v10, 5, v5
v_lshl_add_u32 v10, v6, 6, v10
s_lshl_b32 s28, s84, 16
s_and_b32 s29, s84, 7
s_lshl_b32 s29, s29, 17
s_mov_b32 s30, 20480
buffer_load_dwordx4 v[208:211], v10, s[16:19], s30 offen offset:0
buffer_load_dwordx4 v[212:215], v10, s[16:19], s30 offen offset:16
buffer_load_dwordx4 v[216:219], v10, s[16:19], s30 offen offset:256
buffer_load_dwordx4 v[220:223], v10, s[16:19], s30 offen offset:272
s_waitcnt lgkmcnt(0)
s_mov_b32 s20, s6
s_mov_b32 s21, s7
s_mov_b32 s22, 0x400000
s_mov_b32 s23, 0x00020000
v_lshlrev_b32 v11, 11, v4
v_lshl_add_u32 v11, v6, 5, v11
v_lshl_add_u32 v11, v5, 3, v11
s_add_u32 s31, s28, 0
buffer_load_dwordx4 v[192:195], v8, s[12:15], s31 offen sc1
s_add_u32 s31, s28, 4096
buffer_load_dwordx4 v[196:199], v8, s[12:15], s31 offen sc1
s_cmp_lg_u32 s3, 0
s_cbranch_scc1 .Lws_404
v_mul_u32_u24 v1, 0, v0
v_add_u32 v1, s86, v1
v_mov_b32 v2, 16
s_mov_b64 exec, 1
.Lwl_405:
buffer_load_dword v3, v1, s[88:91], 0 offen sc1
s_waitcnt vmcnt(0)
v_cmp_lt_u32 vcc, v3, v2
s_cbranch_vccz .Lwo_406
s_cmp_eq_u32 s80, 0
s_cbranch_scc1 .Lwo_406
s_sub_u32 s80, s80, 1
s_branch .Lwl_405
.Lwo_406:
s_mov_b64 exec, -1
.Lws_404:
s_barrier
s_add_u32 s31, s29, 0
buffer_load_dwordx4 v[64:67], v9, s[24:27], s31 offen offset:0 sc1
buffer_load_dwordx4 v[68:71], v9, s[24:27], s31 offen offset:1024 sc1
s_add_u32 s31, s29, 1048576
buffer_load_dwordx4 v[72:75], v9, s[24:27], s31 offen offset:0 sc1
buffer_load_dwordx4 v[76:79], v9, s[24:27], s31 offen offset:1024 sc1
s_add_u32 s31, s29, 8192
buffer_load_dwordx4 v[96:99], v9, s[24:27], s31 offen offset:0 sc1
buffer_load_dwordx4 v[100:103], v9, s[24:27], s31 offen offset:1024 sc1
s_add_u32 s31, s29, 1056768
buffer_load_dwordx4 v[104:107], v9, s[24:27], s31 offen offset:0 sc1
buffer_load_dwordx4 v[108:111], v9, s[24:27], s31 offen offset:1024 sc1
v_mov_b32 v12, 0x3f803f80
v_mov_b32 v16, 0
v_mov_b32 v17, 0
v_mov_b32 v18, 0
v_mov_b32 v19, 0
s_waitcnt vmcnt(4)
v_pk_add_f32 v[64:65], v[64:65], v[72:73]
v_pk_add_f32 v[66:67], v[66:67], v[74:75]
v_pk_add_f32 v[68:69], v[68:69], v[76:77]
v_pk_add_f32 v[70:71], v[70:71], v[78:79]
v_cvt_pk_bf16_f32 v248, v64, v65
v_cvt_pk_bf16_f32 v249, v66, v67
v_cvt_pk_bf16_f32 v250, v68, v69
v_cvt_pk_bf16_f32 v251, v70, v71
v_lshlrev_b32 v240, 16, v248
v_and_b32 v241, 0xffff0000, v248
v_lshlrev_b32 v242, 16, v249
v_and_b32 v243, 0xffff0000, v249
v_lshlrev_b32 v244, 16, v250
v_and_b32 v245, 0xffff0000, v250
v_lshlrev_b32 v246, 16, v251
v_and_b32 v247, 0xffff0000, v251
v_mul_f32 v240, v240, v208
v_mul_f32 v241, v241, v209
v_mul_f32 v242, v242, v210
v_mul_f32 v243, v243, v211
v_mul_f32 v244, v244, v212
v_mul_f32 v245, v245, v213
v_mul_f32 v246, v246, v214
v_mul_f32 v247, v247, v215
v_cvt_pk_bf16_f32 v248, v240, v241
v_cvt_pk_bf16_f32 v249, v242, v243
v_cvt_pk_bf16_f32 v250, v244, v245
v_cvt_pk_bf16_f32 v251, v246, v247
v_lshlrev_b32 v240, 16, v248
v_and_b32 v241, 0xffff0000, v248
v_lshlrev_b32 v248, 16, v192
v_and_b32 v192, 0xffff0000, v192
v_lshlrev_b32 v242, 16, v249
v_and_b32 v243, 0xffff0000, v249
v_lshlrev_b32 v249, 16, v193
v_and_b32 v193, 0xffff0000, v193
v_lshlrev_b32 v244, 16, v250
v_and_b32 v245, 0xffff0000, v250
v_lshlrev_b32 v250, 16, v194
v_and_b32 v194, 0xffff0000, v194
v_lshlrev_b32 v246, 16, v251
v_and_b32 v247, 0xffff0000, v251
v_lshlrev_b32 v251, 16, v195
v_and_b32 v195, 0xffff0000, v195
v_add_f32 v240, v240, v248
v_add_f32 v241, v241, v192
v_add_f32 v242, v242, v249
v_add_f32 v243, v243, v193
v_add_f32 v244, v244, v250
v_add_f32 v245, v245, v194
v_add_f32 v246, v246, v251
v_add_f32 v247, v247, v195
v_cvt_pk_bf16_f32 v192, v240, v241
v_cvt_pk_bf16_f32 v193, v242, v243
v_cvt_pk_bf16_f32 v194, v244, v245
v_cvt_pk_bf16_f32 v195, v246, v247
buffer_store_dwordx2 v[192:193], v11, s[20:23], s28 offen offset:0
buffer_store_dwordx2 v[194:195], v11, s[20:23], s28 offen offset:16
s_waitcnt vmcnt(2)
v_pk_add_f32 v[96:97], v[96:97], v[104:105]
v_pk_add_f32 v[98:99], v[98:99], v[106:107]
v_pk_add_f32 v[100:101], v[100:101], v[108:109]
v_pk_add_f32 v[102:103], v[102:103], v[110:111]
v_cvt_pk_bf16_f32 v248, v96, v97
v_cvt_pk_bf16_f32 v249, v98, v99
v_cvt_pk_bf16_f32 v250, v100, v101
v_cvt_pk_bf16_f32 v251, v102, v103
v_lshlrev_b32 v240, 16, v248
v_and_b32 v241, 0xffff0000, v248
v_lshlrev_b32 v242, 16, v249
v_and_b32 v243, 0xffff0000, v249
v_lshlrev_b32 v244, 16, v250
v_and_b32 v245, 0xffff0000, v250
v_lshlrev_b32 v246, 16, v251
v_and_b32 v247, 0xffff0000, v251
v_mul_f32 v240, v240, v216
v_mul_f32 v241, v241, v217
v_mul_f32 v242, v242, v218
v_mul_f32 v243, v243, v219
v_mul_f32 v244, v244, v220
v_mul_f32 v245, v245, v221
v_mul_f32 v246, v246, v222
v_mul_f32 v247, v247, v223
v_cvt_pk_bf16_f32 v248, v240, v241
v_cvt_pk_bf16_f32 v249, v242, v243
v_cvt_pk_bf16_f32 v250, v244, v245
v_cvt_pk_bf16_f32 v251, v246, v247
v_lshlrev_b32 v240, 16, v248
v_and_b32 v241, 0xffff0000, v248
v_lshlrev_b32 v248, 16, v196
v_and_b32 v196, 0xffff0000, v196
v_lshlrev_b32 v242, 16, v249
v_and_b32 v243, 0xffff0000, v249
v_lshlrev_b32 v249, 16, v197
v_and_b32 v197, 0xffff0000, v197
v_lshlrev_b32 v244, 16, v250
v_and_b32 v245, 0xffff0000, v250
v_lshlrev_b32 v250, 16, v198
v_and_b32 v198, 0xffff0000, v198
v_lshlrev_b32 v246, 16, v251
v_and_b32 v247, 0xffff0000, v251
v_lshlrev_b32 v251, 16, v199
v_and_b32 v199, 0xffff0000, v199
v_add_f32 v240, v240, v248
v_add_f32 v241, v241, v196
v_add_f32 v242, v242, v249
v_add_f32 v243, v243, v197
v_add_f32 v244, v244, v250
v_add_f32 v245, v245, v198
v_add_f32 v246, v246, v251
v_add_f32 v247, v247, v199
v_cvt_pk_bf16_f32 v196, v240, v241
v_cvt_pk_bf16_f32 v197, v242, v243
v_cvt_pk_bf16_f32 v198, v244, v245
v_cvt_pk_bf16_f32 v199, v246, v247
buffer_store_dwordx2 v[196:197], v11, s[20:23], s28 offen offset:128
buffer_store_dwordx2 v[198:199], v11, s[20:23], s28 offen offset:144
.Ldone_373:
s_waitcnt vmcnt(0)
s_endpgm
.section .rodata,"a"
.p2align 6
.amdhsa_kernel main_kernel
.amdhsa_next_free_vgpr 512
.amdhsa_next_free_sgpr 102
.amdhsa_accum_offset 256
.amdhsa_group_segment_fixed_size 0
.amdhsa_kernarg_size 120
.amdhsa_user_sgpr_count 2
.amdhsa_user_sgpr_kernarg_segment_ptr 1
.amdhsa_system_sgpr_workgroup_id_x 1
.end_amdhsa_kernel
```
